```python
import torch

def _softmax(x, axis=-1):
    return torch.softmax(x, dim=axis)
def _gelu(x):
    return torch.nn.functional.gelu(x, approximate="tanh")
def _silu(x):
    return torch.nn.functional.silu(x)
def _sigmoid(x):
    return torch.sigmoid(x)
def _layernorm(x, axis=-1, eps=1e-5):
    m = x.mean(dim=axis, keepdim=True)
    v = x.var(dim=axis, keepdim=True, unbiased=False)
    return (x - m) / torch.sqrt(v + eps)
def _scatter_add(tgt, idx, src, axis=0):
    return tgt.clone().index_add_(axis, idx, src)
def _segment_sum(src, seg, n):
    out = torch.zeros((n,) + src.shape[1:], dtype=src.dtype)
    return out.index_add_(0, seg, src)
def _pad(x, pw):
    flat = tuple(v for pair in reversed(pw) for v in pair)
    return torch.nn.functional.pad(x, flat)

kernel_name = 'interleave_layers__spectral_gfnet__dense_activation_silu__prompt'

def setup_inputs():

    _w = (lambda a: (lambda t: t.to(torch.bfloat16) if t.is_floating_point() else t)(torch.as_tensor(a)))
    def _A_setup():
        B, S, D = 1, 2048, 640
        Df = D // 2 + 1
        return {
            "x": _w((lambda *s: torch.randn(*s, dtype=torch.bfloat16) * 0.05)(B, S, D)),
            "w_r": _w((lambda *s: torch.randn(*s, dtype=torch.bfloat16) * 0.4)(S, Df) * 0.02),
            "w_i": _w((lambda *s: torch.randn(*s, dtype=torch.bfloat16) * 0.4)(S, Df) * 0.02),
        }
    _A_in = _A_setup()

    def _B_setup():
        B, S, D, F = 1, 2048, 640, 1536
        return {
            "x": _w((lambda *s: torch.randn(*s, dtype=torch.bfloat16) * 0.05)(B, S, D)),
            "w1": _w((lambda *s: torch.randn(*s, dtype=torch.bfloat16) * 0.4)(D, F) * (D ** -0.5)),
            "w2": _w((lambda *s: torch.randn(*s, dtype=torch.bfloat16) * 0.1)(F, D) * (F ** -0.5)),
        }
    _B_in = _B_setup()

    return {
        "A_x": _A_in["x"],
        "A_w_r": _A_in["w_r"],
        "A_w_i": _A_in["w_i"],
        "B_x": _B_in["x"],
        "B_w1": _B_in["w1"],
        "B_w2": _B_in["w2"],
    }

def reference(A_x, A_w_r, A_w_i, B_x, B_w1, B_w2):
    def _A_ref(x, w_r, w_i):
        B, S, D = x.shape
        X = (lambda x, axes=(-2,-1): torch.fft.rfft2(x.float(), dim=axes))(x, axes=(-2, -1))
        W = w_r + 1j * w_i
        X = X * W
        y = (lambda x, s, axes=(-2,-1): torch.fft.irfft2(x, s=s, dim=axes).to(torch.bfloat16))(X, (S, D), axes=(-2, -1))
        return y

    def _B_ref(x, w1, w2):
        h = torch.einsum("bsd,df->bsf", x, w1)
        h = _silu(h)
        out = torch.einsum("bsf,fd->bsd", h, w2)
        return out

    x = A_x
    x = x + _A_ref(_layernorm(x, axis=-1), A_w_r, A_w_i)
    x = x + _B_ref(_layernorm(x, axis=-1), B_w1, B_w2)
    x = x + _A_ref(_layernorm(x, axis=-1), A_w_r, A_w_i)
    x = x + _B_ref(_layernorm(x, axis=-1), B_w1, B_w2)
    return x
```

```asm
; @launch kernel=k1_kernel grid=(448,1,1) block=(256,1,1) lds=37632
; @launch kernel=c1_kernel grid=(252,1,1) block=(256,1,1) lds=83968
; @launch kernel=g12a_kernel grid=(256,1,1) block=(256,1,1) lds=159744
; @launch kernel=c2_kernel grid=(192,1,1) block=(256,1,1) lds=83968
; @launch kernel=g12b_kernel grid=(256,1,1) block=(256,1,1) lds=159744
.amdgcn_target "amdgcn-amd-amdhsa--gfx950"
.text
.globl k1_kernel
.p2align 8
.type k1_kernel,@function
k1_kernel:
    s_cmp_ge_u32 s2, 384
    s_cbranch_scc1 L_k1_touch
    s_load_dwordx2 s[4:5], s[0:1], 64
    s_load_dwordx2 s[32:33], s[0:1], 0
    s_load_dwordx2 s[34:35], s[0:1], 8
    s_load_dwordx2 s[36:37], s[0:1], 16
    s_getpc_b64 s[6:7]
    s_add_u32 s6, s6, tab_base@rel32@lo+4
    s_addc_u32 s7, s7, tab_base@rel32@hi+12
    s_mov_b32 s12, s6
    s_and_b32 s13, s7, 0xffff
    s_mov_b32 s14, 121344
    s_mov_b32 s15, 0x20000
    s_waitcnt lgkmcnt(0)
    s_mov_b32 s8, s4
    s_and_b32 s9, s5, 0xffff
    s_mov_b32 s10, 0x10000000
    s_mov_b32 s11, 0x20000
    s_mov_b32 s16, s32
    s_and_b32 s17, s33, 0xffff
    s_mov_b32 s18, 2621440
    s_mov_b32 s19, 0x20000
    s_mov_b32 s20, s34
    s_and_b32 s21, s35, 0xffff
    s_mov_b32 s22, 1314816
    s_mov_b32 s23, 0x20000
    s_mov_b32 s24, s36
    s_and_b32 s25, s37, 0xffff
    s_mov_b32 s26, 1314816
    s_mov_b32 s27, 0x20000
    v_and_b32 v2, 15, v0
    v_bfe_u32 v3, v0, 4, 2
    v_lshrrev_b32 v1, 6, v0
    s_nop 0
    v_readfirstlane_b32 s44, v1
    s_mov_b32 s46, 0x05040100
    s_mov_b32 s47, 0x07060302
    s_cmp_ge_u32 s2, 128
    s_cbranch_scc1 L_k1_w
    s_lshl_b32 s45, s2, 4
    v_add_u32 v4, s45, v2
    s_mul_i32 s48, s2, 20480
    v_lshlrev_b32 v5, 4, v0
    s_add_u32 s49, s48, 0
    buffer_load_dwordx4 v[40:43], v5, s[16:19], s49 offen
    s_add_u32 s49, s48, 4096
    buffer_load_dwordx4 v[44:47], v5, s[16:19], s49 offen
    s_add_u32 s49, s48, 8192
    buffer_load_dwordx4 v[48:51], v5, s[16:19], s49 offen
    s_add_u32 s49, s48, 12288
    buffer_load_dwordx4 v[52:55], v5, s[16:19], s49 offen
    s_add_u32 s49, s48, 16384
    buffer_load_dwordx4 v[56:59], v5, s[16:19], s49 offen
    v_and_b32 v6, 63, v0
    v_lshlrev_b32 v6, 4, v6
    s_lshl_b32 s50, s44, 10
    s_add_u32 m0, s50, 512
    s_add_u32 s50, s50, 0
    buffer_load_dwordx4 v6, s[12:15], s50 offen lds
    s_add_u32 m0, m0, 4096
    s_add_u32 s50, s50, 4096
    buffer_load_dwordx4 v6, s[12:15], s50 offen lds
    s_add_u32 m0, m0, 4096
    s_add_u32 s50, s50, 4096
    buffer_load_dwordx4 v6, s[12:15], s50 offen lds
    s_add_u32 m0, m0, 4096
    s_add_u32 s50, s50, 4096
    buffer_load_dwordx4 v6, s[12:15], s50 offen lds
    s_mov_b32 s48, 52429
    v_add_u32 v7, 0, v0
    v_mul_lo_u32 v8, v7, s48
    v_lshrrev_b32 v8, 22, v8
    v_lshlrev_b32 v7, 4, v7
    v_lshl_add_u32 v7, v8, 4, v7
    s_waitcnt vmcnt(8)
    ds_write_b128 v7, v[40:43] offset:16896
    v_add_u32 v7, 256, v0
    v_mul_lo_u32 v8, v7, s48
    v_lshrrev_b32 v8, 22, v8
    v_lshlrev_b32 v7, 4, v7
    v_lshl_add_u32 v7, v8, 4, v7
    s_waitcnt vmcnt(7)
    ds_write_b128 v7, v[44:47] offset:16896
    v_add_u32 v7, 512, v0
    v_mul_lo_u32 v8, v7, s48
    v_lshrrev_b32 v8, 22, v8
    v_lshlrev_b32 v7, 4, v7
    v_lshl_add_u32 v7, v8, 4, v7
    s_waitcnt vmcnt(6)
    ds_write_b128 v7, v[48:51] offset:16896
    v_add_u32 v7, 768, v0
    v_mul_lo_u32 v8, v7, s48
    v_lshrrev_b32 v8, 22, v8
    v_lshlrev_b32 v7, 4, v7
    v_lshl_add_u32 v7, v8, 4, v7
    s_waitcnt vmcnt(5)
    ds_write_b128 v7, v[52:55] offset:16896
    v_add_u32 v7, 1024, v0
    v_mul_lo_u32 v8, v7, s48
    v_lshrrev_b32 v8, 22, v8
    v_lshlrev_b32 v7, 4, v7
    v_lshl_add_u32 v7, v8, 4, v7
    s_waitcnt vmcnt(4)
    ds_write_b128 v7, v[56:59] offset:16896
    s_waitcnt vmcnt(0)
    s_waitcnt lgkmcnt(0)
    s_barrier
    v_mul_u32_u24 v5, 1296, v2
    v_lshl_add_u32 v5, v3, 6, v5
    s_lshl_b32 s49, s44, 2
    v_add_u32 v5, s49, v5
    ds_read_b32 v16, v5 offset:16896
    ds_read_b32 v17, v5 offset:16912
    ds_read_b32 v18, v5 offset:16928
    ds_read_b32 v19, v5 offset:16944
    ds_read_b32 v20, v5 offset:17152
    ds_read_b32 v21, v5 offset:17168
    ds_read_b32 v22, v5 offset:17184
    ds_read_b32 v23, v5 offset:17200
    ds_read_b32 v24, v5 offset:17408
    ds_read_b32 v25, v5 offset:17424
    ds_read_b32 v26, v5 offset:17440
    ds_read_b32 v27, v5 offset:17456
    ds_read_b32 v28, v5 offset:17664
    ds_read_b32 v29, v5 offset:17680
    ds_read_b32 v30, v5 offset:17696
    ds_read_b32 v31, v5 offset:17712
    ds_read_b32 v32, v5 offset:17920
    ds_read_b32 v33, v5 offset:17936
    ds_read_b32 v34, v5 offset:17952
    ds_read_b32 v35, v5 offset:17968
    ds_read_b128 a[0:3], v6 offset:512
    ds_read_b128 a[4:7], v6 offset:1536
    ds_read_b128 a[8:11], v6 offset:2560
    ds_read_b128 a[12:15], v6 offset:3584
    ds_read_b128 a[16:19], v6 offset:4608
    ds_read_b128 a[20:23], v6 offset:5632
    ds_read_b128 a[24:27], v6 offset:6656
    ds_read_b128 a[28:31], v6 offset:7680
    ds_read_b128 a[32:35], v6 offset:8704
    ds_read_b128 a[36:39], v6 offset:9728
    ds_read_b128 a[40:43], v6 offset:10752
    ds_read_b128 a[44:47], v6 offset:11776
    ds_read_b128 a[48:51], v6 offset:12800
    ds_read_b128 a[52:55], v6 offset:13824
    ds_read_b128 a[56:59], v6 offset:14848
    v_lshlrev_b32 v7, 2, v4
    v_lshl_add_u32 v7, v3, 17, v7
    v_mov_b32 v8, v7
    v_cmp_eq_u32 vcc, 0, v3
    v_add_u32 v9, 2621440, v7
    s_nop 0
    v_cndmask_b32 v8, v7, v9, vcc
    v_lshlrev_b32 v9, 3, v4
    v_mov_b32 v12, 0
    v_mov_b32 v13, 0
    v_lshlrev_b32 v10, 6, v4
    v_lshl_add_u32 v10, v3, 4, v10
    s_mul_i32 s54, s44, 655360
    s_add_u32 s54, s54, 16777216
    s_waitcnt lgkmcnt(15)
    v_perm_b32 v104, v17, v16, s46
    v_perm_b32 v105, v19, v18, s46
    v_perm_b32 v106, v17, v16, s47
    v_perm_b32 v107, v19, v18, s47
    s_add_u32 s55, s54, 0
    buffer_store_dwordx4 v[104:107], v10, s[8:11], s55 offen
    v_perm_b32 v108, v21, v20, s46
    v_perm_b32 v109, v23, v22, s46
    v_perm_b32 v110, v21, v20, s47
    v_perm_b32 v111, v23, v22, s47
    s_add_u32 s55, s54, 131072
    buffer_store_dwordx4 v[108:111], v10, s[8:11], s55 offen
    v_perm_b32 v112, v25, v24, s46
    v_perm_b32 v113, v27, v26, s46
    v_perm_b32 v114, v25, v24, s47
    v_perm_b32 v115, v27, v26, s47
    s_add_u32 s55, s54, 262144
    buffer_store_dwordx4 v[112:115], v10, s[8:11], s55 offen
    v_perm_b32 v116, v29, v28, s46
    v_perm_b32 v117, v31, v30, s46
    v_perm_b32 v118, v29, v28, s47
    v_perm_b32 v119, v31, v30, s47
    s_add_u32 s55, s54, 393216
    buffer_store_dwordx4 v[116:119], v10, s[8:11], s55 offen
    v_perm_b32 v120, v33, v32, s46
    v_perm_b32 v121, v35, v34, s46
    v_perm_b32 v122, v33, v32, s47
    v_perm_b32 v123, v35, v34, s47
    s_add_u32 s55, s54, 524288
    buffer_store_dwordx4 v[120:123], v10, s[8:11], s55 offen
    s_lshl_b32 s51, s44, 1
    s_add_u32 s51, s51, 0
    s_lshl_b32 s52, s51, 13
    s_add_u32 s52, s52, 9437184
    v_lshlrev_b32 v40, 16, v16
    v_lshlrev_b32 v41, 16, v17
    v_lshlrev_b32 v42, 16, v18
    v_lshlrev_b32 v43, 16, v19
    v_lshlrev_b32 v44, 16, v20
    v_lshlrev_b32 v45, 16, v21
    v_lshlrev_b32 v46, 16, v22
    v_lshlrev_b32 v47, 16, v23
    v_lshlrev_b32 v48, 16, v24
    v_lshlrev_b32 v49, 16, v25
    v_lshlrev_b32 v50, 16, v26
    v_lshlrev_b32 v51, 16, v27
    v_lshlrev_b32 v52, 16, v28
    v_lshlrev_b32 v53, 16, v29
    v_lshlrev_b32 v54, 16, v30
    v_lshlrev_b32 v55, 16, v31
    v_lshlrev_b32 v56, 16, v32
    v_lshlrev_b32 v57, 16, v33
    v_lshlrev_b32 v58, 16, v34
    v_lshlrev_b32 v59, 16, v35
    v_pk_add_f32 v[68:69], v[40:41], v[42:43]
    v_pk_add_f32 v[68:69], v[68:69], v[44:45]
    v_pk_add_f32 v[68:69], v[68:69], v[46:47]
    v_pk_add_f32 v[68:69], v[68:69], v[48:49]
    v_pk_add_f32 v[68:69], v[68:69], v[50:51]
    v_pk_add_f32 v[68:69], v[68:69], v[52:53]
    v_pk_add_f32 v[68:69], v[68:69], v[54:55]
    v_pk_add_f32 v[68:69], v[68:69], v[56:57]
    v_pk_add_f32 v[68:69], v[68:69], v[58:59]
    v_add_f32 v64, v68, v69
    v_mov_b32 v65, v64
    s_nop 1
    v_permlane32_swap_b32 v64, v65
    v_add_f32 v64, v64, v65
    v_mov_b32 v65, v64
    s_nop 1
    v_permlane16_swap_b32 v64, v65
    v_add_f32 v64, v64, v65
    v_mul_f32 v66, 0x3c4ccccd, v64
    v_pk_add_f32 v[40:41], v[40:41], v[66:67] op_sel_hi:[1,0] neg_lo:[0,1] neg_hi:[0,1]
    v_pk_add_f32 v[42:43], v[42:43], v[66:67] op_sel_hi:[1,0] neg_lo:[0,1] neg_hi:[0,1]
    v_pk_add_f32 v[44:45], v[44:45], v[66:67] op_sel_hi:[1,0] neg_lo:[0,1] neg_hi:[0,1]
    v_pk_add_f32 v[46:47], v[46:47], v[66:67] op_sel_hi:[1,0] neg_lo:[0,1] neg_hi:[0,1]
    v_pk_add_f32 v[48:49], v[48:49], v[66:67] op_sel_hi:[1,0] neg_lo:[0,1] neg_hi:[0,1]
    v_pk_add_f32 v[50:51], v[50:51], v[66:67] op_sel_hi:[1,0] neg_lo:[0,1] neg_hi:[0,1]
    v_pk_add_f32 v[52:53], v[52:53], v[66:67] op_sel_hi:[1,0] neg_lo:[0,1] neg_hi:[0,1]
    v_pk_add_f32 v[54:55], v[54:55], v[66:67] op_sel_hi:[1,0] neg_lo:[0,1] neg_hi:[0,1]
    v_pk_add_f32 v[56:57], v[56:57], v[66:67] op_sel_hi:[1,0] neg_lo:[0,1] neg_hi:[0,1]
    v_pk_add_f32 v[58:59], v[58:59], v[66:67] op_sel_hi:[1,0] neg_lo:[0,1] neg_hi:[0,1]
    v_pk_mul_f32 v[68:69], v[40:41], v[40:41]
    v_pk_fma_f32 v[68:69], v[42:43], v[42:43], v[68:69]
    v_pk_fma_f32 v[68:69], v[44:45], v[44:45], v[68:69]
    v_pk_fma_f32 v[68:69], v[46:47], v[46:47], v[68:69]
    v_pk_fma_f32 v[68:69], v[48:49], v[48:49], v[68:69]
    v_pk_fma_f32 v[68:69], v[50:51], v[50:51], v[68:69]
    v_pk_fma_f32 v[68:69], v[52:53], v[52:53], v[68:69]
    v_pk_fma_f32 v[68:69], v[54:55], v[54:55], v[68:69]
    v_pk_fma_f32 v[68:69], v[56:57], v[56:57], v[68:69]
    v_pk_fma_f32 v[68:69], v[58:59], v[58:59], v[68:69]
    v_add_f32 v67, v68, v69
    v_cvt_pk_bf16_f32 v72, v40, v41
    v_cvt_pk_bf16_f32 v73, v42, v43
    v_cvt_pk_bf16_f32 v74, v44, v45
    v_cvt_pk_bf16_f32 v75, v46, v47
    v_cvt_pk_bf16_f32 v76, v48, v49
    v_cvt_pk_bf16_f32 v77, v50, v51
    v_cvt_pk_bf16_f32 v78, v52, v53
    v_cvt_pk_bf16_f32 v79, v54, v55
    v_cvt_pk_bf16_f32 v80, v56, v57
    v_cvt_pk_bf16_f32 v81, v58, v59
    v_mov_b32 v82, 0
    v_mov_b32 v83, 0
    v_mov_b32 v65, v67
    s_nop 1
    v_permlane32_swap_b32 v67, v65
    v_add_f32 v67, v67, v65
    v_mov_b32 v65, v67
    s_nop 1
    v_permlane16_swap_b32 v67, v65
    v_add_f32 v67, v67, v65
    s_waitcnt lgkmcnt(14)
    v_mfma_f32_16x16x32_bf16 v[84:87], a[0:3], v[72:75], 0
    s_waitcnt lgkmcnt(13)
    v_mfma_f32_16x16x32_bf16 v[84:87], a[4:7], v[76:79], v[84:87]
    s_waitcnt lgkmcnt(12)
    v_mfma_f32_16x16x32_bf16 v[84:87], a[8:11], v[80:83], v[84:87]
    s_waitcnt lgkmcnt(11)
    v_mfma_f32_16x16x32_bf16 v[88:91], a[12:15], v[72:75], 0
    s_waitcnt lgkmcnt(10)
    v_mfma_f32_16x16x32_bf16 v[88:91], a[16:19], v[76:79], v[88:91]
    s_waitcnt lgkmcnt(9)
    v_mfma_f32_16x16x32_bf16 v[88:91], a[20:23], v[80:83], v[88:91]
    s_waitcnt lgkmcnt(8)
    v_mfma_f32_16x16x32_bf16 v[92:95], a[24:27], v[72:75], 0
    s_waitcnt lgkmcnt(7)
    v_mfma_f32_16x16x32_bf16 v[92:95], a[28:31], v[76:79], v[92:95]
    s_waitcnt lgkmcnt(6)
    v_mfma_f32_16x16x32_bf16 v[92:95], a[32:35], v[80:83], v[92:95]
    s_waitcnt lgkmcnt(5)
    v_mfma_f32_16x16x32_bf16 v[96:99], a[36:39], v[72:75], 0
    s_waitcnt lgkmcnt(4)
    v_mfma_f32_16x16x32_bf16 v[96:99], a[40:43], v[76:79], v[96:99]
    s_waitcnt lgkmcnt(3)
    v_mfma_f32_16x16x32_bf16 v[96:99], a[44:47], v[80:83], v[96:99]
    s_waitcnt lgkmcnt(2)
    v_mfma_f32_16x16x32_bf16 v[100:103], a[48:51], v[72:75], 0
    s_waitcnt lgkmcnt(1)
    v_mfma_f32_16x16x32_bf16 v[100:103], a[52:55], v[76:79], v[100:103]
    s_waitcnt lgkmcnt(0)
    v_mfma_f32_16x16x32_bf16 v[100:103], a[56:59], v[80:83], v[100:103]
    v_cvt_pk_bf16_f32 v68, v64, v64
    v_and_b32 v68, 0xffff0000, v68
    v_sub_f32 v69, v64, v68
    v_cvt_pk_bf16_f32 v68, v68, v69
    v_fmac_f32 v67, v64, v66
    s_mov_b64 exec, 0xffff
    buffer_store_dword v68, v7, s[8:11], s52 offen
    s_mov_b64 exec, -1
    v_add_f32 v12, v12, v64
    v_add_f32 v13, v13, v67
    v_cvt_pk_bf16_f32 v40, v84, v85
    s_add_u32 s55, s52, 0
    buffer_store_dword v40, v8, s[8:11], s55 offen
    v_cvt_pk_bf16_f32 v41, v86, v87
    s_add_u32 s55, s52, 65536
    buffer_store_dword v41, v7, s[8:11], s55 offen
    v_cvt_pk_bf16_f32 v42, v88, v89
    s_add_u32 s55, s52, 524288
    buffer_store_dword v42, v7, s[8:11], s55 offen
    v_cvt_pk_bf16_f32 v43, v90, v91
    s_add_u32 s55, s52, 589824
    buffer_store_dword v43, v7, s[8:11], s55 offen
    v_cvt_pk_bf16_f32 v44, v92, v93
    s_add_u32 s55, s52, 1048576
    buffer_store_dword v44, v7, s[8:11], s55 offen
    v_cvt_pk_bf16_f32 v45, v94, v95
    s_add_u32 s55, s52, 1114112
    buffer_store_dword v45, v7, s[8:11], s55 offen
    v_cvt_pk_bf16_f32 v46, v96, v97
    s_add_u32 s55, s52, 1572864
    buffer_store_dword v46, v7, s[8:11], s55 offen
    v_cvt_pk_bf16_f32 v47, v98, v99
    s_add_u32 s55, s52, 1638400
    buffer_store_dword v47, v7, s[8:11], s55 offen
    v_cvt_pk_bf16_f32 v48, v100, v101
    s_add_u32 s55, s52, 2097152
    buffer_store_dword v48, v7, s[8:11], s55 offen
    v_cvt_pk_bf16_f32 v49, v102, v103
    s_add_u32 s55, s52, 2162688
    buffer_store_dword v49, v7, s[8:11], s55 offen
    s_lshl_b32 s51, s44, 1
    s_add_u32 s51, s51, 1
    s_lshl_b32 s52, s51, 13
    s_add_u32 s52, s52, 9437184
    v_and_b32 v40, 0xffff0000, v16
    v_and_b32 v41, 0xffff0000, v17
    v_and_b32 v42, 0xffff0000, v18
    v_and_b32 v43, 0xffff0000, v19
    v_and_b32 v44, 0xffff0000, v20
    v_and_b32 v45, 0xffff0000, v21
    v_and_b32 v46, 0xffff0000, v22
    v_and_b32 v47, 0xffff0000, v23
    v_and_b32 v48, 0xffff0000, v24
    v_and_b32 v49, 0xffff0000, v25
    v_and_b32 v50, 0xffff0000, v26
    v_and_b32 v51, 0xffff0000, v27
    v_and_b32 v52, 0xffff0000, v28
    v_and_b32 v53, 0xffff0000, v29
    v_and_b32 v54, 0xffff0000, v30
    v_and_b32 v55, 0xffff0000, v31
    v_and_b32 v56, 0xffff0000, v32
    v_and_b32 v57, 0xffff0000, v33
    v_and_b32 v58, 0xffff0000, v34
    v_and_b32 v59, 0xffff0000, v35
    v_pk_add_f32 v[68:69], v[40:41], v[42:43]
    v_pk_add_f32 v[68:69], v[68:69], v[44:45]
    v_pk_add_f32 v[68:69], v[68:69], v[46:47]
    v_pk_add_f32 v[68:69], v[68:69], v[48:49]
    v_pk_add_f32 v[68:69], v[68:69], v[50:51]
    v_pk_add_f32 v[68:69], v[68:69], v[52:53]
    v_pk_add_f32 v[68:69], v[68:69], v[54:55]
    v_pk_add_f32 v[68:69], v[68:69], v[56:57]
    v_pk_add_f32 v[68:69], v[68:69], v[58:59]
    v_add_f32 v64, v68, v69
    v_mov_b32 v65, v64
    s_nop 1
    v_permlane32_swap_b32 v64, v65
    v_add_f32 v64, v64, v65
    v_mov_b32 v65, v64
    s_nop 1
    v_permlane16_swap_b32 v64, v65
    v_add_f32 v64, v64, v65
    v_mul_f32 v66, 0x3c4ccccd, v64
    v_pk_add_f32 v[40:41], v[40:41], v[66:67] op_sel_hi:[1,0] neg_lo:[0,1] neg_hi:[0,1]
    v_pk_add_f32 v[42:43], v[42:43], v[66:67] op_sel_hi:[1,0] neg_lo:[0,1] neg_hi:[0,1]
    v_pk_add_f32 v[44:45], v[44:45], v[66:67] op_sel_hi:[1,0] neg_lo:[0,1] neg_hi:[0,1]
    v_pk_add_f32 v[46:47], v[46:47], v[66:67] op_sel_hi:[1,0] neg_lo:[0,1] neg_hi:[0,1]
    v_pk_add_f32 v[48:49], v[48:49], v[66:67] op_sel_hi:[1,0] neg_lo:[0,1] neg_hi:[0,1]
    v_pk_add_f32 v[50:51], v[50:51], v[66:67] op_sel_hi:[1,0] neg_lo:[0,1] neg_hi:[0,1]
    v_pk_add_f32 v[52:53], v[52:53], v[66:67] op_sel_hi:[1,0] neg_lo:[0,1] neg_hi:[0,1]
    v_pk_add_f32 v[54:55], v[54:55], v[66:67] op_sel_hi:[1,0] neg_lo:[0,1] neg_hi:[0,1]
    v_pk_add_f32 v[56:57], v[56:57], v[66:67] op_sel_hi:[1,0] neg_lo:[0,1] neg_hi:[0,1]
    v_pk_add_f32 v[58:59], v[58:59], v[66:67] op_sel_hi:[1,0] neg_lo:[0,1] neg_hi:[0,1]
    v_pk_mul_f32 v[68:69], v[40:41], v[40:41]
    v_pk_fma_f32 v[68:69], v[42:43], v[42:43], v[68:69]
    v_pk_fma_f32 v[68:69], v[44:45], v[44:45], v[68:69]
    v_pk_fma_f32 v[68:69], v[46:47], v[46:47], v[68:69]
    v_pk_fma_f32 v[68:69], v[48:49], v[48:49], v[68:69]
    v_pk_fma_f32 v[68:69], v[50:51], v[50:51], v[68:69]
    v_pk_fma_f32 v[68:69], v[52:53], v[52:53], v[68:69]
    v_pk_fma_f32 v[68:69], v[54:55], v[54:55], v[68:69]
    v_pk_fma_f32 v[68:69], v[56:57], v[56:57], v[68:69]
    v_pk_fma_f32 v[68:69], v[58:59], v[58:59], v[68:69]
    v_add_f32 v67, v68, v69
    v_cvt_pk_bf16_f32 v72, v40, v41
    v_cvt_pk_bf16_f32 v73, v42, v43
    v_cvt_pk_bf16_f32 v74, v44, v45
    v_cvt_pk_bf16_f32 v75, v46, v47
    v_cvt_pk_bf16_f32 v76, v48, v49
    v_cvt_pk_bf16_f32 v77, v50, v51
    v_cvt_pk_bf16_f32 v78, v52, v53
    v_cvt_pk_bf16_f32 v79, v54, v55
    v_cvt_pk_bf16_f32 v80, v56, v57
    v_cvt_pk_bf16_f32 v81, v58, v59
    v_mov_b32 v82, 0
    v_mov_b32 v83, 0
    v_mov_b32 v65, v67
    s_nop 1
    v_permlane32_swap_b32 v67, v65
    v_add_f32 v67, v67, v65
    v_mov_b32 v65, v67
    s_nop 1
    v_permlane16_swap_b32 v67, v65
    v_add_f32 v67, v67, v65
    v_mfma_f32_16x16x32_bf16 v[84:87], a[0:3], v[72:75], 0
    v_mfma_f32_16x16x32_bf16 v[84:87], a[4:7], v[76:79], v[84:87]
    v_mfma_f32_16x16x32_bf16 v[84:87], a[8:11], v[80:83], v[84:87]
    v_mfma_f32_16x16x32_bf16 v[88:91], a[12:15], v[72:75], 0
    v_mfma_f32_16x16x32_bf16 v[88:91], a[16:19], v[76:79], v[88:91]
    v_mfma_f32_16x16x32_bf16 v[88:91], a[20:23], v[80:83], v[88:91]
    v_mfma_f32_16x16x32_bf16 v[92:95], a[24:27], v[72:75], 0
    v_mfma_f32_16x16x32_bf16 v[92:95], a[28:31], v[76:79], v[92:95]
    v_mfma_f32_16x16x32_bf16 v[92:95], a[32:35], v[80:83], v[92:95]
    v_mfma_f32_16x16x32_bf16 v[96:99], a[36:39], v[72:75], 0
    v_mfma_f32_16x16x32_bf16 v[96:99], a[40:43], v[76:79], v[96:99]
    v_mfma_f32_16x16x32_bf16 v[96:99], a[44:47], v[80:83], v[96:99]
    v_mfma_f32_16x16x32_bf16 v[100:103], a[48:51], v[72:75], 0
    v_mfma_f32_16x16x32_bf16 v[100:103], a[52:55], v[76:79], v[100:103]
    v_mfma_f32_16x16x32_bf16 v[100:103], a[56:59], v[80:83], v[100:103]
    v_cvt_pk_bf16_f32 v68, v64, v64
    v_and_b32 v68, 0xffff0000, v68
    v_sub_f32 v69, v64, v68
    v_cvt_pk_bf16_f32 v68, v68, v69
    v_fmac_f32 v67, v64, v66
    s_mov_b64 exec, 0xffff
    buffer_store_dword v68, v7, s[8:11], s52 offen
    s_mov_b64 exec, -1
    v_add_f32 v12, v12, v64
    v_add_f32 v13, v13, v67
    v_cvt_pk_bf16_f32 v40, v84, v85
    s_add_u32 s55, s52, 0
    buffer_store_dword v40, v8, s[8:11], s55 offen
    v_cvt_pk_bf16_f32 v41, v86, v87
    s_add_u32 s55, s52, 65536
    buffer_store_dword v41, v7, s[8:11], s55 offen
    v_cvt_pk_bf16_f32 v42, v88, v89
    s_add_u32 s55, s52, 524288
    buffer_store_dword v42, v7, s[8:11], s55 offen
    v_cvt_pk_bf16_f32 v43, v90, v91
    s_add_u32 s55, s52, 589824
    buffer_store_dword v43, v7, s[8:11], s55 offen
    v_cvt_pk_bf16_f32 v44, v92, v93
    s_add_u32 s55, s52, 1048576
    buffer_store_dword v44, v7, s[8:11], s55 offen
    v_cvt_pk_bf16_f32 v45, v94, v95
    s_add_u32 s55, s52, 1114112
    buffer_store_dword v45, v7, s[8:11], s55 offen
    v_cvt_pk_bf16_f32 v46, v96, v97
    s_add_u32 s55, s52, 1572864
    buffer_store_dword v46, v7, s[8:11], s55 offen
    v_cvt_pk_bf16_f32 v47, v98, v99
    s_add_u32 s55, s52, 1638400
    buffer_store_dword v47, v7, s[8:11], s55 offen
    v_cvt_pk_bf16_f32 v48, v100, v101
    s_add_u32 s55, s52, 2097152
    buffer_store_dword v48, v7, s[8:11], s55 offen
    v_cvt_pk_bf16_f32 v49, v102, v103
    s_add_u32 s55, s52, 2162688
    buffer_store_dword v49, v7, s[8:11], s55 offen
    s_lshl_b32 s51, s44, 7
    v_lshl_add_u32 v14, v2, 3, s51
    s_mov_b64 exec, 0xffff
    ds_write_b64 v14, v[12:13]
    s_mov_b64 exec, -1
    s_waitcnt lgkmcnt(0)
    s_barrier
    s_cmp_eq_u32 s44, 0
    s_cbranch_scc0 L_k1_xdone
    v_lshlrev_b32 v14, 3, v2
    ds_read_b64 v[16:17], v14 offset:0
    ds_read_b64 v[18:19], v14 offset:128
    ds_read_b64 v[20:21], v14 offset:256
    ds_read_b64 v[22:23], v14 offset:384
    s_waitcnt lgkmcnt(2)
    v_pk_add_f32 v[16:17], v[16:17], v[18:19]
    s_waitcnt lgkmcnt(0)
    v_pk_add_f32 v[20:21], v[20:21], v[22:23]
    v_pk_add_f32 v[16:17], v[16:17], v[20:21]
    v_mov_b32 v18, 0
    v_mov_b32 v19, 0
    s_mov_b32 s51, 12582912
    s_mov_b32 s52, 12648448
    s_mov_b64 exec, 0xffff
    buffer_store_dwordx2 v[16:17], v9, s[8:11], s51 offen
    buffer_store_dwordx2 v[18:19], v9, s[8:11], s52 offen
    s_mov_b64 exec, -1
    s_nop 15
L_k1_xdone:
    s_waitcnt vmcnt(0)
    s_endpgm
    s_nop 15
L_k1_w:
    s_sub_u32 s45, s2, 128
    s_lshr_b32 s48, s45, 5
    s_and_b32 s49, s45, 31
    s_lshl_b32 s49, s49, 2
    s_add_u32 s49, s49, s44
    s_lshr_b32 s50, s49, 6
    s_and_b32 s51, s49, 63
    s_and_b32 s52, s51, 15
    s_lshr_b32 s53, s51, 4
    s_lshl_b32 s54, s50, 4
    s_add_u32 s54, s54, s52
    s_lshl_b32 s55, s53, 9
    s_add_u32 s54, s54, s55
    v_and_b32 v4, 63, v0
    s_mul_i32 s55, s48, 80
    v_add_u32 v5, s55, v4
    v_sub_u32 v6, 640, v5
    s_cmp_lt_u32 s48, 4
    s_cselect_b32 s56, 0, -1
    s_cselect_b32 s57, 0, 0x80000000
    v_mov_b32 v7, s56
    v_cmp_eq_u32 vcc, 0, v7
    s_nop 1
    v_cndmask_b32 v5, v6, v5, vcc
    v_lshlrev_b32 v5, 1, v5
    s_add_u32 s58, s54, 0
    s_sub_u32 s59, 0, s58
    s_and_b32 s59, s59, 2047
    s_cmp_lt_u32 s48, 4
    s_cselect_b32 s60, s58, s59
    s_mul_i32 s60, s60, 642
    buffer_load_ushort v16, v5, s[20:23], s60 offen
    buffer_load_ushort v32, v5, s[24:27], s60 offen
    s_add_u32 s58, s54, 128
    s_sub_u32 s59, 0, s58
    s_and_b32 s59, s59, 2047
    s_cmp_lt_u32 s48, 4
    s_cselect_b32 s60, s58, s59
    s_mul_i32 s60, s60, 642
    buffer_load_ushort v17, v5, s[20:23], s60 offen
    buffer_load_ushort v33, v5, s[24:27], s60 offen
    s_add_u32 s58, s54, 256
    s_sub_u32 s59, 0, s58
    s_and_b32 s59, s59, 2047
    s_cmp_lt_u32 s48, 4
    s_cselect_b32 s60, s58, s59
    s_mul_i32 s60, s60, 642
    buffer_load_ushort v18, v5, s[20:23], s60 offen
    buffer_load_ushort v34, v5, s[24:27], s60 offen
    s_add_u32 s58, s54, 384
    s_sub_u32 s59, 0, s58
    s_and_b32 s59, s59, 2047
    s_cmp_lt_u32 s48, 4
    s_cselect_b32 s60, s58, s59
    s_mul_i32 s60, s60, 642
    buffer_load_ushort v19, v5, s[20:23], s60 offen
    buffer_load_ushort v35, v5, s[24:27], s60 offen
    s_add_u32 s58, s54, 32
    s_sub_u32 s59, 0, s58
    s_and_b32 s59, s59, 2047
    s_cmp_lt_u32 s48, 4
    s_cselect_b32 s60, s58, s59
    s_mul_i32 s60, s60, 642
    buffer_load_ushort v20, v5, s[20:23], s60 offen
    buffer_load_ushort v36, v5, s[24:27], s60 offen
    s_add_u32 s58, s54, 160
    s_sub_u32 s59, 0, s58
    s_and_b32 s59, s59, 2047
    s_cmp_lt_u32 s48, 4
    s_cselect_b32 s60, s58, s59
    s_mul_i32 s60, s60, 642
    buffer_load_ushort v21, v5, s[20:23], s60 offen
    buffer_load_ushort v37, v5, s[24:27], s60 offen
    s_add_u32 s58, s54, 288
    s_sub_u32 s59, 0, s58
    s_and_b32 s59, s59, 2047
    s_cmp_lt_u32 s48, 4
    s_cselect_b32 s60, s58, s59
    s_mul_i32 s60, s60, 642
    buffer_load_ushort v22, v5, s[20:23], s60 offen
    buffer_load_ushort v38, v5, s[24:27], s60 offen
    s_add_u32 s58, s54, 416
    s_sub_u32 s59, 0, s58
    s_and_b32 s59, s59, 2047
    s_cmp_lt_u32 s48, 4
    s_cselect_b32 s60, s58, s59
    s_mul_i32 s60, s60, 642
    buffer_load_ushort v23, v5, s[20:23], s60 offen
    buffer_load_ushort v39, v5, s[24:27], s60 offen
    s_add_u32 s58, s54, 64
    s_sub_u32 s59, 0, s58
    s_and_b32 s59, s59, 2047
    s_cmp_lt_u32 s48, 4
    s_cselect_b32 s60, s58, s59
    s_mul_i32 s60, s60, 642
    buffer_load_ushort v24, v5, s[20:23], s60 offen
    buffer_load_ushort v40, v5, s[24:27], s60 offen
    s_add_u32 s58, s54, 192
    s_sub_u32 s59, 0, s58
    s_and_b32 s59, s59, 2047
    s_cmp_lt_u32 s48, 4
    s_cselect_b32 s60, s58, s59
    s_mul_i32 s60, s60, 642
    buffer_load_ushort v25, v5, s[20:23], s60 offen
    buffer_load_ushort v41, v5, s[24:27], s60 offen
    s_add_u32 s58, s54, 320
    s_sub_u32 s59, 0, s58
    s_and_b32 s59, s59, 2047
    s_cmp_lt_u32 s48, 4
    s_cselect_b32 s60, s58, s59
    s_mul_i32 s60, s60, 642
    buffer_load_ushort v26, v5, s[20:23], s60 offen
    buffer_load_ushort v42, v5, s[24:27], s60 offen
    s_add_u32 s58, s54, 448
    s_sub_u32 s59, 0, s58
    s_and_b32 s59, s59, 2047
    s_cmp_lt_u32 s48, 4
    s_cselect_b32 s60, s58, s59
    s_mul_i32 s60, s60, 642
    buffer_load_ushort v27, v5, s[20:23], s60 offen
    buffer_load_ushort v43, v5, s[24:27], s60 offen
    s_add_u32 s58, s54, 96
    s_sub_u32 s59, 0, s58
    s_and_b32 s59, s59, 2047
    s_cmp_lt_u32 s48, 4
    s_cselect_b32 s60, s58, s59
    s_mul_i32 s60, s60, 642
    buffer_load_ushort v28, v5, s[20:23], s60 offen
    buffer_load_ushort v44, v5, s[24:27], s60 offen
    s_add_u32 s58, s54, 224
    s_sub_u32 s59, 0, s58
    s_and_b32 s59, s59, 2047
    s_cmp_lt_u32 s48, 4
    s_cselect_b32 s60, s58, s59
    s_mul_i32 s60, s60, 642
    buffer_load_ushort v29, v5, s[20:23], s60 offen
    buffer_load_ushort v45, v5, s[24:27], s60 offen
    s_add_u32 s58, s54, 352
    s_sub_u32 s59, 0, s58
    s_and_b32 s59, s59, 2047
    s_cmp_lt_u32 s48, 4
    s_cselect_b32 s60, s58, s59
    s_mul_i32 s60, s60, 642
    buffer_load_ushort v30, v5, s[20:23], s60 offen
    buffer_load_ushort v46, v5, s[24:27], s60 offen
    s_add_u32 s58, s54, 480
    s_sub_u32 s59, 0, s58
    s_and_b32 s59, s59, 2047
    s_cmp_lt_u32 s48, 4
    s_cselect_b32 s60, s58, s59
    s_mul_i32 s60, s60, 642
    buffer_load_ushort v31, v5, s[20:23], s60 offen
    buffer_load_ushort v47, v5, s[24:27], s60 offen
    s_and_b32 s61, s48, 3
    s_cmp_eq_u32 s61, 0
    s_cbranch_scc0 L_k1_w_nosym
    s_add_u32 s58, s54, 0
    s_sub_u32 s59, 0, s58
    s_and_b32 s59, s59, 2047
    s_cmp_lt_u32 s48, 4
    s_cselect_b32 s60, s59, s58
    s_mul_i32 s60, s60, 642
    buffer_load_ushort v48, v5, s[20:23], s60 offen
    buffer_load_ushort v64, v5, s[24:27], s60 offen
    s_add_u32 s58, s54, 128
    s_sub_u32 s59, 0, s58
    s_and_b32 s59, s59, 2047
    s_cmp_lt_u32 s48, 4
    s_cselect_b32 s60, s59, s58
    s_mul_i32 s60, s60, 642
    buffer_load_ushort v49, v5, s[20:23], s60 offen
    buffer_load_ushort v65, v5, s[24:27], s60 offen
    s_add_u32 s58, s54, 256
    s_sub_u32 s59, 0, s58
    s_and_b32 s59, s59, 2047
    s_cmp_lt_u32 s48, 4
    s_cselect_b32 s60, s59, s58
    s_mul_i32 s60, s60, 642
    buffer_load_ushort v50, v5, s[20:23], s60 offen
    buffer_load_ushort v66, v5, s[24:27], s60 offen
    s_add_u32 s58, s54, 384
    s_sub_u32 s59, 0, s58
    s_and_b32 s59, s59, 2047
    s_cmp_lt_u32 s48, 4
    s_cselect_b32 s60, s59, s58
    s_mul_i32 s60, s60, 642
    buffer_load_ushort v51, v5, s[20:23], s60 offen
    buffer_load_ushort v67, v5, s[24:27], s60 offen
    s_add_u32 s58, s54, 32
    s_sub_u32 s59, 0, s58
    s_and_b32 s59, s59, 2047
    s_cmp_lt_u32 s48, 4
    s_cselect_b32 s60, s59, s58
    s_mul_i32 s60, s60, 642
    buffer_load_ushort v52, v5, s[20:23], s60 offen
    buffer_load_ushort v68, v5, s[24:27], s60 offen
    s_add_u32 s58, s54, 160
    s_sub_u32 s59, 0, s58
    s_and_b32 s59, s59, 2047
    s_cmp_lt_u32 s48, 4
    s_cselect_b32 s60, s59, s58
    s_mul_i32 s60, s60, 642
    buffer_load_ushort v53, v5, s[20:23], s60 offen
    buffer_load_ushort v69, v5, s[24:27], s60 offen
    s_add_u32 s58, s54, 288
    s_sub_u32 s59, 0, s58
    s_and_b32 s59, s59, 2047
    s_cmp_lt_u32 s48, 4
    s_cselect_b32 s60, s59, s58
    s_mul_i32 s60, s60, 642
    buffer_load_ushort v54, v5, s[20:23], s60 offen
    buffer_load_ushort v70, v5, s[24:27], s60 offen
    s_add_u32 s58, s54, 416
    s_sub_u32 s59, 0, s58
    s_and_b32 s59, s59, 2047
    s_cmp_lt_u32 s48, 4
    s_cselect_b32 s60, s59, s58
    s_mul_i32 s60, s60, 642
    buffer_load_ushort v55, v5, s[20:23], s60 offen
    buffer_load_ushort v71, v5, s[24:27], s60 offen
    s_add_u32 s58, s54, 64
    s_sub_u32 s59, 0, s58
    s_and_b32 s59, s59, 2047
    s_cmp_lt_u32 s48, 4
    s_cselect_b32 s60, s59, s58
    s_mul_i32 s60, s60, 642
    buffer_load_ushort v56, v5, s[20:23], s60 offen
    buffer_load_ushort v72, v5, s[24:27], s60 offen
    s_add_u32 s58, s54, 192
    s_sub_u32 s59, 0, s58
    s_and_b32 s59, s59, 2047
    s_cmp_lt_u32 s48, 4
    s_cselect_b32 s60, s59, s58
    s_mul_i32 s60, s60, 642
    buffer_load_ushort v57, v5, s[20:23], s60 offen
    buffer_load_ushort v73, v5, s[24:27], s60 offen
    s_add_u32 s58, s54, 320
    s_sub_u32 s59, 0, s58
    s_and_b32 s59, s59, 2047
    s_cmp_lt_u32 s48, 4
    s_cselect_b32 s60, s59, s58
    s_mul_i32 s60, s60, 642
    buffer_load_ushort v58, v5, s[20:23], s60 offen
    buffer_load_ushort v74, v5, s[24:27], s60 offen
    s_add_u32 s58, s54, 448
    s_sub_u32 s59, 0, s58
    s_and_b32 s59, s59, 2047
    s_cmp_lt_u32 s48, 4
    s_cselect_b32 s60, s59, s58
    s_mul_i32 s60, s60, 642
    buffer_load_ushort v59, v5, s[20:23], s60 offen
    buffer_load_ushort v75, v5, s[24:27], s60 offen
    s_add_u32 s58, s54, 96
    s_sub_u32 s59, 0, s58
    s_and_b32 s59, s59, 2047
    s_cmp_lt_u32 s48, 4
    s_cselect_b32 s60, s59, s58
    s_mul_i32 s60, s60, 642
    buffer_load_ushort v60, v5, s[20:23], s60 offen
    buffer_load_ushort v76, v5, s[24:27], s60 offen
    s_add_u32 s58, s54, 224
    s_sub_u32 s59, 0, s58
    s_and_b32 s59, s59, 2047
    s_cmp_lt_u32 s48, 4
    s_cselect_b32 s60, s59, s58
    s_mul_i32 s60, s60, 642
    buffer_load_ushort v61, v5, s[20:23], s60 offen
    buffer_load_ushort v77, v5, s[24:27], s60 offen
    s_add_u32 s58, s54, 352
    s_sub_u32 s59, 0, s58
    s_and_b32 s59, s59, 2047
    s_cmp_lt_u32 s48, 4
    s_cselect_b32 s60, s59, s58
    s_mul_i32 s60, s60, 642
    buffer_load_ushort v62, v5, s[20:23], s60 offen
    buffer_load_ushort v78, v5, s[24:27], s60 offen
    s_add_u32 s58, s54, 480
    s_sub_u32 s59, 0, s58
    s_and_b32 s59, s59, 2047
    s_cmp_lt_u32 s48, 4
    s_cselect_b32 s60, s59, s58
    s_mul_i32 s60, s60, 642
    buffer_load_ushort v63, v5, s[20:23], s60 offen
    buffer_load_ushort v79, v5, s[24:27], s60 offen
    s_waitcnt vmcnt(0)
    s_mov_b64 exec, 1
    v_lshlrev_b32 v8, 16, v16
    v_lshlrev_b32 v9, 16, v48
    v_add_f32 v8, v8, v9
    v_mul_f32 v8, 0.5, v8
    v_lshlrev_b32 v10, 16, v32
    v_lshlrev_b32 v9, 16, v64
    v_sub_f32 v10, v10, v9
    v_mul_f32 v10, 0.5, v10
    v_cvt_pk_bf16_f32 v8, v8, v10
    v_and_b32 v16, 0xffff, v8
    v_lshrrev_b32 v32, 16, v8
    v_lshlrev_b32 v8, 16, v17
    v_lshlrev_b32 v9, 16, v49
    v_add_f32 v8, v8, v9
    v_mul_f32 v8, 0.5, v8
    v_lshlrev_b32 v10, 16, v33
    v_lshlrev_b32 v9, 16, v65
    v_sub_f32 v10, v10, v9
    v_mul_f32 v10, 0.5, v10
    v_cvt_pk_bf16_f32 v8, v8, v10
    v_and_b32 v17, 0xffff, v8
    v_lshrrev_b32 v33, 16, v8
    v_lshlrev_b32 v8, 16, v18
    v_lshlrev_b32 v9, 16, v50
    v_add_f32 v8, v8, v9
    v_mul_f32 v8, 0.5, v8
    v_lshlrev_b32 v10, 16, v34
    v_lshlrev_b32 v9, 16, v66
    v_sub_f32 v10, v10, v9
    v_mul_f32 v10, 0.5, v10
    v_cvt_pk_bf16_f32 v8, v8, v10
    v_and_b32 v18, 0xffff, v8
    v_lshrrev_b32 v34, 16, v8
    v_lshlrev_b32 v8, 16, v19
    v_lshlrev_b32 v9, 16, v51
    v_add_f32 v8, v8, v9
    v_mul_f32 v8, 0.5, v8
    v_lshlrev_b32 v10, 16, v35
    v_lshlrev_b32 v9, 16, v67
    v_sub_f32 v10, v10, v9
    v_mul_f32 v10, 0.5, v10
    v_cvt_pk_bf16_f32 v8, v8, v10
    v_and_b32 v19, 0xffff, v8
    v_lshrrev_b32 v35, 16, v8
    v_lshlrev_b32 v8, 16, v20
    v_lshlrev_b32 v9, 16, v52
    v_add_f32 v8, v8, v9
    v_mul_f32 v8, 0.5, v8
    v_lshlrev_b32 v10, 16, v36
    v_lshlrev_b32 v9, 16, v68
    v_sub_f32 v10, v10, v9
    v_mul_f32 v10, 0.5, v10
    v_cvt_pk_bf16_f32 v8, v8, v10
    v_and_b32 v20, 0xffff, v8
    v_lshrrev_b32 v36, 16, v8
    v_lshlrev_b32 v8, 16, v21
    v_lshlrev_b32 v9, 16, v53
    v_add_f32 v8, v8, v9
    v_mul_f32 v8, 0.5, v8
    v_lshlrev_b32 v10, 16, v37
    v_lshlrev_b32 v9, 16, v69
    v_sub_f32 v10, v10, v9
    v_mul_f32 v10, 0.5, v10
    v_cvt_pk_bf16_f32 v8, v8, v10
    v_and_b32 v21, 0xffff, v8
    v_lshrrev_b32 v37, 16, v8
    v_lshlrev_b32 v8, 16, v22
    v_lshlrev_b32 v9, 16, v54
    v_add_f32 v8, v8, v9
    v_mul_f32 v8, 0.5, v8
    v_lshlrev_b32 v10, 16, v38
    v_lshlrev_b32 v9, 16, v70
    v_sub_f32 v10, v10, v9
    v_mul_f32 v10, 0.5, v10
    v_cvt_pk_bf16_f32 v8, v8, v10
    v_and_b32 v22, 0xffff, v8
    v_lshrrev_b32 v38, 16, v8
    v_lshlrev_b32 v8, 16, v23
    v_lshlrev_b32 v9, 16, v55
    v_add_f32 v8, v8, v9
    v_mul_f32 v8, 0.5, v8
    v_lshlrev_b32 v10, 16, v39
    v_lshlrev_b32 v9, 16, v71
    v_sub_f32 v10, v10, v9
    v_mul_f32 v10, 0.5, v10
    v_cvt_pk_bf16_f32 v8, v8, v10
    v_and_b32 v23, 0xffff, v8
    v_lshrrev_b32 v39, 16, v8
    v_lshlrev_b32 v8, 16, v24
    v_lshlrev_b32 v9, 16, v56
    v_add_f32 v8, v8, v9
    v_mul_f32 v8, 0.5, v8
    v_lshlrev_b32 v10, 16, v40
    v_lshlrev_b32 v9, 16, v72
    v_sub_f32 v10, v10, v9
    v_mul_f32 v10, 0.5, v10
    v_cvt_pk_bf16_f32 v8, v8, v10
    v_and_b32 v24, 0xffff, v8
    v_lshrrev_b32 v40, 16, v8
    v_lshlrev_b32 v8, 16, v25
    v_lshlrev_b32 v9, 16, v57
    v_add_f32 v8, v8, v9
    v_mul_f32 v8, 0.5, v8
    v_lshlrev_b32 v10, 16, v41
    v_lshlrev_b32 v9, 16, v73
    v_sub_f32 v10, v10, v9
    v_mul_f32 v10, 0.5, v10
    v_cvt_pk_bf16_f32 v8, v8, v10
    v_and_b32 v25, 0xffff, v8
    v_lshrrev_b32 v41, 16, v8
    v_lshlrev_b32 v8, 16, v26
    v_lshlrev_b32 v9, 16, v58
    v_add_f32 v8, v8, v9
    v_mul_f32 v8, 0.5, v8
    v_lshlrev_b32 v10, 16, v42
    v_lshlrev_b32 v9, 16, v74
    v_sub_f32 v10, v10, v9
    v_mul_f32 v10, 0.5, v10
    v_cvt_pk_bf16_f32 v8, v8, v10
    v_and_b32 v26, 0xffff, v8
    v_lshrrev_b32 v42, 16, v8
    v_lshlrev_b32 v8, 16, v27
    v_lshlrev_b32 v9, 16, v59
    v_add_f32 v8, v8, v9
    v_mul_f32 v8, 0.5, v8
    v_lshlrev_b32 v10, 16, v43
    v_lshlrev_b32 v9, 16, v75
    v_sub_f32 v10, v10, v9
    v_mul_f32 v10, 0.5, v10
    v_cvt_pk_bf16_f32 v8, v8, v10
    v_and_b32 v27, 0xffff, v8
    v_lshrrev_b32 v43, 16, v8
    v_lshlrev_b32 v8, 16, v28
    v_lshlrev_b32 v9, 16, v60
    v_add_f32 v8, v8, v9
    v_mul_f32 v8, 0.5, v8
    v_lshlrev_b32 v10, 16, v44
    v_lshlrev_b32 v9, 16, v76
    v_sub_f32 v10, v10, v9
    v_mul_f32 v10, 0.5, v10
    v_cvt_pk_bf16_f32 v8, v8, v10
    v_and_b32 v28, 0xffff, v8
    v_lshrrev_b32 v44, 16, v8
    v_lshlrev_b32 v8, 16, v29
    v_lshlrev_b32 v9, 16, v61
    v_add_f32 v8, v8, v9
    v_mul_f32 v8, 0.5, v8
    v_lshlrev_b32 v10, 16, v45
    v_lshlrev_b32 v9, 16, v77
    v_sub_f32 v10, v10, v9
    v_mul_f32 v10, 0.5, v10
    v_cvt_pk_bf16_f32 v8, v8, v10
    v_and_b32 v29, 0xffff, v8
    v_lshrrev_b32 v45, 16, v8
    v_lshlrev_b32 v8, 16, v30
    v_lshlrev_b32 v9, 16, v62
    v_add_f32 v8, v8, v9
    v_mul_f32 v8, 0.5, v8
    v_lshlrev_b32 v10, 16, v46
    v_lshlrev_b32 v9, 16, v78
    v_sub_f32 v10, v10, v9
    v_mul_f32 v10, 0.5, v10
    v_cvt_pk_bf16_f32 v8, v8, v10
    v_and_b32 v30, 0xffff, v8
    v_lshrrev_b32 v46, 16, v8
    v_lshlrev_b32 v8, 16, v31
    v_lshlrev_b32 v9, 16, v63
    v_add_f32 v8, v8, v9
    v_mul_f32 v8, 0.5, v8
    v_lshlrev_b32 v10, 16, v47
    v_lshlrev_b32 v9, 16, v79
    v_sub_f32 v10, v10, v9
    v_mul_f32 v10, 0.5, v10
    v_cvt_pk_bf16_f32 v8, v8, v10
    v_and_b32 v31, 0xffff, v8
    v_lshrrev_b32 v47, 16, v8
    s_mov_b64 exec, -1
    s_nop 15
L_k1_w_nosym:
    s_waitcnt vmcnt(0)
    v_lshl_or_b32 v16, v32, 16, v16
    v_xor_b32 v16, s57, v16
    v_lshl_or_b32 v17, v33, 16, v17
    v_xor_b32 v17, s57, v17
    v_lshl_or_b32 v18, v34, 16, v18
    v_xor_b32 v18, s57, v18
    v_lshl_or_b32 v19, v35, 16, v19
    v_xor_b32 v19, s57, v19
    v_lshl_or_b32 v20, v36, 16, v20
    v_xor_b32 v20, s57, v20
    v_lshl_or_b32 v21, v37, 16, v21
    v_xor_b32 v21, s57, v21
    v_lshl_or_b32 v22, v38, 16, v22
    v_xor_b32 v22, s57, v22
    v_lshl_or_b32 v23, v39, 16, v23
    v_xor_b32 v23, s57, v23
    v_lshl_or_b32 v24, v40, 16, v24
    v_xor_b32 v24, s57, v24
    v_lshl_or_b32 v25, v41, 16, v25
    v_xor_b32 v25, s57, v25
    v_lshl_or_b32 v26, v42, 16, v26
    v_xor_b32 v26, s57, v26
    v_lshl_or_b32 v27, v43, 16, v27
    v_xor_b32 v27, s57, v27
    v_lshl_or_b32 v28, v44, 16, v28
    v_xor_b32 v28, s57, v28
    v_lshl_or_b32 v29, v45, 16, v29
    v_xor_b32 v29, s57, v29
    v_lshl_or_b32 v30, v46, 16, v30
    v_xor_b32 v30, s57, v30
    v_lshl_or_b32 v31, v47, 16, v31
    v_xor_b32 v31, s57, v31
    v_lshlrev_b32 v6, 16, v4
    s_lshl_b32 s58, s48, 13
    s_lshl_b32 s59, s49, 6
    s_add_u32 s58, s58, s59
    s_add_u32 s58, s58, 6291456
    v_cmp_gt_u32 vcc, 41, v4
    s_nop 0
    s_and_saveexec_b64 s[62:63], vcc
    buffer_store_dwordx4 v[16:19], v6, s[8:11], s58 offen offset:0
    buffer_store_dwordx4 v[20:23], v6, s[8:11], s58 offen offset:16
    buffer_store_dwordx4 v[24:27], v6, s[8:11], s58 offen offset:32
    buffer_store_dwordx4 v[28:31], v6, s[8:11], s58 offen offset:48
    s_waitcnt vmcnt(0)
    s_endpgm
    s_nop 15
L_k1_end:
    s_endpgm
    s_nop 15
L_k1_touch:
    s_cmp_ge_u32 s2, 448
    s_cbranch_scc1 L_k1_end
    s_getpc_b64 s[6:7]
L_k1_pc:
    s_sub_u32 s8, s6, L_k1_pc-k1_kernel
    s_subb_u32 s9, s7, 0
    s_and_b32 s9, s9, 0xffff
    s_mov_b32 s10, L_text_end-k1_kernel
    s_mov_b32 s11, 0x20000
    s_getpc_b64 s[6:7]
    s_add_u32 s6, s6, tab_base@rel32@lo+4
    s_addc_u32 s7, s7, tab_base@rel32@hi+12
    s_mov_b32 s12, s6
    s_and_b32 s13, s7, 0xffff
    s_mov_b32 s14, 121344
    s_mov_b32 s15, 0x20000
    s_sub_u32 s16, s2, 384
    s_lshl_b32 s16, s16, 12
    v_lshlrev_b32 v1, 4, v0
    buffer_load_dwordx4 v[4:7], v1, s[8:11], s16 offen
    buffer_load_dwordx4 v[8:11], v1, s[12:15], s16 offen
    s_waitcnt vmcnt(0)
    s_endpgm
.globl c1_kernel
.p2align 8
.type c1_kernel,@function
c1_kernel:
    s_cmp_ge_u32 s2, 192
    s_cbranch_scc1 L_c_prep
    s_mov_b32 s60, 12582912
L_c_body:
    s_and_b32 s40, s2, 7
    s_lshr_b32 s41, s2, 3
    s_and_b32 s42, s41, 3
    s_lshr_b32 s43, s41, 3
    s_lshl_b32 s43, s43, 3
    s_add_u32 s40, s40, s43
    s_lshl_b32 s40, s40, 1
    s_bfe_u32 s43, s41, 0x10002
    s_add_u32 s40, s40, s43
    s_cmp_ge_u32 s40, 41
    s_cbranch_scc1 L_c_end
    s_load_dwordx2 s[4:5], s[0:1], 64
    s_getpc_b64 s[6:7]
    s_add_u32 s6, s6, tab_base@rel32@lo+4
    s_addc_u32 s7, s7, tab_base@rel32@hi+12
    s_mov_b32 s12, s6
    s_and_b32 s13, s7, 0xffff
    s_mov_b32 s14, 121344
    s_mov_b32 s15, 0x20000
    v_and_b32 v2, 15, v0
    v_bfe_u32 v3, v0, 4, 2
    v_lshrrev_b32 v1, 6, v0
    s_nop 0
    v_readfirstlane_b32 s44, v1
    v_and_b32 v4, 63, v0
    v_lshlrev_b32 v8, 4, v4
    v_and_b32 v6, 3, v2
    v_lshl_add_u32 v6, v6, 3, v3
    v_lshlrev_b32 v6, 2, v6
    s_lshl_b32 s48, s40, 3
    s_lshl_b32 s49, s42, 1
    s_add_u32 s48, s48, s49
    s_lshl_b32 s49, s48, 6
    s_add_u32 s49, s49, 15360
    buffer_load_dword v200, v6, s[12:15], s49 offen
    buffer_load_dword v201, v6, s[12:15], s49 offen offset:16
    s_waitcnt lgkmcnt(0)
    s_mov_b32 s8, s4
    s_and_b32 s9, s5, 0xffff
    s_mov_b32 s10, 0x10000000
    s_mov_b32 s11, 0x20000
    v_lshl_add_u32 v7, v2, 2, v3
    v_lshlrev_b32 v7, 3, v7
    s_lshl_b32 s45, s44, 12
    v_add_u32 v7, s45, v7
    buffer_load_dwordx2 v[16:17], v7, s[8:11], s60 offen offset:0
    buffer_load_dwordx2 v[18:19], v7, s[8:11], s60 offen offset:512
    buffer_load_dwordx2 v[20:21], v7, s[8:11], s60 offen offset:1024
    buffer_load_dwordx2 v[22:23], v7, s[8:11], s60 offen offset:1536
    buffer_load_dwordx2 v[24:25], v7, s[8:11], s60 offen offset:2048
    buffer_load_dwordx2 v[26:27], v7, s[8:11], s60 offen offset:2560
    buffer_load_dwordx2 v[28:29], v7, s[8:11], s60 offen offset:3072
    buffer_load_dwordx2 v[30:31], v7, s[8:11], s60 offen offset:3584
    v_lshlrev_b32 v5, 13, v3
    v_lshl_add_u32 v5, v2, 4, v5
    s_lshl_b32 s45, s44, 11
    v_add_u32 v5, s45, v5
    s_lshl_b32 s46, s40, 16
    s_add_u32 s46, s46, 9437184
    s_add_u32 s47, s46, 32768
    buffer_load_dwordx4 a[0:3], v5, s[8:11], s46 offen offset:0
    buffer_load_dwordx4 a[4:7], v5, s[8:11], s47 offen offset:0
    buffer_load_dwordx4 a[8:11], v5, s[8:11], s46 offen offset:256
    buffer_load_dwordx4 a[12:15], v5, s[8:11], s47 offen offset:256
    buffer_load_dwordx4 a[16:19], v5, s[8:11], s46 offen offset:512
    buffer_load_dwordx4 a[20:23], v5, s[8:11], s47 offen offset:512
    buffer_load_dwordx4 a[24:27], v5, s[8:11], s46 offen offset:768
    buffer_load_dwordx4 a[28:31], v5, s[8:11], s47 offen offset:768
    buffer_load_dwordx4 a[32:35], v5, s[8:11], s46 offen offset:1024
    buffer_load_dwordx4 a[36:39], v5, s[8:11], s47 offen offset:1024
    buffer_load_dwordx4 a[40:43], v5, s[8:11], s46 offen offset:1280
    buffer_load_dwordx4 a[44:47], v5, s[8:11], s47 offen offset:1280
    buffer_load_dwordx4 a[48:51], v5, s[8:11], s46 offen offset:1536
    buffer_load_dwordx4 a[52:55], v5, s[8:11], s47 offen offset:1536
    buffer_load_dwordx4 a[56:59], v5, s[8:11], s46 offen offset:1792
    buffer_load_dwordx4 a[60:63], v5, s[8:11], s47 offen offset:1792
    s_and_b32 s51, s44, 1
    s_lshl_b32 s52, s44, 10
    s_add_u32 m0, s52, 34816
    s_add_u32 s52, s52, 36352
    buffer_load_dwordx4 v8, s[12:15], s52 offen lds
    s_add_u32 m0, m0, 4096
    s_add_u32 s52, s52, 4096
    buffer_load_dwordx4 v8, s[12:15], s52 offen lds
    s_add_u32 m0, m0, 4096
    s_add_u32 s52, s52, 4096
    buffer_load_dwordx4 v8, s[12:15], s52 offen lds
    s_add_u32 m0, m0, 4096
    s_add_u32 s52, s52, 4096
    buffer_load_dwordx4 v8, s[12:15], s52 offen lds
    s_add_u32 m0, m0, 4096
    s_add_u32 s52, s52, 4096
    buffer_load_dwordx4 v8, s[12:15], s52 offen lds
    s_add_u32 m0, m0, 4096
    s_add_u32 s52, s52, 4096
    buffer_load_dwordx4 v8, s[12:15], s52 offen lds
    s_add_u32 m0, m0, 4096
    s_add_u32 s52, s52, 4096
    buffer_load_dwordx4 v8, s[12:15], s52 offen lds
    s_add_u32 m0, m0, 4096
    s_add_u32 s52, s52, 4096
    buffer_load_dwordx4 v8, s[12:15], s52 offen lds
    s_add_u32 m0, m0, 4096
    s_add_u32 s52, s52, 4096
    buffer_load_dwordx4 v8, s[12:15], s52 offen lds
    s_add_u32 m0, m0, 4096
    s_add_u32 s52, s52, 4096
    buffer_load_dwordx4 v8, s[12:15], s52 offen lds
    s_add_u32 m0, m0, 4096
    s_add_u32 s52, s52, 4096
    buffer_load_dwordx4 v8, s[12:15], s52 offen lds
    s_add_u32 m0, m0, 4096
    s_add_u32 s52, s52, 4096
    buffer_load_dwordx4 v8, s[12:15], s52 offen lds
    v_lshlrev_b32 v9, 6, v4
    s_lshl_b32 s52, s48, 13
    s_lshl_b32 s53, s44, 12
    s_add_u32 s52, s52, s53
    s_add_u32 s52, s52, 6291456
    buffer_load_dwordx4 v[176:179], v9, s[8:11], s52 offen offset:0
    buffer_load_dwordx4 v[180:183], v9, s[8:11], s52 offen offset:16
    buffer_load_dwordx4 v[184:187], v9, s[8:11], s52 offen offset:32
    buffer_load_dwordx4 v[188:191], v9, s[8:11], s52 offen offset:48
    s_or_b32 s53, s40, s42
    s_or_b32 s53, s53, s44
    s_cmp_eq_u32 s53, 0
    s_cselect_b32 s54, -1, 0
    s_mov_b32 s55, 0
    v_lshlrev_b32 v6, 8, v4
    v_mov_b32 v7, 0
    s_mov_b32 s53, 12713984
    s_mov_b64 exec, s[54:55]
    buffer_store_dword v7, v6, s[8:11], s53 offen
    s_mov_b64 exec, -1
    v_lshrrev_b32 v10, 2, v2
    v_cmp_eq_u32 vcc, 0, v10
    s_waitcnt vmcnt(42)
    s_nop 0
    v_cndmask_b32 v192, 0, v200, vcc
    s_waitcnt vmcnt(41)
    v_cndmask_b32 v196, 0, v201, vcc
    v_cmp_eq_u32 vcc, 1, v10
    s_nop 1
    v_cndmask_b32 v193, 0, v200, vcc
    v_cndmask_b32 v197, 0, v201, vcc
    v_cmp_eq_u32 vcc, 2, v10
    s_nop 1
    v_cndmask_b32 v194, 0, v200, vcc
    v_cndmask_b32 v198, 0, v201, vcc
    v_cmp_eq_u32 vcc, 3, v10
    s_nop 1
    v_cndmask_b32 v195, 0, v200, vcc
    v_cndmask_b32 v199, 0, v201, vcc
    s_or_b32 s53, s40, s42
    s_cmp_eq_u32 s53, 0
    s_cselect_b32 s53, 0xc4200000, 0
    s_mov_b32 s54, 0x3acccccd
    s_mov_b32 s55, s54
    s_waitcnt vmcnt(40)
    v_pk_mul_f32 v[16:17], v[16:17], s[54:55]
    v_fma_f32 v17, -v16, v16, v17
    v_cvt_pk_bf16_f32 v13, v16, v17
    v_lshlrev_b32 v16, 16, v13
    v_and_b32 v17, 0xffff0000, v13
    v_mov_b32 v210, v16
    v_add_f32 v17, 0x3727c5ac, v17
    s_waitcnt vmcnt(39)
    v_pk_mul_f32 v[18:19], v[18:19], s[54:55]
    v_fma_f32 v19, -v18, v18, v19
    v_cvt_pk_bf16_f32 v13, v18, v19
    v_lshlrev_b32 v18, 16, v13
    v_and_b32 v19, 0xffff0000, v13
    v_mov_b32 v211, v18
    v_add_f32 v19, 0x3727c5ac, v19
    s_waitcnt vmcnt(38)
    v_pk_mul_f32 v[20:21], v[20:21], s[54:55]
    v_fma_f32 v21, -v20, v20, v21
    v_cvt_pk_bf16_f32 v13, v20, v21
    v_lshlrev_b32 v20, 16, v13
    v_and_b32 v21, 0xffff0000, v13
    v_mov_b32 v212, v20
    v_add_f32 v21, 0x3727c5ac, v21
    s_waitcnt vmcnt(37)
    v_pk_mul_f32 v[22:23], v[22:23], s[54:55]
    v_fma_f32 v23, -v22, v22, v23
    v_cvt_pk_bf16_f32 v13, v22, v23
    v_lshlrev_b32 v22, 16, v13
    v_and_b32 v23, 0xffff0000, v13
    v_mov_b32 v213, v22
    v_add_f32 v23, 0x3727c5ac, v23
    s_waitcnt vmcnt(36)
    v_pk_mul_f32 v[24:25], v[24:25], s[54:55]
    v_fma_f32 v25, -v24, v24, v25
    v_cvt_pk_bf16_f32 v13, v24, v25
    v_lshlrev_b32 v24, 16, v13
    v_and_b32 v25, 0xffff0000, v13
    v_mov_b32 v214, v24
    v_add_f32 v25, 0x3727c5ac, v25
    s_waitcnt vmcnt(35)
    v_pk_mul_f32 v[26:27], v[26:27], s[54:55]
    v_fma_f32 v27, -v26, v26, v27
    v_cvt_pk_bf16_f32 v13, v26, v27
    v_lshlrev_b32 v26, 16, v13
    v_and_b32 v27, 0xffff0000, v13
    v_mov_b32 v215, v26
    v_add_f32 v27, 0x3727c5ac, v27
    s_waitcnt vmcnt(34)
    v_pk_mul_f32 v[28:29], v[28:29], s[54:55]
    v_fma_f32 v29, -v28, v28, v29
    v_cvt_pk_bf16_f32 v13, v28, v29
    v_lshlrev_b32 v28, 16, v13
    v_and_b32 v29, 0xffff0000, v13
    v_mov_b32 v216, v28
    v_add_f32 v29, 0x3727c5ac, v29
    s_waitcnt vmcnt(33)
    v_pk_mul_f32 v[30:31], v[30:31], s[54:55]
    v_fma_f32 v31, -v30, v30, v31
    v_cvt_pk_bf16_f32 v13, v30, v31
    v_lshlrev_b32 v30, 16, v13
    v_and_b32 v31, 0xffff0000, v13
    v_mov_b32 v217, v30
    v_add_f32 v31, 0x3727c5ac, v31
    v_cvt_pk_bf16_f32 v13, v17, v19
    v_lshlrev_b32 v17, 16, v13
    v_and_b32 v19, 0xffff0000, v13
    v_sqrt_f32 v17, v17
    v_sqrt_f32 v19, v19
    s_nop 0
    v_cvt_pk_bf16_f32 v13, v17, v19
    v_lshlrev_b32 v17, 16, v13
    v_and_b32 v19, 0xffff0000, v13
    v_rcp_f32 v17, v17
    v_rcp_f32 v19, v19
    v_mul_f32 v202, 0x354ccccd, v17
    v_mul_f32 v203, 0x354ccccd, v19
    v_cvt_pk_bf16_f32 v13, v21, v23
    v_lshlrev_b32 v21, 16, v13
    v_and_b32 v23, 0xffff0000, v13
    v_sqrt_f32 v21, v21
    v_sqrt_f32 v23, v23
    s_nop 0
    v_cvt_pk_bf16_f32 v13, v21, v23
    v_lshlrev_b32 v21, 16, v13
    v_and_b32 v23, 0xffff0000, v13
    v_rcp_f32 v21, v21
    v_rcp_f32 v23, v23
    v_mul_f32 v204, 0x354ccccd, v21
    v_mul_f32 v205, 0x354ccccd, v23
    v_cvt_pk_bf16_f32 v13, v25, v27
    v_lshlrev_b32 v25, 16, v13
    v_and_b32 v27, 0xffff0000, v13
    v_sqrt_f32 v25, v25
    v_sqrt_f32 v27, v27
    s_nop 0
    v_cvt_pk_bf16_f32 v13, v25, v27
    v_lshlrev_b32 v25, 16, v13
    v_and_b32 v27, 0xffff0000, v13
    v_rcp_f32 v25, v25
    v_rcp_f32 v27, v27
    v_mul_f32 v206, 0x354ccccd, v25
    v_mul_f32 v207, 0x354ccccd, v27
    v_cvt_pk_bf16_f32 v13, v29, v31
    v_lshlrev_b32 v29, 16, v13
    v_and_b32 v31, 0xffff0000, v13
    v_sqrt_f32 v29, v29
    v_sqrt_f32 v31, v31
    s_nop 0
    v_cvt_pk_bf16_f32 v13, v29, v31
    v_lshlrev_b32 v29, 16, v13
    v_and_b32 v31, 0xffff0000, v13
    v_rcp_f32 v29, v29
    v_rcp_f32 v31, v31
    v_mul_f32 v208, 0x354ccccd, v29
    v_mul_f32 v209, 0x354ccccd, v31
    s_waitcnt vmcnt(32)
    v_mfma_f32_16x16x32_bf16 v[218:221], v[192:195], a[0:3], 0
    s_waitcnt vmcnt(31)
    v_mfma_f32_16x16x32_bf16 v[218:221], v[196:199], a[4:7], v[218:221]
    s_waitcnt vmcnt(30)
    v_mfma_f32_16x16x32_bf16 v[222:225], v[192:195], a[8:11], 0
    s_waitcnt vmcnt(29)
    v_mfma_f32_16x16x32_bf16 v[222:225], v[196:199], a[12:15], v[222:225]
    s_waitcnt vmcnt(28)
    v_mfma_f32_16x16x32_bf16 v[226:229], v[192:195], a[16:19], 0
    s_waitcnt vmcnt(27)
    v_mfma_f32_16x16x32_bf16 v[226:229], v[196:199], a[20:23], v[226:229]
    s_waitcnt vmcnt(26)
    v_mfma_f32_16x16x32_bf16 v[230:233], v[192:195], a[24:27], 0
    s_waitcnt vmcnt(25)
    v_mfma_f32_16x16x32_bf16 v[230:233], v[196:199], a[28:31], v[230:233]
    s_waitcnt vmcnt(24)
    v_mfma_f32_16x16x32_bf16 v[234:237], v[192:195], a[32:35], 0
    s_waitcnt vmcnt(23)
    v_mfma_f32_16x16x32_bf16 v[234:237], v[196:199], a[36:39], v[234:237]
    s_waitcnt vmcnt(22)
    v_mfma_f32_16x16x32_bf16 v[238:241], v[192:195], a[40:43], 0
    s_waitcnt vmcnt(21)
    v_mfma_f32_16x16x32_bf16 v[238:241], v[196:199], a[44:47], v[238:241]
    s_waitcnt vmcnt(20)
    v_mfma_f32_16x16x32_bf16 v[242:245], v[192:195], a[48:51], 0
    s_waitcnt vmcnt(19)
    v_mfma_f32_16x16x32_bf16 v[242:245], v[196:199], a[52:55], v[242:245]
    s_waitcnt vmcnt(18)
    v_mfma_f32_16x16x32_bf16 v[246:249], v[192:195], a[56:59], 0
    s_waitcnt vmcnt(17)
    v_mfma_f32_16x16x32_bf16 v[246:249], v[196:199], a[60:63], v[246:249]
    v_fmac_f32 v218, s53, v210
    v_pk_mul_f32 v[218:219], v[218:219], v[202:203] op_sel:[0,0] op_sel_hi:[1,0]
    v_pk_mul_f32 v[220:221], v[220:221], v[202:203] op_sel:[0,0] op_sel_hi:[1,0]
    v_fmac_f32 v222, s53, v211
    v_pk_mul_f32 v[222:223], v[222:223], v[202:203] op_sel:[0,1] op_sel_hi:[1,1]
    v_pk_mul_f32 v[224:225], v[224:225], v[202:203] op_sel:[0,1] op_sel_hi:[1,1]
    v_fmac_f32 v226, s53, v212
    v_pk_mul_f32 v[226:227], v[226:227], v[204:205] op_sel:[0,0] op_sel_hi:[1,0]
    v_pk_mul_f32 v[228:229], v[228:229], v[204:205] op_sel:[0,0] op_sel_hi:[1,0]
    v_fmac_f32 v230, s53, v213
    v_pk_mul_f32 v[230:231], v[230:231], v[204:205] op_sel:[0,1] op_sel_hi:[1,1]
    v_pk_mul_f32 v[232:233], v[232:233], v[204:205] op_sel:[0,1] op_sel_hi:[1,1]
    v_fmac_f32 v234, s53, v214
    v_pk_mul_f32 v[234:235], v[234:235], v[206:207] op_sel:[0,0] op_sel_hi:[1,0]
    v_pk_mul_f32 v[236:237], v[236:237], v[206:207] op_sel:[0,0] op_sel_hi:[1,0]
    v_fmac_f32 v238, s53, v215
    v_pk_mul_f32 v[238:239], v[238:239], v[206:207] op_sel:[0,1] op_sel_hi:[1,1]
    v_pk_mul_f32 v[240:241], v[240:241], v[206:207] op_sel:[0,1] op_sel_hi:[1,1]
    v_fmac_f32 v242, s53, v216
    v_pk_mul_f32 v[242:243], v[242:243], v[208:209] op_sel:[0,0] op_sel_hi:[1,0]
    v_pk_mul_f32 v[244:245], v[244:245], v[208:209] op_sel:[0,0] op_sel_hi:[1,0]
    v_fmac_f32 v246, s53, v217
    v_pk_mul_f32 v[246:247], v[246:247], v[208:209] op_sel:[0,1] op_sel_hi:[1,1]
    v_pk_mul_f32 v[248:249], v[248:249], v[208:209] op_sel:[0,1] op_sel_hi:[1,1]
    v_cvt_pk_bf16_f32 v16, v218, v222
    v_cvt_pk_bf16_f32 v17, v226, v230
    v_cvt_pk_bf16_f32 v18, v234, v238
    v_cvt_pk_bf16_f32 v19, v242, v246
    v_cvt_pk_bf16_f32 v20, v219, v223
    v_cvt_pk_bf16_f32 v21, v227, v231
    v_cvt_pk_bf16_f32 v22, v235, v239
    v_cvt_pk_bf16_f32 v23, v243, v247
    v_cvt_pk_bf16_f32 v24, v220, v224
    v_cvt_pk_bf16_f32 v25, v228, v232
    v_cvt_pk_bf16_f32 v26, v236, v240
    v_cvt_pk_bf16_f32 v27, v244, v248
    v_cvt_pk_bf16_f32 v28, v221, v225
    v_cvt_pk_bf16_f32 v29, v229, v233
    v_cvt_pk_bf16_f32 v30, v237, v241
    v_cvt_pk_bf16_f32 v31, v245, v249
    v_lshlrev_b32 v10, 10, v3
    v_lshl_add_u32 v10, v2, 4, v10
    s_lshl_b32 s45, s44, 8
    v_add_u32 v10, s45, v10
    ds_write_b128 v10, v[16:19] offset:0
    ds_write_b128 v10, v[20:23] offset:4096
    ds_write_b128 v10, v[24:27] offset:8192
    ds_write_b128 v10, v[28:31] offset:12288
    s_waitcnt vmcnt(5)
    s_waitcnt lgkmcnt(0)
    s_barrier
    s_mul_i32 s52, s51, 3072
    v_add_u32 v11, s52, v8
    ds_read_b128 a[184:187], v11 offset:34816
    ds_read_b128 a[188:191], v11 offset:35840
    ds_read_b128 a[192:195], v11 offset:36864
    s_lshr_b32 s45, s44, 1
    s_lshl_b32 s45, s45, 13
    v_add_u32 v10, s45, v8
    ds_read_b128 v[32:35], v10 offset:0
    ds_read_b128 v[36:39], v10 offset:1024
    ds_read_b128 v[40:43], v10 offset:2048
    ds_read_b128 v[44:47], v10 offset:3072
    ds_read_b128 v[48:51], v10 offset:4096
    ds_read_b128 v[52:55], v10 offset:5120
    ds_read_b128 v[56:59], v10 offset:6144
    ds_read_b128 v[60:63], v10 offset:7168
    s_lshl_b32 s52, s51, 13
    s_add_u32 s52, s52, 65536
    v_add_u32 v11, s52, v8
    ds_read_b128 v[144:147], v11 offset:0
    ds_read_b128 v[148:151], v11 offset:1024
    ds_read_b128 v[152:155], v11 offset:2048
    ds_read_b128 v[156:159], v11 offset:3072
    ds_read_b128 v[160:163], v11 offset:4096
    ds_read_b128 v[164:167], v11 offset:5120
    ds_read_b128 v[168:171], v11 offset:6144
    ds_read_b128 v[172:175], v11 offset:7168
    ds_read_b128 a[88:91], v8 offset:40960
    ds_read_b128 a[92:95], v8 offset:41984
    ds_read_b128 a[96:99], v8 offset:43008
    ds_read_b128 a[100:103], v8 offset:44032
    ds_read_b128 a[104:107], v8 offset:45056
    ds_read_b128 a[108:111], v8 offset:46080
    ds_read_b128 a[112:115], v8 offset:47104
    ds_read_b128 a[116:119], v8 offset:48128
    ds_read_b128 a[120:123], v8 offset:49152
    ds_read_b128 a[124:127], v8 offset:50176
    ds_read_b128 a[128:131], v8 offset:51200
    ds_read_b128 a[132:135], v8 offset:52224
    ds_read_b128 a[136:139], v8 offset:53248
    ds_read_b128 a[140:143], v8 offset:54272
    ds_read_b128 a[144:147], v8 offset:55296
    ds_read_b128 a[148:151], v8 offset:56320
    ds_read_b128 a[152:155], v8 offset:57344
    ds_read_b128 a[156:159], v8 offset:58368
    ds_read_b128 a[160:163], v8 offset:59392
    ds_read_b128 a[164:167], v8 offset:60416
    ds_read_b128 a[168:171], v8 offset:61440
    ds_read_b128 a[172:175], v8 offset:62464
    ds_read_b128 a[176:179], v8 offset:63488
    ds_read_b128 a[180:183], v8 offset:64512
    ds_read_b128 a[64:67], v8 offset:34816
    ds_read_b128 a[68:71], v8 offset:35840
    ds_read_b128 a[72:75], v8 offset:36864
    ds_read_b128 a[76:79], v8 offset:37888
    ds_read_b128 a[80:83], v8 offset:38912
    ds_read_b128 a[84:87], v8 offset:39936
    s_waitcnt lgkmcnt(15)
    v_mfma_f32_16x16x32_bf16 v[64:67], v[32:35], a[184:187], 0
    s_waitcnt vmcnt(4)
    v_lshlrev_b32 v16, 16, v176
    v_and_b32 v192, 0xffff0000, v176
    v_lshlrev_b32 v17, 16, v177
    v_and_b32 v193, 0xffff0000, v177
    v_mfma_f32_16x16x32_bf16 v[80:83], v[32:35], a[188:191], 0
    v_lshlrev_b32 v18, 16, v178
    v_and_b32 v194, 0xffff0000, v178
    v_lshlrev_b32 v19, 16, v179
    v_and_b32 v195, 0xffff0000, v179
    v_mfma_f32_16x16x32_bf16 v[64:67], v[48:51], a[192:195], v[64:67]
    s_waitcnt vmcnt(3)
    v_lshlrev_b32 v20, 16, v180
    v_and_b32 v196, 0xffff0000, v180
    v_lshlrev_b32 v21, 16, v181
    v_and_b32 v197, 0xffff0000, v181
    v_mfma_f32_16x16x32_bf16 v[80:83], v[48:51], a[184:187], v[80:83]
    v_lshlrev_b32 v22, 16, v182
    v_and_b32 v198, 0xffff0000, v182
    v_lshlrev_b32 v23, 16, v183
    v_and_b32 v199, 0xffff0000, v183
    v_mfma_f32_16x16x32_bf16 v[68:71], v[36:39], a[184:187], 0
    s_waitcnt vmcnt(2)
    v_lshlrev_b32 v24, 16, v184
    v_and_b32 v200, 0xffff0000, v184
    v_lshlrev_b32 v25, 16, v185
    v_and_b32 v201, 0xffff0000, v185
    v_mfma_f32_16x16x32_bf16 v[84:87], v[36:39], a[188:191], 0
    v_lshlrev_b32 v26, 16, v186
    v_and_b32 v202, 0xffff0000, v186
    v_lshlrev_b32 v27, 16, v187
    v_and_b32 v203, 0xffff0000, v187
    v_mfma_f32_16x16x32_bf16 v[68:71], v[52:55], a[192:195], v[68:71]
    s_waitcnt vmcnt(1)
    v_lshlrev_b32 v28, 16, v188
    v_and_b32 v204, 0xffff0000, v188
    v_lshlrev_b32 v29, 16, v189
    v_and_b32 v205, 0xffff0000, v189
    v_mfma_f32_16x16x32_bf16 v[84:87], v[52:55], a[184:187], v[84:87]
    v_lshlrev_b32 v30, 16, v190
    v_and_b32 v206, 0xffff0000, v190
    v_lshlrev_b32 v31, 16, v191
    v_and_b32 v207, 0xffff0000, v191
    v_mfma_f32_16x16x32_bf16 v[72:75], v[40:43], a[184:187], 0
    v_mul_f32 v96, v64, v144
    v_mul_f32 v112, v64, v160
    v_fma_f32 v96, -v80, v160, v96
    v_fmac_f32 v112, v80, v144
    v_mul_f32 v97, v65, v145
    v_mfma_f32_16x16x32_bf16 v[88:91], v[40:43], a[188:191], 0
    v_mul_f32 v113, v65, v161
    v_fma_f32 v97, -v81, v161, v97
    v_fmac_f32 v113, v81, v145
    v_mul_f32 v98, v66, v146
    v_mul_f32 v114, v66, v162
    v_mfma_f32_16x16x32_bf16 v[72:75], v[56:59], a[192:195], v[72:75]
    v_fma_f32 v98, -v82, v162, v98
    v_fmac_f32 v114, v82, v146
    v_mul_f32 v99, v67, v147
    v_mul_f32 v115, v67, v163
    v_fma_f32 v99, -v83, v163, v99
    v_mfma_f32_16x16x32_bf16 v[88:91], v[56:59], a[184:187], v[88:91]
    v_fmac_f32 v115, v83, v147
    v_cvt_pk_bf16_f32 v128, v96, v97
    v_cvt_pk_bf16_f32 v129, v98, v99
    v_cvt_pk_bf16_f32 v136, v112, v113
    v_cvt_pk_bf16_f32 v137, v114, v115
    v_mfma_f32_16x16x32_bf16 v[76:79], v[44:47], a[184:187], 0
    v_mul_f32 v100, v68, v148
    v_mul_f32 v116, v68, v164
    v_fma_f32 v100, -v84, v164, v100
    v_fmac_f32 v116, v84, v148
    v_mul_f32 v101, v69, v149
    v_mfma_f32_16x16x32_bf16 v[92:95], v[44:47], a[188:191], 0
    v_mul_f32 v117, v69, v165
    v_fma_f32 v101, -v85, v165, v101
    v_fmac_f32 v117, v85, v149
    v_mul_f32 v102, v70, v150
    v_mul_f32 v118, v70, v166
    v_mfma_f32_16x16x32_bf16 v[76:79], v[60:63], a[192:195], v[76:79]
    v_fma_f32 v102, -v86, v166, v102
    v_fmac_f32 v118, v86, v150
    v_mul_f32 v103, v71, v151
    v_mul_f32 v119, v71, v167
    v_fma_f32 v103, -v87, v167, v103
    v_mfma_f32_16x16x32_bf16 v[92:95], v[60:63], a[184:187], v[92:95]
    v_fmac_f32 v119, v87, v151
    v_cvt_pk_bf16_f32 v130, v100, v101
    v_cvt_pk_bf16_f32 v131, v102, v103
    v_cvt_pk_bf16_f32 v138, v116, v117
    v_cvt_pk_bf16_f32 v139, v118, v119
    v_mfma_f32_16x16x32_bf16 v[218:221], a[88:91], v[128:131], 0
    v_mul_f32 v104, v72, v152
    v_mul_f32 v120, v72, v168
    v_mfma_f32_16x16x32_bf16 v[234:237], a[88:91], v[136:139], 0
    v_fma_f32 v104, -v88, v168, v104
    v_fmac_f32 v120, v88, v152
    v_mul_f32 v105, v73, v153
    s_waitcnt lgkmcnt(13)
    v_mfma_f32_16x16x32_bf16 v[218:221], a[152:155], v[136:139], v[218:221]
    v_mul_f32 v121, v73, v169
    v_fma_f32 v105, -v89, v169, v105
    v_mfma_f32_16x16x32_bf16 v[234:237], a[120:123], v[128:131], v[234:237]
    v_fmac_f32 v121, v89, v153
    v_mul_f32 v106, v74, v154
    v_mul_f32 v122, v74, v170
    v_mfma_f32_16x16x32_bf16 v[222:225], a[96:99], v[128:131], 0
    v_fma_f32 v106, -v90, v170, v106
    v_fmac_f32 v122, v90, v154
    v_mfma_f32_16x16x32_bf16 v[238:241], a[96:99], v[136:139], 0
    v_mul_f32 v107, v75, v155
    v_mul_f32 v123, v75, v171
    v_fma_f32 v107, -v91, v171, v107
    s_waitcnt lgkmcnt(11)
    v_mfma_f32_16x16x32_bf16 v[222:225], a[160:163], v[136:139], v[222:225]
    v_fmac_f32 v123, v91, v155
    v_cvt_pk_bf16_f32 v132, v104, v105
    v_mfma_f32_16x16x32_bf16 v[238:241], a[128:131], v[128:131], v[238:241]
    v_cvt_pk_bf16_f32 v133, v106, v107
    v_cvt_pk_bf16_f32 v140, v120, v121
    v_cvt_pk_bf16_f32 v141, v122, v123
    v_mfma_f32_16x16x32_bf16 v[226:229], a[104:107], v[128:131], 0
    v_mul_f32 v108, v76, v156
    v_mul_f32 v124, v76, v172
    v_mfma_f32_16x16x32_bf16 v[242:245], a[104:107], v[136:139], 0
    v_fma_f32 v108, -v92, v172, v108
    v_fmac_f32 v124, v92, v156
    v_mul_f32 v109, v77, v157
    s_waitcnt lgkmcnt(9)
    v_mfma_f32_16x16x32_bf16 v[226:229], a[168:171], v[136:139], v[226:229]
    v_mul_f32 v125, v77, v173
    v_fma_f32 v109, -v93, v173, v109
    v_mfma_f32_16x16x32_bf16 v[242:245], a[136:139], v[128:131], v[242:245]
    v_fmac_f32 v125, v93, v157
    v_mul_f32 v110, v78, v158
    v_mul_f32 v126, v78, v174
    v_mfma_f32_16x16x32_bf16 v[230:233], a[112:115], v[128:131], 0
    v_fma_f32 v110, -v94, v174, v110
    v_fmac_f32 v126, v94, v158
    v_mfma_f32_16x16x32_bf16 v[246:249], a[112:115], v[136:139], 0
    v_mul_f32 v111, v79, v159
    v_mul_f32 v127, v79, v175
    v_fma_f32 v111, -v95, v175, v111
    s_waitcnt lgkmcnt(7)
    v_mfma_f32_16x16x32_bf16 v[230:233], a[176:179], v[136:139], v[230:233]
    v_fmac_f32 v127, v95, v159
    v_cvt_pk_bf16_f32 v134, v108, v109
    v_mfma_f32_16x16x32_bf16 v[246:249], a[144:147], v[128:131], v[246:249]
    v_cvt_pk_bf16_f32 v135, v110, v111
    v_cvt_pk_bf16_f32 v142, v124, v125
    v_cvt_pk_bf16_f32 v143, v126, v127
    v_mfma_f32_16x16x32_bf16 v[218:221], a[92:95], v[132:135], v[218:221]
    s_nop 0
    v_mfma_f32_16x16x32_bf16 v[234:237], a[92:95], v[140:143], v[234:237]
    v_mfma_f32_16x16x32_bf16 v[218:221], a[156:159], v[140:143], v[218:221]
    v_mfma_f32_16x16x32_bf16 v[234:237], a[124:127], v[132:135], v[234:237]
    v_mfma_f32_16x16x32_bf16 v[222:225], a[100:103], v[132:135], v[222:225]
    v_mfma_f32_16x16x32_bf16 v[238:241], a[100:103], v[140:143], v[238:241]
    v_mfma_f32_16x16x32_bf16 v[222:225], a[164:167], v[140:143], v[222:225]
    v_mfma_f32_16x16x32_bf16 v[238:241], a[132:135], v[132:135], v[238:241]
    v_mfma_f32_16x16x32_bf16 v[226:229], a[108:111], v[132:135], v[226:229]
    s_nop 1
    v_mul_f32 v96, v218, v16
    v_mul_f32 v112, v218, v192
    v_fma_f32 v96, -v234, v192, v96
    v_fmac_f32 v112, v234, v16
    v_mul_f32 v97, v219, v17
    v_mfma_f32_16x16x32_bf16 v[242:245], a[108:111], v[140:143], v[242:245]
    v_mul_f32 v113, v219, v193
    v_fma_f32 v97, -v235, v193, v97
    v_fmac_f32 v113, v235, v17
    v_mul_f32 v98, v220, v18
    v_mul_f32 v114, v220, v194
    v_mfma_f32_16x16x32_bf16 v[226:229], a[172:175], v[140:143], v[226:229]
    v_fma_f32 v98, -v236, v194, v98
    v_fmac_f32 v114, v236, v18
    v_mul_f32 v99, v221, v19
    v_mul_f32 v115, v221, v195
    v_fma_f32 v99, -v237, v195, v99
    v_mfma_f32_16x16x32_bf16 v[242:245], a[140:143], v[132:135], v[242:245]
    v_fmac_f32 v115, v237, v19
    v_cvt_pk_bf16_f32 v32, v96, v97
    v_cvt_pk_bf16_f32 v33, v98, v99
    v_cvt_pk_bf16_f32 v40, v112, v113
    v_cvt_pk_bf16_f32 v41, v114, v115
    v_mfma_f32_16x16x32_bf16 v[230:233], a[116:119], v[132:135], v[230:233]
    v_mul_f32 v100, v222, v20
    v_mul_f32 v116, v222, v196
    v_fma_f32 v100, -v238, v196, v100
    v_fmac_f32 v116, v238, v20
    v_mul_f32 v101, v223, v21
    v_mfma_f32_16x16x32_bf16 v[246:249], a[116:119], v[140:143], v[246:249]
    v_mul_f32 v117, v223, v197
    v_fma_f32 v101, -v239, v197, v101
    v_fmac_f32 v117, v239, v21
    v_mul_f32 v102, v224, v22
    v_mul_f32 v118, v224, v198
    s_waitcnt lgkmcnt(6)
    v_mfma_f32_16x16x32_bf16 v[230:233], a[180:183], v[140:143], v[230:233]
    v_fma_f32 v102, -v240, v198, v102
    v_fmac_f32 v118, v240, v22
    v_mul_f32 v103, v225, v23
    v_mul_f32 v119, v225, v199
    v_fma_f32 v103, -v241, v199, v103
    v_mfma_f32_16x16x32_bf16 v[246:249], a[148:151], v[132:135], v[246:249]
    v_fmac_f32 v119, v241, v23
    v_cvt_pk_bf16_f32 v34, v100, v101
    v_cvt_pk_bf16_f32 v35, v102, v103
    v_cvt_pk_bf16_f32 v42, v116, v117
    v_cvt_pk_bf16_f32 v43, v118, v119
    v_mfma_f32_16x16x32_bf16 v[64:67], a[88:91], v[32:35], 0
    v_mul_f32 v104, v226, v24
    v_mul_f32 v120, v226, v200
    v_mfma_f32_16x16x32_bf16 v[80:83], a[88:91], v[40:43], 0
    v_fma_f32 v104, -v242, v200, v104
    v_fmac_f32 v120, v242, v24
    v_mul_f32 v105, v227, v25
    v_mfma_f32_16x16x32_bf16 v[64:67], a[120:123], v[40:43], v[64:67]
    v_mul_f32 v121, v227, v201
    v_fma_f32 v105, -v243, v201, v105
    v_mfma_f32_16x16x32_bf16 v[80:83], a[152:155], v[32:35], v[80:83]
    v_fmac_f32 v121, v243, v25
    v_mul_f32 v106, v228, v26
    v_mul_f32 v122, v228, v202
    v_mfma_f32_16x16x32_bf16 v[68:71], a[96:99], v[32:35], 0
    v_fma_f32 v106, -v244, v202, v106
    v_fmac_f32 v122, v244, v26
    v_mfma_f32_16x16x32_bf16 v[84:87], a[96:99], v[40:43], 0
    v_mul_f32 v107, v229, v27
    v_mul_f32 v123, v229, v203
    v_fma_f32 v107, -v245, v203, v107
    v_mfma_f32_16x16x32_bf16 v[68:71], a[128:131], v[40:43], v[68:71]
    v_fmac_f32 v123, v245, v27
    v_cvt_pk_bf16_f32 v36, v104, v105
    v_mfma_f32_16x16x32_bf16 v[84:87], a[160:163], v[32:35], v[84:87]
    v_cvt_pk_bf16_f32 v37, v106, v107
    v_cvt_pk_bf16_f32 v44, v120, v121
    v_cvt_pk_bf16_f32 v45, v122, v123
    v_mfma_f32_16x16x32_bf16 v[72:75], a[104:107], v[32:35], 0
    v_mul_f32 v108, v230, v28
    v_mul_f32 v124, v230, v204
    v_mfma_f32_16x16x32_bf16 v[88:91], a[104:107], v[40:43], 0
    v_fma_f32 v108, -v246, v204, v108
    v_fmac_f32 v124, v246, v28
    v_mul_f32 v109, v231, v29
    v_mfma_f32_16x16x32_bf16 v[72:75], a[136:139], v[40:43], v[72:75]
    v_mul_f32 v125, v231, v205
    v_fma_f32 v109, -v247, v205, v109
    v_mfma_f32_16x16x32_bf16 v[88:91], a[168:171], v[32:35], v[88:91]
    v_fmac_f32 v125, v247, v29
    v_mul_f32 v110, v232, v30
    v_mul_f32 v126, v232, v206
    v_mfma_f32_16x16x32_bf16 v[76:79], a[112:115], v[32:35], 0
    v_fma_f32 v110, -v248, v206, v110
    v_fmac_f32 v126, v248, v30
    v_mfma_f32_16x16x32_bf16 v[92:95], a[112:115], v[40:43], 0
    v_mul_f32 v111, v233, v31
    v_mul_f32 v127, v233, v207
    v_fma_f32 v111, -v249, v207, v111
    v_mfma_f32_16x16x32_bf16 v[76:79], a[144:147], v[40:43], v[76:79]
    v_fmac_f32 v127, v249, v31
    v_cvt_pk_bf16_f32 v38, v108, v109
    v_mfma_f32_16x16x32_bf16 v[92:95], a[176:179], v[32:35], v[92:95]
    v_cvt_pk_bf16_f32 v39, v110, v111
    v_cvt_pk_bf16_f32 v46, v124, v125
    v_cvt_pk_bf16_f32 v47, v126, v127
    v_mfma_f32_16x16x32_bf16 v[64:67], a[92:95], v[36:39], v[64:67]
    s_nop 0
    v_mfma_f32_16x16x32_bf16 v[80:83], a[92:95], v[44:47], v[80:83]
    v_mfma_f32_16x16x32_bf16 v[64:67], a[124:127], v[44:47], v[64:67]
    v_mfma_f32_16x16x32_bf16 v[80:83], a[156:159], v[36:39], v[80:83]
    v_mfma_f32_16x16x32_bf16 v[68:71], a[100:103], v[36:39], v[68:71]
    v_mfma_f32_16x16x32_bf16 v[84:87], a[100:103], v[44:47], v[84:87]
    v_mfma_f32_16x16x32_bf16 v[68:71], a[132:135], v[44:47], v[68:71]
    v_mfma_f32_16x16x32_bf16 v[84:87], a[164:167], v[36:39], v[84:87]
    v_mfma_f32_16x16x32_bf16 v[72:75], a[108:111], v[36:39], v[72:75]
    s_nop 1
    v_mul_f32 v96, v64, v144
    v_mul_f32 v112, v80, v144
    v_fmac_f32 v96, v80, v160
    v_fma_f32 v112, -v64, v160, v112
    v_mfma_f32_16x16x32_bf16 v[88:91], a[108:111], v[44:47], v[88:91]
    v_mul_f32 v97, v65, v145
    v_mul_f32 v113, v81, v145
    v_fmac_f32 v97, v81, v161
    v_fma_f32 v113, -v65, v161, v113
    v_mfma_f32_16x16x32_bf16 v[72:75], a[140:143], v[44:47], v[72:75]
    v_mul_f32 v98, v66, v146
    v_mul_f32 v114, v82, v146
    v_fmac_f32 v98, v82, v162
    v_fma_f32 v114, -v66, v162, v114
    v_mfma_f32_16x16x32_bf16 v[88:91], a[172:175], v[36:39], v[88:91]
    v_mul_f32 v99, v67, v147
    v_mul_f32 v115, v83, v147
    v_fmac_f32 v99, v83, v163
    v_fma_f32 v115, -v67, v163, v115
    v_mfma_f32_16x16x32_bf16 v[76:79], a[116:119], v[36:39], v[76:79]
    v_mul_f32 v100, v68, v148
    v_mul_f32 v116, v84, v148
    v_fmac_f32 v100, v84, v164
    v_fma_f32 v116, -v68, v164, v116
    v_mfma_f32_16x16x32_bf16 v[92:95], a[116:119], v[44:47], v[92:95]
    v_mul_f32 v101, v69, v149
    v_mul_f32 v117, v85, v149
    v_fmac_f32 v101, v85, v165
    v_fma_f32 v117, -v69, v165, v117
    v_mfma_f32_16x16x32_bf16 v[76:79], a[148:151], v[44:47], v[76:79]
    v_mul_f32 v102, v70, v150
    v_mul_f32 v118, v86, v150
    v_fmac_f32 v102, v86, v166
    v_fma_f32 v118, -v70, v166, v118
    v_mfma_f32_16x16x32_bf16 v[92:95], a[180:183], v[36:39], v[92:95]
    v_mul_f32 v103, v71, v151
    v_mul_f32 v119, v87, v151
    v_fmac_f32 v103, v87, v167
    v_fma_f32 v119, -v71, v167, v119
    v_mul_f32 v104, v72, v152
    v_mul_f32 v120, v88, v152
    v_fmac_f32 v104, v88, v168
    v_fma_f32 v120, -v72, v168, v120
    v_mul_f32 v105, v73, v153
    v_mul_f32 v121, v89, v153
    v_fmac_f32 v105, v89, v169
    v_fma_f32 v121, -v73, v169, v121
    v_mul_f32 v106, v74, v154
    v_mul_f32 v122, v90, v154
    v_fmac_f32 v106, v90, v170
    v_fma_f32 v122, -v74, v170, v122
    v_mul_f32 v107, v75, v155
    v_mul_f32 v123, v91, v155
    v_fmac_f32 v107, v91, v171
    v_fma_f32 v123, -v75, v171, v123
    v_mul_f32 v108, v76, v156
    v_mul_f32 v124, v92, v156
    v_fmac_f32 v108, v92, v172
    v_fma_f32 v124, -v76, v172, v124
    v_mul_f32 v109, v77, v157
    v_mul_f32 v125, v93, v157
    v_fmac_f32 v109, v93, v173
    v_fma_f32 v125, -v77, v173, v125
    v_mul_f32 v110, v78, v158
    v_mul_f32 v126, v94, v158
    v_fmac_f32 v110, v94, v174
    v_fma_f32 v126, -v78, v174, v126
    v_mul_f32 v111, v79, v159
    v_mul_f32 v127, v95, v159
    v_fmac_f32 v111, v95, v175
    v_fma_f32 v127, -v79, v175, v127
    v_cvt_pk_bf16_f32 v128, v96, v100
    v_cvt_pk_bf16_f32 v129, v104, v108
    v_cvt_pk_bf16_f32 v130, v97, v101
    v_cvt_pk_bf16_f32 v131, v105, v109
    v_cvt_pk_bf16_f32 v132, v98, v102
    v_cvt_pk_bf16_f32 v133, v106, v110
    v_cvt_pk_bf16_f32 v134, v99, v103
    v_cvt_pk_bf16_f32 v135, v107, v111
    v_cvt_pk_bf16_f32 v136, v112, v116
    v_cvt_pk_bf16_f32 v137, v120, v124
    v_cvt_pk_bf16_f32 v138, v113, v117
    v_cvt_pk_bf16_f32 v139, v121, v125
    v_cvt_pk_bf16_f32 v140, v114, v118
    v_cvt_pk_bf16_f32 v141, v122, v126
    v_cvt_pk_bf16_f32 v142, v115, v119
    v_cvt_pk_bf16_f32 v143, v123, v127
    s_lshr_b32 s45, s44, 1
    s_mul_i32 s45, s45, 9216
    s_mul_i32 s46, s51, 2304
    s_add_u32 s45, s45, s46
    s_add_u32 s45, s45, 16384
    v_mul_u32_u24 v10, 144, v2
    v_lshl_add_u32 v10, v3, 5, v10
    v_add_u32 v10, s45, v10
    ds_write_b128 v10, v[128:131] offset:0
    ds_write_b128 v10, v[132:135] offset:16
    ds_write_b128 v10, v[136:139] offset:4608
    ds_write_b128 v10, v[140:143] offset:4624
    s_waitcnt lgkmcnt(0)
    s_barrier
    v_lshrrev_b32 v10, 2, v2
    v_lshl_add_u32 v10, v3, 3, v10
    v_mul_u32_u24 v10, 144, v10
    v_and_b32 v11, 3, v2
    v_lshl_add_u32 v10, v11, 3, v10
    s_lshl_b32 s45, s44, 5
    s_add_u32 s45, s45, 16384
    v_add_u32 v10, s45, v10
    ds_read_b64_tr_b16 v[32:33], v10 offset:0
    ds_read_b64_tr_b16 v[34:35], v10 offset:576
    ds_read_b64_tr_b16 v[36:37], v10 offset:4608
    ds_read_b64_tr_b16 v[38:39], v10 offset:5184
    ds_read_b64_tr_b16 v[40:41], v10 offset:9216
    ds_read_b64_tr_b16 v[42:43], v10 offset:9792
    ds_read_b64_tr_b16 v[44:45], v10 offset:13824
    ds_read_b64_tr_b16 v[46:47], v10 offset:14400
    s_waitcnt lgkmcnt(6)
    v_mfma_f32_16x16x32_bf16 v[64:67], a[64:67], v[32:35], 0
    s_waitcnt lgkmcnt(4)
    v_mfma_f32_16x16x32_bf16 v[72:75], a[64:67], v[36:39], 0
    v_mfma_f32_16x16x32_bf16 v[64:67], a[68:71], v[36:39], v[64:67]
    v_mfma_f32_16x16x32_bf16 v[72:75], a[72:75], v[32:35], v[72:75]
    v_mfma_f32_16x16x32_bf16 v[68:71], a[76:79], v[32:35], 0
    v_mfma_f32_16x16x32_bf16 v[76:79], a[76:79], v[36:39], 0
    v_mfma_f32_16x16x32_bf16 v[68:71], a[80:83], v[36:39], v[68:71]
    v_mfma_f32_16x16x32_bf16 v[76:79], a[84:87], v[32:35], v[76:79]
    s_waitcnt lgkmcnt(2)
    v_mfma_f32_16x16x32_bf16 v[80:83], a[64:67], v[40:43], 0
    s_waitcnt lgkmcnt(0)
    v_mfma_f32_16x16x32_bf16 v[88:91], a[64:67], v[44:47], 0
    v_mfma_f32_16x16x32_bf16 v[80:83], a[68:71], v[44:47], v[80:83]
    v_mfma_f32_16x16x32_bf16 v[88:91], a[72:75], v[40:43], v[88:91]
    v_mfma_f32_16x16x32_bf16 v[84:87], a[76:79], v[40:43], 0
    v_mfma_f32_16x16x32_bf16 v[92:95], a[76:79], v[44:47], 0
    v_mfma_f32_16x16x32_bf16 v[84:87], a[80:83], v[44:47], v[84:87]
    v_mfma_f32_16x16x32_bf16 v[92:95], a[84:87], v[40:43], v[92:95]
    v_lshl_add_u32 v10, v3, 8, v2
    s_lshl_b32 s45, s44, 4
    v_add_u32 v10, s45, v10
    v_lshlrev_b32 v10, 4, v10
    s_lshr_b32 s45, s40, 1
    s_lshl_b32 s45, s45, 2
    s_add_u32 s45, s45, s42
    s_lshl_b32 s45, s45, 15
    s_and_b32 s46, s40, 1
    s_lshl_b32 s46, s46, 3
    s_add_u32 s45, s45, s46
    s_add_u32 s45, s45, 13631488
    s_add_u32 s46, s45, 16384
    v_cvt_pk_bf16_f32 v96, v64, v72
    v_cvt_pk_bf16_f32 v97, v80, v88
    buffer_store_dwordx2 v[96:97], v10, s[8:11], s45 offen offset:0
    v_cvt_pk_bf16_f32 v98, v65, v73
    v_cvt_pk_bf16_f32 v99, v81, v89
    buffer_store_dwordx2 v[98:99], v10, s[8:11], s45 offen offset:1024
    v_cvt_pk_bf16_f32 v100, v66, v74
    v_cvt_pk_bf16_f32 v101, v82, v90
    buffer_store_dwordx2 v[100:101], v10, s[8:11], s45 offen offset:2048
    v_cvt_pk_bf16_f32 v102, v67, v75
    v_cvt_pk_bf16_f32 v103, v83, v91
    buffer_store_dwordx2 v[102:103], v10, s[8:11], s45 offen offset:3072
    v_cvt_pk_bf16_f32 v104, v68, v76
    v_cvt_pk_bf16_f32 v105, v84, v92
    buffer_store_dwordx2 v[104:105], v10, s[8:11], s46 offen offset:0
    v_cvt_pk_bf16_f32 v106, v69, v77
    v_cvt_pk_bf16_f32 v107, v85, v93
    buffer_store_dwordx2 v[106:107], v10, s[8:11], s46 offen offset:1024
    v_cvt_pk_bf16_f32 v108, v70, v78
    v_cvt_pk_bf16_f32 v109, v86, v94
    buffer_store_dwordx2 v[108:109], v10, s[8:11], s46 offen offset:2048
    v_cvt_pk_bf16_f32 v110, v71, v79
    v_cvt_pk_bf16_f32 v111, v87, v95
    buffer_store_dwordx2 v[110:111], v10, s[8:11], s46 offen offset:3072
    s_waitcnt vmcnt(0)
    s_nop 15
L_c_end:
    s_endpgm
    s_nop 15
L_c_prep:
    s_cmp_ge_u32 s2, 252
    s_cbranch_scc1 L_prep_end
    s_load_dwordx2 s[4:5], s[0:1], 64
    s_load_dwordx2 s[32:33], s[0:1], 32
    s_load_dwordx2 s[34:35], s[0:1], 40
    s_getpc_b64 s[6:7]
    s_add_u32 s6, s6, tab_base@rel32@lo+4
    s_addc_u32 s7, s7, tab_base@rel32@hi+12
    s_mov_b32 s12, s6
    s_and_b32 s13, s7, 0xffff
    s_mov_b32 s14, 121344
    s_mov_b32 s15, 0x20000
    s_waitcnt lgkmcnt(0)
    s_mov_b32 s8, s4
    s_and_b32 s9, s5, 0xffff
    s_mov_b32 s10, 0x10000000
    s_mov_b32 s11, 0x20000
    s_mov_b32 s28, s32
    s_and_b32 s29, s33, 0xffff
    s_mov_b32 s30, 1966080
    s_mov_b32 s31, 0x20000
    s_mov_b32 s40, s34
    s_and_b32 s41, s35, 0xffff
    s_mov_b32 s42, 1966080
    s_mov_b32 s43, 0x20000
    v_and_b32 v2, 15, v0
    v_bfe_u32 v3, v0, 4, 2
    v_lshrrev_b32 v1, 6, v0
    s_nop 0
    v_readfirstlane_b32 s44, v1
    v_and_b32 v4, 63, v0
    v_lshlrev_b32 v8, 4, v4
    s_mov_b32 s46, 0x05040100
    s_mov_b32 s47, 0x07060302
    s_lshl_b32 s59, s44, 14
    v_lshrrev_b32 v9, 1, v2
    v_lshlrev_b32 v9, 10, v9
    v_and_b32 v10, 1, v2
    v_lshl_add_u32 v9, v10, 7, v9
    v_lshl_add_u32 v9, v3, 8, v9
    v_add_u32 v9, s59, v9
    v_add_u32 v10, s59, v8
    s_cmp_ge_u32 s2, 222
    s_cbranch_scc1 L_prep_w2
    s_sub_u32 s45, s2, 192
    s_lshl_b32 s45, s45, 2
    s_add_u32 s45, s45, s44
    s_mul_i32 s45, s45, 2
    v_mul_u32_u24 v5, 98304, v3
    v_lshl_add_u32 v5, v2, 4, v5
    s_add_u32 s56, s45, 0
    s_mul_i32 s57, s56, 43691
    s_lshr_b32 s60, s57, 19
    s_mul_i32 s58, s60, 12
    s_sub_u32 s61, s56, s58
    s_lshl_b32 s50, s60, 1
    s_add_u32 s50, s50, 0
    s_mul_i32 s51, s50, 13
    s_lshr_b32 s51, s51, 6
    s_mul_i32 s52, s51, 5
    s_sub_u32 s52, s50, s52
    s_lshl_b32 s52, s52, 7
    s_add_u32 s52, s52, s51
    s_add_u32 s52, s52, 0
    s_mul_i32 s52, s52, 3072
    s_lshl_b32 s53, s61, 8
    s_add_u32 s52, s52, s53
    buffer_load_dwordx4 v[16:19], v5, s[28:31], s52 offen
    s_lshl_b32 s50, s60, 1
    s_add_u32 s50, s50, 0
    s_mul_i32 s51, s50, 13
    s_lshr_b32 s51, s51, 6
    s_mul_i32 s52, s51, 5
    s_sub_u32 s52, s50, s52
    s_lshl_b32 s52, s52, 7
    s_add_u32 s52, s52, s51
    s_add_u32 s52, s52, 8
    s_mul_i32 s52, s52, 3072
    s_lshl_b32 s53, s61, 8
    s_add_u32 s52, s52, s53
    buffer_load_dwordx4 v[20:23], v5, s[28:31], s52 offen
    s_lshl_b32 s50, s60, 1
    s_add_u32 s50, s50, 0
    s_mul_i32 s51, s50, 13
    s_lshr_b32 s51, s51, 6
    s_mul_i32 s52, s51, 5
    s_sub_u32 s52, s50, s52
    s_lshl_b32 s52, s52, 7
    s_add_u32 s52, s52, s51
    s_add_u32 s52, s52, 16
    s_mul_i32 s52, s52, 3072
    s_lshl_b32 s53, s61, 8
    s_add_u32 s52, s52, s53
    buffer_load_dwordx4 v[24:27], v5, s[28:31], s52 offen
    s_lshl_b32 s50, s60, 1
    s_add_u32 s50, s50, 0
    s_mul_i32 s51, s50, 13
    s_lshr_b32 s51, s51, 6
    s_mul_i32 s52, s51, 5
    s_sub_u32 s52, s50, s52
    s_lshl_b32 s52, s52, 7
    s_add_u32 s52, s52, s51
    s_add_u32 s52, s52, 24
    s_mul_i32 s52, s52, 3072
    s_lshl_b32 s53, s61, 8
    s_add_u32 s52, s52, s53
    buffer_load_dwordx4 v[28:31], v5, s[28:31], s52 offen
    s_lshl_b32 s50, s60, 1
    s_add_u32 s50, s50, 1
    s_mul_i32 s51, s50, 13
    s_lshr_b32 s51, s51, 6
    s_mul_i32 s52, s51, 5
    s_sub_u32 s52, s50, s52
    s_lshl_b32 s52, s52, 7
    s_add_u32 s52, s52, s51
    s_add_u32 s52, s52, 0
    s_mul_i32 s52, s52, 3072
    s_lshl_b32 s53, s61, 8
    s_add_u32 s52, s52, s53
    buffer_load_dwordx4 v[32:35], v5, s[28:31], s52 offen
    s_lshl_b32 s50, s60, 1
    s_add_u32 s50, s50, 1
    s_mul_i32 s51, s50, 13
    s_lshr_b32 s51, s51, 6
    s_mul_i32 s52, s51, 5
    s_sub_u32 s52, s50, s52
    s_lshl_b32 s52, s52, 7
    s_add_u32 s52, s52, s51
    s_add_u32 s52, s52, 8
    s_mul_i32 s52, s52, 3072
    s_lshl_b32 s53, s61, 8
    s_add_u32 s52, s52, s53
    buffer_load_dwordx4 v[36:39], v5, s[28:31], s52 offen
    s_lshl_b32 s50, s60, 1
    s_add_u32 s50, s50, 1
    s_mul_i32 s51, s50, 13
    s_lshr_b32 s51, s51, 6
    s_mul_i32 s52, s51, 5
    s_sub_u32 s52, s50, s52
    s_lshl_b32 s52, s52, 7
    s_add_u32 s52, s52, s51
    s_add_u32 s52, s52, 16
    s_mul_i32 s52, s52, 3072
    s_lshl_b32 s53, s61, 8
    s_add_u32 s52, s52, s53
    buffer_load_dwordx4 v[40:43], v5, s[28:31], s52 offen
    s_lshl_b32 s50, s60, 1
    s_add_u32 s50, s50, 1
    s_mul_i32 s51, s50, 13
    s_lshr_b32 s51, s51, 6
    s_mul_i32 s52, s51, 5
    s_sub_u32 s52, s50, s52
    s_lshl_b32 s52, s52, 7
    s_add_u32 s52, s52, s51
    s_add_u32 s52, s52, 24
    s_mul_i32 s52, s52, 3072
    s_lshl_b32 s53, s61, 8
    s_add_u32 s52, s52, s53
    buffer_load_dwordx4 v[44:47], v5, s[28:31], s52 offen
    s_add_u32 s56, s45, 1
    s_mul_i32 s57, s56, 43691
    s_lshr_b32 s62, s57, 19
    s_mul_i32 s58, s62, 12
    s_sub_u32 s63, s56, s58
    s_lshl_b32 s50, s62, 1
    s_add_u32 s50, s50, 0
    s_mul_i32 s51, s50, 13
    s_lshr_b32 s51, s51, 6
    s_mul_i32 s52, s51, 5
    s_sub_u32 s52, s50, s52
    s_lshl_b32 s52, s52, 7
    s_add_u32 s52, s52, s51
    s_add_u32 s52, s52, 0
    s_mul_i32 s52, s52, 3072
    s_lshl_b32 s53, s63, 8
    s_add_u32 s52, s52, s53
    buffer_load_dwordx4 v[48:51], v5, s[28:31], s52 offen
    s_lshl_b32 s50, s62, 1
    s_add_u32 s50, s50, 0
    s_mul_i32 s51, s50, 13
    s_lshr_b32 s51, s51, 6
    s_mul_i32 s52, s51, 5
    s_sub_u32 s52, s50, s52
    s_lshl_b32 s52, s52, 7
    s_add_u32 s52, s52, s51
    s_add_u32 s52, s52, 8
    s_mul_i32 s52, s52, 3072
    s_lshl_b32 s53, s63, 8
    s_add_u32 s52, s52, s53
    buffer_load_dwordx4 v[52:55], v5, s[28:31], s52 offen
    s_lshl_b32 s50, s62, 1
    s_add_u32 s50, s50, 0
    s_mul_i32 s51, s50, 13
    s_lshr_b32 s51, s51, 6
    s_mul_i32 s52, s51, 5
    s_sub_u32 s52, s50, s52
    s_lshl_b32 s52, s52, 7
    s_add_u32 s52, s52, s51
    s_add_u32 s52, s52, 16
    s_mul_i32 s52, s52, 3072
    s_lshl_b32 s53, s63, 8
    s_add_u32 s52, s52, s53
    buffer_load_dwordx4 v[56:59], v5, s[28:31], s52 offen
    s_lshl_b32 s50, s62, 1
    s_add_u32 s50, s50, 0
    s_mul_i32 s51, s50, 13
    s_lshr_b32 s51, s51, 6
    s_mul_i32 s52, s51, 5
    s_sub_u32 s52, s50, s52
    s_lshl_b32 s52, s52, 7
    s_add_u32 s52, s52, s51
    s_add_u32 s52, s52, 24
    s_mul_i32 s52, s52, 3072
    s_lshl_b32 s53, s63, 8
    s_add_u32 s52, s52, s53
    buffer_load_dwordx4 v[60:63], v5, s[28:31], s52 offen
    s_lshl_b32 s50, s62, 1
    s_add_u32 s50, s50, 1
    s_mul_i32 s51, s50, 13
    s_lshr_b32 s51, s51, 6
    s_mul_i32 s52, s51, 5
    s_sub_u32 s52, s50, s52
    s_lshl_b32 s52, s52, 7
    s_add_u32 s52, s52, s51
    s_add_u32 s52, s52, 0
    s_mul_i32 s52, s52, 3072
    s_lshl_b32 s53, s63, 8
    s_add_u32 s52, s52, s53
    buffer_load_dwordx4 v[64:67], v5, s[28:31], s52 offen
    s_lshl_b32 s50, s62, 1
    s_add_u32 s50, s50, 1
    s_mul_i32 s51, s50, 13
    s_lshr_b32 s51, s51, 6
    s_mul_i32 s52, s51, 5
    s_sub_u32 s52, s50, s52
    s_lshl_b32 s52, s52, 7
    s_add_u32 s52, s52, s51
    s_add_u32 s52, s52, 8
    s_mul_i32 s52, s52, 3072
    s_lshl_b32 s53, s63, 8
    s_add_u32 s52, s52, s53
    buffer_load_dwordx4 v[68:71], v5, s[28:31], s52 offen
    s_lshl_b32 s50, s62, 1
    s_add_u32 s50, s50, 1
    s_mul_i32 s51, s50, 13
    s_lshr_b32 s51, s51, 6
    s_mul_i32 s52, s51, 5
    s_sub_u32 s52, s50, s52
    s_lshl_b32 s52, s52, 7
    s_add_u32 s52, s52, s51
    s_add_u32 s52, s52, 16
    s_mul_i32 s52, s52, 3072
    s_lshl_b32 s53, s63, 8
    s_add_u32 s52, s52, s53
    buffer_load_dwordx4 v[72:75], v5, s[28:31], s52 offen
    s_lshl_b32 s50, s62, 1
    s_add_u32 s50, s50, 1
    s_mul_i32 s51, s50, 13
    s_lshr_b32 s51, s51, 6
    s_mul_i32 s52, s51, 5
    s_sub_u32 s52, s50, s52
    s_lshl_b32 s52, s52, 7
    s_add_u32 s52, s52, s51
    s_add_u32 s52, s52, 24
    s_mul_i32 s52, s52, 3072
    s_lshl_b32 s53, s63, 8
    s_add_u32 s52, s52, s53
    buffer_load_dwordx4 v[76:79], v5, s[28:31], s52 offen
    s_waitcnt vmcnt(14)
    v_perm_b32 v80, v20, v16, s46
    s_waitcnt vmcnt(12)
    v_perm_b32 v81, v28, v24, s46
    s_waitcnt vmcnt(10)
    v_perm_b32 v82, v36, v32, s46
    s_waitcnt vmcnt(8)
    v_perm_b32 v83, v44, v40, s46
    v_perm_b32 v84, v20, v16, s47
    v_perm_b32 v85, v28, v24, s47
    v_perm_b32 v86, v36, v32, s47
    v_perm_b32 v87, v44, v40, s47
    v_perm_b32 v88, v21, v17, s46
    v_perm_b32 v89, v29, v25, s46
    v_perm_b32 v90, v37, v33, s46
    v_perm_b32 v91, v45, v41, s46
    v_perm_b32 v92, v21, v17, s47
    v_perm_b32 v93, v29, v25, s47
    v_perm_b32 v94, v37, v33, s47
    v_perm_b32 v95, v45, v41, s47
    v_perm_b32 v96, v22, v18, s46
    v_perm_b32 v97, v30, v26, s46
    v_perm_b32 v98, v38, v34, s46
    v_perm_b32 v99, v46, v42, s46
    v_perm_b32 v100, v22, v18, s47
    v_perm_b32 v101, v30, v26, s47
    v_perm_b32 v102, v38, v34, s47
    v_perm_b32 v103, v46, v42, s47
    v_perm_b32 v104, v23, v19, s46
    v_perm_b32 v105, v31, v27, s46
    v_perm_b32 v106, v39, v35, s46
    v_perm_b32 v107, v47, v43, s46
    v_perm_b32 v108, v23, v19, s47
    v_perm_b32 v109, v31, v27, s47
    v_perm_b32 v110, v39, v35, s47
    v_perm_b32 v111, v47, v43, s47
    ds_write_b128 v9, v[80:83] offset:0
    ds_write_b128 v9, v[84:87] offset:16
    ds_write_b128 v9, v[88:91] offset:32
    ds_write_b128 v9, v[92:95] offset:48
    ds_write_b128 v9, v[96:99] offset:64
    ds_write_b128 v9, v[100:103] offset:80
    ds_write_b128 v9, v[104:107] offset:96
    ds_write_b128 v9, v[108:111] offset:112
    ds_read_b128 v[16:19], v10 offset:0
    ds_read_b128 v[20:23], v10 offset:1024
    ds_read_b128 v[24:27], v10 offset:2048
    ds_read_b128 v[28:31], v10 offset:3072
    ds_read_b128 v[32:35], v10 offset:4096
    ds_read_b128 v[36:39], v10 offset:5120
    ds_read_b128 v[40:43], v10 offset:6144
    ds_read_b128 v[44:47], v10 offset:7168
    s_mul_i32 s50, s61, 163840
    s_lshl_b32 s51, s60, 10
    s_add_u32 s50, s50, s51
    s_add_u32 s51, s50, 0
    s_waitcnt lgkmcnt(7)
    buffer_store_dwordx4 v[16:19], v8, s[8:11], s51 offen
    s_add_u32 s51, s50, 20480
    s_waitcnt lgkmcnt(6)
    buffer_store_dwordx4 v[20:23], v8, s[8:11], s51 offen
    s_add_u32 s51, s50, 40960
    s_waitcnt lgkmcnt(5)
    buffer_store_dwordx4 v[24:27], v8, s[8:11], s51 offen
    s_add_u32 s51, s50, 61440
    s_waitcnt lgkmcnt(4)
    buffer_store_dwordx4 v[28:31], v8, s[8:11], s51 offen
    s_add_u32 s51, s50, 81920
    s_waitcnt lgkmcnt(3)
    buffer_store_dwordx4 v[32:35], v8, s[8:11], s51 offen
    s_add_u32 s51, s50, 102400
    s_waitcnt lgkmcnt(2)
    buffer_store_dwordx4 v[36:39], v8, s[8:11], s51 offen
    s_add_u32 s51, s50, 122880
    s_waitcnt lgkmcnt(1)
    buffer_store_dwordx4 v[40:43], v8, s[8:11], s51 offen
    s_add_u32 s51, s50, 143360
    s_waitcnt lgkmcnt(0)
    buffer_store_dwordx4 v[44:47], v8, s[8:11], s51 offen
    s_waitcnt vmcnt(14)
    v_perm_b32 v112, v52, v48, s46
    s_waitcnt vmcnt(12)
    v_perm_b32 v113, v60, v56, s46
    s_waitcnt vmcnt(10)
    v_perm_b32 v114, v68, v64, s46
    s_waitcnt vmcnt(8)
    v_perm_b32 v115, v76, v72, s46
    v_perm_b32 v116, v52, v48, s47
    v_perm_b32 v117, v60, v56, s47
    v_perm_b32 v118, v68, v64, s47
    v_perm_b32 v119, v76, v72, s47
    v_perm_b32 v120, v53, v49, s46
    v_perm_b32 v121, v61, v57, s46
    v_perm_b32 v122, v69, v65, s46
    v_perm_b32 v123, v77, v73, s46
    v_perm_b32 v124, v53, v49, s47
    v_perm_b32 v125, v61, v57, s47
    v_perm_b32 v126, v69, v65, s47
    v_perm_b32 v127, v77, v73, s47
    v_perm_b32 v128, v54, v50, s46
    v_perm_b32 v129, v62, v58, s46
    v_perm_b32 v130, v70, v66, s46
    v_perm_b32 v131, v78, v74, s46
    v_perm_b32 v132, v54, v50, s47
    v_perm_b32 v133, v62, v58, s47
    v_perm_b32 v134, v70, v66, s47
    v_perm_b32 v135, v78, v74, s47
    v_perm_b32 v136, v55, v51, s46
    v_perm_b32 v137, v63, v59, s46
    v_perm_b32 v138, v71, v67, s46
    v_perm_b32 v139, v79, v75, s46
    v_perm_b32 v140, v55, v51, s47
    v_perm_b32 v141, v63, v59, s47
    v_perm_b32 v142, v71, v67, s47
    v_perm_b32 v143, v79, v75, s47
    ds_write_b128 v9, v[112:115] offset:8192
    ds_write_b128 v9, v[116:119] offset:8208
    ds_write_b128 v9, v[120:123] offset:8224
    ds_write_b128 v9, v[124:127] offset:8240
    ds_write_b128 v9, v[128:131] offset:8256
    ds_write_b128 v9, v[132:135] offset:8272
    ds_write_b128 v9, v[136:139] offset:8288
    ds_write_b128 v9, v[140:143] offset:8304
    ds_read_b128 v[48:51], v10 offset:8192
    ds_read_b128 v[52:55], v10 offset:9216
    ds_read_b128 v[56:59], v10 offset:10240
    ds_read_b128 v[60:63], v10 offset:11264
    ds_read_b128 v[64:67], v10 offset:12288
    ds_read_b128 v[68:71], v10 offset:13312
    ds_read_b128 v[72:75], v10 offset:14336
    ds_read_b128 v[76:79], v10 offset:15360
    s_mul_i32 s50, s63, 163840
    s_lshl_b32 s51, s62, 10
    s_add_u32 s50, s50, s51
    s_add_u32 s51, s50, 0
    s_waitcnt lgkmcnt(7)
    buffer_store_dwordx4 v[48:51], v8, s[8:11], s51 offen
    s_add_u32 s51, s50, 20480
    s_waitcnt lgkmcnt(6)
    buffer_store_dwordx4 v[52:55], v8, s[8:11], s51 offen
    s_add_u32 s51, s50, 40960
    s_waitcnt lgkmcnt(5)
    buffer_store_dwordx4 v[56:59], v8, s[8:11], s51 offen
    s_add_u32 s51, s50, 61440
    s_waitcnt lgkmcnt(4)
    buffer_store_dwordx4 v[60:63], v8, s[8:11], s51 offen
    s_add_u32 s51, s50, 81920
    s_waitcnt lgkmcnt(3)
    buffer_store_dwordx4 v[64:67], v8, s[8:11], s51 offen
    s_add_u32 s51, s50, 102400
    s_waitcnt lgkmcnt(2)
    buffer_store_dwordx4 v[68:71], v8, s[8:11], s51 offen
    s_add_u32 s51, s50, 122880
    s_waitcnt lgkmcnt(1)
    buffer_store_dwordx4 v[72:75], v8, s[8:11], s51 offen
    s_add_u32 s51, s50, 143360
    s_waitcnt lgkmcnt(0)
    buffer_store_dwordx4 v[76:79], v8, s[8:11], s51 offen
    s_endpgm
    s_nop 15
L_prep_w2:
    s_sub_u32 s45, s2, 222
    s_lshl_b32 s45, s45, 2
    s_add_u32 s45, s45, s44
    s_mul_i32 s45, s45, 2
    v_mul_u32_u24 v5, 5120, v3
    v_lshl_add_u32 v5, v2, 4, v5
    s_add_u32 s56, s45, 0
    s_mul_i32 s57, s56, 52429
    s_lshr_b32 s60, s57, 18
    s_mul_i32 s58, s60, 5
    s_sub_u32 s61, s56, s58
    s_lshl_b32 s50, s60, 5
    s_add_u32 s50, s50, 0
    s_mul_i32 s50, s50, 1280
    s_lshl_b32 s53, s61, 8
    s_add_u32 s50, s50, s53
    buffer_load_dwordx4 v[16:19], v5, s[40:43], s50 offen
    s_lshl_b32 s50, s60, 5
    s_add_u32 s50, s50, 1
    s_mul_i32 s50, s50, 1280
    s_lshl_b32 s53, s61, 8
    s_add_u32 s50, s50, s53
    buffer_load_dwordx4 v[20:23], v5, s[40:43], s50 offen
    s_lshl_b32 s50, s60, 5
    s_add_u32 s50, s50, 2
    s_mul_i32 s50, s50, 1280
    s_lshl_b32 s53, s61, 8
    s_add_u32 s50, s50, s53
    buffer_load_dwordx4 v[24:27], v5, s[40:43], s50 offen
    s_lshl_b32 s50, s60, 5
    s_add_u32 s50, s50, 3
    s_mul_i32 s50, s50, 1280
    s_lshl_b32 s53, s61, 8
    s_add_u32 s50, s50, s53
    buffer_load_dwordx4 v[28:31], v5, s[40:43], s50 offen
    s_lshl_b32 s50, s60, 5
    s_add_u32 s50, s50, 16
    s_mul_i32 s50, s50, 1280
    s_lshl_b32 s53, s61, 8
    s_add_u32 s50, s50, s53
    buffer_load_dwordx4 v[32:35], v5, s[40:43], s50 offen
    s_lshl_b32 s50, s60, 5
    s_add_u32 s50, s50, 17
    s_mul_i32 s50, s50, 1280
    s_lshl_b32 s53, s61, 8
    s_add_u32 s50, s50, s53
    buffer_load_dwordx4 v[36:39], v5, s[40:43], s50 offen
    s_lshl_b32 s50, s60, 5
    s_add_u32 s50, s50, 18
    s_mul_i32 s50, s50, 1280
    s_lshl_b32 s53, s61, 8
    s_add_u32 s50, s50, s53
    buffer_load_dwordx4 v[40:43], v5, s[40:43], s50 offen
    s_lshl_b32 s50, s60, 5
    s_add_u32 s50, s50, 19
    s_mul_i32 s50, s50, 1280
    s_lshl_b32 s53, s61, 8
    s_add_u32 s50, s50, s53
    buffer_load_dwordx4 v[44:47], v5, s[40:43], s50 offen
    s_add_u32 s56, s45, 1
    s_mul_i32 s57, s56, 52429
    s_lshr_b32 s62, s57, 18
    s_mul_i32 s58, s62, 5
    s_sub_u32 s63, s56, s58
    s_lshl_b32 s50, s62, 5
    s_add_u32 s50, s50, 0
    s_mul_i32 s50, s50, 1280
    s_lshl_b32 s53, s63, 8
    s_add_u32 s50, s50, s53
    buffer_load_dwordx4 v[48:51], v5, s[40:43], s50 offen
    s_lshl_b32 s50, s62, 5
    s_add_u32 s50, s50, 1
    s_mul_i32 s50, s50, 1280
    s_lshl_b32 s53, s63, 8
    s_add_u32 s50, s50, s53
    buffer_load_dwordx4 v[52:55], v5, s[40:43], s50 offen
    s_lshl_b32 s50, s62, 5
    s_add_u32 s50, s50, 2
    s_mul_i32 s50, s50, 1280
    s_lshl_b32 s53, s63, 8
    s_add_u32 s50, s50, s53
    buffer_load_dwordx4 v[56:59], v5, s[40:43], s50 offen
    s_lshl_b32 s50, s62, 5
    s_add_u32 s50, s50, 3
    s_mul_i32 s50, s50, 1280
    s_lshl_b32 s53, s63, 8
    s_add_u32 s50, s50, s53
    buffer_load_dwordx4 v[60:63], v5, s[40:43], s50 offen
    s_lshl_b32 s50, s62, 5
    s_add_u32 s50, s50, 16
    s_mul_i32 s50, s50, 1280
    s_lshl_b32 s53, s63, 8
    s_add_u32 s50, s50, s53
    buffer_load_dwordx4 v[64:67], v5, s[40:43], s50 offen
    s_lshl_b32 s50, s62, 5
    s_add_u32 s50, s50, 17
    s_mul_i32 s50, s50, 1280
    s_lshl_b32 s53, s63, 8
    s_add_u32 s50, s50, s53
    buffer_load_dwordx4 v[68:71], v5, s[40:43], s50 offen
    s_lshl_b32 s50, s62, 5
    s_add_u32 s50, s50, 18
    s_mul_i32 s50, s50, 1280
    s_lshl_b32 s53, s63, 8
    s_add_u32 s50, s50, s53
    buffer_load_dwordx4 v[72:75], v5, s[40:43], s50 offen
    s_lshl_b32 s50, s62, 5
    s_add_u32 s50, s50, 19
    s_mul_i32 s50, s50, 1280
    s_lshl_b32 s53, s63, 8
    s_add_u32 s50, s50, s53
    buffer_load_dwordx4 v[76:79], v5, s[40:43], s50 offen
    s_waitcnt vmcnt(14)
    v_perm_b32 v80, v20, v16, s46
    s_waitcnt vmcnt(12)
    v_perm_b32 v81, v28, v24, s46
    s_waitcnt vmcnt(10)
    v_perm_b32 v82, v36, v32, s46
    s_waitcnt vmcnt(8)
    v_perm_b32 v83, v44, v40, s46
    v_perm_b32 v84, v20, v16, s47
    v_perm_b32 v85, v28, v24, s47
    v_perm_b32 v86, v36, v32, s47
    v_perm_b32 v87, v44, v40, s47
    v_perm_b32 v88, v21, v17, s46
    v_perm_b32 v89, v29, v25, s46
    v_perm_b32 v90, v37, v33, s46
    v_perm_b32 v91, v45, v41, s46
    v_perm_b32 v92, v21, v17, s47
    v_perm_b32 v93, v29, v25, s47
    v_perm_b32 v94, v37, v33, s47
    v_perm_b32 v95, v45, v41, s47
    v_perm_b32 v96, v22, v18, s46
    v_perm_b32 v97, v30, v26, s46
    v_perm_b32 v98, v38, v34, s46
    v_perm_b32 v99, v46, v42, s46
    v_perm_b32 v100, v22, v18, s47
    v_perm_b32 v101, v30, v26, s47
    v_perm_b32 v102, v38, v34, s47
    v_perm_b32 v103, v46, v42, s47
    v_perm_b32 v104, v23, v19, s46
    v_perm_b32 v105, v31, v27, s46
    v_perm_b32 v106, v39, v35, s46
    v_perm_b32 v107, v47, v43, s46
    v_perm_b32 v108, v23, v19, s47
    v_perm_b32 v109, v31, v27, s47
    v_perm_b32 v110, v39, v35, s47
    v_perm_b32 v111, v47, v43, s47
    ds_write_b128 v9, v[80:83] offset:0
    ds_write_b128 v9, v[84:87] offset:16
    ds_write_b128 v9, v[88:91] offset:32
    ds_write_b128 v9, v[92:95] offset:48
    ds_write_b128 v9, v[96:99] offset:64
    ds_write_b128 v9, v[100:103] offset:80
    ds_write_b128 v9, v[104:107] offset:96
    ds_write_b128 v9, v[108:111] offset:112
    ds_read_b128 v[16:19], v10 offset:0
    ds_read_b128 v[20:23], v10 offset:1024
    ds_read_b128 v[24:27], v10 offset:2048
    ds_read_b128 v[28:31], v10 offset:3072
    ds_read_b128 v[32:35], v10 offset:4096
    ds_read_b128 v[36:39], v10 offset:5120
    ds_read_b128 v[40:43], v10 offset:6144
    ds_read_b128 v[44:47], v10 offset:7168
    s_mul_i32 s50, s61, 49152
    s_lshl_b32 s51, s60, 10
    s_add_u32 s50, s50, s51
    s_add_u32 s52, s50, 2097152
    buffer_store_dwordx4 v[80:83], v8, s[8:11], s52 offen
    s_add_u32 s52, s50, 2342912
    buffer_store_dwordx4 v[84:87], v8, s[8:11], s52 offen
    s_add_u32 s52, s50, 2588672
    buffer_store_dwordx4 v[88:91], v8, s[8:11], s52 offen
    s_add_u32 s52, s50, 2834432
    buffer_store_dwordx4 v[92:95], v8, s[8:11], s52 offen
    s_add_u32 s52, s50, 3080192
    buffer_store_dwordx4 v[96:99], v8, s[8:11], s52 offen
    s_add_u32 s52, s50, 3325952
    buffer_store_dwordx4 v[100:103], v8, s[8:11], s52 offen
    s_add_u32 s52, s50, 3571712
    buffer_store_dwordx4 v[104:107], v8, s[8:11], s52 offen
    s_add_u32 s52, s50, 3817472
    buffer_store_dwordx4 v[108:111], v8, s[8:11], s52 offen
    s_mul_i32 s50, s61, 393216
    s_add_u32 s50, s50, s51
    s_add_u32 s52, s50, 4194304
    s_waitcnt lgkmcnt(7)
    buffer_store_dwordx4 v[16:19], v8, s[8:11], s52 offen
    s_add_u32 s52, s50, 4243456
    s_waitcnt lgkmcnt(6)
    buffer_store_dwordx4 v[20:23], v8, s[8:11], s52 offen
    s_add_u32 s52, s50, 4292608
    s_waitcnt lgkmcnt(5)
    buffer_store_dwordx4 v[24:27], v8, s[8:11], s52 offen
    s_add_u32 s52, s50, 4341760
    s_waitcnt lgkmcnt(4)
    buffer_store_dwordx4 v[28:31], v8, s[8:11], s52 offen
    s_add_u32 s52, s50, 4390912
    s_waitcnt lgkmcnt(3)
    buffer_store_dwordx4 v[32:35], v8, s[8:11], s52 offen
    s_add_u32 s52, s50, 4440064
    s_waitcnt lgkmcnt(2)
    buffer_store_dwordx4 v[36:39], v8, s[8:11], s52 offen
    s_add_u32 s52, s50, 4489216
    s_waitcnt lgkmcnt(1)
    buffer_store_dwordx4 v[40:43], v8, s[8:11], s52 offen
    s_add_u32 s52, s50, 4538368
    s_waitcnt lgkmcnt(0)
    buffer_store_dwordx4 v[44:47], v8, s[8:11], s52 offen
    s_waitcnt vmcnt(22)
    v_perm_b32 v112, v52, v48, s46
    s_waitcnt vmcnt(20)
    v_perm_b32 v113, v60, v56, s46
    s_waitcnt vmcnt(18)
    v_perm_b32 v114, v68, v64, s46
    s_waitcnt vmcnt(16)
    v_perm_b32 v115, v76, v72, s46
    v_perm_b32 v116, v52, v48, s47
    v_perm_b32 v117, v60, v56, s47
    v_perm_b32 v118, v68, v64, s47
    v_perm_b32 v119, v76, v72, s47
    v_perm_b32 v120, v53, v49, s46
    v_perm_b32 v121, v61, v57, s46
    v_perm_b32 v122, v69, v65, s46
    v_perm_b32 v123, v77, v73, s46
    v_perm_b32 v124, v53, v49, s47
    v_perm_b32 v125, v61, v57, s47
    v_perm_b32 v126, v69, v65, s47
    v_perm_b32 v127, v77, v73, s47
    v_perm_b32 v128, v54, v50, s46
    v_perm_b32 v129, v62, v58, s46
    v_perm_b32 v130, v70, v66, s46
    v_perm_b32 v131, v78, v74, s46
    v_perm_b32 v132, v54, v50, s47
    v_perm_b32 v133, v62, v58, s47
    v_perm_b32 v134, v70, v66, s47
    v_perm_b32 v135, v78, v74, s47
    v_perm_b32 v136, v55, v51, s46
    v_perm_b32 v137, v63, v59, s46
    v_perm_b32 v138, v71, v67, s46
    v_perm_b32 v139, v79, v75, s46
    v_perm_b32 v140, v55, v51, s47
    v_perm_b32 v141, v63, v59, s47
    v_perm_b32 v142, v71, v67, s47
    v_perm_b32 v143, v79, v75, s47
    ds_write_b128 v9, v[112:115] offset:8192
    ds_write_b128 v9, v[116:119] offset:8208
    ds_write_b128 v9, v[120:123] offset:8224
    ds_write_b128 v9, v[124:127] offset:8240
    ds_write_b128 v9, v[128:131] offset:8256
    ds_write_b128 v9, v[132:135] offset:8272
    ds_write_b128 v9, v[136:139] offset:8288
    ds_write_b128 v9, v[140:143] offset:8304
    ds_read_b128 v[48:51], v10 offset:8192
    ds_read_b128 v[52:55], v10 offset:9216
    ds_read_b128 v[56:59], v10 offset:10240
    ds_read_b128 v[60:63], v10 offset:11264
    ds_read_b128 v[64:67], v10 offset:12288
    ds_read_b128 v[68:71], v10 offset:13312
    ds_read_b128 v[72:75], v10 offset:14336
    ds_read_b128 v[76:79], v10 offset:15360
    s_mul_i32 s50, s63, 49152
    s_lshl_b32 s51, s62, 10
    s_add_u32 s50, s50, s51
    s_add_u32 s52, s50, 2097152
    buffer_store_dwordx4 v[112:115], v8, s[8:11], s52 offen
    s_add_u32 s52, s50, 2342912
    buffer_store_dwordx4 v[116:119], v8, s[8:11], s52 offen
    s_add_u32 s52, s50, 2588672
    buffer_store_dwordx4 v[120:123], v8, s[8:11], s52 offen
    s_add_u32 s52, s50, 2834432
    buffer_store_dwordx4 v[124:127], v8, s[8:11], s52 offen
    s_add_u32 s52, s50, 3080192
    buffer_store_dwordx4 v[128:131], v8, s[8:11], s52 offen
    s_add_u32 s52, s50, 3325952
    buffer_store_dwordx4 v[132:135], v8, s[8:11], s52 offen
    s_add_u32 s52, s50, 3571712
    buffer_store_dwordx4 v[136:139], v8, s[8:11], s52 offen
    s_add_u32 s52, s50, 3817472
    buffer_store_dwordx4 v[140:143], v8, s[8:11], s52 offen
    s_mul_i32 s50, s63, 393216
    s_add_u32 s50, s50, s51
    s_add_u32 s52, s50, 4194304
    s_waitcnt lgkmcnt(7)
    buffer_store_dwordx4 v[48:51], v8, s[8:11], s52 offen
    s_add_u32 s52, s50, 4243456
    s_waitcnt lgkmcnt(6)
    buffer_store_dwordx4 v[52:55], v8, s[8:11], s52 offen
    s_add_u32 s52, s50, 4292608
    s_waitcnt lgkmcnt(5)
    buffer_store_dwordx4 v[56:59], v8, s[8:11], s52 offen
    s_add_u32 s52, s50, 4341760
    s_waitcnt lgkmcnt(4)
    buffer_store_dwordx4 v[60:63], v8, s[8:11], s52 offen
    s_add_u32 s52, s50, 4390912
    s_waitcnt lgkmcnt(3)
    buffer_store_dwordx4 v[64:67], v8, s[8:11], s52 offen
    s_add_u32 s52, s50, 4440064
    s_waitcnt lgkmcnt(2)
    buffer_store_dwordx4 v[68:71], v8, s[8:11], s52 offen
    s_add_u32 s52, s50, 4489216
    s_waitcnt lgkmcnt(1)
    buffer_store_dwordx4 v[72:75], v8, s[8:11], s52 offen
    s_add_u32 s52, s50, 4538368
    s_waitcnt lgkmcnt(0)
    buffer_store_dwordx4 v[76:79], v8, s[8:11], s52 offen
    s_nop 15
L_prep_end:
    s_endpgm
.globl c2_kernel
.p2align 8
.type c2_kernel,@function
c2_kernel:
    s_mov_b32 s60, 12648448
    s_branch L_c_body
.globl g12a_kernel
.p2align 8
.type g12a_kernel,@function
g12a_kernel:
    s_mov_b32 s60, 12582912
    s_mov_b32 s65, 2097152
    s_mov_b32 s66, 26214400
    s_cmp_ge_u32 s2, 256
    s_cbranch_scc1 L_g12a_kernel_end
    s_and_b32 s40, s2, 7
    s_lshl_b32 s40, s40, 2
    s_lshr_b32 s41, s2, 6
    s_add_u32 s40, s40, s41
    s_lshr_b32 s41, s2, 3
    s_and_b32 s41, s41, 7
    s_load_dwordx2 s[4:5], s[0:1], 64
    s_load_dwordx2 s[32:33], s[0:1], 48
    s_getpc_b64 s[6:7]
    s_add_u32 s6, s6, tab_base@rel32@lo+4
    s_addc_u32 s7, s7, tab_base@rel32@hi+12
    s_mov_b32 s12, s6
    s_and_b32 s13, s7, 0xffff
    s_mov_b32 s14, 121344
    s_mov_b32 s15, 0x20000
    v_and_b32 v2, 15, v0
    v_bfe_u32 v3, v0, 4, 2
    v_lshrrev_b32 v1, 6, v0
    s_nop 0
    v_readfirstlane_b32 s44, v1
    v_and_b32 v4, 63, v0
    v_lshlrev_b32 v8, 4, v4
    s_lshl_b32 s52, s44, 10
    s_add_u32 m0, s52, 106496
    s_add_u32 s52, s52, 83456
    buffer_load_dwordx4 v8, s[12:15], s52 offen lds
    s_add_u32 m0, m0, 4096
    s_add_u32 s52, s52, 4096
    buffer_load_dwordx4 v8, s[12:15], s52 offen lds
    s_add_u32 m0, m0, 4096
    s_add_u32 s52, s52, 4096
    buffer_load_dwordx4 v8, s[12:15], s52 offen lds
    s_add_u32 m0, m0, 4096
    s_add_u32 s52, s52, 4096
    buffer_load_dwordx4 v8, s[12:15], s52 offen lds
    s_add_u32 m0, m0, 4096
    s_add_u32 s52, s52, 4096
    buffer_load_dwordx4 v8, s[12:15], s52 offen lds
    s_add_u32 m0, m0, 4096
    s_add_u32 s52, s52, 4096
    buffer_load_dwordx4 v8, s[12:15], s52 offen lds
    s_add_u32 m0, m0, 4096
    s_add_u32 s52, s52, 4096
    buffer_load_dwordx4 v8, s[12:15], s52 offen lds
    s_add_u32 m0, m0, 4096
    s_add_u32 s52, s52, 4096
    buffer_load_dwordx4 v8, s[12:15], s52 offen lds
    s_add_u32 m0, m0, 4096
    s_add_u32 s52, s52, 4096
    buffer_load_dwordx4 v8, s[12:15], s52 offen lds
    s_add_u32 m0, m0, 4096
    s_add_u32 s52, s52, 4096
    buffer_load_dwordx4 v8, s[12:15], s52 offen lds
    s_waitcnt lgkmcnt(0)
    s_mov_b32 s8, s4
    s_and_b32 s9, s5, 0xffff
    s_mov_b32 s10, 0x10000000
    s_mov_b32 s11, 0x20000
    s_mov_b32 s28, s32
    s_and_b32 s29, s33, 0xffff
    s_mov_b32 s30, 2621440
    s_mov_b32 s31, 0x20000
    s_lshl_b32 s45, s40, 6
    s_lshl_b32 s46, s44, 4
    s_add_u32 s45, s45, s46
    v_add_u32 v5, s45, v2
    v_lshlrev_b32 v7, 3, v5
    s_mov_b32 s47, 13631488
    buffer_load_dword v12, v7, s[8:11], s60 offen
    v_lshlrev_b32 v7, 4, v5
    buffer_load_ushort v13, v7, s[8:11], s47 offen
    v_lshl_add_u32 v7, v3, 15, v7
    s_mov_b32 s47, 13631488
    buffer_load_dwordx4 a[0:3], v7, s[8:11], s47 offen
    s_mov_b32 s47, 13762560
    buffer_load_dwordx4 a[4:7], v7, s[8:11], s47 offen
    s_mov_b32 s47, 13893632
    buffer_load_dwordx4 a[8:11], v7, s[8:11], s47 offen
    s_mov_b32 s47, 14024704
    buffer_load_dwordx4 a[12:15], v7, s[8:11], s47 offen
    s_mov_b32 s47, 14155776
    buffer_load_dwordx4 a[16:19], v7, s[8:11], s47 offen
    s_mov_b32 s47, 14286848
    buffer_load_dwordx4 a[20:23], v7, s[8:11], s47 offen
    s_mov_b32 s47, 14417920
    buffer_load_dwordx4 a[24:27], v7, s[8:11], s47 offen
    s_mov_b32 s47, 14548992
    buffer_load_dwordx4 a[28:31], v7, s[8:11], s47 offen
    s_mov_b32 s47, 14680064
    buffer_load_dwordx4 a[32:35], v7, s[8:11], s47 offen
    s_mov_b32 s47, 14811136
    buffer_load_dwordx4 a[36:39], v7, s[8:11], s47 offen
    s_mov_b32 s47, 14942208
    buffer_load_dwordx4 a[40:43], v7, s[8:11], s47 offen
    s_mov_b32 s47, 15073280
    buffer_load_dwordx4 a[44:47], v7, s[8:11], s47 offen
    s_mov_b32 s47, 15204352
    buffer_load_dwordx4 a[48:51], v7, s[8:11], s47 offen
    s_mov_b32 s47, 15335424
    buffer_load_dwordx4 a[52:55], v7, s[8:11], s47 offen
    s_mov_b32 s47, 15466496
    buffer_load_dwordx4 a[56:59], v7, s[8:11], s47 offen
    s_mov_b32 s47, 15597568
    buffer_load_dwordx4 a[60:63], v7, s[8:11], s47 offen
    s_mov_b32 s47, 15728640
    buffer_load_dwordx4 a[64:67], v7, s[8:11], s47 offen
    s_mov_b32 s47, 15859712
    buffer_load_dwordx4 a[68:71], v7, s[8:11], s47 offen
    s_mov_b32 s47, 15990784
    buffer_load_dwordx4 a[72:75], v7, s[8:11], s47 offen
    s_mov_b32 s47, 16121856
    buffer_load_dwordx4 a[76:79], v7, s[8:11], s47 offen
    s_mov_b32 s47, 16252928
    buffer_load_dwordx4 a[80:83], v7, s[8:11], s47 offen
    v_lshlrev_b32 v6, 6, v5
    v_lshl_add_u32 v6, v3, 4, v6
    s_mul_i32 s49, s41, 12
    s_mul_i32 s50, s44, 3
    s_add_u32 s49, s49, s50
    s_and_b32 s53, s44, 1
    s_add_u32 s50, s49, s53
    s_add_u32 s51, s50, 1
    s_lshl_b32 s54, s53, 1
    s_sub_u32 s52, 2, s54
    s_add_u32 s52, s52, s49
    s_mov_b32 s56, s50
    s_mov_b32 s57, s52
    s_mul_i32 s50, s50, 20480
    s_add_u32 s50, s50, 0
    s_mul_i32 s51, s51, 20480
    s_add_u32 s51, s51, 0
    s_mul_i32 s52, s52, 20480
    s_add_u32 s52, s52, 0
    v_lshlrev_b32 v9, 2, v3
    v_sub_u32 v9, v2, v9
    v_mov_b32 v14, 0x3f80
    v_mov_b32 v15, 0x3f800000
    v_cmp_eq_u32 vcc, 0, v9
    s_nop 1
    v_cndmask_b32 v10, 0, v14, vcc
    v_cmp_eq_u32 vcc, 1, v9
    s_nop 1
    v_cndmask_b32 v10, v10, v15, vcc
    v_cmp_eq_u32 vcc, 2, v9
    s_nop 1
    v_cndmask_b32 v11, 0, v14, vcc
    v_cmp_eq_u32 vcc, 3, v9
    s_nop 1
    v_cndmask_b32 v11, v11, v15, vcc
    s_mul_i32 s59, s44, 26624
    v_lshl_add_u32 v9, v3, 5, v2
    v_mul_u32_u24 v9, 208, v9
    v_add_u32 v9, s59, v9
    v_add_u32 v4, 106496, v8
    s_waitcnt vmcnt(23)
    s_waitcnt lgkmcnt(0)
    s_barrier
    ds_read_b128 a[84:87], v4 offset:0
    ds_read_b128 a[88:91], v4 offset:1024
    ds_read_b128 a[92:95], v4 offset:2048
    ds_read_b128 a[96:99], v4 offset:3072
    s_waitcnt vmcnt(21)
    v_lshlrev_b32 v13, 16, v13
    v_fmac_f32 v13, 0x3acccccd, v12
    v_mov_b32 v14, v13
    v_mov_b32 v15, v13
    v_cvt_pk_bf16_f32 v12, v15, v13
    v_lshlrev_b32 v15, 16, v12
    v_and_b32 v13, 0xffff0000, v12
    s_waitcnt vmcnt(20) lgkmcnt(3)
    v_mfma_f32_16x16x16_bf16 v[96:99], a[84:85], a[0:1], 0
    v_mfma_f32_16x16x16_bf16 v[100:103], a[86:87], a[2:3], 0
    s_waitcnt vmcnt(19) lgkmcnt(2)
    v_mfma_f32_16x16x16_bf16 v[104:107], a[88:89], a[4:5], 0
    v_mfma_f32_16x16x16_bf16 v[108:111], a[90:91], a[6:7], 0
    s_waitcnt vmcnt(18) lgkmcnt(1)
    v_mfma_f32_16x16x16_bf16 v[112:115], a[92:93], a[8:9], 0
    v_mfma_f32_16x16x16_bf16 v[116:119], a[94:95], a[10:11], 0
    s_mov_b32 s47, 16777216
    buffer_load_dwordx4 v[16:19], v6, s[8:11], s47 offen
    s_waitcnt vmcnt(18) lgkmcnt(0)
    v_mfma_f32_16x16x16_bf16 v[120:123], a[96:97], a[12:13], 0
    v_mfma_f32_16x16x16_bf16 v[124:127], a[98:99], a[14:15], 0
    ds_read_b128 a[84:87], v4 offset:4096
    ds_read_b128 a[88:91], v4 offset:5120
    v_cvt_pk_bf16_f32 v128, v96, v97
    v_cvt_pk_bf16_f32 v132, v98, v99
    v_cvt_pk_bf16_f32 v129, v100, v101
    v_cvt_pk_bf16_f32 v133, v102, v103
    v_cvt_pk_bf16_f32 v130, v104, v105
    v_cvt_pk_bf16_f32 v134, v106, v107
    s_mov_b32 s47, 16908288
    buffer_load_dwordx4 v[20:23], v6, s[8:11], s47 offen
    v_cvt_pk_bf16_f32 v131, v108, v109
    v_cvt_pk_bf16_f32 v135, v110, v111
    ds_write_b128 v9, v[128:131] offset:0
    ds_write_b128 v9, v[132:135] offset:3328
    s_waitcnt vmcnt(18) lgkmcnt(3)
    v_mfma_f32_16x16x16_bf16 v[96:99], a[84:85], a[16:17], 0
    v_mfma_f32_16x16x16_bf16 v[100:103], a[86:87], a[18:19], 0
    s_waitcnt vmcnt(17) lgkmcnt(2)
    v_mfma_f32_16x16x16_bf16 v[104:107], a[88:89], a[20:21], 0
    v_mfma_f32_16x16x16_bf16 v[108:111], a[90:91], a[22:23], 0
    s_mov_b32 s47, 17039360
    buffer_load_dwordx4 v[24:27], v6, s[8:11], s47 offen
    ds_read_b128 a[92:95], v4 offset:6144
    ds_read_b128 a[96:99], v4 offset:7168
    v_cvt_pk_bf16_f32 v136, v112, v113
    v_cvt_pk_bf16_f32 v140, v114, v115
    v_cvt_pk_bf16_f32 v137, v116, v117
    v_cvt_pk_bf16_f32 v141, v118, v119
    v_cvt_pk_bf16_f32 v138, v120, v121
    v_cvt_pk_bf16_f32 v142, v122, v123
    v_cvt_pk_bf16_f32 v139, v124, v125
    v_cvt_pk_bf16_f32 v143, v126, v127
    ds_write_b128 v9, v[136:139] offset:16
    ds_write_b128 v9, v[140:143] offset:3344
    s_mov_b32 s47, 17170432
    buffer_load_dwordx4 v[28:31], v6, s[8:11], s47 offen
    s_waitcnt vmcnt(18) lgkmcnt(3)
    v_mfma_f32_16x16x16_bf16 v[112:115], a[92:93], a[24:25], 0
    v_mfma_f32_16x16x16_bf16 v[116:119], a[94:95], a[26:27], 0
    s_waitcnt vmcnt(17) lgkmcnt(2)
    v_mfma_f32_16x16x16_bf16 v[120:123], a[96:97], a[28:29], 0
    v_mfma_f32_16x16x16_bf16 v[124:127], a[98:99], a[30:31], 0
    ds_read_b128 a[84:87], v4 offset:8192
    ds_read_b128 a[88:91], v4 offset:9216
    v_cvt_pk_bf16_f32 v128, v96, v97
    v_cvt_pk_bf16_f32 v132, v98, v99
    s_mov_b32 s47, 17301504
    buffer_load_dwordx4 v[32:35], v6, s[8:11], s47 offen
    v_cvt_pk_bf16_f32 v129, v100, v101
    v_cvt_pk_bf16_f32 v133, v102, v103
    v_cvt_pk_bf16_f32 v130, v104, v105
    v_cvt_pk_bf16_f32 v134, v106, v107
    v_cvt_pk_bf16_f32 v131, v108, v109
    v_cvt_pk_bf16_f32 v135, v110, v111
    ds_write_b128 v9, v[128:131] offset:32
    ds_write_b128 v9, v[132:135] offset:3360
    s_waitcnt vmcnt(17) lgkmcnt(3)
    v_mfma_f32_16x16x16_bf16 v[96:99], a[84:85], a[32:33], 0
    v_mfma_f32_16x16x16_bf16 v[100:103], a[86:87], a[34:35], 0
    s_mov_b32 s47, 17432576
    buffer_load_dwordx4 v[36:39], v6, s[8:11], s47 offen
    s_waitcnt vmcnt(17) lgkmcnt(2)
    v_mfma_f32_16x16x16_bf16 v[104:107], a[88:89], a[36:37], 0
    v_mfma_f32_16x16x16_bf16 v[108:111], a[90:91], a[38:39], 0
    ds_read_b128 a[92:95], v4 offset:10240
    ds_read_b128 a[96:99], v4 offset:11264
    v_cvt_pk_bf16_f32 v136, v112, v113
    v_cvt_pk_bf16_f32 v140, v114, v115
    v_cvt_pk_bf16_f32 v137, v116, v117
    v_cvt_pk_bf16_f32 v141, v118, v119
    v_cvt_pk_bf16_f32 v138, v120, v121
    v_cvt_pk_bf16_f32 v142, v122, v123
    s_mov_b32 s47, 17563648
    buffer_load_dwordx4 v[40:43], v6, s[8:11], s47 offen
    v_cvt_pk_bf16_f32 v139, v124, v125
    v_cvt_pk_bf16_f32 v143, v126, v127
    ds_write_b128 v9, v[136:139] offset:48
    ds_write_b128 v9, v[140:143] offset:3376
    s_waitcnt vmcnt(17) lgkmcnt(3)
    v_mfma_f32_16x16x16_bf16 v[112:115], a[92:93], a[40:41], 0
    v_mfma_f32_16x16x16_bf16 v[116:119], a[94:95], a[42:43], 0
    s_waitcnt vmcnt(16) lgkmcnt(2)
    v_mfma_f32_16x16x16_bf16 v[120:123], a[96:97], a[44:45], 0
    v_mfma_f32_16x16x16_bf16 v[124:127], a[98:99], a[46:47], 0
    s_mov_b32 s47, 17694720
    buffer_load_dwordx4 v[44:47], v6, s[8:11], s47 offen
    ds_read_b128 a[84:87], v4 offset:12288
    ds_read_b128 a[88:91], v4 offset:13312
    v_cvt_pk_bf16_f32 v128, v96, v97
    v_cvt_pk_bf16_f32 v132, v98, v99
    v_cvt_pk_bf16_f32 v129, v100, v101
    v_cvt_pk_bf16_f32 v133, v102, v103
    v_cvt_pk_bf16_f32 v130, v104, v105
    v_cvt_pk_bf16_f32 v134, v106, v107
    v_cvt_pk_bf16_f32 v131, v108, v109
    v_cvt_pk_bf16_f32 v135, v110, v111
    ds_write_b128 v9, v[128:131] offset:64
    ds_write_b128 v9, v[132:135] offset:3392
    s_mov_b32 s47, 17825792
    buffer_load_dwordx4 v[48:51], v6, s[8:11], s47 offen
    s_waitcnt vmcnt(17) lgkmcnt(3)
    v_mfma_f32_16x16x16_bf16 v[96:99], a[84:85], a[48:49], 0
    v_mfma_f32_16x16x16_bf16 v[100:103], a[86:87], a[50:51], 0
    s_waitcnt vmcnt(16) lgkmcnt(2)
    v_mfma_f32_16x16x16_bf16 v[104:107], a[88:89], a[52:53], 0
    v_mfma_f32_16x16x16_bf16 v[108:111], a[90:91], a[54:55], 0
    ds_read_b128 a[92:95], v4 offset:14336
    ds_read_b128 a[96:99], v4 offset:15360
    v_cvt_pk_bf16_f32 v136, v112, v113
    v_cvt_pk_bf16_f32 v140, v114, v115
    s_mov_b32 s47, 17956864
    buffer_load_dwordx4 v[52:55], v6, s[8:11], s47 offen
    v_cvt_pk_bf16_f32 v137, v116, v117
    v_cvt_pk_bf16_f32 v141, v118, v119
    v_cvt_pk_bf16_f32 v138, v120, v121
    v_cvt_pk_bf16_f32 v142, v122, v123
    v_cvt_pk_bf16_f32 v139, v124, v125
    v_cvt_pk_bf16_f32 v143, v126, v127
    ds_write_b128 v9, v[136:139] offset:80
    ds_write_b128 v9, v[140:143] offset:3408
    s_waitcnt vmcnt(16) lgkmcnt(3)
    v_mfma_f32_16x16x16_bf16 v[112:115], a[92:93], a[56:57], 0
    v_mfma_f32_16x16x16_bf16 v[116:119], a[94:95], a[58:59], 0
    s_mov_b32 s47, 18087936
    buffer_load_dwordx4 v[56:59], v6, s[8:11], s47 offen
    s_waitcnt vmcnt(16) lgkmcnt(2)
    v_mfma_f32_16x16x16_bf16 v[120:123], a[96:97], a[60:61], 0
    v_mfma_f32_16x16x16_bf16 v[124:127], a[98:99], a[62:63], 0
    ds_read_b128 a[84:87], v4 offset:16384
    ds_read_b128 a[88:91], v4 offset:17408
    v_cvt_pk_bf16_f32 v128, v96, v97
    v_cvt_pk_bf16_f32 v132, v98, v99
    v_cvt_pk_bf16_f32 v129, v100, v101
    v_cvt_pk_bf16_f32 v133, v102, v103
    v_cvt_pk_bf16_f32 v130, v104, v105
    v_cvt_pk_bf16_f32 v134, v106, v107
    s_mov_b32 s47, 18219008
    buffer_load_dwordx4 v[60:63], v6, s[8:11], s47 offen
    v_cvt_pk_bf16_f32 v131, v108, v109
    v_cvt_pk_bf16_f32 v135, v110, v111
    ds_write_b128 v9, v[128:131] offset:96
    ds_write_b128 v9, v[132:135] offset:3424
    s_waitcnt vmcnt(16) lgkmcnt(3)
    v_mfma_f32_16x16x16_bf16 v[96:99], a[84:85], a[64:65], 0
    v_mfma_f32_16x16x16_bf16 v[100:103], a[86:87], a[66:67], 0
    s_waitcnt vmcnt(15) lgkmcnt(2)
    v_mfma_f32_16x16x16_bf16 v[104:107], a[88:89], a[68:69], 0
    v_mfma_f32_16x16x16_bf16 v[108:111], a[90:91], a[70:71], 0
    s_mov_b32 s47, 18350080
    buffer_load_dwordx4 v[64:67], v6, s[8:11], s47 offen
    ds_read_b128 a[92:95], v4 offset:18432
    ds_read_b128 a[96:99], v4 offset:19456
    v_cvt_pk_bf16_f32 v136, v112, v113
    v_cvt_pk_bf16_f32 v140, v114, v115
    v_cvt_pk_bf16_f32 v137, v116, v117
    v_cvt_pk_bf16_f32 v141, v118, v119
    v_cvt_pk_bf16_f32 v138, v120, v121
    v_cvt_pk_bf16_f32 v142, v122, v123
    v_cvt_pk_bf16_f32 v139, v124, v125
    v_cvt_pk_bf16_f32 v143, v126, v127
    ds_write_b128 v9, v[136:139] offset:112
    ds_write_b128 v9, v[140:143] offset:3440
    s_mov_b32 s47, 18481152
    buffer_load_dwordx4 v[68:71], v6, s[8:11], s47 offen
    s_waitcnt vmcnt(16) lgkmcnt(3)
    v_mfma_f32_16x16x16_bf16 v[112:115], a[92:93], a[72:73], 0
    v_mfma_f32_16x16x16_bf16 v[116:119], a[94:95], a[74:75], 0
    s_waitcnt vmcnt(15) lgkmcnt(2)
    v_mfma_f32_16x16x16_bf16 v[120:123], a[96:97], a[76:77], 0
    v_mfma_f32_16x16x16_bf16 v[124:127], a[98:99], a[78:79], 0
    ds_read_b128 a[84:87], v4 offset:20480
    v_cvt_pk_bf16_f32 v128, v96, v97
    v_cvt_pk_bf16_f32 v132, v98, v99
    v_cvt_pk_bf16_f32 v129, v100, v101
    s_mov_b32 s47, 18612224
    buffer_load_dwordx4 v[72:75], v6, s[8:11], s47 offen
    v_cvt_pk_bf16_f32 v133, v102, v103
    v_cvt_pk_bf16_f32 v130, v104, v105
    v_cvt_pk_bf16_f32 v134, v106, v107
    v_cvt_pk_bf16_f32 v131, v108, v109
    v_cvt_pk_bf16_f32 v135, v110, v111
    ds_write_b128 v9, v[128:131] offset:128
    ds_write_b128 v9, v[132:135] offset:3456
    ds_read_b128 a[100:103], v4 offset:22528
    ds_read_b128 a[104:107], v4 offset:23552
    ds_read_b128 a[108:111], v4 offset:24576
    ds_read_b128 a[112:115], v4 offset:25600
    ds_read_b128 a[116:119], v4 offset:26624
    s_mov_b32 s47, 18743296
    buffer_load_dwordx4 v[76:79], v6, s[8:11], s47 offen
    ds_read_b128 a[120:123], v4 offset:27648
    ds_read_b128 a[124:127], v4 offset:28672
    ds_read_b128 a[128:131], v4 offset:29696
    ds_read_b128 a[132:135], v4 offset:30720
    ds_read_b128 a[136:139], v4 offset:31744
    ds_read_b128 a[140:143], v4 offset:32768
    ds_read_b128 a[144:147], v4 offset:33792
    ds_read_b128 a[148:151], v4 offset:34816
    ds_read_b128 a[152:155], v4 offset:35840
    ds_read_b128 a[156:159], v4 offset:36864
    s_waitcnt vmcnt(16) lgkmcnt(15)
    v_mfma_f32_16x16x16_bf16 v[96:99], a[84:85], a[80:81], 0
    s_mov_b32 s47, 18874368
    buffer_load_dwordx4 v[80:83], v6, s[8:11], s47 offen
    v_cvt_pk_bf16_f32 v136, v112, v113
    v_cvt_pk_bf16_f32 v140, v114, v115
    v_cvt_pk_bf16_f32 v137, v116, v117
    v_cvt_pk_bf16_f32 v141, v118, v119
    v_cvt_pk_bf16_f32 v138, v120, v121
    v_cvt_pk_bf16_f32 v142, v122, v123
    v_cvt_pk_bf16_f32 v139, v124, v125
    v_cvt_pk_bf16_f32 v143, v126, v127
    ds_write_b128 v9, v[136:139] offset:144
    ds_write_b128 v9, v[140:143] offset:3472
    v_cvt_pk_bf16_f32 v128, v96, v97
    v_cvt_pk_bf16_f32 v132, v98, v99
    s_mov_b32 s47, 19005440
    buffer_load_dwordx4 v[84:87], v6, s[8:11], s47 offen
    v_mov_b32 v129, 0
    v_mov_b32 v133, 0
    v_mov_b32 v130, 0
    v_mov_b32 v134, 0
    v_mov_b32 v131, 0
    v_mov_b32 v135, 0
    ds_write_b128 v9, v[128:131] offset:160
    ds_write_b128 v9, v[132:135] offset:3488
    v_mov_b32 v136, 0
    v_mov_b32 v140, 0
    v_mov_b32 v137, 0
    v_mov_b32 v141, 0
    s_mov_b32 s47, 19136512
    buffer_load_dwordx4 v[88:91], v6, s[8:11], s47 offen
    v_mov_b32 v138, 0
    v_mov_b32 v142, 0
    v_mov_b32 v139, 0
    v_mov_b32 v143, 0
    ds_write_b128 v9, v[136:139] offset:176
    ds_write_b128 v9, v[140:143] offset:3504
    s_waitcnt lgkmcnt(0)
    v_sub_f32 v252, 0, v15
    v_sub_f32 v253, 0, v15
    v_sub_f32 v254, 0, v15
    v_sub_f32 v255, 0, v15
    v_mul_u32_u24 v9, 208, v2
    s_mov_b32 s47, 19267584
    buffer_load_dwordx4 v[92:95], v6, s[8:11], s47 offen
    v_lshl_add_u32 v9, v3, 4, v9
    v_add_u32 v9, s59, v9
    v_add_u32 v12, s59, v8
    v_mov_b32 v13, v5
    ds_read_b128 a[84:87], v9 offset:0
    ds_read_b128 a[88:91], v9 offset:64
    ds_read_b128 a[92:95], v9 offset:128
    ds_read_b128 a[96:99], v9 offset:3328
    ds_read_b128 v[244:247], v9 offset:3392
    ds_read_b128 v[248:251], v9 offset:3456
    s_waitcnt lgkmcnt(5)
    v_mfma_f32_16x16x32_bf16 v[96:99], a[100:103], a[84:87], v[252:255]
    s_add_u32 s55, s50, 0
    buffer_load_dwordx4 a[160:163], v8, s[8:11], s55 offen offset:0
    v_mfma_f32_16x16x32_bf16 v[100:103], a[112:115], a[84:87], v[252:255]
    v_mfma_f32_16x16x32_bf16 v[104:107], a[124:127], a[84:87], v[252:255]
    v_mfma_f32_16x16x32_bf16 v[108:111], a[136:139], a[84:87], v[252:255]
    v_mfma_f32_16x16x32_bf16 v[112:115], a[148:151], a[84:87], v[252:255]
    s_waitcnt lgkmcnt(4)
    v_mfma_f32_16x16x32_bf16 v[96:99], a[104:107], a[88:91], v[96:99]
    v_mfma_f32_16x16x32_bf16 v[100:103], a[116:119], a[88:91], v[100:103]
    s_add_u32 s55, s51, 0
    buffer_load_dwordx4 a[164:167], v8, s[8:11], s55 offen offset:0
    v_mfma_f32_16x16x32_bf16 v[104:107], a[128:131], a[88:91], v[104:107]
    v_mfma_f32_16x16x32_bf16 v[108:111], a[140:143], a[88:91], v[108:111]
    v_mfma_f32_16x16x32_bf16 v[112:115], a[152:155], a[88:91], v[112:115]
    s_waitcnt lgkmcnt(3)
    v_mfma_f32_16x16x32_bf16 v[96:99], a[108:111], a[92:95], v[96:99]
    v_mfma_f32_16x16x32_bf16 v[100:103], a[120:123], a[92:95], v[100:103]
    v_mfma_f32_16x16x32_bf16 v[104:107], a[132:135], a[92:95], v[104:107]
    s_add_u32 s55, s52, 0
    buffer_load_dwordx4 a[168:171], v8, s[8:11], s55 offen offset:0
    v_mfma_f32_16x16x32_bf16 v[108:111], a[144:147], a[92:95], v[108:111]
    v_mfma_f32_16x16x32_bf16 v[112:115], a[156:159], a[92:95], v[112:115]
    s_waitcnt vmcnt(22)
    v_mfma_f32_16x16x16_bf16 v[96:99], v[10:11], v[16:17], v[96:99]
    s_waitcnt vmcnt(21)
    v_mfma_f32_16x16x16_bf16 v[100:103], v[10:11], v[20:21], v[100:103]
    s_waitcnt vmcnt(20)
    v_mfma_f32_16x16x16_bf16 v[104:107], v[10:11], v[24:25], v[104:107]
    s_waitcnt vmcnt(19)
    v_mfma_f32_16x16x16_bf16 v[108:111], v[10:11], v[28:29], v[108:111]
    s_add_u32 s55, s50, 0
    buffer_load_dwordx4 a[172:175], v8, s[8:11], s55 offen offset:1024
    s_waitcnt vmcnt(19)
    v_mfma_f32_16x16x16_bf16 v[112:115], v[10:11], v[32:33], v[112:115]
    ds_read_b128 a[84:87], v9 offset:6656
    ds_read_b128 a[88:91], v9 offset:6720
    ds_read_b128 a[92:95], v9 offset:6784
    s_waitcnt lgkmcnt(5)
    v_mfma_f32_16x16x32_bf16 v[116:119], a[100:103], a[96:99], v[252:255]
    v_mfma_f32_16x16x32_bf16 v[120:123], a[112:115], a[96:99], v[252:255]
    v_mfma_f32_16x16x32_bf16 v[124:127], a[124:127], a[96:99], v[252:255]
    v_mfma_f32_16x16x32_bf16 v[128:131], a[136:139], a[96:99], v[252:255]
    s_add_u32 s55, s51, 0
    buffer_load_dwordx4 a[176:179], v8, s[8:11], s55 offen offset:1024
    v_mfma_f32_16x16x32_bf16 v[132:135], a[148:151], a[96:99], v[252:255]
    v_cvt_pk_bf16_f32 v236, v96, v97
    v_cvt_pk_bf16_f32 v237, v98, v99
    v_cvt_pk_bf16_f32 v238, v100, v101
    v_cvt_pk_bf16_f32 v239, v102, v103
    ds_write_b128 v12, v[236:239] offset:0
    s_nop 0
    v_mfma_f32_16x16x32_bf16 v[4:7], v[236:239], v[236:239], 0
    v_cvt_pk_bf16_f32 v240, v104, v105
    v_cvt_pk_bf16_f32 v241, v106, v107
    v_cvt_pk_bf16_f32 v242, v108, v109
    s_add_u32 s55, s52, 0
    buffer_load_dwordx4 a[180:183], v8, s[8:11], s55 offen offset:1024
    v_cvt_pk_bf16_f32 v243, v110, v111
    ds_write_b128 v12, v[240:243] offset:1024
    s_nop 0
    v_mfma_f32_16x16x32_bf16 v[4:7], v[240:243], v[240:243], v[4:7]
    s_waitcnt lgkmcnt(6)
    v_mfma_f32_16x16x32_bf16 v[116:119], a[104:107], v[244:247], v[116:119]
    v_mfma_f32_16x16x32_bf16 v[120:123], a[116:119], v[244:247], v[120:123]
    v_mfma_f32_16x16x32_bf16 v[124:127], a[128:131], v[244:247], v[124:127]
    v_mfma_f32_16x16x32_bf16 v[128:131], a[140:143], v[244:247], v[128:131]
    s_add_u32 s55, s50, 0
    buffer_load_dwordx4 a[184:187], v8, s[8:11], s55 offen offset:2048
    v_mfma_f32_16x16x32_bf16 v[132:135], a[152:155], v[244:247], v[132:135]
    s_waitcnt lgkmcnt(5)
    v_mfma_f32_16x16x32_bf16 v[116:119], a[108:111], v[248:251], v[116:119]
    v_mfma_f32_16x16x32_bf16 v[120:123], a[120:123], v[248:251], v[120:123]
    v_mfma_f32_16x16x32_bf16 v[124:127], a[132:135], v[248:251], v[124:127]
    v_mfma_f32_16x16x32_bf16 v[128:131], a[144:147], v[248:251], v[128:131]
    v_mfma_f32_16x16x32_bf16 v[132:135], a[156:159], v[248:251], v[132:135]
    s_add_u32 s55, s51, 0
    buffer_load_dwordx4 a[188:191], v8, s[8:11], s55 offen offset:2048
    v_mfma_f32_16x16x16_bf16 v[116:119], v[10:11], v[18:19], v[116:119]
    v_mfma_f32_16x16x16_bf16 v[120:123], v[10:11], v[22:23], v[120:123]
    v_mfma_f32_16x16x16_bf16 v[124:127], v[10:11], v[26:27], v[124:127]
    v_mfma_f32_16x16x16_bf16 v[128:131], v[10:11], v[30:31], v[128:131]
    v_mfma_f32_16x16x16_bf16 v[132:135], v[10:11], v[34:35], v[132:135]
    ds_read_b128 a[96:99], v9 offset:9984
    ds_read_b128 v[244:247], v9 offset:10048
    s_add_u32 s55, s52, 0
    buffer_load_dwordx4 a[192:195], v8, s[8:11], s55 offen offset:2048
    ds_read_b128 v[248:251], v9 offset:10112
    s_waitcnt lgkmcnt(7)
    v_mfma_f32_16x16x32_bf16 v[136:139], a[100:103], a[84:87], v[252:255]
    v_mfma_f32_16x16x32_bf16 v[140:143], a[112:115], a[84:87], v[252:255]
    v_mfma_f32_16x16x32_bf16 v[144:147], a[124:127], a[84:87], v[252:255]
    v_mfma_f32_16x16x32_bf16 v[148:151], a[136:139], a[84:87], v[252:255]
    v_mfma_f32_16x16x32_bf16 v[152:155], a[148:151], a[84:87], v[252:255]
    v_cvt_pk_bf16_f32 v236, v112, v113
    s_add_u32 s55, s50, 0
    buffer_load_dwordx4 a[196:199], v8, s[8:11], s55 offen offset:3072
    v_cvt_pk_bf16_f32 v237, v114, v115
    v_cvt_pk_bf16_f32 v238, v116, v117
    v_cvt_pk_bf16_f32 v239, v118, v119
    ds_write_b128 v12, v[236:239] offset:2048
    s_nop 0
    v_mfma_f32_16x16x32_bf16 v[4:7], v[236:239], v[236:239], v[4:7]
    v_cvt_pk_bf16_f32 v240, v120, v121
    v_cvt_pk_bf16_f32 v241, v122, v123
    v_cvt_pk_bf16_f32 v242, v124, v125
    v_cvt_pk_bf16_f32 v243, v126, v127
    ds_write_b128 v12, v[240:243] offset:3072
    s_nop 0
    v_mfma_f32_16x16x32_bf16 v[4:7], v[240:243], v[240:243], v[4:7]
    s_add_u32 s55, s51, 0
    buffer_load_dwordx4 a[200:203], v8, s[8:11], s55 offen offset:3072
    v_cvt_pk_bf16_f32 v236, v128, v129
    v_cvt_pk_bf16_f32 v237, v130, v131
    v_cvt_pk_bf16_f32 v238, v132, v133
    v_cvt_pk_bf16_f32 v239, v134, v135
    ds_write_b128 v12, v[236:239] offset:4096
    s_nop 0
    v_mfma_f32_16x16x32_bf16 v[4:7], v[236:239], v[236:239], v[4:7]
    s_waitcnt lgkmcnt(9)
    v_mfma_f32_16x16x32_bf16 v[136:139], a[104:107], a[88:91], v[136:139]
    v_mfma_f32_16x16x32_bf16 v[140:143], a[116:119], a[88:91], v[140:143]
    v_mfma_f32_16x16x32_bf16 v[144:147], a[128:131], a[88:91], v[144:147]
    s_add_u32 s55, s52, 0
    buffer_load_dwordx4 a[204:207], v8, s[8:11], s55 offen offset:3072
    v_mfma_f32_16x16x32_bf16 v[148:151], a[140:143], a[88:91], v[148:151]
    v_mfma_f32_16x16x32_bf16 v[152:155], a[152:155], a[88:91], v[152:155]
    s_waitcnt lgkmcnt(8)
    v_mfma_f32_16x16x32_bf16 v[136:139], a[108:111], a[92:95], v[136:139]
    v_mfma_f32_16x16x32_bf16 v[140:143], a[120:123], a[92:95], v[140:143]
    v_mfma_f32_16x16x32_bf16 v[144:147], a[132:135], a[92:95], v[144:147]
    v_mfma_f32_16x16x32_bf16 v[148:151], a[144:147], a[92:95], v[148:151]
    s_add_u32 s55, s50, 4096
    buffer_load_dwordx4 a[208:211], v8, s[8:11], s55 offen offset:0
    v_mfma_f32_16x16x32_bf16 v[152:155], a[156:159], a[92:95], v[152:155]
    s_waitcnt vmcnt(27)
    v_mfma_f32_16x16x16_bf16 v[136:139], v[10:11], v[36:37], v[136:139]
    s_waitcnt vmcnt(26)
    v_mfma_f32_16x16x16_bf16 v[140:143], v[10:11], v[40:41], v[140:143]
    s_waitcnt vmcnt(25)
    v_mfma_f32_16x16x16_bf16 v[144:147], v[10:11], v[44:45], v[144:147]
    s_waitcnt vmcnt(24)
    v_mfma_f32_16x16x16_bf16 v[148:151], v[10:11], v[48:49], v[148:151]
    s_waitcnt vmcnt(23)
    v_mfma_f32_16x16x16_bf16 v[152:155], v[10:11], v[52:53], v[152:155]
    s_add_u32 s55, s51, 4096
    buffer_load_dwordx4 a[212:215], v8, s[8:11], s55 offen offset:0
    ds_read_b128 a[84:87], v9 offset:13312
    ds_read_b128 a[88:91], v9 offset:13376
    ds_read_b128 a[92:95], v9 offset:13440
    s_waitcnt lgkmcnt(8)
    v_mfma_f32_16x16x32_bf16 v[156:159], a[100:103], a[96:99], v[252:255]
    v_mfma_f32_16x16x32_bf16 v[160:163], a[112:115], a[96:99], v[252:255]
    v_mfma_f32_16x16x32_bf16 v[164:167], a[124:127], a[96:99], v[252:255]
    v_mfma_f32_16x16x32_bf16 v[168:171], a[136:139], a[96:99], v[252:255]
    v_mfma_f32_16x16x32_bf16 v[172:175], a[148:151], a[96:99], v[252:255]
    s_add_u32 s55, s52, 4096
    buffer_load_dwordx4 a[216:219], v8, s[8:11], s55 offen offset:0
    v_cvt_pk_bf16_f32 v240, v136, v137
    v_cvt_pk_bf16_f32 v241, v138, v139
    v_cvt_pk_bf16_f32 v242, v140, v141
    v_cvt_pk_bf16_f32 v243, v142, v143
    ds_write_b128 v12, v[240:243] offset:5120
    s_nop 0
    v_mfma_f32_16x16x32_bf16 v[4:7], v[240:243], v[240:243], v[4:7]
    v_cvt_pk_bf16_f32 v236, v144, v145
    v_cvt_pk_bf16_f32 v237, v146, v147
    v_cvt_pk_bf16_f32 v238, v148, v149
    v_cvt_pk_bf16_f32 v239, v150, v151
    ds_write_b128 v12, v[236:239] offset:6144
    s_add_u32 s55, s50, 4096
    buffer_load_dwordx4 a[220:223], v8, s[8:11], s55 offen offset:1024
    v_mfma_f32_16x16x32_bf16 v[4:7], v[236:239], v[236:239], v[4:7]
    s_waitcnt lgkmcnt(9)
    v_mfma_f32_16x16x32_bf16 v[156:159], a[104:107], v[244:247], v[156:159]
    v_mfma_f32_16x16x32_bf16 v[160:163], a[116:119], v[244:247], v[160:163]
    v_mfma_f32_16x16x32_bf16 v[164:167], a[128:131], v[244:247], v[164:167]
    v_mfma_f32_16x16x32_bf16 v[168:171], a[140:143], v[244:247], v[168:171]
    v_mfma_f32_16x16x32_bf16 v[172:175], a[152:155], v[244:247], v[172:175]
    s_add_u32 s55, s51, 4096
    buffer_load_dwordx4 a[224:227], v8, s[8:11], s55 offen offset:1024
    s_waitcnt lgkmcnt(8)
    v_mfma_f32_16x16x32_bf16 v[156:159], a[108:111], v[248:251], v[156:159]
    v_mfma_f32_16x16x32_bf16 v[160:163], a[120:123], v[248:251], v[160:163]
    v_mfma_f32_16x16x32_bf16 v[164:167], a[132:135], v[248:251], v[164:167]
    v_mfma_f32_16x16x32_bf16 v[168:171], a[144:147], v[248:251], v[168:171]
    v_mfma_f32_16x16x32_bf16 v[172:175], a[156:159], v[248:251], v[172:175]
    s_nop 1
    v_mfma_f32_16x16x16_bf16 v[156:159], v[10:11], v[38:39], v[156:159]
    s_add_u32 s55, s52, 4096
    buffer_load_dwordx4 a[228:231], v8, s[8:11], s55 offen offset:1024
    v_mfma_f32_16x16x16_bf16 v[160:163], v[10:11], v[42:43], v[160:163]
    v_mfma_f32_16x16x16_bf16 v[164:167], v[10:11], v[46:47], v[164:167]
    v_mfma_f32_16x16x16_bf16 v[168:171], v[10:11], v[50:51], v[168:171]
    v_mfma_f32_16x16x16_bf16 v[172:175], v[10:11], v[54:55], v[172:175]
    ds_read_b128 a[96:99], v9 offset:16640
    ds_read_b128 v[244:247], v9 offset:16704
    ds_read_b128 v[248:251], v9 offset:16768
    s_waitcnt lgkmcnt(7)
    v_mfma_f32_16x16x32_bf16 v[176:179], a[100:103], a[84:87], v[252:255]
    s_add_u32 s55, s50, 4096
    buffer_load_dwordx4 a[232:235], v8, s[8:11], s55 offen offset:2048
    v_mfma_f32_16x16x32_bf16 v[180:183], a[112:115], a[84:87], v[252:255]
    v_mfma_f32_16x16x32_bf16 v[184:187], a[124:127], a[84:87], v[252:255]
    v_mfma_f32_16x16x32_bf16 v[188:191], a[136:139], a[84:87], v[252:255]
    v_mfma_f32_16x16x32_bf16 v[192:195], a[148:151], a[84:87], v[252:255]
    v_cvt_pk_bf16_f32 v240, v152, v153
    v_cvt_pk_bf16_f32 v241, v154, v155
    v_cvt_pk_bf16_f32 v242, v156, v157
    v_cvt_pk_bf16_f32 v243, v158, v159
    s_add_u32 s55, s51, 4096
    buffer_load_dwordx4 a[236:239], v8, s[8:11], s55 offen offset:2048
    ds_write_b128 v12, v[240:243] offset:7168
    v_mfma_f32_16x16x32_bf16 v[4:7], v[240:243], v[240:243], v[4:7]
    v_cvt_pk_bf16_f32 v236, v160, v161
    v_cvt_pk_bf16_f32 v237, v162, v163
    v_cvt_pk_bf16_f32 v238, v164, v165
    v_cvt_pk_bf16_f32 v239, v166, v167
    ds_write_b128 v12, v[236:239] offset:8192
    s_nop 0
    v_mfma_f32_16x16x32_bf16 v[4:7], v[236:239], v[236:239], v[4:7]
    v_cvt_pk_bf16_f32 v240, v168, v169
    v_cvt_pk_bf16_f32 v241, v170, v171
    s_add_u32 s55, s52, 4096
    buffer_load_dwordx4 a[240:243], v8, s[8:11], s55 offen offset:2048
    v_cvt_pk_bf16_f32 v242, v172, v173
    v_cvt_pk_bf16_f32 v243, v174, v175
    ds_write_b128 v12, v[240:243] offset:9216
    s_nop 0
    v_mfma_f32_16x16x32_bf16 v[4:7], v[240:243], v[240:243], v[4:7]
    s_waitcnt lgkmcnt(9)
    v_mfma_f32_16x16x32_bf16 v[176:179], a[104:107], a[88:91], v[176:179]
    v_mfma_f32_16x16x32_bf16 v[180:183], a[116:119], a[88:91], v[180:183]
    v_mfma_f32_16x16x32_bf16 v[184:187], a[128:131], a[88:91], v[184:187]
    v_mfma_f32_16x16x32_bf16 v[188:191], a[140:143], a[88:91], v[188:191]
    s_add_u32 s55, s50, 4096
    buffer_load_dwordx4 a[244:247], v8, s[8:11], s55 offen offset:3072
    v_mfma_f32_16x16x32_bf16 v[192:195], a[152:155], a[88:91], v[192:195]
    s_waitcnt lgkmcnt(8)
    v_mfma_f32_16x16x32_bf16 v[176:179], a[108:111], a[92:95], v[176:179]
    v_mfma_f32_16x16x32_bf16 v[180:183], a[120:123], a[92:95], v[180:183]
    v_mfma_f32_16x16x32_bf16 v[184:187], a[132:135], a[92:95], v[184:187]
    v_mfma_f32_16x16x32_bf16 v[188:191], a[144:147], a[92:95], v[188:191]
    v_mfma_f32_16x16x32_bf16 v[192:195], a[156:159], a[92:95], v[192:195]
    s_add_u32 s55, s51, 4096
    buffer_load_dwordx4 a[248:251], v8, s[8:11], s55 offen offset:3072
    s_waitcnt vmcnt(32)
    v_mfma_f32_16x16x16_bf16 v[176:179], v[10:11], v[56:57], v[176:179]
    s_waitcnt vmcnt(31)
    v_mfma_f32_16x16x16_bf16 v[180:183], v[10:11], v[60:61], v[180:183]
    s_waitcnt vmcnt(30)
    v_mfma_f32_16x16x16_bf16 v[184:187], v[10:11], v[64:65], v[184:187]
    s_waitcnt vmcnt(29)
    v_mfma_f32_16x16x16_bf16 v[188:191], v[10:11], v[68:69], v[188:191]
    s_waitcnt vmcnt(28)
    v_mfma_f32_16x16x16_bf16 v[192:195], v[10:11], v[72:73], v[192:195]
    ds_read_b128 a[84:87], v9 offset:19968
    ds_read_b128 a[88:91], v9 offset:20032
    s_add_u32 s55, s52, 4096
    buffer_load_dwordx4 a[252:255], v8, s[8:11], s55 offen offset:3072
    ds_read_b128 a[92:95], v9 offset:20096
    s_waitcnt lgkmcnt(8)
    v_mfma_f32_16x16x32_bf16 v[196:199], a[100:103], a[96:99], v[252:255]
    v_mfma_f32_16x16x32_bf16 v[200:203], a[112:115], a[96:99], v[252:255]
    v_mfma_f32_16x16x32_bf16 v[204:207], a[124:127], a[96:99], v[252:255]
    v_mfma_f32_16x16x32_bf16 v[208:211], a[136:139], a[96:99], v[252:255]
    v_mfma_f32_16x16x32_bf16 v[212:215], a[148:151], a[96:99], v[252:255]
    v_cvt_pk_bf16_f32 v236, v176, v177
    s_add_u32 s55, s50, 8192
    buffer_load_dwordx4 a[0:3], v8, s[8:11], s55 offen offset:0
    v_cvt_pk_bf16_f32 v237, v178, v179
    v_cvt_pk_bf16_f32 v238, v180, v181
    v_cvt_pk_bf16_f32 v239, v182, v183
    ds_write_b128 v12, v[236:239] offset:10240
    s_nop 0
    v_mfma_f32_16x16x32_bf16 v[4:7], v[236:239], v[236:239], v[4:7]
    v_cvt_pk_bf16_f32 v240, v184, v185
    v_cvt_pk_bf16_f32 v241, v186, v187
    v_cvt_pk_bf16_f32 v242, v188, v189
    v_cvt_pk_bf16_f32 v243, v190, v191
    ds_write_b128 v12, v[240:243] offset:11264
    s_nop 0
    v_mfma_f32_16x16x32_bf16 v[4:7], v[240:243], v[240:243], v[4:7]
    s_add_u32 s55, s51, 8192
    buffer_load_dwordx4 a[4:7], v8, s[8:11], s55 offen offset:0
    s_waitcnt lgkmcnt(9)
    v_mfma_f32_16x16x32_bf16 v[196:199], a[104:107], v[244:247], v[196:199]
    v_mfma_f32_16x16x32_bf16 v[200:203], a[116:119], v[244:247], v[200:203]
    v_mfma_f32_16x16x32_bf16 v[204:207], a[128:131], v[244:247], v[204:207]
    v_mfma_f32_16x16x32_bf16 v[208:211], a[140:143], v[244:247], v[208:211]
    v_mfma_f32_16x16x32_bf16 v[212:215], a[152:155], v[244:247], v[212:215]
    s_waitcnt lgkmcnt(8)
    v_mfma_f32_16x16x32_bf16 v[196:199], a[108:111], v[248:251], v[196:199]
    s_add_u32 s55, s52, 8192
    buffer_load_dwordx4 a[8:11], v8, s[8:11], s55 offen offset:0
    v_mfma_f32_16x16x32_bf16 v[200:203], a[120:123], v[248:251], v[200:203]
    v_mfma_f32_16x16x32_bf16 v[204:207], a[132:135], v[248:251], v[204:207]
    v_mfma_f32_16x16x32_bf16 v[208:211], a[144:147], v[248:251], v[208:211]
    v_mfma_f32_16x16x32_bf16 v[212:215], a[156:159], v[248:251], v[212:215]
    v_mfma_f32_16x16x16_bf16 v[196:199], v[10:11], v[58:59], v[196:199]
    s_nop 1
    v_mfma_f32_16x16x16_bf16 v[200:203], v[10:11], v[62:63], v[200:203]
    s_add_u32 s55, s50, 8192
    buffer_load_dwordx4 a[12:15], v8, s[8:11], s55 offen offset:1024
    v_mfma_f32_16x16x16_bf16 v[204:207], v[10:11], v[66:67], v[204:207]
    v_mfma_f32_16x16x16_bf16 v[208:211], v[10:11], v[70:71], v[208:211]
    v_mfma_f32_16x16x16_bf16 v[212:215], v[10:11], v[74:75], v[212:215]
    ds_read_b128 a[96:99], v9 offset:23296
    ds_read_b128 v[16:19], v9 offset:23360
    ds_read_b128 v[20:23], v9 offset:23424
    s_waitcnt lgkmcnt(7)
    v_mfma_f32_16x16x32_bf16 v[216:219], a[100:103], a[84:87], v[252:255]
    v_mfma_f32_16x16x32_bf16 v[220:223], a[112:115], a[84:87], v[252:255]
    s_add_u32 s55, s51, 8192
    buffer_load_dwordx4 a[16:19], v8, s[8:11], s55 offen offset:1024
    v_mfma_f32_16x16x32_bf16 v[224:227], a[124:127], a[84:87], v[252:255]
    v_mfma_f32_16x16x32_bf16 v[228:231], a[136:139], a[84:87], v[252:255]
    v_mfma_f32_16x16x32_bf16 v[232:235], a[148:151], a[84:87], v[252:255]
    v_cvt_pk_bf16_f32 v236, v192, v193
    v_cvt_pk_bf16_f32 v237, v194, v195
    v_cvt_pk_bf16_f32 v238, v196, v197
    v_cvt_pk_bf16_f32 v239, v198, v199
    ds_write_b128 v12, v[236:239] offset:12288
    s_nop 0
    v_mfma_f32_16x16x32_bf16 v[4:7], v[236:239], v[236:239], v[4:7]
    s_add_u32 s55, s52, 8192
    buffer_load_dwordx4 a[20:23], v8, s[8:11], s55 offen offset:1024
    v_cvt_pk_bf16_f32 v240, v200, v201
    v_cvt_pk_bf16_f32 v241, v202, v203
    v_cvt_pk_bf16_f32 v242, v204, v205
    v_cvt_pk_bf16_f32 v243, v206, v207
    ds_write_b128 v12, v[240:243] offset:13312
    s_nop 0
    v_mfma_f32_16x16x32_bf16 v[4:7], v[240:243], v[240:243], v[4:7]
    v_cvt_pk_bf16_f32 v236, v208, v209
    v_cvt_pk_bf16_f32 v237, v210, v211
    v_cvt_pk_bf16_f32 v238, v212, v213
    v_cvt_pk_bf16_f32 v239, v214, v215
    ds_write_b128 v12, v[236:239] offset:14336
    s_add_u32 s55, s50, 8192
    buffer_load_dwordx4 a[24:27], v8, s[8:11], s55 offen offset:2048
    v_mfma_f32_16x16x32_bf16 v[4:7], v[236:239], v[236:239], v[4:7]
    s_waitcnt lgkmcnt(9)
    v_mfma_f32_16x16x32_bf16 v[216:219], a[104:107], a[88:91], v[216:219]
    v_mfma_f32_16x16x32_bf16 v[220:223], a[116:119], a[88:91], v[220:223]
    v_mfma_f32_16x16x32_bf16 v[224:227], a[128:131], a[88:91], v[224:227]
    v_mfma_f32_16x16x32_bf16 v[228:231], a[140:143], a[88:91], v[228:231]
    v_mfma_f32_16x16x32_bf16 v[232:235], a[152:155], a[88:91], v[232:235]
    s_add_u32 s55, s51, 8192
    buffer_load_dwordx4 a[28:31], v8, s[8:11], s55 offen offset:2048
    s_waitcnt lgkmcnt(8)
    v_mfma_f32_16x16x32_bf16 v[216:219], a[108:111], a[92:95], v[216:219]
    v_mfma_f32_16x16x32_bf16 v[220:223], a[120:123], a[92:95], v[220:223]
    v_mfma_f32_16x16x32_bf16 v[224:227], a[132:135], a[92:95], v[224:227]
    v_mfma_f32_16x16x32_bf16 v[228:231], a[144:147], a[92:95], v[228:231]
    v_mfma_f32_16x16x32_bf16 v[232:235], a[156:159], a[92:95], v[232:235]
    s_waitcnt vmcnt(36)
    s_nop 0
    v_mfma_f32_16x16x16_bf16 v[216:219], v[10:11], v[76:77], v[216:219]
    s_add_u32 s55, s52, 8192
    buffer_load_dwordx4 a[32:35], v8, s[8:11], s55 offen offset:2048
    s_waitcnt vmcnt(36)
    v_mfma_f32_16x16x16_bf16 v[220:223], v[10:11], v[80:81], v[220:223]
    s_waitcnt vmcnt(35)
    v_mfma_f32_16x16x16_bf16 v[224:227], v[10:11], v[84:85], v[224:227]
    s_waitcnt vmcnt(34)
    v_mfma_f32_16x16x16_bf16 v[228:231], v[10:11], v[88:89], v[228:231]
    s_waitcnt vmcnt(33)
    v_mfma_f32_16x16x16_bf16 v[232:235], v[10:11], v[92:93], v[232:235]
    s_waitcnt lgkmcnt(5)
    v_mfma_f32_16x16x32_bf16 v[236:239], a[100:103], a[96:99], v[252:255]
    v_mfma_f32_16x16x32_bf16 v[240:243], a[112:115], a[96:99], v[252:255]
    s_add_u32 s55, s50, 8192
    buffer_load_dwordx4 a[36:39], v8, s[8:11], s55 offen offset:3072
    v_mfma_f32_16x16x32_bf16 v[244:247], a[124:127], a[96:99], v[252:255]
    v_mfma_f32_16x16x32_bf16 v[248:251], a[136:139], a[96:99], v[252:255]
    v_mfma_f32_16x16x32_bf16 v[252:255], a[148:151], a[96:99], v[252:255]
    v_cvt_pk_bf16_f32 v36, v216, v217
    v_cvt_pk_bf16_f32 v37, v218, v219
    v_cvt_pk_bf16_f32 v38, v220, v221
    v_cvt_pk_bf16_f32 v39, v222, v223
    ds_write_b128 v12, v[36:39] offset:15360
    s_nop 0
    v_mfma_f32_16x16x32_bf16 v[4:7], v[36:39], v[36:39], v[4:7]
    s_add_u32 s55, s51, 8192
    buffer_load_dwordx4 a[40:43], v8, s[8:11], s55 offen offset:3072
    v_cvt_pk_bf16_f32 v24, v224, v225
    v_cvt_pk_bf16_f32 v25, v226, v227
    v_cvt_pk_bf16_f32 v26, v228, v229
    v_cvt_pk_bf16_f32 v27, v230, v231
    ds_write_b128 v12, v[24:27] offset:16384
    s_nop 0
    v_mfma_f32_16x16x32_bf16 v[4:7], v[24:27], v[24:27], v[4:7]
    s_waitcnt lgkmcnt(6)
    v_mfma_f32_16x16x32_bf16 v[236:239], a[104:107], v[16:19], v[236:239]
    v_mfma_f32_16x16x32_bf16 v[240:243], a[116:119], v[16:19], v[240:243]
    v_mfma_f32_16x16x32_bf16 v[244:247], a[128:131], v[16:19], v[244:247]
    s_add_u32 s55, s52, 8192
    buffer_load_dwordx4 a[44:47], v8, s[8:11], s55 offen offset:3072
    v_mfma_f32_16x16x32_bf16 v[248:251], a[140:143], v[16:19], v[248:251]
    v_mfma_f32_16x16x32_bf16 v[252:255], a[152:155], v[16:19], v[252:255]
    s_waitcnt lgkmcnt(5)
    v_mfma_f32_16x16x32_bf16 v[236:239], a[108:111], v[20:23], v[236:239]
    v_mfma_f32_16x16x32_bf16 v[240:243], a[120:123], v[20:23], v[240:243]
    v_mfma_f32_16x16x32_bf16 v[244:247], a[132:135], v[20:23], v[244:247]
    v_mfma_f32_16x16x32_bf16 v[248:251], a[144:147], v[20:23], v[248:251]
    s_add_u32 s55, s50, 12288
    buffer_load_dwordx4 a[48:51], v8, s[8:11], s55 offen offset:0
    v_mfma_f32_16x16x32_bf16 v[252:255], a[156:159], v[20:23], v[252:255]
    v_mfma_f32_16x16x16_bf16 v[236:239], v[10:11], v[78:79], v[236:239]
    v_mfma_f32_16x16x16_bf16 v[240:243], v[10:11], v[82:83], v[240:243]
    v_mfma_f32_16x16x16_bf16 v[244:247], v[10:11], v[86:87], v[244:247]
    v_mfma_f32_16x16x16_bf16 v[248:251], v[10:11], v[90:91], v[248:251]
    s_nop 1
    v_mfma_f32_16x16x16_bf16 v[252:255], v[10:11], v[94:95], v[252:255]
    s_add_u32 s55, s51, 12288
    buffer_load_dwordx4 a[52:55], v8, s[8:11], s55 offen offset:0
    v_cvt_pk_bf16_f32 v28, v232, v233
    v_cvt_pk_bf16_f32 v29, v234, v235
    v_cvt_pk_bf16_f32 v30, v236, v237
    v_cvt_pk_bf16_f32 v31, v238, v239
    ds_write_b128 v12, v[28:31] offset:17408
    s_nop 0
    v_mfma_f32_16x16x32_bf16 v[4:7], v[28:31], v[28:31], v[4:7]
    s_add_u32 s55, s52, 12288
    buffer_load_dwordx4 a[56:59], v8, s[8:11], s55 offen offset:0
    v_cvt_pk_bf16_f32 v32, v240, v241
    v_cvt_pk_bf16_f32 v33, v242, v243
    v_cvt_pk_bf16_f32 v34, v244, v245
    v_cvt_pk_bf16_f32 v35, v246, v247
    ds_write_b128 v12, v[32:35] offset:18432
    s_nop 0
    v_mfma_f32_16x16x32_bf16 v[4:7], v[32:35], v[32:35], v[4:7]
    s_add_u32 s55, s50, 12288
    buffer_load_dwordx4 a[60:63], v8, s[8:11], s55 offen offset:1024
    v_cvt_pk_bf16_f32 v36, v248, v249
    v_cvt_pk_bf16_f32 v37, v250, v251
    v_cvt_pk_bf16_f32 v38, v252, v253
    v_cvt_pk_bf16_f32 v39, v254, v255
    ds_write_b128 v12, v[36:39] offset:19456
    s_nop 0
    v_mfma_f32_16x16x32_bf16 v[4:7], v[36:39], v[36:39], v[4:7]
    s_add_u32 s55, s51, 12288
    buffer_load_dwordx4 a[64:67], v8, s[8:11], s55 offen offset:1024
    v_and_b32 v9, 3, v2
    v_cmp_eq_u32 vcc, 1, v9
    s_nop 3
    v_cndmask_b32 v4, v4, v5, vcc
    v_cmp_eq_u32 vcc, 2, v9
    s_nop 1
    v_cndmask_b32 v4, v4, v6, vcc
    v_cmp_eq_u32 vcc, 3, v9
    s_add_u32 s55, s52, 12288
    buffer_load_dwordx4 a[68:71], v8, s[8:11], s55 offen offset:1024
    v_cndmask_b32 v4, v4, v7, vcc
    v_sub_f32 v10, v14, v15
    v_mul_f32 v12, 0x3acccccd, v4
    v_fma_f32 v12, -v10, v10, v12
    v_cvt_pk_bf16_f32 v13, v11, v12
    v_lshlrev_b32 v11, 16, v13
    s_add_u32 s55, s50, 12288
    buffer_load_dwordx4 a[72:75], v8, s[8:11], s55 offen offset:2048
    v_and_b32 v12, 0xffff0000, v13
    v_add_f32 v12, 0x3727c5ac, v12
    v_cvt_pk_bf16_f32 v13, v11, v12
    v_lshlrev_b32 v11, 16, v13
    v_and_b32 v12, 0xffff0000, v13
    v_sqrt_f32 v12, v12
    s_add_u32 s55, s51, 12288
    buffer_load_dwordx4 a[76:79], v8, s[8:11], s55 offen offset:2048
    v_cvt_pk_bf16_f32 v13, v11, v12
    v_lshlrev_b32 v11, 16, v13
    v_and_b32 v12, 0xffff0000, v13
    v_rcp_f32 v12, v12
    s_lshl_b32 s49, s44, 6
    s_add_u32 s49, s49, 151296
    s_add_u32 s55, s52, 12288
    buffer_load_dwordx4 a[80:83], v8, s[8:11], s55 offen offset:2048
    v_lshl_add_u32 v13, v2, 2, s49
    v_lshrrev_b32 v9, 2, v2
    v_cmp_eq_u32 vcc, v9, v3
    s_nop 0
    s_and_saveexec_b64 s[62:63], vcc
    ds_write_b32 v13, v12
    s_mov_b64 exec, -1
    s_waitcnt lgkmcnt(0)
    s_barrier
    s_lshl_b32 s49, s44, 10
    s_add_u32 m0, s49, 106496
    s_add_u32 s55, s50, 12288
    buffer_load_dwordx4 a[84:87], v8, s[8:11], s55 offen offset:3072
    s_add_u32 s49, s49, 0
    buffer_load_dwordx4 v8, s[12:15], s49 offen lds
    s_add_u32 m0, m0, 4096
    s_add_u32 s49, s49, 4096
    buffer_load_dwordx4 v8, s[12:15], s49 offen lds
    s_add_u32 m0, m0, 4096
    s_add_u32 s55, s51, 12288
    buffer_load_dwordx4 a[88:91], v8, s[8:11], s55 offen offset:3072
    s_add_u32 s49, s49, 4096
    buffer_load_dwordx4 v8, s[12:15], s49 offen lds
    s_add_u32 m0, m0, 4096
    s_add_u32 s49, s49, 4096
    buffer_load_dwordx4 v8, s[12:15], s49 offen lds
    s_mul_i32 s67, s41, 245760
    s_add_u32 s55, s52, 12288
    buffer_load_dwordx4 a[92:95], v8, s[8:11], s55 offen offset:3072
    s_mul_i32 s49, s44, 12288
    s_add_u32 s67, s67, s49
    s_add_u32 s67, s67, s65
    v_lshlrev_b32 v13, 2, v2
    v_add_u32 v13, 151296, v13
    ds_read_b32 v92, v13 offset:0
    s_add_u32 s55, s50, 16384
    buffer_load_dwordx4 a[96:99], v8, s[8:11], s55 offen offset:0
    ds_read_b32 v93, v13 offset:64
    ds_read_b32 v94, v13 offset:128
    ds_read_b32 v95, v13 offset:192
    v_add_u32 v9, 53248, v8
    s_mov_b32 s58, 0xbfb8aa3b
    s_lshl_b32 s45, s40, 2
    s_add_u32 s55, s51, 16384
    buffer_load_dwordx4 a[100:103], v8, s[8:11], s55 offen offset:0
    s_mul_i32 s45, s45, 49152
    s_add_u32 s45, s45, s66
    s_lshr_b32 s46, s56, 1
    s_lshl_b32 s46, s46, 10
    s_add_u32 s46, s46, s45
    s_lshr_b32 s48, s57, 1
    s_add_u32 s55, s52, 16384
    buffer_load_dwordx4 a[104:107], v8, s[8:11], s55 offen offset:0
    s_lshl_b32 s48, s48, 10
    s_add_u32 s48, s48, s45
    s_lshl_b32 s49, s44, 11
    s_add_u32 s49, s49, 151552
    v_lshrrev_b32 v7, 1, v8
    v_add_u32 v7, s49, v7
    s_add_u32 s55, s50, 16384
    buffer_load_dwordx4 a[108:111], v8, s[8:11], s55 offen offset:1024
    ds_read_b128 v[64:67], v8 offset:0
    ds_read_b128 v[68:71], v8 offset:26624
    ds_read_b128 v[72:75], v9 offset:0
    ds_read_b128 v[76:79], v9 offset:26624
    ds_read_b128 v[80:83], v8 offset:1024
    s_waitcnt vmcnt(55) lgkmcnt(4)
    v_mfma_f32_16x16x32_bf16 v[16:19], a[160:163], v[64:67], 0
    s_add_u32 s55, s51, 16384
    buffer_load_dwordx4 a[112:115], v8, s[8:11], s55 offen offset:1024
    s_waitcnt vmcnt(55)
    v_mfma_f32_16x16x32_bf16 v[20:23], a[164:167], v[64:67], 0
    s_waitcnt vmcnt(54)
    v_mfma_f32_16x16x32_bf16 v[24:27], a[168:171], v[64:67], 0
    ds_read_b128 v[64:67], v8 offset:27648
    s_waitcnt lgkmcnt(4)
    v_mfma_f32_16x16x32_bf16 v[28:31], a[160:163], v[68:71], 0
    s_add_u32 s55, s52, 16384
    buffer_load_dwordx4 a[116:119], v8, s[8:11], s55 offen offset:1024
    v_mfma_f32_16x16x32_bf16 v[32:35], a[164:167], v[68:71], 0
    v_mfma_f32_16x16x32_bf16 v[36:39], a[168:171], v[68:71], 0
    s_mul_i32 s63, s41, 20
    ds_read_b128 v[68:71], v9 offset:1024
    s_add_u32 s55, s50, 16384
    buffer_load_dwordx4 a[120:123], v8, s[8:11], s55 offen offset:2048
    s_waitcnt lgkmcnt(4)
    v_mfma_f32_16x16x32_bf16 v[40:43], a[160:163], v[72:75], 0
    v_mfma_f32_16x16x32_bf16 v[44:47], a[164:167], v[72:75], 0
    v_mfma_f32_16x16x32_bf16 v[48:51], a[168:171], v[72:75], 0
    s_add_u32 s55, s51, 16384
    buffer_load_dwordx4 a[124:127], v8, s[8:11], s55 offen offset:2048
    ds_read_b128 v[72:75], v9 offset:27648
    s_waitcnt lgkmcnt(4)
    v_mfma_f32_16x16x32_bf16 v[52:55], a[160:163], v[76:79], 0
    v_mfma_f32_16x16x32_bf16 v[56:59], a[164:167], v[76:79], 0
    s_set_gpr_idx_on s63, 0x1
    v_add_f32 v84, v96, v15
    v_add_f32 v85, v97, v15
    s_set_gpr_idx_off
    v_mfma_f32_16x16x32_bf16 v[60:63], a[168:171], v[76:79], 0
    s_add_u32 s55, s52, 16384
    buffer_load_dwordx4 a[128:131], v8, s[8:11], s55 offen offset:2048
    ds_read_b128 v[76:79], v8 offset:2048
    s_waitcnt vmcnt(57) lgkmcnt(4)
    v_mfma_f32_16x16x32_bf16 v[16:19], a[172:175], v[80:83], v[16:19]
    s_waitcnt vmcnt(56)
    v_mfma_f32_16x16x32_bf16 v[20:23], a[176:179], v[80:83], v[20:23]
    s_waitcnt vmcnt(55)
    v_mfma_f32_16x16x32_bf16 v[24:27], a[180:183], v[80:83], v[24:27]
    s_add_u32 s55, s50, 16384
    buffer_load_dwordx4 a[132:135], v8, s[8:11], s55 offen offset:3072
    ds_read_b128 v[80:83], v8 offset:28672
    s_waitcnt lgkmcnt(4)
    v_mfma_f32_16x16x32_bf16 v[28:31], a[172:175], v[64:67], v[28:31]
    v_mfma_f32_16x16x32_bf16 v[32:35], a[176:179], v[64:67], v[32:35]
    v_cvt_pk_bf16_f32 v86, v84, v85
    s_add_u32 s55, s51, 16384
    buffer_load_dwordx4 a[136:139], v8, s[8:11], s55 offen offset:3072
    v_mfma_f32_16x16x32_bf16 v[36:39], a[180:183], v[64:67], v[36:39]
    ds_read_b128 v[64:67], v9 offset:2048
    s_waitcnt lgkmcnt(4)
    v_mfma_f32_16x16x32_bf16 v[40:43], a[172:175], v[68:71], v[40:43]
    v_mfma_f32_16x16x32_bf16 v[44:47], a[176:179], v[68:71], v[44:47]
    s_add_u32 s55, s52, 16384
    buffer_load_dwordx4 a[140:143], v8, s[8:11], s55 offen offset:3072
    v_mfma_f32_16x16x32_bf16 v[48:51], a[180:183], v[68:71], v[48:51]
    ds_read_b128 v[68:71], v9 offset:28672
    s_waitcnt lgkmcnt(4)
    v_mfma_f32_16x16x32_bf16 v[52:55], a[172:175], v[72:75], v[52:55]
    v_accvgpr_write_b32 a144, v86
    s_add_u32 s55, s67, 0
    buffer_load_dwordx4 a[160:163], v8, s[8:11], s55 offen offset:0
    v_mfma_f32_16x16x32_bf16 v[56:59], a[176:179], v[72:75], v[56:59]
    v_mfma_f32_16x16x32_bf16 v[60:63], a[180:183], v[72:75], v[60:63]
    ds_read_b128 v[72:75], v8 offset:3072
    s_waitcnt vmcnt(58) lgkmcnt(4)
    v_mfma_f32_16x16x32_bf16 v[16:19], a[184:187], v[76:79], v[16:19]
    s_waitcnt vmcnt(57)
    v_mfma_f32_16x16x32_bf16 v[20:23], a[188:191], v[76:79], v[20:23]
    s_waitcnt vmcnt(56)
    v_mfma_f32_16x16x32_bf16 v[24:27], a[192:195], v[76:79], v[24:27]
    s_add_u32 s55, s67, 49152
    buffer_load_dwordx4 a[164:167], v8, s[8:11], s55 offen offset:0
    ds_read_b128 v[76:79], v8 offset:29696
    s_waitcnt lgkmcnt(4)
    v_mfma_f32_16x16x32_bf16 v[28:31], a[184:187], v[80:83], v[28:31]
    s_set_gpr_idx_on s63, 0x1
    v_add_f32 v84, v98, v15
    v_add_f32 v85, v99, v15
    s_set_gpr_idx_off
    v_mfma_f32_16x16x32_bf16 v[32:35], a[188:191], v[80:83], v[32:35]
    v_mfma_f32_16x16x32_bf16 v[36:39], a[192:195], v[80:83], v[36:39]
    ds_read_b128 v[80:83], v9 offset:3072
    s_waitcnt lgkmcnt(4)
    v_mfma_f32_16x16x32_bf16 v[40:43], a[184:187], v[64:67], v[40:43]
    s_add_u32 s55, s67, 98304
    buffer_load_dwordx4 a[168:171], v8, s[8:11], s55 offen offset:0
    v_mfma_f32_16x16x32_bf16 v[44:47], a[188:191], v[64:67], v[44:47]
    v_mfma_f32_16x16x32_bf16 v[48:51], a[192:195], v[64:67], v[48:51]
    v_cvt_pk_bf16_f32 v86, v84, v85
    ds_read_b128 v[64:67], v9 offset:29696
    s_waitcnt lgkmcnt(4)
    v_mfma_f32_16x16x32_bf16 v[52:55], a[184:187], v[68:71], v[52:55]
    v_mfma_f32_16x16x32_bf16 v[56:59], a[188:191], v[68:71], v[56:59]
    s_add_u32 s55, s67, 147456
    buffer_load_dwordx4 a[172:175], v8, s[8:11], s55 offen offset:0
    v_mfma_f32_16x16x32_bf16 v[60:63], a[192:195], v[68:71], v[60:63]
    ds_read_b128 v[68:71], v8 offset:4096
    s_waitcnt vmcnt(58) lgkmcnt(4)
    v_mfma_f32_16x16x32_bf16 v[16:19], a[196:199], v[72:75], v[16:19]
    s_waitcnt vmcnt(57)
    v_mfma_f32_16x16x32_bf16 v[20:23], a[200:203], v[72:75], v[20:23]
    v_accvgpr_write_b32 a145, v86
    s_waitcnt vmcnt(56)
    v_mfma_f32_16x16x32_bf16 v[24:27], a[204:207], v[72:75], v[24:27]
    s_add_u32 s55, s67, 196608
    buffer_load_dwordx4 a[176:179], v8, s[8:11], s55 offen offset:0
    ds_read_b128 v[72:75], v8 offset:30720
    s_waitcnt lgkmcnt(4)
    v_mfma_f32_16x16x32_bf16 v[28:31], a[196:199], v[76:79], v[28:31]
    v_mfma_f32_16x16x32_bf16 v[32:35], a[200:203], v[76:79], v[32:35]
    v_mfma_f32_16x16x32_bf16 v[36:39], a[204:207], v[76:79], v[36:39]
    ds_read_b128 v[76:79], v9 offset:4096
    s_waitcnt lgkmcnt(4)
    v_mfma_f32_16x16x32_bf16 v[40:43], a[196:199], v[80:83], v[40:43]
    s_add_u32 s55, s67, 0
    buffer_load_dwordx4 a[180:183], v8, s[8:11], s55 offen offset:1024
    v_mfma_f32_16x16x32_bf16 v[44:47], a[200:203], v[80:83], v[44:47]
    s_set_gpr_idx_on s63, 0x1
    v_add_f32 v84, v100, v15
    v_add_f32 v85, v101, v15
    s_set_gpr_idx_off
    v_mfma_f32_16x16x32_bf16 v[48:51], a[204:207], v[80:83], v[48:51]
    ds_read_b128 v[80:83], v9 offset:30720
    s_waitcnt lgkmcnt(4)
    v_mfma_f32_16x16x32_bf16 v[52:55], a[196:199], v[64:67], v[52:55]
    v_mfma_f32_16x16x32_bf16 v[56:59], a[200:203], v[64:67], v[56:59]
    v_mfma_f32_16x16x32_bf16 v[60:63], a[204:207], v[64:67], v[60:63]
    s_add_u32 s55, s67, 49152
    buffer_load_dwordx4 a[184:187], v8, s[8:11], s55 offen offset:1024
    ds_read_b128 v[64:67], v8 offset:5120
    s_waitcnt vmcnt(58) lgkmcnt(4)
    v_mfma_f32_16x16x32_bf16 v[16:19], a[208:211], v[68:71], v[16:19]
    v_cvt_pk_bf16_f32 v86, v84, v85
    s_waitcnt vmcnt(57)
    v_mfma_f32_16x16x32_bf16 v[20:23], a[212:215], v[68:71], v[20:23]
    s_waitcnt vmcnt(56)
    v_mfma_f32_16x16x32_bf16 v[24:27], a[216:219], v[68:71], v[24:27]
    ds_read_b128 v[68:71], v8 offset:31744
    s_waitcnt lgkmcnt(4)
    v_mfma_f32_16x16x32_bf16 v[28:31], a[208:211], v[72:75], v[28:31]
    s_add_u32 s55, s67, 98304
    buffer_load_dwordx4 a[188:191], v8, s[8:11], s55 offen offset:1024
    v_mfma_f32_16x16x32_bf16 v[32:35], a[212:215], v[72:75], v[32:35]
    v_mfma_f32_16x16x32_bf16 v[36:39], a[216:219], v[72:75], v[36:39]
    ds_read_b128 v[72:75], v9 offset:5120
    s_waitcnt lgkmcnt(4)
    v_mfma_f32_16x16x32_bf16 v[40:43], a[208:211], v[76:79], v[40:43]
    v_accvgpr_write_b32 a146, v86
    v_mfma_f32_16x16x32_bf16 v[44:47], a[212:215], v[76:79], v[44:47]
    s_add_u32 s55, s67, 147456
    buffer_load_dwordx4 a[192:195], v8, s[8:11], s55 offen offset:1024
    v_mfma_f32_16x16x32_bf16 v[48:51], a[216:219], v[76:79], v[48:51]
    ds_read_b128 v[76:79], v9 offset:31744
    s_waitcnt lgkmcnt(4)
    v_mfma_f32_16x16x32_bf16 v[52:55], a[208:211], v[80:83], v[52:55]
    v_mfma_f32_16x16x32_bf16 v[56:59], a[212:215], v[80:83], v[56:59]
    v_mfma_f32_16x16x32_bf16 v[60:63], a[216:219], v[80:83], v[60:63]
    s_set_gpr_idx_on s63, 0x1
    v_add_f32 v84, v102, v15
    v_add_f32 v85, v103, v15
    s_set_gpr_idx_off
    ds_read_b128 v[80:83], v8 offset:6144
    s_add_u32 s55, s67, 196608
    buffer_load_dwordx4 a[196:199], v8, s[8:11], s55 offen offset:1024
    s_waitcnt vmcnt(58) lgkmcnt(4)
    v_mfma_f32_16x16x32_bf16 v[16:19], a[220:223], v[64:67], v[16:19]
    s_waitcnt vmcnt(57)
    v_mfma_f32_16x16x32_bf16 v[20:23], a[224:227], v[64:67], v[20:23]
    s_waitcnt vmcnt(56)
    v_mfma_f32_16x16x32_bf16 v[24:27], a[228:231], v[64:67], v[24:27]
    ds_read_b128 v[64:67], v8 offset:32768
    s_waitcnt lgkmcnt(4)
    v_mfma_f32_16x16x32_bf16 v[28:31], a[220:223], v[68:71], v[28:31]
    v_mfma_f32_16x16x32_bf16 v[32:35], a[224:227], v[68:71], v[32:35]
    s_add_u32 s55, s67, 0
    buffer_load_dwordx4 a[200:203], v8, s[8:11], s55 offen offset:2048
    v_mfma_f32_16x16x32_bf16 v[36:39], a[228:231], v[68:71], v[36:39]
    v_cvt_pk_bf16_f32 v86, v84, v85
    ds_read_b128 v[68:71], v9 offset:6144
    s_waitcnt lgkmcnt(4)
    v_mfma_f32_16x16x32_bf16 v[40:43], a[220:223], v[72:75], v[40:43]
    v_mfma_f32_16x16x32_bf16 v[44:47], a[224:227], v[72:75], v[44:47]
    v_mfma_f32_16x16x32_bf16 v[48:51], a[228:231], v[72:75], v[48:51]
    s_add_u32 s55, s67, 49152
    buffer_load_dwordx4 a[204:207], v8, s[8:11], s55 offen offset:2048
    ds_read_b128 v[72:75], v9 offset:32768
    s_waitcnt lgkmcnt(4)
    v_mfma_f32_16x16x32_bf16 v[52:55], a[220:223], v[76:79], v[52:55]
    v_mfma_f32_16x16x32_bf16 v[56:59], a[224:227], v[76:79], v[56:59]
    v_accvgpr_write_b32 a147, v86
    v_mfma_f32_16x16x32_bf16 v[60:63], a[228:231], v[76:79], v[60:63]
    ds_read_b128 v[76:79], v8 offset:7168
    s_waitcnt vmcnt(57) lgkmcnt(4)
    v_mfma_f32_16x16x32_bf16 v[16:19], a[232:235], v[80:83], v[16:19]
    s_add_u32 s55, s67, 98304
    buffer_load_dwordx4 a[208:211], v8, s[8:11], s55 offen offset:2048
    s_waitcnt vmcnt(57)
    v_mfma_f32_16x16x32_bf16 v[20:23], a[236:239], v[80:83], v[20:23]
    s_waitcnt vmcnt(56)
    v_mfma_f32_16x16x32_bf16 v[24:27], a[240:243], v[80:83], v[24:27]
    ds_read_b128 v[80:83], v8 offset:33792
    s_waitcnt lgkmcnt(4)
    v_mfma_f32_16x16x32_bf16 v[28:31], a[232:235], v[64:67], v[28:31]
    s_set_gpr_idx_on s63, 0x1
    v_add_f32 v84, v104, v15
    v_add_f32 v85, v105, v15
    s_set_gpr_idx_off
    v_mfma_f32_16x16x32_bf16 v[32:35], a[236:239], v[64:67], v[32:35]
    v_mfma_f32_16x16x32_bf16 v[36:39], a[240:243], v[64:67], v[36:39]
    s_add_u32 s55, s67, 147456
    buffer_load_dwordx4 a[212:215], v8, s[8:11], s55 offen offset:2048
    ds_read_b128 v[64:67], v9 offset:7168
    s_waitcnt lgkmcnt(4)
    v_mfma_f32_16x16x32_bf16 v[40:43], a[232:235], v[68:71], v[40:43]
    v_mfma_f32_16x16x32_bf16 v[44:47], a[236:239], v[68:71], v[44:47]
    v_mfma_f32_16x16x32_bf16 v[48:51], a[240:243], v[68:71], v[48:51]
    ds_read_b128 v[68:71], v9 offset:33792
    s_waitcnt lgkmcnt(4)
    v_mfma_f32_16x16x32_bf16 v[52:55], a[232:235], v[72:75], v[52:55]
    s_add_u32 s55, s67, 196608
    buffer_load_dwordx4 a[216:219], v8, s[8:11], s55 offen offset:2048
    v_cvt_pk_bf16_f32 v86, v84, v85
    v_mfma_f32_16x16x32_bf16 v[56:59], a[236:239], v[72:75], v[56:59]
    v_mfma_f32_16x16x32_bf16 v[60:63], a[240:243], v[72:75], v[60:63]
    ds_read_b128 v[72:75], v8 offset:8192
    s_waitcnt vmcnt(57) lgkmcnt(4)
    v_mfma_f32_16x16x32_bf16 v[16:19], a[244:247], v[76:79], v[16:19]
    s_waitcnt vmcnt(56)
    v_mfma_f32_16x16x32_bf16 v[20:23], a[248:251], v[76:79], v[20:23]
    s_add_u32 s55, s67, 0
    buffer_load_dwordx4 a[220:223], v8, s[8:11], s55 offen offset:3072
    s_waitcnt vmcnt(56)
    v_mfma_f32_16x16x32_bf16 v[24:27], a[252:255], v[76:79], v[24:27]
    v_accvgpr_write_b32 a148, v86
    ds_read_b128 v[76:79], v8 offset:34816
    s_waitcnt lgkmcnt(4)
    v_mfma_f32_16x16x32_bf16 v[28:31], a[244:247], v[80:83], v[28:31]
    v_mfma_f32_16x16x32_bf16 v[32:35], a[248:251], v[80:83], v[32:35]
    v_mfma_f32_16x16x32_bf16 v[36:39], a[252:255], v[80:83], v[36:39]
    s_add_u32 s55, s67, 49152
    buffer_load_dwordx4 a[224:227], v8, s[8:11], s55 offen offset:3072
    ds_read_b128 v[80:83], v9 offset:8192
    s_waitcnt lgkmcnt(4)
    v_mfma_f32_16x16x32_bf16 v[40:43], a[244:247], v[64:67], v[40:43]
    v_mfma_f32_16x16x32_bf16 v[44:47], a[248:251], v[64:67], v[44:47]
    v_mfma_f32_16x16x32_bf16 v[48:51], a[252:255], v[64:67], v[48:51]
    s_set_gpr_idx_on s63, 0x1
    v_add_f32 v84, v106, v15
    v_add_f32 v85, v107, v15
    s_set_gpr_idx_off
    ds_read_b128 v[64:67], v9 offset:34816
    s_waitcnt lgkmcnt(4)
    v_mfma_f32_16x16x32_bf16 v[52:55], a[244:247], v[68:71], v[52:55]
    s_add_u32 s55, s67, 98304
    buffer_load_dwordx4 a[228:231], v8, s[8:11], s55 offen offset:3072
    v_mfma_f32_16x16x32_bf16 v[56:59], a[248:251], v[68:71], v[56:59]
    v_mfma_f32_16x16x32_bf16 v[60:63], a[252:255], v[68:71], v[60:63]
    ds_read_b128 v[68:71], v8 offset:9216
    s_waitcnt vmcnt(57) lgkmcnt(4)
    v_mfma_f32_16x16x32_bf16 v[16:19], a[0:3], v[72:75], v[16:19]
    s_waitcnt vmcnt(56)
    v_mfma_f32_16x16x32_bf16 v[20:23], a[4:7], v[72:75], v[20:23]
    v_cvt_pk_bf16_f32 v86, v84, v85
    s_add_u32 s55, s67, 147456
    buffer_load_dwordx4 a[232:235], v8, s[8:11], s55 offen offset:3072
    s_waitcnt vmcnt(56)
    v_mfma_f32_16x16x32_bf16 v[24:27], a[8:11], v[72:75], v[24:27]
    ds_read_b128 v[72:75], v8 offset:35840
    s_waitcnt lgkmcnt(4)
    v_mfma_f32_16x16x32_bf16 v[28:31], a[0:3], v[76:79], v[28:31]
    v_mfma_f32_16x16x32_bf16 v[32:35], a[4:7], v[76:79], v[32:35]
    v_mfma_f32_16x16x32_bf16 v[36:39], a[8:11], v[76:79], v[36:39]
    ds_read_b128 v[76:79], v9 offset:9216
    s_add_u32 s55, s67, 196608
    buffer_load_dwordx4 a[236:239], v8, s[8:11], s55 offen offset:3072
    s_waitcnt lgkmcnt(4)
    v_mfma_f32_16x16x32_bf16 v[40:43], a[0:3], v[80:83], v[40:43]
    v_accvgpr_write_b32 a149, v86
    v_mfma_f32_16x16x32_bf16 v[44:47], a[4:7], v[80:83], v[44:47]
    v_mfma_f32_16x16x32_bf16 v[48:51], a[8:11], v[80:83], v[48:51]
    ds_read_b128 v[80:83], v9 offset:35840
    s_waitcnt lgkmcnt(4)
    v_mfma_f32_16x16x32_bf16 v[52:55], a[0:3], v[64:67], v[52:55]
    s_add_u32 s55, s67, 4096
    buffer_load_dwordx4 a[240:243], v8, s[8:11], s55 offen offset:0
    v_mfma_f32_16x16x32_bf16 v[56:59], a[4:7], v[64:67], v[56:59]
    v_mfma_f32_16x16x32_bf16 v[60:63], a[8:11], v[64:67], v[60:63]
    ds_read_b128 v[64:67], v8 offset:10240
    s_waitcnt vmcnt(57) lgkmcnt(4)
    v_mfma_f32_16x16x32_bf16 v[16:19], a[12:15], v[68:71], v[16:19]
    s_set_gpr_idx_on s63, 0x1
    v_add_f32 v84, v108, v15
    v_add_f32 v85, v109, v15
    s_set_gpr_idx_off
    s_waitcnt vmcnt(56)
    v_mfma_f32_16x16x32_bf16 v[20:23], a[16:19], v[68:71], v[20:23]
    s_waitcnt vmcnt(55)
    v_mfma_f32_16x16x32_bf16 v[24:27], a[20:23], v[68:71], v[24:27]
    s_add_u32 s55, s67, 53248
    buffer_load_dwordx4 a[244:247], v8, s[8:11], s55 offen offset:0
    ds_read_b128 v[68:71], v8 offset:36864
    s_waitcnt lgkmcnt(4)
    v_mfma_f32_16x16x32_bf16 v[28:31], a[12:15], v[72:75], v[28:31]
    v_mfma_f32_16x16x32_bf16 v[32:35], a[16:19], v[72:75], v[32:35]
    v_mfma_f32_16x16x32_bf16 v[36:39], a[20:23], v[72:75], v[36:39]
    v_cvt_pk_bf16_f32 v86, v84, v85
    ds_read_b128 v[72:75], v9 offset:10240
    s_waitcnt lgkmcnt(4)
    v_mfma_f32_16x16x32_bf16 v[40:43], a[12:15], v[76:79], v[40:43]
    s_add_u32 s55, s67, 102400
    buffer_load_dwordx4 a[248:251], v8, s[8:11], s55 offen offset:0
    v_mfma_f32_16x16x32_bf16 v[44:47], a[16:19], v[76:79], v[44:47]
    v_mfma_f32_16x16x32_bf16 v[48:51], a[20:23], v[76:79], v[48:51]
    ds_read_b128 v[76:79], v9 offset:36864
    s_waitcnt lgkmcnt(4)
    v_mfma_f32_16x16x32_bf16 v[52:55], a[12:15], v[80:83], v[52:55]
    v_mfma_f32_16x16x32_bf16 v[56:59], a[16:19], v[80:83], v[56:59]
    v_mfma_f32_16x16x32_bf16 v[60:63], a[20:23], v[80:83], v[60:63]
    s_add_u32 s55, s67, 151552
    buffer_load_dwordx4 a[252:255], v8, s[8:11], s55 offen offset:0
    v_accvgpr_write_b32 a150, v86
    ds_read_b128 v[80:83], v8 offset:11264
    s_waitcnt vmcnt(57) lgkmcnt(4)
    v_mfma_f32_16x16x32_bf16 v[16:19], a[24:27], v[64:67], v[16:19]
    s_waitcnt vmcnt(56)
    v_mfma_f32_16x16x32_bf16 v[20:23], a[28:31], v[64:67], v[20:23]
    s_waitcnt vmcnt(55)
    v_mfma_f32_16x16x32_bf16 v[24:27], a[32:35], v[64:67], v[24:27]
    ds_read_b128 v[64:67], v8 offset:37888
    s_waitcnt lgkmcnt(4)
    v_mfma_f32_16x16x32_bf16 v[28:31], a[24:27], v[68:71], v[28:31]
    s_add_u32 s55, s67, 200704
    buffer_load_dwordx4 a[0:3], v8, s[8:11], s55 offen offset:0
    v_mfma_f32_16x16x32_bf16 v[32:35], a[28:31], v[68:71], v[32:35]
    s_set_gpr_idx_on s63, 0x1
    v_add_f32 v84, v110, v15
    v_add_f32 v85, v111, v15
    s_set_gpr_idx_off
    v_mfma_f32_16x16x32_bf16 v[36:39], a[32:35], v[68:71], v[36:39]
    ds_read_b128 v[68:71], v9 offset:11264
    s_waitcnt lgkmcnt(4)
    v_mfma_f32_16x16x32_bf16 v[40:43], a[24:27], v[72:75], v[40:43]
    v_mfma_f32_16x16x32_bf16 v[44:47], a[28:31], v[72:75], v[44:47]
    v_mfma_f32_16x16x32_bf16 v[48:51], a[32:35], v[72:75], v[48:51]
    s_add_u32 s55, s67, 4096
    buffer_load_dwordx4 a[4:7], v8, s[8:11], s55 offen offset:1024
    ds_read_b128 v[72:75], v9 offset:37888
    s_waitcnt lgkmcnt(4)
    v_mfma_f32_16x16x32_bf16 v[52:55], a[24:27], v[76:79], v[52:55]
    v_mfma_f32_16x16x32_bf16 v[56:59], a[28:31], v[76:79], v[56:59]
    v_cvt_pk_bf16_f32 v86, v84, v85
    v_mfma_f32_16x16x32_bf16 v[60:63], a[32:35], v[76:79], v[60:63]
    ds_read_b128 v[76:79], v8 offset:12288
    s_waitcnt vmcnt(56) lgkmcnt(4)
    v_mfma_f32_16x16x32_bf16 v[16:19], a[36:39], v[80:83], v[16:19]
    s_add_u32 s55, s67, 53248
    buffer_load_dwordx4 a[8:11], v8, s[8:11], s55 offen offset:1024
    s_waitcnt vmcnt(56)
    v_mfma_f32_16x16x32_bf16 v[20:23], a[40:43], v[80:83], v[20:23]
    s_waitcnt vmcnt(55)
    v_mfma_f32_16x16x32_bf16 v[24:27], a[44:47], v[80:83], v[24:27]
    ds_read_b128 v[80:83], v8 offset:38912
    s_waitcnt lgkmcnt(4)
    v_mfma_f32_16x16x32_bf16 v[28:31], a[36:39], v[64:67], v[28:31]
    v_accvgpr_write_b32 a151, v86
    v_mfma_f32_16x16x32_bf16 v[32:35], a[40:43], v[64:67], v[32:35]
    s_add_u32 s55, s67, 102400
    buffer_load_dwordx4 a[12:15], v8, s[8:11], s55 offen offset:1024
    v_mfma_f32_16x16x32_bf16 v[36:39], a[44:47], v[64:67], v[36:39]
    ds_read_b128 v[64:67], v9 offset:12288
    s_waitcnt lgkmcnt(4)
    v_mfma_f32_16x16x32_bf16 v[40:43], a[36:39], v[68:71], v[40:43]
    v_mfma_f32_16x16x32_bf16 v[44:47], a[40:43], v[68:71], v[44:47]
    v_mfma_f32_16x16x32_bf16 v[48:51], a[44:47], v[68:71], v[48:51]
    s_set_gpr_idx_on s63, 0x1
    v_add_f32 v84, v112, v15
    v_add_f32 v85, v113, v15
    s_set_gpr_idx_off
    ds_read_b128 v[68:71], v9 offset:38912
    s_add_u32 s55, s67, 151552
    buffer_load_dwordx4 a[16:19], v8, s[8:11], s55 offen offset:1024
    s_waitcnt lgkmcnt(4)
    v_mfma_f32_16x16x32_bf16 v[52:55], a[36:39], v[72:75], v[52:55]
    v_mfma_f32_16x16x32_bf16 v[56:59], a[40:43], v[72:75], v[56:59]
    v_mfma_f32_16x16x32_bf16 v[60:63], a[44:47], v[72:75], v[60:63]
    ds_read_b128 v[72:75], v8 offset:13312
    s_waitcnt vmcnt(56) lgkmcnt(4)
    v_mfma_f32_16x16x32_bf16 v[16:19], a[48:51], v[76:79], v[16:19]
    s_waitcnt vmcnt(55)
    v_mfma_f32_16x16x32_bf16 v[20:23], a[52:55], v[76:79], v[20:23]
    s_add_u32 s55, s67, 200704
    buffer_load_dwordx4 a[20:23], v8, s[8:11], s55 offen offset:1024
    s_waitcnt vmcnt(55)
    v_mfma_f32_16x16x32_bf16 v[24:27], a[56:59], v[76:79], v[24:27]
    v_cvt_pk_bf16_f32 v86, v84, v85
    ds_read_b128 v[76:79], v8 offset:39936
    s_waitcnt lgkmcnt(4)
    v_mfma_f32_16x16x32_bf16 v[28:31], a[48:51], v[80:83], v[28:31]
    v_mfma_f32_16x16x32_bf16 v[32:35], a[52:55], v[80:83], v[32:35]
    v_mfma_f32_16x16x32_bf16 v[36:39], a[56:59], v[80:83], v[36:39]
    s_add_u32 s55, s67, 4096
    buffer_load_dwordx4 a[24:27], v8, s[8:11], s55 offen offset:2048
    ds_read_b128 v[80:83], v9 offset:13312
    s_waitcnt lgkmcnt(4)
    v_mfma_f32_16x16x32_bf16 v[40:43], a[48:51], v[64:67], v[40:43]
    v_mfma_f32_16x16x32_bf16 v[44:47], a[52:55], v[64:67], v[44:47]
    v_accvgpr_write_b32 a152, v86
    v_mfma_f32_16x16x32_bf16 v[48:51], a[56:59], v[64:67], v[48:51]
    ds_read_b128 v[64:67], v9 offset:39936
    s_waitcnt lgkmcnt(4)
    v_mfma_f32_16x16x32_bf16 v[52:55], a[48:51], v[68:71], v[52:55]
    s_add_u32 s55, s67, 53248
    buffer_load_dwordx4 a[28:31], v8, s[8:11], s55 offen offset:2048
    v_mfma_f32_16x16x32_bf16 v[56:59], a[52:55], v[68:71], v[56:59]
    v_mfma_f32_16x16x32_bf16 v[60:63], a[56:59], v[68:71], v[60:63]
    ds_read_b128 v[68:71], v8 offset:14336
    s_waitcnt vmcnt(56) lgkmcnt(4)
    v_mfma_f32_16x16x32_bf16 v[16:19], a[60:63], v[72:75], v[16:19]
    s_waitcnt vmcnt(55)
    v_mfma_f32_16x16x32_bf16 v[20:23], a[64:67], v[72:75], v[20:23]
    s_set_gpr_idx_on s63, 0x1
    v_add_f32 v84, v114, v15
    v_add_f32 v85, v115, v15
    s_set_gpr_idx_off
    s_waitcnt vmcnt(54)
    v_mfma_f32_16x16x32_bf16 v[24:27], a[68:71], v[72:75], v[24:27]
    s_add_u32 s55, s67, 102400
    buffer_load_dwordx4 a[32:35], v8, s[8:11], s55 offen offset:2048
    ds_read_b128 v[72:75], v8 offset:40960
    s_waitcnt lgkmcnt(4)
    v_mfma_f32_16x16x32_bf16 v[28:31], a[60:63], v[76:79], v[28:31]
    v_mfma_f32_16x16x32_bf16 v[32:35], a[64:67], v[76:79], v[32:35]
    v_mfma_f32_16x16x32_bf16 v[36:39], a[68:71], v[76:79], v[36:39]
    ds_read_b128 v[76:79], v9 offset:14336
    s_waitcnt lgkmcnt(4)
    v_mfma_f32_16x16x32_bf16 v[40:43], a[60:63], v[80:83], v[40:43]
    s_add_u32 s55, s67, 151552
    buffer_load_dwordx4 a[36:39], v8, s[8:11], s55 offen offset:2048
    v_cvt_pk_bf16_f32 v86, v84, v85
    v_mfma_f32_16x16x32_bf16 v[44:47], a[64:67], v[80:83], v[44:47]
    v_mfma_f32_16x16x32_bf16 v[48:51], a[68:71], v[80:83], v[48:51]
    ds_read_b128 v[80:83], v9 offset:40960
    s_waitcnt lgkmcnt(4)
    v_mfma_f32_16x16x32_bf16 v[52:55], a[60:63], v[64:67], v[52:55]
    v_mfma_f32_16x16x32_bf16 v[56:59], a[64:67], v[64:67], v[56:59]
    s_add_u32 s55, s67, 200704
    buffer_load_dwordx4 a[40:43], v8, s[8:11], s55 offen offset:2048
    v_mfma_f32_16x16x32_bf16 v[60:63], a[68:71], v[64:67], v[60:63]
    v_accvgpr_write_b32 a153, v86
    ds_read_b128 v[64:67], v8 offset:15360
    s_waitcnt vmcnt(56) lgkmcnt(4)
    v_mfma_f32_16x16x32_bf16 v[16:19], a[72:75], v[68:71], v[16:19]
    s_waitcnt vmcnt(55)
    v_mfma_f32_16x16x32_bf16 v[20:23], a[76:79], v[68:71], v[20:23]
    s_waitcnt vmcnt(54)
    v_mfma_f32_16x16x32_bf16 v[24:27], a[80:83], v[68:71], v[24:27]
    s_add_u32 s55, s67, 4096
    buffer_load_dwordx4 a[44:47], v8, s[8:11], s55 offen offset:3072
    ds_read_b128 v[68:71], v8 offset:16384
    s_waitcnt lgkmcnt(4)
    v_mfma_f32_16x16x32_bf16 v[28:31], a[72:75], v[72:75], v[28:31]
    v_mfma_f32_16x16x32_bf16 v[32:35], a[76:79], v[72:75], v[32:35]
    v_mfma_f32_16x16x32_bf16 v[36:39], a[80:83], v[72:75], v[36:39]
    ds_read_b128 v[72:75], v8 offset:17408
    s_waitcnt lgkmcnt(4)
    v_mfma_f32_16x16x32_bf16 v[40:43], a[72:75], v[76:79], v[40:43]
    s_add_u32 s55, s67, 53248
    buffer_load_dwordx4 a[48:51], v8, s[8:11], s55 offen offset:3072
    v_mfma_f32_16x16x32_bf16 v[44:47], a[76:79], v[76:79], v[44:47]
    v_mfma_f32_16x16x32_bf16 v[48:51], a[80:83], v[76:79], v[48:51]
    ds_read_b128 v[76:79], v8 offset:18432
    s_waitcnt lgkmcnt(4)
    v_mfma_f32_16x16x32_bf16 v[52:55], a[72:75], v[80:83], v[52:55]
    v_mfma_f32_16x16x32_bf16 v[56:59], a[76:79], v[80:83], v[56:59]
    v_mfma_f32_16x16x32_bf16 v[60:63], a[80:83], v[80:83], v[60:63]
    s_add_u32 s55, s67, 102400
    buffer_load_dwordx4 a[52:55], v8, s[8:11], s55 offen offset:3072
    ds_read_b128 v[80:83], v8 offset:19456
    s_waitcnt vmcnt(56) lgkmcnt(4)
    v_mfma_f32_16x16x32_bf16 v[16:19], a[84:87], v[64:67], v[16:19]
    s_waitcnt vmcnt(53)
    v_mfma_f32_16x16x32_bf16 v[20:23], a[88:91], v[64:67], v[20:23]
    s_waitcnt vmcnt(50)
    v_mfma_f32_16x16x32_bf16 v[24:27], a[92:95], v[64:67], v[24:27]
    ds_read_b128 v[64:67], v8 offset:41984
    s_waitcnt vmcnt(49) lgkmcnt(4)
    v_mfma_f32_16x16x32_bf16 v[16:19], a[96:99], v[68:71], v[16:19]
    s_add_u32 s55, s67, 151552
    buffer_load_dwordx4 a[56:59], v8, s[8:11], s55 offen offset:3072
    s_waitcnt vmcnt(49)
    v_mfma_f32_16x16x32_bf16 v[20:23], a[100:103], v[68:71], v[20:23]
    s_waitcnt vmcnt(48)
    v_mfma_f32_16x16x32_bf16 v[24:27], a[104:107], v[68:71], v[24:27]
    ds_read_b128 v[68:71], v8 offset:43008
    s_waitcnt vmcnt(47) lgkmcnt(4)
    v_mfma_f32_16x16x32_bf16 v[16:19], a[108:111], v[72:75], v[16:19]
    s_waitcnt vmcnt(46)
    v_mfma_f32_16x16x32_bf16 v[20:23], a[112:115], v[72:75], v[20:23]
    s_waitcnt vmcnt(45)
    v_mfma_f32_16x16x32_bf16 v[24:27], a[116:119], v[72:75], v[24:27]
    s_add_u32 s55, s67, 200704
    buffer_load_dwordx4 a[60:63], v8, s[8:11], s55 offen offset:3072
    ds_read_b128 v[72:75], v8 offset:44032
    s_waitcnt vmcnt(45) lgkmcnt(4)
    v_mfma_f32_16x16x32_bf16 v[16:19], a[120:123], v[76:79], v[16:19]
    s_waitcnt vmcnt(44)
    v_mfma_f32_16x16x32_bf16 v[20:23], a[124:127], v[76:79], v[20:23]
    s_waitcnt vmcnt(43)
    v_mfma_f32_16x16x32_bf16 v[24:27], a[128:131], v[76:79], v[24:27]
    ds_read_b128 v[76:79], v8 offset:45056
    s_waitcnt vmcnt(42) lgkmcnt(4)
    v_mfma_f32_16x16x32_bf16 v[16:19], a[132:135], v[80:83], v[16:19]
    s_add_u32 s55, s67, 8192
    buffer_load_dwordx4 a[64:67], v8, s[8:11], s55 offen offset:0
    s_waitcnt vmcnt(42)
    v_mfma_f32_16x16x32_bf16 v[20:23], a[136:139], v[80:83], v[20:23]
    s_waitcnt vmcnt(41)
    v_mfma_f32_16x16x32_bf16 v[24:27], a[140:143], v[80:83], v[24:27]
    ds_read_b128 v[80:83], v8 offset:46080
    s_waitcnt lgkmcnt(4)
    v_mfma_f32_16x16x32_bf16 v[28:31], a[84:87], v[64:67], v[28:31]
    v_mfma_f32_16x16x32_bf16 v[32:35], a[88:91], v[64:67], v[32:35]
    v_mfma_f32_16x16x32_bf16 v[36:39], a[92:95], v[64:67], v[36:39]
    s_add_u32 s55, s67, 57344
    buffer_load_dwordx4 a[68:71], v8, s[8:11], s55 offen offset:0
    ds_read_b128 v[64:67], v9 offset:15360
    s_waitcnt lgkmcnt(4)
    v_mfma_f32_16x16x32_bf16 v[28:31], a[96:99], v[68:71], v[28:31]
    v_mul_f32 v16, v16, v92
    v_mul_f32 v17, v17, v92
    v_cvt_pk_bf16_f32 v176, v16, v17
    v_lshlrev_b32 v16, 16, v176
    v_and_b32 v17, 0xffff0000, v176
    v_mul_f32 v176, s58, v16
    v_mul_f32 v177, s58, v17
    s_add_u32 s55, s67, 106496
    buffer_load_dwordx4 a[72:75], v8, s[8:11], s55 offen offset:0
    v_exp_f32 v176, v176
    v_exp_f32 v177, v177
    v_mfma_f32_16x16x32_bf16 v[32:35], a[100:103], v[68:71], v[32:35]
    v_add_f32 v176, 1.0, v176
    v_add_f32 v177, 1.0, v177
    v_rcp_f32 v176, v176
    v_rcp_f32 v177, v177
    v_mul_f32 v176, v176, v16
    v_mul_f32 v177, v177, v17
    s_add_u32 s55, s67, 155648
    buffer_load_dwordx4 a[76:79], v8, s[8:11], s55 offen offset:0
    v_cvt_pk_bf16_f32 v192, v176, v177
    v_mul_f32 v18, v18, v92
    v_mfma_f32_16x16x32_bf16 v[36:39], a[104:107], v[68:71], v[36:39]
    v_mul_f32 v19, v19, v92
    v_cvt_pk_bf16_f32 v180, v18, v19
    v_lshlrev_b32 v18, 16, v180
    v_and_b32 v19, 0xffff0000, v180
    v_mul_f32 v180, s58, v18
    v_mul_f32 v181, s58, v19
    s_add_u32 s55, s67, 204800
    buffer_load_dwordx4 a[80:83], v8, s[8:11], s55 offen offset:0
    v_exp_f32 v180, v180
    v_exp_f32 v181, v181
    ds_read_b128 v[68:71], v9 offset:16384
    s_waitcnt lgkmcnt(4)
    v_mfma_f32_16x16x32_bf16 v[28:31], a[108:111], v[72:75], v[28:31]
    v_add_f32 v180, 1.0, v180
    v_add_f32 v181, 1.0, v181
    v_rcp_f32 v180, v180
    v_rcp_f32 v181, v181
    v_mul_f32 v180, v180, v18
    v_mul_f32 v181, v181, v19
    v_cvt_pk_bf16_f32 v193, v180, v181
    v_mul_f32 v20, v20, v92
    v_mfma_f32_16x16x32_bf16 v[32:35], a[112:115], v[72:75], v[32:35]
    v_mul_f32 v21, v21, v92
    v_cvt_pk_bf16_f32 v184, v20, v21
    v_lshlrev_b32 v20, 16, v184
    v_and_b32 v21, 0xffff0000, v184
    v_mul_f32 v184, s58, v20
    v_mul_f32 v185, s58, v21
    v_exp_f32 v184, v184
    v_exp_f32 v185, v185
    v_mfma_f32_16x16x32_bf16 v[36:39], a[116:119], v[72:75], v[36:39]
    v_add_f32 v184, 1.0, v184
    v_add_f32 v185, 1.0, v185
    v_rcp_f32 v184, v184
    v_rcp_f32 v185, v185
    v_mul_f32 v184, v184, v20
    v_mul_f32 v185, v185, v21
    v_cvt_pk_bf16_f32 v194, v184, v185
    v_mul_f32 v22, v22, v92
    ds_read_b128 v[72:75], v9 offset:17408
    s_waitcnt lgkmcnt(4)
    v_mfma_f32_16x16x32_bf16 v[28:31], a[120:123], v[76:79], v[28:31]
    v_mul_f32 v23, v23, v92
    v_cvt_pk_bf16_f32 v188, v22, v23
    v_lshlrev_b32 v22, 16, v188
    v_and_b32 v23, 0xffff0000, v188
    v_mul_f32 v188, s58, v22
    v_mul_f32 v189, s58, v23
    v_exp_f32 v188, v188
    v_exp_f32 v189, v189
    v_add_f32 v188, 1.0, v188
    v_mfma_f32_16x16x32_bf16 v[32:35], a[124:127], v[76:79], v[32:35]
    v_add_f32 v189, 1.0, v189
    v_rcp_f32 v188, v188
    v_rcp_f32 v189, v189
    v_mul_f32 v188, v188, v22
    v_mul_f32 v189, v189, v23
    v_cvt_pk_bf16_f32 v195, v188, v189
    v_mul_f32 v24, v24, v92
    v_mul_f32 v25, v25, v92
    v_mfma_f32_16x16x32_bf16 v[36:39], a[128:131], v[76:79], v[36:39]
    v_cvt_pk_bf16_f32 v176, v24, v25
    v_lshlrev_b32 v24, 16, v176
    v_and_b32 v25, 0xffff0000, v176
    v_mul_f32 v176, s58, v24
    v_mul_f32 v177, s58, v25
    v_exp_f32 v176, v176
    v_exp_f32 v177, v177
    v_add_f32 v176, 1.0, v176
    ds_read_b128 v[76:79], v9 offset:18432
    s_waitcnt lgkmcnt(4)
    v_mfma_f32_16x16x32_bf16 v[28:31], a[132:135], v[80:83], v[28:31]
    v_add_f32 v177, 1.0, v177
    v_rcp_f32 v176, v176
    v_rcp_f32 v177, v177
    v_mul_f32 v176, v176, v24
    v_mul_f32 v177, v177, v25
    v_cvt_pk_bf16_f32 v196, v176, v177
    v_mul_f32 v26, v26, v92
    v_mul_f32 v27, v27, v92
    v_mfma_f32_16x16x32_bf16 v[32:35], a[136:139], v[80:83], v[32:35]
    v_cvt_pk_bf16_f32 v180, v26, v27
    v_lshlrev_b32 v26, 16, v180
    v_and_b32 v27, 0xffff0000, v180
    v_mul_f32 v180, s58, v26
    v_mul_f32 v181, s58, v27
    v_exp_f32 v180, v180
    v_exp_f32 v181, v181
    v_add_f32 v180, 1.0, v180
    v_mfma_f32_16x16x32_bf16 v[36:39], a[140:143], v[80:83], v[36:39]
    v_add_f32 v181, 1.0, v181
    v_rcp_f32 v180, v180
    v_rcp_f32 v181, v181
    v_mul_f32 v180, v180, v26
    v_mul_f32 v181, v181, v27
    v_cvt_pk_bf16_f32 v197, v180, v181
    s_add_u32 s55, s46, 0
    buffer_store_dwordx4 v[192:195], v8, s[8:11], s55 offen sc1
    ds_write_b64 v7, v[196:197] offset:0
    ds_read_b128 v[80:83], v9 offset:19456
    s_waitcnt lgkmcnt(5)
    v_mfma_f32_16x16x32_bf16 v[40:43], a[84:87], v[64:67], v[40:43]
    v_mfma_f32_16x16x32_bf16 v[44:47], a[88:91], v[64:67], v[44:47]
    v_mfma_f32_16x16x32_bf16 v[48:51], a[92:95], v[64:67], v[48:51]
    ds_read_b128 v[64:67], v9 offset:41984
    s_waitcnt lgkmcnt(5)
    v_mfma_f32_16x16x32_bf16 v[40:43], a[96:99], v[68:71], v[40:43]
    v_mul_f32 v28, v28, v93
    v_mul_f32 v29, v29, v93
    v_cvt_pk_bf16_f32 v176, v28, v29
    v_lshlrev_b32 v28, 16, v176
    v_and_b32 v29, 0xffff0000, v176
    v_mul_f32 v176, s58, v28
    v_mul_f32 v177, s58, v29
    v_exp_f32 v176, v176
    v_exp_f32 v177, v177
    v_mfma_f32_16x16x32_bf16 v[44:47], a[100:103], v[68:71], v[44:47]
    v_add_f32 v176, 1.0, v176
    v_add_f32 v177, 1.0, v177
    v_rcp_f32 v176, v176
    v_rcp_f32 v177, v177
    v_mul_f32 v176, v176, v28
    v_mul_f32 v177, v177, v29
    v_cvt_pk_bf16_f32 v200, v176, v177
    v_mul_f32 v30, v30, v93
    v_mfma_f32_16x16x32_bf16 v[48:51], a[104:107], v[68:71], v[48:51]
    v_mul_f32 v31, v31, v93
    v_cvt_pk_bf16_f32 v180, v30, v31
    v_lshlrev_b32 v30, 16, v180
    v_and_b32 v31, 0xffff0000, v180
    v_mul_f32 v180, s58, v30
    v_mul_f32 v181, s58, v31
    v_exp_f32 v180, v180
    v_exp_f32 v181, v181
    ds_read_b128 v[68:71], v9 offset:43008
    s_waitcnt lgkmcnt(5)
    v_mfma_f32_16x16x32_bf16 v[40:43], a[108:111], v[72:75], v[40:43]
    v_add_f32 v180, 1.0, v180
    v_add_f32 v181, 1.0, v181
    v_rcp_f32 v180, v180
    v_rcp_f32 v181, v181
    v_mul_f32 v180, v180, v30
    v_mul_f32 v181, v181, v31
    v_cvt_pk_bf16_f32 v201, v180, v181
    v_mul_f32 v32, v32, v93
    v_mfma_f32_16x16x32_bf16 v[44:47], a[112:115], v[72:75], v[44:47]
    v_mul_f32 v33, v33, v93
    v_cvt_pk_bf16_f32 v184, v32, v33
    v_lshlrev_b32 v32, 16, v184
    v_and_b32 v33, 0xffff0000, v184
    v_mul_f32 v184, s58, v32
    v_mul_f32 v185, s58, v33
    v_exp_f32 v184, v184
    v_exp_f32 v185, v185
    v_mfma_f32_16x16x32_bf16 v[48:51], a[116:119], v[72:75], v[48:51]
    v_add_f32 v184, 1.0, v184
    v_add_f32 v185, 1.0, v185
    v_rcp_f32 v184, v184
    v_rcp_f32 v185, v185
    v_mul_f32 v184, v184, v32
    v_mul_f32 v185, v185, v33
    v_cvt_pk_bf16_f32 v202, v184, v185
    v_mul_f32 v34, v34, v93
    ds_read_b128 v[72:75], v9 offset:44032
    s_waitcnt lgkmcnt(5)
    v_mfma_f32_16x16x32_bf16 v[40:43], a[120:123], v[76:79], v[40:43]
    v_mul_f32 v35, v35, v93
    v_cvt_pk_bf16_f32 v188, v34, v35
    v_lshlrev_b32 v34, 16, v188
    v_and_b32 v35, 0xffff0000, v188
    v_mul_f32 v188, s58, v34
    v_mul_f32 v189, s58, v35
    v_exp_f32 v188, v188
    v_exp_f32 v189, v189
    v_add_f32 v188, 1.0, v188
    v_mfma_f32_16x16x32_bf16 v[44:47], a[124:127], v[76:79], v[44:47]
    v_add_f32 v189, 1.0, v189
    v_rcp_f32 v188, v188
    v_rcp_f32 v189, v189
    v_mul_f32 v188, v188, v34
    v_mul_f32 v189, v189, v35
    v_cvt_pk_bf16_f32 v203, v188, v189
    v_mul_f32 v36, v36, v93
    v_mul_f32 v37, v37, v93
    v_mfma_f32_16x16x32_bf16 v[48:51], a[128:131], v[76:79], v[48:51]
    v_cvt_pk_bf16_f32 v176, v36, v37
    v_lshlrev_b32 v36, 16, v176
    v_and_b32 v37, 0xffff0000, v176
    v_mul_f32 v176, s58, v36
    v_mul_f32 v177, s58, v37
    v_exp_f32 v176, v176
    v_exp_f32 v177, v177
    v_add_f32 v176, 1.0, v176
    ds_read_b128 v[76:79], v9 offset:45056
    s_waitcnt lgkmcnt(4)
    v_mfma_f32_16x16x32_bf16 v[40:43], a[132:135], v[80:83], v[40:43]
    v_add_f32 v177, 1.0, v177
    v_rcp_f32 v176, v176
    v_rcp_f32 v177, v177
    v_mul_f32 v176, v176, v36
    v_mul_f32 v177, v177, v37
    v_cvt_pk_bf16_f32 v204, v176, v177
    v_mul_f32 v38, v38, v93
    v_mul_f32 v39, v39, v93
    v_mfma_f32_16x16x32_bf16 v[44:47], a[136:139], v[80:83], v[44:47]
    v_cvt_pk_bf16_f32 v180, v38, v39
    v_lshlrev_b32 v38, 16, v180
    v_and_b32 v39, 0xffff0000, v180
    v_mul_f32 v180, s58, v38
    v_mul_f32 v181, s58, v39
    v_exp_f32 v180, v180
    v_exp_f32 v181, v181
    v_add_f32 v180, 1.0, v180
    v_mfma_f32_16x16x32_bf16 v[48:51], a[140:143], v[80:83], v[48:51]
    v_add_f32 v181, 1.0, v181
    v_rcp_f32 v180, v180
    v_rcp_f32 v181, v181
    v_mul_f32 v180, v180, v38
    v_mul_f32 v181, v181, v39
    v_cvt_pk_bf16_f32 v205, v180, v181
    s_add_u32 s55, s46, 49152
    buffer_store_dwordx4 v[200:203], v8, s[8:11], s55 offen sc1
    ds_write_b64 v7, v[204:205] offset:512
    ds_read_b128 v[80:83], v9 offset:46080
    s_waitcnt lgkmcnt(5)
    v_mfma_f32_16x16x32_bf16 v[52:55], a[84:87], v[64:67], v[52:55]
    v_mfma_f32_16x16x32_bf16 v[56:59], a[88:91], v[64:67], v[56:59]
    v_mfma_f32_16x16x32_bf16 v[60:63], a[92:95], v[64:67], v[60:63]
    s_waitcnt lgkmcnt(4)
    v_mfma_f32_16x16x32_bf16 v[52:55], a[96:99], v[68:71], v[52:55]
    v_mul_f32 v40, v40, v94
    v_mul_f32 v41, v41, v94
    v_cvt_pk_bf16_f32 v176, v40, v41
    v_lshlrev_b32 v40, 16, v176
    s_add_u32 s55, s67, 8192
    buffer_load_dwordx4 a[84:87], v8, s[8:11], s55 offen offset:1024
    v_and_b32 v41, 0xffff0000, v176
    v_mul_f32 v176, s58, v40
    v_mul_f32 v177, s58, v41
    v_exp_f32 v176, v176
    v_exp_f32 v177, v177
    v_mfma_f32_16x16x32_bf16 v[56:59], a[100:103], v[68:71], v[56:59]
    v_add_f32 v176, 1.0, v176
    v_add_f32 v177, 1.0, v177
    v_rcp_f32 v176, v176
    s_add_u32 s55, s67, 57344
    buffer_load_dwordx4 a[88:91], v8, s[8:11], s55 offen offset:1024
    v_rcp_f32 v177, v177
    v_mul_f32 v176, v176, v40
    v_mul_f32 v177, v177, v41
    v_cvt_pk_bf16_f32 v208, v176, v177
    v_mul_f32 v42, v42, v94
    v_mfma_f32_16x16x32_bf16 v[60:63], a[104:107], v[68:71], v[60:63]
    v_mul_f32 v43, v43, v94
    v_cvt_pk_bf16_f32 v180, v42, v43
    v_lshlrev_b32 v42, 16, v180
    s_add_u32 s55, s67, 106496
    buffer_load_dwordx4 a[92:95], v8, s[8:11], s55 offen offset:1024
    v_and_b32 v43, 0xffff0000, v180
    v_mul_f32 v180, s58, v42
    v_mul_f32 v181, s58, v43
    v_exp_f32 v180, v180
    v_exp_f32 v181, v181
    s_waitcnt lgkmcnt(3)
    v_mfma_f32_16x16x32_bf16 v[52:55], a[108:111], v[72:75], v[52:55]
    v_add_f32 v180, 1.0, v180
    v_add_f32 v181, 1.0, v181
    v_rcp_f32 v180, v180
    s_add_u32 s55, s67, 155648
    buffer_load_dwordx4 a[96:99], v8, s[8:11], s55 offen offset:1024
    v_rcp_f32 v181, v181
    v_mul_f32 v180, v180, v42
    v_mul_f32 v181, v181, v43
    v_cvt_pk_bf16_f32 v209, v180, v181
    v_mul_f32 v44, v44, v94
    v_mfma_f32_16x16x32_bf16 v[56:59], a[112:115], v[72:75], v[56:59]
    v_mul_f32 v45, v45, v94
    v_cvt_pk_bf16_f32 v184, v44, v45
    v_lshlrev_b32 v44, 16, v184
    s_add_u32 s55, s67, 204800
    buffer_load_dwordx4 a[100:103], v8, s[8:11], s55 offen offset:1024
    v_and_b32 v45, 0xffff0000, v184
    v_mul_f32 v184, s58, v44
    v_mul_f32 v185, s58, v45
    v_exp_f32 v184, v184
    v_exp_f32 v185, v185
    v_mfma_f32_16x16x32_bf16 v[60:63], a[116:119], v[72:75], v[60:63]
    v_add_f32 v184, 1.0, v184
    v_add_f32 v185, 1.0, v185
    v_rcp_f32 v184, v184
    s_add_u32 s55, s67, 8192
    buffer_load_dwordx4 a[104:107], v8, s[8:11], s55 offen offset:2048
    v_rcp_f32 v185, v185
    v_mul_f32 v184, v184, v44
    v_mul_f32 v185, v185, v45
    v_cvt_pk_bf16_f32 v210, v184, v185
    v_mul_f32 v46, v46, v94
    s_waitcnt lgkmcnt(2)
    v_mfma_f32_16x16x32_bf16 v[52:55], a[120:123], v[76:79], v[52:55]
    v_mul_f32 v47, v47, v94
    v_cvt_pk_bf16_f32 v188, v46, v47
    v_lshlrev_b32 v46, 16, v188
    s_add_u32 s55, s67, 57344
    buffer_load_dwordx4 a[108:111], v8, s[8:11], s55 offen offset:2048
    v_and_b32 v47, 0xffff0000, v188
    v_mul_f32 v188, s58, v46
    v_mul_f32 v189, s58, v47
    v_exp_f32 v188, v188
    v_exp_f32 v189, v189
    v_add_f32 v188, 1.0, v188
    v_mfma_f32_16x16x32_bf16 v[56:59], a[124:127], v[76:79], v[56:59]
    v_add_f32 v189, 1.0, v189
    v_rcp_f32 v188, v188
    s_add_u32 s55, s67, 106496
    buffer_load_dwordx4 a[112:115], v8, s[8:11], s55 offen offset:2048
    v_rcp_f32 v189, v189
    v_mul_f32 v188, v188, v46
    v_mul_f32 v189, v189, v47
    v_cvt_pk_bf16_f32 v211, v188, v189
    v_mul_f32 v48, v48, v94
    v_mul_f32 v49, v49, v94
    v_mfma_f32_16x16x32_bf16 v[60:63], a[128:131], v[76:79], v[60:63]
    v_cvt_pk_bf16_f32 v176, v48, v49
    v_lshlrev_b32 v48, 16, v176
    s_add_u32 s55, s67, 155648
    buffer_load_dwordx4 a[116:119], v8, s[8:11], s55 offen offset:2048
    v_and_b32 v49, 0xffff0000, v176
    v_mul_f32 v176, s58, v48
    v_mul_f32 v177, s58, v49
    v_exp_f32 v176, v176
    v_exp_f32 v177, v177
    v_add_f32 v176, 1.0, v176
    s_waitcnt lgkmcnt(0)
    v_mfma_f32_16x16x32_bf16 v[52:55], a[132:135], v[80:83], v[52:55]
    v_add_f32 v177, 1.0, v177
    v_rcp_f32 v176, v176
    s_add_u32 s55, s67, 204800
    buffer_load_dwordx4 a[120:123], v8, s[8:11], s55 offen offset:2048
    v_rcp_f32 v177, v177
    v_mul_f32 v176, v176, v48
    v_mul_f32 v177, v177, v49
    v_cvt_pk_bf16_f32 v212, v176, v177
    v_mul_f32 v50, v50, v94
    v_mul_f32 v51, v51, v94
    v_mfma_f32_16x16x32_bf16 v[56:59], a[136:139], v[80:83], v[56:59]
    v_cvt_pk_bf16_f32 v180, v50, v51
    v_lshlrev_b32 v50, 16, v180
    s_add_u32 s55, s67, 8192
    buffer_load_dwordx4 a[124:127], v8, s[8:11], s55 offen offset:3072
    v_and_b32 v51, 0xffff0000, v180
    v_mul_f32 v180, s58, v50
    v_mul_f32 v181, s58, v51
    v_exp_f32 v180, v180
    v_exp_f32 v181, v181
    v_add_f32 v180, 1.0, v180
    v_mfma_f32_16x16x32_bf16 v[60:63], a[140:143], v[80:83], v[60:63]
    v_add_f32 v181, 1.0, v181
    v_rcp_f32 v180, v180
    s_add_u32 s55, s67, 57344
    buffer_load_dwordx4 a[128:131], v8, s[8:11], s55 offen offset:3072
    v_rcp_f32 v181, v181
    v_mul_f32 v180, v180, v50
    v_mul_f32 v181, v181, v51
    v_cvt_pk_bf16_f32 v213, v180, v181
    s_add_u32 s55, s46, 98304
    buffer_store_dwordx4 v[208:211], v8, s[8:11], s55 offen sc1
    ds_write_b64 v7, v[212:213] offset:1024
    v_mul_f32 v52, v52, v95
    v_mul_f32 v53, v53, v95
    v_cvt_pk_bf16_f32 v176, v52, v53
    v_lshlrev_b32 v52, 16, v176
    v_and_b32 v53, 0xffff0000, v176
    v_mul_f32 v176, s58, v52
    v_mul_f32 v177, s58, v53
    v_exp_f32 v176, v176
    v_exp_f32 v177, v177
    v_add_f32 v176, 1.0, v176
    v_add_f32 v177, 1.0, v177
    v_rcp_f32 v176, v176
    v_rcp_f32 v177, v177
    v_mul_f32 v176, v176, v52
    v_mul_f32 v177, v177, v53
    v_cvt_pk_bf16_f32 v216, v176, v177
    v_mul_f32 v54, v54, v95
    v_mul_f32 v55, v55, v95
    v_cvt_pk_bf16_f32 v180, v54, v55
    v_lshlrev_b32 v54, 16, v180
    v_and_b32 v55, 0xffff0000, v180
    v_mul_f32 v180, s58, v54
    v_mul_f32 v181, s58, v55
    v_exp_f32 v180, v180
    v_exp_f32 v181, v181
    v_add_f32 v180, 1.0, v180
    v_add_f32 v181, 1.0, v181
    v_rcp_f32 v180, v180
    v_rcp_f32 v181, v181
    v_mul_f32 v180, v180, v54
    v_mul_f32 v181, v181, v55
    v_cvt_pk_bf16_f32 v217, v180, v181
    v_mul_f32 v56, v56, v95
    v_mul_f32 v57, v57, v95
    v_cvt_pk_bf16_f32 v184, v56, v57
    v_lshlrev_b32 v56, 16, v184
    v_and_b32 v57, 0xffff0000, v184
    v_mul_f32 v184, s58, v56
    v_mul_f32 v185, s58, v57
    v_exp_f32 v184, v184
    v_exp_f32 v185, v185
    v_add_f32 v184, 1.0, v184
    v_add_f32 v185, 1.0, v185
    v_rcp_f32 v184, v184
    v_rcp_f32 v185, v185
    v_mul_f32 v184, v184, v56
    v_mul_f32 v185, v185, v57
    v_cvt_pk_bf16_f32 v218, v184, v185
    v_mul_f32 v58, v58, v95
    v_mul_f32 v59, v59, v95
    v_cvt_pk_bf16_f32 v188, v58, v59
    v_lshlrev_b32 v58, 16, v188
    v_and_b32 v59, 0xffff0000, v188
    v_mul_f32 v188, s58, v58
    v_mul_f32 v189, s58, v59
    v_exp_f32 v188, v188
    v_exp_f32 v189, v189
    v_add_f32 v188, 1.0, v188
    v_add_f32 v189, 1.0, v189
    v_rcp_f32 v188, v188
    v_rcp_f32 v189, v189
    v_mul_f32 v188, v188, v58
    v_mul_f32 v189, v189, v59
    v_cvt_pk_bf16_f32 v219, v188, v189
    v_mul_f32 v60, v60, v95
    v_mul_f32 v61, v61, v95
    v_cvt_pk_bf16_f32 v176, v60, v61
    v_lshlrev_b32 v60, 16, v176
    v_and_b32 v61, 0xffff0000, v176
    v_mul_f32 v176, s58, v60
    v_mul_f32 v177, s58, v61
    v_exp_f32 v176, v176
    v_exp_f32 v177, v177
    v_add_f32 v176, 1.0, v176
    v_add_f32 v177, 1.0, v177
    v_rcp_f32 v176, v176
    v_rcp_f32 v177, v177
    v_mul_f32 v176, v176, v60
    v_mul_f32 v177, v177, v61
    v_cvt_pk_bf16_f32 v220, v176, v177
    v_mul_f32 v62, v62, v95
    v_mul_f32 v63, v63, v95
    v_cvt_pk_bf16_f32 v180, v62, v63
    v_lshlrev_b32 v62, 16, v180
    v_and_b32 v63, 0xffff0000, v180
    v_mul_f32 v180, s58, v62
    v_mul_f32 v181, s58, v63
    v_exp_f32 v180, v180
    v_exp_f32 v181, v181
    v_add_f32 v180, 1.0, v180
    v_add_f32 v181, 1.0, v181
    v_rcp_f32 v180, v180
    v_rcp_f32 v181, v181
    v_mul_f32 v180, v180, v62
    v_mul_f32 v181, v181, v63
    v_cvt_pk_bf16_f32 v221, v180, v181
    s_add_u32 s55, s46, 147456
    buffer_store_dwordx4 v[216:219], v8, s[8:11], s55 offen sc1
    ds_write_b64 v7, v[220:221] offset:1536
    s_waitcnt lgkmcnt(0)
    s_barrier
    v_xor_b32 v7, 2048, v7
    ds_read_b64 v[198:199], v7 offset:0
    ds_read_b64 v[206:207], v7 offset:512
    ds_read_b64 v[214:215], v7 offset:1024
    ds_read_b64 v[222:223], v7 offset:1536
    s_cmp_eq_u32 s53, 0
    s_cselect_b64 exec, -1, 0
    s_add_u32 s55, s48, 0
    s_waitcnt lgkmcnt(3)
    buffer_store_dwordx4 v[196:199], v8, s[8:11], s55 offen sc1
    s_add_u32 s55, s48, 49152
    s_waitcnt lgkmcnt(2)
    buffer_store_dwordx4 v[204:207], v8, s[8:11], s55 offen sc1
    s_add_u32 s55, s48, 98304
    s_waitcnt lgkmcnt(1)
    buffer_store_dwordx4 v[212:215], v8, s[8:11], s55 offen sc1
    s_add_u32 s55, s48, 147456
    s_waitcnt lgkmcnt(0)
    buffer_store_dwordx4 v[220:223], v8, s[8:11], s55 offen sc1
    s_mov_b64 exec, -1
    s_add_u32 s55, s67, 106496
    buffer_load_dwordx4 a[132:135], v8, s[8:11], s55 offen offset:3072
    s_add_u32 s55, s67, 155648
    buffer_load_dwordx4 a[136:139], v8, s[8:11], s55 offen offset:3072
    s_add_u32 s55, s67, 204800
    buffer_load_dwordx4 a[140:143], v8, s[8:11], s55 offen offset:3072
    s_waitcnt vmcnt(3)
    s_barrier
    s_lshl_b32 s49, s40, 8
    s_add_u32 s49, s49, 12713984
    v_mov_b32 v5, s49
    v_mov_b32 v4, 1
    s_cmp_eq_u32 s44, 0
    s_cbranch_scc0 L_g12a_go
    s_mov_b64 exec, 1
    buffer_atomic_add v4, v5, s[8:11], 0 offen
    s_mov_b32 s49, 0
L_g12a_poll:
    s_sleep 2
    buffer_load_dword v4, v5, s[8:11], 0 offen sc1
    s_waitcnt vmcnt(0)
    v_readfirstlane_b32 s50, v4
    s_add_u32 s49, s49, 1
    s_cmp_ge_u32 s50, 8
    s_cbranch_scc1 L_g12a_go0
    s_cmp_lt_u32 s49, 0x80000
    s_cbranch_scc1 L_g12a_poll
L_g12a_go0:
    s_mov_b64 exec, -1
    s_nop 15
L_g12a_go:
    s_barrier
    s_mul_i32 s47, s40, 196608
    s_mul_i32 s49, s44, 12288
    s_add_u32 s47, s47, s49
    s_add_u32 s47, s47, s66
    s_add_u32 s55, s47, 0
    buffer_load_dwordx4 v[96:99], v8, s[8:11], s55 offen offset:0 sc1
    s_add_u32 s55, s47, 0
    buffer_load_dwordx4 v[100:103], v8, s[8:11], s55 offen offset:1024 sc1
    s_add_u32 s55, s47, 0
    buffer_load_dwordx4 v[104:107], v8, s[8:11], s55 offen offset:2048 sc1
    s_add_u32 s55, s47, 0
    buffer_load_dwordx4 v[108:111], v8, s[8:11], s55 offen offset:3072 sc1
    s_add_u32 s55, s47, 4096
    buffer_load_dwordx4 v[112:115], v8, s[8:11], s55 offen offset:0 sc1
    s_add_u32 s55, s47, 4096
    buffer_load_dwordx4 v[116:119], v8, s[8:11], s55 offen offset:1024 sc1
    s_add_u32 s55, s47, 4096
    buffer_load_dwordx4 v[120:123], v8, s[8:11], s55 offen offset:2048 sc1
    s_add_u32 s55, s47, 4096
    buffer_load_dwordx4 v[124:127], v8, s[8:11], s55 offen offset:3072 sc1
    s_add_u32 s55, s47, 8192
    buffer_load_dwordx4 v[128:131], v8, s[8:11], s55 offen offset:0 sc1
    s_add_u32 s55, s47, 8192
    buffer_load_dwordx4 v[132:135], v8, s[8:11], s55 offen offset:1024 sc1
    s_add_u32 s55, s47, 8192
    buffer_load_dwordx4 v[136:139], v8, s[8:11], s55 offen offset:2048 sc1
    s_add_u32 s55, s47, 8192
    buffer_load_dwordx4 v[140:143], v8, s[8:11], s55 offen offset:3072 sc1
    s_add_u32 s55, s47, 49152
    buffer_load_dwordx4 v[144:147], v8, s[8:11], s55 offen offset:0 sc1
    s_add_u32 s55, s47, 49152
    buffer_load_dwordx4 v[148:151], v8, s[8:11], s55 offen offset:1024 sc1
    s_add_u32 s55, s47, 49152
    buffer_load_dwordx4 v[152:155], v8, s[8:11], s55 offen offset:2048 sc1
    s_add_u32 s55, s47, 49152
    buffer_load_dwordx4 v[156:159], v8, s[8:11], s55 offen offset:3072 sc1
    s_add_u32 s55, s47, 53248
    buffer_load_dwordx4 v[160:163], v8, s[8:11], s55 offen offset:0 sc1
    s_add_u32 s55, s47, 53248
    buffer_load_dwordx4 v[164:167], v8, s[8:11], s55 offen offset:1024 sc1
    s_add_u32 s55, s47, 53248
    buffer_load_dwordx4 v[168:171], v8, s[8:11], s55 offen offset:2048 sc1
    s_add_u32 s55, s47, 53248
    buffer_load_dwordx4 v[172:175], v8, s[8:11], s55 offen offset:3072 sc1
    s_add_u32 s55, s47, 57344
    buffer_load_dwordx4 v[176:179], v8, s[8:11], s55 offen offset:0 sc1
    s_add_u32 s55, s47, 57344
    buffer_load_dwordx4 v[180:183], v8, s[8:11], s55 offen offset:1024 sc1
    s_add_u32 s55, s47, 57344
    buffer_load_dwordx4 v[184:187], v8, s[8:11], s55 offen offset:2048 sc1
    s_add_u32 s55, s47, 57344
    buffer_load_dwordx4 v[188:191], v8, s[8:11], s55 offen offset:3072 sc1
    s_add_u32 s55, s47, 98304
    buffer_load_dwordx4 v[192:195], v8, s[8:11], s55 offen offset:0 sc1
    s_add_u32 s55, s47, 98304
    buffer_load_dwordx4 v[196:199], v8, s[8:11], s55 offen offset:1024 sc1
    s_add_u32 s55, s47, 98304
    buffer_load_dwordx4 v[200:203], v8, s[8:11], s55 offen offset:2048 sc1
    s_add_u32 s55, s47, 98304
    buffer_load_dwordx4 v[204:207], v8, s[8:11], s55 offen offset:3072 sc1
    s_add_u32 s55, s47, 102400
    buffer_load_dwordx4 v[208:211], v8, s[8:11], s55 offen offset:0 sc1
    s_add_u32 s55, s47, 102400
    buffer_load_dwordx4 v[212:215], v8, s[8:11], s55 offen offset:1024 sc1
    s_add_u32 s55, s47, 102400
    buffer_load_dwordx4 v[216:219], v8, s[8:11], s55 offen offset:2048 sc1
    s_add_u32 s55, s47, 102400
    buffer_load_dwordx4 v[220:223], v8, s[8:11], s55 offen offset:3072 sc1
    s_add_u32 s55, s47, 106496
    buffer_load_dwordx4 v[224:227], v8, s[8:11], s55 offen offset:0 sc1
    s_add_u32 s55, s47, 106496
    buffer_load_dwordx4 v[228:231], v8, s[8:11], s55 offen offset:1024 sc1
    s_add_u32 s55, s47, 106496
    buffer_load_dwordx4 v[232:235], v8, s[8:11], s55 offen offset:2048 sc1
    s_add_u32 s55, s47, 106496
    buffer_load_dwordx4 v[236:239], v8, s[8:11], s55 offen offset:3072 sc1
    s_add_u32 s55, s47, 147456
    buffer_load_dwordx4 v[240:243], v8, s[8:11], s55 offen offset:0 sc1
    s_add_u32 s55, s47, 147456
    buffer_load_dwordx4 v[244:247], v8, s[8:11], s55 offen offset:1024 sc1
    s_add_u32 s55, s47, 147456
    buffer_load_dwordx4 v[248:251], v8, s[8:11], s55 offen offset:2048 sc1
    s_add_u32 s55, s47, 147456
    buffer_load_dwordx4 v[252:255], v8, s[8:11], s55 offen offset:3072 sc1
    s_lshl_b32 s48, s40, 6
    s_lshl_b32 s46, s44, 4
    s_add_u32 s48, s48, s46
    v_add_u32 v5, s48, v2
    s_mov_b32 s48, 1280
    v_mul_lo_u32 v6, v5, s48
    v_lshl_add_u32 v6, v3, 3, v6
    s_mul_i32 s49, s41, 160
    v_add_u32 v6, s49, v6
    s_mul_i32 s46, s44, 20480
    v_add_u32 v9, s46, v8
    s_waitcnt vmcnt(39)
    v_mfma_f32_16x16x32_bf16 v[16:19], a[160:163], v[96:99], 0
    v_mfma_f32_16x16x32_bf16 v[20:23], a[164:167], v[96:99], 0
    v_mfma_f32_16x16x32_bf16 v[24:27], a[168:171], v[96:99], 0
    v_mfma_f32_16x16x32_bf16 v[28:31], a[172:175], v[96:99], 0
    v_mfma_f32_16x16x32_bf16 v[32:35], a[176:179], v[96:99], 0
    s_add_u32 s55, s47, 151552
    buffer_load_dwordx4 v[96:99], v8, s[8:11], s55 offen offset:0 sc1
    s_waitcnt vmcnt(39)
    v_mfma_f32_16x16x32_bf16 v[16:19], a[180:183], v[100:103], v[16:19]
    v_mfma_f32_16x16x32_bf16 v[20:23], a[184:187], v[100:103], v[20:23]
    v_mfma_f32_16x16x32_bf16 v[24:27], a[188:191], v[100:103], v[24:27]
    v_mfma_f32_16x16x32_bf16 v[28:31], a[192:195], v[100:103], v[28:31]
    v_mfma_f32_16x16x32_bf16 v[32:35], a[196:199], v[100:103], v[32:35]
    s_add_u32 s55, s47, 151552
    buffer_load_dwordx4 v[100:103], v8, s[8:11], s55 offen offset:1024 sc1
    s_waitcnt vmcnt(39)
    v_mfma_f32_16x16x32_bf16 v[16:19], a[200:203], v[104:107], v[16:19]
    v_mfma_f32_16x16x32_bf16 v[20:23], a[204:207], v[104:107], v[20:23]
    v_mfma_f32_16x16x32_bf16 v[24:27], a[208:211], v[104:107], v[24:27]
    v_mfma_f32_16x16x32_bf16 v[28:31], a[212:215], v[104:107], v[28:31]
    v_mfma_f32_16x16x32_bf16 v[32:35], a[216:219], v[104:107], v[32:35]
    s_add_u32 s55, s47, 151552
    buffer_load_dwordx4 v[104:107], v8, s[8:11], s55 offen offset:2048 sc1
    s_waitcnt vmcnt(39)
    v_mfma_f32_16x16x32_bf16 v[16:19], a[220:223], v[108:111], v[16:19]
    v_mfma_f32_16x16x32_bf16 v[20:23], a[224:227], v[108:111], v[20:23]
    v_mfma_f32_16x16x32_bf16 v[24:27], a[228:231], v[108:111], v[24:27]
    v_mfma_f32_16x16x32_bf16 v[28:31], a[232:235], v[108:111], v[28:31]
    v_mfma_f32_16x16x32_bf16 v[32:35], a[236:239], v[108:111], v[32:35]
    s_add_u32 s55, s47, 151552
    buffer_load_dwordx4 v[108:111], v8, s[8:11], s55 offen offset:3072 sc1
    s_waitcnt vmcnt(39)
    v_mfma_f32_16x16x32_bf16 v[16:19], a[240:243], v[112:115], v[16:19]
    v_mfma_f32_16x16x32_bf16 v[20:23], a[244:247], v[112:115], v[20:23]
    v_mfma_f32_16x16x32_bf16 v[24:27], a[248:251], v[112:115], v[24:27]
    v_mfma_f32_16x16x32_bf16 v[28:31], a[252:255], v[112:115], v[28:31]
    v_mfma_f32_16x16x32_bf16 v[32:35], a[0:3], v[112:115], v[32:35]
    s_add_u32 s55, s47, 155648
    buffer_load_dwordx4 v[112:115], v8, s[8:11], s55 offen offset:0 sc1
    s_waitcnt vmcnt(39)
    v_mfma_f32_16x16x32_bf16 v[16:19], a[4:7], v[116:119], v[16:19]
    v_mfma_f32_16x16x32_bf16 v[20:23], a[8:11], v[116:119], v[20:23]
    v_mfma_f32_16x16x32_bf16 v[24:27], a[12:15], v[116:119], v[24:27]
    v_mfma_f32_16x16x32_bf16 v[28:31], a[16:19], v[116:119], v[28:31]
    v_mfma_f32_16x16x32_bf16 v[32:35], a[20:23], v[116:119], v[32:35]
    s_add_u32 s55, s47, 155648
    buffer_load_dwordx4 v[116:119], v8, s[8:11], s55 offen offset:1024 sc1
    s_waitcnt vmcnt(39)
    v_mfma_f32_16x16x32_bf16 v[16:19], a[24:27], v[120:123], v[16:19]
    v_mfma_f32_16x16x32_bf16 v[20:23], a[28:31], v[120:123], v[20:23]
    v_mfma_f32_16x16x32_bf16 v[24:27], a[32:35], v[120:123], v[24:27]
    v_mfma_f32_16x16x32_bf16 v[28:31], a[36:39], v[120:123], v[28:31]
    v_mfma_f32_16x16x32_bf16 v[32:35], a[40:43], v[120:123], v[32:35]
    s_add_u32 s55, s47, 155648
    buffer_load_dwordx4 v[120:123], v8, s[8:11], s55 offen offset:2048 sc1
    s_waitcnt vmcnt(39)
    v_mfma_f32_16x16x32_bf16 v[16:19], a[44:47], v[124:127], v[16:19]
    v_mfma_f32_16x16x32_bf16 v[20:23], a[48:51], v[124:127], v[20:23]
    v_mfma_f32_16x16x32_bf16 v[24:27], a[52:55], v[124:127], v[24:27]
    v_mfma_f32_16x16x32_bf16 v[28:31], a[56:59], v[124:127], v[28:31]
    v_mfma_f32_16x16x32_bf16 v[32:35], a[60:63], v[124:127], v[32:35]
    s_add_u32 s55, s47, 155648
    buffer_load_dwordx4 v[124:127], v8, s[8:11], s55 offen offset:3072 sc1
    s_waitcnt vmcnt(39)
    v_mfma_f32_16x16x32_bf16 v[16:19], a[64:67], v[128:131], v[16:19]
    v_mfma_f32_16x16x32_bf16 v[20:23], a[68:71], v[128:131], v[20:23]
    v_mfma_f32_16x16x32_bf16 v[24:27], a[72:75], v[128:131], v[24:27]
    v_mfma_f32_16x16x32_bf16 v[28:31], a[76:79], v[128:131], v[28:31]
    v_mfma_f32_16x16x32_bf16 v[32:35], a[80:83], v[128:131], v[32:35]
    s_waitcnt vmcnt(38)
    v_mfma_f32_16x16x32_bf16 v[16:19], a[84:87], v[132:135], v[16:19]
    v_mfma_f32_16x16x32_bf16 v[20:23], a[88:91], v[132:135], v[20:23]
    v_mfma_f32_16x16x32_bf16 v[24:27], a[92:95], v[132:135], v[24:27]
    v_mfma_f32_16x16x32_bf16 v[28:31], a[96:99], v[132:135], v[28:31]
    v_mfma_f32_16x16x32_bf16 v[32:35], a[100:103], v[132:135], v[32:35]
    s_waitcnt vmcnt(37)
    v_mfma_f32_16x16x32_bf16 v[16:19], a[104:107], v[136:139], v[16:19]
    v_mfma_f32_16x16x32_bf16 v[20:23], a[108:111], v[136:139], v[20:23]
    v_mfma_f32_16x16x32_bf16 v[24:27], a[112:115], v[136:139], v[24:27]
    v_mfma_f32_16x16x32_bf16 v[28:31], a[116:119], v[136:139], v[28:31]
    v_mfma_f32_16x16x32_bf16 v[32:35], a[120:123], v[136:139], v[32:35]
    s_waitcnt vmcnt(36)
    v_mfma_f32_16x16x32_bf16 v[16:19], a[124:127], v[140:143], v[16:19]
    v_mfma_f32_16x16x32_bf16 v[20:23], a[128:131], v[140:143], v[20:23]
    v_mfma_f32_16x16x32_bf16 v[24:27], a[132:135], v[140:143], v[24:27]
    v_mfma_f32_16x16x32_bf16 v[28:31], a[136:139], v[140:143], v[28:31]
    v_mfma_f32_16x16x32_bf16 v[32:35], a[140:143], v[140:143], v[32:35]
    s_waitcnt vmcnt(35)
    v_mfma_f32_16x16x32_bf16 v[36:39], a[160:163], v[144:147], 0
    v_mfma_f32_16x16x32_bf16 v[40:43], a[164:167], v[144:147], 0
    v_mfma_f32_16x16x32_bf16 v[44:47], a[168:171], v[144:147], 0
    v_mfma_f32_16x16x32_bf16 v[48:51], a[172:175], v[144:147], 0
    v_mfma_f32_16x16x32_bf16 v[52:55], a[176:179], v[144:147], 0
    s_waitcnt vmcnt(34)
    v_mfma_f32_16x16x32_bf16 v[36:39], a[180:183], v[148:151], v[36:39]
    v_mfma_f32_16x16x32_bf16 v[40:43], a[184:187], v[148:151], v[40:43]
    v_mfma_f32_16x16x32_bf16 v[44:47], a[188:191], v[148:151], v[44:47]
    v_mfma_f32_16x16x32_bf16 v[48:51], a[192:195], v[148:151], v[48:51]
    v_mfma_f32_16x16x32_bf16 v[52:55], a[196:199], v[148:151], v[52:55]
    s_waitcnt vmcnt(33)
    v_mfma_f32_16x16x32_bf16 v[36:39], a[200:203], v[152:155], v[36:39]
    v_mfma_f32_16x16x32_bf16 v[40:43], a[204:207], v[152:155], v[40:43]
    v_mfma_f32_16x16x32_bf16 v[44:47], a[208:211], v[152:155], v[44:47]
    v_mfma_f32_16x16x32_bf16 v[48:51], a[212:215], v[152:155], v[48:51]
    v_mfma_f32_16x16x32_bf16 v[52:55], a[216:219], v[152:155], v[52:55]
    ds_write_b128 v9, v[16:19] offset:0
    s_waitcnt vmcnt(32)
    v_mfma_f32_16x16x32_bf16 v[36:39], a[220:223], v[156:159], v[36:39]
    v_mfma_f32_16x16x32_bf16 v[40:43], a[224:227], v[156:159], v[40:43]
    v_mfma_f32_16x16x32_bf16 v[44:47], a[228:231], v[156:159], v[44:47]
    v_mfma_f32_16x16x32_bf16 v[48:51], a[232:235], v[156:159], v[48:51]
    v_mfma_f32_16x16x32_bf16 v[52:55], a[236:239], v[156:159], v[52:55]
    ds_write_b128 v9, v[20:23] offset:1024
    s_waitcnt vmcnt(31)
    v_mfma_f32_16x16x32_bf16 v[36:39], a[240:243], v[160:163], v[36:39]
    v_mfma_f32_16x16x32_bf16 v[40:43], a[244:247], v[160:163], v[40:43]
    v_mfma_f32_16x16x32_bf16 v[44:47], a[248:251], v[160:163], v[44:47]
    v_mfma_f32_16x16x32_bf16 v[48:51], a[252:255], v[160:163], v[48:51]
    v_mfma_f32_16x16x32_bf16 v[52:55], a[0:3], v[160:163], v[52:55]
    ds_write_b128 v9, v[24:27] offset:2048
    s_waitcnt vmcnt(30)
    v_mfma_f32_16x16x32_bf16 v[36:39], a[4:7], v[164:167], v[36:39]
    v_mfma_f32_16x16x32_bf16 v[40:43], a[8:11], v[164:167], v[40:43]
    v_mfma_f32_16x16x32_bf16 v[44:47], a[12:15], v[164:167], v[44:47]
    v_mfma_f32_16x16x32_bf16 v[48:51], a[16:19], v[164:167], v[48:51]
    v_mfma_f32_16x16x32_bf16 v[52:55], a[20:23], v[164:167], v[52:55]
    ds_write_b128 v9, v[28:31] offset:3072
    s_waitcnt vmcnt(29)
    v_mfma_f32_16x16x32_bf16 v[36:39], a[24:27], v[168:171], v[36:39]
    v_mfma_f32_16x16x32_bf16 v[40:43], a[28:31], v[168:171], v[40:43]
    v_mfma_f32_16x16x32_bf16 v[44:47], a[32:35], v[168:171], v[44:47]
    v_mfma_f32_16x16x32_bf16 v[48:51], a[36:39], v[168:171], v[48:51]
    v_mfma_f32_16x16x32_bf16 v[52:55], a[40:43], v[168:171], v[52:55]
    ds_write_b128 v9, v[32:35] offset:4096
    s_waitcnt vmcnt(28)
    v_mfma_f32_16x16x32_bf16 v[36:39], a[44:47], v[172:175], v[36:39]
    v_mfma_f32_16x16x32_bf16 v[40:43], a[48:51], v[172:175], v[40:43]
    v_mfma_f32_16x16x32_bf16 v[44:47], a[52:55], v[172:175], v[44:47]
    v_mfma_f32_16x16x32_bf16 v[48:51], a[56:59], v[172:175], v[48:51]
    v_mfma_f32_16x16x32_bf16 v[52:55], a[60:63], v[172:175], v[52:55]
    s_waitcnt vmcnt(27)
    v_mfma_f32_16x16x32_bf16 v[36:39], a[64:67], v[176:179], v[36:39]
    v_mfma_f32_16x16x32_bf16 v[40:43], a[68:71], v[176:179], v[40:43]
    v_mfma_f32_16x16x32_bf16 v[44:47], a[72:75], v[176:179], v[44:47]
    v_mfma_f32_16x16x32_bf16 v[48:51], a[76:79], v[176:179], v[48:51]
    v_mfma_f32_16x16x32_bf16 v[52:55], a[80:83], v[176:179], v[52:55]
    s_waitcnt vmcnt(26)
    v_mfma_f32_16x16x32_bf16 v[36:39], a[84:87], v[180:183], v[36:39]
    v_mfma_f32_16x16x32_bf16 v[40:43], a[88:91], v[180:183], v[40:43]
    v_mfma_f32_16x16x32_bf16 v[44:47], a[92:95], v[180:183], v[44:47]
    v_mfma_f32_16x16x32_bf16 v[48:51], a[96:99], v[180:183], v[48:51]
    v_mfma_f32_16x16x32_bf16 v[52:55], a[100:103], v[180:183], v[52:55]
    s_waitcnt vmcnt(25)
    v_mfma_f32_16x16x32_bf16 v[36:39], a[104:107], v[184:187], v[36:39]
    v_mfma_f32_16x16x32_bf16 v[40:43], a[108:111], v[184:187], v[40:43]
    v_mfma_f32_16x16x32_bf16 v[44:47], a[112:115], v[184:187], v[44:47]
    v_mfma_f32_16x16x32_bf16 v[48:51], a[116:119], v[184:187], v[48:51]
    v_mfma_f32_16x16x32_bf16 v[52:55], a[120:123], v[184:187], v[52:55]
    s_waitcnt vmcnt(24)
    v_mfma_f32_16x16x32_bf16 v[36:39], a[124:127], v[188:191], v[36:39]
    v_mfma_f32_16x16x32_bf16 v[40:43], a[128:131], v[188:191], v[40:43]
    v_mfma_f32_16x16x32_bf16 v[44:47], a[132:135], v[188:191], v[44:47]
    v_mfma_f32_16x16x32_bf16 v[48:51], a[136:139], v[188:191], v[48:51]
    v_mfma_f32_16x16x32_bf16 v[52:55], a[140:143], v[188:191], v[52:55]
    s_waitcnt vmcnt(23)
    v_mfma_f32_16x16x32_bf16 v[56:59], a[160:163], v[192:195], 0
    v_mfma_f32_16x16x32_bf16 v[60:63], a[164:167], v[192:195], 0
    v_mfma_f32_16x16x32_bf16 v[64:67], a[168:171], v[192:195], 0
    v_mfma_f32_16x16x32_bf16 v[68:71], a[172:175], v[192:195], 0
    v_mfma_f32_16x16x32_bf16 v[72:75], a[176:179], v[192:195], 0
    s_waitcnt vmcnt(22)
    v_mfma_f32_16x16x32_bf16 v[56:59], a[180:183], v[196:199], v[56:59]
    v_mfma_f32_16x16x32_bf16 v[60:63], a[184:187], v[196:199], v[60:63]
    v_mfma_f32_16x16x32_bf16 v[64:67], a[188:191], v[196:199], v[64:67]
    v_mfma_f32_16x16x32_bf16 v[68:71], a[192:195], v[196:199], v[68:71]
    v_mfma_f32_16x16x32_bf16 v[72:75], a[196:199], v[196:199], v[72:75]
    s_waitcnt vmcnt(21)
    v_mfma_f32_16x16x32_bf16 v[56:59], a[200:203], v[200:203], v[56:59]
    v_mfma_f32_16x16x32_bf16 v[60:63], a[204:207], v[200:203], v[60:63]
    v_mfma_f32_16x16x32_bf16 v[64:67], a[208:211], v[200:203], v[64:67]
    v_mfma_f32_16x16x32_bf16 v[68:71], a[212:215], v[200:203], v[68:71]
    v_mfma_f32_16x16x32_bf16 v[72:75], a[216:219], v[200:203], v[72:75]
    ds_write_b128 v9, v[36:39] offset:5120
    s_waitcnt vmcnt(20)
    v_mfma_f32_16x16x32_bf16 v[56:59], a[220:223], v[204:207], v[56:59]
    v_mfma_f32_16x16x32_bf16 v[60:63], a[224:227], v[204:207], v[60:63]
    v_mfma_f32_16x16x32_bf16 v[64:67], a[228:231], v[204:207], v[64:67]
    v_mfma_f32_16x16x32_bf16 v[68:71], a[232:235], v[204:207], v[68:71]
    v_mfma_f32_16x16x32_bf16 v[72:75], a[236:239], v[204:207], v[72:75]
    ds_write_b128 v9, v[40:43] offset:6144
    s_waitcnt vmcnt(19)
    v_mfma_f32_16x16x32_bf16 v[56:59], a[240:243], v[208:211], v[56:59]
    v_mfma_f32_16x16x32_bf16 v[60:63], a[244:247], v[208:211], v[60:63]
    v_mfma_f32_16x16x32_bf16 v[64:67], a[248:251], v[208:211], v[64:67]
    v_mfma_f32_16x16x32_bf16 v[68:71], a[252:255], v[208:211], v[68:71]
    v_mfma_f32_16x16x32_bf16 v[72:75], a[0:3], v[208:211], v[72:75]
    ds_write_b128 v9, v[44:47] offset:7168
    s_waitcnt vmcnt(18)
    v_mfma_f32_16x16x32_bf16 v[56:59], a[4:7], v[212:215], v[56:59]
    v_mfma_f32_16x16x32_bf16 v[60:63], a[8:11], v[212:215], v[60:63]
    v_mfma_f32_16x16x32_bf16 v[64:67], a[12:15], v[212:215], v[64:67]
    v_mfma_f32_16x16x32_bf16 v[68:71], a[16:19], v[212:215], v[68:71]
    v_mfma_f32_16x16x32_bf16 v[72:75], a[20:23], v[212:215], v[72:75]
    ds_write_b128 v9, v[48:51] offset:8192
    s_waitcnt vmcnt(17)
    v_mfma_f32_16x16x32_bf16 v[56:59], a[24:27], v[216:219], v[56:59]
    v_mfma_f32_16x16x32_bf16 v[60:63], a[28:31], v[216:219], v[60:63]
    v_mfma_f32_16x16x32_bf16 v[64:67], a[32:35], v[216:219], v[64:67]
    v_mfma_f32_16x16x32_bf16 v[68:71], a[36:39], v[216:219], v[68:71]
    v_mfma_f32_16x16x32_bf16 v[72:75], a[40:43], v[216:219], v[72:75]
    ds_write_b128 v9, v[52:55] offset:9216
    s_waitcnt vmcnt(16)
    v_mfma_f32_16x16x32_bf16 v[56:59], a[44:47], v[220:223], v[56:59]
    v_mfma_f32_16x16x32_bf16 v[60:63], a[48:51], v[220:223], v[60:63]
    v_mfma_f32_16x16x32_bf16 v[64:67], a[52:55], v[220:223], v[64:67]
    v_mfma_f32_16x16x32_bf16 v[68:71], a[56:59], v[220:223], v[68:71]
    v_mfma_f32_16x16x32_bf16 v[72:75], a[60:63], v[220:223], v[72:75]
    s_waitcnt vmcnt(15)
    v_mfma_f32_16x16x32_bf16 v[56:59], a[64:67], v[224:227], v[56:59]
    v_mfma_f32_16x16x32_bf16 v[60:63], a[68:71], v[224:227], v[60:63]
    v_mfma_f32_16x16x32_bf16 v[64:67], a[72:75], v[224:227], v[64:67]
    v_mfma_f32_16x16x32_bf16 v[68:71], a[76:79], v[224:227], v[68:71]
    v_mfma_f32_16x16x32_bf16 v[72:75], a[80:83], v[224:227], v[72:75]
    s_waitcnt vmcnt(14)
    v_mfma_f32_16x16x32_bf16 v[56:59], a[84:87], v[228:231], v[56:59]
    v_mfma_f32_16x16x32_bf16 v[60:63], a[88:91], v[228:231], v[60:63]
    v_mfma_f32_16x16x32_bf16 v[64:67], a[92:95], v[228:231], v[64:67]
    v_mfma_f32_16x16x32_bf16 v[68:71], a[96:99], v[228:231], v[68:71]
    v_mfma_f32_16x16x32_bf16 v[72:75], a[100:103], v[228:231], v[72:75]
    s_waitcnt vmcnt(13)
    v_mfma_f32_16x16x32_bf16 v[56:59], a[104:107], v[232:235], v[56:59]
    v_mfma_f32_16x16x32_bf16 v[60:63], a[108:111], v[232:235], v[60:63]
    v_mfma_f32_16x16x32_bf16 v[64:67], a[112:115], v[232:235], v[64:67]
    v_mfma_f32_16x16x32_bf16 v[68:71], a[116:119], v[232:235], v[68:71]
    v_mfma_f32_16x16x32_bf16 v[72:75], a[120:123], v[232:235], v[72:75]
    s_waitcnt vmcnt(12)
    v_mfma_f32_16x16x32_bf16 v[56:59], a[124:127], v[236:239], v[56:59]
    v_mfma_f32_16x16x32_bf16 v[60:63], a[128:131], v[236:239], v[60:63]
    v_mfma_f32_16x16x32_bf16 v[64:67], a[132:135], v[236:239], v[64:67]
    v_mfma_f32_16x16x32_bf16 v[68:71], a[136:139], v[236:239], v[68:71]
    v_mfma_f32_16x16x32_bf16 v[72:75], a[140:143], v[236:239], v[72:75]
    s_waitcnt vmcnt(11)
    v_mfma_f32_16x16x32_bf16 v[76:79], a[160:163], v[240:243], 0
    v_mfma_f32_16x16x32_bf16 v[80:83], a[164:167], v[240:243], 0
    v_mfma_f32_16x16x32_bf16 v[84:87], a[168:171], v[240:243], 0
    v_mfma_f32_16x16x32_bf16 v[88:91], a[172:175], v[240:243], 0
    v_mfma_f32_16x16x32_bf16 v[92:95], a[176:179], v[240:243], 0
    s_waitcnt vmcnt(10)
    v_mfma_f32_16x16x32_bf16 v[76:79], a[180:183], v[244:247], v[76:79]
    v_mfma_f32_16x16x32_bf16 v[80:83], a[184:187], v[244:247], v[80:83]
    v_mfma_f32_16x16x32_bf16 v[84:87], a[188:191], v[244:247], v[84:87]
    v_mfma_f32_16x16x32_bf16 v[88:91], a[192:195], v[244:247], v[88:91]
    v_mfma_f32_16x16x32_bf16 v[92:95], a[196:199], v[244:247], v[92:95]
    s_waitcnt vmcnt(9)
    v_mfma_f32_16x16x32_bf16 v[76:79], a[200:203], v[248:251], v[76:79]
    v_mfma_f32_16x16x32_bf16 v[80:83], a[204:207], v[248:251], v[80:83]
    v_mfma_f32_16x16x32_bf16 v[84:87], a[208:211], v[248:251], v[84:87]
    v_mfma_f32_16x16x32_bf16 v[88:91], a[212:215], v[248:251], v[88:91]
    v_mfma_f32_16x16x32_bf16 v[92:95], a[216:219], v[248:251], v[92:95]
    ds_write_b128 v9, v[56:59] offset:10240
    s_waitcnt vmcnt(8)
    v_mfma_f32_16x16x32_bf16 v[76:79], a[220:223], v[252:255], v[76:79]
    v_mfma_f32_16x16x32_bf16 v[80:83], a[224:227], v[252:255], v[80:83]
    v_mfma_f32_16x16x32_bf16 v[84:87], a[228:231], v[252:255], v[84:87]
    v_mfma_f32_16x16x32_bf16 v[88:91], a[232:235], v[252:255], v[88:91]
    v_mfma_f32_16x16x32_bf16 v[92:95], a[236:239], v[252:255], v[92:95]
    ds_write_b128 v9, v[60:63] offset:11264
    s_waitcnt vmcnt(7)
    v_mfma_f32_16x16x32_bf16 v[76:79], a[240:243], v[96:99], v[76:79]
    v_mfma_f32_16x16x32_bf16 v[80:83], a[244:247], v[96:99], v[80:83]
    v_mfma_f32_16x16x32_bf16 v[84:87], a[248:251], v[96:99], v[84:87]
    v_mfma_f32_16x16x32_bf16 v[88:91], a[252:255], v[96:99], v[88:91]
    v_mfma_f32_16x16x32_bf16 v[92:95], a[0:3], v[96:99], v[92:95]
    ds_write_b128 v9, v[64:67] offset:12288
    s_waitcnt vmcnt(6)
    v_mfma_f32_16x16x32_bf16 v[76:79], a[4:7], v[100:103], v[76:79]
    v_mfma_f32_16x16x32_bf16 v[80:83], a[8:11], v[100:103], v[80:83]
    v_mfma_f32_16x16x32_bf16 v[84:87], a[12:15], v[100:103], v[84:87]
    v_mfma_f32_16x16x32_bf16 v[88:91], a[16:19], v[100:103], v[88:91]
    v_mfma_f32_16x16x32_bf16 v[92:95], a[20:23], v[100:103], v[92:95]
    ds_write_b128 v9, v[68:71] offset:13312
    s_waitcnt vmcnt(5)
    v_mfma_f32_16x16x32_bf16 v[76:79], a[24:27], v[104:107], v[76:79]
    v_mfma_f32_16x16x32_bf16 v[80:83], a[28:31], v[104:107], v[80:83]
    v_mfma_f32_16x16x32_bf16 v[84:87], a[32:35], v[104:107], v[84:87]
    v_mfma_f32_16x16x32_bf16 v[88:91], a[36:39], v[104:107], v[88:91]
    v_mfma_f32_16x16x32_bf16 v[92:95], a[40:43], v[104:107], v[92:95]
    ds_write_b128 v9, v[72:75] offset:14336
    s_waitcnt vmcnt(4)
    v_mfma_f32_16x16x32_bf16 v[76:79], a[44:47], v[108:111], v[76:79]
    v_mfma_f32_16x16x32_bf16 v[80:83], a[48:51], v[108:111], v[80:83]
    v_mfma_f32_16x16x32_bf16 v[84:87], a[52:55], v[108:111], v[84:87]
    v_mfma_f32_16x16x32_bf16 v[88:91], a[56:59], v[108:111], v[88:91]
    v_mfma_f32_16x16x32_bf16 v[92:95], a[60:63], v[108:111], v[92:95]
    s_waitcnt vmcnt(3)
    v_mfma_f32_16x16x32_bf16 v[76:79], a[64:67], v[112:115], v[76:79]
    v_mfma_f32_16x16x32_bf16 v[80:83], a[68:71], v[112:115], v[80:83]
    v_mfma_f32_16x16x32_bf16 v[84:87], a[72:75], v[112:115], v[84:87]
    v_mfma_f32_16x16x32_bf16 v[88:91], a[76:79], v[112:115], v[88:91]
    v_mfma_f32_16x16x32_bf16 v[92:95], a[80:83], v[112:115], v[92:95]
    s_waitcnt vmcnt(2)
    v_mfma_f32_16x16x32_bf16 v[76:79], a[84:87], v[116:119], v[76:79]
    v_mfma_f32_16x16x32_bf16 v[80:83], a[88:91], v[116:119], v[80:83]
    v_mfma_f32_16x16x32_bf16 v[84:87], a[92:95], v[116:119], v[84:87]
    v_mfma_f32_16x16x32_bf16 v[88:91], a[96:99], v[116:119], v[88:91]
    v_mfma_f32_16x16x32_bf16 v[92:95], a[100:103], v[116:119], v[92:95]
    s_waitcnt vmcnt(1)
    v_mfma_f32_16x16x32_bf16 v[76:79], a[104:107], v[120:123], v[76:79]
    v_mfma_f32_16x16x32_bf16 v[80:83], a[108:111], v[120:123], v[80:83]
    v_mfma_f32_16x16x32_bf16 v[84:87], a[112:115], v[120:123], v[84:87]
    v_mfma_f32_16x16x32_bf16 v[88:91], a[116:119], v[120:123], v[88:91]
    v_mfma_f32_16x16x32_bf16 v[92:95], a[120:123], v[120:123], v[92:95]
    s_waitcnt vmcnt(0)
    v_mfma_f32_16x16x32_bf16 v[76:79], a[124:127], v[124:127], v[76:79]
    v_mfma_f32_16x16x32_bf16 v[80:83], a[128:131], v[124:127], v[80:83]
    v_mfma_f32_16x16x32_bf16 v[84:87], a[132:135], v[124:127], v[84:87]
    v_mfma_f32_16x16x32_bf16 v[88:91], a[136:139], v[124:127], v[88:91]
    v_mfma_f32_16x16x32_bf16 v[92:95], a[140:143], v[124:127], v[92:95]
    s_nop 3
    ds_write_b128 v9, v[76:79] offset:15360
    ds_write_b128 v9, v[80:83] offset:16384
    ds_write_b128 v9, v[84:87] offset:17408
    ds_write_b128 v9, v[88:91] offset:18432
    ds_write_b128 v9, v[92:95] offset:19456
    s_waitcnt lgkmcnt(0)
    s_barrier
    s_mul_i32 s46, s44, 5120
    v_add_u32 v9, s46, v8
    v_add_u32 v10, 40960, v9
    ds_read_b128 v[16:19], v9 offset:0
    ds_read_b128 v[20:23], v9 offset:1024
    ds_read_b128 v[24:27], v9 offset:2048
    ds_read_b128 v[28:31], v9 offset:3072
    ds_read_b128 v[32:35], v9 offset:4096
    ds_read_b128 v[36:39], v9 offset:20480
    ds_read_b128 v[40:43], v9 offset:21504
    ds_read_b128 v[44:47], v9 offset:22528
    ds_read_b128 v[48:51], v9 offset:23552
    ds_read_b128 v[52:55], v9 offset:24576
    ds_read_b128 v[56:59], v10 offset:0
    ds_read_b128 v[60:63], v10 offset:1024
    ds_read_b128 v[64:67], v10 offset:2048
    ds_read_b128 v[68:71], v10 offset:3072
    ds_read_b128 v[72:75], v10 offset:4096
    ds_read_b128 v[76:79], v10 offset:20480
    ds_read_b128 v[80:83], v10 offset:21504
    ds_read_b128 v[84:87], v10 offset:22528
    ds_read_b128 v[88:91], v10 offset:23552
    ds_read_b128 v[92:95], v10 offset:24576
    v_add_u32 v10, 106496, v8
    ds_read_b128 v[112:115], v10 offset:0
    ds_read_b128 v[116:119], v10 offset:1024
    ds_read_b128 v[120:123], v10 offset:2048
    ds_read_b128 v[124:127], v10 offset:3072
    ds_read_b128 v[128:131], v10 offset:4096
    ds_read_b128 v[132:135], v10 offset:5120
    ds_read_b128 v[136:139], v10 offset:6144
    ds_read_b128 v[140:143], v10 offset:7168
    ds_read_b128 v[144:147], v10 offset:8192
    ds_read_b128 v[148:151], v10 offset:9216
    ds_read_b128 v[152:155], v10 offset:10240
    ds_read_b128 v[156:159], v10 offset:11264
    ds_read_b128 v[160:163], v10 offset:12288
    ds_read_b128 v[164:167], v10 offset:13312
    ds_read_b128 v[168:171], v10 offset:14336
    s_waitcnt lgkmcnt(15)
    v_pk_add_f32 v[16:17], v[16:17], v[36:37]
    v_pk_add_f32 v[56:57], v[56:57], v[76:77]
    v_pk_add_f32 v[18:19], v[18:19], v[38:39]
    v_pk_add_f32 v[58:59], v[58:59], v[78:79]
    v_pk_add_f32 v[20:21], v[20:21], v[40:41]
    v_pk_add_f32 v[60:61], v[60:61], v[80:81]
    v_pk_add_f32 v[22:23], v[22:23], v[42:43]
    v_pk_add_f32 v[62:63], v[62:63], v[82:83]
    v_pk_add_f32 v[24:25], v[24:25], v[44:45]
    v_pk_add_f32 v[64:65], v[64:65], v[84:85]
    v_pk_add_f32 v[26:27], v[26:27], v[46:47]
    v_pk_add_f32 v[66:67], v[66:67], v[86:87]
    v_pk_add_f32 v[28:29], v[28:29], v[48:49]
    v_pk_add_f32 v[68:69], v[68:69], v[88:89]
    v_pk_add_f32 v[30:31], v[30:31], v[50:51]
    v_pk_add_f32 v[70:71], v[70:71], v[90:91]
    v_pk_add_f32 v[32:33], v[32:33], v[52:53]
    v_pk_add_f32 v[72:73], v[72:73], v[92:93]
    v_pk_add_f32 v[34:35], v[34:35], v[54:55]
    v_pk_add_f32 v[74:75], v[74:75], v[94:95]
    v_pk_add_f32 v[16:17], v[16:17], v[56:57]
    v_pk_add_f32 v[18:19], v[18:19], v[58:59]
    v_pk_add_f32 v[20:21], v[20:21], v[60:61]
    v_pk_add_f32 v[22:23], v[22:23], v[62:63]
    v_pk_add_f32 v[24:25], v[24:25], v[64:65]
    v_pk_add_f32 v[26:27], v[26:27], v[66:67]
    v_pk_add_f32 v[28:29], v[28:29], v[68:69]
    v_pk_add_f32 v[30:31], v[30:31], v[70:71]
    v_pk_add_f32 v[32:33], v[32:33], v[72:73]
    v_pk_add_f32 v[34:35], v[34:35], v[74:75]
    s_waitcnt vmcnt(0)
    s_waitcnt lgkmcnt(0)
    v_accvgpr_read_b32 v96, a144
    v_accvgpr_read_b32 v97, a145
    v_accvgpr_read_b32 v98, a146
    v_accvgpr_read_b32 v99, a147
    v_accvgpr_read_b32 v100, a148
    v_accvgpr_read_b32 v101, a149
    v_accvgpr_read_b32 v102, a150
    v_accvgpr_read_b32 v103, a151
    v_accvgpr_read_b32 v104, a152
    v_accvgpr_read_b32 v105, a153
    v_cvt_pk_bf16_f32 v10, v16, v17
    v_lshlrev_b32 v16, 16, v10
    v_and_b32 v17, 0xffff0000, v10
    v_lshlrev_b32 v36, 16, v96
    v_and_b32 v37, 0xffff0000, v96
    v_pk_add_f32 v[16:17], v[16:17], v[36:37]
    v_cvt_pk_bf16_f32 v56, v16, v17
    v_cvt_pk_bf16_f32 v10, v18, v19
    v_lshlrev_b32 v18, 16, v10
    v_and_b32 v19, 0xffff0000, v10
    v_lshlrev_b32 v38, 16, v97
    v_and_b32 v39, 0xffff0000, v97
    v_pk_add_f32 v[18:19], v[18:19], v[38:39]
    v_cvt_pk_bf16_f32 v57, v18, v19
    v_cvt_pk_bf16_f32 v10, v20, v21
    v_lshlrev_b32 v20, 16, v10
    v_and_b32 v21, 0xffff0000, v10
    v_lshlrev_b32 v40, 16, v98
    v_and_b32 v41, 0xffff0000, v98
    v_pk_add_f32 v[20:21], v[20:21], v[40:41]
    v_cvt_pk_bf16_f32 v58, v20, v21
    v_cvt_pk_bf16_f32 v10, v22, v23
    v_lshlrev_b32 v22, 16, v10
    v_and_b32 v23, 0xffff0000, v10
    v_lshlrev_b32 v42, 16, v99
    v_and_b32 v43, 0xffff0000, v99
    v_pk_add_f32 v[22:23], v[22:23], v[42:43]
    v_cvt_pk_bf16_f32 v59, v22, v23
    v_cvt_pk_bf16_f32 v10, v24, v25
    v_lshlrev_b32 v24, 16, v10
    v_and_b32 v25, 0xffff0000, v10
    v_lshlrev_b32 v44, 16, v100
    v_and_b32 v45, 0xffff0000, v100
    v_pk_add_f32 v[24:25], v[24:25], v[44:45]
    v_cvt_pk_bf16_f32 v60, v24, v25
    v_cvt_pk_bf16_f32 v10, v26, v27
    v_lshlrev_b32 v26, 16, v10
    v_and_b32 v27, 0xffff0000, v10
    v_lshlrev_b32 v46, 16, v101
    v_and_b32 v47, 0xffff0000, v101
    v_pk_add_f32 v[26:27], v[26:27], v[46:47]
    v_cvt_pk_bf16_f32 v61, v26, v27
    v_cvt_pk_bf16_f32 v10, v28, v29
    v_lshlrev_b32 v28, 16, v10
    v_and_b32 v29, 0xffff0000, v10
    v_lshlrev_b32 v48, 16, v102
    v_and_b32 v49, 0xffff0000, v102
    v_pk_add_f32 v[28:29], v[28:29], v[48:49]
    v_cvt_pk_bf16_f32 v62, v28, v29
    v_cvt_pk_bf16_f32 v10, v30, v31
    v_lshlrev_b32 v30, 16, v10
    v_and_b32 v31, 0xffff0000, v10
    v_lshlrev_b32 v50, 16, v103
    v_and_b32 v51, 0xffff0000, v103
    v_pk_add_f32 v[30:31], v[30:31], v[50:51]
    v_cvt_pk_bf16_f32 v63, v30, v31
    v_cvt_pk_bf16_f32 v10, v32, v33
    v_lshlrev_b32 v32, 16, v10
    v_and_b32 v33, 0xffff0000, v10
    v_lshlrev_b32 v52, 16, v104
    v_and_b32 v53, 0xffff0000, v104
    v_pk_add_f32 v[32:33], v[32:33], v[52:53]
    v_cvt_pk_bf16_f32 v64, v32, v33
    v_cvt_pk_bf16_f32 v10, v34, v35
    v_lshlrev_b32 v34, 16, v10
    v_and_b32 v35, 0xffff0000, v10
    v_lshlrev_b32 v54, 16, v105
    v_and_b32 v55, 0xffff0000, v105
    v_pk_add_f32 v[34:35], v[34:35], v[54:55]
    v_cvt_pk_bf16_f32 v65, v34, v35
    v_lshlrev_b32 v7, 6, v5
    v_lshl_add_u32 v7, v3, 4, v7
    s_lshr_b32 s51, s41, 1
    s_mul_i32 s51, s51, 655360
    s_and_b32 s50, s41, 1
    s_lshl_b32 s50, s50, 3
    s_add_u32 s51, s51, s50
    s_add_u32 s50, s51, 16777216
    buffer_store_dwordx2 v[56:57], v7, s[8:11], s50 offen
    s_add_u32 s50, s51, 16908288
    buffer_store_dwordx2 v[58:59], v7, s[8:11], s50 offen
    s_add_u32 s50, s51, 17039360
    buffer_store_dwordx2 v[60:61], v7, s[8:11], s50 offen
    s_add_u32 s50, s51, 17170432
    buffer_store_dwordx2 v[62:63], v7, s[8:11], s50 offen
    s_add_u32 s50, s51, 17301504
    buffer_store_dwordx2 v[64:65], v7, s[8:11], s50 offen
    v_lshlrev_b32 v16, 16, v56
    v_and_b32 v17, 0xffff0000, v56
    v_lshlrev_b32 v18, 16, v57
    v_and_b32 v19, 0xffff0000, v57
    v_lshlrev_b32 v20, 16, v58
    v_and_b32 v21, 0xffff0000, v58
    v_lshlrev_b32 v22, 16, v59
    v_and_b32 v23, 0xffff0000, v59
    v_lshlrev_b32 v24, 16, v60
    v_and_b32 v25, 0xffff0000, v60
    v_lshlrev_b32 v26, 16, v61
    v_and_b32 v27, 0xffff0000, v61
    v_lshlrev_b32 v28, 16, v62
    v_and_b32 v29, 0xffff0000, v62
    v_lshlrev_b32 v30, 16, v63
    v_and_b32 v31, 0xffff0000, v63
    v_lshlrev_b32 v32, 16, v64
    v_and_b32 v33, 0xffff0000, v64
    v_lshlrev_b32 v34, 16, v65
    v_and_b32 v35, 0xffff0000, v65
    v_lshlrev_b32 v7, 2, v5
    v_lshl_add_u32 v7, v3, 17, v7
    v_cmp_eq_u32 vcc, 0, v3
    v_add_u32 v9, 2621440, v7
    s_nop 0
    v_cndmask_b32 v11, v7, v9, vcc
    v_lshlrev_b32 v9, 3, v5
    s_lshl_b32 s52, s41, 13
    s_add_u32 s52, s52, 9437184
    s_mov_b32 s53, 12648448
    v_pk_add_f32 v[180:181], v[16:17], v[18:19]
    v_pk_add_f32 v[180:181], v[180:181], v[20:21]
    v_pk_add_f32 v[180:181], v[180:181], v[22:23]
    v_pk_add_f32 v[180:181], v[180:181], v[24:25]
    v_pk_add_f32 v[180:181], v[180:181], v[26:27]
    v_pk_add_f32 v[180:181], v[180:181], v[28:29]
    v_pk_add_f32 v[180:181], v[180:181], v[30:31]
    v_pk_add_f32 v[180:181], v[180:181], v[32:33]
    v_pk_add_f32 v[180:181], v[180:181], v[34:35]
    v_add_f32 v176, v180, v181
    v_mov_b32 v177, v176
    s_nop 1
    v_permlane32_swap_b32 v176, v177
    v_add_f32 v176, v176, v177
    v_mov_b32 v177, v176
    s_nop 1
    v_permlane16_swap_b32 v176, v177
    v_add_f32 v176, v176, v177
    v_mul_f32 v178, 0x3c4ccccd, v176
    v_pk_add_f32 v[16:17], v[16:17], v[178:179] op_sel_hi:[1,0] neg_lo:[0,1] neg_hi:[0,1]
    v_pk_add_f32 v[18:19], v[18:19], v[178:179] op_sel_hi:[1,0] neg_lo:[0,1] neg_hi:[0,1]
    v_pk_add_f32 v[20:21], v[20:21], v[178:179] op_sel_hi:[1,0] neg_lo:[0,1] neg_hi:[0,1]
    v_pk_add_f32 v[22:23], v[22:23], v[178:179] op_sel_hi:[1,0] neg_lo:[0,1] neg_hi:[0,1]
    v_pk_add_f32 v[24:25], v[24:25], v[178:179] op_sel_hi:[1,0] neg_lo:[0,1] neg_hi:[0,1]
    v_pk_add_f32 v[26:27], v[26:27], v[178:179] op_sel_hi:[1,0] neg_lo:[0,1] neg_hi:[0,1]
    v_pk_add_f32 v[28:29], v[28:29], v[178:179] op_sel_hi:[1,0] neg_lo:[0,1] neg_hi:[0,1]
    v_pk_add_f32 v[30:31], v[30:31], v[178:179] op_sel_hi:[1,0] neg_lo:[0,1] neg_hi:[0,1]
    v_pk_add_f32 v[32:33], v[32:33], v[178:179] op_sel_hi:[1,0] neg_lo:[0,1] neg_hi:[0,1]
    v_pk_add_f32 v[34:35], v[34:35], v[178:179] op_sel_hi:[1,0] neg_lo:[0,1] neg_hi:[0,1]
    v_pk_mul_f32 v[180:181], v[16:17], v[16:17]
    v_pk_fma_f32 v[180:181], v[18:19], v[18:19], v[180:181]
    v_pk_fma_f32 v[180:181], v[20:21], v[20:21], v[180:181]
    v_pk_fma_f32 v[180:181], v[22:23], v[22:23], v[180:181]
    v_pk_fma_f32 v[180:181], v[24:25], v[24:25], v[180:181]
    v_pk_fma_f32 v[180:181], v[26:27], v[26:27], v[180:181]
    v_pk_fma_f32 v[180:181], v[28:29], v[28:29], v[180:181]
    v_pk_fma_f32 v[180:181], v[30:31], v[30:31], v[180:181]
    v_pk_fma_f32 v[180:181], v[32:33], v[32:33], v[180:181]
    v_pk_fma_f32 v[180:181], v[34:35], v[34:35], v[180:181]
    v_add_f32 v179, v180, v181
    v_cvt_pk_bf16_f32 v184, v16, v17
    v_cvt_pk_bf16_f32 v185, v18, v19
    v_cvt_pk_bf16_f32 v186, v20, v21
    v_cvt_pk_bf16_f32 v187, v22, v23
    v_cvt_pk_bf16_f32 v188, v24, v25
    v_cvt_pk_bf16_f32 v189, v26, v27
    v_cvt_pk_bf16_f32 v190, v28, v29
    v_cvt_pk_bf16_f32 v191, v30, v31
    v_cvt_pk_bf16_f32 v192, v32, v33
    v_cvt_pk_bf16_f32 v193, v34, v35
    v_mov_b32 v194, 0
    v_mov_b32 v195, 0
    v_mov_b32 v177, v179
    s_nop 1
    v_permlane32_swap_b32 v179, v177
    v_add_f32 v179, v179, v177
    v_mov_b32 v177, v179
    s_nop 1
    v_permlane16_swap_b32 v179, v177
    v_add_f32 v179, v179, v177
    v_mfma_f32_16x16x32_bf16 v[196:199], v[112:115], v[184:187], 0
    v_mfma_f32_16x16x32_bf16 v[196:199], v[116:119], v[188:191], v[196:199]
    v_mfma_f32_16x16x32_bf16 v[196:199], v[120:123], v[192:195], v[196:199]
    v_mfma_f32_16x16x32_bf16 v[200:203], v[124:127], v[184:187], 0
    v_mfma_f32_16x16x32_bf16 v[200:203], v[128:131], v[188:191], v[200:203]
    v_mfma_f32_16x16x32_bf16 v[200:203], v[132:135], v[192:195], v[200:203]
    v_mfma_f32_16x16x32_bf16 v[204:207], v[136:139], v[184:187], 0
    v_mfma_f32_16x16x32_bf16 v[204:207], v[140:143], v[188:191], v[204:207]
    v_mfma_f32_16x16x32_bf16 v[204:207], v[144:147], v[192:195], v[204:207]
    v_mfma_f32_16x16x32_bf16 v[208:211], v[148:151], v[184:187], 0
    v_mfma_f32_16x16x32_bf16 v[208:211], v[152:155], v[188:191], v[208:211]
    v_mfma_f32_16x16x32_bf16 v[208:211], v[156:159], v[192:195], v[208:211]
    v_mfma_f32_16x16x32_bf16 v[212:215], v[160:163], v[184:187], 0
    v_mfma_f32_16x16x32_bf16 v[212:215], v[164:167], v[188:191], v[212:215]
    v_mfma_f32_16x16x32_bf16 v[212:215], v[168:171], v[192:195], v[212:215]
    v_cvt_pk_bf16_f32 v180, v176, v176
    v_and_b32 v180, 0xffff0000, v180
    v_sub_f32 v181, v176, v180
    v_cvt_pk_bf16_f32 v180, v180, v181
    v_fmac_f32 v179, v176, v178
    s_mov_b64 exec, 0xffff
    buffer_store_dword v180, v7, s[8:11], s52 offen
    buffer_atomic_add_f32 v176, v9, s[8:11], s53 offen
    buffer_atomic_add_f32 v179, v9, s[8:11], s53 offen offset:4
    s_mov_b64 exec, -1
    v_cvt_pk_bf16_f32 v16, v196, v197
    s_add_u32 s55, s52, 0
    buffer_store_dword v16, v11, s[8:11], s55 offen
    v_cvt_pk_bf16_f32 v17, v198, v199
    s_add_u32 s55, s52, 65536
    buffer_store_dword v17, v7, s[8:11], s55 offen
    v_cvt_pk_bf16_f32 v18, v200, v201
    s_add_u32 s55, s52, 524288
    buffer_store_dword v18, v7, s[8:11], s55 offen
    v_cvt_pk_bf16_f32 v19, v202, v203
    s_add_u32 s55, s52, 589824
    buffer_store_dword v19, v7, s[8:11], s55 offen
    v_cvt_pk_bf16_f32 v20, v204, v205
    s_add_u32 s55, s52, 1048576
    buffer_store_dword v20, v7, s[8:11], s55 offen
    v_cvt_pk_bf16_f32 v21, v206, v207
    s_add_u32 s55, s52, 1114112
    buffer_store_dword v21, v7, s[8:11], s55 offen
    v_cvt_pk_bf16_f32 v22, v208, v209
    s_add_u32 s55, s52, 1572864
    buffer_store_dword v22, v7, s[8:11], s55 offen
    v_cvt_pk_bf16_f32 v23, v210, v211
    s_add_u32 s55, s52, 1638400
    buffer_store_dword v23, v7, s[8:11], s55 offen
    v_cvt_pk_bf16_f32 v24, v212, v213
    s_add_u32 s55, s52, 2097152
    buffer_store_dword v24, v7, s[8:11], s55 offen
    v_cvt_pk_bf16_f32 v25, v214, v215
    s_add_u32 s55, s52, 2162688
    buffer_store_dword v25, v7, s[8:11], s55 offen
    s_waitcnt vmcnt(0)
    s_nop 15
L_g12a_kernel_end:
    s_endpgm
.globl g12b_kernel
.p2align 8
.type g12b_kernel,@function
g12b_kernel:
    s_mov_b32 s60, 12648448
    s_mov_b32 s65, 4194304
    s_mov_b32 s66, 33554432
    s_cmp_ge_u32 s2, 256
    s_cbranch_scc1 L_g12b_kernel_end
    s_and_b32 s40, s2, 7
    s_lshl_b32 s40, s40, 2
    s_lshr_b32 s41, s2, 6
    s_add_u32 s40, s40, s41
    s_lshr_b32 s41, s2, 3
    s_and_b32 s41, s41, 7
    s_load_dwordx2 s[4:5], s[0:1], 64
    s_load_dwordx2 s[32:33], s[0:1], 48
    s_getpc_b64 s[6:7]
    s_add_u32 s6, s6, tab_base@rel32@lo+4
    s_addc_u32 s7, s7, tab_base@rel32@hi+12
    s_mov_b32 s12, s6
    s_and_b32 s13, s7, 0xffff
    s_mov_b32 s14, 121344
    s_mov_b32 s15, 0x20000
    v_and_b32 v2, 15, v0
    v_bfe_u32 v3, v0, 4, 2
    v_lshrrev_b32 v1, 6, v0
    s_nop 0
    v_readfirstlane_b32 s44, v1
    v_and_b32 v4, 63, v0
    v_lshlrev_b32 v8, 4, v4
    s_lshl_b32 s52, s44, 10
    s_add_u32 m0, s52, 106496
    s_add_u32 s52, s52, 83456
    buffer_load_dwordx4 v8, s[12:15], s52 offen lds
    s_add_u32 m0, m0, 4096
    s_add_u32 s52, s52, 4096
    buffer_load_dwordx4 v8, s[12:15], s52 offen lds
    s_add_u32 m0, m0, 4096
    s_add_u32 s52, s52, 4096
    buffer_load_dwordx4 v8, s[12:15], s52 offen lds
    s_add_u32 m0, m0, 4096
    s_add_u32 s52, s52, 4096
    buffer_load_dwordx4 v8, s[12:15], s52 offen lds
    s_add_u32 m0, m0, 4096
    s_add_u32 s52, s52, 4096
    buffer_load_dwordx4 v8, s[12:15], s52 offen lds
    s_add_u32 m0, m0, 4096
    s_add_u32 s52, s52, 4096
    buffer_load_dwordx4 v8, s[12:15], s52 offen lds
    s_add_u32 m0, m0, 4096
    s_add_u32 s52, s52, 4096
    buffer_load_dwordx4 v8, s[12:15], s52 offen lds
    s_add_u32 m0, m0, 4096
    s_add_u32 s52, s52, 4096
    buffer_load_dwordx4 v8, s[12:15], s52 offen lds
    s_add_u32 m0, m0, 4096
    s_add_u32 s52, s52, 4096
    buffer_load_dwordx4 v8, s[12:15], s52 offen lds
    s_add_u32 m0, m0, 4096
    s_add_u32 s52, s52, 4096
    buffer_load_dwordx4 v8, s[12:15], s52 offen lds
    s_waitcnt lgkmcnt(0)
    s_mov_b32 s8, s4
    s_and_b32 s9, s5, 0xffff
    s_mov_b32 s10, 0x10000000
    s_mov_b32 s11, 0x20000
    s_mov_b32 s28, s32
    s_and_b32 s29, s33, 0xffff
    s_mov_b32 s30, 2621440
    s_mov_b32 s31, 0x20000
    s_lshl_b32 s45, s40, 6
    s_lshl_b32 s46, s44, 4
    s_add_u32 s45, s45, s46
    v_add_u32 v5, s45, v2
    v_lshlrev_b32 v7, 3, v5
    s_mov_b32 s47, 13631488
    buffer_load_dword v12, v7, s[8:11], s60 offen
    v_lshlrev_b32 v7, 4, v5
    buffer_load_ushort v13, v7, s[8:11], s47 offen
    v_lshl_add_u32 v7, v3, 15, v7
    s_mov_b32 s47, 13631488
    buffer_load_dwordx4 a[0:3], v7, s[8:11], s47 offen
    s_mov_b32 s47, 13762560
    buffer_load_dwordx4 a[4:7], v7, s[8:11], s47 offen
    s_mov_b32 s47, 13893632
    buffer_load_dwordx4 a[8:11], v7, s[8:11], s47 offen
    s_mov_b32 s47, 14024704
    buffer_load_dwordx4 a[12:15], v7, s[8:11], s47 offen
    s_mov_b32 s47, 14155776
    buffer_load_dwordx4 a[16:19], v7, s[8:11], s47 offen
    s_mov_b32 s47, 14286848
    buffer_load_dwordx4 a[20:23], v7, s[8:11], s47 offen
    s_mov_b32 s47, 14417920
    buffer_load_dwordx4 a[24:27], v7, s[8:11], s47 offen
    s_mov_b32 s47, 14548992
    buffer_load_dwordx4 a[28:31], v7, s[8:11], s47 offen
    s_mov_b32 s47, 14680064
    buffer_load_dwordx4 a[32:35], v7, s[8:11], s47 offen
    s_mov_b32 s47, 14811136
    buffer_load_dwordx4 a[36:39], v7, s[8:11], s47 offen
    s_mov_b32 s47, 14942208
    buffer_load_dwordx4 a[40:43], v7, s[8:11], s47 offen
    s_mov_b32 s47, 15073280
    buffer_load_dwordx4 a[44:47], v7, s[8:11], s47 offen
    s_mov_b32 s47, 15204352
    buffer_load_dwordx4 a[48:51], v7, s[8:11], s47 offen
    s_mov_b32 s47, 15335424
    buffer_load_dwordx4 a[52:55], v7, s[8:11], s47 offen
    s_mov_b32 s47, 15466496
    buffer_load_dwordx4 a[56:59], v7, s[8:11], s47 offen
    s_mov_b32 s47, 15597568
    buffer_load_dwordx4 a[60:63], v7, s[8:11], s47 offen
    s_mov_b32 s47, 15728640
    buffer_load_dwordx4 a[64:67], v7, s[8:11], s47 offen
    s_mov_b32 s47, 15859712
    buffer_load_dwordx4 a[68:71], v7, s[8:11], s47 offen
    s_mov_b32 s47, 15990784
    buffer_load_dwordx4 a[72:75], v7, s[8:11], s47 offen
    s_mov_b32 s47, 16121856
    buffer_load_dwordx4 a[76:79], v7, s[8:11], s47 offen
    s_mov_b32 s47, 16252928
    buffer_load_dwordx4 a[80:83], v7, s[8:11], s47 offen
    v_lshlrev_b32 v6, 6, v5
    v_lshl_add_u32 v6, v3, 4, v6
    s_mul_i32 s49, s41, 12
    s_mul_i32 s50, s44, 3
    s_add_u32 s49, s49, s50
    s_and_b32 s53, s44, 1
    s_add_u32 s50, s49, s53
    s_add_u32 s51, s50, 1
    s_lshl_b32 s54, s53, 1
    s_sub_u32 s52, 2, s54
    s_add_u32 s52, s52, s49
    s_mov_b32 s56, s50
    s_mov_b32 s57, s52
    s_mul_i32 s50, s50, 20480
    s_add_u32 s50, s50, 0
    s_mul_i32 s51, s51, 20480
    s_add_u32 s51, s51, 0
    s_mul_i32 s52, s52, 20480
    s_add_u32 s52, s52, 0
    v_lshlrev_b32 v9, 2, v3
    v_sub_u32 v9, v2, v9
    v_mov_b32 v14, 0x3f80
    v_mov_b32 v15, 0x3f800000
    v_cmp_eq_u32 vcc, 0, v9
    s_nop 1
    v_cndmask_b32 v10, 0, v14, vcc
    v_cmp_eq_u32 vcc, 1, v9
    s_nop 1
    v_cndmask_b32 v10, v10, v15, vcc
    v_cmp_eq_u32 vcc, 2, v9
    s_nop 1
    v_cndmask_b32 v11, 0, v14, vcc
    v_cmp_eq_u32 vcc, 3, v9
    s_nop 1
    v_cndmask_b32 v11, v11, v15, vcc
    s_mul_i32 s59, s44, 26624
    v_lshl_add_u32 v9, v3, 5, v2
    v_mul_u32_u24 v9, 208, v9
    v_add_u32 v9, s59, v9
    v_add_u32 v4, 106496, v8
    s_waitcnt vmcnt(23)
    s_waitcnt lgkmcnt(0)
    s_barrier
    ds_read_b128 a[84:87], v4 offset:0
    ds_read_b128 a[88:91], v4 offset:1024
    ds_read_b128 a[92:95], v4 offset:2048
    ds_read_b128 a[96:99], v4 offset:3072
    s_waitcnt vmcnt(21)
    v_lshlrev_b32 v13, 16, v13
    v_fmac_f32 v13, 0x3acccccd, v12
    v_mov_b32 v14, v13
    v_mov_b32 v15, v13
    v_cvt_pk_bf16_f32 v12, v15, v13
    v_lshlrev_b32 v15, 16, v12
    v_and_b32 v13, 0xffff0000, v12
    s_waitcnt vmcnt(20) lgkmcnt(3)
    v_mfma_f32_16x16x16_bf16 v[96:99], a[84:85], a[0:1], 0
    v_mfma_f32_16x16x16_bf16 v[100:103], a[86:87], a[2:3], 0
    s_waitcnt vmcnt(19) lgkmcnt(2)
    v_mfma_f32_16x16x16_bf16 v[104:107], a[88:89], a[4:5], 0
    v_mfma_f32_16x16x16_bf16 v[108:111], a[90:91], a[6:7], 0
    s_waitcnt vmcnt(18) lgkmcnt(1)
    v_mfma_f32_16x16x16_bf16 v[112:115], a[92:93], a[8:9], 0
    v_mfma_f32_16x16x16_bf16 v[116:119], a[94:95], a[10:11], 0
    s_mov_b32 s47, 16777216
    buffer_load_dwordx4 v[16:19], v6, s[8:11], s47 offen
    s_waitcnt vmcnt(18) lgkmcnt(0)
    v_mfma_f32_16x16x16_bf16 v[120:123], a[96:97], a[12:13], 0
    v_mfma_f32_16x16x16_bf16 v[124:127], a[98:99], a[14:15], 0
    ds_read_b128 a[84:87], v4 offset:4096
    ds_read_b128 a[88:91], v4 offset:5120
    v_cvt_pk_bf16_f32 v128, v96, v97
    v_cvt_pk_bf16_f32 v132, v98, v99
    v_cvt_pk_bf16_f32 v129, v100, v101
    v_cvt_pk_bf16_f32 v133, v102, v103
    v_cvt_pk_bf16_f32 v130, v104, v105
    v_cvt_pk_bf16_f32 v134, v106, v107
    s_mov_b32 s47, 16908288
    buffer_load_dwordx4 v[20:23], v6, s[8:11], s47 offen
    v_cvt_pk_bf16_f32 v131, v108, v109
    v_cvt_pk_bf16_f32 v135, v110, v111
    ds_write_b128 v9, v[128:131] offset:0
    ds_write_b128 v9, v[132:135] offset:3328
    s_waitcnt vmcnt(18) lgkmcnt(3)
    v_mfma_f32_16x16x16_bf16 v[96:99], a[84:85], a[16:17], 0
    v_mfma_f32_16x16x16_bf16 v[100:103], a[86:87], a[18:19], 0
    s_waitcnt vmcnt(17) lgkmcnt(2)
    v_mfma_f32_16x16x16_bf16 v[104:107], a[88:89], a[20:21], 0
    v_mfma_f32_16x16x16_bf16 v[108:111], a[90:91], a[22:23], 0
    s_mov_b32 s47, 17039360
    buffer_load_dwordx4 v[24:27], v6, s[8:11], s47 offen
    ds_read_b128 a[92:95], v4 offset:6144
    ds_read_b128 a[96:99], v4 offset:7168
    v_cvt_pk_bf16_f32 v136, v112, v113
    v_cvt_pk_bf16_f32 v140, v114, v115
    v_cvt_pk_bf16_f32 v137, v116, v117
    v_cvt_pk_bf16_f32 v141, v118, v119
    v_cvt_pk_bf16_f32 v138, v120, v121
    v_cvt_pk_bf16_f32 v142, v122, v123
    v_cvt_pk_bf16_f32 v139, v124, v125
    v_cvt_pk_bf16_f32 v143, v126, v127
    ds_write_b128 v9, v[136:139] offset:16
    ds_write_b128 v9, v[140:143] offset:3344
    s_mov_b32 s47, 17170432
    buffer_load_dwordx4 v[28:31], v6, s[8:11], s47 offen
    s_waitcnt vmcnt(18) lgkmcnt(3)
    v_mfma_f32_16x16x16_bf16 v[112:115], a[92:93], a[24:25], 0
    v_mfma_f32_16x16x16_bf16 v[116:119], a[94:95], a[26:27], 0
    s_waitcnt vmcnt(17) lgkmcnt(2)
    v_mfma_f32_16x16x16_bf16 v[120:123], a[96:97], a[28:29], 0
    v_mfma_f32_16x16x16_bf16 v[124:127], a[98:99], a[30:31], 0
    ds_read_b128 a[84:87], v4 offset:8192
    ds_read_b128 a[88:91], v4 offset:9216
    v_cvt_pk_bf16_f32 v128, v96, v97
    v_cvt_pk_bf16_f32 v132, v98, v99
    s_mov_b32 s47, 17301504
    buffer_load_dwordx4 v[32:35], v6, s[8:11], s47 offen
    v_cvt_pk_bf16_f32 v129, v100, v101
    v_cvt_pk_bf16_f32 v133, v102, v103
    v_cvt_pk_bf16_f32 v130, v104, v105
    v_cvt_pk_bf16_f32 v134, v106, v107
    v_cvt_pk_bf16_f32 v131, v108, v109
    v_cvt_pk_bf16_f32 v135, v110, v111
    ds_write_b128 v9, v[128:131] offset:32
    ds_write_b128 v9, v[132:135] offset:3360
    s_waitcnt vmcnt(17) lgkmcnt(3)
    v_mfma_f32_16x16x16_bf16 v[96:99], a[84:85], a[32:33], 0
    v_mfma_f32_16x16x16_bf16 v[100:103], a[86:87], a[34:35], 0
    s_mov_b32 s47, 17432576
    buffer_load_dwordx4 v[36:39], v6, s[8:11], s47 offen
    s_waitcnt vmcnt(17) lgkmcnt(2)
    v_mfma_f32_16x16x16_bf16 v[104:107], a[88:89], a[36:37], 0
    v_mfma_f32_16x16x16_bf16 v[108:111], a[90:91], a[38:39], 0
    ds_read_b128 a[92:95], v4 offset:10240
    ds_read_b128 a[96:99], v4 offset:11264
    v_cvt_pk_bf16_f32 v136, v112, v113
    v_cvt_pk_bf16_f32 v140, v114, v115
    v_cvt_pk_bf16_f32 v137, v116, v117
    v_cvt_pk_bf16_f32 v141, v118, v119
    v_cvt_pk_bf16_f32 v138, v120, v121
    v_cvt_pk_bf16_f32 v142, v122, v123
    s_mov_b32 s47, 17563648
    buffer_load_dwordx4 v[40:43], v6, s[8:11], s47 offen
    v_cvt_pk_bf16_f32 v139, v124, v125
    v_cvt_pk_bf16_f32 v143, v126, v127
    ds_write_b128 v9, v[136:139] offset:48
    ds_write_b128 v9, v[140:143] offset:3376
    s_waitcnt vmcnt(17) lgkmcnt(3)
    v_mfma_f32_16x16x16_bf16 v[112:115], a[92:93], a[40:41], 0
    v_mfma_f32_16x16x16_bf16 v[116:119], a[94:95], a[42:43], 0
    s_waitcnt vmcnt(16) lgkmcnt(2)
    v_mfma_f32_16x16x16_bf16 v[120:123], a[96:97], a[44:45], 0
    v_mfma_f32_16x16x16_bf16 v[124:127], a[98:99], a[46:47], 0
    s_mov_b32 s47, 17694720
    buffer_load_dwordx4 v[44:47], v6, s[8:11], s47 offen
    ds_read_b128 a[84:87], v4 offset:12288
    ds_read_b128 a[88:91], v4 offset:13312
    v_cvt_pk_bf16_f32 v128, v96, v97
    v_cvt_pk_bf16_f32 v132, v98, v99
    v_cvt_pk_bf16_f32 v129, v100, v101
    v_cvt_pk_bf16_f32 v133, v102, v103
    v_cvt_pk_bf16_f32 v130, v104, v105
    v_cvt_pk_bf16_f32 v134, v106, v107
    v_cvt_pk_bf16_f32 v131, v108, v109
    v_cvt_pk_bf16_f32 v135, v110, v111
    ds_write_b128 v9, v[128:131] offset:64
    ds_write_b128 v9, v[132:135] offset:3392
    s_mov_b32 s47, 17825792
    buffer_load_dwordx4 v[48:51], v6, s[8:11], s47 offen
    s_waitcnt vmcnt(17) lgkmcnt(3)
    v_mfma_f32_16x16x16_bf16 v[96:99], a[84:85], a[48:49], 0
    v_mfma_f32_16x16x16_bf16 v[100:103], a[86:87], a[50:51], 0
    s_waitcnt vmcnt(16) lgkmcnt(2)
    v_mfma_f32_16x16x16_bf16 v[104:107], a[88:89], a[52:53], 0
    v_mfma_f32_16x16x16_bf16 v[108:111], a[90:91], a[54:55], 0
    ds_read_b128 a[92:95], v4 offset:14336
    ds_read_b128 a[96:99], v4 offset:15360
    v_cvt_pk_bf16_f32 v136, v112, v113
    v_cvt_pk_bf16_f32 v140, v114, v115
    s_mov_b32 s47, 17956864
    buffer_load_dwordx4 v[52:55], v6, s[8:11], s47 offen
    v_cvt_pk_bf16_f32 v137, v116, v117
    v_cvt_pk_bf16_f32 v141, v118, v119
    v_cvt_pk_bf16_f32 v138, v120, v121
    v_cvt_pk_bf16_f32 v142, v122, v123
    v_cvt_pk_bf16_f32 v139, v124, v125
    v_cvt_pk_bf16_f32 v143, v126, v127
    ds_write_b128 v9, v[136:139] offset:80
    ds_write_b128 v9, v[140:143] offset:3408
    s_waitcnt vmcnt(16) lgkmcnt(3)
    v_mfma_f32_16x16x16_bf16 v[112:115], a[92:93], a[56:57], 0
    v_mfma_f32_16x16x16_bf16 v[116:119], a[94:95], a[58:59], 0
    s_mov_b32 s47, 18087936
    buffer_load_dwordx4 v[56:59], v6, s[8:11], s47 offen
    s_waitcnt vmcnt(16) lgkmcnt(2)
    v_mfma_f32_16x16x16_bf16 v[120:123], a[96:97], a[60:61], 0
    v_mfma_f32_16x16x16_bf16 v[124:127], a[98:99], a[62:63], 0
    ds_read_b128 a[84:87], v4 offset:16384
    ds_read_b128 a[88:91], v4 offset:17408
    v_cvt_pk_bf16_f32 v128, v96, v97
    v_cvt_pk_bf16_f32 v132, v98, v99
    v_cvt_pk_bf16_f32 v129, v100, v101
    v_cvt_pk_bf16_f32 v133, v102, v103
    v_cvt_pk_bf16_f32 v130, v104, v105
    v_cvt_pk_bf16_f32 v134, v106, v107
    s_mov_b32 s47, 18219008
    buffer_load_dwordx4 v[60:63], v6, s[8:11], s47 offen
    v_cvt_pk_bf16_f32 v131, v108, v109
    v_cvt_pk_bf16_f32 v135, v110, v111
    ds_write_b128 v9, v[128:131] offset:96
    ds_write_b128 v9, v[132:135] offset:3424
    s_waitcnt vmcnt(16) lgkmcnt(3)
    v_mfma_f32_16x16x16_bf16 v[96:99], a[84:85], a[64:65], 0
    v_mfma_f32_16x16x16_bf16 v[100:103], a[86:87], a[66:67], 0
    s_waitcnt vmcnt(15) lgkmcnt(2)
    v_mfma_f32_16x16x16_bf16 v[104:107], a[88:89], a[68:69], 0
    v_mfma_f32_16x16x16_bf16 v[108:111], a[90:91], a[70:71], 0
    s_mov_b32 s47, 18350080
    buffer_load_dwordx4 v[64:67], v6, s[8:11], s47 offen
    ds_read_b128 a[92:95], v4 offset:18432
    ds_read_b128 a[96:99], v4 offset:19456
    v_cvt_pk_bf16_f32 v136, v112, v113
    v_cvt_pk_bf16_f32 v140, v114, v115
    v_cvt_pk_bf16_f32 v137, v116, v117
    v_cvt_pk_bf16_f32 v141, v118, v119
    v_cvt_pk_bf16_f32 v138, v120, v121
    v_cvt_pk_bf16_f32 v142, v122, v123
    v_cvt_pk_bf16_f32 v139, v124, v125
    v_cvt_pk_bf16_f32 v143, v126, v127
    ds_write_b128 v9, v[136:139] offset:112
    ds_write_b128 v9, v[140:143] offset:3440
    s_mov_b32 s47, 18481152
    buffer_load_dwordx4 v[68:71], v6, s[8:11], s47 offen
    s_waitcnt vmcnt(16) lgkmcnt(3)
    v_mfma_f32_16x16x16_bf16 v[112:115], a[92:93], a[72:73], 0
    v_mfma_f32_16x16x16_bf16 v[116:119], a[94:95], a[74:75], 0
    s_waitcnt vmcnt(15) lgkmcnt(2)
    v_mfma_f32_16x16x16_bf16 v[120:123], a[96:97], a[76:77], 0
    v_mfma_f32_16x16x16_bf16 v[124:127], a[98:99], a[78:79], 0
    ds_read_b128 a[84:87], v4 offset:20480
    v_cvt_pk_bf16_f32 v128, v96, v97
    v_cvt_pk_bf16_f32 v132, v98, v99
    v_cvt_pk_bf16_f32 v129, v100, v101
    s_mov_b32 s47, 18612224
    buffer_load_dwordx4 v[72:75], v6, s[8:11], s47 offen
    v_cvt_pk_bf16_f32 v133, v102, v103
    v_cvt_pk_bf16_f32 v130, v104, v105
    v_cvt_pk_bf16_f32 v134, v106, v107
    v_cvt_pk_bf16_f32 v131, v108, v109
    v_cvt_pk_bf16_f32 v135, v110, v111
    ds_write_b128 v9, v[128:131] offset:128
    ds_write_b128 v9, v[132:135] offset:3456
    ds_read_b128 a[100:103], v4 offset:22528
    ds_read_b128 a[104:107], v4 offset:23552
    ds_read_b128 a[108:111], v4 offset:24576
    ds_read_b128 a[112:115], v4 offset:25600
    ds_read_b128 a[116:119], v4 offset:26624
    s_mov_b32 s47, 18743296
    buffer_load_dwordx4 v[76:79], v6, s[8:11], s47 offen
    ds_read_b128 a[120:123], v4 offset:27648
    ds_read_b128 a[124:127], v4 offset:28672
    ds_read_b128 a[128:131], v4 offset:29696
    ds_read_b128 a[132:135], v4 offset:30720
    ds_read_b128 a[136:139], v4 offset:31744
    ds_read_b128 a[140:143], v4 offset:32768
    ds_read_b128 a[144:147], v4 offset:33792
    ds_read_b128 a[148:151], v4 offset:34816
    ds_read_b128 a[152:155], v4 offset:35840
    ds_read_b128 a[156:159], v4 offset:36864
    s_waitcnt vmcnt(16) lgkmcnt(15)
    v_mfma_f32_16x16x16_bf16 v[96:99], a[84:85], a[80:81], 0
    s_mov_b32 s47, 18874368
    buffer_load_dwordx4 v[80:83], v6, s[8:11], s47 offen
    v_cvt_pk_bf16_f32 v136, v112, v113
    v_cvt_pk_bf16_f32 v140, v114, v115
    v_cvt_pk_bf16_f32 v137, v116, v117
    v_cvt_pk_bf16_f32 v141, v118, v119
    v_cvt_pk_bf16_f32 v138, v120, v121
    v_cvt_pk_bf16_f32 v142, v122, v123
    v_cvt_pk_bf16_f32 v139, v124, v125
    v_cvt_pk_bf16_f32 v143, v126, v127
    ds_write_b128 v9, v[136:139] offset:144
    ds_write_b128 v9, v[140:143] offset:3472
    v_cvt_pk_bf16_f32 v128, v96, v97
    v_cvt_pk_bf16_f32 v132, v98, v99
    s_mov_b32 s47, 19005440
    buffer_load_dwordx4 v[84:87], v6, s[8:11], s47 offen
    v_mov_b32 v129, 0
    v_mov_b32 v133, 0
    v_mov_b32 v130, 0
    v_mov_b32 v134, 0
    v_mov_b32 v131, 0
    v_mov_b32 v135, 0
    ds_write_b128 v9, v[128:131] offset:160
    ds_write_b128 v9, v[132:135] offset:3488
    v_mov_b32 v136, 0
    v_mov_b32 v140, 0
    v_mov_b32 v137, 0
    v_mov_b32 v141, 0
    s_mov_b32 s47, 19136512
    buffer_load_dwordx4 v[88:91], v6, s[8:11], s47 offen
    v_mov_b32 v138, 0
    v_mov_b32 v142, 0
    v_mov_b32 v139, 0
    v_mov_b32 v143, 0
    ds_write_b128 v9, v[136:139] offset:176
    ds_write_b128 v9, v[140:143] offset:3504
    s_waitcnt lgkmcnt(0)
    v_sub_f32 v252, 0, v15
    v_sub_f32 v253, 0, v15
    v_sub_f32 v254, 0, v15
    v_sub_f32 v255, 0, v15
    v_mul_u32_u24 v9, 208, v2
    s_mov_b32 s47, 19267584
    buffer_load_dwordx4 v[92:95], v6, s[8:11], s47 offen
    v_lshl_add_u32 v9, v3, 4, v9
    v_add_u32 v9, s59, v9
    v_add_u32 v12, s59, v8
    v_mov_b32 v13, v5
    ds_read_b128 a[84:87], v9 offset:0
    ds_read_b128 a[88:91], v9 offset:64
    ds_read_b128 a[92:95], v9 offset:128
    ds_read_b128 a[96:99], v9 offset:3328
    ds_read_b128 v[244:247], v9 offset:3392
    ds_read_b128 v[248:251], v9 offset:3456
    s_waitcnt lgkmcnt(5)
    v_mfma_f32_16x16x32_bf16 v[96:99], a[100:103], a[84:87], v[252:255]
    s_add_u32 s55, s50, 0
    buffer_load_dwordx4 a[160:163], v8, s[8:11], s55 offen offset:0
    v_mfma_f32_16x16x32_bf16 v[100:103], a[112:115], a[84:87], v[252:255]
    v_mfma_f32_16x16x32_bf16 v[104:107], a[124:127], a[84:87], v[252:255]
    v_mfma_f32_16x16x32_bf16 v[108:111], a[136:139], a[84:87], v[252:255]
    v_mfma_f32_16x16x32_bf16 v[112:115], a[148:151], a[84:87], v[252:255]
    s_waitcnt lgkmcnt(4)
    v_mfma_f32_16x16x32_bf16 v[96:99], a[104:107], a[88:91], v[96:99]
    v_mfma_f32_16x16x32_bf16 v[100:103], a[116:119], a[88:91], v[100:103]
    s_add_u32 s55, s51, 0
    buffer_load_dwordx4 a[164:167], v8, s[8:11], s55 offen offset:0
    v_mfma_f32_16x16x32_bf16 v[104:107], a[128:131], a[88:91], v[104:107]
    v_mfma_f32_16x16x32_bf16 v[108:111], a[140:143], a[88:91], v[108:111]
    v_mfma_f32_16x16x32_bf16 v[112:115], a[152:155], a[88:91], v[112:115]
    s_waitcnt lgkmcnt(3)
    v_mfma_f32_16x16x32_bf16 v[96:99], a[108:111], a[92:95], v[96:99]
    v_mfma_f32_16x16x32_bf16 v[100:103], a[120:123], a[92:95], v[100:103]
    v_mfma_f32_16x16x32_bf16 v[104:107], a[132:135], a[92:95], v[104:107]
    s_add_u32 s55, s52, 0
    buffer_load_dwordx4 a[168:171], v8, s[8:11], s55 offen offset:0
    v_mfma_f32_16x16x32_bf16 v[108:111], a[144:147], a[92:95], v[108:111]
    v_mfma_f32_16x16x32_bf16 v[112:115], a[156:159], a[92:95], v[112:115]
    s_waitcnt vmcnt(22)
    v_mfma_f32_16x16x16_bf16 v[96:99], v[10:11], v[16:17], v[96:99]
    s_waitcnt vmcnt(21)
    v_mfma_f32_16x16x16_bf16 v[100:103], v[10:11], v[20:21], v[100:103]
    s_waitcnt vmcnt(20)
    v_mfma_f32_16x16x16_bf16 v[104:107], v[10:11], v[24:25], v[104:107]
    s_waitcnt vmcnt(19)
    v_mfma_f32_16x16x16_bf16 v[108:111], v[10:11], v[28:29], v[108:111]
    s_add_u32 s55, s50, 0
    buffer_load_dwordx4 a[172:175], v8, s[8:11], s55 offen offset:1024
    s_waitcnt vmcnt(19)
    v_mfma_f32_16x16x16_bf16 v[112:115], v[10:11], v[32:33], v[112:115]
    ds_read_b128 a[84:87], v9 offset:6656
    ds_read_b128 a[88:91], v9 offset:6720
    ds_read_b128 a[92:95], v9 offset:6784
    s_waitcnt lgkmcnt(5)
    v_mfma_f32_16x16x32_bf16 v[116:119], a[100:103], a[96:99], v[252:255]
    v_mfma_f32_16x16x32_bf16 v[120:123], a[112:115], a[96:99], v[252:255]
    v_mfma_f32_16x16x32_bf16 v[124:127], a[124:127], a[96:99], v[252:255]
    v_mfma_f32_16x16x32_bf16 v[128:131], a[136:139], a[96:99], v[252:255]
    s_add_u32 s55, s51, 0
    buffer_load_dwordx4 a[176:179], v8, s[8:11], s55 offen offset:1024
    v_mfma_f32_16x16x32_bf16 v[132:135], a[148:151], a[96:99], v[252:255]
    v_cvt_pk_bf16_f32 v236, v96, v97
    v_cvt_pk_bf16_f32 v237, v98, v99
    v_cvt_pk_bf16_f32 v238, v100, v101
    v_cvt_pk_bf16_f32 v239, v102, v103
    ds_write_b128 v12, v[236:239] offset:0
    s_nop 0
    v_mfma_f32_16x16x32_bf16 v[4:7], v[236:239], v[236:239], 0
    v_cvt_pk_bf16_f32 v240, v104, v105
    v_cvt_pk_bf16_f32 v241, v106, v107
    v_cvt_pk_bf16_f32 v242, v108, v109
    s_add_u32 s55, s52, 0
    buffer_load_dwordx4 a[180:183], v8, s[8:11], s55 offen offset:1024
    v_cvt_pk_bf16_f32 v243, v110, v111
    ds_write_b128 v12, v[240:243] offset:1024
    s_nop 0
    v_mfma_f32_16x16x32_bf16 v[4:7], v[240:243], v[240:243], v[4:7]
    s_waitcnt lgkmcnt(6)
    v_mfma_f32_16x16x32_bf16 v[116:119], a[104:107], v[244:247], v[116:119]
    v_mfma_f32_16x16x32_bf16 v[120:123], a[116:119], v[244:247], v[120:123]
    v_mfma_f32_16x16x32_bf16 v[124:127], a[128:131], v[244:247], v[124:127]
    v_mfma_f32_16x16x32_bf16 v[128:131], a[140:143], v[244:247], v[128:131]
    s_add_u32 s55, s50, 0
    buffer_load_dwordx4 a[184:187], v8, s[8:11], s55 offen offset:2048
    v_mfma_f32_16x16x32_bf16 v[132:135], a[152:155], v[244:247], v[132:135]
    s_waitcnt lgkmcnt(5)
    v_mfma_f32_16x16x32_bf16 v[116:119], a[108:111], v[248:251], v[116:119]
    v_mfma_f32_16x16x32_bf16 v[120:123], a[120:123], v[248:251], v[120:123]
    v_mfma_f32_16x16x32_bf16 v[124:127], a[132:135], v[248:251], v[124:127]
    v_mfma_f32_16x16x32_bf16 v[128:131], a[144:147], v[248:251], v[128:131]
    v_mfma_f32_16x16x32_bf16 v[132:135], a[156:159], v[248:251], v[132:135]
    s_add_u32 s55, s51, 0
    buffer_load_dwordx4 a[188:191], v8, s[8:11], s55 offen offset:2048
    v_mfma_f32_16x16x16_bf16 v[116:119], v[10:11], v[18:19], v[116:119]
    v_mfma_f32_16x16x16_bf16 v[120:123], v[10:11], v[22:23], v[120:123]
    v_mfma_f32_16x16x16_bf16 v[124:127], v[10:11], v[26:27], v[124:127]
    v_mfma_f32_16x16x16_bf16 v[128:131], v[10:11], v[30:31], v[128:131]
    v_mfma_f32_16x16x16_bf16 v[132:135], v[10:11], v[34:35], v[132:135]
    ds_read_b128 a[96:99], v9 offset:9984
    ds_read_b128 v[244:247], v9 offset:10048
    s_add_u32 s55, s52, 0
    buffer_load_dwordx4 a[192:195], v8, s[8:11], s55 offen offset:2048
    ds_read_b128 v[248:251], v9 offset:10112
    s_waitcnt lgkmcnt(7)
    v_mfma_f32_16x16x32_bf16 v[136:139], a[100:103], a[84:87], v[252:255]
    v_mfma_f32_16x16x32_bf16 v[140:143], a[112:115], a[84:87], v[252:255]
    v_mfma_f32_16x16x32_bf16 v[144:147], a[124:127], a[84:87], v[252:255]
    v_mfma_f32_16x16x32_bf16 v[148:151], a[136:139], a[84:87], v[252:255]
    v_mfma_f32_16x16x32_bf16 v[152:155], a[148:151], a[84:87], v[252:255]
    v_cvt_pk_bf16_f32 v236, v112, v113
    s_add_u32 s55, s50, 0
    buffer_load_dwordx4 a[196:199], v8, s[8:11], s55 offen offset:3072
    v_cvt_pk_bf16_f32 v237, v114, v115
    v_cvt_pk_bf16_f32 v238, v116, v117
    v_cvt_pk_bf16_f32 v239, v118, v119
    ds_write_b128 v12, v[236:239] offset:2048
    s_nop 0
    v_mfma_f32_16x16x32_bf16 v[4:7], v[236:239], v[236:239], v[4:7]
    v_cvt_pk_bf16_f32 v240, v120, v121
    v_cvt_pk_bf16_f32 v241, v122, v123
    v_cvt_pk_bf16_f32 v242, v124, v125
    v_cvt_pk_bf16_f32 v243, v126, v127
    ds_write_b128 v12, v[240:243] offset:3072
    s_nop 0
    v_mfma_f32_16x16x32_bf16 v[4:7], v[240:243], v[240:243], v[4:7]
    s_add_u32 s55, s51, 0
    buffer_load_dwordx4 a[200:203], v8, s[8:11], s55 offen offset:3072
    v_cvt_pk_bf16_f32 v236, v128, v129
    v_cvt_pk_bf16_f32 v237, v130, v131
    v_cvt_pk_bf16_f32 v238, v132, v133
    v_cvt_pk_bf16_f32 v239, v134, v135
    ds_write_b128 v12, v[236:239] offset:4096
    s_nop 0
    v_mfma_f32_16x16x32_bf16 v[4:7], v[236:239], v[236:239], v[4:7]
    s_waitcnt lgkmcnt(9)
    v_mfma_f32_16x16x32_bf16 v[136:139], a[104:107], a[88:91], v[136:139]
    v_mfma_f32_16x16x32_bf16 v[140:143], a[116:119], a[88:91], v[140:143]
    v_mfma_f32_16x16x32_bf16 v[144:147], a[128:131], a[88:91], v[144:147]
    s_add_u32 s55, s52, 0
    buffer_load_dwordx4 a[204:207], v8, s[8:11], s55 offen offset:3072
    v_mfma_f32_16x16x32_bf16 v[148:151], a[140:143], a[88:91], v[148:151]
    v_mfma_f32_16x16x32_bf16 v[152:155], a[152:155], a[88:91], v[152:155]
    s_waitcnt lgkmcnt(8)
    v_mfma_f32_16x16x32_bf16 v[136:139], a[108:111], a[92:95], v[136:139]
    v_mfma_f32_16x16x32_bf16 v[140:143], a[120:123], a[92:95], v[140:143]
    v_mfma_f32_16x16x32_bf16 v[144:147], a[132:135], a[92:95], v[144:147]
    v_mfma_f32_16x16x32_bf16 v[148:151], a[144:147], a[92:95], v[148:151]
    s_add_u32 s55, s50, 4096
    buffer_load_dwordx4 a[208:211], v8, s[8:11], s55 offen offset:0
    v_mfma_f32_16x16x32_bf16 v[152:155], a[156:159], a[92:95], v[152:155]
    s_waitcnt vmcnt(27)
    v_mfma_f32_16x16x16_bf16 v[136:139], v[10:11], v[36:37], v[136:139]
    s_waitcnt vmcnt(26)
    v_mfma_f32_16x16x16_bf16 v[140:143], v[10:11], v[40:41], v[140:143]
    s_waitcnt vmcnt(25)
    v_mfma_f32_16x16x16_bf16 v[144:147], v[10:11], v[44:45], v[144:147]
    s_waitcnt vmcnt(24)
    v_mfma_f32_16x16x16_bf16 v[148:151], v[10:11], v[48:49], v[148:151]
    s_waitcnt vmcnt(23)
    v_mfma_f32_16x16x16_bf16 v[152:155], v[10:11], v[52:53], v[152:155]
    s_add_u32 s55, s51, 4096
    buffer_load_dwordx4 a[212:215], v8, s[8:11], s55 offen offset:0
    ds_read_b128 a[84:87], v9 offset:13312
    ds_read_b128 a[88:91], v9 offset:13376
    ds_read_b128 a[92:95], v9 offset:13440
    s_waitcnt lgkmcnt(8)
    v_mfma_f32_16x16x32_bf16 v[156:159], a[100:103], a[96:99], v[252:255]
    v_mfma_f32_16x16x32_bf16 v[160:163], a[112:115], a[96:99], v[252:255]
    v_mfma_f32_16x16x32_bf16 v[164:167], a[124:127], a[96:99], v[252:255]
    v_mfma_f32_16x16x32_bf16 v[168:171], a[136:139], a[96:99], v[252:255]
    v_mfma_f32_16x16x32_bf16 v[172:175], a[148:151], a[96:99], v[252:255]
    s_add_u32 s55, s52, 4096
    buffer_load_dwordx4 a[216:219], v8, s[8:11], s55 offen offset:0
    v_cvt_pk_bf16_f32 v240, v136, v137
    v_cvt_pk_bf16_f32 v241, v138, v139
    v_cvt_pk_bf16_f32 v242, v140, v141
    v_cvt_pk_bf16_f32 v243, v142, v143
    ds_write_b128 v12, v[240:243] offset:5120
    s_nop 0
    v_mfma_f32_16x16x32_bf16 v[4:7], v[240:243], v[240:243], v[4:7]
    v_cvt_pk_bf16_f32 v236, v144, v145
    v_cvt_pk_bf16_f32 v237, v146, v147
    v_cvt_pk_bf16_f32 v238, v148, v149
    v_cvt_pk_bf16_f32 v239, v150, v151
    ds_write_b128 v12, v[236:239] offset:6144
    s_add_u32 s55, s50, 4096
    buffer_load_dwordx4 a[220:223], v8, s[8:11], s55 offen offset:1024
    v_mfma_f32_16x16x32_bf16 v[4:7], v[236:239], v[236:239], v[4:7]
    s_waitcnt lgkmcnt(9)
    v_mfma_f32_16x16x32_bf16 v[156:159], a[104:107], v[244:247], v[156:159]
    v_mfma_f32_16x16x32_bf16 v[160:163], a[116:119], v[244:247], v[160:163]
    v_mfma_f32_16x16x32_bf16 v[164:167], a[128:131], v[244:247], v[164:167]
    v_mfma_f32_16x16x32_bf16 v[168:171], a[140:143], v[244:247], v[168:171]
    v_mfma_f32_16x16x32_bf16 v[172:175], a[152:155], v[244:247], v[172:175]
    s_add_u32 s55, s51, 4096
    buffer_load_dwordx4 a[224:227], v8, s[8:11], s55 offen offset:1024
    s_waitcnt lgkmcnt(8)
    v_mfma_f32_16x16x32_bf16 v[156:159], a[108:111], v[248:251], v[156:159]
    v_mfma_f32_16x16x32_bf16 v[160:163], a[120:123], v[248:251], v[160:163]
    v_mfma_f32_16x16x32_bf16 v[164:167], a[132:135], v[248:251], v[164:167]
    v_mfma_f32_16x16x32_bf16 v[168:171], a[144:147], v[248:251], v[168:171]
    v_mfma_f32_16x16x32_bf16 v[172:175], a[156:159], v[248:251], v[172:175]
    s_nop 1
    v_mfma_f32_16x16x16_bf16 v[156:159], v[10:11], v[38:39], v[156:159]
    s_add_u32 s55, s52, 4096
    buffer_load_dwordx4 a[228:231], v8, s[8:11], s55 offen offset:1024
    v_mfma_f32_16x16x16_bf16 v[160:163], v[10:11], v[42:43], v[160:163]
    v_mfma_f32_16x16x16_bf16 v[164:167], v[10:11], v[46:47], v[164:167]
    v_mfma_f32_16x16x16_bf16 v[168:171], v[10:11], v[50:51], v[168:171]
    v_mfma_f32_16x16x16_bf16 v[172:175], v[10:11], v[54:55], v[172:175]
    ds_read_b128 a[96:99], v9 offset:16640
    ds_read_b128 v[244:247], v9 offset:16704
    ds_read_b128 v[248:251], v9 offset:16768
    s_waitcnt lgkmcnt(7)
    v_mfma_f32_16x16x32_bf16 v[176:179], a[100:103], a[84:87], v[252:255]
    s_add_u32 s55, s50, 4096
    buffer_load_dwordx4 a[232:235], v8, s[8:11], s55 offen offset:2048
    v_mfma_f32_16x16x32_bf16 v[180:183], a[112:115], a[84:87], v[252:255]
    v_mfma_f32_16x16x32_bf16 v[184:187], a[124:127], a[84:87], v[252:255]
    v_mfma_f32_16x16x32_bf16 v[188:191], a[136:139], a[84:87], v[252:255]
    v_mfma_f32_16x16x32_bf16 v[192:195], a[148:151], a[84:87], v[252:255]
    v_cvt_pk_bf16_f32 v240, v152, v153
    v_cvt_pk_bf16_f32 v241, v154, v155
    v_cvt_pk_bf16_f32 v242, v156, v157
    v_cvt_pk_bf16_f32 v243, v158, v159
    s_add_u32 s55, s51, 4096
    buffer_load_dwordx4 a[236:239], v8, s[8:11], s55 offen offset:2048
    ds_write_b128 v12, v[240:243] offset:7168
    v_mfma_f32_16x16x32_bf16 v[4:7], v[240:243], v[240:243], v[4:7]
    v_cvt_pk_bf16_f32 v236, v160, v161
    v_cvt_pk_bf16_f32 v237, v162, v163
    v_cvt_pk_bf16_f32 v238, v164, v165
    v_cvt_pk_bf16_f32 v239, v166, v167
    ds_write_b128 v12, v[236:239] offset:8192
    s_nop 0
    v_mfma_f32_16x16x32_bf16 v[4:7], v[236:239], v[236:239], v[4:7]
    v_cvt_pk_bf16_f32 v240, v168, v169
    v_cvt_pk_bf16_f32 v241, v170, v171
    s_add_u32 s55, s52, 4096
    buffer_load_dwordx4 a[240:243], v8, s[8:11], s55 offen offset:2048
    v_cvt_pk_bf16_f32 v242, v172, v173
    v_cvt_pk_bf16_f32 v243, v174, v175
    ds_write_b128 v12, v[240:243] offset:9216
    s_nop 0
    v_mfma_f32_16x16x32_bf16 v[4:7], v[240:243], v[240:243], v[4:7]
    s_waitcnt lgkmcnt(9)
    v_mfma_f32_16x16x32_bf16 v[176:179], a[104:107], a[88:91], v[176:179]
    v_mfma_f32_16x16x32_bf16 v[180:183], a[116:119], a[88:91], v[180:183]
    v_mfma_f32_16x16x32_bf16 v[184:187], a[128:131], a[88:91], v[184:187]
    v_mfma_f32_16x16x32_bf16 v[188:191], a[140:143], a[88:91], v[188:191]
    s_add_u32 s55, s50, 4096
    buffer_load_dwordx4 a[244:247], v8, s[8:11], s55 offen offset:3072
    v_mfma_f32_16x16x32_bf16 v[192:195], a[152:155], a[88:91], v[192:195]
    s_waitcnt lgkmcnt(8)
    v_mfma_f32_16x16x32_bf16 v[176:179], a[108:111], a[92:95], v[176:179]
    v_mfma_f32_16x16x32_bf16 v[180:183], a[120:123], a[92:95], v[180:183]
    v_mfma_f32_16x16x32_bf16 v[184:187], a[132:135], a[92:95], v[184:187]
    v_mfma_f32_16x16x32_bf16 v[188:191], a[144:147], a[92:95], v[188:191]
    v_mfma_f32_16x16x32_bf16 v[192:195], a[156:159], a[92:95], v[192:195]
    s_add_u32 s55, s51, 4096
    buffer_load_dwordx4 a[248:251], v8, s[8:11], s55 offen offset:3072
    s_waitcnt vmcnt(32)
    v_mfma_f32_16x16x16_bf16 v[176:179], v[10:11], v[56:57], v[176:179]
    s_waitcnt vmcnt(31)
    v_mfma_f32_16x16x16_bf16 v[180:183], v[10:11], v[60:61], v[180:183]
    s_waitcnt vmcnt(30)
    v_mfma_f32_16x16x16_bf16 v[184:187], v[10:11], v[64:65], v[184:187]
    s_waitcnt vmcnt(29)
    v_mfma_f32_16x16x16_bf16 v[188:191], v[10:11], v[68:69], v[188:191]
    s_waitcnt vmcnt(28)
    v_mfma_f32_16x16x16_bf16 v[192:195], v[10:11], v[72:73], v[192:195]
    ds_read_b128 a[84:87], v9 offset:19968
    ds_read_b128 a[88:91], v9 offset:20032
    s_add_u32 s55, s52, 4096
    buffer_load_dwordx4 a[252:255], v8, s[8:11], s55 offen offset:3072
    ds_read_b128 a[92:95], v9 offset:20096
    s_waitcnt lgkmcnt(8)
    v_mfma_f32_16x16x32_bf16 v[196:199], a[100:103], a[96:99], v[252:255]
    v_mfma_f32_16x16x32_bf16 v[200:203], a[112:115], a[96:99], v[252:255]
    v_mfma_f32_16x16x32_bf16 v[204:207], a[124:127], a[96:99], v[252:255]
    v_mfma_f32_16x16x32_bf16 v[208:211], a[136:139], a[96:99], v[252:255]
    v_mfma_f32_16x16x32_bf16 v[212:215], a[148:151], a[96:99], v[252:255]
    v_cvt_pk_bf16_f32 v236, v176, v177
    s_add_u32 s55, s50, 8192
    buffer_load_dwordx4 a[0:3], v8, s[8:11], s55 offen offset:0
    v_cvt_pk_bf16_f32 v237, v178, v179
    v_cvt_pk_bf16_f32 v238, v180, v181
    v_cvt_pk_bf16_f32 v239, v182, v183
    ds_write_b128 v12, v[236:239] offset:10240
    s_nop 0
    v_mfma_f32_16x16x32_bf16 v[4:7], v[236:239], v[236:239], v[4:7]
    v_cvt_pk_bf16_f32 v240, v184, v185
    v_cvt_pk_bf16_f32 v241, v186, v187
    v_cvt_pk_bf16_f32 v242, v188, v189
    v_cvt_pk_bf16_f32 v243, v190, v191
    ds_write_b128 v12, v[240:243] offset:11264
    s_nop 0
    v_mfma_f32_16x16x32_bf16 v[4:7], v[240:243], v[240:243], v[4:7]
    s_add_u32 s55, s51, 8192
    buffer_load_dwordx4 a[4:7], v8, s[8:11], s55 offen offset:0
    s_waitcnt lgkmcnt(9)
    v_mfma_f32_16x16x32_bf16 v[196:199], a[104:107], v[244:247], v[196:199]
    v_mfma_f32_16x16x32_bf16 v[200:203], a[116:119], v[244:247], v[200:203]
    v_mfma_f32_16x16x32_bf16 v[204:207], a[128:131], v[244:247], v[204:207]
    v_mfma_f32_16x16x32_bf16 v[208:211], a[140:143], v[244:247], v[208:211]
    v_mfma_f32_16x16x32_bf16 v[212:215], a[152:155], v[244:247], v[212:215]
    s_waitcnt lgkmcnt(8)
    v_mfma_f32_16x16x32_bf16 v[196:199], a[108:111], v[248:251], v[196:199]
    s_add_u32 s55, s52, 8192
    buffer_load_dwordx4 a[8:11], v8, s[8:11], s55 offen offset:0
    v_mfma_f32_16x16x32_bf16 v[200:203], a[120:123], v[248:251], v[200:203]
    v_mfma_f32_16x16x32_bf16 v[204:207], a[132:135], v[248:251], v[204:207]
    v_mfma_f32_16x16x32_bf16 v[208:211], a[144:147], v[248:251], v[208:211]
    v_mfma_f32_16x16x32_bf16 v[212:215], a[156:159], v[248:251], v[212:215]
    v_mfma_f32_16x16x16_bf16 v[196:199], v[10:11], v[58:59], v[196:199]
    s_nop 1
    v_mfma_f32_16x16x16_bf16 v[200:203], v[10:11], v[62:63], v[200:203]
    s_add_u32 s55, s50, 8192
    buffer_load_dwordx4 a[12:15], v8, s[8:11], s55 offen offset:1024
    v_mfma_f32_16x16x16_bf16 v[204:207], v[10:11], v[66:67], v[204:207]
    v_mfma_f32_16x16x16_bf16 v[208:211], v[10:11], v[70:71], v[208:211]
    v_mfma_f32_16x16x16_bf16 v[212:215], v[10:11], v[74:75], v[212:215]
    ds_read_b128 a[96:99], v9 offset:23296
    ds_read_b128 v[16:19], v9 offset:23360
    ds_read_b128 v[20:23], v9 offset:23424
    s_waitcnt lgkmcnt(7)
    v_mfma_f32_16x16x32_bf16 v[216:219], a[100:103], a[84:87], v[252:255]
    v_mfma_f32_16x16x32_bf16 v[220:223], a[112:115], a[84:87], v[252:255]
    s_add_u32 s55, s51, 8192
    buffer_load_dwordx4 a[16:19], v8, s[8:11], s55 offen offset:1024
    v_mfma_f32_16x16x32_bf16 v[224:227], a[124:127], a[84:87], v[252:255]
    v_mfma_f32_16x16x32_bf16 v[228:231], a[136:139], a[84:87], v[252:255]
    v_mfma_f32_16x16x32_bf16 v[232:235], a[148:151], a[84:87], v[252:255]
    v_cvt_pk_bf16_f32 v236, v192, v193
    v_cvt_pk_bf16_f32 v237, v194, v195
    v_cvt_pk_bf16_f32 v238, v196, v197
    v_cvt_pk_bf16_f32 v239, v198, v199
    ds_write_b128 v12, v[236:239] offset:12288
    s_nop 0
    v_mfma_f32_16x16x32_bf16 v[4:7], v[236:239], v[236:239], v[4:7]
    s_add_u32 s55, s52, 8192
    buffer_load_dwordx4 a[20:23], v8, s[8:11], s55 offen offset:1024
    v_cvt_pk_bf16_f32 v240, v200, v201
    v_cvt_pk_bf16_f32 v241, v202, v203
    v_cvt_pk_bf16_f32 v242, v204, v205
    v_cvt_pk_bf16_f32 v243, v206, v207
    ds_write_b128 v12, v[240:243] offset:13312
    s_nop 0
    v_mfma_f32_16x16x32_bf16 v[4:7], v[240:243], v[240:243], v[4:7]
    v_cvt_pk_bf16_f32 v236, v208, v209
    v_cvt_pk_bf16_f32 v237, v210, v211
    v_cvt_pk_bf16_f32 v238, v212, v213
    v_cvt_pk_bf16_f32 v239, v214, v215
    ds_write_b128 v12, v[236:239] offset:14336
    s_add_u32 s55, s50, 8192
    buffer_load_dwordx4 a[24:27], v8, s[8:11], s55 offen offset:2048
    v_mfma_f32_16x16x32_bf16 v[4:7], v[236:239], v[236:239], v[4:7]
    s_waitcnt lgkmcnt(9)
    v_mfma_f32_16x16x32_bf16 v[216:219], a[104:107], a[88:91], v[216:219]
    v_mfma_f32_16x16x32_bf16 v[220:223], a[116:119], a[88:91], v[220:223]
    v_mfma_f32_16x16x32_bf16 v[224:227], a[128:131], a[88:91], v[224:227]
    v_mfma_f32_16x16x32_bf16 v[228:231], a[140:143], a[88:91], v[228:231]
    v_mfma_f32_16x16x32_bf16 v[232:235], a[152:155], a[88:91], v[232:235]
    s_add_u32 s55, s51, 8192
    buffer_load_dwordx4 a[28:31], v8, s[8:11], s55 offen offset:2048
    s_waitcnt lgkmcnt(8)
    v_mfma_f32_16x16x32_bf16 v[216:219], a[108:111], a[92:95], v[216:219]
    v_mfma_f32_16x16x32_bf16 v[220:223], a[120:123], a[92:95], v[220:223]
    v_mfma_f32_16x16x32_bf16 v[224:227], a[132:135], a[92:95], v[224:227]
    v_mfma_f32_16x16x32_bf16 v[228:231], a[144:147], a[92:95], v[228:231]
    v_mfma_f32_16x16x32_bf16 v[232:235], a[156:159], a[92:95], v[232:235]
    s_waitcnt vmcnt(36)
    s_nop 0
    v_mfma_f32_16x16x16_bf16 v[216:219], v[10:11], v[76:77], v[216:219]
    s_add_u32 s55, s52, 8192
    buffer_load_dwordx4 a[32:35], v8, s[8:11], s55 offen offset:2048
    s_waitcnt vmcnt(36)
    v_mfma_f32_16x16x16_bf16 v[220:223], v[10:11], v[80:81], v[220:223]
    s_waitcnt vmcnt(35)
    v_mfma_f32_16x16x16_bf16 v[224:227], v[10:11], v[84:85], v[224:227]
    s_waitcnt vmcnt(34)
    v_mfma_f32_16x16x16_bf16 v[228:231], v[10:11], v[88:89], v[228:231]
    s_waitcnt vmcnt(33)
    v_mfma_f32_16x16x16_bf16 v[232:235], v[10:11], v[92:93], v[232:235]
    s_waitcnt lgkmcnt(5)
    v_mfma_f32_16x16x32_bf16 v[236:239], a[100:103], a[96:99], v[252:255]
    v_mfma_f32_16x16x32_bf16 v[240:243], a[112:115], a[96:99], v[252:255]
    s_add_u32 s55, s50, 8192
    buffer_load_dwordx4 a[36:39], v8, s[8:11], s55 offen offset:3072
    v_mfma_f32_16x16x32_bf16 v[244:247], a[124:127], a[96:99], v[252:255]
    v_mfma_f32_16x16x32_bf16 v[248:251], a[136:139], a[96:99], v[252:255]
    v_mfma_f32_16x16x32_bf16 v[252:255], a[148:151], a[96:99], v[252:255]
    v_cvt_pk_bf16_f32 v36, v216, v217
    v_cvt_pk_bf16_f32 v37, v218, v219
    v_cvt_pk_bf16_f32 v38, v220, v221
    v_cvt_pk_bf16_f32 v39, v222, v223
    ds_write_b128 v12, v[36:39] offset:15360
    s_nop 0
    v_mfma_f32_16x16x32_bf16 v[4:7], v[36:39], v[36:39], v[4:7]
    s_add_u32 s55, s51, 8192
    buffer_load_dwordx4 a[40:43], v8, s[8:11], s55 offen offset:3072
    v_cvt_pk_bf16_f32 v24, v224, v225
    v_cvt_pk_bf16_f32 v25, v226, v227
    v_cvt_pk_bf16_f32 v26, v228, v229
    v_cvt_pk_bf16_f32 v27, v230, v231
    ds_write_b128 v12, v[24:27] offset:16384
    s_nop 0
    v_mfma_f32_16x16x32_bf16 v[4:7], v[24:27], v[24:27], v[4:7]
    s_waitcnt lgkmcnt(6)
    v_mfma_f32_16x16x32_bf16 v[236:239], a[104:107], v[16:19], v[236:239]
    v_mfma_f32_16x16x32_bf16 v[240:243], a[116:119], v[16:19], v[240:243]
    v_mfma_f32_16x16x32_bf16 v[244:247], a[128:131], v[16:19], v[244:247]
    s_add_u32 s55, s52, 8192
    buffer_load_dwordx4 a[44:47], v8, s[8:11], s55 offen offset:3072
    v_mfma_f32_16x16x32_bf16 v[248:251], a[140:143], v[16:19], v[248:251]
    v_mfma_f32_16x16x32_bf16 v[252:255], a[152:155], v[16:19], v[252:255]
    s_waitcnt lgkmcnt(5)
    v_mfma_f32_16x16x32_bf16 v[236:239], a[108:111], v[20:23], v[236:239]
    v_mfma_f32_16x16x32_bf16 v[240:243], a[120:123], v[20:23], v[240:243]
    v_mfma_f32_16x16x32_bf16 v[244:247], a[132:135], v[20:23], v[244:247]
    v_mfma_f32_16x16x32_bf16 v[248:251], a[144:147], v[20:23], v[248:251]
    s_add_u32 s55, s50, 12288
    buffer_load_dwordx4 a[48:51], v8, s[8:11], s55 offen offset:0
    v_mfma_f32_16x16x32_bf16 v[252:255], a[156:159], v[20:23], v[252:255]
    v_mfma_f32_16x16x16_bf16 v[236:239], v[10:11], v[78:79], v[236:239]
    v_mfma_f32_16x16x16_bf16 v[240:243], v[10:11], v[82:83], v[240:243]
    v_mfma_f32_16x16x16_bf16 v[244:247], v[10:11], v[86:87], v[244:247]
    v_mfma_f32_16x16x16_bf16 v[248:251], v[10:11], v[90:91], v[248:251]
    s_nop 1
    v_mfma_f32_16x16x16_bf16 v[252:255], v[10:11], v[94:95], v[252:255]
    s_add_u32 s55, s51, 12288
    buffer_load_dwordx4 a[52:55], v8, s[8:11], s55 offen offset:0
    v_cvt_pk_bf16_f32 v28, v232, v233
    v_cvt_pk_bf16_f32 v29, v234, v235
    v_cvt_pk_bf16_f32 v30, v236, v237
    v_cvt_pk_bf16_f32 v31, v238, v239
    ds_write_b128 v12, v[28:31] offset:17408
    s_nop 0
    v_mfma_f32_16x16x32_bf16 v[4:7], v[28:31], v[28:31], v[4:7]
    s_add_u32 s55, s52, 12288
    buffer_load_dwordx4 a[56:59], v8, s[8:11], s55 offen offset:0
    v_cvt_pk_bf16_f32 v32, v240, v241
    v_cvt_pk_bf16_f32 v33, v242, v243
    v_cvt_pk_bf16_f32 v34, v244, v245
    v_cvt_pk_bf16_f32 v35, v246, v247
    ds_write_b128 v12, v[32:35] offset:18432
    s_nop 0
    v_mfma_f32_16x16x32_bf16 v[4:7], v[32:35], v[32:35], v[4:7]
    s_add_u32 s55, s50, 12288
    buffer_load_dwordx4 a[60:63], v8, s[8:11], s55 offen offset:1024
    v_cvt_pk_bf16_f32 v36, v248, v249
    v_cvt_pk_bf16_f32 v37, v250, v251
    v_cvt_pk_bf16_f32 v38, v252, v253
    v_cvt_pk_bf16_f32 v39, v254, v255
    ds_write_b128 v12, v[36:39] offset:19456
    s_nop 0
    v_mfma_f32_16x16x32_bf16 v[4:7], v[36:39], v[36:39], v[4:7]
    s_add_u32 s55, s51, 12288
    buffer_load_dwordx4 a[64:67], v8, s[8:11], s55 offen offset:1024
    v_and_b32 v9, 3, v2
    v_cmp_eq_u32 vcc, 1, v9
    s_nop 3
    v_cndmask_b32 v4, v4, v5, vcc
    v_cmp_eq_u32 vcc, 2, v9
    s_nop 1
    v_cndmask_b32 v4, v4, v6, vcc
    v_cmp_eq_u32 vcc, 3, v9
    s_add_u32 s55, s52, 12288
    buffer_load_dwordx4 a[68:71], v8, s[8:11], s55 offen offset:1024
    v_cndmask_b32 v4, v4, v7, vcc
    v_sub_f32 v10, v14, v15
    v_mul_f32 v12, 0x3acccccd, v4
    v_fma_f32 v12, -v10, v10, v12
    v_cvt_pk_bf16_f32 v13, v11, v12
    v_lshlrev_b32 v11, 16, v13
    s_add_u32 s55, s50, 12288
    buffer_load_dwordx4 a[72:75], v8, s[8:11], s55 offen offset:2048
    v_and_b32 v12, 0xffff0000, v13
    v_add_f32 v12, 0x3727c5ac, v12
    v_cvt_pk_bf16_f32 v13, v11, v12
    v_lshlrev_b32 v11, 16, v13
    v_and_b32 v12, 0xffff0000, v13
    v_sqrt_f32 v12, v12
    s_add_u32 s55, s51, 12288
    buffer_load_dwordx4 a[76:79], v8, s[8:11], s55 offen offset:2048
    v_cvt_pk_bf16_f32 v13, v11, v12
    v_lshlrev_b32 v11, 16, v13
    v_and_b32 v12, 0xffff0000, v13
    v_rcp_f32 v12, v12
    s_lshl_b32 s49, s44, 6
    s_add_u32 s49, s49, 151296
    s_add_u32 s55, s52, 12288
    buffer_load_dwordx4 a[80:83], v8, s[8:11], s55 offen offset:2048
    v_lshl_add_u32 v13, v2, 2, s49
    v_lshrrev_b32 v9, 2, v2
    v_cmp_eq_u32 vcc, v9, v3
    s_nop 0
    s_and_saveexec_b64 s[62:63], vcc
    ds_write_b32 v13, v12
    s_mov_b64 exec, -1
    s_waitcnt lgkmcnt(0)
    s_barrier
    s_mul_i32 s67, s41, 245760
    s_mul_i32 s49, s44, 12288
    s_add_u32 s55, s50, 12288
    buffer_load_dwordx4 a[84:87], v8, s[8:11], s55 offen offset:3072
    s_add_u32 s67, s67, s49
    s_add_u32 s67, s67, s65
    v_lshlrev_b32 v13, 2, v2
    v_add_u32 v13, 151296, v13
    ds_read_b32 v92, v13 offset:0
    ds_read_b32 v93, v13 offset:64
    s_add_u32 s55, s51, 12288
    buffer_load_dwordx4 a[88:91], v8, s[8:11], s55 offen offset:3072
    ds_read_b32 v94, v13 offset:128
    ds_read_b32 v95, v13 offset:192
    v_add_u32 v9, 53248, v8
    s_mov_b32 s58, 0xbfb8aa3b
    s_lshl_b32 s45, s40, 2
    s_mul_i32 s45, s45, 49152
    s_add_u32 s55, s52, 12288
    buffer_load_dwordx4 a[92:95], v8, s[8:11], s55 offen offset:3072
    s_add_u32 s45, s45, s66
    s_lshr_b32 s46, s56, 1
    s_lshl_b32 s46, s46, 10
    s_add_u32 s46, s46, s45
    s_lshr_b32 s48, s57, 1
    s_lshl_b32 s48, s48, 10
    s_add_u32 s55, s50, 16384
    buffer_load_dwordx4 a[96:99], v8, s[8:11], s55 offen offset:0
    s_add_u32 s48, s48, s45
    s_lshl_b32 s49, s44, 11
    s_add_u32 s49, s49, 151552
    v_lshrrev_b32 v7, 1, v8
    v_add_u32 v7, s49, v7
    ds_read_b128 v[64:67], v8 offset:0
    s_add_u32 s55, s51, 16384
    buffer_load_dwordx4 a[100:103], v8, s[8:11], s55 offen offset:0
    ds_read_b128 v[68:71], v8 offset:26624
    ds_read_b128 v[72:75], v9 offset:0
    ds_read_b128 v[76:79], v9 offset:26624
    ds_read_b128 v[80:83], v8 offset:1024
    s_waitcnt vmcnt(49) lgkmcnt(4)
    v_mfma_f32_16x16x32_bf16 v[16:19], a[160:163], v[64:67], 0
    s_add_u32 s55, s52, 16384
    buffer_load_dwordx4 a[104:107], v8, s[8:11], s55 offen offset:0
    s_waitcnt vmcnt(49)
    v_mfma_f32_16x16x32_bf16 v[20:23], a[164:167], v[64:67], 0
    s_mul_i32 s63, s41, 20
    s_waitcnt vmcnt(48)
    v_mfma_f32_16x16x32_bf16 v[24:27], a[168:171], v[64:67], 0
    ds_read_b128 v[64:67], v8 offset:27648
    s_add_u32 s55, s50, 16384
    buffer_load_dwordx4 a[108:111], v8, s[8:11], s55 offen offset:1024
    s_waitcnt lgkmcnt(4)
    v_mfma_f32_16x16x32_bf16 v[28:31], a[160:163], v[68:71], 0
    s_mul_i32 s61, s41, 10
    v_mfma_f32_16x16x32_bf16 v[32:35], a[164:167], v[68:71], 0
    s_lshr_b32 s62, s61, 4
    s_add_u32 s55, s51, 16384
    buffer_load_dwordx4 a[112:115], v8, s[8:11], s55 offen offset:1024
    v_mfma_f32_16x16x32_bf16 v[36:39], a[168:171], v[68:71], 0
    ds_read_b128 v[68:71], v9 offset:1024
    s_waitcnt lgkmcnt(4)
    v_mfma_f32_16x16x32_bf16 v[40:43], a[160:163], v[72:75], 0
    s_min_u32 s62, s62, 3
    s_add_u32 s55, s52, 16384
    buffer_load_dwordx4 a[116:119], v8, s[8:11], s55 offen offset:1024
    v_mfma_f32_16x16x32_bf16 v[44:47], a[164:167], v[72:75], 0
    v_mfma_f32_16x16x32_bf16 v[48:51], a[168:171], v[72:75], 0
    s_lshl_b32 s63, s62, 2
    ds_read_b128 v[72:75], v9 offset:27648
    s_add_u32 s55, s50, 16384
    buffer_load_dwordx4 a[120:123], v8, s[8:11], s55 offen offset:2048
    s_waitcnt lgkmcnt(4)
    v_mfma_f32_16x16x32_bf16 v[52:55], a[160:163], v[76:79], 0
    s_lshl_b32 s62, s62, 4
    v_mfma_f32_16x16x32_bf16 v[56:59], a[164:167], v[76:79], 0
    v_mfma_f32_16x16x32_bf16 v[60:63], a[168:171], v[76:79], 0
    s_add_u32 s55, s51, 16384
    buffer_load_dwordx4 a[124:127], v8, s[8:11], s55 offen offset:2048
    s_sub_u32 s62, s62, s61
    ds_read_b128 v[76:79], v8 offset:2048
    s_waitcnt vmcnt(52) lgkmcnt(4)
    v_mfma_f32_16x16x32_bf16 v[16:19], a[172:175], v[80:83], v[16:19]
    s_waitcnt vmcnt(51)
    v_mfma_f32_16x16x32_bf16 v[20:23], a[176:179], v[80:83], v[20:23]
    s_add_u32 s55, s52, 16384
    buffer_load_dwordx4 a[128:131], v8, s[8:11], s55 offen offset:2048
    v_lshl_add_u32 v0, v3, 2, s62
    s_waitcnt vmcnt(51)
    v_mfma_f32_16x16x32_bf16 v[24:27], a[180:183], v[80:83], v[24:27]
    s_add_u32 s61, s59, 20480
    ds_read_b128 v[80:83], v8 offset:28672
    s_waitcnt lgkmcnt(4)
    v_mfma_f32_16x16x32_bf16 v[28:31], a[172:175], v[64:67], v[28:31]
    s_add_u32 s55, s50, 16384
    buffer_load_dwordx4 a[132:135], v8, s[8:11], s55 offen offset:3072
    v_mfma_f32_16x16x32_bf16 v[32:35], a[176:179], v[64:67], v[32:35]
    v_mul_u32_u24 v1, 176, v2
    v_mfma_f32_16x16x32_bf16 v[36:39], a[180:183], v[64:67], v[36:39]
    ds_read_b128 v[64:67], v9 offset:2048
    s_add_u32 s55, s51, 16384
    buffer_load_dwordx4 a[136:139], v8, s[8:11], s55 offen offset:3072
    s_waitcnt lgkmcnt(4)
    v_mfma_f32_16x16x32_bf16 v[40:43], a[172:175], v[68:71], v[40:43]
    v_add_u32 v1, s61, v1
    v_mfma_f32_16x16x32_bf16 v[44:47], a[176:179], v[68:71], v[44:47]
    s_set_gpr_idx_on s63, 0x1
    v_add_f32 v84, v96, v15
    v_add_f32 v85, v116, v15
    s_set_gpr_idx_off
    v_mfma_f32_16x16x32_bf16 v[48:51], a[180:183], v[68:71], v[48:51]
    s_add_u32 s55, s52, 16384
    buffer_load_dwordx4 a[140:143], v8, s[8:11], s55 offen offset:3072
    ds_read_b128 v[68:71], v9 offset:28672
    s_waitcnt lgkmcnt(4)
    v_mfma_f32_16x16x32_bf16 v[52:55], a[172:175], v[72:75], v[52:55]
    v_cvt_pk_bf16_f32 v88, v84, v85
    v_mfma_f32_16x16x32_bf16 v[56:59], a[176:179], v[72:75], v[56:59]
    s_add_u32 s55, s67, 0
    buffer_load_dwordx4 a[160:163], v8, s[8:11], s55 offen offset:0
    v_mfma_f32_16x16x32_bf16 v[60:63], a[180:183], v[72:75], v[60:63]
    s_set_gpr_idx_on s63, 0x1
    v_add_f32 v84, v136, v15
    v_add_f32 v85, v156, v15
    s_set_gpr_idx_off
    ds_read_b128 v[72:75], v8 offset:3072
    s_waitcnt vmcnt(54) lgkmcnt(4)
    v_mfma_f32_16x16x32_bf16 v[16:19], a[184:187], v[76:79], v[16:19]
    v_cvt_pk_bf16_f32 v89, v84, v85
    s_waitcnt vmcnt(53)
    v_mfma_f32_16x16x32_bf16 v[20:23], a[188:191], v[76:79], v[20:23]
    s_waitcnt vmcnt(52)
    v_mfma_f32_16x16x32_bf16 v[24:27], a[192:195], v[76:79], v[24:27]
    s_add_u32 s55, s67, 49152
    buffer_load_dwordx4 a[164:167], v8, s[8:11], s55 offen offset:0
    s_set_gpr_idx_on s63, 0x1
    v_add_f32 v84, v176, v15
    v_add_f32 v85, v196, v15
    s_set_gpr_idx_off
    ds_read_b128 v[76:79], v8 offset:29696
    s_waitcnt lgkmcnt(4)
    v_mfma_f32_16x16x32_bf16 v[28:31], a[184:187], v[80:83], v[28:31]
    v_mfma_f32_16x16x32_bf16 v[32:35], a[188:191], v[80:83], v[32:35]
    v_cvt_pk_bf16_f32 v90, v84, v85
    v_mfma_f32_16x16x32_bf16 v[36:39], a[192:195], v[80:83], v[36:39]
    s_set_gpr_idx_on s63, 0x1
    v_add_f32 v84, v216, v15
    v_add_f32 v85, v236, v15
    s_set_gpr_idx_off
    ds_read_b128 v[80:83], v9 offset:3072
    s_waitcnt lgkmcnt(4)
    v_mfma_f32_16x16x32_bf16 v[40:43], a[184:187], v[64:67], v[40:43]
    s_add_u32 s55, s67, 98304
    buffer_load_dwordx4 a[168:171], v8, s[8:11], s55 offen offset:0
    v_mfma_f32_16x16x32_bf16 v[44:47], a[188:191], v[64:67], v[44:47]
    v_cvt_pk_bf16_f32 v91, v84, v85
    v_mfma_f32_16x16x32_bf16 v[48:51], a[192:195], v[64:67], v[48:51]
    ds_read_b128 v[64:67], v9 offset:29696
    s_waitcnt lgkmcnt(4)
    v_mfma_f32_16x16x32_bf16 v[52:55], a[184:187], v[68:71], v[52:55]
    v_add_u32 v84, 0, v0
    v_mfma_f32_16x16x32_bf16 v[56:59], a[188:191], v[68:71], v[56:59]
    s_add_u32 s55, s67, 147456
    buffer_load_dwordx4 a[172:175], v8, s[8:11], s55 offen offset:0
    v_lshl_add_u32 v85, v84, 4, v1
    v_mfma_f32_16x16x32_bf16 v[60:63], a[192:195], v[68:71], v[60:63]
    ds_read_b128 v[68:71], v8 offset:4096
    s_waitcnt vmcnt(54) lgkmcnt(4)
    v_mfma_f32_16x16x32_bf16 v[16:19], a[196:199], v[72:75], v[16:19]
    v_cmp_gt_u32 vcc, 10, v84
    s_nop 1
    s_and_saveexec_b64 s[68:69], vcc
    ds_write_b128 v85, v[88:91]
    s_mov_b64 exec, -1
    s_waitcnt vmcnt(53)
    v_mfma_f32_16x16x32_bf16 v[20:23], a[200:203], v[72:75], v[20:23]
    s_waitcnt vmcnt(52)
    v_mfma_f32_16x16x32_bf16 v[24:27], a[204:207], v[72:75], v[24:27]
    s_add_u32 s55, s67, 196608
    buffer_load_dwordx4 a[176:179], v8, s[8:11], s55 offen offset:0
    s_set_gpr_idx_on s63, 0x1
    v_add_f32 v84, v97, v15
    v_add_f32 v85, v117, v15
    s_set_gpr_idx_off
    ds_read_b128 v[72:75], v8 offset:30720
    s_waitcnt lgkmcnt(5)
    v_mfma_f32_16x16x32_bf16 v[28:31], a[196:199], v[76:79], v[28:31]
    v_cvt_pk_bf16_f32 v88, v84, v85
    v_mfma_f32_16x16x32_bf16 v[32:35], a[200:203], v[76:79], v[32:35]
    v_mfma_f32_16x16x32_bf16 v[36:39], a[204:207], v[76:79], v[36:39]
    s_set_gpr_idx_on s63, 0x1
    v_add_f32 v84, v137, v15
    v_add_f32 v85, v157, v15
    s_set_gpr_idx_off
    ds_read_b128 v[76:79], v9 offset:4096
    s_waitcnt lgkmcnt(5)
    v_mfma_f32_16x16x32_bf16 v[40:43], a[196:199], v[80:83], v[40:43]
    s_add_u32 s55, s67, 0
    buffer_load_dwordx4 a[180:183], v8, s[8:11], s55 offen offset:1024
    v_mfma_f32_16x16x32_bf16 v[44:47], a[200:203], v[80:83], v[44:47]
    v_cvt_pk_bf16_f32 v89, v84, v85
    v_mfma_f32_16x16x32_bf16 v[48:51], a[204:207], v[80:83], v[48:51]
    s_set_gpr_idx_on s63, 0x1
    v_add_f32 v84, v177, v15
    v_add_f32 v85, v197, v15
    s_set_gpr_idx_off
    ds_read_b128 v[80:83], v9 offset:30720
    s_waitcnt lgkmcnt(5)
    v_mfma_f32_16x16x32_bf16 v[52:55], a[196:199], v[64:67], v[52:55]
    v_mfma_f32_16x16x32_bf16 v[56:59], a[200:203], v[64:67], v[56:59]
    s_add_u32 s55, s67, 49152
    buffer_load_dwordx4 a[184:187], v8, s[8:11], s55 offen offset:1024
    v_cvt_pk_bf16_f32 v90, v84, v85
    v_mfma_f32_16x16x32_bf16 v[60:63], a[204:207], v[64:67], v[60:63]
    ds_read_b128 v[64:67], v8 offset:5120
    s_waitcnt vmcnt(54) lgkmcnt(5)
    v_mfma_f32_16x16x32_bf16 v[16:19], a[208:211], v[68:71], v[16:19]
    s_set_gpr_idx_on s63, 0x1
    v_add_f32 v84, v217, v15
    v_add_f32 v85, v237, v15
    s_set_gpr_idx_off
    s_waitcnt vmcnt(53)
    v_mfma_f32_16x16x32_bf16 v[20:23], a[212:215], v[68:71], v[20:23]
    v_cvt_pk_bf16_f32 v91, v84, v85
    s_waitcnt vmcnt(52)
    v_mfma_f32_16x16x32_bf16 v[24:27], a[216:219], v[68:71], v[24:27]
    s_add_u32 s55, s67, 98304
    buffer_load_dwordx4 a[188:191], v8, s[8:11], s55 offen offset:1024
    ds_read_b128 v[68:71], v8 offset:31744
    s_waitcnt lgkmcnt(4)
    v_mfma_f32_16x16x32_bf16 v[28:31], a[208:211], v[72:75], v[28:31]
    v_add_u32 v84, 1, v0
    v_mfma_f32_16x16x32_bf16 v[32:35], a[212:215], v[72:75], v[32:35]
    v_mfma_f32_16x16x32_bf16 v[36:39], a[216:219], v[72:75], v[36:39]
    v_lshl_add_u32 v85, v84, 4, v1
    ds_read_b128 v[72:75], v9 offset:5120
    s_add_u32 s55, s67, 147456
    buffer_load_dwordx4 a[192:195], v8, s[8:11], s55 offen offset:1024
    s_waitcnt lgkmcnt(4)
    v_mfma_f32_16x16x32_bf16 v[40:43], a[208:211], v[76:79], v[40:43]
    v_cmp_gt_u32 vcc, 10, v84
    s_nop 1
    s_and_saveexec_b64 s[68:69], vcc
    ds_write_b128 v85, v[88:91]
    s_mov_b64 exec, -1
    v_mfma_f32_16x16x32_bf16 v[44:47], a[212:215], v[76:79], v[44:47]
    v_mfma_f32_16x16x32_bf16 v[48:51], a[216:219], v[76:79], v[48:51]
    s_set_gpr_idx_on s63, 0x1
    v_add_f32 v84, v98, v15
    v_add_f32 v85, v118, v15
    s_set_gpr_idx_off
    ds_read_b128 v[76:79], v9 offset:31744
    s_waitcnt lgkmcnt(5)
    v_mfma_f32_16x16x32_bf16 v[52:55], a[208:211], v[80:83], v[52:55]
    v_mfma_f32_16x16x32_bf16 v[56:59], a[212:215], v[80:83], v[56:59]
    s_add_u32 s55, s67, 196608
    buffer_load_dwordx4 a[196:199], v8, s[8:11], s55 offen offset:1024
    v_cvt_pk_bf16_f32 v88, v84, v85
    v_mfma_f32_16x16x32_bf16 v[60:63], a[216:219], v[80:83], v[60:63]
    s_set_gpr_idx_on s63, 0x1
    v_add_f32 v84, v138, v15
    v_add_f32 v85, v158, v15
    s_set_gpr_idx_off
    ds_read_b128 v[80:83], v8 offset:6144
    s_waitcnt vmcnt(54) lgkmcnt(5)
    v_mfma_f32_16x16x32_bf16 v[16:19], a[220:223], v[64:67], v[16:19]
    s_waitcnt vmcnt(53)
    v_mfma_f32_16x16x32_bf16 v[20:23], a[224:227], v[64:67], v[20:23]
    v_cvt_pk_bf16_f32 v89, v84, v85
    s_waitcnt vmcnt(52)
    v_mfma_f32_16x16x32_bf16 v[24:27], a[228:231], v[64:67], v[24:27]
    s_add_u32 s55, s67, 0
    buffer_load_dwordx4 a[200:203], v8, s[8:11], s55 offen offset:2048
    ds_read_b128 v[64:67], v8 offset:32768
    s_waitcnt lgkmcnt(5)
    v_mfma_f32_16x16x32_bf16 v[28:31], a[220:223], v[68:71], v[28:31]
    s_set_gpr_idx_on s63, 0x1
    v_add_f32 v84, v178, v15
    v_add_f32 v85, v198, v15
    s_set_gpr_idx_off
    v_mfma_f32_16x16x32_bf16 v[32:35], a[224:227], v[68:71], v[32:35]
    v_cvt_pk_bf16_f32 v90, v84, v85
    v_mfma_f32_16x16x32_bf16 v[36:39], a[228:231], v[68:71], v[36:39]
    ds_read_b128 v[68:71], v9 offset:6144
    s_waitcnt lgkmcnt(5)
    v_mfma_f32_16x16x32_bf16 v[40:43], a[220:223], v[72:75], v[40:43]
    s_add_u32 s55, s67, 49152
    buffer_load_dwordx4 a[204:207], v8, s[8:11], s55 offen offset:2048
    s_set_gpr_idx_on s63, 0x1
    v_add_f32 v84, v218, v15
    v_add_f32 v85, v238, v15
    s_set_gpr_idx_off
    v_mfma_f32_16x16x32_bf16 v[44:47], a[224:227], v[72:75], v[44:47]
    v_mfma_f32_16x16x32_bf16 v[48:51], a[228:231], v[72:75], v[48:51]
    v_cvt_pk_bf16_f32 v91, v84, v85
    ds_read_b128 v[72:75], v9 offset:32768
    s_waitcnt lgkmcnt(4)
    v_mfma_f32_16x16x32_bf16 v[52:55], a[220:223], v[76:79], v[52:55]
    v_add_u32 v84, 2, v0
    v_mfma_f32_16x16x32_bf16 v[56:59], a[224:227], v[76:79], v[56:59]
    s_add_u32 s55, s67, 98304
    buffer_load_dwordx4 a[208:211], v8, s[8:11], s55 offen offset:2048
    v_mfma_f32_16x16x32_bf16 v[60:63], a[228:231], v[76:79], v[60:63]
    v_lshl_add_u32 v85, v84, 4, v1
    ds_read_b128 v[76:79], v8 offset:7168
    s_waitcnt vmcnt(54) lgkmcnt(4)
    v_mfma_f32_16x16x32_bf16 v[16:19], a[232:235], v[80:83], v[16:19]
    s_waitcnt vmcnt(53)
    v_mfma_f32_16x16x32_bf16 v[20:23], a[236:239], v[80:83], v[20:23]
    v_cmp_gt_u32 vcc, 10, v84
    s_nop 1
    s_and_saveexec_b64 s[68:69], vcc
    ds_write_b128 v85, v[88:91]
    s_mov_b64 exec, -1
    s_waitcnt vmcnt(52)
    v_mfma_f32_16x16x32_bf16 v[24:27], a[240:243], v[80:83], v[24:27]
    s_add_u32 s55, s67, 147456
    buffer_load_dwordx4 a[212:215], v8, s[8:11], s55 offen offset:2048
    s_set_gpr_idx_on s63, 0x1
    v_add_f32 v84, v99, v15
    v_add_f32 v85, v119, v15
    s_set_gpr_idx_off
    ds_read_b128 v[80:83], v8 offset:33792
    s_waitcnt lgkmcnt(5)
    v_mfma_f32_16x16x32_bf16 v[28:31], a[232:235], v[64:67], v[28:31]
    v_mfma_f32_16x16x32_bf16 v[32:35], a[236:239], v[64:67], v[32:35]
    v_cvt_pk_bf16_f32 v88, v84, v85
    v_mfma_f32_16x16x32_bf16 v[36:39], a[240:243], v[64:67], v[36:39]
    ds_read_b128 v[64:67], v9 offset:7168
    s_waitcnt lgkmcnt(5)
    v_mfma_f32_16x16x32_bf16 v[40:43], a[232:235], v[68:71], v[40:43]
    s_add_u32 s55, s67, 196608
    buffer_load_dwordx4 a[216:219], v8, s[8:11], s55 offen offset:2048
    s_set_gpr_idx_on s63, 0x1
    v_add_f32 v84, v139, v15
    v_add_f32 v85, v159, v15
    s_set_gpr_idx_off
    v_mfma_f32_16x16x32_bf16 v[44:47], a[236:239], v[68:71], v[44:47]
    v_cvt_pk_bf16_f32 v89, v84, v85
    v_mfma_f32_16x16x32_bf16 v[48:51], a[240:243], v[68:71], v[48:51]
    ds_read_b128 v[68:71], v9 offset:33792
    s_waitcnt lgkmcnt(5)
    v_mfma_f32_16x16x32_bf16 v[52:55], a[232:235], v[72:75], v[52:55]
    s_set_gpr_idx_on s63, 0x1
    v_add_f32 v84, v179, v15
    v_add_f32 v85, v199, v15
    s_set_gpr_idx_off
    v_mfma_f32_16x16x32_bf16 v[56:59], a[236:239], v[72:75], v[56:59]
    s_add_u32 s55, s67, 0
    buffer_load_dwordx4 a[220:223], v8, s[8:11], s55 offen offset:3072
    v_mfma_f32_16x16x32_bf16 v[60:63], a[240:243], v[72:75], v[60:63]
    v_cvt_pk_bf16_f32 v90, v84, v85
    ds_read_b128 v[72:75], v8 offset:8192
    s_waitcnt vmcnt(54) lgkmcnt(5)
    v_mfma_f32_16x16x32_bf16 v[16:19], a[244:247], v[76:79], v[16:19]
    s_set_gpr_idx_on s63, 0x1
    v_add_f32 v84, v219, v15
    v_add_f32 v85, v239, v15
    s_set_gpr_idx_off
    s_waitcnt vmcnt(53)
    v_mfma_f32_16x16x32_bf16 v[20:23], a[248:251], v[76:79], v[20:23]
    s_waitcnt vmcnt(52)
    v_mfma_f32_16x16x32_bf16 v[24:27], a[252:255], v[76:79], v[24:27]
    s_add_u32 s55, s67, 49152
    buffer_load_dwordx4 a[224:227], v8, s[8:11], s55 offen offset:3072
    v_cvt_pk_bf16_f32 v91, v84, v85
    ds_read_b128 v[76:79], v8 offset:34816
    s_waitcnt lgkmcnt(4)
    v_mfma_f32_16x16x32_bf16 v[28:31], a[244:247], v[80:83], v[28:31]
    v_mfma_f32_16x16x32_bf16 v[32:35], a[248:251], v[80:83], v[32:35]
    v_add_u32 v84, 3, v0
    v_mfma_f32_16x16x32_bf16 v[36:39], a[252:255], v[80:83], v[36:39]
    v_lshl_add_u32 v85, v84, 4, v1
    s_add_u32 s55, s67, 98304
    buffer_load_dwordx4 a[228:231], v8, s[8:11], s55 offen offset:3072
    ds_read_b128 v[80:83], v9 offset:8192
    s_waitcnt lgkmcnt(4)
    v_mfma_f32_16x16x32_bf16 v[40:43], a[244:247], v[64:67], v[40:43]
    v_mfma_f32_16x16x32_bf16 v[44:47], a[248:251], v[64:67], v[44:47]
    v_cmp_gt_u32 vcc, 10, v84
    s_nop 1
    s_and_saveexec_b64 s[68:69], vcc
    ds_write_b128 v85, v[88:91]
    s_mov_b64 exec, -1
    v_mfma_f32_16x16x32_bf16 v[48:51], a[252:255], v[64:67], v[48:51]
    ds_read_b128 v[64:67], v9 offset:34816
    s_waitcnt lgkmcnt(5)
    v_mfma_f32_16x16x32_bf16 v[52:55], a[244:247], v[68:71], v[52:55]
    s_add_u32 s55, s67, 147456
    buffer_load_dwordx4 a[232:235], v8, s[8:11], s55 offen offset:3072
    s_set_gpr_idx_on s63, 0x1
    v_add_f32 v84, v100, v15
    v_add_f32 v85, v120, v15
    s_set_gpr_idx_off
    v_mfma_f32_16x16x32_bf16 v[56:59], a[248:251], v[68:71], v[56:59]
    v_cvt_pk_bf16_f32 v88, v84, v85
    v_mfma_f32_16x16x32_bf16 v[60:63], a[252:255], v[68:71], v[60:63]
    ds_read_b128 v[68:71], v8 offset:9216
    s_waitcnt vmcnt(54) lgkmcnt(5)
    v_mfma_f32_16x16x32_bf16 v[16:19], a[0:3], v[72:75], v[16:19]
    s_set_gpr_idx_on s63, 0x1
    v_add_f32 v84, v140, v15
    v_add_f32 v85, v160, v15
    s_set_gpr_idx_off
    s_waitcnt vmcnt(53)
    v_mfma_f32_16x16x32_bf16 v[20:23], a[4:7], v[72:75], v[20:23]
    s_add_u32 s55, s67, 196608
    buffer_load_dwordx4 a[236:239], v8, s[8:11], s55 offen offset:3072
    s_waitcnt vmcnt(53)
    v_mfma_f32_16x16x32_bf16 v[24:27], a[8:11], v[72:75], v[24:27]
    v_cvt_pk_bf16_f32 v89, v84, v85
    ds_read_b128 v[72:75], v8 offset:35840
    s_waitcnt lgkmcnt(5)
    v_mfma_f32_16x16x32_bf16 v[28:31], a[0:3], v[76:79], v[28:31]
    s_set_gpr_idx_on s63, 0x1
    v_add_f32 v84, v180, v15
    v_add_f32 v85, v200, v15
    s_set_gpr_idx_off
    v_mfma_f32_16x16x32_bf16 v[32:35], a[4:7], v[76:79], v[32:35]
    v_mfma_f32_16x16x32_bf16 v[36:39], a[8:11], v[76:79], v[36:39]
    s_add_u32 s55, s67, 4096
    buffer_load_dwordx4 a[240:243], v8, s[8:11], s55 offen offset:0
    v_cvt_pk_bf16_f32 v90, v84, v85
    ds_read_b128 v[76:79], v9 offset:9216
    s_waitcnt lgkmcnt(5)
    v_mfma_f32_16x16x32_bf16 v[40:43], a[0:3], v[80:83], v[40:43]
    v_mfma_f32_16x16x32_bf16 v[44:47], a[4:7], v[80:83], v[44:47]
    s_set_gpr_idx_on s63, 0x1
    v_add_f32 v84, v220, v15
    v_add_f32 v85, v240, v15
    s_set_gpr_idx_off
    v_mfma_f32_16x16x32_bf16 v[48:51], a[8:11], v[80:83], v[48:51]
    v_cvt_pk_bf16_f32 v91, v84, v85
    ds_read_b128 v[80:83], v9 offset:35840
    s_add_u32 s55, s67, 53248
    buffer_load_dwordx4 a[244:247], v8, s[8:11], s55 offen offset:0
    s_waitcnt lgkmcnt(4)
    v_mfma_f32_16x16x32_bf16 v[52:55], a[0:3], v[64:67], v[52:55]
    v_mfma_f32_16x16x32_bf16 v[56:59], a[4:7], v[64:67], v[56:59]
    v_add_u32 v84, 16, v0
    v_mfma_f32_16x16x32_bf16 v[60:63], a[8:11], v[64:67], v[60:63]
    ds_read_b128 v[64:67], v8 offset:10240
    s_waitcnt vmcnt(54) lgkmcnt(4)
    v_mfma_f32_16x16x32_bf16 v[16:19], a[12:15], v[68:71], v[16:19]
    s_add_u32 s55, s67, 102400
    buffer_load_dwordx4 a[248:251], v8, s[8:11], s55 offen offset:0
    v_lshl_add_u32 v85, v84, 4, v1
    s_waitcnt vmcnt(54)
    v_mfma_f32_16x16x32_bf16 v[20:23], a[16:19], v[68:71], v[20:23]
    v_cmp_gt_u32 vcc, 10, v84
    s_nop 1
    s_and_saveexec_b64 s[68:69], vcc
    ds_write_b128 v85, v[88:91]
    s_mov_b64 exec, -1
    s_waitcnt vmcnt(53)
    v_mfma_f32_16x16x32_bf16 v[24:27], a[20:23], v[68:71], v[24:27]
    ds_read_b128 v[68:71], v8 offset:36864
    s_waitcnt lgkmcnt(5)
    v_mfma_f32_16x16x32_bf16 v[28:31], a[12:15], v[72:75], v[28:31]
    s_set_gpr_idx_on s63, 0x1
    v_add_f32 v84, v101, v15
    v_add_f32 v85, v121, v15
    s_set_gpr_idx_off
    v_mfma_f32_16x16x32_bf16 v[32:35], a[16:19], v[72:75], v[32:35]
    s_add_u32 s55, s67, 151552
    buffer_load_dwordx4 a[252:255], v8, s[8:11], s55 offen offset:0
    v_mfma_f32_16x16x32_bf16 v[36:39], a[20:23], v[72:75], v[36:39]
    v_cvt_pk_bf16_f32 v88, v84, v85
    ds_read_b128 v[72:75], v9 offset:10240
    s_waitcnt lgkmcnt(5)
    v_mfma_f32_16x16x32_bf16 v[40:43], a[12:15], v[76:79], v[40:43]
    s_set_gpr_idx_on s63, 0x1
    v_add_f32 v84, v141, v15
    v_add_f32 v85, v161, v15
    s_set_gpr_idx_off
    v_mfma_f32_16x16x32_bf16 v[44:47], a[16:19], v[76:79], v[44:47]
    v_mfma_f32_16x16x32_bf16 v[48:51], a[20:23], v[76:79], v[48:51]
    s_add_u32 s55, s67, 200704
    buffer_load_dwordx4 a[0:3], v8, s[8:11], s55 offen offset:0
    v_cvt_pk_bf16_f32 v89, v84, v85
    ds_read_b128 v[76:79], v9 offset:36864
    s_waitcnt lgkmcnt(5)
    v_mfma_f32_16x16x32_bf16 v[52:55], a[12:15], v[80:83], v[52:55]
    v_mfma_f32_16x16x32_bf16 v[56:59], a[16:19], v[80:83], v[56:59]
    s_set_gpr_idx_on s63, 0x1
    v_add_f32 v84, v181, v15
    v_add_f32 v85, v201, v15
    s_set_gpr_idx_off
    v_mfma_f32_16x16x32_bf16 v[60:63], a[20:23], v[80:83], v[60:63]
    v_cvt_pk_bf16_f32 v90, v84, v85
    ds_read_b128 v[80:83], v8 offset:11264
    s_add_u32 s55, s67, 4096
    buffer_load_dwordx4 a[4:7], v8, s[8:11], s55 offen offset:1024
    s_waitcnt vmcnt(55) lgkmcnt(5)
    v_mfma_f32_16x16x32_bf16 v[16:19], a[24:27], v[64:67], v[16:19]
    s_waitcnt vmcnt(54)
    v_mfma_f32_16x16x32_bf16 v[20:23], a[28:31], v[64:67], v[20:23]
    s_set_gpr_idx_on s63, 0x1
    v_add_f32 v84, v221, v15
    v_add_f32 v85, v241, v15
    s_set_gpr_idx_off
    s_waitcnt vmcnt(53)
    v_mfma_f32_16x16x32_bf16 v[24:27], a[32:35], v[64:67], v[24:27]
    ds_read_b128 v[64:67], v8 offset:37888
    s_waitcnt lgkmcnt(4)
    v_mfma_f32_16x16x32_bf16 v[28:31], a[24:27], v[68:71], v[28:31]
    v_cvt_pk_bf16_f32 v91, v84, v85
    s_add_u32 s55, s67, 53248
    buffer_load_dwordx4 a[8:11], v8, s[8:11], s55 offen offset:1024
    v_mfma_f32_16x16x32_bf16 v[32:35], a[28:31], v[68:71], v[32:35]
    v_add_u32 v84, 17, v0
    v_mfma_f32_16x16x32_bf16 v[36:39], a[32:35], v[68:71], v[36:39]
    ds_read_b128 v[68:71], v9 offset:11264
    s_waitcnt lgkmcnt(4)
    v_mfma_f32_16x16x32_bf16 v[40:43], a[24:27], v[72:75], v[40:43]
    v_lshl_add_u32 v85, v84, 4, v1
    v_mfma_f32_16x16x32_bf16 v[44:47], a[28:31], v[72:75], v[44:47]
    s_add_u32 s55, s67, 102400
    buffer_load_dwordx4 a[12:15], v8, s[8:11], s55 offen offset:1024
    v_mfma_f32_16x16x32_bf16 v[48:51], a[32:35], v[72:75], v[48:51]
    v_cmp_gt_u32 vcc, 10, v84
    s_nop 1
    s_and_saveexec_b64 s[68:69], vcc
    ds_write_b128 v85, v[88:91]
    s_mov_b64 exec, -1
    ds_read_b128 v[72:75], v9 offset:37888
    s_waitcnt lgkmcnt(5)
    v_mfma_f32_16x16x32_bf16 v[52:55], a[24:27], v[76:79], v[52:55]
    s_set_gpr_idx_on s63, 0x1
    v_add_f32 v84, v102, v15
    v_add_f32 v85, v122, v15
    s_set_gpr_idx_off
    v_mfma_f32_16x16x32_bf16 v[56:59], a[28:31], v[76:79], v[56:59]
    v_mfma_f32_16x16x32_bf16 v[60:63], a[32:35], v[76:79], v[60:63]
    v_cvt_pk_bf16_f32 v88, v84, v85
    s_add_u32 s55, s67, 151552
    buffer_load_dwordx4 a[16:19], v8, s[8:11], s55 offen offset:1024
    ds_read_b128 v[76:79], v8 offset:12288
    s_waitcnt vmcnt(55) lgkmcnt(5)
    v_mfma_f32_16x16x32_bf16 v[16:19], a[36:39], v[80:83], v[16:19]
    s_waitcnt vmcnt(54)
    v_mfma_f32_16x16x32_bf16 v[20:23], a[40:43], v[80:83], v[20:23]
    s_set_gpr_idx_on s63, 0x1
    v_add_f32 v84, v142, v15
    v_add_f32 v85, v162, v15
    s_set_gpr_idx_off
    s_waitcnt vmcnt(53)
    v_mfma_f32_16x16x32_bf16 v[24:27], a[44:47], v[80:83], v[24:27]
    v_cvt_pk_bf16_f32 v89, v84, v85
    ds_read_b128 v[80:83], v8 offset:38912
    s_waitcnt lgkmcnt(5)
    v_mfma_f32_16x16x32_bf16 v[28:31], a[36:39], v[64:67], v[28:31]
    s_add_u32 s55, s67, 200704
    buffer_load_dwordx4 a[20:23], v8, s[8:11], s55 offen offset:1024
    v_mfma_f32_16x16x32_bf16 v[32:35], a[40:43], v[64:67], v[32:35]
    s_set_gpr_idx_on s63, 0x1
    v_add_f32 v84, v182, v15
    v_add_f32 v85, v202, v15
    s_set_gpr_idx_off
    v_mfma_f32_16x16x32_bf16 v[36:39], a[44:47], v[64:67], v[36:39]
    ds_read_b128 v[64:67], v9 offset:12288
    s_waitcnt lgkmcnt(5)
    v_mfma_f32_16x16x32_bf16 v[40:43], a[36:39], v[68:71], v[40:43]
    v_cvt_pk_bf16_f32 v90, v84, v85
    v_mfma_f32_16x16x32_bf16 v[44:47], a[40:43], v[68:71], v[44:47]
    s_add_u32 s55, s67, 4096
    buffer_load_dwordx4 a[24:27], v8, s[8:11], s55 offen offset:2048
    s_set_gpr_idx_on s63, 0x1
    v_add_f32 v84, v222, v15
    v_add_f32 v85, v242, v15
    s_set_gpr_idx_off
    v_mfma_f32_16x16x32_bf16 v[48:51], a[44:47], v[68:71], v[48:51]
    ds_read_b128 v[68:71], v9 offset:38912
    s_waitcnt lgkmcnt(4)
    v_mfma_f32_16x16x32_bf16 v[52:55], a[36:39], v[72:75], v[52:55]
    v_cvt_pk_bf16_f32 v91, v84, v85
    v_mfma_f32_16x16x32_bf16 v[56:59], a[40:43], v[72:75], v[56:59]
    v_mfma_f32_16x16x32_bf16 v[60:63], a[44:47], v[72:75], v[60:63]
    s_add_u32 s55, s67, 53248
    buffer_load_dwordx4 a[28:31], v8, s[8:11], s55 offen offset:2048
    v_add_u32 v84, 18, v0
    ds_read_b128 v[72:75], v8 offset:13312
    s_waitcnt vmcnt(55) lgkmcnt(4)
    v_mfma_f32_16x16x32_bf16 v[16:19], a[48:51], v[76:79], v[16:19]
    v_lshl_add_u32 v85, v84, 4, v1
    s_waitcnt vmcnt(54)
    v_mfma_f32_16x16x32_bf16 v[20:23], a[52:55], v[76:79], v[20:23]
    s_waitcnt vmcnt(53)
    v_mfma_f32_16x16x32_bf16 v[24:27], a[56:59], v[76:79], v[24:27]
    v_cmp_gt_u32 vcc, 10, v84
    s_nop 1
    s_and_saveexec_b64 s[68:69], vcc
    ds_write_b128 v85, v[88:91]
    s_mov_b64 exec, -1
    ds_read_b128 v[76:79], v8 offset:39936
    s_add_u32 s55, s67, 102400
    buffer_load_dwordx4 a[32:35], v8, s[8:11], s55 offen offset:2048
    s_waitcnt lgkmcnt(5)
    v_mfma_f32_16x16x32_bf16 v[28:31], a[48:51], v[80:83], v[28:31]
    v_mfma_f32_16x16x32_bf16 v[32:35], a[52:55], v[80:83], v[32:35]
    s_set_gpr_idx_on s63, 0x1
    v_add_f32 v84, v103, v15
    v_add_f32 v85, v123, v15
    s_set_gpr_idx_off
    v_mfma_f32_16x16x32_bf16 v[36:39], a[56:59], v[80:83], v[36:39]
    v_cvt_pk_bf16_f32 v88, v84, v85
    ds_read_b128 v[80:83], v9 offset:13312
    s_waitcnt lgkmcnt(5)
    v_mfma_f32_16x16x32_bf16 v[40:43], a[48:51], v[64:67], v[40:43]
    s_add_u32 s55, s67, 151552
    buffer_load_dwordx4 a[36:39], v8, s[8:11], s55 offen offset:2048
    v_mfma_f32_16x16x32_bf16 v[44:47], a[52:55], v[64:67], v[44:47]
    s_set_gpr_idx_on s63, 0x1
    v_add_f32 v84, v143, v15
    v_add_f32 v85, v163, v15
    s_set_gpr_idx_off
    v_mfma_f32_16x16x32_bf16 v[48:51], a[56:59], v[64:67], v[48:51]
    ds_read_b128 v[64:67], v9 offset:39936
    s_waitcnt lgkmcnt(5)
    v_mfma_f32_16x16x32_bf16 v[52:55], a[48:51], v[68:71], v[52:55]
    v_cvt_pk_bf16_f32 v89, v84, v85
    v_mfma_f32_16x16x32_bf16 v[56:59], a[52:55], v[68:71], v[56:59]
    s_add_u32 s55, s67, 200704
    buffer_load_dwordx4 a[40:43], v8, s[8:11], s55 offen offset:2048
    s_set_gpr_idx_on s63, 0x1
    v_add_f32 v84, v183, v15
    v_add_f32 v85, v203, v15
    s_set_gpr_idx_off
    v_mfma_f32_16x16x32_bf16 v[60:63], a[56:59], v[68:71], v[60:63]
    ds_read_b128 v[68:71], v8 offset:14336
    s_waitcnt vmcnt(55) lgkmcnt(5)
    v_mfma_f32_16x16x32_bf16 v[16:19], a[60:63], v[72:75], v[16:19]
    v_cvt_pk_bf16_f32 v90, v84, v85
    s_waitcnt vmcnt(54)
    v_mfma_f32_16x16x32_bf16 v[20:23], a[64:67], v[72:75], v[20:23]
    s_waitcnt vmcnt(53)
    v_mfma_f32_16x16x32_bf16 v[24:27], a[68:71], v[72:75], v[24:27]
    s_add_u32 s55, s67, 4096
    buffer_load_dwordx4 a[44:47], v8, s[8:11], s55 offen offset:3072
    s_set_gpr_idx_on s63, 0x1
    v_add_f32 v84, v223, v15
    v_add_f32 v85, v243, v15
    s_set_gpr_idx_off
    ds_read_b128 v[72:75], v8 offset:40960
    s_waitcnt lgkmcnt(4)
    v_mfma_f32_16x16x32_bf16 v[28:31], a[60:63], v[76:79], v[28:31]
    v_cvt_pk_bf16_f32 v91, v84, v85
    v_mfma_f32_16x16x32_bf16 v[32:35], a[64:67], v[76:79], v[32:35]
    v_mfma_f32_16x16x32_bf16 v[36:39], a[68:71], v[76:79], v[36:39]
    v_add_u32 v84, 19, v0
    ds_read_b128 v[76:79], v9 offset:14336
    s_add_u32 s55, s67, 53248
    buffer_load_dwordx4 a[48:51], v8, s[8:11], s55 offen offset:3072
    s_waitcnt lgkmcnt(4)
    v_mfma_f32_16x16x32_bf16 v[40:43], a[60:63], v[80:83], v[40:43]
    v_mfma_f32_16x16x32_bf16 v[44:47], a[64:67], v[80:83], v[44:47]
    v_lshl_add_u32 v85, v84, 4, v1
    v_mfma_f32_16x16x32_bf16 v[48:51], a[68:71], v[80:83], v[48:51]
    v_cmp_gt_u32 vcc, 10, v84
    s_nop 1
    s_and_saveexec_b64 s[68:69], vcc
    ds_write_b128 v85, v[88:91]
    s_mov_b64 exec, -1
    ds_read_b128 v[80:83], v9 offset:40960
    s_waitcnt lgkmcnt(5)
    v_mfma_f32_16x16x32_bf16 v[52:55], a[60:63], v[64:67], v[52:55]
    s_add_u32 s55, s67, 102400
    buffer_load_dwordx4 a[52:55], v8, s[8:11], s55 offen offset:3072
    v_mfma_f32_16x16x32_bf16 v[56:59], a[64:67], v[64:67], v[56:59]
    v_lshl_add_u32 v1, v3, 3, v1
    v_mfma_f32_16x16x32_bf16 v[60:63], a[68:71], v[64:67], v[60:63]
    ds_read_b64 a[144:145], v1 offset:0
    ds_read_b64 a[146:147], v1 offset:32
    ds_read_b64 a[148:149], v1 offset:64
    ds_read_b64 a[150:151], v1 offset:96
    ds_read_b64 a[152:153], v1 offset:128
    ds_read_b128 v[64:67], v8 offset:15360
    s_waitcnt vmcnt(55) lgkmcnt(10)
    v_mfma_f32_16x16x32_bf16 v[16:19], a[72:75], v[68:71], v[16:19]
    s_waitcnt vmcnt(54)
    v_mfma_f32_16x16x32_bf16 v[20:23], a[76:79], v[68:71], v[20:23]
    s_add_u32 s55, s67, 151552
    buffer_load_dwordx4 a[56:59], v8, s[8:11], s55 offen offset:3072
    s_waitcnt vmcnt(54)
    v_mfma_f32_16x16x32_bf16 v[24:27], a[80:83], v[68:71], v[24:27]
    ds_read_b128 v[68:71], v8 offset:16384
    s_waitcnt lgkmcnt(10)
    v_mfma_f32_16x16x32_bf16 v[28:31], a[72:75], v[72:75], v[28:31]
    v_mfma_f32_16x16x32_bf16 v[32:35], a[76:79], v[72:75], v[32:35]
    v_mfma_f32_16x16x32_bf16 v[36:39], a[80:83], v[72:75], v[36:39]
    ds_read_b128 v[72:75], v8 offset:17408
    s_add_u32 s55, s67, 200704
    buffer_load_dwordx4 a[60:63], v8, s[8:11], s55 offen offset:3072
    s_waitcnt lgkmcnt(10)
    v_mfma_f32_16x16x32_bf16 v[40:43], a[72:75], v[76:79], v[40:43]
    v_mfma_f32_16x16x32_bf16 v[44:47], a[76:79], v[76:79], v[44:47]
    v_mfma_f32_16x16x32_bf16 v[48:51], a[80:83], v[76:79], v[48:51]
    ds_read_b128 v[76:79], v8 offset:18432
    s_waitcnt lgkmcnt(9)
    v_mfma_f32_16x16x32_bf16 v[52:55], a[72:75], v[80:83], v[52:55]
    v_mfma_f32_16x16x32_bf16 v[56:59], a[76:79], v[80:83], v[56:59]
    s_add_u32 s55, s67, 8192
    buffer_load_dwordx4 a[64:67], v8, s[8:11], s55 offen offset:0
    v_mfma_f32_16x16x32_bf16 v[60:63], a[80:83], v[80:83], v[60:63]
    ds_read_b128 v[80:83], v8 offset:19456
    s_waitcnt vmcnt(55) lgkmcnt(4)
    v_mfma_f32_16x16x32_bf16 v[16:19], a[84:87], v[64:67], v[16:19]
    s_waitcnt vmcnt(54)
    v_mfma_f32_16x16x32_bf16 v[20:23], a[88:91], v[64:67], v[20:23]
    s_waitcnt vmcnt(53)
    v_mfma_f32_16x16x32_bf16 v[24:27], a[92:95], v[64:67], v[24:27]
    ds_read_b128 v[64:67], v8 offset:41984
    s_add_u32 s55, s67, 57344
    buffer_load_dwordx4 a[68:71], v8, s[8:11], s55 offen offset:0
    s_waitcnt vmcnt(53) lgkmcnt(4)
    v_mfma_f32_16x16x32_bf16 v[16:19], a[96:99], v[68:71], v[16:19]
    s_waitcnt vmcnt(52)
    v_mfma_f32_16x16x32_bf16 v[20:23], a[100:103], v[68:71], v[20:23]
    s_waitcnt vmcnt(51)
    v_mfma_f32_16x16x32_bf16 v[24:27], a[104:107], v[68:71], v[24:27]
    ds_read_b128 v[68:71], v8 offset:43008
    s_waitcnt vmcnt(50) lgkmcnt(4)
    v_mfma_f32_16x16x32_bf16 v[16:19], a[108:111], v[72:75], v[16:19]
    s_waitcnt vmcnt(49)
    v_mfma_f32_16x16x32_bf16 v[20:23], a[112:115], v[72:75], v[20:23]
    s_add_u32 s55, s67, 106496
    buffer_load_dwordx4 a[72:75], v8, s[8:11], s55 offen offset:0
    s_waitcnt vmcnt(49)
    v_mfma_f32_16x16x32_bf16 v[24:27], a[116:119], v[72:75], v[24:27]
    ds_read_b128 v[72:75], v8 offset:44032
    s_waitcnt vmcnt(48) lgkmcnt(4)
    v_mfma_f32_16x16x32_bf16 v[16:19], a[120:123], v[76:79], v[16:19]
    s_waitcnt vmcnt(47)
    v_mfma_f32_16x16x32_bf16 v[20:23], a[124:127], v[76:79], v[20:23]
    s_waitcnt vmcnt(46)
    v_mfma_f32_16x16x32_bf16 v[24:27], a[128:131], v[76:79], v[24:27]
    ds_read_b128 v[76:79], v8 offset:45056
    s_add_u32 s55, s67, 155648
    buffer_load_dwordx4 a[76:79], v8, s[8:11], s55 offen offset:0
    s_waitcnt vmcnt(46) lgkmcnt(4)
    v_mfma_f32_16x16x32_bf16 v[16:19], a[132:135], v[80:83], v[16:19]
    s_waitcnt vmcnt(45)
    v_mfma_f32_16x16x32_bf16 v[20:23], a[136:139], v[80:83], v[20:23]
    s_waitcnt vmcnt(44)
    v_mfma_f32_16x16x32_bf16 v[24:27], a[140:143], v[80:83], v[24:27]
    ds_read_b128 v[80:83], v8 offset:46080
    s_waitcnt lgkmcnt(4)
    v_mfma_f32_16x16x32_bf16 v[28:31], a[84:87], v[64:67], v[28:31]
    v_mfma_f32_16x16x32_bf16 v[32:35], a[88:91], v[64:67], v[32:35]
    s_add_u32 s55, s67, 204800
    buffer_load_dwordx4 a[80:83], v8, s[8:11], s55 offen offset:0
    v_mfma_f32_16x16x32_bf16 v[36:39], a[92:95], v[64:67], v[36:39]
    ds_read_b128 v[64:67], v9 offset:15360
    s_waitcnt lgkmcnt(4)
    v_mfma_f32_16x16x32_bf16 v[28:31], a[96:99], v[68:71], v[28:31]
    v_mul_f32 v16, v16, v92
    v_mul_f32 v17, v17, v92
    v_cvt_pk_bf16_f32 v176, v16, v17
    v_lshlrev_b32 v16, 16, v176
    v_and_b32 v17, 0xffff0000, v176
    v_mul_f32 v176, s58, v16
    v_mul_f32 v177, s58, v17
    v_exp_f32 v176, v176
    v_exp_f32 v177, v177
    v_mfma_f32_16x16x32_bf16 v[32:35], a[100:103], v[68:71], v[32:35]
    v_add_f32 v176, 1.0, v176
    v_add_f32 v177, 1.0, v177
    v_rcp_f32 v176, v176
    v_rcp_f32 v177, v177
    v_mul_f32 v176, v176, v16
    v_mul_f32 v177, v177, v17
    v_cvt_pk_bf16_f32 v192, v176, v177
    v_mul_f32 v18, v18, v92
    v_mfma_f32_16x16x32_bf16 v[36:39], a[104:107], v[68:71], v[36:39]
    v_mul_f32 v19, v19, v92
    v_cvt_pk_bf16_f32 v180, v18, v19
    v_lshlrev_b32 v18, 16, v180
    v_and_b32 v19, 0xffff0000, v180
    v_mul_f32 v180, s58, v18
    v_mul_f32 v181, s58, v19
    v_exp_f32 v180, v180
    v_exp_f32 v181, v181
    ds_read_b128 v[68:71], v9 offset:16384
    s_waitcnt lgkmcnt(4)
    v_mfma_f32_16x16x32_bf16 v[28:31], a[108:111], v[72:75], v[28:31]
    v_add_f32 v180, 1.0, v180
    v_add_f32 v181, 1.0, v181
    v_rcp_f32 v180, v180
    v_rcp_f32 v181, v181
    v_mul_f32 v180, v180, v18
    v_mul_f32 v181, v181, v19
    v_cvt_pk_bf16_f32 v193, v180, v181
    v_mul_f32 v20, v20, v92
    v_mfma_f32_16x16x32_bf16 v[32:35], a[112:115], v[72:75], v[32:35]
    v_mul_f32 v21, v21, v92
    v_cvt_pk_bf16_f32 v184, v20, v21
    v_lshlrev_b32 v20, 16, v184
    v_and_b32 v21, 0xffff0000, v184
    v_mul_f32 v184, s58, v20
    v_mul_f32 v185, s58, v21
    v_exp_f32 v184, v184
    v_exp_f32 v185, v185
    v_mfma_f32_16x16x32_bf16 v[36:39], a[116:119], v[72:75], v[36:39]
    v_add_f32 v184, 1.0, v184
    v_add_f32 v185, 1.0, v185
    v_rcp_f32 v184, v184
    v_rcp_f32 v185, v185
    v_mul_f32 v184, v184, v20
    v_mul_f32 v185, v185, v21
    v_cvt_pk_bf16_f32 v194, v184, v185
    v_mul_f32 v22, v22, v92
    ds_read_b128 v[72:75], v9 offset:17408
    s_waitcnt lgkmcnt(4)
    v_mfma_f32_16x16x32_bf16 v[28:31], a[120:123], v[76:79], v[28:31]
    v_mul_f32 v23, v23, v92
    v_cvt_pk_bf16_f32 v188, v22, v23
    v_lshlrev_b32 v22, 16, v188
    v_and_b32 v23, 0xffff0000, v188
    v_mul_f32 v188, s58, v22
    v_mul_f32 v189, s58, v23
    v_exp_f32 v188, v188
    v_exp_f32 v189, v189
    v_add_f32 v188, 1.0, v188
    v_mfma_f32_16x16x32_bf16 v[32:35], a[124:127], v[76:79], v[32:35]
    v_add_f32 v189, 1.0, v189
    v_rcp_f32 v188, v188
    v_rcp_f32 v189, v189
    v_mul_f32 v188, v188, v22
    v_mul_f32 v189, v189, v23
    v_cvt_pk_bf16_f32 v195, v188, v189
    v_mul_f32 v24, v24, v92
    v_mul_f32 v25, v25, v92
    v_mfma_f32_16x16x32_bf16 v[36:39], a[128:131], v[76:79], v[36:39]
    v_cvt_pk_bf16_f32 v176, v24, v25
    v_lshlrev_b32 v24, 16, v176
    v_and_b32 v25, 0xffff0000, v176
    v_mul_f32 v176, s58, v24
    v_mul_f32 v177, s58, v25
    v_exp_f32 v176, v176
    v_exp_f32 v177, v177
    v_add_f32 v176, 1.0, v176
    ds_read_b128 v[76:79], v9 offset:18432
    s_waitcnt lgkmcnt(4)
    v_mfma_f32_16x16x32_bf16 v[28:31], a[132:135], v[80:83], v[28:31]
    v_add_f32 v177, 1.0, v177
    v_rcp_f32 v176, v176
    v_rcp_f32 v177, v177
    v_mul_f32 v176, v176, v24
    v_mul_f32 v177, v177, v25
    v_cvt_pk_bf16_f32 v196, v176, v177
    v_mul_f32 v26, v26, v92
    v_mul_f32 v27, v27, v92
    v_mfma_f32_16x16x32_bf16 v[32:35], a[136:139], v[80:83], v[32:35]
    v_cvt_pk_bf16_f32 v180, v26, v27
    v_lshlrev_b32 v26, 16, v180
    v_and_b32 v27, 0xffff0000, v180
    v_mul_f32 v180, s58, v26
    v_mul_f32 v181, s58, v27
    v_exp_f32 v180, v180
    v_exp_f32 v181, v181
    v_add_f32 v180, 1.0, v180
    v_mfma_f32_16x16x32_bf16 v[36:39], a[140:143], v[80:83], v[36:39]
    v_add_f32 v181, 1.0, v181
    v_rcp_f32 v180, v180
    v_rcp_f32 v181, v181
    v_mul_f32 v180, v180, v26
    v_mul_f32 v181, v181, v27
    v_cvt_pk_bf16_f32 v197, v180, v181
    s_add_u32 s55, s46, 0
    buffer_store_dwordx4 v[192:195], v8, s[8:11], s55 offen sc1
    ds_write_b64 v7, v[196:197] offset:0
    ds_read_b128 v[80:83], v9 offset:19456
    s_waitcnt lgkmcnt(5)
    v_mfma_f32_16x16x32_bf16 v[40:43], a[84:87], v[64:67], v[40:43]
    v_mfma_f32_16x16x32_bf16 v[44:47], a[88:91], v[64:67], v[44:47]
    v_mfma_f32_16x16x32_bf16 v[48:51], a[92:95], v[64:67], v[48:51]
    ds_read_b128 v[64:67], v9 offset:41984
    s_waitcnt lgkmcnt(5)
    v_mfma_f32_16x16x32_bf16 v[40:43], a[96:99], v[68:71], v[40:43]
    v_mul_f32 v28, v28, v93
    v_mul_f32 v29, v29, v93
    v_cvt_pk_bf16_f32 v176, v28, v29
    v_lshlrev_b32 v28, 16, v176
    v_and_b32 v29, 0xffff0000, v176
    v_mul_f32 v176, s58, v28
    v_mul_f32 v177, s58, v29
    v_exp_f32 v176, v176
    v_exp_f32 v177, v177
    v_mfma_f32_16x16x32_bf16 v[44:47], a[100:103], v[68:71], v[44:47]
    v_add_f32 v176, 1.0, v176
    v_add_f32 v177, 1.0, v177
    v_rcp_f32 v176, v176
    v_rcp_f32 v177, v177
    v_mul_f32 v176, v176, v28
    v_mul_f32 v177, v177, v29
    v_cvt_pk_bf16_f32 v200, v176, v177
    v_mul_f32 v30, v30, v93
    v_mfma_f32_16x16x32_bf16 v[48:51], a[104:107], v[68:71], v[48:51]
    v_mul_f32 v31, v31, v93
    v_cvt_pk_bf16_f32 v180, v30, v31
    v_lshlrev_b32 v30, 16, v180
    v_and_b32 v31, 0xffff0000, v180
    v_mul_f32 v180, s58, v30
    v_mul_f32 v181, s58, v31
    v_exp_f32 v180, v180
    v_exp_f32 v181, v181
    ds_read_b128 v[68:71], v9 offset:43008
    s_waitcnt lgkmcnt(5)
    v_mfma_f32_16x16x32_bf16 v[40:43], a[108:111], v[72:75], v[40:43]
    v_add_f32 v180, 1.0, v180
    v_add_f32 v181, 1.0, v181
    v_rcp_f32 v180, v180
    v_rcp_f32 v181, v181
    v_mul_f32 v180, v180, v30
    v_mul_f32 v181, v181, v31
    v_cvt_pk_bf16_f32 v201, v180, v181
    v_mul_f32 v32, v32, v93
    v_mfma_f32_16x16x32_bf16 v[44:47], a[112:115], v[72:75], v[44:47]
    v_mul_f32 v33, v33, v93
    v_cvt_pk_bf16_f32 v184, v32, v33
    v_lshlrev_b32 v32, 16, v184
    v_and_b32 v33, 0xffff0000, v184
    v_mul_f32 v184, s58, v32
    v_mul_f32 v185, s58, v33
    v_exp_f32 v184, v184
    v_exp_f32 v185, v185
    v_mfma_f32_16x16x32_bf16 v[48:51], a[116:119], v[72:75], v[48:51]
    v_add_f32 v184, 1.0, v184
    v_add_f32 v185, 1.0, v185
    v_rcp_f32 v184, v184
    v_rcp_f32 v185, v185
    v_mul_f32 v184, v184, v32
    v_mul_f32 v185, v185, v33
    v_cvt_pk_bf16_f32 v202, v184, v185
    v_mul_f32 v34, v34, v93
    ds_read_b128 v[72:75], v9 offset:44032
    s_waitcnt lgkmcnt(5)
    v_mfma_f32_16x16x32_bf16 v[40:43], a[120:123], v[76:79], v[40:43]
    v_mul_f32 v35, v35, v93
    v_cvt_pk_bf16_f32 v188, v34, v35
    v_lshlrev_b32 v34, 16, v188
    v_and_b32 v35, 0xffff0000, v188
    v_mul_f32 v188, s58, v34
    v_mul_f32 v189, s58, v35
    v_exp_f32 v188, v188
    v_exp_f32 v189, v189
    v_add_f32 v188, 1.0, v188
    v_mfma_f32_16x16x32_bf16 v[44:47], a[124:127], v[76:79], v[44:47]
    v_add_f32 v189, 1.0, v189
    v_rcp_f32 v188, v188
    v_rcp_f32 v189, v189
    v_mul_f32 v188, v188, v34
    v_mul_f32 v189, v189, v35
    v_cvt_pk_bf16_f32 v203, v188, v189
    v_mul_f32 v36, v36, v93
    v_mul_f32 v37, v37, v93
    v_mfma_f32_16x16x32_bf16 v[48:51], a[128:131], v[76:79], v[48:51]
    v_cvt_pk_bf16_f32 v176, v36, v37
    v_lshlrev_b32 v36, 16, v176
    v_and_b32 v37, 0xffff0000, v176
    v_mul_f32 v176, s58, v36
    v_mul_f32 v177, s58, v37
    v_exp_f32 v176, v176
    v_exp_f32 v177, v177
    v_add_f32 v176, 1.0, v176
    ds_read_b128 v[76:79], v9 offset:45056
    s_waitcnt lgkmcnt(4)
    v_mfma_f32_16x16x32_bf16 v[40:43], a[132:135], v[80:83], v[40:43]
    v_add_f32 v177, 1.0, v177
    v_rcp_f32 v176, v176
    v_rcp_f32 v177, v177
    v_mul_f32 v176, v176, v36
    v_mul_f32 v177, v177, v37
    v_cvt_pk_bf16_f32 v204, v176, v177
    v_mul_f32 v38, v38, v93
    v_mul_f32 v39, v39, v93
    v_mfma_f32_16x16x32_bf16 v[44:47], a[136:139], v[80:83], v[44:47]
    v_cvt_pk_bf16_f32 v180, v38, v39
    v_lshlrev_b32 v38, 16, v180
    v_and_b32 v39, 0xffff0000, v180
    v_mul_f32 v180, s58, v38
    v_mul_f32 v181, s58, v39
    v_exp_f32 v180, v180
    v_exp_f32 v181, v181
    v_add_f32 v180, 1.0, v180
    v_mfma_f32_16x16x32_bf16 v[48:51], a[140:143], v[80:83], v[48:51]
    v_add_f32 v181, 1.0, v181
    v_rcp_f32 v180, v180
    v_rcp_f32 v181, v181
    v_mul_f32 v180, v180, v38
    v_mul_f32 v181, v181, v39
    v_cvt_pk_bf16_f32 v205, v180, v181
    s_add_u32 s55, s46, 49152
    buffer_store_dwordx4 v[200:203], v8, s[8:11], s55 offen sc1
    ds_write_b64 v7, v[204:205] offset:512
    ds_read_b128 v[80:83], v9 offset:46080
    s_waitcnt lgkmcnt(5)
    v_mfma_f32_16x16x32_bf16 v[52:55], a[84:87], v[64:67], v[52:55]
    v_mfma_f32_16x16x32_bf16 v[56:59], a[88:91], v[64:67], v[56:59]
    v_mfma_f32_16x16x32_bf16 v[60:63], a[92:95], v[64:67], v[60:63]
    s_waitcnt lgkmcnt(4)
    v_mfma_f32_16x16x32_bf16 v[52:55], a[96:99], v[68:71], v[52:55]
    v_mul_f32 v40, v40, v94
    v_mul_f32 v41, v41, v94
    v_cvt_pk_bf16_f32 v176, v40, v41
    v_lshlrev_b32 v40, 16, v176
    s_add_u32 s55, s67, 8192
    buffer_load_dwordx4 a[84:87], v8, s[8:11], s55 offen offset:1024
    v_and_b32 v41, 0xffff0000, v176
    v_mul_f32 v176, s58, v40
    v_mul_f32 v177, s58, v41
    v_exp_f32 v176, v176
    v_exp_f32 v177, v177
    v_mfma_f32_16x16x32_bf16 v[56:59], a[100:103], v[68:71], v[56:59]
    v_add_f32 v176, 1.0, v176
    v_add_f32 v177, 1.0, v177
    v_rcp_f32 v176, v176
    s_add_u32 s55, s67, 57344
    buffer_load_dwordx4 a[88:91], v8, s[8:11], s55 offen offset:1024
    v_rcp_f32 v177, v177
    v_mul_f32 v176, v176, v40
    v_mul_f32 v177, v177, v41
    v_cvt_pk_bf16_f32 v208, v176, v177
    v_mul_f32 v42, v42, v94
    v_mfma_f32_16x16x32_bf16 v[60:63], a[104:107], v[68:71], v[60:63]
    v_mul_f32 v43, v43, v94
    v_cvt_pk_bf16_f32 v180, v42, v43
    v_lshlrev_b32 v42, 16, v180
    s_add_u32 s55, s67, 106496
    buffer_load_dwordx4 a[92:95], v8, s[8:11], s55 offen offset:1024
    v_and_b32 v43, 0xffff0000, v180
    v_mul_f32 v180, s58, v42
    v_mul_f32 v181, s58, v43
    v_exp_f32 v180, v180
    v_exp_f32 v181, v181
    s_waitcnt lgkmcnt(3)
    v_mfma_f32_16x16x32_bf16 v[52:55], a[108:111], v[72:75], v[52:55]
    v_add_f32 v180, 1.0, v180
    v_add_f32 v181, 1.0, v181
    v_rcp_f32 v180, v180
    s_add_u32 s55, s67, 155648
    buffer_load_dwordx4 a[96:99], v8, s[8:11], s55 offen offset:1024
    v_rcp_f32 v181, v181
    v_mul_f32 v180, v180, v42
    v_mul_f32 v181, v181, v43
    v_cvt_pk_bf16_f32 v209, v180, v181
    v_mul_f32 v44, v44, v94
    v_mfma_f32_16x16x32_bf16 v[56:59], a[112:115], v[72:75], v[56:59]
    v_mul_f32 v45, v45, v94
    v_cvt_pk_bf16_f32 v184, v44, v45
    v_lshlrev_b32 v44, 16, v184
    s_add_u32 s55, s67, 204800
    buffer_load_dwordx4 a[100:103], v8, s[8:11], s55 offen offset:1024
    v_and_b32 v45, 0xffff0000, v184
    v_mul_f32 v184, s58, v44
    v_mul_f32 v185, s58, v45
    v_exp_f32 v184, v184
    v_exp_f32 v185, v185
    v_mfma_f32_16x16x32_bf16 v[60:63], a[116:119], v[72:75], v[60:63]
    v_add_f32 v184, 1.0, v184
    v_add_f32 v185, 1.0, v185
    v_rcp_f32 v184, v184
    s_add_u32 s55, s67, 8192
    buffer_load_dwordx4 a[104:107], v8, s[8:11], s55 offen offset:2048
    v_rcp_f32 v185, v185
    v_mul_f32 v184, v184, v44
    v_mul_f32 v185, v185, v45
    v_cvt_pk_bf16_f32 v210, v184, v185
    v_mul_f32 v46, v46, v94
    s_waitcnt lgkmcnt(2)
    v_mfma_f32_16x16x32_bf16 v[52:55], a[120:123], v[76:79], v[52:55]
    v_mul_f32 v47, v47, v94
    v_cvt_pk_bf16_f32 v188, v46, v47
    v_lshlrev_b32 v46, 16, v188
    s_add_u32 s55, s67, 57344
    buffer_load_dwordx4 a[108:111], v8, s[8:11], s55 offen offset:2048
    v_and_b32 v47, 0xffff0000, v188
    v_mul_f32 v188, s58, v46
    v_mul_f32 v189, s58, v47
    v_exp_f32 v188, v188
    v_exp_f32 v189, v189
    v_add_f32 v188, 1.0, v188
    v_mfma_f32_16x16x32_bf16 v[56:59], a[124:127], v[76:79], v[56:59]
    v_add_f32 v189, 1.0, v189
    v_rcp_f32 v188, v188
    s_add_u32 s55, s67, 106496
    buffer_load_dwordx4 a[112:115], v8, s[8:11], s55 offen offset:2048
    v_rcp_f32 v189, v189
    v_mul_f32 v188, v188, v46
    v_mul_f32 v189, v189, v47
    v_cvt_pk_bf16_f32 v211, v188, v189
    v_mul_f32 v48, v48, v94
    v_mul_f32 v49, v49, v94
    v_mfma_f32_16x16x32_bf16 v[60:63], a[128:131], v[76:79], v[60:63]
    v_cvt_pk_bf16_f32 v176, v48, v49
    v_lshlrev_b32 v48, 16, v176
    s_add_u32 s55, s67, 155648
    buffer_load_dwordx4 a[116:119], v8, s[8:11], s55 offen offset:2048
    v_and_b32 v49, 0xffff0000, v176
    v_mul_f32 v176, s58, v48
    v_mul_f32 v177, s58, v49
    v_exp_f32 v176, v176
    v_exp_f32 v177, v177
    v_add_f32 v176, 1.0, v176
    s_waitcnt lgkmcnt(0)
    v_mfma_f32_16x16x32_bf16 v[52:55], a[132:135], v[80:83], v[52:55]
    v_add_f32 v177, 1.0, v177
    v_rcp_f32 v176, v176
    s_add_u32 s55, s67, 204800
    buffer_load_dwordx4 a[120:123], v8, s[8:11], s55 offen offset:2048
    v_rcp_f32 v177, v177
    v_mul_f32 v176, v176, v48
    v_mul_f32 v177, v177, v49
    v_cvt_pk_bf16_f32 v212, v176, v177
    v_mul_f32 v50, v50, v94
    v_mul_f32 v51, v51, v94
    v_mfma_f32_16x16x32_bf16 v[56:59], a[136:139], v[80:83], v[56:59]
    v_cvt_pk_bf16_f32 v180, v50, v51
    v_lshlrev_b32 v50, 16, v180
    s_add_u32 s55, s67, 8192
    buffer_load_dwordx4 a[124:127], v8, s[8:11], s55 offen offset:3072
    v_and_b32 v51, 0xffff0000, v180
    v_mul_f32 v180, s58, v50
    v_mul_f32 v181, s58, v51
    v_exp_f32 v180, v180
    v_exp_f32 v181, v181
    v_add_f32 v180, 1.0, v180
    v_mfma_f32_16x16x32_bf16 v[60:63], a[140:143], v[80:83], v[60:63]
    v_add_f32 v181, 1.0, v181
    v_rcp_f32 v180, v180
    s_add_u32 s55, s67, 57344
    buffer_load_dwordx4 a[128:131], v8, s[8:11], s55 offen offset:3072
    v_rcp_f32 v181, v181
    v_mul_f32 v180, v180, v50
    v_mul_f32 v181, v181, v51
    v_cvt_pk_bf16_f32 v213, v180, v181
    s_add_u32 s55, s46, 98304
    buffer_store_dwordx4 v[208:211], v8, s[8:11], s55 offen sc1
    ds_write_b64 v7, v[212:213] offset:1024
    v_mul_f32 v52, v52, v95
    v_mul_f32 v53, v53, v95
    v_cvt_pk_bf16_f32 v176, v52, v53
    v_lshlrev_b32 v52, 16, v176
    v_and_b32 v53, 0xffff0000, v176
    v_mul_f32 v176, s58, v52
    v_mul_f32 v177, s58, v53
    v_exp_f32 v176, v176
    v_exp_f32 v177, v177
    v_add_f32 v176, 1.0, v176
    v_add_f32 v177, 1.0, v177
    v_rcp_f32 v176, v176
    v_rcp_f32 v177, v177
    v_mul_f32 v176, v176, v52
    v_mul_f32 v177, v177, v53
    v_cvt_pk_bf16_f32 v216, v176, v177
    v_mul_f32 v54, v54, v95
    v_mul_f32 v55, v55, v95
    v_cvt_pk_bf16_f32 v180, v54, v55
    v_lshlrev_b32 v54, 16, v180
    v_and_b32 v55, 0xffff0000, v180
    v_mul_f32 v180, s58, v54
    v_mul_f32 v181, s58, v55
    v_exp_f32 v180, v180
    v_exp_f32 v181, v181
    v_add_f32 v180, 1.0, v180
    v_add_f32 v181, 1.0, v181
    v_rcp_f32 v180, v180
    v_rcp_f32 v181, v181
    v_mul_f32 v180, v180, v54
    v_mul_f32 v181, v181, v55
    v_cvt_pk_bf16_f32 v217, v180, v181
    v_mul_f32 v56, v56, v95
    v_mul_f32 v57, v57, v95
    v_cvt_pk_bf16_f32 v184, v56, v57
    v_lshlrev_b32 v56, 16, v184
    v_and_b32 v57, 0xffff0000, v184
    v_mul_f32 v184, s58, v56
    v_mul_f32 v185, s58, v57
    v_exp_f32 v184, v184
    v_exp_f32 v185, v185
    v_add_f32 v184, 1.0, v184
    v_add_f32 v185, 1.0, v185
    v_rcp_f32 v184, v184
    v_rcp_f32 v185, v185
    v_mul_f32 v184, v184, v56
    v_mul_f32 v185, v185, v57
    v_cvt_pk_bf16_f32 v218, v184, v185
    v_mul_f32 v58, v58, v95
    v_mul_f32 v59, v59, v95
    v_cvt_pk_bf16_f32 v188, v58, v59
    v_lshlrev_b32 v58, 16, v188
    v_and_b32 v59, 0xffff0000, v188
    v_mul_f32 v188, s58, v58
    v_mul_f32 v189, s58, v59
    v_exp_f32 v188, v188
    v_exp_f32 v189, v189
    v_add_f32 v188, 1.0, v188
    v_add_f32 v189, 1.0, v189
    v_rcp_f32 v188, v188
    v_rcp_f32 v189, v189
    v_mul_f32 v188, v188, v58
    v_mul_f32 v189, v189, v59
    v_cvt_pk_bf16_f32 v219, v188, v189
    v_mul_f32 v60, v60, v95
    v_mul_f32 v61, v61, v95
    v_cvt_pk_bf16_f32 v176, v60, v61
    v_lshlrev_b32 v60, 16, v176
    v_and_b32 v61, 0xffff0000, v176
    v_mul_f32 v176, s58, v60
    v_mul_f32 v177, s58, v61
    v_exp_f32 v176, v176
    v_exp_f32 v177, v177
    v_add_f32 v176, 1.0, v176
    v_add_f32 v177, 1.0, v177
    v_rcp_f32 v176, v176
    v_rcp_f32 v177, v177
    v_mul_f32 v176, v176, v60
    v_mul_f32 v177, v177, v61
    v_cvt_pk_bf16_f32 v220, v176, v177
    v_mul_f32 v62, v62, v95
    v_mul_f32 v63, v63, v95
    v_cvt_pk_bf16_f32 v180, v62, v63
    v_lshlrev_b32 v62, 16, v180
    v_and_b32 v63, 0xffff0000, v180
    v_mul_f32 v180, s58, v62
    v_mul_f32 v181, s58, v63
    v_exp_f32 v180, v180
    v_exp_f32 v181, v181
    v_add_f32 v180, 1.0, v180
    v_add_f32 v181, 1.0, v181
    v_rcp_f32 v180, v180
    v_rcp_f32 v181, v181
    v_mul_f32 v180, v180, v62
    v_mul_f32 v181, v181, v63
    v_cvt_pk_bf16_f32 v221, v180, v181
    s_add_u32 s55, s46, 147456
    buffer_store_dwordx4 v[216:219], v8, s[8:11], s55 offen sc1
    ds_write_b64 v7, v[220:221] offset:1536
    s_waitcnt lgkmcnt(0)
    s_barrier
    v_xor_b32 v7, 2048, v7
    ds_read_b64 v[198:199], v7 offset:0
    ds_read_b64 v[206:207], v7 offset:512
    ds_read_b64 v[214:215], v7 offset:1024
    ds_read_b64 v[222:223], v7 offset:1536
    s_cmp_eq_u32 s53, 0
    s_cselect_b64 exec, -1, 0
    s_add_u32 s55, s48, 0
    s_waitcnt lgkmcnt(3)
    buffer_store_dwordx4 v[196:199], v8, s[8:11], s55 offen sc1
    s_add_u32 s55, s48, 49152
    s_waitcnt lgkmcnt(2)
    buffer_store_dwordx4 v[204:207], v8, s[8:11], s55 offen sc1
    s_add_u32 s55, s48, 98304
    s_waitcnt lgkmcnt(1)
    buffer_store_dwordx4 v[212:215], v8, s[8:11], s55 offen sc1
    s_add_u32 s55, s48, 147456
    s_waitcnt lgkmcnt(0)
    buffer_store_dwordx4 v[220:223], v8, s[8:11], s55 offen sc1
    s_mov_b64 exec, -1
    s_add_u32 s55, s67, 106496
    buffer_load_dwordx4 a[132:135], v8, s[8:11], s55 offen offset:3072
    s_add_u32 s55, s67, 155648
    buffer_load_dwordx4 a[136:139], v8, s[8:11], s55 offen offset:3072
    s_add_u32 s55, s67, 204800
    buffer_load_dwordx4 a[140:143], v8, s[8:11], s55 offen offset:3072
    s_waitcnt vmcnt(3)
    s_barrier
    s_lshl_b32 s49, s40, 8
    s_add_u32 s49, s49, 12713984
    v_mov_b32 v5, s49
    v_mov_b32 v4, 1
    s_cmp_eq_u32 s44, 0
    s_cbranch_scc0 L_g12b_go
    s_mov_b64 exec, 1
    buffer_atomic_add v4, v5, s[8:11], 0 offen
    s_mov_b32 s49, 0
L_g12b_poll:
    s_sleep 2
    buffer_load_dword v4, v5, s[8:11], 0 offen sc1
    s_waitcnt vmcnt(0)
    v_readfirstlane_b32 s50, v4
    s_add_u32 s49, s49, 1
    s_cmp_ge_u32 s50, 8
    s_cbranch_scc1 L_g12b_go0
    s_cmp_lt_u32 s49, 0x80000
    s_cbranch_scc1 L_g12b_poll
L_g12b_go0:
    s_mov_b64 exec, -1
    s_nop 15
L_g12b_go:
    s_barrier
    s_mul_i32 s47, s40, 196608
    s_mul_i32 s49, s44, 12288
    s_add_u32 s47, s47, s49
    s_add_u32 s47, s47, s66
    s_add_u32 s55, s47, 0
    buffer_load_dwordx4 v[96:99], v8, s[8:11], s55 offen offset:0 sc1
    s_add_u32 s55, s47, 0
    buffer_load_dwordx4 v[100:103], v8, s[8:11], s55 offen offset:1024 sc1
    s_add_u32 s55, s47, 0
    buffer_load_dwordx4 v[104:107], v8, s[8:11], s55 offen offset:2048 sc1
    s_add_u32 s55, s47, 0
    buffer_load_dwordx4 v[108:111], v8, s[8:11], s55 offen offset:3072 sc1
    s_add_u32 s55, s47, 4096
    buffer_load_dwordx4 v[112:115], v8, s[8:11], s55 offen offset:0 sc1
    s_add_u32 s55, s47, 4096
    buffer_load_dwordx4 v[116:119], v8, s[8:11], s55 offen offset:1024 sc1
    s_add_u32 s55, s47, 4096
    buffer_load_dwordx4 v[120:123], v8, s[8:11], s55 offen offset:2048 sc1
    s_add_u32 s55, s47, 4096
    buffer_load_dwordx4 v[124:127], v8, s[8:11], s55 offen offset:3072 sc1
    s_add_u32 s55, s47, 8192
    buffer_load_dwordx4 v[128:131], v8, s[8:11], s55 offen offset:0 sc1
    s_add_u32 s55, s47, 8192
    buffer_load_dwordx4 v[132:135], v8, s[8:11], s55 offen offset:1024 sc1
    s_add_u32 s55, s47, 8192
    buffer_load_dwordx4 v[136:139], v8, s[8:11], s55 offen offset:2048 sc1
    s_add_u32 s55, s47, 8192
    buffer_load_dwordx4 v[140:143], v8, s[8:11], s55 offen offset:3072 sc1
    s_add_u32 s55, s47, 49152
    buffer_load_dwordx4 v[144:147], v8, s[8:11], s55 offen offset:0 sc1
    s_add_u32 s55, s47, 49152
    buffer_load_dwordx4 v[148:151], v8, s[8:11], s55 offen offset:1024 sc1
    s_add_u32 s55, s47, 49152
    buffer_load_dwordx4 v[152:155], v8, s[8:11], s55 offen offset:2048 sc1
    s_add_u32 s55, s47, 49152
    buffer_load_dwordx4 v[156:159], v8, s[8:11], s55 offen offset:3072 sc1
    s_add_u32 s55, s47, 53248
    buffer_load_dwordx4 v[160:163], v8, s[8:11], s55 offen offset:0 sc1
    s_add_u32 s55, s47, 53248
    buffer_load_dwordx4 v[164:167], v8, s[8:11], s55 offen offset:1024 sc1
    s_add_u32 s55, s47, 53248
    buffer_load_dwordx4 v[168:171], v8, s[8:11], s55 offen offset:2048 sc1
    s_add_u32 s55, s47, 53248
    buffer_load_dwordx4 v[172:175], v8, s[8:11], s55 offen offset:3072 sc1
    s_add_u32 s55, s47, 57344
    buffer_load_dwordx4 v[176:179], v8, s[8:11], s55 offen offset:0 sc1
    s_add_u32 s55, s47, 57344
    buffer_load_dwordx4 v[180:183], v8, s[8:11], s55 offen offset:1024 sc1
    s_add_u32 s55, s47, 57344
    buffer_load_dwordx4 v[184:187], v8, s[8:11], s55 offen offset:2048 sc1
    s_add_u32 s55, s47, 57344
    buffer_load_dwordx4 v[188:191], v8, s[8:11], s55 offen offset:3072 sc1
    s_add_u32 s55, s47, 98304
    buffer_load_dwordx4 v[192:195], v8, s[8:11], s55 offen offset:0 sc1
    s_add_u32 s55, s47, 98304
    buffer_load_dwordx4 v[196:199], v8, s[8:11], s55 offen offset:1024 sc1
    s_add_u32 s55, s47, 98304
    buffer_load_dwordx4 v[200:203], v8, s[8:11], s55 offen offset:2048 sc1
    s_add_u32 s55, s47, 98304
    buffer_load_dwordx4 v[204:207], v8, s[8:11], s55 offen offset:3072 sc1
    s_add_u32 s55, s47, 102400
    buffer_load_dwordx4 v[208:211], v8, s[8:11], s55 offen offset:0 sc1
    s_add_u32 s55, s47, 102400
    buffer_load_dwordx4 v[212:215], v8, s[8:11], s55 offen offset:1024 sc1
    s_add_u32 s55, s47, 102400
    buffer_load_dwordx4 v[216:219], v8, s[8:11], s55 offen offset:2048 sc1
    s_add_u32 s55, s47, 102400
    buffer_load_dwordx4 v[220:223], v8, s[8:11], s55 offen offset:3072 sc1
    s_add_u32 s55, s47, 106496
    buffer_load_dwordx4 v[224:227], v8, s[8:11], s55 offen offset:0 sc1
    s_add_u32 s55, s47, 106496
    buffer_load_dwordx4 v[228:231], v8, s[8:11], s55 offen offset:1024 sc1
    s_add_u32 s55, s47, 106496
    buffer_load_dwordx4 v[232:235], v8, s[8:11], s55 offen offset:2048 sc1
    s_add_u32 s55, s47, 106496
    buffer_load_dwordx4 v[236:239], v8, s[8:11], s55 offen offset:3072 sc1
    s_add_u32 s55, s47, 147456
    buffer_load_dwordx4 v[240:243], v8, s[8:11], s55 offen offset:0 sc1
    s_add_u32 s55, s47, 147456
    buffer_load_dwordx4 v[244:247], v8, s[8:11], s55 offen offset:1024 sc1
    s_add_u32 s55, s47, 147456
    buffer_load_dwordx4 v[248:251], v8, s[8:11], s55 offen offset:2048 sc1
    s_add_u32 s55, s47, 147456
    buffer_load_dwordx4 v[252:255], v8, s[8:11], s55 offen offset:3072 sc1
    s_lshl_b32 s48, s40, 6
    s_lshl_b32 s46, s44, 4
    s_add_u32 s48, s48, s46
    v_add_u32 v5, s48, v2
    s_mov_b32 s48, 1280
    v_mul_lo_u32 v6, v5, s48
    v_lshl_add_u32 v6, v3, 3, v6
    s_mul_i32 s49, s41, 160
    v_add_u32 v6, s49, v6
    s_mul_i32 s46, s44, 20480
    v_add_u32 v9, s46, v8
    s_waitcnt vmcnt(39)
    v_mfma_f32_16x16x32_bf16 v[16:19], a[160:163], v[96:99], 0
    v_mfma_f32_16x16x32_bf16 v[20:23], a[164:167], v[96:99], 0
    v_mfma_f32_16x16x32_bf16 v[24:27], a[168:171], v[96:99], 0
    v_mfma_f32_16x16x32_bf16 v[28:31], a[172:175], v[96:99], 0
    v_mfma_f32_16x16x32_bf16 v[32:35], a[176:179], v[96:99], 0
    s_add_u32 s55, s47, 151552
    buffer_load_dwordx4 v[96:99], v8, s[8:11], s55 offen offset:0 sc1
    s_waitcnt vmcnt(39)
    v_mfma_f32_16x16x32_bf16 v[16:19], a[180:183], v[100:103], v[16:19]
    v_mfma_f32_16x16x32_bf16 v[20:23], a[184:187], v[100:103], v[20:23]
    v_mfma_f32_16x16x32_bf16 v[24:27], a[188:191], v[100:103], v[24:27]
    v_mfma_f32_16x16x32_bf16 v[28:31], a[192:195], v[100:103], v[28:31]
    v_mfma_f32_16x16x32_bf16 v[32:35], a[196:199], v[100:103], v[32:35]
    s_add_u32 s55, s47, 151552
    buffer_load_dwordx4 v[100:103], v8, s[8:11], s55 offen offset:1024 sc1
    s_waitcnt vmcnt(39)
    v_mfma_f32_16x16x32_bf16 v[16:19], a[200:203], v[104:107], v[16:19]
    v_mfma_f32_16x16x32_bf16 v[20:23], a[204:207], v[104:107], v[20:23]
    v_mfma_f32_16x16x32_bf16 v[24:27], a[208:211], v[104:107], v[24:27]
    v_mfma_f32_16x16x32_bf16 v[28:31], a[212:215], v[104:107], v[28:31]
    v_mfma_f32_16x16x32_bf16 v[32:35], a[216:219], v[104:107], v[32:35]
    s_add_u32 s55, s47, 151552
    buffer_load_dwordx4 v[104:107], v8, s[8:11], s55 offen offset:2048 sc1
    s_waitcnt vmcnt(39)
    v_mfma_f32_16x16x32_bf16 v[16:19], a[220:223], v[108:111], v[16:19]
    v_mfma_f32_16x16x32_bf16 v[20:23], a[224:227], v[108:111], v[20:23]
    v_mfma_f32_16x16x32_bf16 v[24:27], a[228:231], v[108:111], v[24:27]
    v_mfma_f32_16x16x32_bf16 v[28:31], a[232:235], v[108:111], v[28:31]
    v_mfma_f32_16x16x32_bf16 v[32:35], a[236:239], v[108:111], v[32:35]
    s_add_u32 s55, s47, 151552
    buffer_load_dwordx4 v[108:111], v8, s[8:11], s55 offen offset:3072 sc1
    s_waitcnt vmcnt(39)
    v_mfma_f32_16x16x32_bf16 v[16:19], a[240:243], v[112:115], v[16:19]
    v_mfma_f32_16x16x32_bf16 v[20:23], a[244:247], v[112:115], v[20:23]
    v_mfma_f32_16x16x32_bf16 v[24:27], a[248:251], v[112:115], v[24:27]
    v_mfma_f32_16x16x32_bf16 v[28:31], a[252:255], v[112:115], v[28:31]
    v_mfma_f32_16x16x32_bf16 v[32:35], a[0:3], v[112:115], v[32:35]
    s_add_u32 s55, s47, 155648
    buffer_load_dwordx4 v[112:115], v8, s[8:11], s55 offen offset:0 sc1
    s_waitcnt vmcnt(39)
    v_mfma_f32_16x16x32_bf16 v[16:19], a[4:7], v[116:119], v[16:19]
    v_mfma_f32_16x16x32_bf16 v[20:23], a[8:11], v[116:119], v[20:23]
    v_mfma_f32_16x16x32_bf16 v[24:27], a[12:15], v[116:119], v[24:27]
    v_mfma_f32_16x16x32_bf16 v[28:31], a[16:19], v[116:119], v[28:31]
    v_mfma_f32_16x16x32_bf16 v[32:35], a[20:23], v[116:119], v[32:35]
    s_add_u32 s55, s47, 155648
    buffer_load_dwordx4 v[116:119], v8, s[8:11], s55 offen offset:1024 sc1
    s_waitcnt vmcnt(39)
    v_mfma_f32_16x16x32_bf16 v[16:19], a[24:27], v[120:123], v[16:19]
    v_mfma_f32_16x16x32_bf16 v[20:23], a[28:31], v[120:123], v[20:23]
    v_mfma_f32_16x16x32_bf16 v[24:27], a[32:35], v[120:123], v[24:27]
    v_mfma_f32_16x16x32_bf16 v[28:31], a[36:39], v[120:123], v[28:31]
    v_mfma_f32_16x16x32_bf16 v[32:35], a[40:43], v[120:123], v[32:35]
    s_add_u32 s55, s47, 155648
    buffer_load_dwordx4 v[120:123], v8, s[8:11], s55 offen offset:2048 sc1
    s_waitcnt vmcnt(39)
    v_mfma_f32_16x16x32_bf16 v[16:19], a[44:47], v[124:127], v[16:19]
    v_mfma_f32_16x16x32_bf16 v[20:23], a[48:51], v[124:127], v[20:23]
    v_mfma_f32_16x16x32_bf16 v[24:27], a[52:55], v[124:127], v[24:27]
    v_mfma_f32_16x16x32_bf16 v[28:31], a[56:59], v[124:127], v[28:31]
    v_mfma_f32_16x16x32_bf16 v[32:35], a[60:63], v[124:127], v[32:35]
    s_add_u32 s55, s47, 155648
    buffer_load_dwordx4 v[124:127], v8, s[8:11], s55 offen offset:3072 sc1
    s_waitcnt vmcnt(39)
    v_mfma_f32_16x16x32_bf16 v[16:19], a[64:67], v[128:131], v[16:19]
    v_mfma_f32_16x16x32_bf16 v[20:23], a[68:71], v[128:131], v[20:23]
    v_mfma_f32_16x16x32_bf16 v[24:27], a[72:75], v[128:131], v[24:27]
    v_mfma_f32_16x16x32_bf16 v[28:31], a[76:79], v[128:131], v[28:31]
    v_mfma_f32_16x16x32_bf16 v[32:35], a[80:83], v[128:131], v[32:35]
    s_waitcnt vmcnt(38)
    v_mfma_f32_16x16x32_bf16 v[16:19], a[84:87], v[132:135], v[16:19]
    v_mfma_f32_16x16x32_bf16 v[20:23], a[88:91], v[132:135], v[20:23]
    v_mfma_f32_16x16x32_bf16 v[24:27], a[92:95], v[132:135], v[24:27]
    v_mfma_f32_16x16x32_bf16 v[28:31], a[96:99], v[132:135], v[28:31]
    v_mfma_f32_16x16x32_bf16 v[32:35], a[100:103], v[132:135], v[32:35]
    s_waitcnt vmcnt(37)
    v_mfma_f32_16x16x32_bf16 v[16:19], a[104:107], v[136:139], v[16:19]
    v_mfma_f32_16x16x32_bf16 v[20:23], a[108:111], v[136:139], v[20:23]
    v_mfma_f32_16x16x32_bf16 v[24:27], a[112:115], v[136:139], v[24:27]
    v_mfma_f32_16x16x32_bf16 v[28:31], a[116:119], v[136:139], v[28:31]
    v_mfma_f32_16x16x32_bf16 v[32:35], a[120:123], v[136:139], v[32:35]
    s_waitcnt vmcnt(36)
    v_mfma_f32_16x16x32_bf16 v[16:19], a[124:127], v[140:143], v[16:19]
    v_mfma_f32_16x16x32_bf16 v[20:23], a[128:131], v[140:143], v[20:23]
    v_mfma_f32_16x16x32_bf16 v[24:27], a[132:135], v[140:143], v[24:27]
    v_mfma_f32_16x16x32_bf16 v[28:31], a[136:139], v[140:143], v[28:31]
    v_mfma_f32_16x16x32_bf16 v[32:35], a[140:143], v[140:143], v[32:35]
    s_waitcnt vmcnt(35)
    v_mfma_f32_16x16x32_bf16 v[36:39], a[160:163], v[144:147], 0
    v_mfma_f32_16x16x32_bf16 v[40:43], a[164:167], v[144:147], 0
    v_mfma_f32_16x16x32_bf16 v[44:47], a[168:171], v[144:147], 0
    v_mfma_f32_16x16x32_bf16 v[48:51], a[172:175], v[144:147], 0
    v_mfma_f32_16x16x32_bf16 v[52:55], a[176:179], v[144:147], 0
    s_waitcnt vmcnt(34)
    v_mfma_f32_16x16x32_bf16 v[36:39], a[180:183], v[148:151], v[36:39]
    v_mfma_f32_16x16x32_bf16 v[40:43], a[184:187], v[148:151], v[40:43]
    v_mfma_f32_16x16x32_bf16 v[44:47], a[188:191], v[148:151], v[44:47]
    v_mfma_f32_16x16x32_bf16 v[48:51], a[192:195], v[148:151], v[48:51]
    v_mfma_f32_16x16x32_bf16 v[52:55], a[196:199], v[148:151], v[52:55]
    s_waitcnt vmcnt(33)
    v_mfma_f32_16x16x32_bf16 v[36:39], a[200:203], v[152:155], v[36:39]
    v_mfma_f32_16x16x32_bf16 v[40:43], a[204:207], v[152:155], v[40:43]
    v_mfma_f32_16x16x32_bf16 v[44:47], a[208:211], v[152:155], v[44:47]
    v_mfma_f32_16x16x32_bf16 v[48:51], a[212:215], v[152:155], v[48:51]
    v_mfma_f32_16x16x32_bf16 v[52:55], a[216:219], v[152:155], v[52:55]
    ds_write_b128 v9, v[16:19] offset:0
    s_waitcnt vmcnt(32)
    v_mfma_f32_16x16x32_bf16 v[36:39], a[220:223], v[156:159], v[36:39]
    v_mfma_f32_16x16x32_bf16 v[40:43], a[224:227], v[156:159], v[40:43]
    v_mfma_f32_16x16x32_bf16 v[44:47], a[228:231], v[156:159], v[44:47]
    v_mfma_f32_16x16x32_bf16 v[48:51], a[232:235], v[156:159], v[48:51]
    v_mfma_f32_16x16x32_bf16 v[52:55], a[236:239], v[156:159], v[52:55]
    ds_write_b128 v9, v[20:23] offset:1024
    s_waitcnt vmcnt(31)
    v_mfma_f32_16x16x32_bf16 v[36:39], a[240:243], v[160:163], v[36:39]
    v_mfma_f32_16x16x32_bf16 v[40:43], a[244:247], v[160:163], v[40:43]
    v_mfma_f32_16x16x32_bf16 v[44:47], a[248:251], v[160:163], v[44:47]
    v_mfma_f32_16x16x32_bf16 v[48:51], a[252:255], v[160:163], v[48:51]
    v_mfma_f32_16x16x32_bf16 v[52:55], a[0:3], v[160:163], v[52:55]
    ds_write_b128 v9, v[24:27] offset:2048
    s_waitcnt vmcnt(30)
    v_mfma_f32_16x16x32_bf16 v[36:39], a[4:7], v[164:167], v[36:39]
    v_mfma_f32_16x16x32_bf16 v[40:43], a[8:11], v[164:167], v[40:43]
    v_mfma_f32_16x16x32_bf16 v[44:47], a[12:15], v[164:167], v[44:47]
    v_mfma_f32_16x16x32_bf16 v[48:51], a[16:19], v[164:167], v[48:51]
    v_mfma_f32_16x16x32_bf16 v[52:55], a[20:23], v[164:167], v[52:55]
    ds_write_b128 v9, v[28:31] offset:3072
    s_waitcnt vmcnt(29)
    v_mfma_f32_16x16x32_bf16 v[36:39], a[24:27], v[168:171], v[36:39]
    v_mfma_f32_16x16x32_bf16 v[40:43], a[28:31], v[168:171], v[40:43]
    v_mfma_f32_16x16x32_bf16 v[44:47], a[32:35], v[168:171], v[44:47]
    v_mfma_f32_16x16x32_bf16 v[48:51], a[36:39], v[168:171], v[48:51]
    v_mfma_f32_16x16x32_bf16 v[52:55], a[40:43], v[168:171], v[52:55]
    ds_write_b128 v9, v[32:35] offset:4096
    s_waitcnt vmcnt(28)
    v_mfma_f32_16x16x32_bf16 v[36:39], a[44:47], v[172:175], v[36:39]
    v_mfma_f32_16x16x32_bf16 v[40:43], a[48:51], v[172:175], v[40:43]
    v_mfma_f32_16x16x32_bf16 v[44:47], a[52:55], v[172:175], v[44:47]
    v_mfma_f32_16x16x32_bf16 v[48:51], a[56:59], v[172:175], v[48:51]
    v_mfma_f32_16x16x32_bf16 v[52:55], a[60:63], v[172:175], v[52:55]
    s_waitcnt vmcnt(27)
    v_mfma_f32_16x16x32_bf16 v[36:39], a[64:67], v[176:179], v[36:39]
    v_mfma_f32_16x16x32_bf16 v[40:43], a[68:71], v[176:179], v[40:43]
    v_mfma_f32_16x16x32_bf16 v[44:47], a[72:75], v[176:179], v[44:47]
    v_mfma_f32_16x16x32_bf16 v[48:51], a[76:79], v[176:179], v[48:51]
    v_mfma_f32_16x16x32_bf16 v[52:55], a[80:83], v[176:179], v[52:55]
    s_waitcnt vmcnt(26)
    v_mfma_f32_16x16x32_bf16 v[36:39], a[84:87], v[180:183], v[36:39]
    v_mfma_f32_16x16x32_bf16 v[40:43], a[88:91], v[180:183], v[40:43]
    v_mfma_f32_16x16x32_bf16 v[44:47], a[92:95], v[180:183], v[44:47]
    v_mfma_f32_16x16x32_bf16 v[48:51], a[96:99], v[180:183], v[48:51]
    v_mfma_f32_16x16x32_bf16 v[52:55], a[100:103], v[180:183], v[52:55]
    s_waitcnt vmcnt(25)
    v_mfma_f32_16x16x32_bf16 v[36:39], a[104:107], v[184:187], v[36:39]
    v_mfma_f32_16x16x32_bf16 v[40:43], a[108:111], v[184:187], v[40:43]
    v_mfma_f32_16x16x32_bf16 v[44:47], a[112:115], v[184:187], v[44:47]
    v_mfma_f32_16x16x32_bf16 v[48:51], a[116:119], v[184:187], v[48:51]
    v_mfma_f32_16x16x32_bf16 v[52:55], a[120:123], v[184:187], v[52:55]
    s_waitcnt vmcnt(24)
    v_mfma_f32_16x16x32_bf16 v[36:39], a[124:127], v[188:191], v[36:39]
    v_mfma_f32_16x16x32_bf16 v[40:43], a[128:131], v[188:191], v[40:43]
    v_mfma_f32_16x16x32_bf16 v[44:47], a[132:135], v[188:191], v[44:47]
    v_mfma_f32_16x16x32_bf16 v[48:51], a[136:139], v[188:191], v[48:51]
    v_mfma_f32_16x16x32_bf16 v[52:55], a[140:143], v[188:191], v[52:55]
    s_waitcnt vmcnt(23)
    v_mfma_f32_16x16x32_bf16 v[56:59], a[160:163], v[192:195], 0
    v_mfma_f32_16x16x32_bf16 v[60:63], a[164:167], v[192:195], 0
    v_mfma_f32_16x16x32_bf16 v[64:67], a[168:171], v[192:195], 0
    v_mfma_f32_16x16x32_bf16 v[68:71], a[172:175], v[192:195], 0
    v_mfma_f32_16x16x32_bf16 v[72:75], a[176:179], v[192:195], 0
    s_waitcnt vmcnt(22)
    v_mfma_f32_16x16x32_bf16 v[56:59], a[180:183], v[196:199], v[56:59]
    v_mfma_f32_16x16x32_bf16 v[60:63], a[184:187], v[196:199], v[60:63]
    v_mfma_f32_16x16x32_bf16 v[64:67], a[188:191], v[196:199], v[64:67]
    v_mfma_f32_16x16x32_bf16 v[68:71], a[192:195], v[196:199], v[68:71]
    v_mfma_f32_16x16x32_bf16 v[72:75], a[196:199], v[196:199], v[72:75]
    s_waitcnt vmcnt(21)
    v_mfma_f32_16x16x32_bf16 v[56:59], a[200:203], v[200:203], v[56:59]
    v_mfma_f32_16x16x32_bf16 v[60:63], a[204:207], v[200:203], v[60:63]
    v_mfma_f32_16x16x32_bf16 v[64:67], a[208:211], v[200:203], v[64:67]
    v_mfma_f32_16x16x32_bf16 v[68:71], a[212:215], v[200:203], v[68:71]
    v_mfma_f32_16x16x32_bf16 v[72:75], a[216:219], v[200:203], v[72:75]
    ds_write_b128 v9, v[36:39] offset:5120
    s_waitcnt vmcnt(20)
    v_mfma_f32_16x16x32_bf16 v[56:59], a[220:223], v[204:207], v[56:59]
    v_mfma_f32_16x16x32_bf16 v[60:63], a[224:227], v[204:207], v[60:63]
    v_mfma_f32_16x16x32_bf16 v[64:67], a[228:231], v[204:207], v[64:67]
    v_mfma_f32_16x16x32_bf16 v[68:71], a[232:235], v[204:207], v[68:71]
    v_mfma_f32_16x16x32_bf16 v[72:75], a[236:239], v[204:207], v[72:75]
    ds_write_b128 v9, v[40:43] offset:6144
    s_waitcnt vmcnt(19)
    v_mfma_f32_16x16x32_bf16 v[56:59], a[240:243], v[208:211], v[56:59]
    v_mfma_f32_16x16x32_bf16 v[60:63], a[244:247], v[208:211], v[60:63]
    v_mfma_f32_16x16x32_bf16 v[64:67], a[248:251], v[208:211], v[64:67]
    v_mfma_f32_16x16x32_bf16 v[68:71], a[252:255], v[208:211], v[68:71]
    v_mfma_f32_16x16x32_bf16 v[72:75], a[0:3], v[208:211], v[72:75]
    ds_write_b128 v9, v[44:47] offset:7168
    s_waitcnt vmcnt(18)
    v_mfma_f32_16x16x32_bf16 v[56:59], a[4:7], v[212:215], v[56:59]
    v_mfma_f32_16x16x32_bf16 v[60:63], a[8:11], v[212:215], v[60:63]
    v_mfma_f32_16x16x32_bf16 v[64:67], a[12:15], v[212:215], v[64:67]
    v_mfma_f32_16x16x32_bf16 v[68:71], a[16:19], v[212:215], v[68:71]
    v_mfma_f32_16x16x32_bf16 v[72:75], a[20:23], v[212:215], v[72:75]
    ds_write_b128 v9, v[48:51] offset:8192
    s_waitcnt vmcnt(17)
    v_mfma_f32_16x16x32_bf16 v[56:59], a[24:27], v[216:219], v[56:59]
    v_mfma_f32_16x16x32_bf16 v[60:63], a[28:31], v[216:219], v[60:63]
    v_mfma_f32_16x16x32_bf16 v[64:67], a[32:35], v[216:219], v[64:67]
    v_mfma_f32_16x16x32_bf16 v[68:71], a[36:39], v[216:219], v[68:71]
    v_mfma_f32_16x16x32_bf16 v[72:75], a[40:43], v[216:219], v[72:75]
    ds_write_b128 v9, v[52:55] offset:9216
    s_waitcnt vmcnt(16)
    v_mfma_f32_16x16x32_bf16 v[56:59], a[44:47], v[220:223], v[56:59]
    v_mfma_f32_16x16x32_bf16 v[60:63], a[48:51], v[220:223], v[60:63]
    v_mfma_f32_16x16x32_bf16 v[64:67], a[52:55], v[220:223], v[64:67]
    v_mfma_f32_16x16x32_bf16 v[68:71], a[56:59], v[220:223], v[68:71]
    v_mfma_f32_16x16x32_bf16 v[72:75], a[60:63], v[220:223], v[72:75]
    s_waitcnt vmcnt(15)
    v_mfma_f32_16x16x32_bf16 v[56:59], a[64:67], v[224:227], v[56:59]
    v_mfma_f32_16x16x32_bf16 v[60:63], a[68:71], v[224:227], v[60:63]
    v_mfma_f32_16x16x32_bf16 v[64:67], a[72:75], v[224:227], v[64:67]
    v_mfma_f32_16x16x32_bf16 v[68:71], a[76:79], v[224:227], v[68:71]
    v_mfma_f32_16x16x32_bf16 v[72:75], a[80:83], v[224:227], v[72:75]
    s_waitcnt vmcnt(14)
    v_mfma_f32_16x16x32_bf16 v[56:59], a[84:87], v[228:231], v[56:59]
    v_mfma_f32_16x16x32_bf16 v[60:63], a[88:91], v[228:231], v[60:63]
    v_mfma_f32_16x16x32_bf16 v[64:67], a[92:95], v[228:231], v[64:67]
    v_mfma_f32_16x16x32_bf16 v[68:71], a[96:99], v[228:231], v[68:71]
    v_mfma_f32_16x16x32_bf16 v[72:75], a[100:103], v[228:231], v[72:75]
    s_waitcnt vmcnt(13)
    v_mfma_f32_16x16x32_bf16 v[56:59], a[104:107], v[232:235], v[56:59]
    v_mfma_f32_16x16x32_bf16 v[60:63], a[108:111], v[232:235], v[60:63]
    v_mfma_f32_16x16x32_bf16 v[64:67], a[112:115], v[232:235], v[64:67]
    v_mfma_f32_16x16x32_bf16 v[68:71], a[116:119], v[232:235], v[68:71]
    v_mfma_f32_16x16x32_bf16 v[72:75], a[120:123], v[232:235], v[72:75]
    s_waitcnt vmcnt(12)
    v_mfma_f32_16x16x32_bf16 v[56:59], a[124:127], v[236:239], v[56:59]
    v_mfma_f32_16x16x32_bf16 v[60:63], a[128:131], v[236:239], v[60:63]
    v_mfma_f32_16x16x32_bf16 v[64:67], a[132:135], v[236:239], v[64:67]
    v_mfma_f32_16x16x32_bf16 v[68:71], a[136:139], v[236:239], v[68:71]
    v_mfma_f32_16x16x32_bf16 v[72:75], a[140:143], v[236:239], v[72:75]
    s_waitcnt vmcnt(11)
    v_mfma_f32_16x16x32_bf16 v[76:79], a[160:163], v[240:243], 0
    v_mfma_f32_16x16x32_bf16 v[80:83], a[164:167], v[240:243], 0
    v_mfma_f32_16x16x32_bf16 v[84:87], a[168:171], v[240:243], 0
    v_mfma_f32_16x16x32_bf16 v[88:91], a[172:175], v[240:243], 0
    v_mfma_f32_16x16x32_bf16 v[92:95], a[176:179], v[240:243], 0
    s_waitcnt vmcnt(10)
    v_mfma_f32_16x16x32_bf16 v[76:79], a[180:183], v[244:247], v[76:79]
    v_mfma_f32_16x16x32_bf16 v[80:83], a[184:187], v[244:247], v[80:83]
    v_mfma_f32_16x16x32_bf16 v[84:87], a[188:191], v[244:247], v[84:87]
    v_mfma_f32_16x16x32_bf16 v[88:91], a[192:195], v[244:247], v[88:91]
    v_mfma_f32_16x16x32_bf16 v[92:95], a[196:199], v[244:247], v[92:95]
    s_waitcnt vmcnt(9)
    v_mfma_f32_16x16x32_bf16 v[76:79], a[200:203], v[248:251], v[76:79]
    v_mfma_f32_16x16x32_bf16 v[80:83], a[204:207], v[248:251], v[80:83]
    v_mfma_f32_16x16x32_bf16 v[84:87], a[208:211], v[248:251], v[84:87]
    v_mfma_f32_16x16x32_bf16 v[88:91], a[212:215], v[248:251], v[88:91]
    v_mfma_f32_16x16x32_bf16 v[92:95], a[216:219], v[248:251], v[92:95]
    ds_write_b128 v9, v[56:59] offset:10240
    s_waitcnt vmcnt(8)
    v_mfma_f32_16x16x32_bf16 v[76:79], a[220:223], v[252:255], v[76:79]
    v_mfma_f32_16x16x32_bf16 v[80:83], a[224:227], v[252:255], v[80:83]
    v_mfma_f32_16x16x32_bf16 v[84:87], a[228:231], v[252:255], v[84:87]
    v_mfma_f32_16x16x32_bf16 v[88:91], a[232:235], v[252:255], v[88:91]
    v_mfma_f32_16x16x32_bf16 v[92:95], a[236:239], v[252:255], v[92:95]
    ds_write_b128 v9, v[60:63] offset:11264
    s_waitcnt vmcnt(7)
    v_mfma_f32_16x16x32_bf16 v[76:79], a[240:243], v[96:99], v[76:79]
    v_mfma_f32_16x16x32_bf16 v[80:83], a[244:247], v[96:99], v[80:83]
    v_mfma_f32_16x16x32_bf16 v[84:87], a[248:251], v[96:99], v[84:87]
    v_mfma_f32_16x16x32_bf16 v[88:91], a[252:255], v[96:99], v[88:91]
    v_mfma_f32_16x16x32_bf16 v[92:95], a[0:3], v[96:99], v[92:95]
    ds_write_b128 v9, v[64:67] offset:12288
    s_waitcnt vmcnt(6)
    v_mfma_f32_16x16x32_bf16 v[76:79], a[4:7], v[100:103], v[76:79]
    v_mfma_f32_16x16x32_bf16 v[80:83], a[8:11], v[100:103], v[80:83]
    v_mfma_f32_16x16x32_bf16 v[84:87], a[12:15], v[100:103], v[84:87]
    v_mfma_f32_16x16x32_bf16 v[88:91], a[16:19], v[100:103], v[88:91]
    v_mfma_f32_16x16x32_bf16 v[92:95], a[20:23], v[100:103], v[92:95]
    ds_write_b128 v9, v[68:71] offset:13312
    s_waitcnt vmcnt(5)
    v_mfma_f32_16x16x32_bf16 v[76:79], a[24:27], v[104:107], v[76:79]
    v_mfma_f32_16x16x32_bf16 v[80:83], a[28:31], v[104:107], v[80:83]
    v_mfma_f32_16x16x32_bf16 v[84:87], a[32:35], v[104:107], v[84:87]
    v_mfma_f32_16x16x32_bf16 v[88:91], a[36:39], v[104:107], v[88:91]
    v_mfma_f32_16x16x32_bf16 v[92:95], a[40:43], v[104:107], v[92:95]
    ds_write_b128 v9, v[72:75] offset:14336
    s_waitcnt vmcnt(4)
    v_mfma_f32_16x16x32_bf16 v[76:79], a[44:47], v[108:111], v[76:79]
    v_mfma_f32_16x16x32_bf16 v[80:83], a[48:51], v[108:111], v[80:83]
    v_mfma_f32_16x16x32_bf16 v[84:87], a[52:55], v[108:111], v[84:87]
    v_mfma_f32_16x16x32_bf16 v[88:91], a[56:59], v[108:111], v[88:91]
    v_mfma_f32_16x16x32_bf16 v[92:95], a[60:63], v[108:111], v[92:95]
    s_waitcnt vmcnt(3)
    v_mfma_f32_16x16x32_bf16 v[76:79], a[64:67], v[112:115], v[76:79]
    v_mfma_f32_16x16x32_bf16 v[80:83], a[68:71], v[112:115], v[80:83]
    v_mfma_f32_16x16x32_bf16 v[84:87], a[72:75], v[112:115], v[84:87]
    v_mfma_f32_16x16x32_bf16 v[88:91], a[76:79], v[112:115], v[88:91]
    v_mfma_f32_16x16x32_bf16 v[92:95], a[80:83], v[112:115], v[92:95]
    s_waitcnt vmcnt(2)
    v_mfma_f32_16x16x32_bf16 v[76:79], a[84:87], v[116:119], v[76:79]
    v_mfma_f32_16x16x32_bf16 v[80:83], a[88:91], v[116:119], v[80:83]
    v_mfma_f32_16x16x32_bf16 v[84:87], a[92:95], v[116:119], v[84:87]
    v_mfma_f32_16x16x32_bf16 v[88:91], a[96:99], v[116:119], v[88:91]
    v_mfma_f32_16x16x32_bf16 v[92:95], a[100:103], v[116:119], v[92:95]
    s_waitcnt vmcnt(1)
    v_mfma_f32_16x16x32_bf16 v[76:79], a[104:107], v[120:123], v[76:79]
    v_mfma_f32_16x16x32_bf16 v[80:83], a[108:111], v[120:123], v[80:83]
    v_mfma_f32_16x16x32_bf16 v[84:87], a[112:115], v[120:123], v[84:87]
    v_mfma_f32_16x16x32_bf16 v[88:91], a[116:119], v[120:123], v[88:91]
    v_mfma_f32_16x16x32_bf16 v[92:95], a[120:123], v[120:123], v[92:95]
    s_waitcnt vmcnt(0)
    v_mfma_f32_16x16x32_bf16 v[76:79], a[124:127], v[124:127], v[76:79]
    v_mfma_f32_16x16x32_bf16 v[80:83], a[128:131], v[124:127], v[80:83]
    v_mfma_f32_16x16x32_bf16 v[84:87], a[132:135], v[124:127], v[84:87]
    v_mfma_f32_16x16x32_bf16 v[88:91], a[136:139], v[124:127], v[88:91]
    v_mfma_f32_16x16x32_bf16 v[92:95], a[140:143], v[124:127], v[92:95]
    s_nop 3
    ds_write_b128 v9, v[76:79] offset:15360
    ds_write_b128 v9, v[80:83] offset:16384
    ds_write_b128 v9, v[84:87] offset:17408
    ds_write_b128 v9, v[88:91] offset:18432
    ds_write_b128 v9, v[92:95] offset:19456
    s_waitcnt lgkmcnt(0)
    s_barrier
    s_mul_i32 s46, s44, 5120
    v_add_u32 v9, s46, v8
    v_add_u32 v10, 40960, v9
    ds_read_b128 v[16:19], v9 offset:0
    ds_read_b128 v[20:23], v9 offset:1024
    ds_read_b128 v[24:27], v9 offset:2048
    ds_read_b128 v[28:31], v9 offset:3072
    ds_read_b128 v[32:35], v9 offset:4096
    ds_read_b128 v[36:39], v9 offset:20480
    ds_read_b128 v[40:43], v9 offset:21504
    ds_read_b128 v[44:47], v9 offset:22528
    ds_read_b128 v[48:51], v9 offset:23552
    ds_read_b128 v[52:55], v9 offset:24576
    ds_read_b128 v[56:59], v10 offset:0
    ds_read_b128 v[60:63], v10 offset:1024
    ds_read_b128 v[64:67], v10 offset:2048
    ds_read_b128 v[68:71], v10 offset:3072
    ds_read_b128 v[72:75], v10 offset:4096
    ds_read_b128 v[76:79], v10 offset:20480
    ds_read_b128 v[80:83], v10 offset:21504
    ds_read_b128 v[84:87], v10 offset:22528
    ds_read_b128 v[88:91], v10 offset:23552
    ds_read_b128 v[92:95], v10 offset:24576
    v_add_u32 v10, 106496, v8
    s_waitcnt lgkmcnt(14)
    v_pk_add_f32 v[16:17], v[16:17], v[36:37]
    s_waitcnt lgkmcnt(4)
    v_pk_add_f32 v[56:57], v[56:57], v[76:77]
    v_pk_add_f32 v[18:19], v[18:19], v[38:39]
    v_pk_add_f32 v[58:59], v[58:59], v[78:79]
    v_pk_add_f32 v[20:21], v[20:21], v[40:41]
    s_waitcnt lgkmcnt(3)
    v_pk_add_f32 v[60:61], v[60:61], v[80:81]
    v_pk_add_f32 v[22:23], v[22:23], v[42:43]
    v_pk_add_f32 v[62:63], v[62:63], v[82:83]
    v_pk_add_f32 v[24:25], v[24:25], v[44:45]
    s_waitcnt lgkmcnt(2)
    v_pk_add_f32 v[64:65], v[64:65], v[84:85]
    v_pk_add_f32 v[26:27], v[26:27], v[46:47]
    v_pk_add_f32 v[66:67], v[66:67], v[86:87]
    v_pk_add_f32 v[28:29], v[28:29], v[48:49]
    s_waitcnt lgkmcnt(1)
    v_pk_add_f32 v[68:69], v[68:69], v[88:89]
    v_pk_add_f32 v[30:31], v[30:31], v[50:51]
    v_pk_add_f32 v[70:71], v[70:71], v[90:91]
    v_pk_add_f32 v[32:33], v[32:33], v[52:53]
    s_waitcnt lgkmcnt(0)
    v_pk_add_f32 v[72:73], v[72:73], v[92:93]
    v_pk_add_f32 v[34:35], v[34:35], v[54:55]
    v_pk_add_f32 v[74:75], v[74:75], v[94:95]
    v_pk_add_f32 v[16:17], v[16:17], v[56:57]
    v_pk_add_f32 v[18:19], v[18:19], v[58:59]
    v_pk_add_f32 v[20:21], v[20:21], v[60:61]
    v_pk_add_f32 v[22:23], v[22:23], v[62:63]
    v_pk_add_f32 v[24:25], v[24:25], v[64:65]
    v_pk_add_f32 v[26:27], v[26:27], v[66:67]
    v_pk_add_f32 v[28:29], v[28:29], v[68:69]
    v_pk_add_f32 v[30:31], v[30:31], v[70:71]
    v_pk_add_f32 v[32:33], v[32:33], v[72:73]
    v_pk_add_f32 v[34:35], v[34:35], v[74:75]
    s_waitcnt vmcnt(0)
    s_waitcnt lgkmcnt(0)
    v_accvgpr_read_b32 v96, a144
    v_accvgpr_read_b32 v97, a145
    v_accvgpr_read_b32 v98, a146
    v_accvgpr_read_b32 v99, a147
    v_accvgpr_read_b32 v100, a148
    v_accvgpr_read_b32 v101, a149
    v_accvgpr_read_b32 v102, a150
    v_accvgpr_read_b32 v103, a151
    v_accvgpr_read_b32 v104, a152
    v_accvgpr_read_b32 v105, a153
    v_cvt_pk_bf16_f32 v10, v16, v17
    v_lshlrev_b32 v16, 16, v10
    v_and_b32 v17, 0xffff0000, v10
    v_lshlrev_b32 v36, 16, v96
    v_and_b32 v37, 0xffff0000, v96
    v_pk_add_f32 v[16:17], v[16:17], v[36:37]
    v_cvt_pk_bf16_f32 v56, v16, v17
    v_cvt_pk_bf16_f32 v10, v18, v19
    v_lshlrev_b32 v18, 16, v10
    v_and_b32 v19, 0xffff0000, v10
    v_lshlrev_b32 v38, 16, v97
    v_and_b32 v39, 0xffff0000, v97
    v_pk_add_f32 v[18:19], v[18:19], v[38:39]
    v_cvt_pk_bf16_f32 v57, v18, v19
    v_cvt_pk_bf16_f32 v10, v20, v21
    v_lshlrev_b32 v20, 16, v10
    v_and_b32 v21, 0xffff0000, v10
    v_lshlrev_b32 v40, 16, v98
    v_and_b32 v41, 0xffff0000, v98
    v_pk_add_f32 v[20:21], v[20:21], v[40:41]
    v_cvt_pk_bf16_f32 v58, v20, v21
    v_cvt_pk_bf16_f32 v10, v22, v23
    v_lshlrev_b32 v22, 16, v10
    v_and_b32 v23, 0xffff0000, v10
    v_lshlrev_b32 v42, 16, v99
    v_and_b32 v43, 0xffff0000, v99
    v_pk_add_f32 v[22:23], v[22:23], v[42:43]
    v_cvt_pk_bf16_f32 v59, v22, v23
    v_cvt_pk_bf16_f32 v10, v24, v25
    v_lshlrev_b32 v24, 16, v10
    v_and_b32 v25, 0xffff0000, v10
    v_lshlrev_b32 v44, 16, v100
    v_and_b32 v45, 0xffff0000, v100
    v_pk_add_f32 v[24:25], v[24:25], v[44:45]
    v_cvt_pk_bf16_f32 v60, v24, v25
    v_cvt_pk_bf16_f32 v10, v26, v27
    v_lshlrev_b32 v26, 16, v10
    v_and_b32 v27, 0xffff0000, v10
    v_lshlrev_b32 v46, 16, v101
    v_and_b32 v47, 0xffff0000, v101
    v_pk_add_f32 v[26:27], v[26:27], v[46:47]
    v_cvt_pk_bf16_f32 v61, v26, v27
    v_cvt_pk_bf16_f32 v10, v28, v29
    v_lshlrev_b32 v28, 16, v10
    v_and_b32 v29, 0xffff0000, v10
    v_lshlrev_b32 v48, 16, v102
    v_and_b32 v49, 0xffff0000, v102
    v_pk_add_f32 v[28:29], v[28:29], v[48:49]
    v_cvt_pk_bf16_f32 v62, v28, v29
    v_cvt_pk_bf16_f32 v10, v30, v31
    v_lshlrev_b32 v30, 16, v10
    v_and_b32 v31, 0xffff0000, v10
    v_lshlrev_b32 v50, 16, v103
    v_and_b32 v51, 0xffff0000, v103
    v_pk_add_f32 v[30:31], v[30:31], v[50:51]
    v_cvt_pk_bf16_f32 v63, v30, v31
    v_cvt_pk_bf16_f32 v10, v32, v33
    v_lshlrev_b32 v32, 16, v10
    v_and_b32 v33, 0xffff0000, v10
    v_lshlrev_b32 v52, 16, v104
    v_and_b32 v53, 0xffff0000, v104
    v_pk_add_f32 v[32:33], v[32:33], v[52:53]
    v_cvt_pk_bf16_f32 v64, v32, v33
    v_cvt_pk_bf16_f32 v10, v34, v35
    v_lshlrev_b32 v34, 16, v10
    v_and_b32 v35, 0xffff0000, v10
    v_lshlrev_b32 v54, 16, v105
    v_and_b32 v55, 0xffff0000, v105
    v_pk_add_f32 v[34:35], v[34:35], v[54:55]
    v_cvt_pk_bf16_f32 v65, v34, v35
    buffer_store_dwordx2 v[56:57], v6, s[28:31], 0 offen offset:0
    buffer_store_dwordx2 v[58:59], v6, s[28:31], 0 offen offset:32
    buffer_store_dwordx2 v[60:61], v6, s[28:31], 0 offen offset:64
    buffer_store_dwordx2 v[62:63], v6, s[28:31], 0 offen offset:96
    buffer_store_dwordx2 v[64:65], v6, s[28:31], 0 offen offset:128
    s_waitcnt vmcnt(0)
    s_nop 15
L_g12b_kernel_end:
    s_endpgm
L_text_end:
.section .rodata,"a"
.p2align 6
.amdhsa_kernel k1_kernel
  .amdhsa_next_free_vgpr 184
  .amdhsa_next_free_sgpr 64
  .amdhsa_accum_offset 124
  .amdhsa_group_segment_fixed_size 0
  .amdhsa_kernarg_size 72
  .amdhsa_user_sgpr_count 2
  .amdhsa_user_sgpr_kernarg_segment_ptr 1
  .amdhsa_system_sgpr_workgroup_id_x 1
  .amdhsa_float_denorm_mode_32 3
  .amdhsa_float_denorm_mode_16_64 3
.end_amdhsa_kernel
.p2align 6
.amdhsa_kernel c1_kernel
  .amdhsa_next_free_vgpr 448
  .amdhsa_next_free_sgpr 64
  .amdhsa_accum_offset 252
  .amdhsa_group_segment_fixed_size 0
  .amdhsa_kernarg_size 72
  .amdhsa_user_sgpr_count 2
  .amdhsa_user_sgpr_kernarg_segment_ptr 1
  .amdhsa_system_sgpr_workgroup_id_x 1
  .amdhsa_float_denorm_mode_32 3
  .amdhsa_float_denorm_mode_16_64 3
.end_amdhsa_kernel
.p2align 6
.amdhsa_kernel c2_kernel
  .amdhsa_next_free_vgpr 448
  .amdhsa_next_free_sgpr 64
  .amdhsa_accum_offset 252
  .amdhsa_group_segment_fixed_size 0
  .amdhsa_kernarg_size 72
  .amdhsa_user_sgpr_count 2
  .amdhsa_user_sgpr_kernarg_segment_ptr 1
  .amdhsa_system_sgpr_workgroup_id_x 1
  .amdhsa_float_denorm_mode_32 3
  .amdhsa_float_denorm_mode_16_64 3
.end_amdhsa_kernel
.p2align 6
.amdhsa_kernel g12a_kernel
  .amdhsa_next_free_vgpr 512
  .amdhsa_next_free_sgpr 68
  .amdhsa_accum_offset 256
  .amdhsa_group_segment_fixed_size 0
  .amdhsa_kernarg_size 72
  .amdhsa_user_sgpr_count 2
  .amdhsa_user_sgpr_kernarg_segment_ptr 1
  .amdhsa_system_sgpr_workgroup_id_x 1
  .amdhsa_float_denorm_mode_32 3
  .amdhsa_float_denorm_mode_16_64 3
.end_amdhsa_kernel
.p2align 6
.amdhsa_kernel g12b_kernel
  .amdhsa_next_free_vgpr 512
  .amdhsa_next_free_sgpr 70
  .amdhsa_accum_offset 256
  .amdhsa_group_segment_fixed_size 0
  .amdhsa_kernarg_size 72
  .amdhsa_user_sgpr_count 2
  .amdhsa_user_sgpr_kernarg_segment_ptr 1
  .amdhsa_system_sgpr_workgroup_id_x 1
  .amdhsa_float_denorm_mode_32 3
  .amdhsa_float_denorm_mode_16_64 3
.end_amdhsa_kernel
.p2align 8
tab_base:
.p2align 8
tab_G80F:
.long 0xbf803f80,0xbf803f80,0xbf803f80,0xbf803f80,0x0,0x0,0x0,0x0
.long 0x3f7f3f80,0x3f793f7d,0x3e6f3e9e,0x3da13e20,0xbda18000,0xbe6fbe20,0xbf79bf73,0xbf7fbf7d
.long 0x3f7d3f80,0x3f643f73,0xbf64bf4f,0xbf7dbf73,0xbe208000,0xbee8be9e,0xbee8bf16,0xbe20be9e
.long 0x3f793f80,0x3f433f64,0xbf26bf4f,0xbe6fbee8,0xbe6f8000,0xbf26bee8,0x3f433f16,0x3f793f64
.long 0x3f733f80,0x3f163f4f,0x3f163e9e,0x3f733f4f,0xbe9e8000,0xbf4fbf16,0x3f4f3f73,0x3e9e3f16
.long 0x3f6d3f80,0x3ec43f35,0x3f6d3f80,0x3ec43f35,0xbec48000,0xbf6dbf35,0xbec4258d,0xbf6dbf35
.long 0x3f643f80,0x3e203f16,0xbe203e9e,0xbf64bf16,0xbee88000,0xbf7dbf4f,0xbf7dbf73,0xbee8bf4f
.long 0x3f5a3f80,0xbda13ee8,0xbf7fbf4f,0xbf06bf64,0xbf068000,0xbf7fbf64,0xbda1bf16,0x3f5a3ee8
.long 0xbf803f80,0xbf803f80,0xbf803f80,0xbf803f80,0x0,0x0,0x0,0x0
.long 0x3f6d3f73,0x3f5a3f64,0xbda1248d,0xbe6fbe20,0xbec4be9e,0xbf06bee8,0xbf7fbf80,0xbf79bf7d
.long 0x3f353f4f,0x3ee83f16,0xbf7dbf80,0xbf64bf73,0xbf35bf16,0xbf64bf4f,0x3e20a50d,0x3ee83e9e
.long 0x3ec43f16,0xbda13e20,0x3e6fa554,0x3f263ee8,0xbf6dbf4f,0xbf7fbf7d,0x3f793f80,0x3f433f64
.long 0x248d3e9e,0xbf16be9e,0x3f733f80,0x3f163f4f,0xbf80bf73,0xbf4fbf73,0xbe9e258d,0xbf4fbf16
.long 0xbec4248d,0xbf6dbf35,0xbec425b0,0xbf6dbf35,0xbf6dbf80,0xbec4bf35,0xbf6dbf80,0xbec4bf35
.long 0xbf35be9e,0xbf7dbf73,0xbf64bf80,0xbe20bf16,0xbf35bf73,0x3e20be9e,0x3ee8a5d4,0x3f7d3f4f
.long 0xbf6dbf16,0xbf43bf7d,0x3f06a5f7,0x3f7f3f64,0xbec4bf4f,0x3f263e20,0x3f5a3f80,0xbda13ee8
.long 0xbf803f80,0xbf803f80,0xbf803f80,0xbf803f80,0x0,0x0,0x0,0x0
.long 0x3f433f4f,0x3f263f35,0xbec4be9e,0xbf06bee8,0xbf26bf16,0xbf43bf35,0xbf6dbf73,0xbf5abf64
.long 0x3e203e9e,0xbe20248d,0xbf35bf4f,0xbee8bf16,0xbf7dbf73,0xbf7dbf80,0x3f353f16,0x3f643f4f
.long 0xbf06be9e,0xbf5abf35,0x3f6d3f4f,0x3f7f3f7d,0xbf5abf73,0xbf06bf35,0x3ec43f16,0xbda13e20
.long 0xbf73bf4f,0xbf73bf80,0x25b03e9e,0xbf16be9e,0xbe9ebf16,0x3e9ea50d,0xbf80bf73,0xbf4fbf73
.long 0xbf6dbf80,0xbec4bf35,0xbf6dbf80,0xbec4bf35,0x3ec4a50d,0x3f6d3f35,0x3ec4a5d4,0x3f6d3f35
.long 0xbee8bf4f,0x3ee8a554,0x3f353e9e,0x3f7d3f73,0x3f643f16,0x3f643f80,0x3f353f73,0xbe203e9e
.long 0x3e6fbe9e,0x3f793f35,0x3ec43f4f,0xbf26be20,0x3f793f73,0x3e6f3f35,0xbf6dbf16,0xbf43bf7d
.long 0xbf803f80,0xbf803f80,0xbf803f80,0xbf803f80,0x0,0x0,0x0,0x0
.long 0x3f063f16,0x3ec43ee8,0xbf26bf16,0xbf43bf35,0xbf5abf4f,0xbf6dbf64,0xbf43bf4f,0xbf26bf35
.long 0xbee8be9e,0xbf35bf16,0xbe20be9e,0x3e20a554,0xbf64bf73,0xbf35bf4f,0x3f7d3f73,0x3f7d3f80
.long 0xbf7fbf73,0xbf6dbf7d,0x3f5a3f73,0x3f063f35,0xbda1be9e,0x3ec43e20,0xbf06be9e,0xbf5abf35
.long 0xbf16bf4f,0xa554be9e,0xbf73bf4f,0xbf73bf80,0x3f4f3f16,0x3f803f73,0xbe9ebf16,0x3e9ea5d4
.long 0x3ec4a554,0x3f6d3f35,0x3ec4a5f7,0x3f6d3f35,0x3f6d3f80,0x3ec43f35,0x3f6d3f80,0x3ec43f35
.long 0x3f7d3f4f,0x3f353f73,0x3ee83f4f,0xbee8261f,0x3e203f16,0xbf35be9e,0xbf64bf16,0xbf64bf80
.long 0x3f263f73,0xbec43e20,0xbf79bf73,0xbe6fbf35,0xbf43be9e,0xbf6dbf7d,0x3e6fbe9e,0x3f793f35
.long 0xbf803f80,0xbf803f80,0xbf803f80,0xbf803f80,0x0,0x0,0x0,0x0
.long 0xbf5abf4f,0xbf6dbf64,0xbf43bf4f,0xbf26bf35,0xbf06bf16,0xbec4bee8,0x3f263f16,0x3f433f35
.long 0x3ee83e9e,0x3f353f16,0x3e203e9e,0xbe2025b0,0x3f643f73,0x3f353f4f,0xbf7dbf73,0xbf7dbf80
.long 0x3da13e9e,0xbec4be20,0x3f063e9e,0x3f5a3f35,0xbf7fbf73,0xbf6dbf7d,0x3f5a3f73,0x3f063f35
.long 0xbf16bf4f,0xa5f7be9e,0xbf73bf4f,0xbf73bf80,0x3f4f3f16,0x3f803f73,0xbe9ebf16,0x3e9ea630
.long 0x3f6d3f80,0x3ec43f35,0x3f6d3f80,0x3ec43f35,0xbec4260d,0xbf6dbf35,0xbec42654,0xbf6dbf35
.long 0xbf7dbf4f,0xbf35bf73,0xbee8bf4f,0x3ee8a742,0xbe20bf16,0x3f353e9e,0x3f643f16,0x3f643f80
.long 0x3f433e9e,0x3f6d3f7d,0xbe6f3e9e,0xbf79bf35,0x3f263f73,0xbec43e20,0xbf79bf73,0xbe6fbf35
.long 0xbf803f80,0xbf803f80,0xbf803f80,0xbf803f80,0x0,0x0,0x0,0x0
.long 0xbf79bf73,0xbf7fbf7d,0xbf06bf16,0xbec4bee8,0xbe6fbe9e,0xbda1be20,0x3f5a3f4f,0x3f6d3f64
.long 0x3f643f4f,0x3f7d3f73,0xbee8be9e,0xbf35bf16,0x3ee83f16,0x3e203e9e,0xbf64bf73,0xbf35bf4f
.long 0xbf43bf16,0xbf79bf64,0x3f7f3f73,0x3f6d3f7d,0xbf26bf4f,0xbe6fbee8,0x3da13e9e,0xbec4be20
.long 0x3f163e9e,0x3f733f4f,0xbf16bf4f,0x269fbe9e,0x3f4f3f73,0x3e9e3f16,0x3f4f3f16,0x3f803f73
.long 0xbec4261f,0xbf6dbf35,0xbec42739,0xbf6dbf35,0xbf6dbf80,0xbec4bf35,0xbf6dbf80,0xbec4bf35
.long 0x3e20be9e,0x3f643f16,0x3f7d3f4f,0x3f353f73,0x3f7d3f73,0x3ee83f4f,0x3e203f16,0xbf35be9e
.long 0x3da13f16,0xbf5abee8,0xbf26bf73,0x3ec4be20,0xbf7fbf4f,0xbf06bf64,0x3f433e9e,0x3f6d3f7d
.long 0xbf803f80,0xbf803f80,0xbf803f80,0xbf803f80,0x0,0x0,0x0,0x0
.long 0xbf7fbf80,0xbf79bf7d,0xbe6fbe9e,0xbda1be20,0x3da1a50d,0x3e6f3e20,0x3f793f73,0x3f7f3f7d
.long 0x3f7d3f80,0x3f643f73,0xbf64bf4f,0xbf7dbf73,0xbe20258d,0xbee8be9e,0xbee8bf16,0xbe20be9e
.long 0xbf79bf80,0xbf43bf64,0x3f263f4f,0x3e6f3ee8,0x3e6fa5d4,0x3f263ee8,0xbf43bf16,0xbf79bf64
.long 0x3f733f80,0x3f163f4f,0x3f163e9e,0x3f733f4f,0xbe9e260d,0xbf4fbf16,0x3f4f3f73,0x3e9e3f16
.long 0xbf6dbf80,0xbec4bf35,0xbf6dbf80,0xbec4bf35,0x3ec4a630,0x3f6d3f35,0x3ec4a677,0x3f6d3f35
.long 0x3f643f80,0x3e203f16,0xbe203e9e,0xbf64bf16,0xbee82654,0xbf7dbf4f,0xbf7dbf73,0xbee8bf4f
.long 0xbf5abf80,0x3da1bee8,0x3f7f3f4f,0x3f063f64,0x3f06a677,0x3f7f3f64,0x3da13f16,0xbf5abee8
.long 0xbf803f80,0xbf803f80,0xbf803f80,0xbf803f80,0x0,0x0,0x0,0x0
.long 0xbf6dbf73,0xbf5abf64,0x3da1a554,0x3e6f3e20,0x3ec43e9e,0x3f063ee8,0x3f7f3f80,0x3f793f7d
.long 0x3f353f4f,0x3ee83f16,0xbf7dbf80,0xbf64bf73,0xbf35bf16,0xbf64bf4f,0x3e20a5d4,0x3ee83e9e
.long 0xbec4bf16,0x3da1be20,0xbe6f261f,0xbf26bee8,0x3f6d3f4f,0x3f7f3f7d,0xbf79bf80,0xbf43bf64
.long 0x261f3e9e,0xbf16be9e,0x3f733f80,0x3f163f4f,0xbf80bf73,0xbf4fbf73,0xbe9e2654,0xbf4fbf16
.long 0x3ec4269f,0x3f6d3f35,0x3ec4a742,0x3f6d3f35,0x3f6d3f80,0x3ec43f35,0x3f6d3f80,0x3ec43f35
.long 0xbf35be9e,0xbf7dbf73,0xbf64bf80,0xbe20bf16,0xbf35bf73,0x3e20be9e,0x3ee8a69f,0x3f7d3f4f
.long 0x3f6d3f16,0x3f433f7d,0xbf06a60d,0xbf7fbf64,0x3ec43f4f,0xbf26be20,0xbf5abf80,0x3da1bee8
.long 0xbf803f80,0xbf803f80,0x0,0x0,0x0,0x0,0x0,0x0
.long 0x3ec43e9e,0x3f063ee8,0x0,0x0,0x3f6d3f73,0x3f5a3f64,0x0,0x0
.long 0xbf35bf4f,0xbee8bf16,0x0,0x0,0x3f353f16,0x3f643f4f,0x0,0x0
.long 0xbf6dbf4f,0xbf7fbf7d,0x0,0x0,0xbec4bf16,0x3da1be20,0x0,0x0
.long 0x27393e9e,0xbf16be9e,0x0,0x0,0xbf80bf73,0xbf4fbf73,0x0,0x0
.long 0x3f6d3f80,0x3ec43f35,0x0,0x0,0xbec4268d,0xbf6dbf35,0x0,0x0
.long 0x3f353e9e,0x3f7d3f73,0x0,0x0,0x3f353f73,0xbe203e9e,0x0,0x0
.long 0xbec4bf4f,0x3f263e20,0x0,0x0,0x3f6d3f16,0x3f433f7d,0x0,0x0
.long 0xbf803f80,0xbf803f80,0x0,0x0,0x0,0x0,0x0,0x0
.long 0x3f263f16,0x3f433f35,0x0,0x0,0x3f433f4f,0x3f263f35,0x0,0x0
.long 0xbe20be9e,0x3e20a5f7,0x0,0x0,0x3f7d3f73,0x3f7d3f80,0x0,0x0
.long 0xbf5abf73,0xbf06bf35,0x0,0x0,0x3f063e9e,0x3f5a3f35,0x0,0x0
.long 0xbf73bf4f,0xbf73bf80,0x0,0x0,0xbe9ebf16,0x3e9ea677,0x0,0x0
.long 0xbec4a654,0xbf6dbf35,0x0,0x0,0xbf6dbf80,0xbec4bf35,0x0,0x0
.long 0x3ee83f4f,0xbee8a60d,0x0,0x0,0xbf64bf16,0xbf64bf80,0x0,0x0
.long 0x3f793f73,0x3e6f3f35,0x0,0x0,0xbe6f3e9e,0xbf79bf35,0x0,0x0
.long 0xbf803f80,0xbf803f80,0x0,0x0,0x0,0x0,0x0,0x0
.long 0x3f5a3f4f,0x3f6d3f64,0x0,0x0,0x3f063f16,0x3ec43ee8,0x0,0x0
.long 0x3ee83e9e,0x3f353f16,0x0,0x0,0x3f643f73,0x3f353f4f,0x0,0x0
.long 0xbda1be9e,0x3ec43e20,0x0,0x0,0x3f7f3f73,0x3f6d3f7d,0x0,0x0
.long 0xbf16bf4f,0xa742be9e,0x0,0x0,0x3f4f3f16,0x3f803f73,0x0,0x0
.long 0xbf6dbf80,0xbec4bf35,0x0,0x0,0x3ec4a69f,0x3f6d3f35,0x0,0x0
.long 0xbf7dbf4f,0xbf35bf73,0x0,0x0,0xbe20bf16,0x3f353e9e,0x0,0x0
.long 0xbf43be9e,0xbf6dbf7d,0x0,0x0,0xbf26bf73,0x3ec4be20,0x0,0x0
.long 0xbf803f80,0xbf803f80,0x0,0x0,0x0,0x0,0x0,0x0
.long 0x3f793f73,0x3f7f3f7d,0x0,0x0,0x3e6f3e9e,0x3da13e20,0x0,0x0
.long 0x3f643f4f,0x3f7d3f73,0x0,0x0,0x3ee83f16,0x3e203e9e,0x0,0x0
.long 0x3f433f16,0x3f793f64,0x0,0x0,0x3f263f4f,0x3e6f3ee8,0x0,0x0
.long 0x3f163e9e,0x3f733f4f,0x0,0x0,0x3f4f3f73,0x3e9e3f16,0x0,0x0
.long 0x3ec42631,0x3f6d3f35,0x0,0x0,0x3f6d3f80,0x3ec43f35,0x0,0x0
.long 0x3e20be9e,0x3f643f16,0x0,0x0,0x3f7d3f73,0x3ee83f4f,0x0,0x0
.long 0xbda1bf16,0x3f5a3ee8,0x0,0x0,0x3f7f3f4f,0x3f063f64,0x0,0x0
.long 0x3f4f3f80,0xbe9e3e9e,0xbe9ebf4f,0x3f4f3e9e,0xbf168000,0xbf73bf73,0x3f733f16,0x3f163f73
.long 0x3f433f80,0xbf063e20,0x3f5a3e9e,0x3f263f7d,0xbf268000,0xbf5abf7d,0x3f063f73,0xbf43be20
.long 0x3f353f80,0xbf35248d,0x3f353f80,0xbf35261f,0xbf358000,0xbf35bf80,0xbf35260d,0xbf35bf80
.long 0x3f263f80,0xbf5abe20,0xbf063e9e,0xbf43bf7d,0xbf438000,0xbf06bf7d,0xbf5abf73,0x3f26be20
.long 0x3f163f80,0xbf73be9e,0xbf73bf4f,0x3f16be9e,0xbf4f8000,0xbe9ebf73,0x3e9ebf16,0x3f4f3f73
.long 0x3f063f80,0xbf7fbee8,0x3da1bf4f,0x3f5a3f64,0xbf5a8000,0xbda1bf64,0x3f7f3f16,0xbf063ee8
.long 0x3ee83f80,0xbf7dbf16,0x3f7d3e9e,0xbee83f16,0xbf648000,0x3e20bf4f,0x3e203f73,0xbf64bf4f
.long 0x3ec43f80,0xbf6dbf35,0x3ec43f80,0xbf6dbf35,0xbf6d8000,0x3ec4bf35,0xbf6d2654,0x3ec4bf35
.long 0xbf80bf4f,0xbe9ebf4f,0x3f4f3f80,0xbe9e3e9e,0xa50dbf16,0x3f733f16,0xbf16260d,0xbf73bf73
.long 0xbf6dbf73,0x3e6fbee8,0xbf26261f,0xbf5abf7d,0x3ec4be9e,0x3f793f64,0xbf43bf80,0x3f06be20
.long 0xbf35bf80,0x3f35a554,0xbf35bf80,0x3f35269f,0x3f35a50d,0x3f353f80,0x3f35a630,0x3f353f80
.long 0xbec4bf73,0x3f793ee8,0x3f43a731,0x3f063f7d,0x3f6d3e9e,0x3e6f3f64,0x3f263f80,0xbf5abe20
.long 0xa554bf4f,0x3f733f4f,0x3f163f80,0xbf73be9e,0x3f803f16,0xbe9e3f16,0xbf4f2654,0xbe9ebf73
.long 0x3ec4bf16,0x3f263f7d,0xbf5aa68d,0xbda1bf64,0x3f6d3f4f,0xbf433e20,0xbf06bf80,0x3f7f3ee8
.long 0x3f35be9e,0x3e203f73,0xbee8bf80,0x3f7d3f16,0x3f353f73,0xbf7dbe9e,0x3f64a677,0xbe203f4f
.long 0x3f6da554,0xbec43f35,0x3f6da742,0xbec43f35,0x3ec43f80,0xbf6dbf35,0x3ec43f80,0xbf6dbf35
.long 0x3f4f3e9e,0x3f4f3f80,0xbf80bf4f,0xbe9ebf4f,0x3f163f73,0xbf16258d,0xa630bf16,0x3f733f16
.long 0x3f7f3f4f,0x3da13f35,0x3ec4be9e,0x3f793f64,0xbda13f16,0xbf7fbf35,0x3f6d3f73,0xbe6f3ee8
.long 0x3f353f80,0xbf3525b0,0x3f353f80,0xbf352739,0xbf35258d,0xbf35bf80,0xbf352654,0xbf35bf80
.long 0x3da13f4f,0xbf7fbf35,0xbf6dbe9e,0xbe6fbf64,0xbf7fbf16,0x3da1bf35,0xbec4bf73,0x3f793ee8
.long 0xbf163e9e,0xbf16bf80,0xa742bf4f,0x3f733f4f,0xbf4fbf73,0x3f4fa5d4,0x3f803f16,0xbe9e3f16
.long 0xbf79be9e,0x3e6fbf35,0x3f6d3f4f,0xbf433e20,0xbe6fbf73,0x3f793f35,0xbec43f16,0xbf26bf7d
.long 0xbf64bf4f,0x3f64a5f7,0xbf353e9e,0xbe20bf73,0x3ee8bf16,0x3ee83f80,0xbf35bf73,0x3f7d3e9e
.long 0xbec4bf80,0x3f6d3f35,0xbec4bf80,0x3f6d3f35,0x3f6da5d4,0xbec43f35,0x3f6da7a8,0xbec43f35
.long 0xbe9e3e9e,0xbf80bf4f,0x3f4f3e9e,0x3f4f3f80,0xbf73bf73,0xa5d4bf16,0x3f163f73,0xbf162654
.long 0xbf79bf16,0xbec4bf64,0xbda13f16,0xbf7fbf35,0xbe6fbf4f,0x3f6d3ee8,0xbf7fbf4f,0xbda1bf35
.long 0xbf35bf80,0x3f35a5f7,0xbf35bf80,0x3f35a742,0x3f35a5d4,0x3f353f80,0x3f35a677,0x3f353f80
.long 0x3e6fbf16,0x3f6d3f64,0x3f7f3f16,0xbda13f35,0x3f793f4f,0xbec43ee8,0x3da13f4f,0xbf7fbf35
.long 0x3f733e9e,0x261f3f4f,0xbf163e9e,0xbf16bf80,0x3e9e3f73,0xbf80bf16,0xbf4fbf73,0x3f4fa69f
.long 0x3f433f73,0xbf6dbe20,0xbe6fbf73,0x3f793f35,0xbf263e9e,0xbec4bf7d,0x3f793e9e,0xbe6f3f35
.long 0xbe203f4f,0xbf35bf73,0x3f643f4f,0xbf64a60d,0xbf7dbf16,0x3f35be9e,0xbee83f16,0xbee8bf80
.long 0xbf6d2728,0x3ec4bf35,0xbf6d27ee,0x3ec4bf35,0xbec4bf80,0x3f6d3f35,0xbec4bf80,0x3f6d3f35
.long 0xbe9e3e9e,0xbf80bf4f,0x3f4f3e9e,0x3f4f3f80,0xbf73bf73,0xa677bf16,0x3f163f73,0xbf1626b0
.long 0xbe6fbf4f,0x3f6d3ee8,0xbf7fbf4f,0xbda1bf35,0x3f793f16,0x3ec43f64,0x3da1bf16,0x3f7f3f35
.long 0x3f353f80,0xbf35a654,0x3f353f80,0xbf3527f7,0xbf35268d,0xbf35bf80,0xbf3526d4,0xbf35bf80
.long 0xbf79bf4f,0x3ec4bee8,0xbda1bf4f,0x3f7f3f35,0x3e6fbf16,0x3f6d3f64,0x3f7f3f16,0xbda13f35
.long 0x3f733e9e,0xa60d3f4f,0xbf163e9e,0xbf16bf80,0x3e9e3f73,0xbf80bf16,0xbf4fbf73,0x3f4fa7c2
.long 0xbf263e9e,0xbec4bf7d,0x3f793e9e,0xbe6f3f35,0xbf43bf73,0x3f6d3e20,0x3e6f3f73,0xbf79bf35
.long 0x3e20bf4f,0x3f353f73,0xbf64bf4f,0x3f64a78d,0x3f7d3f16,0xbf353e9e,0x3ee8bf16,0x3ee83f80
.long 0x3ec43f80,0xbf6dbf35,0x3ec43f80,0xbf6dbf35,0xbf6d26d4,0x3ec4bf35,0xbf6d2828,0x3ec4bf35
.long 0xbe9ebf4f,0x3f4f3e9e,0xbe9e3e9e,0xbf80bf4f,0x3f733f16,0x3f163f73,0xbf73bf73,0x271fbf16
.long 0x3f063f73,0xbf43be20,0x3f793f16,0x3ec43f64,0xbf5abe9e,0xbf26bf7d,0x3e6f3f4f,0xbf6dbee8
.long 0xbf35bf80,0x3f352631,0xbf35bf80,0x3f35a777,0x3f35a69f,0x3f353f80,0x3f35a7b9,0x3f353f80
.long 0x3f5a3f73,0xbf263e20,0xbe6f3f16,0xbf6dbf64,0xbf063e9e,0xbf43bf7d,0xbf79bf4f,0x3ec4bee8
.long 0xbf73bf4f,0x3f16be9e,0x3f733e9e,0x28043f4f,0x3e9ebf16,0x3f4f3f73,0x3e9e3f73,0xbf80bf16
.long 0x3f7f3f16,0xbf063ee8,0xbf43bf73,0x3f6d3e20,0xbda13f4f,0xbf5abf64,0x3f26be9e,0x3ec43f7d
.long 0xbf7dbe9e,0x3ee8bf16,0xbe203f4f,0xbf35bf73,0xbe20bf73,0x3f643f4f,0xbf7dbf16,0x3f35be9e
.long 0x3f6da777,0xbec43f35,0x3f6da796,0xbec43f35,0x3ec43f80,0xbf6dbf35,0x3ec43f80,0xbf6dbf35
.long 0x3f4f3f80,0xbe9e3e9e,0xbe9ebf4f,0x3f4f3e9e,0xbf16268d,0xbf73bf73,0x3f733f16,0x3f163f73
.long 0xbf43bf80,0x3f06be20,0xbf5abe9e,0xbf26bf7d,0x3f26a69f,0x3f5a3f7d,0xbf06bf73,0x3f433e20
.long 0x3f353f80,0xbf35a60d,0x3f353f80,0xbf35a137,0xbf3526b0,0xbf35bf80,0xbf3526f7,0xbf35bf80
.long 0xbf26bf80,0x3f5a3e20,0x3f06be9e,0x3f433f7d,0x3f43a7b1,0x3f063f7d,0x3f5a3f73,0xbf263e20
.long 0x3f163f80,0xbf73be9e,0xbf73bf4f,0x3f16be9e,0xbf4f26d4,0xbe9ebf73,0x3e9ebf16,0x3f4f3f73
.long 0xbf06bf80,0x3f7f3ee8,0xbda13f4f,0xbf5abf64,0x3f5a270d,0x3da13f64,0xbf7fbf16,0x3f06bee8
.long 0x3ee83f80,0xbf7dbf16,0x3f7d3e9e,0xbee83f16,0xbf6426f7,0x3e20bf4f,0x3e203f73,0xbf64bf4f
.long 0xbec4bf80,0x3f6d3f35,0xbec4bf80,0x3f6d3f35,0x3f6da7c2,0xbec43f35,0x3f6da86e,0xbec43f35
.long 0xbf80bf4f,0xbe9ebf4f,0x3f4f3f80,0xbe9e3e9e,0xa69fbf16,0x3f733f16,0xbf1626d4,0xbf73bf73
.long 0x3f6d3f73,0xbe6f3ee8,0x3f26a777,0x3f5a3f7d,0xbec43e9e,0xbf79bf64,0x3f433f80,0xbf063e20
.long 0xbf35bf80,0x3f35278d,0xbf35bf80,0x3f35a784,0x3f35271f,0x3f353f80,0x3f35a7c2,0x3f353f80
.long 0x3ec43f73,0xbf79bee8,0xbf432804,0xbf06bf7d,0xbf6dbe9e,0xbe6fbf64,0xbf26bf80,0x3f5a3e20
.long 0xa777bf4f,0x3f733f4f,0x3f163f80,0xbf73be9e,0x3f803f16,0xbe9e3f16,0xbf4f271f,0xbe9ebf73
.long 0xbec43f16,0xbf26bf7d,0x3f5a2754,0x3da13f64,0xbf6dbf4f,0x3f43be20,0x3f063f80,0xbf7fbee8
.long 0x3f35be9e,0x3e203f73,0xbee8bf80,0x3f7d3f16,0x3f353f73,0xbf7dbe9e,0x3f64268d,0xbe203f4f
.long 0xbf6d2804,0x3ec4bf35,0xbf6d268d,0x3ec4bf35,0xbec4bf80,0x3f6d3f35,0xbec4bf80,0x3f6d3f35
.long 0xbf80bf4f,0xbe9ebf4f,0x0,0x0,0xa7b9bf16,0x3f733f16,0x0,0x0
.long 0xbec43e9e,0xbf79bf64,0x0,0x0,0xbf6dbf73,0x3e6fbee8,0x0,0x0
.long 0x3f353f80,0xbf352804,0x0,0x0,0xbf35270d,0xbf35bf80,0x0,0x0
.long 0x3f6d3e9e,0x3e6f3f64,0x0,0x0,0x3ec43f73,0xbf79bee8,0x0,0x0
.long 0xa796bf4f,0x3f733f4f,0x0,0x0,0x3f803f16,0xbe9e3f16,0x0,0x0
.long 0xbf6dbf4f,0x3f43be20,0x0,0x0,0x3ec4bf16,0x3f263f7d,0x0,0x0
.long 0xbf353e9e,0xbe20bf73,0x0,0x0,0xbf35bf73,0x3f7d3e9e,0x0,0x0
.long 0x3ec43f80,0xbf6dbf35,0x0,0x0,0xbf6d2754,0x3ec4bf35,0x0,0x0
.long 0x3f4f3e9e,0x3f4f3f80,0x0,0x0,0x3f163f73,0xbf1626f7,0x0,0x0
.long 0x3da1bf16,0x3f7f3f35,0x0,0x0,0x3f7f3f4f,0x3da13f35,0x0,0x0
.long 0xbf35bf80,0x3f35a78d,0x0,0x0,0x3f3526d4,0x3f353f80,0x0,0x0
.long 0xbf7fbf16,0x3da1bf35,0x0,0x0,0xbda1bf4f,0x3f7f3f35,0x0,0x0
.long 0xbf163e9e,0xbf16bf80,0x0,0x0,0xbf4fbf73,0x3f4f268d,0x0,0x0
.long 0x3e6f3f73,0xbf79bf35,0x0,0x0,0xbf79be9e,0x3e6fbf35,0x0,0x0
.long 0x3f643f4f,0xbf642816,0x0,0x0,0xbee83f16,0xbee8bf80,0x0,0x0
.long 0x3f6da8ac,0xbec43f35,0x0,0x0,0x3ec43f80,0xbf6dbf35,0x0,0x0
.long 0xbe9e3e9e,0xbf80bf4f,0x0,0x0,0xbf73bf73,0xa7c2bf16,0x0,0x0
.long 0x3e6f3f4f,0xbf6dbee8,0x0,0x0,0xbf79bf16,0xbec4bf64,0x0,0x0
.long 0x3f353f80,0xbf352809,0x0,0x0,0xbf35271f,0xbf35bf80,0x0,0x0
.long 0x3f793f4f,0xbec43ee8,0x0,0x0,0xbe6f3f16,0xbf6dbf64,0x0,0x0
.long 0x3f733e9e,0x268d3f4f,0x0,0x0,0x3e9e3f73,0xbf80bf16,0x0,0x0
.long 0x3f26be9e,0x3ec43f7d,0x0,0x0,0x3f433f73,0xbf6dbe20,0x0,0x0
.long 0x3e20bf4f,0x3f353f73,0x0,0x0,0x3f7d3f16,0xbf353e9e,0x0,0x0
.long 0xbec4bf80,0x3f6d3f35,0x0,0x0,0x3f6da7f7,0xbec43f35,0x0,0x0
.long 0xbe9ebf4f,0x3f4f3e9e,0x0,0x0,0x3f733f16,0x3f163f73,0x0,0x0
.long 0xbf06bf73,0x3f433e20,0x0,0x0,0x3f5a3e9e,0x3f263f7d,0x0,0x0
.long 0xbf35bf80,0x3f35a796,0x0,0x0,0x3f3526b1,0x3f353f80,0x0,0x0
.long 0xbf5abf73,0x3f26be20,0x0,0x0,0x3f06be9e,0x3f433f7d,0x0,0x0
.long 0xbf73bf4f,0x3f16be9e,0x0,0x0,0x3e9ebf16,0x3f4f3f73,0x0,0x0
.long 0xbf7fbf16,0x3f06bee8,0x0,0x0,0x3da1bf4f,0x3f5a3f64,0x0,0x0
.long 0xbf7dbe9e,0x3ee8bf16,0x0,0x0,0xbe20bf73,0x3f643f4f,0x0,0x0
.long 0xbf6d281f,0x3ec4bf35,0x0,0x0,0xbec4bf80,0x3f6d3f35,0x0,0x0
.long 0x3e9e3f80,0xbf4fbf4f,0xbf4f3e9e,0x3e9ebf4f,0xbf738000,0x3f16bf16,0xbf16bf73,0x3f733f16
.long 0x3e6f3f80,0xbf26bf64,0xbf43bf4f,0x3f793ee8,0xbf798000,0x3f43bee8,0x3f26bf16,0xbe6f3f64
.long 0x3e203f80,0xbee8bf73,0x3ee8bf4f,0xbe203f73,0xbf7d8000,0x3f64be9e,0x3f643f16,0xbf7dbe9e
.long 0x3da13f80,0xbe6fbf7d,0x3f793e9e,0xbf7fbe20,0xbf7f8000,0x3f79be20,0xbe6f3f73,0x3da1bf7d
.long 0x248d3f80,0xa554bf80,0xa6543f80,0x2631bf80,0xbf808000,0x3f80a50d,0xbf80268d,0x3f80a69f
.long 0xbda13f80,0x3e6fbf7d,0xbf793e9e,0x3f7fbe20,0xbf7f8000,0x3f793e20,0xbe6fbf73,0x3da13f7d
.long 0xbe203f80,0x3ee8bf73,0xbee8bf4f,0x3e203f73,0xbf7d8000,0x3f643e9e,0x3f64bf16,0xbf7d3e9e
.long 0xbe6f3f80,0x3f26bf64,0x3f43bf4f,0xbf793ee8,0xbf798000,0x3f433ee8,0x3f263f16,0xbe6fbf64
.long 0x3f803e9e,0xbf4f3e9e,0x3e9e3f80,0xbf4fbf4f,0x258d3f73,0xbf16bf73,0xbf73268d,0x3f16bf16
.long 0x3f6d3f16,0xbf7fbe20,0xbf79a654,0x3f43bee8,0xbec43f4f,0xbda1bf7d,0xbe6fbf80,0x3f263f64
.long 0x3f353f4f,0xbf64bf16,0xbe20bf80,0x3ee83f73,0xbf353f16,0x3ee8bf4f,0x3f7da69f,0xbf643e9e
.long 0x3ec43f73,0xbf06bf64,0x3f7f2631,0xbf793e20,0xbf6d3e9e,0x3f5abee8,0x3da13f80,0xbe6fbf7d
.long 0x25b03f80,0xa5f7bf80,0xa60d3f80,0x278dbf80,0xbf80258d,0x3f80a5d4,0xbf8026b0,0x3f80271f
.long 0xbec43f73,0x3f06bf64,0xbf7fa60d,0x3f793e20,0xbf6dbe9e,0x3f5a3ee8,0x3da1bf80,0xbe6f3f7d
.long 0xbf353f4f,0x3f64bf16,0x3e20bf80,0xbee83f73,0xbf35bf16,0x3ee83f4f,0x3f7da7b1,0xbf64be9e
.long 0xbf6d3f16,0x3f7fbe20,0x3f79a765,0xbf43bee8,0xbec4bf4f,0xbda13f7d,0xbe6f3f80,0x3f26bf64
.long 0x3e9ebf4f,0x3e9e3f80,0x3f803e9e,0xbf4f3e9e,0x3f733f16,0xbf73260d,0x26b03f73,0xbf16bf73
.long 0x3f5abe9e,0xbf063f35,0xbec43f4f,0xbda1bf7d,0x3f063f73,0xbf5abf35,0xbf6dbf16,0x3f7f3e20
.long 0x3f7d3e9e,0xbf7d261f,0xbf35bf4f,0x3f643f16,0xbe203f73,0xbe20bf80,0x3f35bf16,0xbee83f4f
.long 0x3f263f4f,0xbf43bf35,0x3f6dbe9e,0xbf5a3ee8,0xbf433f16,0x3f26bf35,0x3ec43f73,0xbf06bf64
.long 0x261f3f80,0x269fbf80,0x27f73f80,0xa777bf80,0xbf80260d,0x3f80a630,0xbf8026d4,0x3f80a7b9
.long 0xbf263f4f,0x3f43bf35,0xbf6dbe9e,0x3f5a3ee8,0xbf43bf16,0x3f263f35,0x3ec4bf73,0xbf063f64
.long 0xbf7d3e9e,0x3f7da731,0x3f35bf4f,0xbf643f16,0xbe20bf73,0xbe203f80,0x3f353f16,0xbee8bf4f
.long 0xbf5abe9e,0x3f063f35,0x3ec43f4f,0x3da1bf7d,0x3f06bf73,0xbf5a3f35,0xbf6d3f16,0x3f7fbe20
.long 0xbf4fbf4f,0x3f803e9e,0x3e9ebf4f,0x3e9e3f80,0x3f16bf16,0x26543f73,0x3f733f16,0xbf7326d4
.long 0x3da1bf73,0x3ec43f7d,0x3f063f73,0xbf5abf35,0x3f7f3e9e,0xbf6d3e20,0xbf5a3e9e,0x3f06bf35
.long 0x3f64be9e,0xbf353f16,0xbf7dbe9e,0x3f7da777,0x3ee83f73,0xbf35bf4f,0x3e20bf73,0x3e203f80
.long 0x3f5a3f16,0xbf6dbee8,0x3f43bf16,0xbf263f35,0xbf063f4f,0x3ec4bf64,0x3f263f4f,0xbf43bf35
.long 0x27393f80,0xa742bf80,0xa1373f80,0xa784bf80,0xbf802654,0x3f80a677,0xbf8026f7,0x3f80a7c2
.long 0xbf5a3f16,0x3f6dbee8,0xbf43bf16,0x3f263f35,0xbf06bf4f,0x3ec43f64,0x3f26bf4f,0xbf433f35
.long 0xbf64be9e,0x3f353f16,0x3f7dbe9e,0xbf7d2804,0x3ee8bf73,0xbf353f4f,0x3e203f73,0x3e20bf80
.long 0xbda1bf73,0xbec43f7d,0xbf063f73,0x3f5abf35,0x3f7fbe9e,0xbf6dbe20,0xbf5abe9e,0x3f063f35
.long 0xbf4fbf4f,0x3f803e9e,0x3e9ebf4f,0x3e9e3f80,0x3f16bf16,0x26f73f73,0x3f733f16,0xbf732730
.long 0x3f7f3e9e,0xbf6d3e20,0xbf5a3e9e,0x3f06bf35,0xbda13f73,0xbec4bf7d,0xbf06bf73,0x3f5a3f35
.long 0xbf643e9e,0x3f35bf16,0x3f7d3e9e,0xbf7d268d,0xbee8bf73,0x3f353f4f,0xbe203f73,0xbe20bf80
.long 0x3f06bf4f,0xbec43f64,0xbf26bf4f,0x3f433f35,0x3f5a3f16,0xbf6dbee8,0x3f43bf16,0xbf263f35
.long 0x28043f80,0xa78dbf80,0x28163f80,0xa7b1bf80,0xbf80270d,0x3f8026d4,0xbf802754,0x3f80a877
.long 0xbf06bf4f,0x3ec43f64,0x3f26bf4f,0xbf433f35,0x3f5abf16,0xbf6d3ee8,0x3f433f16,0xbf26bf35
.long 0x3f643e9e,0xbf35bf16,0xbf7d3e9e,0x3f7da85d,0xbee83f73,0x3f35bf4f,0xbe20bf73,0xbe203f80
.long 0xbf7f3e9e,0x3f6d3e20,0x3f5a3e9e,0xbf06bf35,0xbda1bf73,0xbec43f7d,0xbf063f73,0x3f5abf35
.long 0xbf4f3e9e,0x3e9ebf4f,0xbf4fbf4f,0x3f803e9e,0xbf16bf73,0x3f733f16,0x3f16bf16,0xa79f3f73
.long 0x3f26bf16,0xbe6f3f64,0xbda13f73,0xbec4bf7d,0x3f433f4f,0xbf79bee8,0xbf7fbe9e,0x3f6dbe20
.long 0xbee83f4f,0x3e20bf73,0x3f64be9e,0xbf353f16,0xbf64bf16,0x3f7d3e9e,0x3ee83f73,0xbf35bf4f
.long 0x3e6fbf73,0xbda13f7d,0xbf5abf16,0x3f6d3ee8,0x3f793e9e,0xbf7fbe20,0x3f06bf4f,0xbec43f64
.long 0x28093f80,0xa796bf80,0x26d43f80,0x270dbf80,0xbf80271f,0x3f8026b1,0xbf802839,0x3f80a7f7
.long 0xbe6fbf73,0x3da13f7d,0x3f5abf16,0xbf6d3ee8,0x3f79be9e,0xbf7f3e20,0x3f063f4f,0xbec4bf64
.long 0x3ee83f4f,0xbe20bf73,0xbf64be9e,0x3f353f16,0xbf643f16,0x3f7dbe9e,0x3ee8bf73,0xbf353f4f
.long 0xbf26bf16,0x3e6f3f64,0x3da13f73,0x3ec4bf7d,0x3f43bf4f,0xbf793ee8,0xbf7f3e9e,0x3f6d3e20
.long 0x3e9e3f80,0xbf4fbf4f,0xbf4f3e9e,0x3e9ebf4f,0xbf73270d,0x3f16bf16,0xbf16bf73,0x3f733f16
.long 0xbe6fbf80,0x3f263f64,0x3f433f4f,0xbf79bee8,0x3f7926d4,0xbf433ee8,0xbf263f16,0x3e6fbf64
.long 0x3e203f80,0xbee8bf73,0x3ee8bf4f,0xbe203f73,0xbf7d271f,0x3f64be9e,0x3f643f16,0xbf7dbe9e
.long 0xbda1bf80,0x3e6f3f7d,0xbf79be9e,0x3f7f3e20,0x3f7f26b1,0xbf793e20,0x3e6fbf73,0xbda13f7d
.long 0x280d3f80,0xa79fbf80,0xa7c23f80,0xa7c2bf80,0xbf802730,0x3f80268d,0xbf802777,0x3f8021b7
.long 0x3da1bf80,0xbe6f3f7d,0x3f79be9e,0xbf7f3e20,0x3f7f268d,0xbf79be20,0x3e6f3f73,0xbda1bf7d
.long 0xbe203f80,0x3ee8bf73,0xbee8bf4f,0x3e203f73,0xbf7d2831,0x3f643e9e,0x3f64bf16,0xbf7d3e9e
.long 0x3e6fbf80,0xbf263f64,0xbf433f4f,0x3f79bee8,0x3f79a7e5,0xbf43bee8,0xbf26bf16,0x3e6f3f64
.long 0x3f803e9e,0xbf4f3e9e,0x3e9e3f80,0xbf4fbf4f,0x271f3f73,0xbf16bf73,0xbf732754,0x3f16bf16
.long 0xbf6dbf16,0x3f7f3e20,0x3f79a7b1,0xbf433ee8,0x3ec4bf4f,0x3da13f7d,0x3e6f3f80,0xbf26bf64
.long 0x3f353f4f,0xbf64bf16,0xbe20bf80,0x3ee83f73,0xbf353f16,0x3ee8bf4f,0x3f7da7f7,0xbf643e9e
.long 0xbec4bf73,0x3f063f64,0xbf7f281f,0x3f79be20,0x3f6dbe9e,0xbf5a3ee8,0xbda1bf80,0x3e6f3f7d
.long 0x268d3f80,0x2731bf80,0x270d3f80,0x26d4bf80,0xbf80a79f,0x3f80280d,0xbf802842,0x3f80a804
.long 0x3ec4bf73,0xbf063f64,0x3f7f26d4,0xbf79be20,0x3f6d3e9e,0xbf5abee8,0xbda13f80,0x3e6fbf7d
.long 0xbf353f4f,0x3f64bf16,0x3e20bf80,0xbee83f73,0xbf35bf16,0x3ee83f4f,0x3f7da884,0xbf64be9e
.long 0x3f6dbf16,0xbf7f3e20,0xbf792896,0x3f433ee8,0x3ec43f4f,0x3da1bf7d,0x3e6fbf80,0xbf263f64
.long 0x3f803e9e,0xbf4f3e9e,0x0,0x0,0x28393f73,0xbf16bf73,0x0,0x0
.long 0x3ec4bf4f,0x3da13f7d,0x0,0x0,0x3f6d3f16,0xbf7fbe20,0x0,0x0
.long 0xbf35bf4f,0x3f643f16,0x0,0x0,0x3f35bf16,0xbee83f4f,0x0,0x0
.long 0xbf6d3e9e,0x3f5abee8,0x0,0x0,0xbec4bf73,0x3f063f64,0x0,0x0
.long 0x28283f80,0xa7d4bf80,0x0,0x0,0xbf80278d,0x3f80a884,0x0,0x0
.long 0x3f6d3e9e,0xbf5abee8,0x0,0x0,0xbec43f73,0x3f06bf64,0x0,0x0
.long 0x3f35bf4f,0xbf643f16,0x0,0x0,0x3f353f16,0xbee8bf4f,0x0,0x0
.long 0xbec4bf4f,0xbda13f7d,0x0,0x0,0x3f6dbf16,0xbf7f3e20,0x0,0x0
.long 0x3e9ebf4f,0x3e9e3f80,0x0,0x0,0x3f733f16,0xbf732777,0x0,0x0
.long 0xbf06bf73,0x3f5a3f35,0x0,0x0,0x3f5abe9e,0xbf063f35,0x0,0x0
.long 0xbf7dbe9e,0x3f7d26d4,0x0,0x0,0x3e20bf73,0x3e203f80,0x0,0x0
.long 0xbf433f16,0x3f26bf35,0x0,0x0,0xbf26bf4f,0x3f433f35,0x0,0x0
.long 0x27303f80,0xa86ebf80,0x0,0x0,0xbf80a754,0x3f80a80d,0x0,0x0
.long 0x3f433f16,0xbf26bf35,0x0,0x0,0xbf263f4f,0x3f43bf35,0x0,0x0
.long 0x3f7dbe9e,0xbf7d289a,0x0,0x0,0x3e203f73,0x3e20bf80,0x0,0x0
.long 0x3f06bf73,0xbf5a3f35,0x0,0x0,0x3f5a3e9e,0xbf06bf35,0x0,0x0
.long 0xbf4fbf4f,0x3f803e9e,0x0,0x0,0x3f16bf16,0x28423f73,0x0,0x0
.long 0xbf7fbe9e,0x3f6dbe20,0x0,0x0,0x3da1bf73,0x3ec43f7d,0x0,0x0
.long 0xbf643e9e,0x3f35bf16,0x0,0x0,0xbee8bf73,0x3f353f4f,0x0,0x0
.long 0xbf063f4f,0x3ec4bf64,0x0,0x0,0xbf5abf16,0x3f6d3ee8,0x0,0x0
.long 0xa79f3f80,0xa7e5bf80,0x0,0x0,0xbf80279f,0x3f80a889,0x0,0x0
.long 0x3f063f4f,0xbec4bf64,0x0,0x0,0xbf5a3f16,0x3f6dbee8,0x0,0x0
.long 0x3f643e9e,0xbf35bf16,0x0,0x0,0xbee83f73,0x3f35bf4f,0x0,0x0
.long 0x3f7fbe9e,0xbf6dbe20,0x0,0x0,0x3da13f73,0x3ec4bf7d,0x0,0x0
.long 0xbf4f3e9e,0x3e9ebf4f,0x0,0x0,0xbf16bf73,0x3f733f16,0x0,0x0
.long 0xbf263f16,0x3e6fbf64,0x0,0x0,0xbf43bf4f,0x3f793ee8,0x0,0x0
.long 0xbee83f4f,0x3e20bf73,0x0,0x0,0xbf64bf16,0x3f7d3e9e,0x0,0x0
.long 0xbe6f3f73,0x3da1bf7d,0x0,0x0,0xbf79be9e,0x3f7f3e20,0x0,0x0
.long 0xa84b3f80,0x260ebf80,0x0,0x0,0xbf80a731,0x3f80a816,0x0,0x0
.long 0x3e6f3f73,0xbda1bf7d,0x0,0x0,0xbf793e9e,0x3f7fbe20,0x0,0x0
.long 0x3ee83f4f,0xbe20bf73,0x0,0x0,0xbf643f16,0x3f7dbe9e,0x0,0x0
.long 0x3f263f16,0xbe6fbf64,0x0,0x0,0xbf433f4f,0x3f79bee8,0x0,0x0
.long 0xbe9e3f80,0x3f4fbf4f,0x3f4f3e9e,0xbe9ebf4f,0xbf738000,0x3f163f16,0xbf163f73,0x3f73bf16
.long 0xbec43f80,0x3f6dbf35,0xbec43f80,0x3f6dbf35,0xbf6d8000,0x3ec43f35,0xbf6d26b0,0x3ec43f35
.long 0xbee83f80,0x3f7dbf16,0xbf7d3e9e,0x3ee83f16,0xbf648000,0x3e203f4f,0x3e20bf73,0xbf643f4f
.long 0xbf063f80,0x3f7fbee8,0xbda1bf4f,0xbf5a3f64,0xbf5a8000,0xbda13f64,0x3f7fbf16,0xbf06bee8
.long 0xbf163f80,0x3f73be9e,0x3f73bf4f,0xbf16be9e,0xbf4f8000,0xbe9e3f73,0x3e9e3f16,0x3f4fbf73
.long 0xbf263f80,0x3f5abe20,0x3f063e9e,0x3f43bf7d,0xbf438000,0xbf063f7d,0xbf5a3f73,0x3f263e20
.long 0xbf353f80,0x3f35a554,0xbf353f80,0x3f35a777,0xbf358000,0xbf353f80,0xbf3526d4,0xbf353f80
.long 0xbf433f80,0x3f063e20,0xbf5a3e9e,0xbf263f7d,0xbf268000,0xbf5a3f7d,0x3f06bf73,0xbf433e20
.long 0xbf803e9e,0x3f4f3e9e,0xbe9e3f80,0x3f4fbf4f,0xa5d4bf73,0xbf163f73,0xbf7326d4,0x3f163f16
.long 0xbf6d25b0,0x3ec43f35,0xbf6da58e,0x3ec43f35,0x3ec4bf80,0xbf6d3f35,0x3ec4bf80,0xbf6d3f35
.long 0xbf35be9e,0xbe203f73,0x3ee8bf80,0xbf7d3f16,0x3f35bf73,0xbf7d3e9e,0x3f64270d,0xbe20bf4f
.long 0xbec4bf16,0xbf263f7d,0x3f5aa777,0x3da1bf64,0x3f6dbf4f,0xbf43be20,0xbf063f80,0x3f7fbee8
.long 0xa5f7bf4f,0xbf733f4f,0xbf163f80,0x3f73be9e,0x3f80bf16,0xbe9ebf16,0xbf4f26f7,0xbe9e3f73
.long 0x3ec4bf73,0xbf793ee8,0xbf43a137,0xbf063f7d,0x3f6dbe9e,0x3e6fbf64,0x3f26bf80,0xbf5a3e20
.long 0x3f35bf80,0xbf352728,0x3f35bf80,0xbf352804,0x3f35a5d4,0x3f35bf80,0x3f35a7c2,0x3f35bf80
.long 0x3f6dbf73,0xbe6fbee8,0x3f26a784,0x3f5abf7d,0x3ec43e9e,0x3f79bf64,0xbf433f80,0x3f063e20
.long 0xbe9ebf4f,0xbe9e3f80,0xbf803e9e,0x3f4f3e9e,0x3f73bf16,0xbf732654,0xa7c2bf73,0xbf163f73
.long 0x3ec4bf80,0xbf6d3f35,0x3ec4bf80,0xbf6d3f35,0x3f6da630,0xbec4bf35,0x3f6da7c2,0xbec4bf35
.long 0x3f64bf4f,0xbf64a68d,0x3f353e9e,0x3e20bf73,0x3ee83f16,0x3ee8bf80,0xbf353f73,0x3f7dbe9e
.long 0x3f79be9e,0xbe6fbf35,0xbf6d3f4f,0x3f433e20,0xbe6f3f73,0x3f79bf35,0xbec4bf16,0xbf263f7d
.long 0x3f163e9e,0x3f16bf80,0xa78dbf4f,0xbf733f4f,0xbf4f3f73,0x3f4fa677,0x3f80bf16,0xbe9ebf16
.long 0xbda13f4f,0x3f7fbf35,0x3f6dbe9e,0x3e6fbf64,0xbf7f3f16,0x3da13f35,0xbec43f73,0x3f79bee8
.long 0xbf353f80,0x3f35a742,0xbf353f80,0x3f35a796,0xbf352654,0xbf353f80,0xbf352828,0xbf353f80
.long 0xbf7f3f4f,0xbda13f35,0xbec4be9e,0xbf793f64,0xbda1bf16,0xbf7f3f35,0x3f6dbf73,0xbe6fbee8
.long 0x3f4fbf4f,0xbf803e9e,0xbe9ebf4f,0xbe9e3f80,0x3f163f16,0xa69fbf73,0x3f73bf16,0xbf73271f
.long 0x3f6da742,0xbec4bf35,0x3f6d2766,0xbec4bf35,0xbec43f80,0x3f6dbf35,0xbec43f80,0x3f6dbf35
.long 0x3e203f4f,0x3f35bf73,0xbf643f4f,0x3f642754,0xbf7d3f16,0x3f353e9e,0xbee8bf16,0xbee83f80
.long 0xbf433f73,0x3f6dbe20,0x3e6fbf73,0xbf793f35,0xbf26be9e,0xbec43f7d,0x3f79be9e,0xbe6fbf35
.long 0xbf733e9e,0xa60d3f4f,0x3f163e9e,0x3f16bf80,0x3e9ebf73,0xbf803f16,0xbf4f3f73,0x3f4f268d
.long 0xbe6fbf16,0xbf6d3f64,0xbf7f3f16,0x3da13f35,0x3f79bf4f,0xbec4bee8,0x3da1bf4f,0xbf7f3f35
.long 0x3f35bf80,0xbf3527ee,0x3f35bf80,0xbf35268d,0x3f35a7a8,0x3f35bf80,0x3f35a86e,0x3f35bf80
.long 0x3f79bf16,0x3ec4bf64,0x3da13f16,0x3f7fbf35,0xbe6f3f4f,0x3f6dbee8,0xbf7f3f4f,0xbda13f35
.long 0x3f4fbf4f,0xbf803e9e,0xbe9ebf4f,0xbe9e3f80,0x3f163f16,0x268dbf73,0x3f73bf16,0xbf732842
.long 0xbec43f80,0x3f6dbf35,0xbec43f80,0x3f6dbf35,0xbf6d2730,0x3ec43f35,0xbf6d2842,0x3ec43f35
.long 0xbe20bf4f,0xbf353f73,0x3f64bf4f,0xbf64a7b1,0x3f7dbf16,0xbf35be9e,0x3ee83f16,0x3ee8bf80
.long 0x3f263e9e,0x3ec4bf7d,0xbf793e9e,0x3e6f3f35,0xbf433f73,0x3f6dbe20,0x3e6fbf73,0xbf793f35
.long 0xbf733e9e,0x28163f4f,0x3f163e9e,0x3f16bf80,0x3e9ebf73,0xbf803f16,0xbf4f3f73,0x3f4fa80d
.long 0x3f79bf4f,0xbec4bee8,0x3da1bf4f,0xbf7f3f35,0x3e6f3f16,0x3f6dbf64,0x3f7fbf16,0xbda1bf35
.long 0xbf353f80,0x3f35a8ac,0xbf353f80,0x3f35a7e5,0xbf352754,0xbf353f80,0xbf3528a8,0xbf353f80
.long 0x3e6fbf4f,0xbf6d3ee8,0x3f7fbf4f,0x3da1bf35,0x3f79bf16,0x3ec4bf64,0x3da13f16,0x3f7fbf35
.long 0x3f4f3e9e,0xbe9ebf4f,0x3f4fbf4f,0xbf803e9e,0xbf163f73,0x3f73bf16,0x3f163f16,0xa884bf73
.long 0xbf6d268d,0x3ec43f35,0xbf6da7b1,0x3ec43f35,0x3ec4bf80,0xbf6d3f35,0x3ec4bf80,0xbf6d3f35
.long 0x3f7dbe9e,0xbee8bf16,0x3e203f4f,0x3f35bf73,0xbe203f73,0x3f64bf4f,0xbf7d3f16,0x3f353e9e
.long 0xbf7f3f16,0x3f063ee8,0x3f43bf73,0xbf6d3e20,0xbda1bf4f,0xbf5a3f64,0x3f263e9e,0x3ec4bf7d
.long 0x3f73bf4f,0xbf16be9e,0xbf733e9e,0xa84b3f4f,0x3e9e3f16,0x3f4fbf73,0x3e9ebf73,0xbf803f16
.long 0xbf5a3f73,0x3f263e20,0x3e6f3f16,0x3f6dbf64,0xbf06be9e,0xbf433f7d,0xbf793f4f,0x3ec43ee8
.long 0x3f35bf80,0xbf35281f,0x3f35bf80,0xbf352839,0x3f35a7f7,0x3f35bf80,0x3f35a816,0x3f35bf80
.long 0xbf063f73,0x3f43be20,0xbf793f16,0xbec43f64,0xbf5a3e9e,0xbf263f7d,0x3e6fbf4f,0xbf6d3ee8
.long 0xbe9e3f80,0x3f4fbf4f,0x3f4f3e9e,0xbe9ebf4f,0xbf732754,0x3f163f16,0xbf163f73,0x3f73bf16
.long 0x3ec4bf80,0xbf6d3f35,0x3ec4bf80,0xbf6d3f35,0x3f6d260e,0xbec4bf35,0x3f6d27e6,0xbec4bf35
.long 0xbee83f80,0x3f7dbf16,0xbf7d3e9e,0x3ee83f16,0xbf64a78d,0x3e203f4f,0x3e20bf73,0xbf643f4f
.long 0x3f06bf80,0xbf7f3ee8,0x3da13f4f,0x3f5abf64,0x3f5aa7f7,0x3da1bf64,0xbf7f3f16,0x3f063ee8
.long 0xbf163f80,0x3f73be9e,0x3f73bf4f,0xbf16be9e,0xbf4f2777,0xbe9e3f73,0x3e9e3f16,0x3f4fbf73
.long 0x3f26bf80,0xbf5a3e20,0xbf06be9e,0xbf433f7d,0x3f4321b7,0x3f06bf7d,0x3f5abf73,0xbf26be20
.long 0xbf353f80,0x3f35a865,0xbf353f80,0x3f35a880,0xbf352842,0xbf353f80,0xbf3528ee,0xbf353f80
.long 0x3f43bf80,0xbf06be20,0x3f5abe9e,0x3f26bf7d,0x3f26a804,0x3f5abf7d,0xbf063f73,0x3f43be20
.long 0xbf803e9e,0x3f4f3e9e,0xbe9e3f80,0x3f4fbf4f,0xa7f7bf73,0xbf163f73,0xbf73279f,0x3f163f16
.long 0x3f6d270d,0xbec4bf35,0x3f6da7e5,0xbec4bf35,0xbec43f80,0x3f6dbf35,0xbec43f80,0x3f6dbf35
.long 0xbf35be9e,0xbe203f73,0x3ee8bf80,0xbf7d3f16,0x3f35bf73,0xbf7d3e9e,0x3f6427d4,0xbe20bf4f
.long 0x3ec43f16,0x3f26bf7d,0xbf5a2839,0xbda13f64,0xbf6d3f4f,0x3f433e20,0x3f06bf80,0xbf7f3ee8
.long 0x26d4bf4f,0xbf733f4f,0xbf163f80,0x3f73be9e,0x3f80bf16,0xbe9ebf16,0xbf4fa70d,0xbe9e3f73
.long 0xbec43f73,0x3f79bee8,0x3f43a880,0x3f06bf7d,0xbf6d3e9e,0xbe6f3f64,0xbf263f80,0x3f5abe20
.long 0x3f35bf80,0xbf352896,0x3f35bf80,0xbf3528a3,0x3f35a884,0x3f35bf80,0x3f35a70d,0x3f35bf80
.long 0xbf6d3f73,0x3e6f3ee8,0xbf2628a3,0xbf5a3f7d,0xbec4be9e,0xbf793f64,0x3f43bf80,0xbf06be20
.long 0xbf803e9e,0x3f4f3e9e,0x0,0x0,0xa816bf73,0xbf163f73,0x0,0x0
.long 0xbec43f80,0x3f6dbf35,0x0,0x0,0xbf6d27b0,0x3ec43f35,0x0,0x0
.long 0x3f353e9e,0x3e20bf73,0x0,0x0,0xbf353f73,0x3f7dbe9e,0x0,0x0
.long 0x3f6dbf4f,0xbf43be20,0x0,0x0,0x3ec43f16,0x3f26bf7d,0x0,0x0
.long 0xa804bf4f,0xbf733f4f,0x0,0x0,0x3f80bf16,0xbe9ebf16,0x0,0x0
.long 0xbf6d3e9e,0xbe6f3f64,0x0,0x0,0x3ec4bf73,0xbf793ee8,0x0,0x0
.long 0xbf353f80,0x3f35a8c7,0x0,0x0,0xbf3527d4,0xbf353f80,0x0,0x0
.long 0x3ec43e9e,0x3f79bf64,0x0,0x0,0xbf6d3f73,0x3e6f3ee8,0x0,0x0
.long 0xbe9ebf4f,0xbe9e3f80,0x0,0x0,0x3f73bf16,0xbf73a70d,0x0,0x0
.long 0xbf6d2777,0x3ec43f35,0x0,0x0,0x3ec4bf80,0xbf6d3f35,0x0,0x0
.long 0xbf643f4f,0x3f64a804,0x0,0x0,0xbee8bf16,0xbee83f80,0x0,0x0
.long 0xbe6f3f73,0x3f79bf35,0x0,0x0,0xbf793e9e,0x3e6f3f35,0x0,0x0
.long 0x3f163e9e,0x3f16bf80,0x0,0x0,0xbf4f3f73,0x3f4fa896,0x0,0x0
.long 0x3f7fbf16,0xbda1bf35,0x0,0x0,0xbda13f4f,0x3f7fbf35,0x0,0x0
.long 0x3f35bf80,0xbf35a731,0x0,0x0,0x3f35a92c,0x3f35bf80,0x0,0x0
.long 0xbda1bf16,0xbf7f3f35,0x0,0x0,0x3f7fbf4f,0x3da1bf35,0x0,0x0
.long 0x3f4fbf4f,0xbf803e9e,0x0,0x0,0x3f163f16,0xa70dbf73,0x0,0x0
.long 0x3ec4bf80,0xbf6d3f35,0x0,0x0,0x3f6da70d,0xbec4bf35,0x0,0x0
.long 0xbe20bf4f,0xbf353f73,0x0,0x0,0x3f7dbf16,0xbf35be9e,0x0,0x0
.long 0xbf26be9e,0xbec43f7d,0x0,0x0,0x3f43bf73,0xbf6d3e20,0x0,0x0
.long 0xbf733e9e,0xa7313f4f,0x0,0x0,0x3e9ebf73,0xbf803f16,0x0,0x0
.long 0xbf793f4f,0x3ec43ee8,0x0,0x0,0xbe6fbf16,0xbf6d3f64,0x0,0x0
.long 0xbf353f80,0x3f35a907,0x0,0x0,0xbf352877,0xbf353f80,0x0,0x0
.long 0xbe6f3f4f,0x3f6dbee8,0x0,0x0,0xbf793f16,0xbec43f64,0x0,0x0
.long 0x3f4f3e9e,0xbe9ebf4f,0x0,0x0,0xbf163f73,0x3f73bf16,0x0,0x0
.long 0x3f6da60d,0xbec4bf35,0x0,0x0,0xbec43f80,0x3f6dbf35,0x0,0x0
.long 0x3f7dbe9e,0xbee8bf16,0x0,0x0,0xbe203f73,0x3f64bf4f,0x0,0x0
.long 0x3f7fbf16,0xbf06bee8,0x0,0x0,0x3da13f4f,0x3f5abf64,0x0,0x0
.long 0x3f73bf4f,0xbf16be9e,0x0,0x0,0x3e9e3f16,0x3f4fbf73,0x0,0x0
.long 0x3f5abf73,0xbf26be20,0x0,0x0,0x3f063e9e,0x3f43bf7d,0x0,0x0
.long 0x3f35bf80,0xbf352918,0x0,0x0,0x3f35a89f,0x3f35bf80,0x0,0x0
.long 0x3f06bf73,0xbf433e20,0x0,0x0,0x3f5abe9e,0x3f26bf7d,0x0,0x0
.long 0xbf4f3f80,0x3e9e3e9e,0x3e9ebf4f,0xbf4f3e9e,0xbf168000,0xbf733f73,0x3f73bf16,0x3f16bf73
.long 0xbf5a3f80,0x3da13ee8,0x3f7fbf4f,0x3f06bf64,0xbf068000,0xbf7f3f64,0xbda13f16,0x3f5abee8
.long 0xbf643f80,0xbe203f16,0x3e203e9e,0x3f64bf16,0xbee88000,0xbf7d3f4f,0xbf7d3f73,0xbee83f4f
.long 0xbf6d3f80,0xbec43f35,0xbf6d3f80,0xbec43f35,0xbec48000,0xbf6d3f35,0xbec426f7,0xbf6d3f35
.long 0xbf733f80,0xbf163f4f,0xbf163e9e,0xbf733f4f,0xbe9e8000,0xbf4f3f16,0x3f4fbf73,0x3e9ebf16
.long 0xbf793f80,0xbf433f64,0x3f26bf4f,0x3e6fbee8,0xbe6f8000,0xbf263ee8,0x3f43bf16,0x3f79bf64
.long 0xbf7d3f80,0xbf643f73,0x3f64bf4f,0x3f7dbf73,0xbe208000,0xbee83e9e,0xbee83f16,0xbe203e9e
.long 0xbf7f3f80,0xbf793f7d,0xbe6f3e9e,0xbda13e20,0xbda18000,0xbe6f3e20,0xbf793f73,0xbf7f3f7d
.long 0x3f80bf4f,0x3e9ebf4f,0xbf4f3f80,0x3e9e3e9e,0x260d3f16,0x3f73bf16,0xbf16270d,0xbf733f73
.long 0x3f6dbf16,0x3f43bf7d,0xbf06a7f7,0xbf7f3f64,0xbec43f4f,0x3f26be20,0x3f5abf80,0xbda1bee8
.long 0x3f35be9e,0x3f7dbf73,0x3f64bf80,0x3e20bf16,0xbf353f73,0x3e203e9e,0x3ee826d4,0x3f7dbf4f
.long 0x3ec4a5f7,0x3f6dbf35,0x3ec4a78d,0x3f6dbf35,0xbf6d3f80,0xbec43f35,0xbf6d3f80,0xbec43f35
.long 0x261f3e9e,0x3f16be9e,0xbf733f80,0xbf163f4f,0xbf803f73,0xbf4f3f73,0xbe9e271f,0xbf4f3f16
.long 0xbec43f16,0x3da13e20,0xbe6f2809,0xbf263ee8,0xbf6d3f4f,0xbf7f3f7d,0x3f79bf80,0x3f43bf64
.long 0xbf353f4f,0xbee83f16,0x3f7dbf80,0x3f64bf73,0xbf353f16,0xbf643f4f,0x3e2026b1,0x3ee8be9e
.long 0xbf6d3f73,0xbf5a3f64,0x3da1a796,0x3e6fbe20,0xbec43e9e,0xbf063ee8,0xbf7f3f80,0xbf793f7d
.long 0xbf4f3e9e,0xbf4f3f80,0x3f80bf4f,0x3e9ebf4f,0x3f16bf73,0xbf16268d,0x27303f16,0x3f73bf16
.long 0xbe6fbe9e,0xbf793f35,0xbec43f4f,0x3f26be20,0x3f79bf73,0x3e6fbf35,0xbf6d3f16,0xbf433f7d
.long 0x3ee8bf4f,0xbee8a654,0xbf353e9e,0xbf7d3f73,0x3f64bf16,0x3f64bf80,0x3f35bf73,0xbe20be9e
.long 0x3f6dbf80,0x3ec4bf35,0x3f6dbf80,0x3ec4bf35,0x3ec4a677,0x3f6dbf35,0x3ec4268d,0x3f6dbf35
.long 0x3f73bf4f,0x3f73bf80,0x268d3e9e,0x3f16be9e,0xbe9e3f16,0x3e9ea69f,0xbf803f73,0xbf4f3f73
.long 0x3f06be9e,0x3f5abf35,0xbf6d3f4f,0xbf7f3f7d,0xbf5a3f73,0xbf063f35,0x3ec4bf16,0xbda1be20
.long 0xbe203e9e,0x3e202631,0x3f35bf4f,0x3ee8bf16,0xbf7d3f73,0xbf7d3f80,0x3f35bf16,0x3f64bf4f
.long 0xbf433f4f,0xbf263f35,0x3ec4be9e,0x3f06bee8,0xbf263f16,0xbf433f35,0xbf6d3f73,0xbf5a3f64
.long 0x3e9e3e9e,0x3f80bf4f,0xbf4f3e9e,0xbf4f3f80,0xbf733f73,0x26d43f16,0x3f16bf73,0xbf162754
.long 0xbf263f73,0x3ec43e20,0x3f79bf73,0x3e6fbf35,0xbf433e9e,0xbf6d3f7d,0x3e6f3e9e,0x3f79bf35
.long 0xbf7d3f4f,0xbf353f73,0xbee83f4f,0x3ee8a7b1,0x3e20bf16,0xbf353e9e,0xbf643f16,0xbf643f80
.long 0xbec4a60d,0xbf6d3f35,0xbec42816,0xbf6d3f35,0x3f6dbf80,0x3ec4bf35,0x3f6dbf80,0x3ec4bf35
.long 0x3f16bf4f,0xa777be9e,0x3f73bf4f,0x3f73bf80,0x3f4fbf16,0x3f80bf73,0xbe9e3f16,0x3e9ea7f7
.long 0x3f7fbf73,0x3f6dbf7d,0xbf5a3f73,0xbf063f35,0xbda13e9e,0x3ec4be20,0xbf063e9e,0xbf5a3f35
.long 0x3ee8be9e,0x3f35bf16,0x3e20be9e,0xbe20281f,0xbf643f73,0xbf353f4f,0x3f7dbf73,0x3f7dbf80
.long 0xbf063f16,0xbec43ee8,0x3f26bf16,0x3f43bf35,0xbf5a3f4f,0xbf6d3f64,0xbf433f4f,0xbf263f35
.long 0x3e9e3e9e,0x3f80bf4f,0xbf4f3e9e,0xbf4f3f80,0xbf733f73,0x27773f16,0x3f16bf73,0xbf1627b0
.long 0xbf433e9e,0xbf6d3f7d,0x3e6f3e9e,0x3f79bf35,0x3f26bf73,0xbec4be20,0xbf793f73,0xbe6f3f35
.long 0x3f7dbf4f,0x3f35bf73,0x3ee8bf4f,0xbee82777,0xbe203f16,0x3f35be9e,0x3f64bf16,0x3f64bf80
.long 0xbf6d3f80,0xbec43f35,0xbf6d3f80,0xbec43f35,0xbec42777,0xbf6d3f35,0xbec4a70d,0xbf6d3f35
.long 0x3f16bf4f,0x26d4be9e,0x3f73bf4f,0x3f73bf80,0x3f4fbf16,0x3f80bf73,0xbe9e3f16,0x3e9ea70d
.long 0xbda13e9e,0x3ec4be20,0xbf063e9e,0xbf5a3f35,0xbf7f3f73,0xbf6d3f7d,0x3f5abf73,0x3f06bf35
.long 0xbee83e9e,0xbf353f16,0xbe203e9e,0x3e20a902,0x3f64bf73,0x3f35bf4f,0xbf7d3f73,0xbf7d3f80
.long 0x3f5abf4f,0x3f6dbf64,0x3f43bf4f,0x3f26bf35,0xbf063f16,0xbec43ee8,0x3f26bf16,0x3f43bf35
.long 0x3e9ebf4f,0xbf4f3e9e,0x3e9e3e9e,0x3f80bf4f,0x3f73bf16,0x3f16bf73,0xbf733f73,0xa81f3f16
.long 0xbda13f16,0x3f5abee8,0x3f26bf73,0xbec4be20,0xbf7f3f4f,0xbf063f64,0x3f43be9e,0x3f6dbf7d
.long 0xbe20be9e,0xbf643f16,0xbf7d3f4f,0xbf353f73,0x3f7dbf73,0x3ee8bf4f,0x3e20bf16,0xbf353e9e
.long 0x3ec4a865,0x3f6dbf35,0x3ec4a804,0x3f6dbf35,0xbf6d3f80,0xbec43f35,0xbf6d3f80,0xbec43f35
.long 0xbf163e9e,0xbf733f4f,0x3f16bf4f,0x27e6be9e,0x3f4fbf73,0x3e9ebf16,0x3f4fbf16,0x3f80bf73
.long 0x3f43bf16,0x3f79bf64,0xbf7f3f73,0xbf6d3f7d,0xbf263f4f,0xbe6f3ee8,0x3da1be9e,0xbec43e20
.long 0xbf643f4f,0xbf7d3f73,0x3ee8be9e,0x3f35bf16,0x3ee8bf16,0x3e20be9e,0xbf643f73,0xbf353f4f
.long 0x3f79bf73,0x3f7fbf7d,0x3f06bf16,0x3ec4bee8,0xbe6f3e9e,0xbda13e20,0x3f5abf4f,0x3f6dbf64
.long 0xbf4f3f80,0x3e9e3e9e,0x3e9ebf4f,0xbf4f3e9e,0xbf16278d,0xbf733f73,0x3f73bf16,0x3f16bf73
.long 0x3f5abf80,0xbda1bee8,0xbf7f3f4f,0xbf063f64,0x3f062877,0x3f7fbf64,0x3da1bf16,0xbf5a3ee8
.long 0xbf643f80,0xbe203f16,0x3e203e9e,0x3f64bf16,0xbee8a754,0xbf7d3f4f,0xbf7d3f73,0xbee83f4f
.long 0x3f6dbf80,0x3ec4bf35,0x3f6dbf80,0x3ec4bf35,0x3ec4a80d,0x3f6dbf35,0x3ec4a896,0x3f6dbf35
.long 0xbf733f80,0xbf163f4f,0xbf163e9e,0xbf733f4f,0xbe9e279f,0xbf4f3f16,0x3f4fbf73,0x3e9ebf16
.long 0x3f79bf80,0x3f43bf64,0xbf263f4f,0xbe6f3ee8,0x3e6fa889,0x3f26bee8,0xbf433f16,0xbf793f64
.long 0xbf7d3f80,0xbf643f73,0x3f64bf4f,0x3f7dbf73,0xbe20a731,0xbee83e9e,0xbee83f16,0xbe203e9e
.long 0x3f7fbf80,0x3f79bf7d,0x3e6fbe9e,0x3da1be20,0x3da1a816,0x3e6fbe20,0x3f79bf73,0x3f7fbf7d
.long 0x3f80bf4f,0x3e9ebf4f,0xbf4f3f80,0x3e9e3e9e,0x279f3f16,0x3f73bf16,0xbf1627d4,0xbf733f73
.long 0xbf6d3f16,0xbf433f7d,0x3f0627e6,0x3f7fbf64,0x3ec4bf4f,0xbf263e20,0xbf5a3f80,0x3da13ee8
.long 0x3f35be9e,0x3f7dbf73,0x3f64bf80,0x3e20bf16,0xbf353f73,0x3e203e9e,0x3ee8a831,0x3f7dbf4f
.long 0xbec4289a,0xbf6d3f35,0xbec4a731,0xbf6d3f35,0x3f6dbf80,0x3ec4bf35,0x3f6dbf80,0x3ec4bf35
.long 0x28393e9e,0x3f16be9e,0xbf733f80,0xbf163f4f,0xbf803f73,0xbf4f3f73,0xbe9e2877,0xbf4f3f16
.long 0x3ec4bf16,0xbda1be20,0x3e6fa6d4,0x3f26bee8,0x3f6dbf4f,0x3f7fbf7d,0xbf793f80,0xbf433f64
.long 0xbf353f4f,0xbee83f16,0x3f7dbf80,0x3f64bf73,0xbf353f16,0xbf643f4f,0x3e20a89f,0x3ee8be9e
.long 0x3f6dbf73,0x3f5abf64,0xbda127c2,0xbe6f3e20,0x3ec4be9e,0x3f06bee8,0x3f7fbf80,0x3f79bf7d
.long 0x3f80bf4f,0x3e9ebf4f,0x0,0x0,0x28b93f16,0x3f73bf16,0x0,0x0
.long 0x3ec4bf4f,0xbf263e20,0x0,0x0,0x3f6dbf16,0x3f43bf7d,0x0,0x0
.long 0xbf353e9e,0xbf7d3f73,0x0,0x0,0x3f35bf73,0xbe20be9e,0x0,0x0
.long 0xbf6d3f80,0xbec43f35,0x0,0x0,0xbec427f7,0xbf6d3f35,0x0,0x0
.long 0x27c23e9e,0x3f16be9e,0x0,0x0,0xbf803f73,0xbf4f3f73,0x0,0x0
.long 0x3f6dbf4f,0x3f7fbf7d,0x0,0x0,0xbec43f16,0x3da13e20,0x0,0x0
.long 0x3f35bf4f,0x3ee8bf16,0x0,0x0,0x3f35bf16,0x3f64bf4f,0x0,0x0
.long 0xbec43e9e,0xbf063ee8,0x0,0x0,0x3f6dbf73,0x3f5abf64,0x0,0x0
.long 0xbf4f3e9e,0xbf4f3f80,0x0,0x0,0x3f16bf73,0xbf1627f7,0x0,0x0
.long 0xbf793f73,0xbe6f3f35,0x0,0x0,0xbe6fbe9e,0xbf793f35,0x0,0x0
.long 0xbee83f4f,0x3ee8285d,0x0,0x0,0xbf643f16,0xbf643f80,0x0,0x0
.long 0x3ec4a892,0x3f6dbf35,0x0,0x0,0xbf6d3f80,0xbec43f35,0x0,0x0
.long 0x3f73bf4f,0x3f73bf80,0x0,0x0,0xbe9e3f16,0x3e9e2754,0x0,0x0
.long 0x3f5abf73,0x3f06bf35,0x0,0x0,0x3f06be9e,0x3f5abf35,0x0,0x0
.long 0x3e20be9e,0xbe2027e5,0x0,0x0,0x3f7dbf73,0x3f7dbf80,0x0,0x0
.long 0xbf263f16,0xbf433f35,0x0,0x0,0x3f43bf4f,0x3f26bf35,0x0,0x0
.long 0x3e9e3e9e,0x3f80bf4f,0x0,0x0,0xbf733f73,0x28c23f16,0x0,0x0
.long 0x3f43be9e,0x3f6dbf7d,0x0,0x0,0xbf263f73,0x3ec43e20,0x0,0x0
.long 0x3f7dbf4f,0x3f35bf73,0x0,0x0,0xbe203f16,0x3f35be9e,0x0,0x0
.long 0x3f6dbf80,0x3ec4bf35,0x0,0x0,0x3ec4a8e5,0x3f6dbf35,0x0,0x0
.long 0x3f16bf4f,0x284bbe9e,0x0,0x0,0x3f4fbf16,0x3f80bf73,0x0,0x0
.long 0x3da1be9e,0xbec43e20,0x0,0x0,0x3f7fbf73,0x3f6dbf7d,0x0,0x0
.long 0xbee83e9e,0xbf353f16,0x0,0x0,0x3f64bf73,0x3f35bf4f,0x0,0x0
.long 0xbf5a3f4f,0xbf6d3f64,0x0,0x0,0x3f06bf16,0x3ec4bee8,0x0,0x0
.long 0x3e9ebf4f,0xbf4f3e9e,0x0,0x0,0x3f73bf16,0x3f16bf73,0x0,0x0
.long 0x3da1bf16,0xbf5a3ee8,0x0,0x0,0x3f7fbf4f,0x3f06bf64,0x0,0x0
.long 0xbe20be9e,0xbf643f16,0x0,0x0,0x3f7dbf73,0x3ee8bf4f,0x0,0x0
.long 0xbec427e5,0xbf6d3f35,0x0,0x0,0x3f6dbf80,0x3ec4bf35,0x0,0x0
.long 0xbf163e9e,0xbf733f4f,0x0,0x0,0x3f4fbf73,0x3e9ebf16,0x0,0x0
.long 0xbf433f16,0xbf793f64,0x0,0x0,0x3f26bf4f,0x3e6fbee8,0x0,0x0
.long 0xbf643f4f,0xbf7d3f73,0x0,0x0,0x3ee8bf16,0x3e20be9e,0x0,0x0
.long 0xbf793f73,0xbf7f3f7d,0x0,0x0,0x3e6fbe9e,0x3da1be20,0x0,0x0
.p2align 8
tab_TZ:
.long 0x3f803f80,0x3f803f80,0x3f803f80,0x3f803f80,0x3f803f80,0x3f803f80,0x3f803f80,0x3f803f80
.long 0x80008000,0x80008000,0x80008000,0x80008000,0x80008000,0x80008000,0x80008000,0x80008000
.long 0x3f803f80,0x3f353f35,0x248d248d,0xbf35bf35,0xbf80bf80,0xbf35bf35,0xa554a554,0x3f353f35
.long 0x80008000,0xbf35bf35,0xbf80bf80,0xbf35bf35,0xa50da50d,0x3f353f35,0x3f803f80,0x3f353f35
.long 0x3f803f80,0x248d248d,0xbf80bf80,0xa554a554,0x3f803f80,0x248d248d,0xbf80bf80,0xa554a554
.long 0x80008000,0xbf80bf80,0xa50da50d,0x3f803f80,0x80008000,0xbf80bf80,0xa50da50d,0x3f803f80
.long 0x3f803f80,0xbf35bf35,0xa554a554,0x3f353f35,0xbf80bf80,0x3f353f35,0x248d248d,0xbf35bf35
.long 0x80008000,0xbf35bf35,0x3f803f80,0xbf35bf35,0xa50da50d,0x3f353f35,0xbf80bf80,0x3f353f35
.long 0x3f803f80,0xbf80bf80,0x3f803f80,0xbf80bf80,0x3f803f80,0xbf80bf80,0x3f803f80,0xbf80bf80
.long 0x80008000,0xa50da50d,0x80008000,0xa50da50d,0x80008000,0xa50da50d,0x80008000,0xa50da50d
.long 0x3f803f80,0xbf35bf35,0x248d248d,0x3f353f35,0xbf80bf80,0x3f353f35,0xa554a554,0xbf35bf35
.long 0x80008000,0x3f353f35,0xbf80bf80,0x3f353f35,0xa50da50d,0xbf35bf35,0x3f803f80,0xbf35bf35
.long 0x3f803f80,0xa554a554,0xbf80bf80,0x248d248d,0x3f803f80,0xa554a554,0xbf80bf80,0x248d248d
.long 0x80008000,0x3f803f80,0xa50da50d,0xbf80bf80,0x80008000,0x3f803f80,0xa50da50d,0xbf80bf80
.long 0x3f803f80,0x3f353f35,0xa554a554,0xbf35bf35,0xbf80bf80,0xbf35bf35,0x248d248d,0x3f353f35
.long 0x80008000,0x3f353f35,0x3f803f80,0x3f353f35,0xa50da50d,0xbf35bf35,0xbf80bf80,0xbf35bf35
.long 0x3f80,0x3c213f80,0x3ca13f80,0x3cf13f80,0x3d213f80,0x3d493f80,0x3d713f80,0x3d8d3f7f
.long 0x3f808000,0x3f80bc21,0x3f80bca1,0x3f80bcf1,0x3f80bd21,0x3f80bd49,0x3f80bd71,0x3f7fbd8d
.long 0x3f80,0x3f373f33,0x3f80bca1,0x3f30bf3a,0xbd21bf80,0xbf3ebf2c,0xbf803d71,0xbf283f41
.long 0x3f808000,0x3f33bf37,0xbca1bf80,0xbf3abf30,0xbf803d21,0xbf2c3f3e,0x3d713f80,0x3f413f28
.long 0x3f80,0x3f80bc21,0xbca1bf80,0xbf803cf1,0x3d213f80,0x3f80bd49,0xbd71bf80,0xbf7f3d8d
.long 0x3f808000,0xbc21bf80,0xbf803ca1,0x3cf13f80,0x3f80bd21,0xbd49bf80,0xbf803d71,0x3d8d3f7f
.long 0x3f80,0x3f33bf37,0xbf803ca1,0x3f3a3f30,0xbd21bf80,0xbf2c3f3e,0x3f80bd71,0xbf41bf28
.long 0x3f808000,0xbf37bf33,0x3ca13f80,0x3f30bf3a,0xbf803d21,0x3f3e3f2c,0xbd71bf80,0xbf283f41
.long 0x3f80,0xbc21bf80,0x3ca13f80,0xbcf1bf80,0x3d213f80,0xbd49bf80,0x3d713f80,0xbd8dbf7f
.long 0x3f808000,0xbf803c21,0x3f80bca1,0xbf803cf1,0x3f80bd21,0xbf803d49,0x3f80bd71,0xbf7f3d8d
.long 0x3f80,0xbf37bf33,0x3f80bca1,0xbf303f3a,0xbd21bf80,0x3f3e3f2c,0xbf803d71,0x3f28bf41
.long 0x3f808000,0xbf333f37,0xbca1bf80,0x3f3a3f30,0xbf803d21,0x3f2cbf3e,0x3d713f80,0xbf41bf28
.long 0x3f80,0xbf803c21,0xbca1bf80,0x3f80bcf1,0x3d213f80,0xbf803d49,0xbd71bf80,0x3f7fbd8d
.long 0x3f808000,0x3c213f80,0xbf803ca1,0xbcf1bf80,0x3f80bd21,0x3d493f80,0xbf803d71,0xbd8dbf7f
.long 0x3f80,0xbf333f37,0xbf803ca1,0xbf3abf30,0xbd21bf80,0x3f2cbf3e,0x3f80bd71,0x3f413f28
.long 0x3f808000,0x3f373f33,0x3ca13f80,0xbf303f3a,0xbf803d21,0xbf3ebf2c,0xbd71bf80,0x3f28bf41
.long 0x3f80,0x3ca13f80,0x3d213f80,0x3d713f80,0x3da13f7f,0x3dc93f7f,0x3df13f7e,0x3e0c3f7e
.long 0x3f808000,0x3f80bca1,0x3f80bd21,0x3f80bd71,0x3f7fbda1,0x3f7fbdc9,0x3f7ebdf1,0x3f7ebe0c
.long 0x3f80,0x3f393f31,0x3f80bd21,0x3f2abf3f,0xbda1bf7f,0xbf46bf22,0xbf7e3df1,0xbf1b3f4c
.long 0x3f808000,0x3f31bf39,0xbd21bf80,0xbf3fbf2a,0xbf7f3da1,0xbf223f46,0x3df13f7e,0x3f4c3f1b
.long 0x3f80,0x3f80bca1,0xbd21bf80,0xbf803d71,0x3da13f7f,0x3f7fbdc9,0xbdf1bf7e,0xbf7e3e0c
.long 0x3f808000,0xbca1bf80,0xbf803d21,0x3d713f80,0x3f7fbda1,0xbdc9bf7f,0xbf7e3df1,0x3e0c3f7e
.long 0x3f80,0x3f31bf39,0xbf803d21,0x3f3f3f2a,0xbda1bf7f,0xbf223f46,0x3f7ebdf1,0xbf4cbf1b
.long 0x3f808000,0xbf39bf31,0x3d213f80,0x3f2abf3f,0xbf7f3da1,0x3f463f22,0xbdf1bf7e,0xbf1b3f4c
.long 0x3f80,0xbca1bf80,0x3d213f80,0xbd71bf80,0x3da13f7f,0xbdc9bf7f,0x3df13f7e,0xbe0cbf7e
.long 0x3f808000,0xbf803ca1,0x3f80bd21,0xbf803d71,0x3f7fbda1,0xbf7f3dc9,0x3f7ebdf1,0xbf7e3e0c
.long 0x3f80,0xbf39bf31,0x3f80bd21,0xbf2a3f3f,0xbda1bf7f,0x3f463f22,0xbf7e3df1,0x3f1bbf4c
.long 0x3f808000,0xbf313f39,0xbd21bf80,0x3f3f3f2a,0xbf7f3da1,0x3f22bf46,0x3df13f7e,0xbf4cbf1b
.long 0x3f80,0xbf803ca1,0xbd21bf80,0x3f80bd71,0x3da13f7f,0xbf7f3dc9,0xbdf1bf7e,0x3f7ebe0c
.long 0x3f808000,0x3ca13f80,0xbf803d21,0xbd71bf80,0x3f7fbda1,0x3dc93f7f,0xbf7e3df1,0xbe0cbf7e
.long 0x3f80,0xbf313f39,0xbf803d21,0xbf3fbf2a,0xbda1bf7f,0x3f22bf46,0x3f7ebdf1,0x3f4c3f1b
.long 0x3f808000,0x3f393f31,0x3d213f80,0xbf2a3f3f,0xbf7f3da1,0xbf46bf22,0xbdf1bf7e,0x3f1bbf4c
.long 0x3f80,0x3cf13f80,0x3d713f80,0x3db53f7f,0x3df13f7e,0x3e163f7d,0x3e343f7c,0x3e523f7b
.long 0x3f808000,0x3f80bcf1,0x3f80bd71,0x3f7fbdb5,0x3f7ebdf1,0x3f7dbe16,0x3f7cbe34,0x3f7bbe52
.long 0x3f80,0x3f3a3f30,0x3f80bd71,0x3f24bf44,0xbdf1bf7e,0xbf4ebf18,0xbf7c3e34,0xbf0c3f56
.long 0x3f808000,0x3f30bf3a,0xbd71bf80,0xbf44bf24,0xbf7e3df1,0xbf183f4e,0x3e343f7c,0x3f563f0c
.long 0x3f80,0x3f80bcf1,0xbd71bf80,0xbf7f3db5,0x3df13f7e,0x3f7dbe16,0xbe34bf7c,0xbf7b3e52
.long 0x3f808000,0xbcf1bf80,0xbf803d71,0x3db53f7f,0x3f7ebdf1,0xbe16bf7d,0xbf7c3e34,0x3e523f7b
.long 0x3f80,0x3f30bf3a,0xbf803d71,0x3f443f24,0xbdf1bf7e,0xbf183f4e,0x3f7cbe34,0xbf56bf0c
.long 0x3f808000,0xbf3abf30,0x3d713f80,0x3f24bf44,0xbf7e3df1,0x3f4e3f18,0xbe34bf7c,0xbf0c3f56
.long 0x3f80,0xbcf1bf80,0x3d713f80,0xbdb5bf7f,0x3df13f7e,0xbe16bf7d,0x3e343f7c,0xbe52bf7b
.long 0x3f808000,0xbf803cf1,0x3f80bd71,0xbf7f3db5,0x3f7ebdf1,0xbf7d3e16,0x3f7cbe34,0xbf7b3e52
.long 0x3f80,0xbf3abf30,0x3f80bd71,0xbf243f44,0xbdf1bf7e,0x3f4e3f18,0xbf7c3e34,0x3f0cbf56
.long 0x3f808000,0xbf303f3a,0xbd71bf80,0x3f443f24,0xbf7e3df1,0x3f18bf4e,0x3e343f7c,0xbf56bf0c
.long 0x3f80,0xbf803cf1,0xbd71bf80,0x3f7fbdb5,0x3df13f7e,0xbf7d3e16,0xbe34bf7c,0x3f7bbe52
.long 0x3f808000,0x3cf13f80,0xbf803d71,0xbdb5bf7f,0x3f7ebdf1,0x3e163f7d,0xbf7c3e34,0xbe52bf7b
.long 0x3f80,0xbf303f3a,0xbf803d71,0xbf44bf24,0xbdf1bf7e,0x3f18bf4e,0x3f7cbe34,0x3f563f0c
.long 0x3f808000,0x3f3a3f30,0x3d713f80,0xbf243f44,0xbf7e3df1,0xbf4ebf18,0xbe34bf7c,0x3f0cbf56
.long 0x3f80,0x3d213f80,0x3da13f7f,0x3df13f7e,0x3e203f7d,0x3e483f7b,0x3e6f3f79,0x3e8b3f76
.long 0x3f808000,0x3f80bd21,0x3f7fbda1,0x3f7ebdf1,0x3f7dbe20,0x3f7bbe48,0x3f79be6f,0x3f76be8b
.long 0x3f80,0x3f3c3f2e,0x3f7fbda1,0x3f1ebf49,0xbe20bf7d,0xbf55bf0e,0xbf793e6f,0xbefa3f5f
.long 0x3f808000,0x3f2ebf3c,0xbda1bf7f,0xbf49bf1e,0xbf7d3e20,0xbf0e3f55,0x3e6f3f79,0x3f5f3efa
.long 0x3f80,0x3f80bd21,0xbda1bf7f,0xbf7e3df1,0x3e203f7d,0x3f7bbe48,0xbe6fbf79,0xbf763e8b
.long 0x3f808000,0xbd21bf80,0xbf7f3da1,0x3df13f7e,0x3f7dbe20,0xbe48bf7b,0xbf793e6f,0x3e8b3f76
.long 0x3f80,0x3f2ebf3c,0xbf7f3da1,0x3f493f1e,0xbe20bf7d,0xbf0e3f55,0x3f79be6f,0xbf5fbefa
.long 0x3f808000,0xbf3cbf2e,0x3da13f7f,0x3f1ebf49,0xbf7d3e20,0x3f553f0e,0xbe6fbf79,0xbefa3f5f
.long 0x3f80,0xbd21bf80,0x3da13f7f,0xbdf1bf7e,0x3e203f7d,0xbe48bf7b,0x3e6f3f79,0xbe8bbf76
.long 0x3f808000,0xbf803d21,0x3f7fbda1,0xbf7e3df1,0x3f7dbe20,0xbf7b3e48,0x3f79be6f,0xbf763e8b
.long 0x3f80,0xbf3cbf2e,0x3f7fbda1,0xbf1e3f49,0xbe20bf7d,0x3f553f0e,0xbf793e6f,0x3efabf5f
.long 0x3f808000,0xbf2e3f3c,0xbda1bf7f,0x3f493f1e,0xbf7d3e20,0x3f0ebf55,0x3e6f3f79,0xbf5fbefa
.long 0x3f80,0xbf803d21,0xbda1bf7f,0x3f7ebdf1,0x3e203f7d,0xbf7b3e48,0xbe6fbf79,0x3f76be8b
.long 0x3f808000,0x3d213f80,0xbf7f3da1,0xbdf1bf7e,0x3f7dbe20,0x3e483f7b,0xbf793e6f,0xbe8bbf76
.long 0x3f80,0xbf2e3f3c,0xbf7f3da1,0xbf49bf1e,0xbe20bf7d,0x3f0ebf55,0x3f79be6f,0x3f5f3efa
.long 0x3f808000,0x3f3c3f2e,0x3da13f7f,0xbf1e3f49,0xbf7d3e20,0xbf55bf0e,0xbe6fbf79,0x3efabf5f
.long 0x3f80,0x3d493f80,0x3dc93f7f,0x3e163f7d,0x3e483f7b,0x3e793f78,0x3e953f75,0x3eac3f71
.long 0x3f808000,0x3f80bd49,0x3f7fbdc9,0x3f7dbe16,0x3f7bbe48,0x3f78be79,0x3f75be95,0x3f71beac
.long 0x3f80,0x3f3e3f2c,0x3f7fbdc9,0x3f18bf4e,0xbe48bf7b,0xbf5cbf04,0xbf753e95,0xbedb3f67
.long 0x3f808000,0x3f2cbf3e,0xbdc9bf7f,0xbf4ebf18,0xbf7b3e48,0xbf043f5c,0x3e953f75,0x3f673edb
.long 0x3f80,0x3f80bd49,0xbdc9bf7f,0xbf7d3e16,0x3e483f7b,0x3f78be79,0xbe95bf75,0xbf713eac
.long 0x3f808000,0xbd49bf80,0xbf7f3dc9,0x3e163f7d,0x3f7bbe48,0xbe79bf78,0xbf753e95,0x3eac3f71
.long 0x3f80,0x3f2cbf3e,0xbf7f3dc9,0x3f4e3f18,0xbe48bf7b,0xbf043f5c,0x3f75be95,0xbf67bedb
.long 0x3f808000,0xbf3ebf2c,0x3dc93f7f,0x3f18bf4e,0xbf7b3e48,0x3f5c3f04,0xbe95bf75,0xbedb3f67
.long 0x3f80,0xbd49bf80,0x3dc93f7f,0xbe16bf7d,0x3e483f7b,0xbe79bf78,0x3e953f75,0xbeacbf71
.long 0x3f808000,0xbf803d49,0x3f7fbdc9,0xbf7d3e16,0x3f7bbe48,0xbf783e79,0x3f75be95,0xbf713eac
.long 0x3f80,0xbf3ebf2c,0x3f7fbdc9,0xbf183f4e,0xbe48bf7b,0x3f5c3f04,0xbf753e95,0x3edbbf67
.long 0x3f808000,0xbf2c3f3e,0xbdc9bf7f,0x3f4e3f18,0xbf7b3e48,0x3f04bf5c,0x3e953f75,0xbf67bedb
.long 0x3f80,0xbf803d49,0xbdc9bf7f,0x3f7dbe16,0x3e483f7b,0xbf783e79,0xbe95bf75,0x3f71beac
.long 0x3f808000,0x3d493f80,0xbf7f3dc9,0xbe16bf7d,0x3f7bbe48,0x3e793f78,0xbf753e95,0xbeacbf71
.long 0x3f80,0xbf2c3f3e,0xbf7f3dc9,0xbf4ebf18,0xbe48bf7b,0x3f04bf5c,0x3f75be95,0x3f673edb
.long 0x3f808000,0x3f3e3f2c,0x3dc93f7f,0xbf183f4e,0xbf7b3e48,0xbf5cbf04,0xbe95bf75,0x3edbbf67
.long 0x3f80,0x3d713f80,0x3df13f7e,0x3e343f7c,0x3e6f3f79,0x3e953f75,0x3eb13f70,0x3ecd3f6b
.long 0x3f808000,0x3f80bd71,0x3f7ebdf1,0x3f7cbe34,0x3f79be6f,0x3f75be95,0x3f70beb1,0x3f6bbecd
.long 0x3f80,0x3f3f3f2a,0x3f7ebdf1,0x3f12bf52,0xbe6fbf79,0xbf62bef1,0xbf703eb1,0xbebb3f6e
.long 0x3f808000,0x3f2abf3f,0xbdf1bf7e,0xbf52bf12,0xbf793e6f,0xbef13f62,0x3eb13f70,0x3f6e3ebb
.long 0x3f80,0x3f80bd71,0xbdf1bf7e,0xbf7c3e34,0x3e6f3f79,0x3f75be95,0xbeb1bf70,0xbf6b3ecd
.long 0x3f808000,0xbd71bf80,0xbf7e3df1,0x3e343f7c,0x3f79be6f,0xbe95bf75,0xbf703eb1,0x3ecd3f6b
.long 0x3f80,0x3f2abf3f,0xbf7e3df1,0x3f523f12,0xbe6fbf79,0xbef13f62,0x3f70beb1,0xbf6ebebb
.long 0x3f808000,0xbf3fbf2a,0x3df13f7e,0x3f12bf52,0xbf793e6f,0x3f623ef1,0xbeb1bf70,0xbebb3f6e
.long 0x3f80,0xbd71bf80,0x3df13f7e,0xbe34bf7c,0x3e6f3f79,0xbe95bf75,0x3eb13f70,0xbecdbf6b
.long 0x3f808000,0xbf803d71,0x3f7ebdf1,0xbf7c3e34,0x3f79be6f,0xbf753e95,0x3f70beb1,0xbf6b3ecd
.long 0x3f80,0xbf3fbf2a,0x3f7ebdf1,0xbf123f52,0xbe6fbf79,0x3f623ef1,0xbf703eb1,0x3ebbbf6e
.long 0x3f808000,0xbf2a3f3f,0xbdf1bf7e,0x3f523f12,0xbf793e6f,0x3ef1bf62,0x3eb13f70,0xbf6ebebb
.long 0x3f80,0xbf803d71,0xbdf1bf7e,0x3f7cbe34,0x3e6f3f79,0xbf753e95,0xbeb1bf70,0x3f6bbecd
.long 0x3f808000,0x3d713f80,0xbf7e3df1,0xbe34bf7c,0x3f79be6f,0x3e953f75,0xbf703eb1,0xbecdbf6b
.long 0x3f80,0xbf2a3f3f,0xbf7e3df1,0xbf52bf12,0xbe6fbf79,0x3ef1bf62,0x3f70beb1,0x3f6e3ebb
.long 0x3f808000,0x3f3f3f2a,0x3df13f7e,0xbf123f52,0xbf793e6f,0xbf62bef1,0xbeb1bf70,0x3ebbbf6e
.long 0x3f80,0x3d8d3f7f,0x3e0c3f7e,0x3e523f7b,0x3e8b3f76,0x3eac3f71,0x3ecd3f6b,0x3eed3f63
.long 0x3f808000,0x3f7fbd8d,0x3f7ebe0c,0x3f7bbe52,0x3f76be8b,0x3f71beac,0x3f6bbecd,0x3f63beed
.long 0x3f80,0x3f413f28,0x3f7ebe0c,0x3f0cbf56,0xbe8bbf76,0xbf67bedb,0xbf6b3ecd,0xbe993f74
.long 0x3f808000,0x3f28bf41,0xbe0cbf7e,0xbf56bf0c,0xbf763e8b,0xbedb3f67,0x3ecd3f6b,0x3f743e99
.long 0x3f80,0x3f7fbd8d,0xbe0cbf7e,0xbf7b3e52,0x3e8b3f76,0x3f71beac,0xbecdbf6b,0xbf633eed
.long 0x3f808000,0xbd8dbf7f,0xbf7e3e0c,0x3e523f7b,0x3f76be8b,0xbeacbf71,0xbf6b3ecd,0x3eed3f63
.long 0x3f80,0x3f28bf41,0xbf7e3e0c,0x3f563f0c,0xbe8bbf76,0xbedb3f67,0x3f6bbecd,0xbf74be99
.long 0x3f808000,0xbf41bf28,0x3e0c3f7e,0x3f0cbf56,0xbf763e8b,0x3f673edb,0xbecdbf6b,0xbe993f74
.long 0x3f80,0xbd8dbf7f,0x3e0c3f7e,0xbe52bf7b,0x3e8b3f76,0xbeacbf71,0x3ecd3f6b,0xbeedbf63
.long 0x3f808000,0xbf7f3d8d,0x3f7ebe0c,0xbf7b3e52,0x3f76be8b,0xbf713eac,0x3f6bbecd,0xbf633eed
.long 0x3f80,0xbf41bf28,0x3f7ebe0c,0xbf0c3f56,0xbe8bbf76,0x3f673edb,0xbf6b3ecd,0x3e99bf74
.long 0x3f808000,0xbf283f41,0xbe0cbf7e,0x3f563f0c,0xbf763e8b,0x3edbbf67,0x3ecd3f6b,0xbf74be99
.long 0x3f80,0xbf7f3d8d,0xbe0cbf7e,0x3f7bbe52,0x3e8b3f76,0xbf713eac,0xbecdbf6b,0x3f63beed
.long 0x3f808000,0x3d8d3f7f,0xbf7e3e0c,0xbe52bf7b,0x3f76be8b,0x3eac3f71,0xbf6b3ecd,0xbeedbf63
.long 0x3f80,0xbf283f41,0xbf7e3e0c,0xbf56bf0c,0xbe8bbf76,0x3edbbf67,0x3f6bbecd,0x3f743e99
.long 0x3f808000,0x3f413f28,0x3e0c3f7e,0xbf0c3f56,0xbf763e8b,0xbf67bedb,0xbecdbf6b,0x3e99bf74
.long 0x3f80,0x3da13f7f,0x3e203f7d,0x3e6f3f79,0x3e9e3f73,0x3ec43f6d,0x3ee83f64,0x3f063f5a
.long 0x3f808000,0x3f7fbda1,0x3f7dbe20,0x3f79be6f,0x3f73be9e,0x3f6dbec4,0x3f64bee8,0x3f5abf06
.long 0x3f80,0x3f433f26,0x3f7dbe20,0x3f06bf5a,0xbe9ebf73,0xbf6dbec4,0xbf643ee8,0xbe6f3f79
.long 0x3f808000,0x3f26bf43,0xbe20bf7d,0xbf5abf06,0xbf733e9e,0xbec43f6d,0x3ee83f64,0x3f793e6f
.long 0x3f80,0x3f7fbda1,0xbe20bf7d,0xbf793e6f,0x3e9e3f73,0x3f6dbec4,0xbee8bf64,0xbf5a3f06
.long 0x3f808000,0xbda1bf7f,0xbf7d3e20,0x3e6f3f79,0x3f73be9e,0xbec4bf6d,0xbf643ee8,0x3f063f5a
.long 0x3f80,0x3f26bf43,0xbf7d3e20,0x3f5a3f06,0xbe9ebf73,0xbec43f6d,0x3f64bee8,0xbf79be6f
.long 0x3f808000,0xbf43bf26,0x3e203f7d,0x3f06bf5a,0xbf733e9e,0x3f6d3ec4,0xbee8bf64,0xbe6f3f79
.long 0x3f80,0xbda1bf7f,0x3e203f7d,0xbe6fbf79,0x3e9e3f73,0xbec4bf6d,0x3ee83f64,0xbf06bf5a
.long 0x3f808000,0xbf7f3da1,0x3f7dbe20,0xbf793e6f,0x3f73be9e,0xbf6d3ec4,0x3f64bee8,0xbf5a3f06
.long 0x3f80,0xbf43bf26,0x3f7dbe20,0xbf063f5a,0xbe9ebf73,0x3f6d3ec4,0xbf643ee8,0x3e6fbf79
.long 0x3f808000,0xbf263f43,0xbe20bf7d,0x3f5a3f06,0xbf733e9e,0x3ec4bf6d,0x3ee83f64,0xbf79be6f
.long 0x3f80,0xbf7f3da1,0xbe20bf7d,0x3f79be6f,0x3e9e3f73,0xbf6d3ec4,0xbee8bf64,0x3f5abf06
.long 0x3f808000,0x3da13f7f,0xbf7d3e20,0xbe6fbf79,0x3f73be9e,0x3ec43f6d,0xbf643ee8,0xbf06bf5a
.long 0x3f80,0xbf263f43,0xbf7d3e20,0xbf5abf06,0xbe9ebf73,0x3ec4bf6d,0x3f64bee8,0x3f793e6f
.long 0x3f808000,0x3f433f26,0x3e203f7d,0xbf063f5a,0xbf733e9e,0xbf6dbec4,0xbee8bf64,0x3e6fbf79
.long 0x3f80,0x3db53f7f,0x3e343f7c,0x3e863f77,0x3eb13f70,0x3edb3f67,0x3f013f5d,0x3f143f51
.long 0x3f808000,0x3f7fbdb5,0x3f7cbe34,0x3f77be86,0x3f70beb1,0x3f67bedb,0x3f5dbf01,0x3f51bf14
.long 0x3f80,0x3f443f24,0x3f7cbe34,0x3effbf5e,0xbeb1bf70,0xbf71beac,0xbf5d3f01,0xbe2a3f7c
.long 0x3f808000,0x3f24bf44,0xbe34bf7c,0xbf5ebeff,0xbf703eb1,0xbeac3f71,0x3f013f5d,0x3f7c3e2a
.long 0x3f80,0x3f7fbdb5,0xbe34bf7c,0xbf773e86,0x3eb13f70,0x3f67bedb,0xbf01bf5d,0xbf513f14
.long 0x3f808000,0xbdb5bf7f,0xbf7c3e34,0x3e863f77,0x3f70beb1,0xbedbbf67,0xbf5d3f01,0x3f143f51
.long 0x3f80,0x3f24bf44,0xbf7c3e34,0x3f5e3eff,0xbeb1bf70,0xbeac3f71,0x3f5dbf01,0xbf7cbe2a
.long 0x3f808000,0xbf44bf24,0x3e343f7c,0x3effbf5e,0xbf703eb1,0x3f713eac,0xbf01bf5d,0xbe2a3f7c
.long 0x3f80,0xbdb5bf7f,0x3e343f7c,0xbe86bf77,0x3eb13f70,0xbedbbf67,0x3f013f5d,0xbf14bf51
.long 0x3f808000,0xbf7f3db5,0x3f7cbe34,0xbf773e86,0x3f70beb1,0xbf673edb,0x3f5dbf01,0xbf513f14
.long 0x3f80,0xbf44bf24,0x3f7cbe34,0xbeff3f5e,0xbeb1bf70,0x3f713eac,0xbf5d3f01,0x3e2abf7c
.long 0x3f808000,0xbf243f44,0xbe34bf7c,0x3f5e3eff,0xbf703eb1,0x3eacbf71,0x3f013f5d,0xbf7cbe2a
.long 0x3f80,0xbf7f3db5,0xbe34bf7c,0x3f77be86,0x3eb13f70,0xbf673edb,0xbf01bf5d,0x3f51bf14
.long 0x3f808000,0x3db53f7f,0xbf7c3e34,0xbe86bf77,0x3f70beb1,0x3edb3f67,0xbf5d3f01,0xbf14bf51
.long 0x3f80,0xbf243f44,0xbf7c3e34,0xbf5ebeff,0xbeb1bf70,0x3eacbf71,0x3f5dbf01,0x3f7c3e2a
.long 0x3f808000,0x3f443f24,0x3e343f7c,0xbeff3f5e,0xbf703eb1,0xbf71beac,0xbf01bf5d,0x3e2abf7c
.long 0x3f80,0x3dc93f7f,0x3e483f7b,0x3e953f75,0x3ec43f6d,0x3ef13f62,0x3f0e3f55,0x3f223f46
.long 0x3f808000,0x3f7fbdc9,0x3f7bbe48,0x3f75be95,0x3f6dbec4,0x3f62bef1,0x3f55bf0e,0x3f46bf22
.long 0x3f80,0x3f463f22,0x3f7bbe48,0x3ef1bf62,0xbec4bf6d,0xbf75be95,0xbf553f0e,0xbdc93f7f
.long 0x3f808000,0x3f22bf46,0xbe48bf7b,0xbf62bef1,0xbf6d3ec4,0xbe953f75,0x3f0e3f55,0x3f7f3dc9
.long 0x3f80,0x3f7fbdc9,0xbe48bf7b,0xbf753e95,0x3ec43f6d,0x3f62bef1,0xbf0ebf55,0xbf463f22
.long 0x3f808000,0xbdc9bf7f,0xbf7b3e48,0x3e953f75,0x3f6dbec4,0xbef1bf62,0xbf553f0e,0x3f223f46
.long 0x3f80,0x3f22bf46,0xbf7b3e48,0x3f623ef1,0xbec4bf6d,0xbe953f75,0x3f55bf0e,0xbf7fbdc9
.long 0x3f808000,0xbf46bf22,0x3e483f7b,0x3ef1bf62,0xbf6d3ec4,0x3f753e95,0xbf0ebf55,0xbdc93f7f
.long 0x3f80,0xbdc9bf7f,0x3e483f7b,0xbe95bf75,0x3ec43f6d,0xbef1bf62,0x3f0e3f55,0xbf22bf46
.long 0x3f808000,0xbf7f3dc9,0x3f7bbe48,0xbf753e95,0x3f6dbec4,0xbf623ef1,0x3f55bf0e,0xbf463f22
.long 0x3f80,0xbf46bf22,0x3f7bbe48,0xbef13f62,0xbec4bf6d,0x3f753e95,0xbf553f0e,0x3dc9bf7f
.long 0x3f808000,0xbf223f46,0xbe48bf7b,0x3f623ef1,0xbf6d3ec4,0x3e95bf75,0x3f0e3f55,0xbf7fbdc9
.long 0x3f80,0xbf7f3dc9,0xbe48bf7b,0x3f75be95,0x3ec43f6d,0xbf623ef1,0xbf0ebf55,0x3f46bf22
.long 0x3f808000,0x3dc93f7f,0xbf7b3e48,0xbe95bf75,0x3f6dbec4,0x3ef13f62,0xbf553f0e,0xbf22bf46
.long 0x3f80,0xbf223f46,0xbf7b3e48,0xbf62bef1,0xbec4bf6d,0x3e95bf75,0x3f55bf0e,0x3f7f3dc9
.long 0x3f808000,0x3f463f22,0x3e483f7b,0xbef13f62,0xbf6d3ec4,0xbf75be95,0xbf0ebf55,0x3dc9bf7f
.long 0x3f80,0x3ddd3f7f,0x3e5b3f7a,0x3ea33f73,0x3ed63f68,0x3f043f5c,0x3f1b3f4c,0x3f303f3a
.long 0x3f808000,0x3f7fbddd,0x3f7abe5b,0x3f73bea3,0x3f68bed6,0x3f5cbf04,0x3f4cbf1b,0x3f3abf30
.long 0x3f80,0x3f473f20,0x3f7abe5b,0x3ee4bf65,0xbed6bf68,0xbf78be79,0xbf4c3f1b,0xbcf13f80
.long 0x3f808000,0x3f20bf47,0xbe5bbf7a,0xbf65bee4,0xbf683ed6,0xbe793f78,0x3f1b3f4c,0x3f803cf1
.long 0x3f80,0x3f7fbddd,0xbe5bbf7a,0xbf733ea3,0x3ed63f68,0x3f5cbf04,0xbf1bbf4c,0xbf3a3f30
.long 0x3f808000,0xbdddbf7f,0xbf7a3e5b,0x3ea33f73,0x3f68bed6,0xbf04bf5c,0xbf4c3f1b,0x3f303f3a
.long 0x3f80,0x3f20bf47,0xbf7a3e5b,0x3f653ee4,0xbed6bf68,0xbe793f78,0x3f4cbf1b,0xbf80bcf1
.long 0x3f808000,0xbf47bf20,0x3e5b3f7a,0x3ee4bf65,0xbf683ed6,0x3f783e79,0xbf1bbf4c,0xbcf13f80
.long 0x3f80,0xbdddbf7f,0x3e5b3f7a,0xbea3bf73,0x3ed63f68,0xbf04bf5c,0x3f1b3f4c,0xbf30bf3a
.long 0x3f808000,0xbf7f3ddd,0x3f7abe5b,0xbf733ea3,0x3f68bed6,0xbf5c3f04,0x3f4cbf1b,0xbf3a3f30
.long 0x3f80,0xbf47bf20,0x3f7abe5b,0xbee43f65,0xbed6bf68,0x3f783e79,0xbf4c3f1b,0x3cf1bf80
.long 0x3f808000,0xbf203f47,0xbe5bbf7a,0x3f653ee4,0xbf683ed6,0x3e79bf78,0x3f1b3f4c,0xbf80bcf1
.long 0x3f80,0xbf7f3ddd,0xbe5bbf7a,0x3f73bea3,0x3ed63f68,0xbf5c3f04,0xbf1bbf4c,0x3f3abf30
.long 0x3f808000,0x3ddd3f7f,0xbf7a3e5b,0xbea3bf73,0x3f68bed6,0x3f043f5c,0xbf4c3f1b,0xbf30bf3a
.long 0x3f80,0xbf203f47,0xbf7a3e5b,0xbf65bee4,0xbed6bf68,0x3e79bf78,0x3f4cbf1b,0x3f803cf1
.long 0x3f808000,0x3f473f20,0x3e5b3f7a,0xbee43f65,0xbf683ed6,0xbf78be79,0xbf1bbf4c,0x3cf1bf80
.long 0x3f80,0x3df13f7e,0x3e6f3f79,0x3eb13f70,0x3ee83f64,0x3f0e3f55,0x3f263f43,0x3f3c3f2e
.long 0x3f808000,0x3f7ebdf1,0x3f79be6f,0x3f70beb1,0x3f64bee8,0x3f55bf0e,0x3f43bf26,0x3f2ebf3c
.long 0x3f80,0x3f493f1e,0x3f79be6f,0x3ed6bf68,0xbee8bf64,0xbf7bbe48,0xbf433f26,0x3d213f80
.long 0x3f808000,0x3f1ebf49,0xbe6fbf79,0xbf68bed6,0xbf643ee8,0xbe483f7b,0x3f263f43,0x3f80bd21
.long 0x3f80,0x3f7ebdf1,0xbe6fbf79,0xbf703eb1,0x3ee83f64,0x3f55bf0e,0xbf26bf43,0xbf2e3f3c
.long 0x3f808000,0xbdf1bf7e,0xbf793e6f,0x3eb13f70,0x3f64bee8,0xbf0ebf55,0xbf433f26,0x3f3c3f2e
.long 0x3f80,0x3f1ebf49,0xbf793e6f,0x3f683ed6,0xbee8bf64,0xbe483f7b,0x3f43bf26,0xbf803d21
.long 0x3f808000,0xbf49bf1e,0x3e6f3f79,0x3ed6bf68,0xbf643ee8,0x3f7b3e48,0xbf26bf43,0x3d213f80
.long 0x3f80,0xbdf1bf7e,0x3e6f3f79,0xbeb1bf70,0x3ee83f64,0xbf0ebf55,0x3f263f43,0xbf3cbf2e
.long 0x3f808000,0xbf7e3df1,0x3f79be6f,0xbf703eb1,0x3f64bee8,0xbf553f0e,0x3f43bf26,0xbf2e3f3c
.long 0x3f80,0xbf49bf1e,0x3f79be6f,0xbed63f68,0xbee8bf64,0x3f7b3e48,0xbf433f26,0xbd21bf80
.long 0x3f808000,0xbf1e3f49,0xbe6fbf79,0x3f683ed6,0xbf643ee8,0x3e48bf7b,0x3f263f43,0xbf803d21
.long 0x3f80,0xbf7e3df1,0xbe6fbf79,0x3f70beb1,0x3ee83f64,0xbf553f0e,0xbf26bf43,0x3f2ebf3c
.long 0x3f808000,0x3df13f7e,0xbf793e6f,0xbeb1bf70,0x3f64bee8,0x3f0e3f55,0xbf433f26,0xbf3cbf2e
.long 0x3f80,0xbf1e3f49,0xbf793e6f,0xbf68bed6,0xbee8bf64,0x3e48bf7b,0x3f43bf26,0x3f80bd21
.long 0x3f808000,0x3f493f1e,0x3e6f3f79,0xbed63f68,0xbf643ee8,0xbf7bbe48,0xbf26bf43,0xbd21bf80
.long 0x3f80,0x3e023f7e,0x3e813f78,0x3ebf3f6d,0x3efa3f5f,0x3f183f4e,0x3f313f39,0x3f473f20
.long 0x3f808000,0x3f7ebe02,0x3f78be81,0x3f6dbebf,0x3f5fbefa,0x3f4ebf18,0x3f39bf31,0x3f20bf47
.long 0x3f80,0x3f4b3f1d,0x3f78be81,0x3ec9bf6c,0xbefabf5f,0xbf7dbe16,0xbf393f31,0x3ddd3f7f
.long 0x3f808000,0x3f1dbf4b,0xbe81bf78,0xbf6cbec9,0xbf5f3efa,0xbe163f7d,0x3f313f39,0x3f7fbddd
.long 0x3f80,0x3f7ebe02,0xbe81bf78,0xbf6d3ebf,0x3efa3f5f,0x3f4ebf18,0xbf31bf39,0xbf203f47
.long 0x3f808000,0xbe02bf7e,0xbf783e81,0x3ebf3f6d,0x3f5fbefa,0xbf18bf4e,0xbf393f31,0x3f473f20
.long 0x3f80,0x3f1dbf4b,0xbf783e81,0x3f6c3ec9,0xbefabf5f,0xbe163f7d,0x3f39bf31,0xbf7f3ddd
.long 0x3f808000,0xbf4bbf1d,0x3e813f78,0x3ec9bf6c,0xbf5f3efa,0x3f7d3e16,0xbf31bf39,0x3ddd3f7f
.long 0x3f80,0xbe02bf7e,0x3e813f78,0xbebfbf6d,0x3efa3f5f,0xbf18bf4e,0x3f313f39,0xbf47bf20
.long 0x3f808000,0xbf7e3e02,0x3f78be81,0xbf6d3ebf,0x3f5fbefa,0xbf4e3f18,0x3f39bf31,0xbf203f47
.long 0x3f80,0xbf4bbf1d,0x3f78be81,0xbec93f6c,0xbefabf5f,0x3f7d3e16,0xbf393f31,0xbdddbf7f
.long 0x3f808000,0xbf1d3f4b,0xbe81bf78,0x3f6c3ec9,0xbf5f3efa,0x3e16bf7d,0x3f313f39,0xbf7f3ddd
.long 0x3f80,0xbf7e3e02,0xbe81bf78,0x3f6dbebf,0x3efa3f5f,0xbf4e3f18,0xbf31bf39,0x3f20bf47
.long 0x3f808000,0x3e023f7e,0xbf783e81,0xbebfbf6d,0x3f5fbefa,0x3f183f4e,0xbf393f31,0xbf47bf20
.long 0x3f80,0xbf1d3f4b,0xbf783e81,0xbf6cbec9,0xbefabf5f,0x3e16bf7d,0x3f39bf31,0x3f7fbddd
.long 0x3f808000,0x3f4b3f1d,0x3e813f78,0xbec93f6c,0xbf5f3efa,0xbf7dbe16,0xbf31bf39,0xbdddbf7f
.long 0x3f80,0x3e0c3f7e,0x3e8b3f76,0x3ecd3f6b,0x3f063f5a,0x3f223f46,0x3f3c3f2e,0x3f523f12
.long 0x3f808000,0x3f7ebe0c,0x3f76be8b,0x3f6bbecd,0x3f5abf06,0x3f46bf22,0x3f2ebf3c,0x3f12bf52
.long 0x3f80,0x3f4c3f1b,0x3f76be8b,0x3ebbbf6e,0xbf06bf5a,0xbf7fbdc9,0xbf2e3f3c,0x3e343f7c
.long 0x3f808000,0x3f1bbf4c,0xbe8bbf76,0xbf6ebebb,0xbf5a3f06,0xbdc93f7f,0x3f3c3f2e,0x3f7cbe34
.long 0x3f80,0x3f7ebe0c,0xbe8bbf76,0xbf6b3ecd,0x3f063f5a,0x3f46bf22,0xbf3cbf2e,0xbf123f52
.long 0x3f808000,0xbe0cbf7e,0xbf763e8b,0x3ecd3f6b,0x3f5abf06,0xbf22bf46,0xbf2e3f3c,0x3f523f12
.long 0x3f80,0x3f1bbf4c,0xbf763e8b,0x3f6e3ebb,0xbf06bf5a,0xbdc93f7f,0x3f2ebf3c,0xbf7c3e34
.long 0x3f808000,0xbf4cbf1b,0x3e8b3f76,0x3ebbbf6e,0xbf5a3f06,0x3f7f3dc9,0xbf3cbf2e,0x3e343f7c
.long 0x3f80,0xbe0cbf7e,0x3e8b3f76,0xbecdbf6b,0x3f063f5a,0xbf22bf46,0x3f3c3f2e,0xbf52bf12
.long 0x3f808000,0xbf7e3e0c,0x3f76be8b,0xbf6b3ecd,0x3f5abf06,0xbf463f22,0x3f2ebf3c,0xbf123f52
.long 0x3f80,0xbf4cbf1b,0x3f76be8b,0xbebb3f6e,0xbf06bf5a,0x3f7f3dc9,0xbf2e3f3c,0xbe34bf7c
.long 0x3f808000,0xbf1b3f4c,0xbe8bbf76,0x3f6e3ebb,0xbf5a3f06,0x3dc9bf7f,0x3f3c3f2e,0xbf7c3e34
.long 0x3f80,0xbf7e3e0c,0xbe8bbf76,0x3f6bbecd,0x3f063f5a,0xbf463f22,0xbf3cbf2e,0x3f12bf52
.long 0x3f808000,0x3e0c3f7e,0xbf763e8b,0xbecdbf6b,0x3f5abf06,0x3f223f46,0xbf2e3f3c,0xbf52bf12
.long 0x3f80,0xbf1b3f4c,0xbf763e8b,0xbf6ebebb,0xbf06bf5a,0x3dc9bf7f,0x3f2ebf3c,0x3f7cbe34
.long 0x3f808000,0x3f4c3f1b,0x3e8b3f76,0xbebb3f6e,0xbf5a3f06,0xbf7fbdc9,0xbf3cbf2e,0xbe34bf7c
.long 0x3f80,0x3e163f7d,0x3e953f75,0x3edb3f67,0x3f0e3f55,0x3f2c3f3e,0x3f463f22,0x3f5c3f04
.long 0x3f808000,0x3f7dbe16,0x3f75be95,0x3f67bedb,0x3f55bf0e,0x3f3ebf2c,0x3f22bf46,0x3f04bf5c
.long 0x3f80,0x3f4e3f18,0x3f75be95,0x3eacbf71,0xbf0ebf55,0xbf80bd49,0xbf223f46,0x3e793f78
.long 0x3f808000,0x3f18bf4e,0xbe95bf75,0xbf71beac,0xbf553f0e,0xbd493f80,0x3f463f22,0x3f78be79
.long 0x3f80,0x3f7dbe16,0xbe95bf75,0xbf673edb,0x3f0e3f55,0x3f3ebf2c,0xbf46bf22,0xbf043f5c
.long 0x3f808000,0xbe16bf7d,0xbf753e95,0x3edb3f67,0x3f55bf0e,0xbf2cbf3e,0xbf223f46,0x3f5c3f04
.long 0x3f80,0x3f18bf4e,0xbf753e95,0x3f713eac,0xbf0ebf55,0xbd493f80,0x3f22bf46,0xbf783e79
.long 0x3f808000,0xbf4ebf18,0x3e953f75,0x3eacbf71,0xbf553f0e,0x3f803d49,0xbf46bf22,0x3e793f78
.long 0x3f80,0xbe16bf7d,0x3e953f75,0xbedbbf67,0x3f0e3f55,0xbf2cbf3e,0x3f463f22,0xbf5cbf04
.long 0x3f808000,0xbf7d3e16,0x3f75be95,0xbf673edb,0x3f55bf0e,0xbf3e3f2c,0x3f22bf46,0xbf043f5c
.long 0x3f80,0xbf4ebf18,0x3f75be95,0xbeac3f71,0xbf0ebf55,0x3f803d49,0xbf223f46,0xbe79bf78
.long 0x3f808000,0xbf183f4e,0xbe95bf75,0x3f713eac,0xbf553f0e,0x3d49bf80,0x3f463f22,0xbf783e79
.long 0x3f80,0xbf7d3e16,0xbe95bf75,0x3f67bedb,0x3f0e3f55,0xbf3e3f2c,0xbf46bf22,0x3f04bf5c
.long 0x3f808000,0x3e163f7d,0xbf753e95,0xbedbbf67,0x3f55bf0e,0x3f2c3f3e,0xbf223f46,0xbf5cbf04
.long 0x3f80,0xbf183f4e,0xbf753e95,0xbf71beac,0xbf0ebf55,0x3d49bf80,0x3f22bf46,0x3f78be79
.long 0x3f808000,0x3f4e3f18,0x3e953f75,0xbeac3f71,0xbf553f0e,0xbf80bd49,0xbf46bf22,0xbe79bf78
.long 0x3f80,0x3e203f7d,0x3e9e3f73,0x3ee83f64,0x3f163f4f,0x3f353f35,0x3f4f3f16,0x3f643ee8
.long 0x3f808000,0x3f7dbe20,0x3f73be9e,0x3f64bee8,0x3f4fbf16,0x3f35bf35,0x3f16bf4f,0x3ee8bf64
.long 0x3f80,0x3f4f3f16,0x3f73be9e,0x3e9ebf73,0xbf16bf4f,0xbf80a554,0xbf163f4f,0x3e9e3f73
.long 0x3f808000,0x3f16bf4f,0xbe9ebf73,0xbf73be9e,0xbf4f3f16,0xa5543f80,0x3f4f3f16,0x3f73be9e
.long 0x3f80,0x3f7dbe20,0xbe9ebf73,0xbf643ee8,0x3f163f4f,0x3f35bf35,0xbf4fbf16,0xbee83f64
.long 0x3f808000,0xbe20bf7d,0xbf733e9e,0x3ee83f64,0x3f4fbf16,0xbf35bf35,0xbf163f4f,0x3f643ee8
.long 0x3f80,0x3f16bf4f,0xbf733e9e,0x3f733e9e,0xbf16bf4f,0x3f80,0x3f16bf4f,0xbf733e9e
.long 0x3f808000,0xbf4fbf16,0x3e9e3f73,0x3e9ebf73,0xbf4f3f16,0x3f808000,0xbf4fbf16,0x3e9e3f73
.long 0x3f80,0xbe20bf7d,0x3e9e3f73,0xbee8bf64,0x3f163f4f,0xbf35bf35,0x3f4f3f16,0xbf64bee8
.long 0x3f808000,0xbf7d3e20,0x3f73be9e,0xbf643ee8,0x3f4fbf16,0xbf353f35,0x3f16bf4f,0xbee83f64
.long 0x3f80,0xbf4fbf16,0x3f73be9e,0xbe9e3f73,0xbf16bf4f,0x3f80248d,0xbf163f4f,0xbe9ebf73
.long 0x3f808000,0xbf163f4f,0xbe9ebf73,0x3f733e9e,0xbf4f3f16,0x248dbf80,0x3f4f3f16,0xbf733e9e
.long 0x3f80,0xbf7d3e20,0xbe9ebf73,0x3f64bee8,0x3f163f4f,0xbf353f35,0xbf4fbf16,0x3ee8bf64
.long 0x3f808000,0x3e203f7d,0xbf733e9e,0xbee8bf64,0x3f4fbf16,0x3f353f35,0xbf163f4f,0xbf64bee8
.long 0x3f80,0xbf163f4f,0xbf733e9e,0xbf73be9e,0xbf16bf4f,0x250dbf80,0x3f16bf4f,0x3f73be9e
.long 0x3f808000,0x3f4f3f16,0x3e9e3f73,0xbe9e3f73,0xbf4f3f16,0xbf80a50d,0xbf4fbf16,0xbe9ebf73
.long 0x3f80,0x3e2a3f7c,0x3ea83f72,0x3ef63f61,0x3f1e3f49,0x3f3e3f2c,0x3f583f0a,0x3f6c3ec9
.long 0x3f808000,0x3f7cbe2a,0x3f72bea8,0x3f61bef6,0x3f49bf1e,0x3f2cbf3e,0x3f0abf58,0x3ec9bf6c
.long 0x3f80,0x3f513f14,0x3f72bea8,0x3e90bf76,0xbf1ebf49,0xbf803d49,0xbf0a3f58,0x3ebf3f6d
.long 0x3f808000,0x3f14bf51,0xbea8bf72,0xbf76be90,0xbf493f1e,0x3d493f80,0x3f583f0a,0x3f6dbebf
.long 0x3f80,0x3f7cbe2a,0xbea8bf72,0xbf613ef6,0x3f1e3f49,0x3f2cbf3e,0xbf58bf0a,0xbec93f6c
.long 0x3f808000,0xbe2abf7c,0xbf723ea8,0x3ef63f61,0x3f49bf1e,0xbf3ebf2c,0xbf0a3f58,0x3f6c3ec9
.long 0x3f80,0x3f14bf51,0xbf723ea8,0x3f763e90,0xbf1ebf49,0x3d493f80,0x3f0abf58,0xbf6d3ebf
.long 0x3f808000,0xbf51bf14,0x3ea83f72,0x3e90bf76,0xbf493f1e,0x3f80bd49,0xbf58bf0a,0x3ebf3f6d
.long 0x3f80,0xbe2abf7c,0x3ea83f72,0xbef6bf61,0x3f1e3f49,0xbf3ebf2c,0x3f583f0a,0xbf6cbec9
.long 0x3f808000,0xbf7c3e2a,0x3f72bea8,0xbf613ef6,0x3f49bf1e,0xbf2c3f3e,0x3f0abf58,0xbec93f6c
.long 0x3f80,0xbf51bf14,0x3f72bea8,0xbe903f76,0xbf1ebf49,0x3f80bd49,0xbf0a3f58,0xbebfbf6d
.long 0x3f808000,0xbf143f51,0xbea8bf72,0x3f763e90,0xbf493f1e,0xbd49bf80,0x3f583f0a,0xbf6d3ebf
.long 0x3f80,0xbf7c3e2a,0xbea8bf72,0x3f61bef6,0x3f1e3f49,0xbf2c3f3e,0xbf58bf0a,0x3ec9bf6c
.long 0x3f808000,0x3e2a3f7c,0xbf723ea8,0xbef6bf61,0x3f49bf1e,0x3f3e3f2c,0xbf0a3f58,0xbf6cbec9
.long 0x3f80,0xbf143f51,0xbf723ea8,0xbf76be90,0xbf1ebf49,0xbd49bf80,0x3f0abf58,0x3f6dbebf
.long 0x3f808000,0x3f513f14,0x3ea83f72,0xbe903f76,0xbf493f1e,0xbf803d49,0xbf58bf0a,0xbebfbf6d
.long 0x3f80,0x3e343f7c,0x3eb13f70,0x3f013f5d,0x3f263f43,0x3f463f22,0x3f5f3efa,0x3f723ea8
.long 0x3f808000,0x3f7cbe34,0x3f70beb1,0x3f5dbf01,0x3f43bf26,0x3f22bf46,0x3efabf5f,0x3ea8bf72
.long 0x3f80,0x3f523f12,0x3f70beb1,0x3e81bf78,0xbf26bf43,0xbf7f3dc9,0xbefa3f5f,0x3edf3f66
.long 0x3f808000,0x3f12bf52,0xbeb1bf70,0xbf78be81,0xbf433f26,0x3dc93f7f,0x3f5f3efa,0x3f66bedf
.long 0x3f80,0x3f7cbe34,0xbeb1bf70,0xbf5d3f01,0x3f263f43,0x3f22bf46,0xbf5fbefa,0xbea83f72
.long 0x3f808000,0xbe34bf7c,0xbf703eb1,0x3f013f5d,0x3f43bf26,0xbf46bf22,0xbefa3f5f,0x3f723ea8
.long 0x3f80,0x3f12bf52,0xbf703eb1,0x3f783e81,0xbf26bf43,0x3dc93f7f,0x3efabf5f,0xbf663edf
.long 0x3f808000,0xbf52bf12,0x3eb13f70,0x3e81bf78,0xbf433f26,0x3f7fbdc9,0xbf5fbefa,0x3edf3f66
.long 0x3f80,0xbe34bf7c,0x3eb13f70,0xbf01bf5d,0x3f263f43,0xbf46bf22,0x3f5f3efa,0xbf72bea8
.long 0x3f808000,0xbf7c3e34,0x3f70beb1,0xbf5d3f01,0x3f43bf26,0xbf223f46,0x3efabf5f,0xbea83f72
.long 0x3f80,0xbf52bf12,0x3f70beb1,0xbe813f78,0xbf26bf43,0x3f7fbdc9,0xbefa3f5f,0xbedfbf66
.long 0x3f808000,0xbf123f52,0xbeb1bf70,0x3f783e81,0xbf433f26,0xbdc9bf7f,0x3f5f3efa,0xbf663edf
.long 0x3f80,0xbf7c3e34,0xbeb1bf70,0x3f5dbf01,0x3f263f43,0xbf223f46,0xbf5fbefa,0x3ea8bf72
.long 0x3f808000,0x3e343f7c,0xbf703eb1,0xbf01bf5d,0x3f43bf26,0x3f463f22,0xbefa3f5f,0xbf72bea8
.long 0x3f80,0xbf123f52,0xbf703eb1,0xbf78be81,0xbf26bf43,0xbdc9bf7f,0x3efabf5f,0x3f66bedf
.long 0x3f808000,0x3f523f12,0x3eb13f70,0xbe813f78,0xbf433f26,0xbf7f3dc9,0xbf5fbefa,0xbedfbf66
.long 0x3f80,0x3e3e3f7c,0x3ebb3f6e,0x3f083f59,0x3f2e3f3c,0x3f4e3f18,0x3f663edf,0x3f773e86
.long 0x3f808000,0x3f7cbe3e,0x3f6ebebb,0x3f59bf08,0x3f3cbf2e,0x3f18bf4e,0x3edfbf66,0x3e86bf77
.long 0x3f80,0x3f533f10,0x3f6ebebb,0x3e65bf7a,0xbf2ebf3c,0xbf7d3e16,0xbedf3f66,0x3eff3f5e
.long 0x3f808000,0x3f10bf53,0xbebbbf6e,0xbf7abe65,0xbf3c3f2e,0x3e163f7d,0x3f663edf,0x3f5ebeff
.long 0x3f80,0x3f7cbe3e,0xbebbbf6e,0xbf593f08,0x3f2e3f3c,0x3f18bf4e,0xbf66bedf,0xbe863f77
.long 0x3f808000,0xbe3ebf7c,0xbf6e3ebb,0x3f083f59,0x3f3cbf2e,0xbf4ebf18,0xbedf3f66,0x3f773e86
.long 0x3f80,0x3f10bf53,0xbf6e3ebb,0x3f7a3e65,0xbf2ebf3c,0x3e163f7d,0x3edfbf66,0xbf5e3eff
.long 0x3f808000,0xbf53bf10,0x3ebb3f6e,0x3e65bf7a,0xbf3c3f2e,0x3f7dbe16,0xbf66bedf,0x3eff3f5e
.long 0x3f80,0xbe3ebf7c,0x3ebb3f6e,0xbf08bf59,0x3f2e3f3c,0xbf4ebf18,0x3f663edf,0xbf77be86
.long 0x3f808000,0xbf7c3e3e,0x3f6ebebb,0xbf593f08,0x3f3cbf2e,0xbf183f4e,0x3edfbf66,0xbe863f77
.long 0x3f80,0xbf53bf10,0x3f6ebebb,0xbe653f7a,0xbf2ebf3c,0x3f7dbe16,0xbedf3f66,0xbeffbf5e
.long 0x3f808000,0xbf103f53,0xbebbbf6e,0x3f7a3e65,0xbf3c3f2e,0xbe16bf7d,0x3f663edf,0xbf5e3eff
.long 0x3f80,0xbf7c3e3e,0xbebbbf6e,0x3f59bf08,0x3f2e3f3c,0xbf183f4e,0xbf66bedf,0x3e86bf77
.long 0x3f808000,0x3e3e3f7c,0xbf6e3ebb,0xbf08bf59,0x3f3cbf2e,0x3f4e3f18,0xbedf3f66,0xbf77be86
.long 0x3f80,0xbf103f53,0xbf6e3ebb,0xbf7abe65,0xbf2ebf3c,0xbe16bf7d,0x3edfbf66,0x3f5ebeff
.long 0x3f808000,0x3f533f10,0x3ebb3f6e,0xbe653f7a,0xbf3c3f2e,0xbf7d3e16,0xbf66bedf,0xbeffbf5e
.long 0x3f80,0x3e483f7b,0x3ec43f6d,0x3f0e3f55,0x3f353f35,0x3f553f0e,0x3f6d3ec4,0x3f7b3e48
.long 0x3f808000,0x3f7bbe48,0x3f6dbec4,0x3f55bf0e,0x3f35bf35,0x3f0ebf55,0x3ec4bf6d,0x3e48bf7b
.long 0x3f80,0x3f553f0e,0x3f6dbec4,0x3e48bf7b,0xbf35bf35,0xbf7b3e48,0xbec43f6d,0x3f0e3f55
.long 0x3f808000,0x3f0ebf55,0xbec4bf6d,0xbf7bbe48,0xbf353f35,0x3e483f7b,0x3f6d3ec4,0x3f55bf0e
.long 0x3f80,0x3f7bbe48,0xbec4bf6d,0xbf553f0e,0x3f353f35,0x3f0ebf55,0xbf6dbec4,0xbe483f7b
.long 0x3f808000,0xbe48bf7b,0xbf6d3ec4,0x3f0e3f55,0x3f35bf35,0xbf55bf0e,0xbec43f6d,0x3f7b3e48
.long 0x3f80,0x3f0ebf55,0xbf6d3ec4,0x3f7b3e48,0xbf35bf35,0x3e483f7b,0x3ec4bf6d,0xbf553f0e
.long 0x3f808000,0xbf55bf0e,0x3ec43f6d,0x3e48bf7b,0xbf353f35,0x3f7bbe48,0xbf6dbec4,0x3f0e3f55
.long 0x3f80,0xbe48bf7b,0x3ec43f6d,0xbf0ebf55,0x3f353f35,0xbf55bf0e,0x3f6d3ec4,0xbf7bbe48
.long 0x3f808000,0xbf7b3e48,0x3f6dbec4,0xbf553f0e,0x3f35bf35,0xbf0e3f55,0x3ec4bf6d,0xbe483f7b
.long 0x3f80,0xbf55bf0e,0x3f6dbec4,0xbe483f7b,0xbf35bf35,0x3f7bbe48,0xbec43f6d,0xbf0ebf55
.long 0x3f808000,0xbf0e3f55,0xbec4bf6d,0x3f7b3e48,0xbf353f35,0xbe48bf7b,0x3f6d3ec4,0xbf553f0e
.long 0x3f80,0xbf7b3e48,0xbec4bf6d,0x3f55bf0e,0x3f353f35,0xbf0e3f55,0xbf6dbec4,0x3e48bf7b
.long 0x3f808000,0x3e483f7b,0xbf6d3ec4,0xbf0ebf55,0x3f35bf35,0x3f553f0e,0xbec43f6d,0xbf7bbe48
.long 0x3f80,0xbf0e3f55,0xbf6d3ec4,0xbf7bbe48,0xbf35bf35,0xbe48bf7b,0x3ec4bf6d,0x3f55bf0e
.long 0x3f808000,0x3f553f0e,0x3ec43f6d,0xbe483f7b,0xbf353f35,0xbf7b3e48,0xbf6dbec4,0xbf0ebf55
.long 0x3f80,0x3e523f7b,0x3ecd3f6b,0x3f143f51,0x3f3c3f2e,0x3f5c3f04,0x3f723ea8,0x3f7e3e02
.long 0x3f808000,0x3f7bbe52,0x3f6bbecd,0x3f51bf14,0x3f2ebf3c,0x3f04bf5c,0x3ea8bf72,0x3e02bf7e
.long 0x3f80,0x3f563f0c,0x3f6bbecd,0x3e2abf7c,0xbf3cbf2e,0xbf783e79,0xbea83f72,0x3f1d3f4b
.long 0x3f808000,0x3f0cbf56,0xbecdbf6b,0xbf7cbe2a,0xbf2e3f3c,0x3e793f78,0x3f723ea8,0x3f4bbf1d
.long 0x3f80,0x3f7bbe52,0xbecdbf6b,0xbf513f14,0x3f3c3f2e,0x3f04bf5c,0xbf72bea8,0xbe023f7e
.long 0x3f808000,0xbe52bf7b,0xbf6b3ecd,0x3f143f51,0x3f2ebf3c,0xbf5cbf04,0xbea83f72,0x3f7e3e02
.long 0x3f80,0x3f0cbf56,0xbf6b3ecd,0x3f7c3e2a,0xbf3cbf2e,0x3e793f78,0x3ea8bf72,0xbf4b3f1d
.long 0x3f808000,0xbf56bf0c,0x3ecd3f6b,0x3e2abf7c,0xbf2e3f3c,0x3f78be79,0xbf72bea8,0x3f1d3f4b
.long 0x3f80,0xbe52bf7b,0x3ecd3f6b,0xbf14bf51,0x3f3c3f2e,0xbf5cbf04,0x3f723ea8,0xbf7ebe02
.long 0x3f808000,0xbf7b3e52,0x3f6bbecd,0xbf513f14,0x3f2ebf3c,0xbf043f5c,0x3ea8bf72,0xbe023f7e
.long 0x3f80,0xbf56bf0c,0x3f6bbecd,0xbe2a3f7c,0xbf3cbf2e,0x3f78be79,0xbea83f72,0xbf1dbf4b
.long 0x3f808000,0xbf0c3f56,0xbecdbf6b,0x3f7c3e2a,0xbf2e3f3c,0xbe79bf78,0x3f723ea8,0xbf4b3f1d
.long 0x3f80,0xbf7b3e52,0xbecdbf6b,0x3f51bf14,0x3f3c3f2e,0xbf043f5c,0xbf72bea8,0x3e02bf7e
.long 0x3f808000,0x3e523f7b,0xbf6b3ecd,0xbf14bf51,0x3f2ebf3c,0x3f5c3f04,0xbea83f72,0xbf7ebe02
.long 0x3f80,0xbf0c3f56,0xbf6b3ecd,0xbf7cbe2a,0xbf3cbf2e,0xbe79bf78,0x3ea8bf72,0x3f4bbf1d
.long 0x3f808000,0x3f563f0c,0x3ecd3f6b,0xbe2a3f7c,0xbf2e3f3c,0xbf783e79,0xbf72bea8,0xbf1dbf4b
.long 0x3f80,0x3e5b3f7a,0x3ed63f68,0x3f1b3f4c,0x3f433f26,0x3f623ef1,0x3f763e8b,0x3f803d71
.long 0x3f808000,0x3f7abe5b,0x3f68bed6,0x3f4cbf1b,0x3f26bf43,0x3ef1bf62,0x3e8bbf76,0x3d71bf80
.long 0x3f80,0x3f583f0a,0x3f68bed6,0x3e0cbf7e,0xbf43bf26,0xbf753e95,0xbe8b3f76,0x3f2a3f3f
.long 0x3f808000,0x3f0abf58,0xbed6bf68,0xbf7ebe0c,0xbf263f43,0x3e953f75,0x3f763e8b,0x3f3fbf2a
.long 0x3f80,0x3f7abe5b,0xbed6bf68,0xbf4c3f1b,0x3f433f26,0x3ef1bf62,0xbf76be8b,0xbd713f80
.long 0x3f808000,0xbe5bbf7a,0xbf683ed6,0x3f1b3f4c,0x3f26bf43,0xbf62bef1,0xbe8b3f76,0x3f803d71
.long 0x3f80,0x3f0abf58,0xbf683ed6,0x3f7e3e0c,0xbf43bf26,0x3e953f75,0x3e8bbf76,0xbf3f3f2a
.long 0x3f808000,0xbf58bf0a,0x3ed63f68,0x3e0cbf7e,0xbf263f43,0x3f75be95,0xbf76be8b,0x3f2a3f3f
.long 0x3f80,0xbe5bbf7a,0x3ed63f68,0xbf1bbf4c,0x3f433f26,0xbf62bef1,0x3f763e8b,0xbf80bd71
.long 0x3f808000,0xbf7a3e5b,0x3f68bed6,0xbf4c3f1b,0x3f26bf43,0xbef13f62,0x3e8bbf76,0xbd713f80
.long 0x3f80,0xbf58bf0a,0x3f68bed6,0xbe0c3f7e,0xbf43bf26,0x3f75be95,0xbe8b3f76,0xbf2abf3f
.long 0x3f808000,0xbf0a3f58,0xbed6bf68,0x3f7e3e0c,0xbf263f43,0xbe95bf75,0x3f763e8b,0xbf3f3f2a
.long 0x3f80,0xbf7a3e5b,0xbed6bf68,0x3f4cbf1b,0x3f433f26,0xbef13f62,0xbf76be8b,0x3d71bf80
.long 0x3f808000,0x3e5b3f7a,0xbf683ed6,0xbf1bbf4c,0x3f26bf43,0x3f623ef1,0xbe8b3f76,0xbf80bd71
.long 0x3f80,0xbf0a3f58,0xbf683ed6,0xbf7ebe0c,0xbf43bf26,0xbe95bf75,0x3e8bbf76,0x3f3fbf2a
.long 0x3f808000,0x3f583f0a,0x3ed63f68,0xbe0c3f7e,0xbf263f43,0xbf753e95,0xbf76be8b,0xbf2abf3f
.long 0x3f80,0x3e653f7a,0x3edf3f66,0x3f203f47,0x3f493f1e,0x3f673edb,0x3f7a3e5b,0x3f80bc21
.long 0x3f808000,0x3f7abe65,0x3f66bedf,0x3f47bf20,0x3f1ebf49,0x3edbbf67,0x3e5bbf7a,0xbc21bf80
.long 0x3f80,0x3f593f08,0x3f66bedf,0x3dddbf7f,0xbf49bf1e,0xbf713eac,0xbe5b3f7a,0x3f373f33
.long 0x3f808000,0x3f08bf59,0xbedfbf66,0xbf7fbddd,0xbf1e3f49,0x3eac3f71,0x3f7a3e5b,0x3f33bf37
.long 0x3f80,0x3f7abe65,0xbedfbf66,0xbf473f20,0x3f493f1e,0x3edbbf67,0xbf7abe5b,0x3c213f80
.long 0x3f808000,0xbe65bf7a,0xbf663edf,0x3f203f47,0x3f1ebf49,0xbf67bedb,0xbe5b3f7a,0x3f80bc21
.long 0x3f80,0x3f08bf59,0xbf663edf,0x3f7f3ddd,0xbf49bf1e,0x3eac3f71,0x3e5bbf7a,0xbf333f37
.long 0x3f808000,0xbf59bf08,0x3edf3f66,0x3dddbf7f,0xbf1e3f49,0x3f71beac,0xbf7abe5b,0x3f373f33
.long 0x3f80,0xbe65bf7a,0x3edf3f66,0xbf20bf47,0x3f493f1e,0xbf67bedb,0x3f7a3e5b,0xbf803c21
.long 0x3f808000,0xbf7a3e65,0x3f66bedf,0xbf473f20,0x3f1ebf49,0xbedb3f67,0x3e5bbf7a,0x3c213f80
.long 0x3f80,0xbf59bf08,0x3f66bedf,0xbddd3f7f,0xbf49bf1e,0x3f71beac,0xbe5b3f7a,0xbf37bf33
.long 0x3f808000,0xbf083f59,0xbedfbf66,0x3f7f3ddd,0xbf1e3f49,0xbeacbf71,0x3f7a3e5b,0xbf333f37
.long 0x3f80,0xbf7a3e65,0xbedfbf66,0x3f47bf20,0x3f493f1e,0xbedb3f67,0xbf7abe5b,0xbc21bf80
.long 0x3f808000,0x3e653f7a,0xbf663edf,0xbf20bf47,0x3f1ebf49,0x3f673edb,0xbe5b3f7a,0xbf803c21
.long 0x3f80,0xbf083f59,0xbf663edf,0xbf7fbddd,0xbf49bf1e,0xbeacbf71,0x3e5bbf7a,0x3f33bf37
.long 0x3f808000,0x3f593f08,0x3edf3f66,0xbddd3f7f,0xbf1e3f49,0xbf713eac,0xbf7abe5b,0xbf37bf33
.long 0x3f80,0x3e6f3f79,0x3ee83f64,0x3f263f43,0x3f4f3f16,0x3f6d3ec4,0x3f7d3e20,0x3f7fbda1
.long 0x3f808000,0x3f79be6f,0x3f64bee8,0x3f43bf26,0x3f16bf4f,0x3ec4bf6d,0x3e20bf7d,0xbda1bf7f
.long 0x3f80,0x3f5a3f06,0x3f64bee8,0x3da1bf7f,0xbf4fbf16,0xbf6d3ec4,0xbe203f7d,0x3f433f26
.long 0x3f808000,0x3f06bf5a,0xbee8bf64,0xbf7fbda1,0xbf163f4f,0x3ec43f6d,0x3f7d3e20,0x3f26bf43
.long 0x3f80,0x3f79be6f,0xbee8bf64,0xbf433f26,0x3f4f3f16,0x3ec4bf6d,0xbf7dbe20,0x3da13f7f
.long 0x3f808000,0xbe6fbf79,0xbf643ee8,0x3f263f43,0x3f16bf4f,0xbf6dbec4,0xbe203f7d,0x3f7fbda1
.long 0x3f80,0x3f06bf5a,0xbf643ee8,0x3f7f3da1,0xbf4fbf16,0x3ec43f6d,0x3e20bf7d,0xbf263f43
.long 0x3f808000,0xbf5abf06,0x3ee83f64,0x3da1bf7f,0xbf163f4f,0x3f6dbec4,0xbf7dbe20,0x3f433f26
.long 0x3f80,0xbe6fbf79,0x3ee83f64,0xbf26bf43,0x3f4f3f16,0xbf6dbec4,0x3f7d3e20,0xbf7f3da1
.long 0x3f808000,0xbf793e6f,0x3f64bee8,0xbf433f26,0x3f16bf4f,0xbec43f6d,0x3e20bf7d,0x3da13f7f
.long 0x3f80,0xbf5abf06,0x3f64bee8,0xbda13f7f,0xbf4fbf16,0x3f6dbec4,0xbe203f7d,0xbf43bf26
.long 0x3f808000,0xbf063f5a,0xbee8bf64,0x3f7f3da1,0xbf163f4f,0xbec4bf6d,0x3f7d3e20,0xbf263f43
.long 0x3f80,0xbf793e6f,0xbee8bf64,0x3f43bf26,0x3f4f3f16,0xbec43f6d,0xbf7dbe20,0xbda1bf7f
.long 0x3f808000,0x3e6f3f79,0xbf643ee8,0xbf26bf43,0x3f16bf4f,0x3f6d3ec4,0xbe203f7d,0xbf7f3da1
.long 0x3f80,0xbf063f5a,0xbf643ee8,0xbf7fbda1,0xbf4fbf16,0xbec4bf6d,0x3e20bf7d,0x3f26bf43
.long 0x3f808000,0x3f5a3f06,0x3ee83f64,0xbda13f7f,0xbf163f4f,0xbf6d3ec4,0xbf7dbe20,0xbf43bf26
.long 0x3f80,0x3e793f78,0x3ef13f62,0x3f2c3f3e,0x3f553f0e,0x3f713eac,0x3f7f3dc9,0x3f7dbe16
.long 0x3f808000,0x3f78be79,0x3f62bef1,0x3f3ebf2c,0x3f0ebf55,0x3eacbf71,0x3dc9bf7f,0xbe16bf7d
.long 0x3f80,0x3f5c3f04,0x3f62bef1,0x3d49bf80,0xbf55bf0e,0xbf673edb,0xbdc93f7f,0x3f4e3f18
.long 0x3f808000,0x3f04bf5c,0xbef1bf62,0xbf80bd49,0xbf0e3f55,0x3edb3f67,0x3f7f3dc9,0x3f18bf4e
.long 0x3f80,0x3f78be79,0xbef1bf62,0xbf3e3f2c,0x3f553f0e,0x3eacbf71,0xbf7fbdc9,0x3e163f7d
.long 0x3f808000,0xbe79bf78,0xbf623ef1,0x3f2c3f3e,0x3f0ebf55,0xbf71beac,0xbdc93f7f,0x3f7dbe16
.long 0x3f80,0x3f04bf5c,0xbf623ef1,0x3f803d49,0xbf55bf0e,0x3edb3f67,0x3dc9bf7f,0xbf183f4e
.long 0x3f808000,0xbf5cbf04,0x3ef13f62,0x3d49bf80,0xbf0e3f55,0x3f67bedb,0xbf7fbdc9,0x3f4e3f18
.long 0x3f80,0xbe79bf78,0x3ef13f62,0xbf2cbf3e,0x3f553f0e,0xbf71beac,0x3f7f3dc9,0xbf7d3e16
.long 0x3f808000,0xbf783e79,0x3f62bef1,0xbf3e3f2c,0x3f0ebf55,0xbeac3f71,0x3dc9bf7f,0x3e163f7d
.long 0x3f80,0xbf5cbf04,0x3f62bef1,0xbd493f80,0xbf55bf0e,0x3f67bedb,0xbdc93f7f,0xbf4ebf18
.long 0x3f808000,0xbf043f5c,0xbef1bf62,0x3f803d49,0xbf0e3f55,0xbedbbf67,0x3f7f3dc9,0xbf183f4e
.long 0x3f80,0xbf783e79,0xbef1bf62,0x3f3ebf2c,0x3f553f0e,0xbeac3f71,0xbf7fbdc9,0xbe16bf7d
.long 0x3f808000,0x3e793f78,0xbf623ef1,0xbf2cbf3e,0x3f0ebf55,0x3f713eac,0xbdc93f7f,0xbf7d3e16
.long 0x3f80,0xbf043f5c,0xbf623ef1,0xbf80bd49,0xbf55bf0e,0xbedbbf67,0x3dc9bf7f,0x3f18bf4e
.long 0x3f808000,0x3f5c3f04,0x3ef13f62,0xbd493f80,0xbf0e3f55,0xbf673edb,0xbf7fbdc9,0xbf4ebf18
.long 0x3f80,0x3e813f78,0x3efa3f5f,0x3f313f39,0x3f5a3f06,0x3f753e95,0x3f803d21,0x3f7abe5b
.long 0x3f808000,0x3f78be81,0x3f5fbefa,0x3f39bf31,0x3f06bf5a,0x3e95bf75,0x3d21bf80,0xbe5bbf7a
.long 0x3f80,0x3f5d3f01,0x3f5fbefa,0x3ca1bf80,0xbf5abf06,0xbf623ef1,0xbd213f80,0x3f583f0a
.long 0x3f808000,0x3f01bf5d,0xbefabf5f,0xbf80bca1,0xbf063f5a,0x3ef13f62,0x3f803d21,0x3f0abf58
.long 0x3f80,0x3f78be81,0xbefabf5f,0xbf393f31,0x3f5a3f06,0x3e95bf75,0xbf80bd21,0x3e5b3f7a
.long 0x3f808000,0xbe81bf78,0xbf5f3efa,0x3f313f39,0x3f06bf5a,0xbf75be95,0xbd213f80,0x3f7abe5b
.long 0x3f80,0x3f01bf5d,0xbf5f3efa,0x3f803ca1,0xbf5abf06,0x3ef13f62,0x3d21bf80,0xbf0a3f58
.long 0x3f808000,0xbf5dbf01,0x3efa3f5f,0x3ca1bf80,0xbf063f5a,0x3f62bef1,0xbf80bd21,0x3f583f0a
.long 0x3f80,0xbe81bf78,0x3efa3f5f,0xbf31bf39,0x3f5a3f06,0xbf75be95,0x3f803d21,0xbf7a3e5b
.long 0x3f808000,0xbf783e81,0x3f5fbefa,0xbf393f31,0x3f06bf5a,0xbe953f75,0x3d21bf80,0x3e5b3f7a
.long 0x3f80,0xbf5dbf01,0x3f5fbefa,0xbca13f80,0xbf5abf06,0x3f62bef1,0xbd213f80,0xbf58bf0a
.long 0x3f808000,0xbf013f5d,0xbefabf5f,0x3f803ca1,0xbf063f5a,0xbef1bf62,0x3f803d21,0xbf0a3f58
.long 0x3f80,0xbf783e81,0xbefabf5f,0x3f39bf31,0x3f5a3f06,0xbe953f75,0xbf80bd21,0xbe5bbf7a
.long 0x3f808000,0x3e813f78,0xbf5f3efa,0xbf31bf39,0x3f06bf5a,0x3f753e95,0xbd213f80,0xbf7a3e5b
.long 0x3f80,0xbf013f5d,0xbf5f3efa,0xbf80bca1,0xbf5abf06,0xbef1bf62,0x3d21bf80,0x3f0abf58
.long 0x3f808000,0x3f5d3f01,0x3efa3f5f,0xbca13f80,0xbf063f5a,0xbf623ef1,0xbf80bd21,0xbf58bf0a
.long 0x3f80,0x3e863f77,0x3f013f5d,0x3f373f33,0x3f5f3efa,0x3f783e79,0x3f80bca1,0x3f76be90
.long 0x3f808000,0x3f77be86,0x3f5dbf01,0x3f33bf37,0x3efabf5f,0x3e79bf78,0xbca1bf80,0xbe90bf76
.long 0x3f80,0x3f5e3eff,0x3f5dbf01,0xbc21bf80,0xbf5fbefa,0xbf5c3f04,0x3ca13f80,0x3f613ef6
.long 0x3f808000,0x3effbf5e,0xbf01bf5d,0xbf803c21,0xbefa3f5f,0x3f043f5c,0x3f80bca1,0x3ef6bf61
.long 0x3f80,0x3f77be86,0xbf01bf5d,0xbf333f37,0x3f5f3efa,0x3e79bf78,0xbf803ca1,0x3e903f76
.long 0x3f808000,0xbe86bf77,0xbf5d3f01,0x3f373f33,0x3efabf5f,0xbf78be79,0x3ca13f80,0x3f76be90
.long 0x3f80,0x3effbf5e,0xbf5d3f01,0x3f80bc21,0xbf5fbefa,0x3f043f5c,0xbca1bf80,0xbef63f61
.long 0x3f808000,0xbf5ebeff,0x3f013f5d,0xbc21bf80,0xbefa3f5f,0x3f5cbf04,0xbf803ca1,0x3f613ef6
.long 0x3f80,0xbe86bf77,0x3f013f5d,0xbf37bf33,0x3f5f3efa,0xbf78be79,0x3f80bca1,0xbf763e90
.long 0x3f808000,0xbf773e86,0x3f5dbf01,0xbf333f37,0x3efabf5f,0xbe793f78,0xbca1bf80,0x3e903f76
.long 0x3f80,0xbf5ebeff,0x3f5dbf01,0x3c213f80,0xbf5fbefa,0x3f5cbf04,0x3ca13f80,0xbf61bef6
.long 0x3f808000,0xbeff3f5e,0xbf01bf5d,0x3f80bc21,0xbefa3f5f,0xbf04bf5c,0x3f80bca1,0xbef63f61
.long 0x3f80,0xbf773e86,0xbf01bf5d,0x3f33bf37,0x3f5f3efa,0xbe793f78,0xbf803ca1,0xbe90bf76
.long 0x3f808000,0x3e863f77,0xbf5d3f01,0xbf37bf33,0x3efabf5f,0x3f783e79,0x3ca13f80,0xbf763e90
.long 0x3f80,0xbeff3f5e,0xbf5d3f01,0xbf803c21,0xbf5fbefa,0xbf04bf5c,0xbca1bf80,0x3ef6bf61
.long 0x3f808000,0x3f5e3eff,0x3f013f5d,0x3c213f80,0xbefa3f5f,0xbf5c3f04,0xbf803ca1,0xbf61bef6
.long 0x3f80,0x3e8b3f76,0x3f063f5a,0x3f3c3f2e,0x3f643ee8,0x3f7b3e48,0x3f7fbda1,0x3f70beb1
.long 0x3f808000,0x3f76be8b,0x3f5abf06,0x3f2ebf3c,0x3ee8bf64,0x3e48bf7b,0xbda1bf7f,0xbeb1bf70
.long 0x3f80,0x3f5f3efa,0x3f5abf06,0xbd21bf80,0xbf64bee8,0xbf553f0e,0x3da13f7f,0x3f683ed6
.long 0x3f808000,0x3efabf5f,0xbf06bf5a,0xbf803d21,0xbee83f64,0x3f0e3f55,0x3f7fbda1,0x3ed6bf68
.long 0x3f80,0x3f76be8b,0xbf06bf5a,0xbf2e3f3c,0x3f643ee8,0x3e48bf7b,0xbf7f3da1,0x3eb13f70
.long 0x3f808000,0xbe8bbf76,0xbf5a3f06,0x3f3c3f2e,0x3ee8bf64,0xbf7bbe48,0x3da13f7f,0x3f70beb1
.long 0x3f80,0x3efabf5f,0xbf5a3f06,0x3f80bd21,0xbf64bee8,0x3f0e3f55,0xbda1bf7f,0xbed63f68
.long 0x3f808000,0xbf5fbefa,0x3f063f5a,0xbd21bf80,0xbee83f64,0x3f55bf0e,0xbf7f3da1,0x3f683ed6
.long 0x3f80,0xbe8bbf76,0x3f063f5a,0xbf3cbf2e,0x3f643ee8,0xbf7bbe48,0x3f7fbda1,0xbf703eb1
.long 0x3f808000,0xbf763e8b,0x3f5abf06,0xbf2e3f3c,0x3ee8bf64,0xbe483f7b,0xbda1bf7f,0x3eb13f70
.long 0x3f80,0xbf5fbefa,0x3f5abf06,0x3d213f80,0xbf64bee8,0x3f55bf0e,0x3da13f7f,0xbf68bed6
.long 0x3f808000,0xbefa3f5f,0xbf06bf5a,0x3f80bd21,0xbee83f64,0xbf0ebf55,0x3f7fbda1,0xbed63f68
.long 0x3f80,0xbf763e8b,0xbf06bf5a,0x3f2ebf3c,0x3f643ee8,0xbe483f7b,0xbf7f3da1,0xbeb1bf70
.long 0x3f808000,0x3e8b3f76,0xbf5a3f06,0xbf3cbf2e,0x3ee8bf64,0x3f7b3e48,0x3da13f7f,0xbf703eb1
.long 0x3f80,0xbefa3f5f,0xbf5a3f06,0xbf803d21,0xbf64bee8,0xbf0ebf55,0xbda1bf7f,0x3ed6bf68
.long 0x3f808000,0x3f5f3efa,0x3f063f5a,0x3d213f80,0xbee83f64,0xbf553f0e,0xbf7f3da1,0xbf68bed6
.long 0x3f80,0x3e903f76,0x3f0a3f58,0x3f413f28,0x3f683ed6,0x3f7d3e16,0x3f7ebe0c,0x3f6abed2
.long 0x3f808000,0x3f76be90,0x3f58bf0a,0x3f28bf41,0x3ed6bf68,0x3e16bf7d,0xbe0cbf7e,0xbed2bf6a
.long 0x3f80,0x3f613ef6,0x3f58bf0a,0xbd8dbf7f,0xbf68bed6,0xbf4e3f18,0x3e0c3f7e,0x3f6f3eb6
.long 0x3f808000,0x3ef6bf61,0xbf0abf58,0xbf7f3d8d,0xbed63f68,0x3f183f4e,0x3f7ebe0c,0x3eb6bf6f
.long 0x3f80,0x3f76be90,0xbf0abf58,0xbf283f41,0x3f683ed6,0x3e16bf7d,0xbf7e3e0c,0x3ed23f6a
.long 0x3f808000,0xbe90bf76,0xbf583f0a,0x3f413f28,0x3ed6bf68,0xbf7dbe16,0x3e0c3f7e,0x3f6abed2
.long 0x3f80,0x3ef6bf61,0xbf583f0a,0x3f7fbd8d,0xbf68bed6,0x3f183f4e,0xbe0cbf7e,0xbeb63f6f
.long 0x3f808000,0xbf61bef6,0x3f0a3f58,0xbd8dbf7f,0xbed63f68,0x3f4ebf18,0xbf7e3e0c,0x3f6f3eb6
.long 0x3f80,0xbe90bf76,0x3f0a3f58,0xbf41bf28,0x3f683ed6,0xbf7dbe16,0x3f7ebe0c,0xbf6a3ed2
.long 0x3f808000,0xbf763e90,0x3f58bf0a,0xbf283f41,0x3ed6bf68,0xbe163f7d,0xbe0cbf7e,0x3ed23f6a
.long 0x3f80,0xbf61bef6,0x3f58bf0a,0x3d8d3f7f,0xbf68bed6,0x3f4ebf18,0x3e0c3f7e,0xbf6fbeb6
.long 0x3f808000,0xbef63f61,0xbf0abf58,0x3f7fbd8d,0xbed63f68,0xbf18bf4e,0x3f7ebe0c,0xbeb63f6f
.long 0x3f80,0xbf763e90,0xbf0abf58,0x3f28bf41,0x3f683ed6,0xbe163f7d,0xbf7e3e0c,0xbed2bf6a
.long 0x3f808000,0x3e903f76,0xbf583f0a,0xbf41bf28,0x3ed6bf68,0x3f7d3e16,0x3e0c3f7e,0xbf6a3ed2
.long 0x3f80,0xbef63f61,0xbf583f0a,0xbf7f3d8d,0xbf68bed6,0xbf18bf4e,0xbe0cbf7e,0x3eb6bf6f
.long 0x3f808000,0x3f613ef6,0x3f0a3f58,0x3d8d3f7f,0xbed63f68,0xbf4e3f18,0xbf7e3e0c,0xbf6fbeb6
.long 0x3f80,0x3e953f75,0x3f0e3f55,0x3f463f22,0x3f6d3ec4,0x3f7f3dc9,0x3f7bbe48,0x3f62bef1
.long 0x3f808000,0x3f75be95,0x3f55bf0e,0x3f22bf46,0x3ec4bf6d,0x3dc9bf7f,0xbe48bf7b,0xbef1bf62
.long 0x3f80,0x3f623ef1,0x3f55bf0e,0xbdc9bf7f,0xbf6dbec4,0xbf463f22,0x3e483f7b,0x3f753e95
.long 0x3f808000,0x3ef1bf62,0xbf0ebf55,0xbf7f3dc9,0xbec43f6d,0x3f223f46,0x3f7bbe48,0x3e95bf75
.long 0x3f80,0x3f75be95,0xbf0ebf55,0xbf223f46,0x3f6d3ec4,0x3dc9bf7f,0xbf7b3e48,0x3ef13f62
.long 0x3f808000,0xbe95bf75,0xbf553f0e,0x3f463f22,0x3ec4bf6d,0xbf7fbdc9,0x3e483f7b,0x3f62bef1
.long 0x3f80,0x3ef1bf62,0xbf553f0e,0x3f7fbdc9,0xbf6dbec4,0x3f223f46,0xbe48bf7b,0xbe953f75
.long 0x3f808000,0xbf62bef1,0x3f0e3f55,0xbdc9bf7f,0xbec43f6d,0x3f46bf22,0xbf7b3e48,0x3f753e95
.long 0x3f80,0xbe95bf75,0x3f0e3f55,0xbf46bf22,0x3f6d3ec4,0xbf7fbdc9,0x3f7bbe48,0xbf623ef1
.long 0x3f808000,0xbf753e95,0x3f55bf0e,0xbf223f46,0x3ec4bf6d,0xbdc93f7f,0xbe48bf7b,0x3ef13f62
.long 0x3f80,0xbf62bef1,0x3f55bf0e,0x3dc93f7f,0xbf6dbec4,0x3f46bf22,0x3e483f7b,0xbf75be95
.long 0x3f808000,0xbef13f62,0xbf0ebf55,0x3f7fbdc9,0xbec43f6d,0xbf22bf46,0x3f7bbe48,0xbe953f75
.long 0x3f80,0xbf753e95,0xbf0ebf55,0x3f22bf46,0x3f6d3ec4,0xbdc93f7f,0xbf7b3e48,0xbef1bf62
.long 0x3f808000,0x3e953f75,0xbf553f0e,0xbf46bf22,0x3ec4bf6d,0x3f7f3dc9,0x3e483f7b,0xbf623ef1
.long 0x3f80,0xbef13f62,0xbf553f0e,0xbf7f3dc9,0xbf6dbec4,0xbf22bf46,0xbe48bf7b,0x3e95bf75
.long 0x3f808000,0x3f623ef1,0x3f0e3f55,0x3dc93f7f,0xbec43f6d,0xbf463f22,0xbf7b3e48,0xbf75be95
.long 0x3f80,0x3e993f74,0x3f123f52,0x3f4b3f1d,0x3f703eb1,0x3f803d49,0x3f78be81,0x3f59bf08
.long 0x3f808000,0x3f74be99,0x3f52bf12,0x3f1dbf4b,0x3eb1bf70,0x3d49bf80,0xbe81bf78,0xbf08bf59
.long 0x3f80,0x3f633eed,0x3f52bf12,0xbe02bf7e,0xbf70beb1,0xbf3e3f2c,0x3e813f78,0x3f7a3e65
.long 0x3f808000,0x3eedbf63,0xbf12bf52,0xbf7e3e02,0xbeb13f70,0x3f2c3f3e,0x3f78be81,0x3e65bf7a
.long 0x3f80,0x3f74be99,0xbf12bf52,0xbf1d3f4b,0x3f703eb1,0x3d49bf80,0xbf783e81,0x3f083f59
.long 0x3f808000,0xbe99bf74,0xbf523f12,0x3f4b3f1d,0x3eb1bf70,0xbf80bd49,0x3e813f78,0x3f59bf08
.long 0x3f80,0x3eedbf63,0xbf523f12,0x3f7ebe02,0xbf70beb1,0x3f2c3f3e,0xbe81bf78,0xbe653f7a
.long 0x3f808000,0xbf63beed,0x3f123f52,0xbe02bf7e,0xbeb13f70,0x3f3ebf2c,0xbf783e81,0x3f7a3e65
.long 0x3f80,0xbe99bf74,0x3f123f52,0xbf4bbf1d,0x3f703eb1,0xbf80bd49,0x3f78be81,0xbf593f08
.long 0x3f808000,0xbf743e99,0x3f52bf12,0xbf1d3f4b,0x3eb1bf70,0xbd493f80,0xbe81bf78,0x3f083f59
.long 0x3f80,0xbf63beed,0x3f52bf12,0x3e023f7e,0xbf70beb1,0x3f3ebf2c,0x3e813f78,0xbf7abe65
.long 0x3f808000,0xbeed3f63,0xbf12bf52,0x3f7ebe02,0xbeb13f70,0xbf2cbf3e,0x3f78be81,0xbe653f7a
.long 0x3f80,0xbf743e99,0xbf12bf52,0x3f1dbf4b,0x3f703eb1,0xbd493f80,0xbf783e81,0xbf08bf59
.long 0x3f808000,0x3e993f74,0xbf523f12,0xbf4bbf1d,0x3eb1bf70,0x3f803d49,0x3e813f78,0xbf593f08
.long 0x3f80,0xbeed3f63,0xbf523f12,0xbf7e3e02,0xbf70beb1,0xbf2cbf3e,0xbe81bf78,0x3e65bf7a
.long 0x3f808000,0x3f633eed,0x3f123f52,0x3e023f7e,0xbeb13f70,0xbf3e3f2c,0xbf783e81,0xbf7abe65
.long 0x3f80,0x3e9e3f73,0x3f163f4f,0x3f4f3f16,0x3f733e9e,0x3f80248d,0x3f73be9e,0x3f4fbf16
.long 0x3f808000,0x3f73be9e,0x3f4fbf16,0x3f16bf4f,0x3e9ebf73,0x248dbf80,0xbe9ebf73,0xbf16bf4f
.long 0x3f80,0x3f643ee8,0x3f4fbf16,0xbe20bf7d,0xbf73be9e,0xbf353f35,0x3e9e3f73,0x3f7d3e20
.long 0x3f808000,0x3ee8bf64,0xbf16bf4f,0xbf7d3e20,0xbe9e3f73,0x3f353f35,0x3f73be9e,0x3e20bf7d
.long 0x3f80,0x3f73be9e,0xbf16bf4f,0xbf163f4f,0x3f733e9e,0x250dbf80,0xbf733e9e,0x3f163f4f
.long 0x3f808000,0xbe9ebf73,0xbf4f3f16,0x3f4f3f16,0x3e9ebf73,0xbf80a50d,0x3e9e3f73,0x3f4fbf16
.long 0x3f80,0x3ee8bf64,0xbf4f3f16,0x3f7dbe20,0xbf73be9e,0x3f353f35,0xbe9ebf73,0xbe203f7d
.long 0x3f808000,0xbf64bee8,0x3f163f4f,0xbe20bf7d,0xbe9e3f73,0x3f35bf35,0xbf733e9e,0x3f7d3e20
.long 0x3f80,0xbe9ebf73,0x3f163f4f,0xbf4fbf16,0x3f733e9e,0xbf80a554,0x3f73be9e,0xbf4f3f16
.long 0x3f808000,0xbf733e9e,0x3f4fbf16,0xbf163f4f,0x3e9ebf73,0xa5543f80,0xbe9ebf73,0x3f163f4f
.long 0x3f80,0xbf64bee8,0x3f4fbf16,0x3e203f7d,0xbf73be9e,0x3f35bf35,0x3e9e3f73,0xbf7dbe20
.long 0x3f808000,0xbee83f64,0xbf16bf4f,0x3f7dbe20,0xbe9e3f73,0xbf35bf35,0x3f73be9e,0xbe203f7d
.long 0x3f80,0xbf733e9e,0xbf16bf4f,0x3f16bf4f,0x3f733e9e,0x3f80,0xbf733e9e,0xbf16bf4f
.long 0x3f808000,0x3e9e3f73,0xbf4f3f16,0xbf4fbf16,0x3e9ebf73,0x3f808000,0x3e9e3f73,0xbf4f3f16
.long 0x3f80,0xbee83f64,0xbf4f3f16,0xbf7d3e20,0xbf73be9e,0xbf35bf35,0xbe9ebf73,0x3e20bf7d
.long 0x3f808000,0x3f643ee8,0x3f163f4f,0x3e203f7d,0xbe9e3f73,0xbf353f35,0xbf733e9e,0xbf7dbe20
.long 0x3f80,0x3ea33f73,0x3f1b3f4c,0x3f533f10,0x3f763e8b,0x3f80bd49,0x3f6ebebb,0x3f44bf24
.long 0x3f808000,0x3f73bea3,0x3f4cbf1b,0x3f10bf53,0x3e8bbf76,0xbd49bf80,0xbebbbf6e,0xbf24bf44
.long 0x3f80,0x3f653ee4,0x3f4cbf1b,0xbe3ebf7c,0xbf76be8b,0xbf2c3f3e,0x3ebb3f6e,0x3f7f3db5
.long 0x3f808000,0x3ee4bf65,0xbf1bbf4c,0xbf7c3e3e,0xbe8b3f76,0x3f3e3f2c,0x3f6ebebb,0x3db5bf7f
.long 0x3f80,0x3f73bea3,0xbf1bbf4c,0xbf103f53,0x3f763e8b,0xbd49bf80,0xbf6e3ebb,0x3f243f44
.long 0x3f808000,0xbea3bf73,0xbf4c3f1b,0x3f533f10,0x3e8bbf76,0xbf803d49,0x3ebb3f6e,0x3f44bf24
.long 0x3f80,0x3ee4bf65,0xbf4c3f1b,0x3f7cbe3e,0xbf76be8b,0x3f3e3f2c,0xbebbbf6e,0xbdb53f7f
.long 0x3f808000,0xbf65bee4,0x3f1b3f4c,0xbe3ebf7c,0xbe8b3f76,0x3f2cbf3e,0xbf6e3ebb,0x3f7f3db5
.long 0x3f80,0xbea3bf73,0x3f1b3f4c,0xbf53bf10,0x3f763e8b,0xbf803d49,0x3f6ebebb,0xbf443f24
.long 0x3f808000,0xbf733ea3,0x3f4cbf1b,0xbf103f53,0x3e8bbf76,0x3d493f80,0xbebbbf6e,0x3f243f44
.long 0x3f80,0xbf65bee4,0x3f4cbf1b,0x3e3e3f7c,0xbf76be8b,0x3f2cbf3e,0x3ebb3f6e,0xbf7fbdb5
.long 0x3f808000,0xbee43f65,0xbf1bbf4c,0x3f7cbe3e,0xbe8b3f76,0xbf3ebf2c,0x3f6ebebb,0xbdb53f7f
.long 0x3f80,0xbf733ea3,0xbf1bbf4c,0x3f10bf53,0x3f763e8b,0x3d493f80,0xbf6e3ebb,0xbf24bf44
.long 0x3f808000,0x3ea33f73,0xbf4c3f1b,0xbf53bf10,0x3e8bbf76,0x3f80bd49,0x3ebb3f6e,0xbf443f24
.long 0x3f80,0xbee43f65,0xbf4c3f1b,0xbf7c3e3e,0xbf76be8b,0xbf3ebf2c,0xbebbbf6e,0x3db5bf7f
.long 0x3f808000,0x3f653ee4,0x3f1b3f4c,0x3e3e3f7c,0xbe8b3f76,0xbf2c3f3e,0xbf6e3ebb,0xbf7fbdb5
.long 0x3f80,0x3ea83f72,0x3f1e3f49,0x3f583f0a,0x3f793e6f,0x3f7fbdc9,0x3f68bed6,0x3f39bf31
.long 0x3f808000,0x3f72bea8,0x3f49bf1e,0x3f0abf58,0x3e6fbf79,0xbdc9bf7f,0xbed6bf68,0xbf31bf39
.long 0x3f80,0x3f663edf,0x3f49bf1e,0xbe5bbf7a,0xbf79be6f,0xbf223f46,0x3ed63f68,0x3f803ca1
.long 0x3f808000,0x3edfbf66,0xbf1ebf49,0xbf7a3e5b,0xbe6f3f79,0x3f463f22,0x3f68bed6,0x3ca1bf80
.long 0x3f80,0x3f72bea8,0xbf1ebf49,0xbf0a3f58,0x3f793e6f,0xbdc9bf7f,0xbf683ed6,0x3f313f39
.long 0x3f808000,0xbea8bf72,0xbf493f1e,0x3f583f0a,0x3e6fbf79,0xbf7f3dc9,0x3ed63f68,0x3f39bf31
.long 0x3f80,0x3edfbf66,0xbf493f1e,0x3f7abe5b,0xbf79be6f,0x3f463f22,0xbed6bf68,0xbca13f80
.long 0x3f808000,0xbf66bedf,0x3f1e3f49,0xbe5bbf7a,0xbe6f3f79,0x3f22bf46,0xbf683ed6,0x3f803ca1
.long 0x3f80,0xbea8bf72,0x3f1e3f49,0xbf58bf0a,0x3f793e6f,0xbf7f3dc9,0x3f68bed6,0xbf393f31
.long 0x3f808000,0xbf723ea8,0x3f49bf1e,0xbf0a3f58,0x3e6fbf79,0x3dc93f7f,0xbed6bf68,0x3f313f39
.long 0x3f80,0xbf66bedf,0x3f49bf1e,0x3e5b3f7a,0xbf79be6f,0x3f22bf46,0x3ed63f68,0xbf80bca1
.long 0x3f808000,0xbedf3f66,0xbf1ebf49,0x3f7abe5b,0xbe6f3f79,0xbf46bf22,0x3f68bed6,0xbca13f80
.long 0x3f80,0xbf723ea8,0xbf1ebf49,0x3f0abf58,0x3f793e6f,0x3dc93f7f,0xbf683ed6,0xbf31bf39
.long 0x3f808000,0x3ea83f72,0xbf493f1e,0xbf58bf0a,0x3e6fbf79,0x3f7fbdc9,0x3ed63f68,0xbf393f31
.long 0x3f80,0xbedf3f66,0xbf493f1e,0xbf7a3e5b,0xbf79be6f,0xbf46bf22,0xbed6bf68,0x3ca1bf80
.long 0x3f808000,0x3f663edf,0x3f1e3f49,0x3e5b3f7a,0xbe6f3f79,0xbf223f46,0xbf683ed6,0xbf80bca1
.long 0x3f80,0x3eac3f71,0x3f223f46,0x3f5c3f04,0x3f7b3e48,0x3f7dbe16,0x3f62bef1,0x3f2cbf3e
.long 0x3f808000,0x3f71beac,0x3f46bf22,0x3f04bf5c,0x3e48bf7b,0xbe16bf7d,0xbef1bf62,0xbf3ebf2c
.long 0x3f80,0x3f673edb,0x3f46bf22,0xbe79bf78,0xbf7bbe48,0xbf183f4e,0x3ef13f62,0x3f80bd49
.long 0x3f808000,0x3edbbf67,0xbf22bf46,0xbf783e79,0xbe483f7b,0x3f4e3f18,0x3f62bef1,0xbd49bf80
.long 0x3f80,0x3f71beac,0xbf22bf46,0xbf043f5c,0x3f7b3e48,0xbe16bf7d,0xbf623ef1,0x3f3e3f2c
.long 0x3f808000,0xbeacbf71,0xbf463f22,0x3f5c3f04,0x3e48bf7b,0xbf7d3e16,0x3ef13f62,0x3f2cbf3e
.long 0x3f80,0x3edbbf67,0xbf463f22,0x3f78be79,0xbf7bbe48,0x3f4e3f18,0xbef1bf62,0x3d493f80
.long 0x3f808000,0xbf67bedb,0x3f223f46,0xbe79bf78,0xbe483f7b,0x3f18bf4e,0xbf623ef1,0x3f80bd49
.long 0x3f80,0xbeacbf71,0x3f223f46,0xbf5cbf04,0x3f7b3e48,0xbf7d3e16,0x3f62bef1,0xbf2c3f3e
.long 0x3f808000,0xbf713eac,0x3f46bf22,0xbf043f5c,0x3e48bf7b,0x3e163f7d,0xbef1bf62,0x3f3e3f2c
.long 0x3f80,0xbf67bedb,0x3f46bf22,0x3e793f78,0xbf7bbe48,0x3f18bf4e,0x3ef13f62,0xbf803d49
.long 0x3f808000,0xbedb3f67,0xbf22bf46,0x3f78be79,0xbe483f7b,0xbf4ebf18,0x3f62bef1,0x3d493f80
.long 0x3f80,0xbf713eac,0xbf22bf46,0x3f04bf5c,0x3f7b3e48,0x3e163f7d,0xbf623ef1,0xbf3ebf2c
.long 0x3f808000,0x3eac3f71,0xbf463f22,0xbf5cbf04,0x3e48bf7b,0x3f7dbe16,0x3ef13f62,0xbf2c3f3e
.long 0x3f80,0xbedb3f67,0xbf463f22,0xbf783e79,0xbf7bbe48,0xbf4ebf18,0xbef1bf62,0xbd49bf80
.long 0x3f808000,0x3f673edb,0x3f223f46,0x3e793f78,0xbe483f7b,0xbf183f4e,0xbf623ef1,0xbf803d49
.long 0x3f80,0x3eb13f70,0x3f263f43,0x3f5f3efa,0x3f7d3e20,0x3f7bbe48,0x3f5abf06,0x3f1ebf49
.long 0x3f808000,0x3f70beb1,0x3f43bf26,0x3efabf5f,0x3e20bf7d,0xbe48bf7b,0xbf06bf5a,0xbf49bf1e
.long 0x3f80,0x3f683ed6,0x3f43bf26,0xbe8bbf76,0xbf7dbe20,0xbf0e3f55,0x3f063f5a,0x3f7ebdf1
.long 0x3f808000,0x3ed6bf68,0xbf26bf43,0xbf763e8b,0xbe203f7d,0x3f553f0e,0x3f5abf06,0xbdf1bf7e
.long 0x3f80,0x3f70beb1,0xbf26bf43,0xbefa3f5f,0x3f7d3e20,0xbe48bf7b,0xbf5a3f06,0x3f493f1e
.long 0x3f808000,0xbeb1bf70,0xbf433f26,0x3f5f3efa,0x3e20bf7d,0xbf7b3e48,0x3f063f5a,0x3f1ebf49
.long 0x3f80,0x3ed6bf68,0xbf433f26,0x3f76be8b,0xbf7dbe20,0x3f553f0e,0xbf06bf5a,0x3df13f7e
.long 0x3f808000,0xbf68bed6,0x3f263f43,0xbe8bbf76,0xbe203f7d,0x3f0ebf55,0xbf5a3f06,0x3f7ebdf1
.long 0x3f80,0xbeb1bf70,0x3f263f43,0xbf5fbefa,0x3f7d3e20,0xbf7b3e48,0x3f5abf06,0xbf1e3f49
.long 0x3f808000,0xbf703eb1,0x3f43bf26,0xbefa3f5f,0x3e20bf7d,0x3e483f7b,0xbf06bf5a,0x3f493f1e
.long 0x3f80,0xbf68bed6,0x3f43bf26,0x3e8b3f76,0xbf7dbe20,0x3f0ebf55,0x3f063f5a,0xbf7e3df1
.long 0x3f808000,0xbed63f68,0xbf26bf43,0x3f76be8b,0xbe203f7d,0xbf55bf0e,0x3f5abf06,0x3df13f7e
.long 0x3f80,0xbf703eb1,0xbf26bf43,0x3efabf5f,0x3f7d3e20,0x3e483f7b,0xbf5a3f06,0xbf49bf1e
.long 0x3f808000,0x3eb13f70,0xbf433f26,0xbf5fbefa,0x3e20bf7d,0x3f7bbe48,0x3f063f5a,0xbf1e3f49
.long 0x3f80,0xbed63f68,0xbf433f26,0xbf763e8b,0xbf7dbe20,0xbf55bf0e,0xbf06bf5a,0xbdf1bf7e
.long 0x3f808000,0x3f683ed6,0x3f263f43,0x3e8b3f76,0xbe203f7d,0xbf0e3f55,0xbf5a3f06,0xbf7e3df1
.long 0x3f80,0x3eb63f6f,0x3f2a3f3f,0x3f633eed,0x3f7e3df1,0x3f78be79,0x3f52bf12,0x3f10bf53
.long 0x3f808000,0x3f6fbeb6,0x3f3fbf2a,0x3eedbf63,0x3df1bf7e,0xbe79bf78,0xbf12bf52,0xbf53bf10
.long 0x3f80,0x3f6a3ed2,0x3f3fbf2a,0xbe99bf74,0xbf7ebdf1,0xbf043f5c,0x3f123f52,0x3f7cbe3e
.long 0x3f808000,0x3ed2bf6a,0xbf2abf3f,0xbf743e99,0xbdf13f7e,0x3f5c3f04,0x3f52bf12,0xbe3ebf7c
.long 0x3f80,0x3f6fbeb6,0xbf2abf3f,0xbeed3f63,0x3f7e3df1,0xbe79bf78,0xbf523f12,0x3f533f10
.long 0x3f808000,0xbeb6bf6f,0xbf3f3f2a,0x3f633eed,0x3df1bf7e,0xbf783e79,0x3f123f52,0x3f10bf53
.long 0x3f80,0x3ed2bf6a,0xbf3f3f2a,0x3f74be99,0xbf7ebdf1,0x3f5c3f04,0xbf12bf52,0x3e3e3f7c
.long 0x3f808000,0xbf6abed2,0x3f2a3f3f,0xbe99bf74,0xbdf13f7e,0x3f04bf5c,0xbf523f12,0x3f7cbe3e
.long 0x3f80,0xbeb6bf6f,0x3f2a3f3f,0xbf63beed,0x3f7e3df1,0xbf783e79,0x3f52bf12,0xbf103f53
.long 0x3f808000,0xbf6f3eb6,0x3f3fbf2a,0xbeed3f63,0x3df1bf7e,0x3e793f78,0xbf12bf52,0x3f533f10
.long 0x3f80,0xbf6abed2,0x3f3fbf2a,0x3e993f74,0xbf7ebdf1,0x3f04bf5c,0x3f123f52,0xbf7c3e3e
.long 0x3f808000,0xbed23f6a,0xbf2abf3f,0x3f74be99,0xbdf13f7e,0xbf5cbf04,0x3f52bf12,0x3e3e3f7c
.long 0x3f80,0xbf6f3eb6,0xbf2abf3f,0x3eedbf63,0x3f7e3df1,0x3e793f78,0xbf523f12,0xbf53bf10
.long 0x3f808000,0x3eb63f6f,0xbf3f3f2a,0xbf63beed,0x3df1bf7e,0x3f78be79,0x3f123f52,0xbf103f53
.long 0x3f80,0xbed23f6a,0xbf3f3f2a,0xbf743e99,0xbf7ebdf1,0xbf5cbf04,0xbf12bf52,0xbe3ebf7c
.long 0x3f808000,0x3f6a3ed2,0x3f2a3f3f,0x3e993f74,0xbdf13f7e,0xbf043f5c,0xbf523f12,0xbf7c3e3e
.long 0x3f80,0x3ebb3f6e,0x3f2e3f3c,0x3f663edf,0x3f7f3da1,0x3f75be95,0x3f49bf1e,0x3f01bf5d
.long 0x3f808000,0x3f6ebebb,0x3f3cbf2e,0x3edfbf66,0x3da1bf7f,0xbe95bf75,0xbf1ebf49,0xbf5dbf01
.long 0x3f80,0x3f6b3ecd,0x3f3cbf2e,0xbea8bf72,0xbf7fbda1,0xbef13f62,0x3f1e3f49,0x3f78be81
.long 0x3f808000,0x3ecdbf6b,0xbf2ebf3c,0xbf723ea8,0xbda13f7f,0x3f623ef1,0x3f49bf1e,0xbe81bf78
.long 0x3f80,0x3f6ebebb,0xbf2ebf3c,0xbedf3f66,0x3f7f3da1,0xbe95bf75,0xbf493f1e,0x3f5d3f01
.long 0x3f808000,0xbebbbf6e,0xbf3c3f2e,0x3f663edf,0x3da1bf7f,0xbf753e95,0x3f1e3f49,0x3f01bf5d
.long 0x3f80,0x3ecdbf6b,0xbf3c3f2e,0x3f72bea8,0xbf7fbda1,0x3f623ef1,0xbf1ebf49,0x3e813f78
.long 0x3f808000,0xbf6bbecd,0x3f2e3f3c,0xbea8bf72,0xbda13f7f,0x3ef1bf62,0xbf493f1e,0x3f78be81
.long 0x3f80,0xbebbbf6e,0x3f2e3f3c,0xbf66bedf,0x3f7f3da1,0xbf753e95,0x3f49bf1e,0xbf013f5d
.long 0x3f808000,0xbf6e3ebb,0x3f3cbf2e,0xbedf3f66,0x3da1bf7f,0x3e953f75,0xbf1ebf49,0x3f5d3f01
.long 0x3f80,0xbf6bbecd,0x3f3cbf2e,0x3ea83f72,0xbf7fbda1,0x3ef1bf62,0x3f1e3f49,0xbf783e81
.long 0x3f808000,0xbecd3f6b,0xbf2ebf3c,0x3f72bea8,0xbda13f7f,0xbf62bef1,0x3f49bf1e,0x3e813f78
.long 0x3f80,0xbf6e3ebb,0xbf2ebf3c,0x3edfbf66,0x3f7f3da1,0x3e953f75,0xbf493f1e,0xbf5dbf01
.long 0x3f808000,0x3ebb3f6e,0xbf3c3f2e,0xbf66bedf,0x3da1bf7f,0x3f75be95,0x3f1e3f49,0xbf013f5d
.long 0x3f80,0xbecd3f6b,0xbf3c3f2e,0xbf723ea8,0xbf7fbda1,0xbf62bef1,0xbf1ebf49,0xbe81bf78
.long 0x3f808000,0x3f6b3ecd,0x3f2e3f3c,0x3ea83f72,0xbda13f7f,0xbef13f62,0xbf493f1e,0xbf783e81
.long 0x3f80,0x3ebf3f6d,0x3f313f39,0x3f6a3ed2,0x3f803d21,0x3f71beac,0x3f3fbf2a,0x3ee4bf65
.long 0x3f808000,0x3f6dbebf,0x3f39bf31,0x3ed2bf6a,0x3d21bf80,0xbeacbf71,0xbf2abf3f,0xbf65bee4
.long 0x3f80,0x3f6c3ec9,0x3f39bf31,0xbeb6bf6f,0xbf80bd21,0xbedb3f67,0x3f2a3f3f,0x3f73bea3
.long 0x3f808000,0x3ec9bf6c,0xbf31bf39,0xbf6f3eb6,0xbd213f80,0x3f673edb,0x3f3fbf2a,0xbea3bf73
.long 0x3f80,0x3f6dbebf,0xbf31bf39,0xbed23f6a,0x3f803d21,0xbeacbf71,0xbf3f3f2a,0x3f653ee4
.long 0x3f808000,0xbebfbf6d,0xbf393f31,0x3f6a3ed2,0x3d21bf80,0xbf713eac,0x3f2a3f3f,0x3ee4bf65
.long 0x3f80,0x3ec9bf6c,0xbf393f31,0x3f6fbeb6,0xbf80bd21,0x3f673edb,0xbf2abf3f,0x3ea33f73
.long 0x3f808000,0xbf6cbec9,0x3f313f39,0xbeb6bf6f,0xbd213f80,0x3edbbf67,0xbf3f3f2a,0x3f73bea3
.long 0x3f80,0xbebfbf6d,0x3f313f39,0xbf6abed2,0x3f803d21,0xbf713eac,0x3f3fbf2a,0xbee43f65
.long 0x3f808000,0xbf6d3ebf,0x3f39bf31,0xbed23f6a,0x3d21bf80,0x3eac3f71,0xbf2abf3f,0x3f653ee4
.long 0x3f80,0xbf6cbec9,0x3f39bf31,0x3eb63f6f,0xbf80bd21,0x3edbbf67,0x3f2a3f3f,0xbf733ea3
.long 0x3f808000,0xbec93f6c,0xbf31bf39,0x3f6fbeb6,0xbd213f80,0xbf67bedb,0x3f3fbf2a,0x3ea33f73
.long 0x3f80,0xbf6d3ebf,0xbf31bf39,0x3ed2bf6a,0x3f803d21,0x3eac3f71,0xbf3f3f2a,0xbf65bee4
.long 0x3f808000,0x3ebf3f6d,0xbf393f31,0xbf6abed2,0x3d21bf80,0x3f71beac,0x3f2a3f3f,0xbee43f65
.long 0x3f80,0xbec93f6c,0xbf393f31,0xbf6f3eb6,0xbf80bd21,0xbf67bedb,0xbf2abf3f,0xbea3bf73
.long 0x3f808000,0x3f6c3ec9,0x3f313f39,0x3eb63f6f,0xbd213f80,0xbedb3f67,0xbf3f3f2a,0xbf733ea3
.long 0x3f80,0x3ec43f6d,0x3f353f35,0x3f6d3ec4,0x3f80248d,0x3f6dbec4,0x3f35bf35,0x3ec4bf6d
.long 0x3f808000,0x3f6dbec4,0x3f35bf35,0x3ec4bf6d,0x248dbf80,0xbec4bf6d,0xbf35bf35,0xbf6dbec4
.long 0x3f80,0x3f6d3ec4,0x3f35bf35,0xbec4bf6d,0xbf80a554,0xbec43f6d,0x3f353f35,0x3f6dbec4
.long 0x3f808000,0x3ec4bf6d,0xbf35bf35,0xbf6d3ec4,0xa5543f80,0x3f6d3ec4,0x3f35bf35,0xbec4bf6d
.long 0x3f80,0x3f6dbec4,0xbf35bf35,0xbec43f6d,0x3f80248d,0xbec4bf6d,0xbf353f35,0x3f6d3ec4
.long 0x3f808000,0xbec4bf6d,0xbf353f35,0x3f6d3ec4,0x248dbf80,0xbf6d3ec4,0x3f353f35,0x3ec4bf6d
.long 0x3f80,0x3ec4bf6d,0xbf353f35,0x3f6dbec4,0xbf80a554,0x3f6d3ec4,0xbf35bf35,0x3ec43f6d
.long 0x3f808000,0xbf6dbec4,0x3f353f35,0xbec4bf6d,0xa5543f80,0x3ec4bf6d,0xbf353f35,0x3f6dbec4
.long 0x3f80,0xbec4bf6d,0x3f353f35,0xbf6dbec4,0x3f80248d,0xbf6d3ec4,0x3f35bf35,0xbec43f6d
.long 0x3f808000,0xbf6d3ec4,0x3f35bf35,0xbec43f6d,0x248dbf80,0x3ec43f6d,0xbf35bf35,0x3f6d3ec4
.long 0x3f80,0xbf6dbec4,0x3f35bf35,0x3ec43f6d,0xbf80a554,0x3ec4bf6d,0x3f353f35,0xbf6d3ec4
.long 0x3f808000,0xbec43f6d,0xbf35bf35,0x3f6dbec4,0xa5543f80,0xbf6dbec4,0x3f35bf35,0x3ec43f6d
.long 0x3f80,0xbf6d3ec4,0xbf35bf35,0x3ec4bf6d,0x3f80248d,0x3ec43f6d,0xbf353f35,0xbf6dbec4
.long 0x3f808000,0x3ec43f6d,0xbf353f35,0xbf6dbec4,0x248dbf80,0x3f6dbec4,0x3f353f35,0xbec43f6d
.long 0x3f80,0xbec43f6d,0xbf353f35,0xbf6d3ec4,0xbf80a554,0xbf6dbec4,0xbf35bf35,0xbec4bf6d
.long 0x3f808000,0x3f6d3ec4,0x3f353f35,0x3ec43f6d,0xa5543f80,0xbec43f6d,0xbf353f35,0xbf6d3ec4
.p2align 8
tab_F32:
.long 0x3f803f80,0x3f803f80,0x3f803f80,0x3f803f80,0x3f7b3f80,0x3f553f6d,0x3f0e3f35,0x3e483ec4
.long 0x3f6d3f80,0x3ec43f35,0xbec4248d,0xbf6dbf35,0x3f553f80,0xbe483ec4,0xbf7bbf35,0xbf0ebf6d
.long 0x3f353f80,0xbf35248d,0xbf35bf80,0x3f35a554,0x3f0e3f80,0xbf7bbec4,0x3e48bf35,0x3f553f6d
.long 0x3ec43f80,0xbf6dbf35,0x3f6da554,0xbec43f35,0x3e483f80,0xbf0ebf6d,0x3f553f35,0xbf7bbec4
.long 0x248d3f80,0xa554bf80,0x248d3f80,0xa554bf80,0xbe483f80,0x3f0ebf6d,0xbf553f35,0x3f7bbec4
.long 0xbec43f80,0x3f6dbf35,0xbf6d248d,0x3ec43f35,0xbf0e3f80,0x3f7bbec4,0xbe48bf35,0xbf553f6d
.long 0xbf353f80,0x3f35a554,0x3f35bf80,0xbf35248d,0xbf553f80,0x3e483ec4,0x3f7bbf35,0x3f0ebf6d
.long 0xbf6d3f80,0xbec43f35,0x3ec4a554,0x3f6dbf35,0xbf7b3f80,0xbf553f6d,0xbf0e3f35,0xbe483ec4
.long 0x3f803f80,0x3f803f80,0x3f803f80,0x3f803f80,0xbe48248d,0xbf0ebec4,0xbf55bf35,0xbf7bbf6d
.long 0xbf6dbf80,0xbec4bf35,0x3ec4a554,0x3f6d3f35,0x3f0ea554,0x3f7b3f6d,0x3e483f35,0xbf55bec4
.long 0x3f353f80,0xbf35248d,0xbf35bf80,0x3f35a554,0xbf55248d,0xbe48bf6d,0x3f7b3f35,0xbf0e3ec4
.long 0xbec4bf80,0x3f6d3f35,0xbf6d248d,0x3ec4bf35,0x3f7ba554,0xbf553ec4,0x3f0ebf35,0xbe483f6d
.long 0x248d3f80,0xa554bf80,0x248d3f80,0xa554bf80,0xbf7b248d,0x3f553ec4,0xbf0ebf35,0x3e483f6d
.long 0x3ec4bf80,0xbf6d3f35,0x3f6da554,0xbec4bf35,0x3f55a554,0x3e48bf6d,0xbf7b3f35,0x3f0e3ec4
.long 0xbf353f80,0x3f35a554,0x3f35bf80,0xbf35248d,0xbf0e248d,0xbf7b3f6d,0xbe483f35,0x3f55bec4
.long 0x3f6dbf80,0x3ec4bf35,0xbec4248d,0xbf6d3f35,0x3e48a554,0x3f0ebec4,0x3f55bf35,0x3f7bbf6d
.long 0x3f803f80,0x3f803f80,0x3f803f80,0x3f803f80,0xbf7bbf80,0xbf55bf6d,0xbf0ebf35,0xbe48bec4
.long 0x3f6d3f80,0x3ec43f35,0xbec4248d,0xbf6dbf35,0xbf55bf80,0x3e48bec4,0x3f7b3f35,0x3f0e3f6d
.long 0x3f353f80,0xbf35248d,0xbf35bf80,0x3f35a554,0xbf0ebf80,0x3f7b3ec4,0xbe483f35,0xbf55bf6d
.long 0x3ec43f80,0xbf6dbf35,0x3f6da554,0xbec43f35,0xbe48bf80,0x3f0e3f6d,0xbf55bf35,0x3f7b3ec4
.long 0x248d3f80,0xa554bf80,0x248d3f80,0xa554bf80,0x3e48bf80,0xbf0e3f6d,0x3f55bf35,0xbf7b3ec4
.long 0xbec43f80,0x3f6dbf35,0xbf6d248d,0x3ec43f35,0x3f0ebf80,0xbf7b3ec4,0x3e483f35,0x3f55bf6d
.long 0xbf353f80,0x3f35a554,0x3f35bf80,0xbf35248d,0x3f55bf80,0xbe48bec4,0xbf7b3f35,0xbf0e3f6d
.long 0xbf6d3f80,0xbec43f35,0x3ec4a554,0x3f6dbf35,0x3f7bbf80,0x3f55bf6d,0x3f0ebf35,0x3e48bec4
.long 0x3f803f80,0x3f803f80,0x3f803f80,0x3f803f80,0x3e48a554,0x3f0e3ec4,0x3f553f35,0x3f7b3f6d
.long 0xbf6dbf80,0xbec4bf35,0x3ec4a554,0x3f6d3f35,0xbf0e248d,0xbf7bbf6d,0xbe48bf35,0x3f553ec4
.long 0x3f353f80,0xbf35248d,0xbf35bf80,0x3f35a554,0x3f55a554,0x3e483f6d,0xbf7bbf35,0x3f0ebec4
.long 0xbec4bf80,0x3f6d3f35,0xbf6d248d,0x3ec4bf35,0xbf7b248d,0x3f55bec4,0xbf0e3f35,0x3e48bf6d
.long 0x248d3f80,0xa554bf80,0x248d3f80,0xa554bf80,0x3f7ba554,0xbf55bec4,0x3f0e3f35,0xbe48bf6d
.long 0x3ec4bf80,0xbf6d3f35,0x3f6da554,0xbec4bf35,0xbf55248d,0xbe483f6d,0x3f7bbf35,0xbf0ebec4
.long 0xbf353f80,0x3f35a554,0x3f35bf80,0xbf35248d,0x3f0ea554,0x3f7bbf6d,0x3e48bf35,0xbf553ec4
.long 0x3f6dbf80,0x3ec4bf35,0xbec4248d,0xbf6d3f35,0xbe48248d,0xbf0e3ec4,0xbf553f35,0xbf7b3f6d
.long 0x80008000,0x80008000,0x80008000,0x80008000,0xbe488000,0xbf0ebec4,0xbf55bf35,0xbf7bbf6d
.long 0xbec48000,0xbf6dbf35,0xbf6dbf80,0xbec4bf35,0xbf0e8000,0xbf7bbf6d,0xbe48bf35,0x3f553ec4
.long 0xbf358000,0xbf35bf80,0x3f35a50d,0x3f353f80,0xbf558000,0xbe48bf6d,0x3f7b3f35,0xbf0e3ec4
.long 0xbf6d8000,0x3ec4bf35,0x3ec43f80,0xbf6dbf35,0xbf7b8000,0x3f55bec4,0xbf0e3f35,0x3e48bf6d
.long 0xbf808000,0x3f80a50d,0xbf808000,0x3f80a50d,0xbf7b8000,0x3f553ec4,0xbf0ebf35,0x3e483f6d
.long 0xbf6d8000,0x3ec43f35,0x3ec4bf80,0xbf6d3f35,0xbf558000,0xbe483f6d,0x3f7bbf35,0xbf0ebec4
.long 0xbf358000,0xbf353f80,0x3f35a50d,0x3f35bf80,0xbf0e8000,0xbf7b3f6d,0xbe483f35,0x3f55bec4
.long 0xbec48000,0xbf6d3f35,0xbf6d3f80,0xbec43f35,0xbe488000,0xbf0e3ec4,0xbf553f35,0xbf7b3f6d
.long 0x80008000,0x80008000,0x80008000,0x80008000,0xbf7bbf80,0xbf55bf6d,0xbf0ebf35,0xbe48bec4
.long 0x3ec4a50d,0x3f6d3f35,0x3f6d3f80,0x3ec43f35,0x3f553f80,0xbe483ec4,0xbf7bbf35,0xbf0ebf6d
.long 0xbf358000,0xbf35bf80,0x3f35a50d,0x3f353f80,0xbf0ebf80,0x3f7b3ec4,0xbe483f35,0xbf55bf6d
.long 0x3f6da50d,0xbec43f35,0xbec4bf80,0x3f6d3f35,0x3e483f80,0xbf0ebf6d,0x3f553f35,0xbf7bbec4
.long 0xbf808000,0x3f80a50d,0xbf808000,0x3f80a50d,0x3e48bf80,0xbf0e3f6d,0x3f55bf35,0xbf7b3ec4
.long 0x3f6da50d,0xbec4bf35,0xbec43f80,0x3f6dbf35,0xbf0e3f80,0x3f7bbec4,0xbe48bf35,0xbf553f6d
.long 0xbf358000,0xbf353f80,0x3f35a50d,0x3f35bf80,0x3f55bf80,0xbe48bec4,0xbf7b3f35,0xbf0e3f6d
.long 0x3ec4a50d,0x3f6dbf35,0x3f6dbf80,0x3ec4bf35,0xbf7b3f80,0xbf553f6d,0xbf0e3f35,0xbe483ec4
.long 0x80008000,0x80008000,0x80008000,0x80008000,0x3e48a50d,0x3f0e3ec4,0x3f553f35,0x3f7b3f6d
.long 0xbec48000,0xbf6dbf35,0xbf6dbf80,0xbec4bf35,0x3f0ea50d,0x3f7b3f6d,0x3e483f35,0xbf55bec4
.long 0xbf358000,0xbf35bf80,0x3f35a50d,0x3f353f80,0x3f55a50d,0x3e483f6d,0xbf7bbf35,0x3f0ebec4
.long 0xbf6d8000,0x3ec4bf35,0x3ec43f80,0xbf6dbf35,0x3f7ba50d,0xbf553ec4,0x3f0ebf35,0xbe483f6d
.long 0xbf808000,0x3f80a50d,0xbf808000,0x3f80a50d,0x3f7ba50d,0xbf55bec4,0x3f0e3f35,0xbe48bf6d
.long 0xbf6d8000,0x3ec43f35,0x3ec4bf80,0xbf6d3f35,0x3f55a50d,0x3e48bf6d,0xbf7b3f35,0x3f0e3ec4
.long 0xbf358000,0xbf353f80,0x3f35a50d,0x3f35bf80,0x3f0ea50d,0x3f7bbf6d,0x3e48bf35,0xbf553ec4
.long 0xbec48000,0xbf6d3f35,0xbf6d3f80,0xbec43f35,0x3e48a50d,0x3f0ebec4,0x3f55bf35,0x3f7bbf6d
.long 0x80008000,0x80008000,0x80008000,0x80008000,0x3f7b3f80,0x3f553f6d,0x3f0e3f35,0x3e483ec4
.long 0x3ec4a50d,0x3f6d3f35,0x3f6d3f80,0x3ec43f35,0xbf55bf80,0x3e48bec4,0x3f7b3f35,0x3f0e3f6d
.long 0xbf358000,0xbf35bf80,0x3f35a50d,0x3f353f80,0x3f0e3f80,0xbf7bbec4,0x3e48bf35,0x3f553f6d
.long 0x3f6da50d,0xbec43f35,0xbec4bf80,0x3f6d3f35,0xbe48bf80,0x3f0e3f6d,0xbf55bf35,0x3f7b3ec4
.long 0xbf808000,0x3f80a50d,0xbf808000,0x3f80a50d,0xbe483f80,0x3f0ebf6d,0xbf553f35,0x3f7bbec4
.long 0x3f6da50d,0xbec4bf35,0xbec43f80,0x3f6dbf35,0x3f0ebf80,0xbf7b3ec4,0x3e483f35,0x3f55bf6d
.long 0xbf358000,0xbf353f80,0x3f35a50d,0x3f35bf80,0xbf553f80,0x3e483ec4,0x3f7bbf35,0x3f0ebf6d
.long 0x3ec4a50d,0x3f6dbf35,0x3f6dbf80,0x3ec4bf35,0x3f7bbf80,0x3f55bf6d,0x3f0ebf35,0x3e48bec4
.long 0x0,0x0,0x0,0x0,0x3e480000,0x3f0e3ec4,0x3f553f35,0x3f7b3f6d
.long 0x3ec40000,0x3f6d3f35,0x3f6d3f80,0x3ec43f35,0x3f0e0000,0x3f7b3f6d,0x3e483f35,0xbf55bec4
.long 0x3f350000,0x3f353f80,0xbf35250d,0xbf35bf80,0x3f550000,0x3e483f6d,0xbf7bbf35,0x3f0ebec4
.long 0x3f6d0000,0xbec43f35,0xbec4bf80,0x3f6d3f35,0x3f7b0000,0xbf553ec4,0x3f0ebf35,0xbe483f6d
.long 0x3f800000,0xbf80250d,0x3f800000,0xbf80250d,0x3f7b0000,0xbf55bec4,0x3f0e3f35,0xbe48bf6d
.long 0x3f6d0000,0xbec4bf35,0xbec43f80,0x3f6dbf35,0x3f550000,0x3e48bf6d,0xbf7b3f35,0x3f0e3ec4
.long 0x3f350000,0x3f35bf80,0xbf35250d,0xbf353f80,0x3f0e0000,0x3f7bbf6d,0x3e48bf35,0xbf553ec4
.long 0x3ec40000,0x3f6dbf35,0x3f6dbf80,0x3ec4bf35,0x3e480000,0x3f0ebec4,0x3f55bf35,0x3f7bbf6d
.long 0x0,0x0,0x0,0x0,0x3f7b3f80,0x3f553f6d,0x3f0e3f35,0x3e483ec4
.long 0xbec4250d,0xbf6dbf35,0xbf6dbf80,0xbec4bf35,0xbf55bf80,0x3e48bec4,0x3f7b3f35,0x3f0e3f6d
.long 0x3f350000,0x3f353f80,0xbf35250d,0xbf35bf80,0x3f0e3f80,0xbf7bbec4,0x3e48bf35,0x3f553f6d
.long 0xbf6d250d,0x3ec4bf35,0x3ec43f80,0xbf6dbf35,0xbe48bf80,0x3f0e3f6d,0xbf55bf35,0x3f7b3ec4
.long 0x3f800000,0xbf80250d,0x3f800000,0xbf80250d,0xbe483f80,0x3f0ebf6d,0xbf553f35,0x3f7bbec4
.long 0xbf6d250d,0x3ec43f35,0x3ec4bf80,0xbf6d3f35,0x3f0ebf80,0xbf7b3ec4,0x3e483f35,0x3f55bf6d
.long 0x3f350000,0x3f35bf80,0xbf35250d,0xbf353f80,0xbf553f80,0x3e483ec4,0x3f7bbf35,0x3f0ebf6d
.long 0xbec4250d,0xbf6d3f35,0xbf6d3f80,0xbec43f35,0x3f7bbf80,0x3f55bf6d,0x3f0ebf35,0x3e48bec4
.long 0x0,0x0,0x0,0x0,0xbe48250d,0xbf0ebec4,0xbf55bf35,0xbf7bbf6d
.long 0x3ec40000,0x3f6d3f35,0x3f6d3f80,0x3ec43f35,0xbf0e250d,0xbf7bbf6d,0xbe48bf35,0x3f553ec4
.long 0x3f350000,0x3f353f80,0xbf35250d,0xbf35bf80,0xbf55250d,0xbe48bf6d,0x3f7b3f35,0xbf0e3ec4
.long 0x3f6d0000,0xbec43f35,0xbec4bf80,0x3f6d3f35,0xbf7b250d,0x3f55bec4,0xbf0e3f35,0x3e48bf6d
.long 0x3f800000,0xbf80250d,0x3f800000,0xbf80250d,0xbf7b250d,0x3f553ec4,0xbf0ebf35,0x3e483f6d
.long 0x3f6d0000,0xbec4bf35,0xbec43f80,0x3f6dbf35,0xbf55250d,0xbe483f6d,0x3f7bbf35,0xbf0ebec4
.long 0x3f350000,0x3f35bf80,0xbf35250d,0xbf353f80,0xbf0e250d,0xbf7b3f6d,0xbe483f35,0x3f55bec4
.long 0x3ec40000,0x3f6dbf35,0x3f6dbf80,0x3ec4bf35,0xbe48250d,0xbf0e3ec4,0xbf553f35,0xbf7b3f6d
.long 0x0,0x0,0x0,0x0,0xbf7bbf80,0xbf55bf6d,0xbf0ebf35,0xbe48bec4
.long 0xbec4250d,0xbf6dbf35,0xbf6dbf80,0xbec4bf35,0x3f553f80,0xbe483ec4,0xbf7bbf35,0xbf0ebf6d
.long 0x3f350000,0x3f353f80,0xbf35250d,0xbf35bf80,0xbf0ebf80,0x3f7b3ec4,0xbe483f35,0xbf55bf6d
.long 0xbf6d250d,0x3ec4bf35,0x3ec43f80,0xbf6dbf35,0x3e483f80,0xbf0ebf6d,0x3f553f35,0xbf7bbec4
.long 0x3f800000,0xbf80250d,0x3f800000,0xbf80250d,0x3e48bf80,0xbf0e3f6d,0x3f55bf35,0xbf7b3ec4
.long 0xbf6d250d,0x3ec43f35,0x3ec4bf80,0xbf6d3f35,0xbf0e3f80,0x3f7bbec4,0xbe48bf35,0xbf553f6d
.long 0x3f350000,0x3f35bf80,0xbf35250d,0xbf353f80,0x3f55bf80,0xbe48bec4,0xbf7b3f35,0xbf0e3f6d
.long 0xbec4250d,0xbf6d3f35,0xbf6d3f80,0xbec43f35,0xbf7b3f80,0xbf553f6d,0xbf0e3f35,0xbe483ec4
.long 0xbf803f80,0xbf803f80,0xbf803f80,0xbf803f80,0xbf7b3f80,0xbf553f6d,0xbf0e3f35,0xbe483ec4
.long 0xbf6d3f80,0xbec43f35,0x3ec4248d,0x3f6dbf35,0xbf553f80,0x3e483ec4,0x3f7bbf35,0x3f0ebf6d
.long 0xbf353f80,0x3f35248d,0x3f35bf80,0xbf35a554,0xbf0e3f80,0x3f7bbec4,0xbe48bf35,0xbf553f6d
.long 0xbec43f80,0x3f6dbf35,0xbf6da554,0x3ec43f35,0xbe483f80,0x3f0ebf6d,0xbf553f35,0x3f7bbec4
.long 0xa5543f80,0x248dbf80,0xa5543f80,0x248dbf80,0x3e483f80,0xbf0ebf6d,0x3f553f35,0xbf7bbec4
.long 0x3ec43f80,0xbf6dbf35,0x3f6d248d,0xbec43f35,0x3f0e3f80,0xbf7bbec4,0x3e48bf35,0x3f553f6d
.long 0x3f353f80,0xbf35a554,0xbf35bf80,0x3f35248d,0x3f553f80,0xbe483ec4,0xbf7bbf35,0xbf0ebf6d
.long 0x3f6d3f80,0x3ec43f35,0xbec4a554,0xbf6dbf35,0x3f7b3f80,0x3f553f6d,0x3f0e3f35,0x3e483ec4
.long 0xbf803f80,0xbf803f80,0xbf803f80,0xbf803f80,0x3e48248d,0x3f0ebec4,0x3f55bf35,0x3f7bbf6d
.long 0x3f6dbf80,0x3ec4bf35,0xbec4a554,0xbf6d3f35,0xbf0ea554,0xbf7b3f6d,0xbe483f35,0x3f55bec4
.long 0xbf353f80,0x3f35248d,0x3f35bf80,0xbf35a554,0x3f55248d,0x3e48bf6d,0xbf7b3f35,0x3f0e3ec4
.long 0x3ec4bf80,0xbf6d3f35,0x3f6d248d,0xbec4bf35,0xbf7ba554,0x3f553ec4,0xbf0ebf35,0x3e483f6d
.long 0xa5543f80,0x248dbf80,0xa5543f80,0x248dbf80,0x3f7b248d,0xbf553ec4,0x3f0ebf35,0xbe483f6d
.long 0xbec4bf80,0x3f6d3f35,0xbf6da554,0x3ec4bf35,0xbf55a554,0xbe48bf6d,0x3f7b3f35,0xbf0e3ec4
.long 0x3f353f80,0xbf35a554,0xbf35bf80,0x3f35248d,0x3f0e248d,0x3f7b3f6d,0x3e483f35,0xbf55bec4
.long 0xbf6dbf80,0xbec4bf35,0x3ec4248d,0x3f6d3f35,0xbe48a554,0xbf0ebec4,0xbf55bf35,0xbf7bbf6d
.long 0xbf803f80,0xbf803f80,0xbf803f80,0xbf803f80,0x3f7bbf80,0x3f55bf6d,0x3f0ebf35,0x3e48bec4
.long 0xbf6d3f80,0xbec43f35,0x3ec4248d,0x3f6dbf35,0x3f55bf80,0xbe48bec4,0xbf7b3f35,0xbf0e3f6d
.long 0xbf353f80,0x3f35248d,0x3f35bf80,0xbf35a554,0x3f0ebf80,0xbf7b3ec4,0x3e483f35,0x3f55bf6d
.long 0xbec43f80,0x3f6dbf35,0xbf6da554,0x3ec43f35,0x3e48bf80,0xbf0e3f6d,0x3f55bf35,0xbf7b3ec4
.long 0xa5543f80,0x248dbf80,0xa5543f80,0x248dbf80,0xbe48bf80,0x3f0e3f6d,0xbf55bf35,0x3f7b3ec4
.long 0x3ec43f80,0xbf6dbf35,0x3f6d248d,0xbec43f35,0xbf0ebf80,0x3f7b3ec4,0xbe483f35,0xbf55bf6d
.long 0x3f353f80,0xbf35a554,0xbf35bf80,0x3f35248d,0xbf55bf80,0x3e48bec4,0x3f7b3f35,0x3f0e3f6d
.long 0x3f6d3f80,0x3ec43f35,0xbec4a554,0xbf6dbf35,0xbf7bbf80,0xbf55bf6d,0xbf0ebf35,0xbe48bec4
.long 0xbf803f80,0xbf803f80,0xbf803f80,0xbf803f80,0xbe48a554,0xbf0e3ec4,0xbf553f35,0xbf7b3f6d
.long 0x3f6dbf80,0x3ec4bf35,0xbec4a554,0xbf6d3f35,0x3f0e248d,0x3f7bbf6d,0x3e48bf35,0xbf553ec4
.long 0xbf353f80,0x3f35248d,0x3f35bf80,0xbf35a554,0xbf55a554,0xbe483f6d,0x3f7bbf35,0xbf0ebec4
.long 0x3ec4bf80,0xbf6d3f35,0x3f6d248d,0xbec4bf35,0x3f7b248d,0xbf55bec4,0x3f0e3f35,0xbe48bf6d
.long 0xa5543f80,0x248dbf80,0xa5543f80,0x248dbf80,0xbf7ba554,0x3f55bec4,0xbf0e3f35,0x3e48bf6d
.long 0xbec4bf80,0x3f6d3f35,0xbf6da554,0x3ec4bf35,0x3f55248d,0x3e483f6d,0xbf7bbf35,0x3f0ebec4
.long 0x3f353f80,0xbf35a554,0xbf35bf80,0x3f35248d,0xbf0ea554,0xbf7bbf6d,0xbe48bf35,0x3f553ec4
.long 0xbf6dbf80,0xbec4bf35,0x3ec4248d,0x3f6d3f35,0x3e48248d,0x3f0e3ec4,0x3f553f35,0x3f7b3f6d
.long 0xa50d8000,0xa50d8000,0xa50d8000,0xa50d8000,0x3e488000,0x3f0ebec4,0x3f55bf35,0x3f7bbf6d
.long 0x3ec48000,0x3f6dbf35,0x3f6dbf80,0x3ec4bf35,0x3f0e8000,0x3f7bbf6d,0x3e48bf35,0xbf553ec4
.long 0x3f358000,0x3f35bf80,0xbf35a50d,0xbf353f80,0x3f558000,0x3e48bf6d,0xbf7b3f35,0x3f0e3ec4
.long 0x3f6d8000,0xbec4bf35,0xbec43f80,0x3f6dbf35,0x3f7b8000,0xbf55bec4,0x3f0e3f35,0xbe48bf6d
.long 0x3f808000,0xbf80a50d,0x3f808000,0xbf80a50d,0x3f7b8000,0xbf553ec4,0x3f0ebf35,0xbe483f6d
.long 0x3f6d8000,0xbec43f35,0xbec4bf80,0x3f6d3f35,0x3f558000,0x3e483f6d,0xbf7bbf35,0x3f0ebec4
.long 0x3f358000,0x3f353f80,0xbf35a50d,0xbf35bf80,0x3f0e8000,0x3f7b3f6d,0x3e483f35,0xbf55bec4
.long 0x3ec48000,0x3f6d3f35,0x3f6d3f80,0x3ec43f35,0x3e488000,0x3f0e3ec4,0x3f553f35,0x3f7b3f6d
.long 0xa50d8000,0xa50d8000,0xa50d8000,0xa50d8000,0x3f7bbf80,0x3f55bf6d,0x3f0ebf35,0x3e48bec4
.long 0xbec4a50d,0xbf6d3f35,0xbf6d3f80,0xbec43f35,0xbf553f80,0x3e483ec4,0x3f7bbf35,0x3f0ebf6d
.long 0x3f358000,0x3f35bf80,0xbf35a50d,0xbf353f80,0x3f0ebf80,0xbf7b3ec4,0x3e483f35,0x3f55bf6d
.long 0xbf6da50d,0x3ec43f35,0x3ec4bf80,0xbf6d3f35,0xbe483f80,0x3f0ebf6d,0xbf553f35,0x3f7bbec4
.long 0x3f808000,0xbf80a50d,0x3f808000,0xbf80a50d,0xbe48bf80,0x3f0e3f6d,0xbf55bf35,0x3f7b3ec4
.long 0xbf6da50d,0x3ec4bf35,0x3ec43f80,0xbf6dbf35,0x3f0e3f80,0xbf7bbec4,0x3e48bf35,0x3f553f6d
.long 0x3f358000,0x3f353f80,0xbf35a50d,0xbf35bf80,0xbf55bf80,0x3e48bec4,0x3f7b3f35,0x3f0e3f6d
.long 0xbec4a50d,0xbf6dbf35,0xbf6dbf80,0xbec4bf35,0x3f7b3f80,0x3f553f6d,0x3f0e3f35,0x3e483ec4
.long 0xa50d8000,0xa50d8000,0xa50d8000,0xa50d8000,0xbe48a50d,0xbf0e3ec4,0xbf553f35,0xbf7b3f6d
.long 0x3ec48000,0x3f6dbf35,0x3f6dbf80,0x3ec4bf35,0xbf0ea50d,0xbf7b3f6d,0xbe483f35,0x3f55bec4
.long 0x3f358000,0x3f35bf80,0xbf35a50d,0xbf353f80,0xbf55a50d,0xbe483f6d,0x3f7bbf35,0xbf0ebec4
.long 0x3f6d8000,0xbec4bf35,0xbec43f80,0x3f6dbf35,0xbf7ba50d,0x3f553ec4,0xbf0ebf35,0x3e483f6d
.long 0x3f808000,0xbf80a50d,0x3f808000,0xbf80a50d,0xbf7ba50d,0x3f55bec4,0xbf0e3f35,0x3e48bf6d
.long 0x3f6d8000,0xbec43f35,0xbec4bf80,0x3f6d3f35,0xbf55a50d,0xbe48bf6d,0x3f7b3f35,0xbf0e3ec4
.long 0x3f358000,0x3f353f80,0xbf35a50d,0xbf35bf80,0xbf0ea50d,0xbf7bbf6d,0xbe48bf35,0x3f553ec4
.long 0x3ec48000,0x3f6d3f35,0x3f6d3f80,0x3ec43f35,0xbe48a50d,0xbf0ebec4,0xbf55bf35,0xbf7bbf6d
.long 0xa50d8000,0xa50d8000,0xa50d8000,0xa50d8000,0xbf7b3f80,0xbf553f6d,0xbf0e3f35,0xbe483ec4
.long 0xbec4a50d,0xbf6d3f35,0xbf6d3f80,0xbec43f35,0x3f55bf80,0xbe48bec4,0xbf7b3f35,0xbf0e3f6d
.long 0x3f358000,0x3f35bf80,0xbf35a50d,0xbf353f80,0xbf0e3f80,0x3f7bbec4,0xbe48bf35,0xbf553f6d
.long 0xbf6da50d,0x3ec43f35,0x3ec4bf80,0xbf6d3f35,0x3e48bf80,0xbf0e3f6d,0x3f55bf35,0xbf7b3ec4
.long 0x3f808000,0xbf80a50d,0x3f808000,0xbf80a50d,0x3e483f80,0xbf0ebf6d,0x3f553f35,0xbf7bbec4
.long 0xbf6da50d,0x3ec4bf35,0x3ec43f80,0xbf6dbf35,0xbf0ebf80,0x3f7b3ec4,0xbe483f35,0xbf55bf6d
.long 0x3f358000,0x3f353f80,0xbf35a50d,0xbf35bf80,0x3f553f80,0xbe483ec4,0xbf7bbf35,0xbf0ebf6d
.long 0xbec4a50d,0xbf6dbf35,0xbf6dbf80,0xbec4bf35,0xbf7bbf80,0xbf55bf6d,0xbf0ebf35,0xbe48bec4
.long 0x250d0000,0x250d0000,0x250d0000,0x250d0000,0xbe480000,0xbf0e3ec4,0xbf553f35,0xbf7b3f6d
.long 0xbec40000,0xbf6d3f35,0xbf6d3f80,0xbec43f35,0xbf0e0000,0xbf7b3f6d,0xbe483f35,0x3f55bec4
.long 0xbf350000,0xbf353f80,0x3f35250d,0x3f35bf80,0xbf550000,0xbe483f6d,0x3f7bbf35,0xbf0ebec4
.long 0xbf6d0000,0x3ec43f35,0x3ec4bf80,0xbf6d3f35,0xbf7b0000,0x3f553ec4,0xbf0ebf35,0x3e483f6d
.long 0xbf800000,0x3f80250d,0xbf800000,0x3f80250d,0xbf7b0000,0x3f55bec4,0xbf0e3f35,0x3e48bf6d
.long 0xbf6d0000,0x3ec4bf35,0x3ec43f80,0xbf6dbf35,0xbf550000,0xbe48bf6d,0x3f7b3f35,0xbf0e3ec4
.long 0xbf350000,0xbf35bf80,0x3f35250d,0x3f353f80,0xbf0e0000,0xbf7bbf6d,0xbe48bf35,0x3f553ec4
.long 0xbec40000,0xbf6dbf35,0xbf6dbf80,0xbec4bf35,0xbe480000,0xbf0ebec4,0xbf55bf35,0xbf7bbf6d
.long 0x250d0000,0x250d0000,0x250d0000,0x250d0000,0xbf7b3f80,0xbf553f6d,0xbf0e3f35,0xbe483ec4
.long 0x3ec4250d,0x3f6dbf35,0x3f6dbf80,0x3ec4bf35,0x3f55bf80,0xbe48bec4,0xbf7b3f35,0xbf0e3f6d
.long 0xbf350000,0xbf353f80,0x3f35250d,0x3f35bf80,0xbf0e3f80,0x3f7bbec4,0xbe48bf35,0xbf553f6d
.long 0x3f6d250d,0xbec4bf35,0xbec43f80,0x3f6dbf35,0x3e48bf80,0xbf0e3f6d,0x3f55bf35,0xbf7b3ec4
.long 0xbf800000,0x3f80250d,0xbf800000,0x3f80250d,0x3e483f80,0xbf0ebf6d,0x3f553f35,0xbf7bbec4
.long 0x3f6d250d,0xbec43f35,0xbec4bf80,0x3f6d3f35,0xbf0ebf80,0x3f7b3ec4,0xbe483f35,0xbf55bf6d
.long 0xbf350000,0xbf35bf80,0x3f35250d,0x3f353f80,0x3f553f80,0xbe483ec4,0xbf7bbf35,0xbf0ebf6d
.long 0x3ec4250d,0x3f6d3f35,0x3f6d3f80,0x3ec43f35,0xbf7bbf80,0xbf55bf6d,0xbf0ebf35,0xbe48bec4
.long 0x250d0000,0x250d0000,0x250d0000,0x250d0000,0x3e48250d,0x3f0ebec4,0x3f55bf35,0x3f7bbf6d
.long 0xbec40000,0xbf6d3f35,0xbf6d3f80,0xbec43f35,0x3f0e250d,0x3f7bbf6d,0x3e48bf35,0xbf553ec4
.long 0xbf350000,0xbf353f80,0x3f35250d,0x3f35bf80,0x3f55250d,0x3e48bf6d,0xbf7b3f35,0x3f0e3ec4
.long 0xbf6d0000,0x3ec43f35,0x3ec4bf80,0xbf6d3f35,0x3f7b250d,0xbf55bec4,0x3f0e3f35,0xbe48bf6d
.long 0xbf800000,0x3f80250d,0xbf800000,0x3f80250d,0x3f7b250d,0xbf553ec4,0x3f0ebf35,0xbe483f6d
.long 0xbf6d0000,0x3ec4bf35,0x3ec43f80,0xbf6dbf35,0x3f55250d,0x3e483f6d,0xbf7bbf35,0x3f0ebec4
.long 0xbf350000,0xbf35bf80,0x3f35250d,0x3f353f80,0x3f0e250d,0x3f7b3f6d,0x3e483f35,0xbf55bec4
.long 0xbec40000,0xbf6dbf35,0xbf6dbf80,0xbec4bf35,0x3e48250d,0x3f0e3ec4,0x3f553f35,0x3f7b3f6d
.long 0x250d0000,0x250d0000,0x250d0000,0x250d0000,0x3f7bbf80,0x3f55bf6d,0x3f0ebf35,0x3e48bec4
.long 0x3ec4250d,0x3f6dbf35,0x3f6dbf80,0x3ec4bf35,0xbf553f80,0x3e483ec4,0x3f7bbf35,0x3f0ebf6d
.long 0xbf350000,0xbf353f80,0x3f35250d,0x3f35bf80,0x3f0ebf80,0xbf7b3ec4,0x3e483f35,0x3f55bf6d
.long 0x3f6d250d,0xbec4bf35,0xbec43f80,0x3f6dbf35,0xbe483f80,0x3f0ebf6d,0xbf553f35,0x3f7bbec4
.long 0xbf800000,0x3f80250d,0xbf800000,0x3f80250d,0xbe48bf80,0x3f0e3f6d,0xbf55bf35,0x3f7b3ec4
.long 0x3f6d250d,0xbec43f35,0xbec4bf80,0x3f6d3f35,0x3f0e3f80,0xbf7bbec4,0x3e48bf35,0x3f553f6d
.long 0xbf350000,0xbf35bf80,0x3f35250d,0x3f353f80,0xbf55bf80,0x3e48bec4,0x3f7b3f35,0x3f0e3f6d
.long 0x3ec4250d,0x3f6d3f35,0x3f6d3f80,0x3ec43f35,0x3f7b3f80,0x3f553f6d,0x3f0e3f35,0x3e483ec4
.p2align 8
tab_F64:
.long 0x3f803f80,0x3f803f80,0x3f803f80,0x3f803f80,0x248d3f80,0xa554bf80,0xbec43f6d,0x3ec4bf6d
.long 0xbf803f80,0xbf803f80,0xbf353f35,0xbf353f35,0xa5543f80,0x248dbf80,0x3f6d3ec4,0xbf6dbec4
.long 0x3f803f80,0x3f803f80,0x248d248d,0x248d248d,0x248d3f80,0xa554bf80,0xbf6dbec4,0x3f6d3ec4
.long 0xbf803f80,0xbf803f80,0x3f35bf35,0x3f35bf35,0xa5543f80,0x248dbf80,0x3ec4bf6d,0xbec43f6d
.long 0x3f803f80,0x3f803f80,0xbf80bf80,0xbf80bf80,0x248d3f80,0xa554bf80,0x3ec4bf6d,0xbec43f6d
.long 0xbf803f80,0xbf803f80,0x3f35bf35,0x3f35bf35,0xa5543f80,0x248dbf80,0xbf6dbec4,0x3f6d3ec4
.long 0x3f803f80,0x3f803f80,0xa554a554,0xa554a554,0x248d3f80,0xa554bf80,0x3f6d3ec4,0xbf6dbec4
.long 0xbf803f80,0xbf803f80,0xbf353f35,0xbf353f35,0xa5543f80,0x248dbf80,0xbec43f6d,0x3ec4bf6d
.long 0x3f803f80,0x3f803f80,0x3f803f80,0x3f803f80,0x248d3f80,0xa554bf80,0xbec43f6d,0x3ec4bf6d
.long 0xbf803f80,0xbf803f80,0xbf353f35,0xbf353f35,0xa5543f80,0x248dbf80,0x3f6d3ec4,0xbf6dbec4
.long 0x3f803f80,0x3f803f80,0x248d248d,0x248d248d,0x248d3f80,0xa554bf80,0xbf6dbec4,0x3f6d3ec4
.long 0xbf803f80,0xbf803f80,0x3f35bf35,0x3f35bf35,0xa5543f80,0x248dbf80,0x3ec4bf6d,0xbec43f6d
.long 0x3f803f80,0x3f803f80,0xbf80bf80,0xbf80bf80,0x248d3f80,0xa554bf80,0x3ec4bf6d,0xbec43f6d
.long 0xbf803f80,0xbf803f80,0x3f35bf35,0x3f35bf35,0xa5543f80,0x248dbf80,0xbf6dbec4,0x3f6d3ec4
.long 0x3f803f80,0x3f803f80,0xa554a554,0xa554a554,0x248d3f80,0xa554bf80,0x3f6d3ec4,0xbf6dbec4
.long 0xbf803f80,0xbf803f80,0xbf353f35,0xbf353f35,0xa5543f80,0x248dbf80,0xbec43f6d,0x3ec4bf6d
.long 0x3f803f80,0x3f803f80,0x3f803f80,0x3f803f80,0x248d3f80,0xa554bf80,0xbec43f6d,0x3ec4bf6d
.long 0xbf803f80,0xbf803f80,0xbf353f35,0xbf353f35,0xa5543f80,0x248dbf80,0x3f6d3ec4,0xbf6dbec4
.long 0x3f803f80,0x3f803f80,0x248d248d,0x248d248d,0x248d3f80,0xa554bf80,0xbf6dbec4,0x3f6d3ec4
.long 0xbf803f80,0xbf803f80,0x3f35bf35,0x3f35bf35,0xa5543f80,0x248dbf80,0x3ec4bf6d,0xbec43f6d
.long 0x3f803f80,0x3f803f80,0xbf80bf80,0xbf80bf80,0x248d3f80,0xa554bf80,0x3ec4bf6d,0xbec43f6d
.long 0xbf803f80,0xbf803f80,0x3f35bf35,0x3f35bf35,0xa5543f80,0x248dbf80,0xbf6dbec4,0x3f6d3ec4
.long 0x3f803f80,0x3f803f80,0xa554a554,0xa554a554,0x248d3f80,0xa554bf80,0x3f6d3ec4,0xbf6dbec4
.long 0xbf803f80,0xbf803f80,0xbf353f35,0xbf353f35,0xa5543f80,0x248dbf80,0xbec43f6d,0x3ec4bf6d
.long 0x3f803f80,0x3f803f80,0x3f803f80,0x3f803f80,0x248d3f80,0xa554bf80,0xbec43f6d,0x3ec4bf6d
.long 0xbf803f80,0xbf803f80,0xbf353f35,0xbf353f35,0xa5543f80,0x248dbf80,0x3f6d3ec4,0xbf6dbec4
.long 0x3f803f80,0x3f803f80,0x248d248d,0x248d248d,0x248d3f80,0xa554bf80,0xbf6dbec4,0x3f6d3ec4
.long 0xbf803f80,0xbf803f80,0x3f35bf35,0x3f35bf35,0xa5543f80,0x248dbf80,0x3ec4bf6d,0xbec43f6d
.long 0x3f803f80,0x3f803f80,0xbf80bf80,0xbf80bf80,0x248d3f80,0xa554bf80,0x3ec4bf6d,0xbec43f6d
.long 0xbf803f80,0xbf803f80,0x3f35bf35,0x3f35bf35,0xa5543f80,0x248dbf80,0xbf6dbec4,0x3f6d3ec4
.long 0x3f803f80,0x3f803f80,0xa554a554,0xa554a554,0x248d3f80,0xa554bf80,0x3f6d3ec4,0xbf6dbec4
.long 0xbf803f80,0xbf803f80,0xbf353f35,0xbf353f35,0xa5543f80,0x248dbf80,0xbec43f6d,0x3ec4bf6d
.long 0x3f803f80,0x3f803f80,0x3f803f80,0x3f803f80,0xbf353f35,0x3f35bf35,0xbf6d3ec4,0x3f6dbec4
.long 0xa554248d,0xa554248d,0x3f35bf35,0x3f35bf35,0x3f35bf35,0xbf353f35,0xbec4bf6d,0x3ec43f6d
.long 0xbf80bf80,0xbf80bf80,0xa554a554,0xa554a554,0x3f35bf35,0xbf353f35,0x3ec43f6d,0xbec4bf6d
.long 0x248da554,0x248da554,0xbf353f35,0xbf353f35,0xbf353f35,0x3f35bf35,0x3f6dbec4,0xbf6d3ec4
.long 0x3f803f80,0x3f803f80,0xbf80bf80,0xbf80bf80,0xbf353f35,0x3f35bf35,0x3f6dbec4,0xbf6d3ec4
.long 0xa554248d,0xa554248d,0xbf353f35,0xbf353f35,0x3f35bf35,0xbf353f35,0x3ec43f6d,0xbec4bf6d
.long 0xbf80bf80,0xbf80bf80,0x248d248d,0x248d248d,0x3f35bf35,0xbf353f35,0xbec4bf6d,0x3ec43f6d
.long 0x248da554,0x248da554,0x3f35bf35,0x3f35bf35,0xbf353f35,0x3f35bf35,0xbf6d3ec4,0x3f6dbec4
.long 0x3f803f80,0x3f803f80,0x3f803f80,0x3f803f80,0xbf353f35,0x3f35bf35,0xbf6d3ec4,0x3f6dbec4
.long 0xa554248d,0xa554248d,0x3f35bf35,0x3f35bf35,0x3f35bf35,0xbf353f35,0xbec4bf6d,0x3ec43f6d
.long 0xbf80bf80,0xbf80bf80,0xa554a554,0xa554a554,0x3f35bf35,0xbf353f35,0x3ec43f6d,0xbec4bf6d
.long 0x248da554,0x248da554,0xbf353f35,0xbf353f35,0xbf353f35,0x3f35bf35,0x3f6dbec4,0xbf6d3ec4
.long 0x3f803f80,0x3f803f80,0xbf80bf80,0xbf80bf80,0xbf353f35,0x3f35bf35,0x3f6dbec4,0xbf6d3ec4
.long 0xa554248d,0xa554248d,0xbf353f35,0xbf353f35,0x3f35bf35,0xbf353f35,0x3ec43f6d,0xbec4bf6d
.long 0xbf80bf80,0xbf80bf80,0x248d248d,0x248d248d,0x3f35bf35,0xbf353f35,0xbec4bf6d,0x3ec43f6d
.long 0x248da554,0x248da554,0x3f35bf35,0x3f35bf35,0xbf353f35,0x3f35bf35,0xbf6d3ec4,0x3f6dbec4
.long 0x3f803f80,0x3f803f80,0x3f803f80,0x3f803f80,0xbf353f35,0x3f35bf35,0xbf6d3ec4,0x3f6dbec4
.long 0xa554248d,0xa554248d,0x3f35bf35,0x3f35bf35,0x3f35bf35,0xbf353f35,0xbec4bf6d,0x3ec43f6d
.long 0xbf80bf80,0xbf80bf80,0xa554a554,0xa554a554,0x3f35bf35,0xbf353f35,0x3ec43f6d,0xbec4bf6d
.long 0x248da554,0x248da554,0xbf353f35,0xbf353f35,0xbf353f35,0x3f35bf35,0x3f6dbec4,0xbf6d3ec4
.long 0x3f803f80,0x3f803f80,0xbf80bf80,0xbf80bf80,0xbf353f35,0x3f35bf35,0x3f6dbec4,0xbf6d3ec4
.long 0xa554248d,0xa554248d,0xbf353f35,0xbf353f35,0x3f35bf35,0xbf353f35,0x3ec43f6d,0xbec4bf6d
.long 0xbf80bf80,0xbf80bf80,0x248d248d,0x248d248d,0x3f35bf35,0xbf353f35,0xbec4bf6d,0x3ec43f6d
.long 0x248da554,0x248da554,0x3f35bf35,0x3f35bf35,0xbf353f35,0x3f35bf35,0xbf6d3ec4,0x3f6dbec4
.long 0x3f803f80,0x3f803f80,0x3f803f80,0x3f803f80,0xbf353f35,0x3f35bf35,0xbf6d3ec4,0x3f6dbec4
.long 0xa554248d,0xa554248d,0x3f35bf35,0x3f35bf35,0x3f35bf35,0xbf353f35,0xbec4bf6d,0x3ec43f6d
.long 0xbf80bf80,0xbf80bf80,0xa554a554,0xa554a554,0x3f35bf35,0xbf353f35,0x3ec43f6d,0xbec4bf6d
.long 0x248da554,0x248da554,0xbf353f35,0xbf353f35,0xbf353f35,0x3f35bf35,0x3f6dbec4,0xbf6d3ec4
.long 0x3f803f80,0x3f803f80,0xbf80bf80,0xbf80bf80,0xbf353f35,0x3f35bf35,0x3f6dbec4,0xbf6d3ec4
.long 0xa554248d,0xa554248d,0xbf353f35,0xbf353f35,0x3f35bf35,0xbf353f35,0x3ec43f6d,0xbec4bf6d
.long 0xbf80bf80,0xbf80bf80,0x248d248d,0x248d248d,0x3f35bf35,0xbf353f35,0xbec4bf6d,0x3ec43f6d
.long 0x248da554,0x248da554,0x3f35bf35,0x3f35bf35,0xbf353f35,0x3f35bf35,0xbf6d3ec4,0x3f6dbec4
.long 0x3f6d3f80,0x3ec43f35,0x3f623f7f,0x3e953f22,0xbec43f80,0x3f6dbf35,0xbf463f62,0x3f7fbe95
.long 0xbf6d3f80,0xbec43f35,0xbe953f22,0x3ef1bdc9,0x3ec43f80,0xbf6dbf35,0x3f7f3e95,0xbf223ef1
.long 0x3f6d3f80,0x3ec43f35,0xbef1bdc9,0xbf75bf46,0xbec43f80,0x3f6dbf35,0xbf22bef1,0xbdc93f75
.long 0xbf6d3f80,0xbec43f35,0x3f75bf46,0x3f62bf7f,0x3ec43f80,0xbf6dbf35,0xbdc9bf75,0x3f463f62
.long 0x3f6d3f80,0x3ec43f35,0xbf62bf7f,0xbe95bf22,0xbec43f80,0x3f6dbf35,0x3f46bf62,0xbf7f3e95
.long 0xbf6d3f80,0xbec43f35,0x3e95bf22,0xbef13dc9,0x3ec43f80,0xbf6dbf35,0xbf7fbe95,0x3f22bef1
.long 0x3f6d3f80,0x3ec43f35,0x3ef13dc9,0x3f753f46,0xbec43f80,0x3f6dbf35,0x3f223ef1,0x3dc9bf75
.long 0xbf6d3f80,0xbec43f35,0xbf753f46,0xbf623f7f,0x3ec43f80,0xbf6dbf35,0x3dc93f75,0xbf46bf62
.long 0xbec4248d,0xbf6dbf35,0xbef1bdc9,0xbf75bf46,0xbf6d248d,0x3ec43f35,0xbf22bef1,0xbdc93f75
.long 0x3ec4248d,0x3f6dbf35,0x3f75bf46,0x3f62bf7f,0x3f6d248d,0xbec43f35,0xbdc9bf75,0x3f463f62
.long 0xbec4248d,0xbf6dbf35,0xbf62bf7f,0xbe95bf22,0xbf6d248d,0x3ec43f35,0x3f46bf62,0xbf7f3e95
.long 0x3ec4248d,0x3f6dbf35,0x3e95bf22,0xbef13dc9,0x3f6d248d,0xbec43f35,0xbf7fbe95,0x3f22bef1
.long 0xbec4248d,0xbf6dbf35,0x3ef13dc9,0x3f753f46,0xbf6d248d,0x3ec43f35,0x3f223ef1,0x3dc9bf75
.long 0x3ec4248d,0x3f6dbf35,0xbf753f46,0xbf623f7f,0x3f6d248d,0xbec43f35,0x3dc93f75,0xbf46bf62
.long 0xbec4248d,0xbf6dbf35,0x3f623f7f,0x3e953f22,0xbf6d248d,0x3ec43f35,0xbf463f62,0x3f7fbe95
.long 0x3ec4248d,0x3f6dbf35,0xbe953f22,0x3ef1bdc9,0x3f6d248d,0xbec43f35,0x3f7f3e95,0xbf223ef1
.long 0xbf6dbf80,0xbec4bf35,0xbf62bf7f,0xbe95bf22,0x3ec4bf80,0xbf6d3f35,0x3f46bf62,0xbf7f3e95
.long 0x3f6dbf80,0x3ec4bf35,0x3e95bf22,0xbef13dc9,0xbec4bf80,0x3f6d3f35,0xbf7fbe95,0x3f22bef1
.long 0xbf6dbf80,0xbec4bf35,0x3ef13dc9,0x3f753f46,0x3ec4bf80,0xbf6d3f35,0x3f223ef1,0x3dc9bf75
.long 0x3f6dbf80,0x3ec4bf35,0xbf753f46,0xbf623f7f,0xbec4bf80,0x3f6d3f35,0x3dc93f75,0xbf46bf62
.long 0xbf6dbf80,0xbec4bf35,0x3f623f7f,0x3e953f22,0x3ec4bf80,0xbf6d3f35,0xbf463f62,0x3f7fbe95
.long 0x3f6dbf80,0x3ec4bf35,0xbe953f22,0x3ef1bdc9,0xbec4bf80,0x3f6d3f35,0x3f7f3e95,0xbf223ef1
.long 0xbf6dbf80,0xbec4bf35,0xbef1bdc9,0xbf75bf46,0x3ec4bf80,0xbf6d3f35,0xbf22bef1,0xbdc93f75
.long 0x3f6dbf80,0x3ec4bf35,0x3f75bf46,0x3f62bf7f,0xbec4bf80,0x3f6d3f35,0xbdc9bf75,0x3f463f62
.long 0x3ec4a554,0x3f6d3f35,0x3ef13dc9,0x3f753f46,0x3f6da554,0xbec4bf35,0x3f223ef1,0x3dc9bf75
.long 0xbec4a554,0xbf6d3f35,0xbf753f46,0xbf623f7f,0xbf6da554,0x3ec4bf35,0x3dc93f75,0xbf46bf62
.long 0x3ec4a554,0x3f6d3f35,0x3f623f7f,0x3e953f22,0x3f6da554,0xbec4bf35,0xbf463f62,0x3f7fbe95
.long 0xbec4a554,0xbf6d3f35,0xbe953f22,0x3ef1bdc9,0xbf6da554,0x3ec4bf35,0x3f7f3e95,0xbf223ef1
.long 0x3ec4a554,0x3f6d3f35,0xbef1bdc9,0xbf75bf46,0x3f6da554,0xbec4bf35,0xbf22bef1,0xbdc93f75
.long 0xbec4a554,0xbf6d3f35,0x3f75bf46,0x3f62bf7f,0xbf6da554,0x3ec4bf35,0xbdc9bf75,0x3f463f62
.long 0x3ec4a554,0x3f6d3f35,0xbf62bf7f,0xbe95bf22,0x3f6da554,0xbec4bf35,0x3f46bf62,0xbf7f3e95
.long 0xbec4a554,0xbf6d3f35,0x3e95bf22,0xbef13dc9,0xbf6da554,0x3ec4bf35,0xbf7fbe95,0x3f22bef1
.long 0x3f553f7b,0x3e483f0e,0x3f463f75,0x3dc93ef1,0xbf7b3f0e,0x3f553e48,0xbf753dc9,0x3ef13f22
.long 0x3f0ebe48,0x3f7bbf55,0x3f7fbf62,0x3f46bf75,0x3e48bf55,0x3f0e3f7b,0xbf62bf46,0x3f753dc9
.long 0xbf55bf7b,0xbe48bf0e,0x3f223e95,0x3f7f3f62,0x3f7bbf0e,0xbf55be48,0xbe953f7f,0x3f62bf46
.long 0xbf0e3e48,0xbf7b3f55,0xbdc93ef1,0x3f22be95,0xbe483f55,0xbf0ebf7b,0x3ef1bf22,0x3e953f7f
.long 0x3f553f7b,0x3e483f0e,0xbf46bf75,0xbdc9bef1,0xbf7b3f0e,0x3f553e48,0x3f75bdc9,0xbef1bf22
.long 0x3f0ebe48,0x3f7bbf55,0xbf7f3f62,0xbf463f75,0x3e48bf55,0x3f0e3f7b,0x3f623f46,0xbf75bdc9
.long 0xbf55bf7b,0xbe48bf0e,0xbf22be95,0xbf7fbf62,0x3f7bbf0e,0xbf55be48,0x3e95bf7f,0xbf623f46
.long 0xbf0e3e48,0xbf7b3f55,0x3dc9bef1,0xbf223e95,0xbe483f55,0xbf0ebf7b,0xbef13f22,0xbe95bf7f
.long 0xbf0ebe48,0xbf7bbf55,0xbf22be95,0xbf7fbf62,0xbe48bf55,0xbf0e3f7b,0x3e95bf7f,0xbf623f46
.long 0x3f55bf7b,0x3e48bf0e,0x3dc9bef1,0xbf223e95,0xbf7bbf0e,0x3f55be48,0xbef13f22,0xbe95bf7f
.long 0x3f0e3e48,0x3f7b3f55,0x3f463f75,0x3dc93ef1,0x3e483f55,0x3f0ebf7b,0xbf753dc9,0x3ef13f22
.long 0xbf553f7b,0xbe483f0e,0x3f7fbf62,0x3f46bf75,0x3f7b3f0e,0xbf553e48,0xbf62bf46,0x3f753dc9
.long 0xbf0ebe48,0xbf7bbf55,0x3f223e95,0x3f7f3f62,0xbe48bf55,0xbf0e3f7b,0xbe953f7f,0x3f62bf46
.long 0x3f55bf7b,0x3e48bf0e,0xbdc93ef1,0x3f22be95,0xbf7bbf0e,0x3f55be48,0x3ef1bf22,0x3e953f7f
.long 0x3f0e3e48,0x3f7b3f55,0xbf46bf75,0xbdc9bef1,0x3e483f55,0x3f0ebf7b,0x3f75bdc9,0xbef1bf22
.long 0xbf553f7b,0xbe483f0e,0xbf7f3f62,0xbf463f75,0x3f7b3f0e,0xbf553e48,0x3f623f46,0xbf75bdc9
.long 0xbf55bf7b,0xbe48bf0e,0xbf46bf75,0xbdc9bef1,0x3f7bbf0e,0xbf55be48,0x3f75bdc9,0xbef1bf22
.long 0xbf0e3e48,0xbf7b3f55,0xbf7f3f62,0xbf463f75,0xbe483f55,0xbf0ebf7b,0x3f623f46,0xbf75bdc9
.long 0x3f553f7b,0x3e483f0e,0xbf22be95,0xbf7fbf62,0xbf7b3f0e,0x3f553e48,0x3e95bf7f,0xbf623f46
.long 0x3f0ebe48,0x3f7bbf55,0x3dc9bef1,0xbf223e95,0x3e48bf55,0x3f0e3f7b,0xbef13f22,0xbe95bf7f
.long 0xbf55bf7b,0xbe48bf0e,0x3f463f75,0x3dc93ef1,0x3f7bbf0e,0xbf55be48,0xbf753dc9,0x3ef13f22
.long 0xbf0e3e48,0xbf7b3f55,0x3f7fbf62,0x3f46bf75,0xbe483f55,0xbf0ebf7b,0xbf62bf46,0x3f753dc9
.long 0x3f553f7b,0x3e483f0e,0x3f223e95,0x3f7f3f62,0xbf7b3f0e,0x3f553e48,0xbe953f7f,0x3f62bf46
.long 0x3f0ebe48,0x3f7bbf55,0xbdc93ef1,0x3f22be95,0x3e48bf55,0x3f0e3f7b,0x3ef1bf22,0x3e953f7f
.long 0x3f0e3e48,0x3f7b3f55,0x3f223e95,0x3f7f3f62,0x3e483f55,0x3f0ebf7b,0xbe953f7f,0x3f62bf46
.long 0xbf553f7b,0xbe483f0e,0xbdc93ef1,0x3f22be95,0x3f7b3f0e,0xbf553e48,0x3ef1bf22,0x3e953f7f
.long 0xbf0ebe48,0xbf7bbf55,0xbf46bf75,0xbdc9bef1,0xbe48bf55,0xbf0e3f7b,0x3f75bdc9,0xbef1bf22
.long 0x3f55bf7b,0x3e48bf0e,0xbf7f3f62,0xbf463f75,0xbf7bbf0e,0x3f55be48,0x3f623f46,0xbf75bdc9
.long 0x3f0e3e48,0x3f7b3f55,0xbf22be95,0xbf7fbf62,0x3e483f55,0x3f0ebf7b,0x3e95bf7f,0xbf623f46
.long 0xbf553f7b,0xbe483f0e,0x3dc9bef1,0xbf223e95,0x3f7b3f0e,0xbf553e48,0xbef13f22,0xbe95bf7f
.long 0xbf0ebe48,0xbf7bbf55,0x3f463f75,0x3dc93ef1,0xbe48bf55,0xbf0e3f7b,0xbf753dc9,0x3ef13f22
.long 0x3f55bf7b,0x3e48bf0e,0x3f7fbf62,0x3f46bf75,0xbf7bbf0e,0x3f55be48,0xbf62bf46,0x3f753dc9
.long 0x3f353f80,0xbf35248d,0x3f0e3f7b,0xbf55be48,0xbf353f80,0x3f35a554,0xbf7b3f55,0x3e483f0e
.long 0xbf353f80,0x3f35248d,0x3e483f0e,0x3f7bbf55,0x3f353f80,0xbf35a554,0x3f553e48,0x3f0e3f7b
.long 0x3f353f80,0xbf35248d,0xbf55be48,0xbf0ebf7b,0xbf353f80,0x3f35a554,0xbe48bf0e,0xbf7b3f55
.long 0xbf353f80,0x3f35248d,0x3f7bbf55,0xbe48bf0e,0x3f353f80,0xbf35a554,0xbf0ebf7b,0x3f553e48
.long 0x3f353f80,0xbf35248d,0xbf0ebf7b,0x3f553e48,0xbf353f80,0x3f35a554,0x3f7bbf55,0xbe48bf0e
.long 0xbf353f80,0x3f35248d,0xbe48bf0e,0xbf7b3f55,0x3f353f80,0xbf35a554,0xbf55be48,0xbf0ebf7b
.long 0x3f353f80,0xbf35248d,0x3f553e48,0x3f0e3f7b,0xbf353f80,0x3f35a554,0x3e483f0e,0x3f7bbf55
.long 0xbf353f80,0x3f35248d,0xbf7b3f55,0x3e483f0e,0x3f353f80,0xbf35a554,0x3f0e3f7b,0xbf55be48
.long 0xbf35bf80,0x3f35a554,0xbf0ebf7b,0x3f553e48,0x3f35bf80,0xbf35248d,0x3f7bbf55,0xbe48bf0e
.long 0x3f35bf80,0xbf35a554,0xbe48bf0e,0xbf7b3f55,0xbf35bf80,0x3f35248d,0xbf55be48,0xbf0ebf7b
.long 0xbf35bf80,0x3f35a554,0x3f553e48,0x3f0e3f7b,0x3f35bf80,0xbf35248d,0x3e483f0e,0x3f7bbf55
.long 0x3f35bf80,0xbf35a554,0xbf7b3f55,0x3e483f0e,0xbf35bf80,0x3f35248d,0x3f0e3f7b,0xbf55be48
.long 0xbf35bf80,0x3f35a554,0x3f0e3f7b,0xbf55be48,0x3f35bf80,0xbf35248d,0xbf7b3f55,0x3e483f0e
.long 0x3f35bf80,0xbf35a554,0x3e483f0e,0x3f7bbf55,0xbf35bf80,0x3f35248d,0x3f553e48,0x3f0e3f7b
.long 0xbf35bf80,0x3f35a554,0xbf55be48,0xbf0ebf7b,0x3f35bf80,0xbf35248d,0xbe48bf0e,0xbf7b3f55
.long 0x3f35bf80,0xbf35a554,0x3f7bbf55,0xbe48bf0e,0xbf35bf80,0x3f35248d,0xbf0ebf7b,0x3f553e48
.long 0x3f353f80,0xbf35248d,0x3f0e3f7b,0xbf55be48,0xbf353f80,0x3f35a554,0xbf7b3f55,0x3e483f0e
.long 0xbf353f80,0x3f35248d,0x3e483f0e,0x3f7bbf55,0x3f353f80,0xbf35a554,0x3f553e48,0x3f0e3f7b
.long 0x3f353f80,0xbf35248d,0xbf55be48,0xbf0ebf7b,0xbf353f80,0x3f35a554,0xbe48bf0e,0xbf7b3f55
.long 0xbf353f80,0x3f35248d,0x3f7bbf55,0xbe48bf0e,0x3f353f80,0xbf35a554,0xbf0ebf7b,0x3f553e48
.long 0x3f353f80,0xbf35248d,0xbf0ebf7b,0x3f553e48,0xbf353f80,0x3f35a554,0x3f7bbf55,0xbe48bf0e
.long 0xbf353f80,0x3f35248d,0xbe48bf0e,0xbf7b3f55,0x3f353f80,0xbf35a554,0xbf55be48,0xbf0ebf7b
.long 0x3f353f80,0xbf35248d,0x3f553e48,0x3f0e3f7b,0xbf353f80,0x3f35a554,0x3e483f0e,0x3f7bbf55
.long 0xbf353f80,0x3f35248d,0xbf7b3f55,0x3e483f0e,0x3f353f80,0xbf35a554,0x3f0e3f7b,0xbf55be48
.long 0xbf35bf80,0x3f35a554,0xbf0ebf7b,0x3f553e48,0x3f35bf80,0xbf35248d,0x3f7bbf55,0xbe48bf0e
.long 0x3f35bf80,0xbf35a554,0xbe48bf0e,0xbf7b3f55,0xbf35bf80,0x3f35248d,0xbf55be48,0xbf0ebf7b
.long 0xbf35bf80,0x3f35a554,0x3f553e48,0x3f0e3f7b,0x3f35bf80,0xbf35248d,0x3e483f0e,0x3f7bbf55
.long 0x3f35bf80,0xbf35a554,0xbf7b3f55,0x3e483f0e,0xbf35bf80,0x3f35248d,0x3f0e3f7b,0xbf55be48
.long 0xbf35bf80,0x3f35a554,0x3f0e3f7b,0xbf55be48,0x3f35bf80,0xbf35248d,0xbf7b3f55,0x3e483f0e
.long 0x3f35bf80,0xbf35a554,0x3e483f0e,0x3f7bbf55,0xbf35bf80,0x3f35248d,0x3f553e48,0x3f0e3f7b
.long 0xbf35bf80,0x3f35a554,0xbf55be48,0xbf0ebf7b,0x3f35bf80,0xbf35248d,0xbe48bf0e,0xbf7b3f55
.long 0x3f35bf80,0xbf35a554,0x3f7bbf55,0xbe48bf0e,0xbf35bf80,0x3f35248d,0xbf0ebf7b,0x3f553e48
.long 0x3ec43f6d,0xbf6dbec4,0x3e483f55,0xbf7bbf0e,0xbf6d3ec4,0xbec43f6d,0xbf0ebe48,0xbf553f7b
.long 0x3f6dbec4,0x3ec4bf6d,0x3f55bf7b,0xbf0ebe48,0xbec4bf6d,0x3f6d3ec4,0xbf7bbf0e,0xbe48bf55
.long 0xbec4bf6d,0x3f6d3ec4,0x3f7b3f0e,0x3e483f55,0x3f6dbec4,0x3ec4bf6d,0xbf553f7b,0x3f0e3e48
.long 0xbf6d3ec4,0xbec43f6d,0x3f0e3e48,0x3f55bf7b,0x3ec43f6d,0xbf6dbec4,0xbe48bf55,0x3f7b3f0e
.long 0x3ec43f6d,0xbf6dbec4,0xbe48bf55,0x3f7b3f0e,0xbf6d3ec4,0xbec43f6d,0x3f0e3e48,0x3f55bf7b
.long 0x3f6dbec4,0x3ec4bf6d,0xbf553f7b,0x3f0e3e48,0xbec4bf6d,0x3f6d3ec4,0x3f7b3f0e,0x3e483f55
.long 0xbec4bf6d,0x3f6d3ec4,0xbf7bbf0e,0xbe48bf55,0x3f6dbec4,0x3ec4bf6d,0x3f55bf7b,0xbf0ebe48
.long 0xbf6d3ec4,0xbec43f6d,0xbf0ebe48,0xbf553f7b,0x3ec43f6d,0xbf6dbec4,0x3e483f55,0xbf7bbf0e
.long 0xbec4bf6d,0x3f6d3ec4,0xbe48bf55,0x3f7b3f0e,0x3f6dbec4,0x3ec4bf6d,0x3f0e3e48,0x3f55bf7b
.long 0xbf6d3ec4,0xbec43f6d,0xbf553f7b,0x3f0e3e48,0x3ec43f6d,0xbf6dbec4,0x3f7b3f0e,0x3e483f55
.long 0x3ec43f6d,0xbf6dbec4,0xbf7bbf0e,0xbe48bf55,0xbf6d3ec4,0xbec43f6d,0x3f55bf7b,0xbf0ebe48
.long 0x3f6dbec4,0x3ec4bf6d,0xbf0ebe48,0xbf553f7b,0xbec4bf6d,0x3f6d3ec4,0x3e483f55,0xbf7bbf0e
.long 0xbec4bf6d,0x3f6d3ec4,0x3e483f55,0xbf7bbf0e,0x3f6dbec4,0x3ec4bf6d,0xbf0ebe48,0xbf553f7b
.long 0xbf6d3ec4,0xbec43f6d,0x3f55bf7b,0xbf0ebe48,0x3ec43f6d,0xbf6dbec4,0xbf7bbf0e,0xbe48bf55
.long 0x3ec43f6d,0xbf6dbec4,0x3f7b3f0e,0x3e483f55,0xbf6d3ec4,0xbec43f6d,0xbf553f7b,0x3f0e3e48
.long 0x3f6dbec4,0x3ec4bf6d,0x3f0e3e48,0x3f55bf7b,0xbec4bf6d,0x3f6d3ec4,0xbe48bf55,0x3f7b3f0e
.long 0x3ec43f6d,0xbf6dbec4,0x3e483f55,0xbf7bbf0e,0xbf6d3ec4,0xbec43f6d,0xbf0ebe48,0xbf553f7b
.long 0x3f6dbec4,0x3ec4bf6d,0x3f55bf7b,0xbf0ebe48,0xbec4bf6d,0x3f6d3ec4,0xbf7bbf0e,0xbe48bf55
.long 0xbec4bf6d,0x3f6d3ec4,0x3f7b3f0e,0x3e483f55,0x3f6dbec4,0x3ec4bf6d,0xbf553f7b,0x3f0e3e48
.long 0xbf6d3ec4,0xbec43f6d,0x3f0e3e48,0x3f55bf7b,0x3ec43f6d,0xbf6dbec4,0xbe48bf55,0x3f7b3f0e
.long 0x3ec43f6d,0xbf6dbec4,0xbe48bf55,0x3f7b3f0e,0xbf6d3ec4,0xbec43f6d,0x3f0e3e48,0x3f55bf7b
.long 0x3f6dbec4,0x3ec4bf6d,0xbf553f7b,0x3f0e3e48,0xbec4bf6d,0x3f6d3ec4,0x3f7b3f0e,0x3e483f55
.long 0xbec4bf6d,0x3f6d3ec4,0xbf7bbf0e,0xbe48bf55,0x3f6dbec4,0x3ec4bf6d,0x3f55bf7b,0xbf0ebe48
.long 0xbf6d3ec4,0xbec43f6d,0xbf0ebe48,0xbf553f7b,0x3ec43f6d,0xbf6dbec4,0x3e483f55,0xbf7bbf0e
.long 0xbec4bf6d,0x3f6d3ec4,0xbe48bf55,0x3f7b3f0e,0x3f6dbec4,0x3ec4bf6d,0x3f0e3e48,0x3f55bf7b
.long 0xbf6d3ec4,0xbec43f6d,0xbf553f7b,0x3f0e3e48,0x3ec43f6d,0xbf6dbec4,0x3f7b3f0e,0x3e483f55
.long 0x3ec43f6d,0xbf6dbec4,0xbf7bbf0e,0xbe48bf55,0xbf6d3ec4,0xbec43f6d,0x3f55bf7b,0xbf0ebe48
.long 0x3f6dbec4,0x3ec4bf6d,0xbf0ebe48,0xbf553f7b,0xbec4bf6d,0x3f6d3ec4,0x3e483f55,0xbf7bbf0e
.long 0xbec4bf6d,0x3f6d3ec4,0x3e483f55,0xbf7bbf0e,0x3f6dbec4,0x3ec4bf6d,0xbf0ebe48,0xbf553f7b
.long 0xbf6d3ec4,0xbec43f6d,0x3f55bf7b,0xbf0ebe48,0x3ec43f6d,0xbf6dbec4,0xbf7bbf0e,0xbe48bf55
.long 0x3ec43f6d,0xbf6dbec4,0x3f7b3f0e,0x3e483f55,0xbf6d3ec4,0xbec43f6d,0xbf553f7b,0x3f0e3e48
.long 0x3f6dbec4,0x3ec4bf6d,0x3f0e3e48,0x3f55bf7b,0xbec4bf6d,0x3f6d3ec4,0xbe48bf55,0x3f7b3f0e
.long 0x3ec43f80,0xbf6dbf35,0x3dc93f75,0xbf46bf62,0xbf6d3f80,0xbec43f35,0xbf753f46,0xbf623f7f
.long 0xbec43f80,0x3f6dbf35,0x3f223ef1,0x3dc9bf75,0x3f6d3f80,0x3ec43f35,0x3ef13dc9,0x3f753f46
.long 0x3ec43f80,0xbf6dbf35,0xbf7fbe95,0x3f22bef1,0xbf6d3f80,0xbec43f35,0x3e95bf22,0xbef13dc9
.long 0xbec43f80,0x3f6dbf35,0x3f46bf62,0xbf7f3e95,0x3f6d3f80,0x3ec43f35,0xbf62bf7f,0xbe95bf22
.long 0x3ec43f80,0xbf6dbf35,0xbdc9bf75,0x3f463f62,0xbf6d3f80,0xbec43f35,0x3f75bf46,0x3f62bf7f
.long 0xbec43f80,0x3f6dbf35,0xbf22bef1,0xbdc93f75,0x3f6d3f80,0x3ec43f35,0xbef1bdc9,0xbf75bf46
.long 0x3ec43f80,0xbf6dbf35,0x3f7f3e95,0xbf223ef1,0xbf6d3f80,0xbec43f35,0xbe953f22,0x3ef1bdc9
.long 0xbec43f80,0x3f6dbf35,0xbf463f62,0x3f7fbe95,0x3f6d3f80,0x3ec43f35,0x3f623f7f,0x3e953f22
.long 0x3f6da554,0xbec43f35,0x3f7f3e95,0xbf223ef1,0x3ec4a554,0x3f6dbf35,0xbe953f22,0x3ef1bdc9
.long 0xbf6da554,0x3ec43f35,0xbf463f62,0x3f7fbe95,0xbec4a554,0xbf6dbf35,0x3f623f7f,0x3e953f22
.long 0x3f6da554,0xbec43f35,0x3dc93f75,0xbf46bf62,0x3ec4a554,0x3f6dbf35,0xbf753f46,0xbf623f7f
.long 0xbf6da554,0x3ec43f35,0x3f223ef1,0x3dc9bf75,0xbec4a554,0xbf6dbf35,0x3ef13dc9,0x3f753f46
.long 0x3f6da554,0xbec43f35,0xbf7fbe95,0x3f22bef1,0x3ec4a554,0x3f6dbf35,0x3e95bf22,0xbef13dc9
.long 0xbf6da554,0x3ec43f35,0x3f46bf62,0xbf7f3e95,0xbec4a554,0xbf6dbf35,0xbf62bf7f,0xbe95bf22
.long 0x3f6da554,0xbec43f35,0xbdc9bf75,0x3f463f62,0x3ec4a554,0x3f6dbf35,0x3f75bf46,0x3f62bf7f
.long 0xbf6da554,0x3ec43f35,0xbf22bef1,0xbdc93f75,0xbec4a554,0xbf6dbf35,0xbef1bdc9,0xbf75bf46
.long 0xbec4bf80,0x3f6d3f35,0xbdc9bf75,0x3f463f62,0x3f6dbf80,0x3ec4bf35,0x3f75bf46,0x3f62bf7f
.long 0x3ec4bf80,0xbf6d3f35,0xbf22bef1,0xbdc93f75,0xbf6dbf80,0xbec4bf35,0xbef1bdc9,0xbf75bf46
.long 0xbec4bf80,0x3f6d3f35,0x3f7f3e95,0xbf223ef1,0x3f6dbf80,0x3ec4bf35,0xbe953f22,0x3ef1bdc9
.long 0x3ec4bf80,0xbf6d3f35,0xbf463f62,0x3f7fbe95,0xbf6dbf80,0xbec4bf35,0x3f623f7f,0x3e953f22
.long 0xbec4bf80,0x3f6d3f35,0x3dc93f75,0xbf46bf62,0x3f6dbf80,0x3ec4bf35,0xbf753f46,0xbf623f7f
.long 0x3ec4bf80,0xbf6d3f35,0x3f223ef1,0x3dc9bf75,0xbf6dbf80,0xbec4bf35,0x3ef13dc9,0x3f753f46
.long 0xbec4bf80,0x3f6d3f35,0xbf7fbe95,0x3f22bef1,0x3f6dbf80,0x3ec4bf35,0x3e95bf22,0xbef13dc9
.long 0x3ec4bf80,0xbf6d3f35,0x3f46bf62,0xbf7f3e95,0xbf6dbf80,0xbec4bf35,0xbf62bf7f,0xbe95bf22
.long 0xbf6d248d,0x3ec4bf35,0xbf7fbe95,0x3f22bef1,0xbec4248d,0xbf6d3f35,0x3e95bf22,0xbef13dc9
.long 0x3f6d248d,0xbec4bf35,0x3f46bf62,0xbf7f3e95,0x3ec4248d,0x3f6d3f35,0xbf62bf7f,0xbe95bf22
.long 0xbf6d248d,0x3ec4bf35,0xbdc9bf75,0x3f463f62,0xbec4248d,0xbf6d3f35,0x3f75bf46,0x3f62bf7f
.long 0x3f6d248d,0xbec4bf35,0xbf22bef1,0xbdc93f75,0x3ec4248d,0x3f6d3f35,0xbef1bdc9,0xbf75bf46
.long 0xbf6d248d,0x3ec4bf35,0x3f7f3e95,0xbf223ef1,0xbec4248d,0xbf6d3f35,0xbe953f22,0x3ef1bdc9
.long 0x3f6d248d,0xbec4bf35,0xbf463f62,0x3f7fbe95,0x3ec4248d,0x3f6d3f35,0x3f623f7f,0x3e953f22
.long 0xbf6d248d,0x3ec4bf35,0x3dc93f75,0xbf46bf62,0xbec4248d,0xbf6d3f35,0xbf753f46,0xbf623f7f
.long 0x3f6d248d,0xbec4bf35,0x3f223ef1,0x3dc9bf75,0x3ec4248d,0x3f6d3f35,0x3ef13dc9,0x3f753f46
.long 0xbe483f55,0xbf0ebf7b,0xbef13f22,0xbe95bf7f,0xbf0e3e48,0xbf7b3f55,0x3dc9bef1,0xbf223e95
.long 0x3f7bbf0e,0xbf55be48,0x3e95bf7f,0xbf623f46,0xbf55bf7b,0xbe48bf0e,0xbf22be95,0xbf7fbf62
.long 0x3e48bf55,0x3f0e3f7b,0x3f623f46,0xbf75bdc9,0x3f0ebe48,0x3f7bbf55,0xbf7f3f62,0xbf463f75
.long 0xbf7b3f0e,0x3f553e48,0x3f75bdc9,0xbef1bf22,0x3f553f7b,0x3e483f0e,0xbf46bf75,0xbdc9bef1
.long 0xbe483f55,0xbf0ebf7b,0x3ef1bf22,0x3e953f7f,0xbf0e3e48,0xbf7b3f55,0xbdc93ef1,0x3f22be95
.long 0x3f7bbf0e,0xbf55be48,0xbe953f7f,0x3f62bf46,0xbf55bf7b,0xbe48bf0e,0x3f223e95,0x3f7f3f62
.long 0x3e48bf55,0x3f0e3f7b,0xbf62bf46,0x3f753dc9,0x3f0ebe48,0x3f7bbf55,0x3f7fbf62,0x3f46bf75
.long 0xbf7b3f0e,0x3f553e48,0xbf753dc9,0x3ef13f22,0x3f553f7b,0x3e483f0e,0x3f463f75,0x3dc93ef1
.long 0x3f7b3f0e,0xbf553e48,0x3f623f46,0xbf75bdc9,0xbf553f7b,0xbe483f0e,0xbf7f3f62,0xbf463f75
.long 0x3e483f55,0x3f0ebf7b,0x3f75bdc9,0xbef1bf22,0x3f0e3e48,0x3f7b3f55,0xbf46bf75,0xbdc9bef1
.long 0xbf7bbf0e,0x3f55be48,0x3ef1bf22,0x3e953f7f,0x3f55bf7b,0x3e48bf0e,0xbdc93ef1,0x3f22be95
.long 0xbe48bf55,0xbf0e3f7b,0xbe953f7f,0x3f62bf46,0xbf0ebe48,0xbf7bbf55,0x3f223e95,0x3f7f3f62
.long 0x3f7b3f0e,0xbf553e48,0xbf62bf46,0x3f753dc9,0xbf553f7b,0xbe483f0e,0x3f7fbf62,0x3f46bf75
.long 0x3e483f55,0x3f0ebf7b,0xbf753dc9,0x3ef13f22,0x3f0e3e48,0x3f7b3f55,0x3f463f75,0x3dc93ef1
.long 0xbf7bbf0e,0x3f55be48,0xbef13f22,0xbe95bf7f,0x3f55bf7b,0x3e48bf0e,0x3dc9bef1,0xbf223e95
.long 0xbe48bf55,0xbf0e3f7b,0x3e95bf7f,0xbf623f46,0xbf0ebe48,0xbf7bbf55,0xbf22be95,0xbf7fbf62
.long 0x3e48bf55,0x3f0e3f7b,0x3ef1bf22,0x3e953f7f,0x3f0ebe48,0x3f7bbf55,0xbdc93ef1,0x3f22be95
.long 0xbf7b3f0e,0x3f553e48,0xbe953f7f,0x3f62bf46,0x3f553f7b,0x3e483f0e,0x3f223e95,0x3f7f3f62
.long 0xbe483f55,0xbf0ebf7b,0xbf62bf46,0x3f753dc9,0xbf0e3e48,0xbf7b3f55,0x3f7fbf62,0x3f46bf75
.long 0x3f7bbf0e,0xbf55be48,0xbf753dc9,0x3ef13f22,0xbf55bf7b,0xbe48bf0e,0x3f463f75,0x3dc93ef1
.long 0x3e48bf55,0x3f0e3f7b,0xbef13f22,0xbe95bf7f,0x3f0ebe48,0x3f7bbf55,0x3dc9bef1,0xbf223e95
.long 0xbf7b3f0e,0x3f553e48,0x3e95bf7f,0xbf623f46,0x3f553f7b,0x3e483f0e,0xbf22be95,0xbf7fbf62
.long 0xbe483f55,0xbf0ebf7b,0x3f623f46,0xbf75bdc9,0xbf0e3e48,0xbf7b3f55,0xbf7f3f62,0xbf463f75
.long 0x3f7bbf0e,0xbf55be48,0x3f75bdc9,0xbef1bf22,0xbf55bf7b,0xbe48bf0e,0xbf46bf75,0xbdc9bef1
.long 0xbf7bbf0e,0x3f55be48,0xbf62bf46,0x3f753dc9,0x3f55bf7b,0x3e48bf0e,0x3f7fbf62,0x3f46bf75
.long 0xbe48bf55,0xbf0e3f7b,0xbf753dc9,0x3ef13f22,0xbf0ebe48,0xbf7bbf55,0x3f463f75,0x3dc93ef1
.long 0x3f7b3f0e,0xbf553e48,0xbef13f22,0xbe95bf7f,0xbf553f7b,0xbe483f0e,0x3dc9bef1,0xbf223e95
.long 0x3e483f55,0x3f0ebf7b,0x3e95bf7f,0xbf623f46,0x3f0e3e48,0x3f7b3f55,0xbf22be95,0xbf7fbf62
.long 0xbf7bbf0e,0x3f55be48,0x3f623f46,0xbf75bdc9,0x3f55bf7b,0x3e48bf0e,0xbf7f3f62,0xbf463f75
.long 0xbe48bf55,0xbf0e3f7b,0x3f75bdc9,0xbef1bf22,0xbf0ebe48,0xbf7bbf55,0xbf46bf75,0xbdc9bef1
.long 0x3f7b3f0e,0xbf553e48,0x3ef1bf22,0x3e953f7f,0xbf553f7b,0xbe483f0e,0xbdc93ef1,0x3f22be95
.long 0x3e483f55,0x3f0ebf7b,0xbe953f7f,0x3f62bf46,0x3f0e3e48,0x3f7b3f55,0x3f223e95,0x3f7f3f62
.long 0x80008000,0x80008000,0x80008000,0x80008000,0xbf808000,0x3f80a50d,0xbf6dbec4,0x3f6d3ec4
.long 0xa50d8000,0xa50d8000,0x3f35bf35,0x3f35bf35,0x3f808000,0xbf80a50d,0x3ec4bf6d,0xbec43f6d
.long 0x80008000,0x80008000,0xbf80bf80,0xbf80bf80,0xbf808000,0x3f80a50d,0x3ec4bf6d,0xbec43f6d
.long 0xa50d8000,0xa50d8000,0x3f35bf35,0x3f35bf35,0x3f808000,0xbf80a50d,0xbf6dbec4,0x3f6d3ec4
.long 0x80008000,0x80008000,0xa50da50d,0xa50da50d,0xbf808000,0x3f80a50d,0x3f6d3ec4,0xbf6dbec4
.long 0xa50d8000,0xa50d8000,0xbf353f35,0xbf353f35,0x3f808000,0xbf80a50d,0xbec43f6d,0x3ec4bf6d
.long 0x80008000,0x80008000,0x3f803f80,0x3f803f80,0xbf808000,0x3f80a50d,0xbec43f6d,0x3ec4bf6d
.long 0xa50d8000,0xa50d8000,0xbf353f35,0xbf353f35,0x3f808000,0xbf80a50d,0x3f6d3ec4,0xbf6dbec4
.long 0x80008000,0x80008000,0x80008000,0x80008000,0xbf808000,0x3f80a50d,0xbf6dbec4,0x3f6d3ec4
.long 0xa50d8000,0xa50d8000,0x3f35bf35,0x3f35bf35,0x3f808000,0xbf80a50d,0x3ec4bf6d,0xbec43f6d
.long 0x80008000,0x80008000,0xbf80bf80,0xbf80bf80,0xbf808000,0x3f80a50d,0x3ec4bf6d,0xbec43f6d
.long 0xa50d8000,0xa50d8000,0x3f35bf35,0x3f35bf35,0x3f808000,0xbf80a50d,0xbf6dbec4,0x3f6d3ec4
.long 0x80008000,0x80008000,0xa50da50d,0xa50da50d,0xbf808000,0x3f80a50d,0x3f6d3ec4,0xbf6dbec4
.long 0xa50d8000,0xa50d8000,0xbf353f35,0xbf353f35,0x3f808000,0xbf80a50d,0xbec43f6d,0x3ec4bf6d
.long 0x80008000,0x80008000,0x3f803f80,0x3f803f80,0xbf808000,0x3f80a50d,0xbec43f6d,0x3ec4bf6d
.long 0xa50d8000,0xa50d8000,0xbf353f35,0xbf353f35,0x3f808000,0xbf80a50d,0x3f6d3ec4,0xbf6dbec4
.long 0x80008000,0x80008000,0x80008000,0x80008000,0xbf808000,0x3f80a50d,0xbf6dbec4,0x3f6d3ec4
.long 0xa50d8000,0xa50d8000,0x3f35bf35,0x3f35bf35,0x3f808000,0xbf80a50d,0x3ec4bf6d,0xbec43f6d
.long 0x80008000,0x80008000,0xbf80bf80,0xbf80bf80,0xbf808000,0x3f80a50d,0x3ec4bf6d,0xbec43f6d
.long 0xa50d8000,0xa50d8000,0x3f35bf35,0x3f35bf35,0x3f808000,0xbf80a50d,0xbf6dbec4,0x3f6d3ec4
.long 0x80008000,0x80008000,0xa50da50d,0xa50da50d,0xbf808000,0x3f80a50d,0x3f6d3ec4,0xbf6dbec4
.long 0xa50d8000,0xa50d8000,0xbf353f35,0xbf353f35,0x3f808000,0xbf80a50d,0xbec43f6d,0x3ec4bf6d
.long 0x80008000,0x80008000,0x3f803f80,0x3f803f80,0xbf808000,0x3f80a50d,0xbec43f6d,0x3ec4bf6d
.long 0xa50d8000,0xa50d8000,0xbf353f35,0xbf353f35,0x3f808000,0xbf80a50d,0x3f6d3ec4,0xbf6dbec4
.long 0x80008000,0x80008000,0x80008000,0x80008000,0xbf808000,0x3f80a50d,0xbf6dbec4,0x3f6d3ec4
.long 0xa50d8000,0xa50d8000,0x3f35bf35,0x3f35bf35,0x3f808000,0xbf80a50d,0x3ec4bf6d,0xbec43f6d
.long 0x80008000,0x80008000,0xbf80bf80,0xbf80bf80,0xbf808000,0x3f80a50d,0x3ec4bf6d,0xbec43f6d
.long 0xa50d8000,0xa50d8000,0x3f35bf35,0x3f35bf35,0x3f808000,0xbf80a50d,0xbf6dbec4,0x3f6d3ec4
.long 0x80008000,0x80008000,0xa50da50d,0xa50da50d,0xbf808000,0x3f80a50d,0x3f6d3ec4,0xbf6dbec4
.long 0xa50d8000,0xa50d8000,0xbf353f35,0xbf353f35,0x3f808000,0xbf80a50d,0xbec43f6d,0x3ec4bf6d
.long 0x80008000,0x80008000,0x3f803f80,0x3f803f80,0xbf808000,0x3f80a50d,0xbec43f6d,0x3ec4bf6d
.long 0xa50d8000,0xa50d8000,0xbf353f35,0xbf353f35,0x3f808000,0xbf80a50d,0x3f6d3ec4,0xbf6dbec4
.long 0x80008000,0x80008000,0x80008000,0x80008000,0xbf35bf35,0x3f353f35,0xbec4bf6d,0x3ec43f6d
.long 0x3f80bf80,0x3f80bf80,0x3f35bf35,0x3f35bf35,0xbf35bf35,0x3f353f35,0xbf6d3ec4,0x3f6dbec4
.long 0xa50da50d,0xa50da50d,0x3f803f80,0x3f803f80,0x3f353f35,0xbf35bf35,0xbf6d3ec4,0x3f6dbec4
.long 0xbf803f80,0xbf803f80,0x3f35bf35,0x3f35bf35,0x3f353f35,0xbf35bf35,0xbec4bf6d,0x3ec43f6d
.long 0x80008000,0x80008000,0xa50da50d,0xa50da50d,0xbf35bf35,0x3f353f35,0x3ec43f6d,0xbec4bf6d
.long 0x3f80bf80,0x3f80bf80,0xbf353f35,0xbf353f35,0xbf35bf35,0x3f353f35,0x3f6dbec4,0xbf6d3ec4
.long 0xa50da50d,0xa50da50d,0xbf80bf80,0xbf80bf80,0x3f353f35,0xbf35bf35,0x3f6dbec4,0xbf6d3ec4
.long 0xbf803f80,0xbf803f80,0xbf353f35,0xbf353f35,0x3f353f35,0xbf35bf35,0x3ec43f6d,0xbec4bf6d
.long 0x80008000,0x80008000,0x80008000,0x80008000,0xbf35bf35,0x3f353f35,0xbec4bf6d,0x3ec43f6d
.long 0x3f80bf80,0x3f80bf80,0x3f35bf35,0x3f35bf35,0xbf35bf35,0x3f353f35,0xbf6d3ec4,0x3f6dbec4
.long 0xa50da50d,0xa50da50d,0x3f803f80,0x3f803f80,0x3f353f35,0xbf35bf35,0xbf6d3ec4,0x3f6dbec4
.long 0xbf803f80,0xbf803f80,0x3f35bf35,0x3f35bf35,0x3f353f35,0xbf35bf35,0xbec4bf6d,0x3ec43f6d
.long 0x80008000,0x80008000,0xa50da50d,0xa50da50d,0xbf35bf35,0x3f353f35,0x3ec43f6d,0xbec4bf6d
.long 0x3f80bf80,0x3f80bf80,0xbf353f35,0xbf353f35,0xbf35bf35,0x3f353f35,0x3f6dbec4,0xbf6d3ec4
.long 0xa50da50d,0xa50da50d,0xbf80bf80,0xbf80bf80,0x3f353f35,0xbf35bf35,0x3f6dbec4,0xbf6d3ec4
.long 0xbf803f80,0xbf803f80,0xbf353f35,0xbf353f35,0x3f353f35,0xbf35bf35,0x3ec43f6d,0xbec4bf6d
.long 0x80008000,0x80008000,0x80008000,0x80008000,0xbf35bf35,0x3f353f35,0xbec4bf6d,0x3ec43f6d
.long 0x3f80bf80,0x3f80bf80,0x3f35bf35,0x3f35bf35,0xbf35bf35,0x3f353f35,0xbf6d3ec4,0x3f6dbec4
.long 0xa50da50d,0xa50da50d,0x3f803f80,0x3f803f80,0x3f353f35,0xbf35bf35,0xbf6d3ec4,0x3f6dbec4
.long 0xbf803f80,0xbf803f80,0x3f35bf35,0x3f35bf35,0x3f353f35,0xbf35bf35,0xbec4bf6d,0x3ec43f6d
.long 0x80008000,0x80008000,0xa50da50d,0xa50da50d,0xbf35bf35,0x3f353f35,0x3ec43f6d,0xbec4bf6d
.long 0x3f80bf80,0x3f80bf80,0xbf353f35,0xbf353f35,0xbf35bf35,0x3f353f35,0x3f6dbec4,0xbf6d3ec4
.long 0xa50da50d,0xa50da50d,0xbf80bf80,0xbf80bf80,0x3f353f35,0xbf35bf35,0x3f6dbec4,0xbf6d3ec4
.long 0xbf803f80,0xbf803f80,0xbf353f35,0xbf353f35,0x3f353f35,0xbf35bf35,0x3ec43f6d,0xbec4bf6d
.long 0x80008000,0x80008000,0x80008000,0x80008000,0xbf35bf35,0x3f353f35,0xbec4bf6d,0x3ec43f6d
.long 0x3f80bf80,0x3f80bf80,0x3f35bf35,0x3f35bf35,0xbf35bf35,0x3f353f35,0xbf6d3ec4,0x3f6dbec4
.long 0xa50da50d,0xa50da50d,0x3f803f80,0x3f803f80,0x3f353f35,0xbf35bf35,0xbf6d3ec4,0x3f6dbec4
.long 0xbf803f80,0xbf803f80,0x3f35bf35,0x3f35bf35,0x3f353f35,0xbf35bf35,0xbec4bf6d,0x3ec43f6d
.long 0x80008000,0x80008000,0xa50da50d,0xa50da50d,0xbf35bf35,0x3f353f35,0x3ec43f6d,0xbec4bf6d
.long 0x3f80bf80,0x3f80bf80,0xbf353f35,0xbf353f35,0xbf35bf35,0x3f353f35,0x3f6dbec4,0xbf6d3ec4
.long 0xa50da50d,0xa50da50d,0xbf80bf80,0xbf80bf80,0x3f353f35,0xbf35bf35,0x3f6dbec4,0xbf6d3ec4
.long 0xbf803f80,0xbf803f80,0xbf353f35,0xbf353f35,0x3f353f35,0xbf35bf35,0x3ec43f6d,0xbec4bf6d
.long 0xbec48000,0xbf6dbf35,0xbef1bdc9,0xbf75bf46,0xbf6d8000,0x3ec43f35,0xbf22bef1,0xbdc93f75
.long 0x3ec48000,0x3f6dbf35,0x3f75bf46,0x3f62bf7f,0x3f6d8000,0xbec43f35,0xbdc9bf75,0x3f463f62
.long 0xbec48000,0xbf6dbf35,0xbf62bf7f,0xbe95bf22,0xbf6d8000,0x3ec43f35,0x3f46bf62,0xbf7f3e95
.long 0x3ec48000,0x3f6dbf35,0x3e95bf22,0xbef13dc9,0x3f6d8000,0xbec43f35,0xbf7fbe95,0x3f22bef1
.long 0xbec48000,0xbf6dbf35,0x3ef13dc9,0x3f753f46,0xbf6d8000,0x3ec43f35,0x3f223ef1,0x3dc9bf75
.long 0x3ec48000,0x3f6dbf35,0xbf753f46,0xbf623f7f,0x3f6d8000,0xbec43f35,0x3dc93f75,0xbf46bf62
.long 0xbec48000,0xbf6dbf35,0x3f623f7f,0x3e953f22,0xbf6d8000,0x3ec43f35,0xbf463f62,0x3f7fbe95
.long 0x3ec48000,0x3f6dbf35,0xbe953f22,0x3ef1bdc9,0x3f6d8000,0xbec43f35,0x3f7f3e95,0xbf223ef1
.long 0xbf6dbf80,0xbec4bf35,0xbf62bf7f,0xbe95bf22,0x3ec4bf80,0xbf6d3f35,0x3f46bf62,0xbf7f3e95
.long 0x3f6dbf80,0x3ec4bf35,0x3e95bf22,0xbef13dc9,0xbec4bf80,0x3f6d3f35,0xbf7fbe95,0x3f22bef1
.long 0xbf6dbf80,0xbec4bf35,0x3ef13dc9,0x3f753f46,0x3ec4bf80,0xbf6d3f35,0x3f223ef1,0x3dc9bf75
.long 0x3f6dbf80,0x3ec4bf35,0xbf753f46,0xbf623f7f,0xbec4bf80,0x3f6d3f35,0x3dc93f75,0xbf46bf62
.long 0xbf6dbf80,0xbec4bf35,0x3f623f7f,0x3e953f22,0x3ec4bf80,0xbf6d3f35,0xbf463f62,0x3f7fbe95
.long 0x3f6dbf80,0x3ec4bf35,0xbe953f22,0x3ef1bdc9,0xbec4bf80,0x3f6d3f35,0x3f7f3e95,0xbf223ef1
.long 0xbf6dbf80,0xbec4bf35,0xbef1bdc9,0xbf75bf46,0x3ec4bf80,0xbf6d3f35,0xbf22bef1,0xbdc93f75
.long 0x3f6dbf80,0x3ec4bf35,0x3f75bf46,0x3f62bf7f,0xbec4bf80,0x3f6d3f35,0xbdc9bf75,0x3f463f62
.long 0x3ec4a50d,0x3f6d3f35,0x3ef13dc9,0x3f753f46,0x3f6da50d,0xbec4bf35,0x3f223ef1,0x3dc9bf75
.long 0xbec4a50d,0xbf6d3f35,0xbf753f46,0xbf623f7f,0xbf6da50d,0x3ec4bf35,0x3dc93f75,0xbf46bf62
.long 0x3ec4a50d,0x3f6d3f35,0x3f623f7f,0x3e953f22,0x3f6da50d,0xbec4bf35,0xbf463f62,0x3f7fbe95
.long 0xbec4a50d,0xbf6d3f35,0xbe953f22,0x3ef1bdc9,0xbf6da50d,0x3ec4bf35,0x3f7f3e95,0xbf223ef1
.long 0x3ec4a50d,0x3f6d3f35,0xbef1bdc9,0xbf75bf46,0x3f6da50d,0xbec4bf35,0xbf22bef1,0xbdc93f75
.long 0xbec4a50d,0xbf6d3f35,0x3f75bf46,0x3f62bf7f,0xbf6da50d,0x3ec4bf35,0xbdc9bf75,0x3f463f62
.long 0x3ec4a50d,0x3f6d3f35,0xbf62bf7f,0xbe95bf22,0x3f6da50d,0xbec4bf35,0x3f46bf62,0xbf7f3e95
.long 0xbec4a50d,0xbf6d3f35,0x3e95bf22,0xbef13dc9,0xbf6da50d,0x3ec4bf35,0xbf7fbe95,0x3f22bef1
.long 0x3f6d3f80,0x3ec43f35,0x3f623f7f,0x3e953f22,0xbec43f80,0x3f6dbf35,0xbf463f62,0x3f7fbe95
.long 0xbf6d3f80,0xbec43f35,0xbe953f22,0x3ef1bdc9,0x3ec43f80,0xbf6dbf35,0x3f7f3e95,0xbf223ef1
.long 0x3f6d3f80,0x3ec43f35,0xbef1bdc9,0xbf75bf46,0xbec43f80,0x3f6dbf35,0xbf22bef1,0xbdc93f75
.long 0xbf6d3f80,0xbec43f35,0x3f75bf46,0x3f62bf7f,0x3ec43f80,0xbf6dbf35,0xbdc9bf75,0x3f463f62
.long 0x3f6d3f80,0x3ec43f35,0xbf62bf7f,0xbe95bf22,0xbec43f80,0x3f6dbf35,0x3f46bf62,0xbf7f3e95
.long 0xbf6d3f80,0xbec43f35,0x3e95bf22,0xbef13dc9,0x3ec43f80,0xbf6dbf35,0xbf7fbe95,0x3f22bef1
.long 0x3f6d3f80,0x3ec43f35,0x3ef13dc9,0x3f753f46,0xbec43f80,0x3f6dbf35,0x3f223ef1,0x3dc9bf75
.long 0xbf6d3f80,0xbec43f35,0xbf753f46,0xbf623f7f,0x3ec43f80,0xbf6dbf35,0x3dc93f75,0xbf46bf62
.long 0xbf0ebe48,0xbf7bbf55,0xbf22be95,0xbf7fbf62,0xbe48bf55,0xbf0e3f7b,0x3e95bf7f,0xbf623f46
.long 0x3f55bf7b,0x3e48bf0e,0x3dc9bef1,0xbf223e95,0xbf7bbf0e,0x3f55be48,0xbef13f22,0xbe95bf7f
.long 0x3f0e3e48,0x3f7b3f55,0x3f463f75,0x3dc93ef1,0x3e483f55,0x3f0ebf7b,0xbf753dc9,0x3ef13f22
.long 0xbf553f7b,0xbe483f0e,0x3f7fbf62,0x3f46bf75,0x3f7b3f0e,0xbf553e48,0xbf62bf46,0x3f753dc9
.long 0xbf0ebe48,0xbf7bbf55,0x3f223e95,0x3f7f3f62,0xbe48bf55,0xbf0e3f7b,0xbe953f7f,0x3f62bf46
.long 0x3f55bf7b,0x3e48bf0e,0xbdc93ef1,0x3f22be95,0xbf7bbf0e,0x3f55be48,0x3ef1bf22,0x3e953f7f
.long 0x3f0e3e48,0x3f7b3f55,0xbf46bf75,0xbdc9bef1,0x3e483f55,0x3f0ebf7b,0x3f75bdc9,0xbef1bf22
.long 0xbf553f7b,0xbe483f0e,0xbf7f3f62,0xbf463f75,0x3f7b3f0e,0xbf553e48,0x3f623f46,0xbf75bdc9
.long 0xbf55bf7b,0xbe48bf0e,0xbf46bf75,0xbdc9bef1,0x3f7bbf0e,0xbf55be48,0x3f75bdc9,0xbef1bf22
.long 0xbf0e3e48,0xbf7b3f55,0xbf7f3f62,0xbf463f75,0xbe483f55,0xbf0ebf7b,0x3f623f46,0xbf75bdc9
.long 0x3f553f7b,0x3e483f0e,0xbf22be95,0xbf7fbf62,0xbf7b3f0e,0x3f553e48,0x3e95bf7f,0xbf623f46
.long 0x3f0ebe48,0x3f7bbf55,0x3dc9bef1,0xbf223e95,0x3e48bf55,0x3f0e3f7b,0xbef13f22,0xbe95bf7f
.long 0xbf55bf7b,0xbe48bf0e,0x3f463f75,0x3dc93ef1,0x3f7bbf0e,0xbf55be48,0xbf753dc9,0x3ef13f22
.long 0xbf0e3e48,0xbf7b3f55,0x3f7fbf62,0x3f46bf75,0xbe483f55,0xbf0ebf7b,0xbf62bf46,0x3f753dc9
.long 0x3f553f7b,0x3e483f0e,0x3f223e95,0x3f7f3f62,0xbf7b3f0e,0x3f553e48,0xbe953f7f,0x3f62bf46
.long 0x3f0ebe48,0x3f7bbf55,0xbdc93ef1,0x3f22be95,0x3e48bf55,0x3f0e3f7b,0x3ef1bf22,0x3e953f7f
.long 0x3f0e3e48,0x3f7b3f55,0x3f223e95,0x3f7f3f62,0x3e483f55,0x3f0ebf7b,0xbe953f7f,0x3f62bf46
.long 0xbf553f7b,0xbe483f0e,0xbdc93ef1,0x3f22be95,0x3f7b3f0e,0xbf553e48,0x3ef1bf22,0x3e953f7f
.long 0xbf0ebe48,0xbf7bbf55,0xbf46bf75,0xbdc9bef1,0xbe48bf55,0xbf0e3f7b,0x3f75bdc9,0xbef1bf22
.long 0x3f55bf7b,0x3e48bf0e,0xbf7f3f62,0xbf463f75,0xbf7bbf0e,0x3f55be48,0x3f623f46,0xbf75bdc9
.long 0x3f0e3e48,0x3f7b3f55,0xbf22be95,0xbf7fbf62,0x3e483f55,0x3f0ebf7b,0x3e95bf7f,0xbf623f46
.long 0xbf553f7b,0xbe483f0e,0x3dc9bef1,0xbf223e95,0x3f7b3f0e,0xbf553e48,0xbef13f22,0xbe95bf7f
.long 0xbf0ebe48,0xbf7bbf55,0x3f463f75,0x3dc93ef1,0xbe48bf55,0xbf0e3f7b,0xbf753dc9,0x3ef13f22
.long 0x3f55bf7b,0x3e48bf0e,0x3f7fbf62,0x3f46bf75,0xbf7bbf0e,0x3f55be48,0xbf62bf46,0x3f753dc9
.long 0x3f553f7b,0x3e483f0e,0x3f463f75,0x3dc93ef1,0xbf7b3f0e,0x3f553e48,0xbf753dc9,0x3ef13f22
.long 0x3f0ebe48,0x3f7bbf55,0x3f7fbf62,0x3f46bf75,0x3e48bf55,0x3f0e3f7b,0xbf62bf46,0x3f753dc9
.long 0xbf55bf7b,0xbe48bf0e,0x3f223e95,0x3f7f3f62,0x3f7bbf0e,0xbf55be48,0xbe953f7f,0x3f62bf46
.long 0xbf0e3e48,0xbf7b3f55,0xbdc93ef1,0x3f22be95,0xbe483f55,0xbf0ebf7b,0x3ef1bf22,0x3e953f7f
.long 0x3f553f7b,0x3e483f0e,0xbf46bf75,0xbdc9bef1,0xbf7b3f0e,0x3f553e48,0x3f75bdc9,0xbef1bf22
.long 0x3f0ebe48,0x3f7bbf55,0xbf7f3f62,0xbf463f75,0x3e48bf55,0x3f0e3f7b,0x3f623f46,0xbf75bdc9
.long 0xbf55bf7b,0xbe48bf0e,0xbf22be95,0xbf7fbf62,0x3f7bbf0e,0xbf55be48,0x3e95bf7f,0xbf623f46
.long 0xbf0e3e48,0xbf7b3f55,0x3dc9bef1,0xbf223e95,0xbe483f55,0xbf0ebf7b,0xbef13f22,0xbe95bf7f
.long 0xbf358000,0xbf35bf80,0xbf55be48,0xbf0ebf7b,0xbf358000,0xbf353f80,0xbe48bf0e,0xbf7b3f55
.long 0x3f358000,0x3f35bf80,0x3f7bbf55,0xbe48bf0e,0x3f358000,0x3f353f80,0xbf0ebf7b,0x3f553e48
.long 0xbf358000,0xbf35bf80,0xbf0ebf7b,0x3f553e48,0xbf358000,0xbf353f80,0x3f7bbf55,0xbe48bf0e
.long 0x3f358000,0x3f35bf80,0xbe48bf0e,0xbf7b3f55,0x3f358000,0x3f353f80,0xbf55be48,0xbf0ebf7b
.long 0xbf358000,0xbf35bf80,0x3f553e48,0x3f0e3f7b,0xbf358000,0xbf353f80,0x3e483f0e,0x3f7bbf55
.long 0x3f358000,0x3f35bf80,0xbf7b3f55,0x3e483f0e,0x3f358000,0x3f353f80,0x3f0e3f7b,0xbf55be48
.long 0xbf358000,0xbf35bf80,0x3f0e3f7b,0xbf55be48,0xbf358000,0xbf353f80,0xbf7b3f55,0x3e483f0e
.long 0x3f358000,0x3f35bf80,0x3e483f0e,0x3f7bbf55,0x3f358000,0x3f353f80,0x3f553e48,0x3f0e3f7b
.long 0x3f35a50d,0x3f353f80,0x3f553e48,0x3f0e3f7b,0x3f35a50d,0x3f35bf80,0x3e483f0e,0x3f7bbf55
.long 0xbf35a50d,0xbf353f80,0xbf7b3f55,0x3e483f0e,0xbf35a50d,0xbf35bf80,0x3f0e3f7b,0xbf55be48
.long 0x3f35a50d,0x3f353f80,0x3f0e3f7b,0xbf55be48,0x3f35a50d,0x3f35bf80,0xbf7b3f55,0x3e483f0e
.long 0xbf35a50d,0xbf353f80,0x3e483f0e,0x3f7bbf55,0xbf35a50d,0xbf35bf80,0x3f553e48,0x3f0e3f7b
.long 0x3f35a50d,0x3f353f80,0xbf55be48,0xbf0ebf7b,0x3f35a50d,0x3f35bf80,0xbe48bf0e,0xbf7b3f55
.long 0xbf35a50d,0xbf353f80,0x3f7bbf55,0xbe48bf0e,0xbf35a50d,0xbf35bf80,0xbf0ebf7b,0x3f553e48
.long 0x3f35a50d,0x3f353f80,0xbf0ebf7b,0x3f553e48,0x3f35a50d,0x3f35bf80,0x3f7bbf55,0xbe48bf0e
.long 0xbf35a50d,0xbf353f80,0xbe48bf0e,0xbf7b3f55,0xbf35a50d,0xbf35bf80,0xbf55be48,0xbf0ebf7b
.long 0xbf358000,0xbf35bf80,0xbf55be48,0xbf0ebf7b,0xbf358000,0xbf353f80,0xbe48bf0e,0xbf7b3f55
.long 0x3f358000,0x3f35bf80,0x3f7bbf55,0xbe48bf0e,0x3f358000,0x3f353f80,0xbf0ebf7b,0x3f553e48
.long 0xbf358000,0xbf35bf80,0xbf0ebf7b,0x3f553e48,0xbf358000,0xbf353f80,0x3f7bbf55,0xbe48bf0e
.long 0x3f358000,0x3f35bf80,0xbe48bf0e,0xbf7b3f55,0x3f358000,0x3f353f80,0xbf55be48,0xbf0ebf7b
.long 0xbf358000,0xbf35bf80,0x3f553e48,0x3f0e3f7b,0xbf358000,0xbf353f80,0x3e483f0e,0x3f7bbf55
.long 0x3f358000,0x3f35bf80,0xbf7b3f55,0x3e483f0e,0x3f358000,0x3f353f80,0x3f0e3f7b,0xbf55be48
.long 0xbf358000,0xbf35bf80,0x3f0e3f7b,0xbf55be48,0xbf358000,0xbf353f80,0xbf7b3f55,0x3e483f0e
.long 0x3f358000,0x3f35bf80,0x3e483f0e,0x3f7bbf55,0x3f358000,0x3f353f80,0x3f553e48,0x3f0e3f7b
.long 0x3f35a50d,0x3f353f80,0x3f553e48,0x3f0e3f7b,0x3f35a50d,0x3f35bf80,0x3e483f0e,0x3f7bbf55
.long 0xbf35a50d,0xbf353f80,0xbf7b3f55,0x3e483f0e,0xbf35a50d,0xbf35bf80,0x3f0e3f7b,0xbf55be48
.long 0x3f35a50d,0x3f353f80,0x3f0e3f7b,0xbf55be48,0x3f35a50d,0x3f35bf80,0xbf7b3f55,0x3e483f0e
.long 0xbf35a50d,0xbf353f80,0x3e483f0e,0x3f7bbf55,0xbf35a50d,0xbf35bf80,0x3f553e48,0x3f0e3f7b
.long 0x3f35a50d,0x3f353f80,0xbf55be48,0xbf0ebf7b,0x3f35a50d,0x3f35bf80,0xbe48bf0e,0xbf7b3f55
.long 0xbf35a50d,0xbf353f80,0x3f7bbf55,0xbe48bf0e,0xbf35a50d,0xbf35bf80,0xbf0ebf7b,0x3f553e48
.long 0x3f35a50d,0x3f353f80,0xbf0ebf7b,0x3f553e48,0x3f35a50d,0x3f35bf80,0x3f7bbf55,0xbe48bf0e
.long 0xbf35a50d,0xbf353f80,0xbe48bf0e,0xbf7b3f55,0xbf35a50d,0xbf35bf80,0xbf55be48,0xbf0ebf7b
.long 0xbf6dbec4,0xbec4bf6d,0xbf7bbf0e,0xbe48bf55,0x3ec4bf6d,0xbf6d3ec4,0x3f55bf7b,0xbf0ebe48
.long 0x3ec4bf6d,0xbf6d3ec4,0xbf0ebe48,0xbf553f7b,0xbf6dbec4,0xbec4bf6d,0x3e483f55,0xbf7bbf0e
.long 0x3f6d3ec4,0x3ec43f6d,0x3e483f55,0xbf7bbf0e,0xbec43f6d,0x3f6dbec4,0xbf0ebe48,0xbf553f7b
.long 0xbec43f6d,0x3f6dbec4,0x3f55bf7b,0xbf0ebe48,0x3f6d3ec4,0x3ec43f6d,0xbf7bbf0e,0xbe48bf55
.long 0xbf6dbec4,0xbec4bf6d,0x3f7b3f0e,0x3e483f55,0x3ec4bf6d,0xbf6d3ec4,0xbf553f7b,0x3f0e3e48
.long 0x3ec4bf6d,0xbf6d3ec4,0x3f0e3e48,0x3f55bf7b,0xbf6dbec4,0xbec4bf6d,0xbe48bf55,0x3f7b3f0e
.long 0x3f6d3ec4,0x3ec43f6d,0xbe48bf55,0x3f7b3f0e,0xbec43f6d,0x3f6dbec4,0x3f0e3e48,0x3f55bf7b
.long 0xbec43f6d,0x3f6dbec4,0xbf553f7b,0x3f0e3e48,0x3f6d3ec4,0x3ec43f6d,0x3f7b3f0e,0x3e483f55
.long 0x3f6d3ec4,0x3ec43f6d,0x3f7b3f0e,0x3e483f55,0xbec43f6d,0x3f6dbec4,0xbf553f7b,0x3f0e3e48
.long 0xbec43f6d,0x3f6dbec4,0x3f0e3e48,0x3f55bf7b,0x3f6d3ec4,0x3ec43f6d,0xbe48bf55,0x3f7b3f0e
.long 0xbf6dbec4,0xbec4bf6d,0xbe48bf55,0x3f7b3f0e,0x3ec4bf6d,0xbf6d3ec4,0x3f0e3e48,0x3f55bf7b
.long 0x3ec4bf6d,0xbf6d3ec4,0xbf553f7b,0x3f0e3e48,0xbf6dbec4,0xbec4bf6d,0x3f7b3f0e,0x3e483f55
.long 0x3f6d3ec4,0x3ec43f6d,0xbf7bbf0e,0xbe48bf55,0xbec43f6d,0x3f6dbec4,0x3f55bf7b,0xbf0ebe48
.long 0xbec43f6d,0x3f6dbec4,0xbf0ebe48,0xbf553f7b,0x3f6d3ec4,0x3ec43f6d,0x3e483f55,0xbf7bbf0e
.long 0xbf6dbec4,0xbec4bf6d,0x3e483f55,0xbf7bbf0e,0x3ec4bf6d,0xbf6d3ec4,0xbf0ebe48,0xbf553f7b
.long 0x3ec4bf6d,0xbf6d3ec4,0x3f55bf7b,0xbf0ebe48,0xbf6dbec4,0xbec4bf6d,0xbf7bbf0e,0xbe48bf55
.long 0xbf6dbec4,0xbec4bf6d,0xbf7bbf0e,0xbe48bf55,0x3ec4bf6d,0xbf6d3ec4,0x3f55bf7b,0xbf0ebe48
.long 0x3ec4bf6d,0xbf6d3ec4,0xbf0ebe48,0xbf553f7b,0xbf6dbec4,0xbec4bf6d,0x3e483f55,0xbf7bbf0e
.long 0x3f6d3ec4,0x3ec43f6d,0x3e483f55,0xbf7bbf0e,0xbec43f6d,0x3f6dbec4,0xbf0ebe48,0xbf553f7b
.long 0xbec43f6d,0x3f6dbec4,0x3f55bf7b,0xbf0ebe48,0x3f6d3ec4,0x3ec43f6d,0xbf7bbf0e,0xbe48bf55
.long 0xbf6dbec4,0xbec4bf6d,0x3f7b3f0e,0x3e483f55,0x3ec4bf6d,0xbf6d3ec4,0xbf553f7b,0x3f0e3e48
.long 0x3ec4bf6d,0xbf6d3ec4,0x3f0e3e48,0x3f55bf7b,0xbf6dbec4,0xbec4bf6d,0xbe48bf55,0x3f7b3f0e
.long 0x3f6d3ec4,0x3ec43f6d,0xbe48bf55,0x3f7b3f0e,0xbec43f6d,0x3f6dbec4,0x3f0e3e48,0x3f55bf7b
.long 0xbec43f6d,0x3f6dbec4,0xbf553f7b,0x3f0e3e48,0x3f6d3ec4,0x3ec43f6d,0x3f7b3f0e,0x3e483f55
.long 0x3f6d3ec4,0x3ec43f6d,0x3f7b3f0e,0x3e483f55,0xbec43f6d,0x3f6dbec4,0xbf553f7b,0x3f0e3e48
.long 0xbec43f6d,0x3f6dbec4,0x3f0e3e48,0x3f55bf7b,0x3f6d3ec4,0x3ec43f6d,0xbe48bf55,0x3f7b3f0e
.long 0xbf6dbec4,0xbec4bf6d,0xbe48bf55,0x3f7b3f0e,0x3ec4bf6d,0xbf6d3ec4,0x3f0e3e48,0x3f55bf7b
.long 0x3ec4bf6d,0xbf6d3ec4,0xbf553f7b,0x3f0e3e48,0xbf6dbec4,0xbec4bf6d,0x3f7b3f0e,0x3e483f55
.long 0x3f6d3ec4,0x3ec43f6d,0xbf7bbf0e,0xbe48bf55,0xbec43f6d,0x3f6dbec4,0x3f55bf7b,0xbf0ebe48
.long 0xbec43f6d,0x3f6dbec4,0xbf0ebe48,0xbf553f7b,0x3f6d3ec4,0x3ec43f6d,0x3e483f55,0xbf7bbf0e
.long 0xbf6dbec4,0xbec4bf6d,0x3e483f55,0xbf7bbf0e,0x3ec4bf6d,0xbf6d3ec4,0xbf0ebe48,0xbf553f7b
.long 0x3ec4bf6d,0xbf6d3ec4,0x3f55bf7b,0xbf0ebe48,0xbf6dbec4,0xbec4bf6d,0xbf7bbf0e,0xbe48bf55
.long 0xbf6d8000,0x3ec4bf35,0xbf7fbe95,0x3f22bef1,0xbec48000,0xbf6d3f35,0x3e95bf22,0xbef13dc9
.long 0x3f6d8000,0xbec4bf35,0x3f46bf62,0xbf7f3e95,0x3ec48000,0x3f6d3f35,0xbf62bf7f,0xbe95bf22
.long 0xbf6d8000,0x3ec4bf35,0xbdc9bf75,0x3f463f62,0xbec48000,0xbf6d3f35,0x3f75bf46,0x3f62bf7f
.long 0x3f6d8000,0xbec4bf35,0xbf22bef1,0xbdc93f75,0x3ec48000,0x3f6d3f35,0xbef1bdc9,0xbf75bf46
.long 0xbf6d8000,0x3ec4bf35,0x3f7f3e95,0xbf223ef1,0xbec48000,0xbf6d3f35,0xbe953f22,0x3ef1bdc9
.long 0x3f6d8000,0xbec4bf35,0xbf463f62,0x3f7fbe95,0x3ec48000,0x3f6d3f35,0x3f623f7f,0x3e953f22
.long 0xbf6d8000,0x3ec4bf35,0x3dc93f75,0xbf46bf62,0xbec48000,0xbf6d3f35,0xbf753f46,0xbf623f7f
.long 0x3f6d8000,0xbec4bf35,0x3f223ef1,0x3dc9bf75,0x3ec48000,0x3f6d3f35,0x3ef13dc9,0x3f753f46
.long 0x3ec43f80,0xbf6dbf35,0x3dc93f75,0xbf46bf62,0xbf6d3f80,0xbec43f35,0xbf753f46,0xbf623f7f
.long 0xbec43f80,0x3f6dbf35,0x3f223ef1,0x3dc9bf75,0x3f6d3f80,0x3ec43f35,0x3ef13dc9,0x3f753f46
.long 0x3ec43f80,0xbf6dbf35,0xbf7fbe95,0x3f22bef1,0xbf6d3f80,0xbec43f35,0x3e95bf22,0xbef13dc9
.long 0xbec43f80,0x3f6dbf35,0x3f46bf62,0xbf7f3e95,0x3f6d3f80,0x3ec43f35,0xbf62bf7f,0xbe95bf22
.long 0x3ec43f80,0xbf6dbf35,0xbdc9bf75,0x3f463f62,0xbf6d3f80,0xbec43f35,0x3f75bf46,0x3f62bf7f
.long 0xbec43f80,0x3f6dbf35,0xbf22bef1,0xbdc93f75,0x3f6d3f80,0x3ec43f35,0xbef1bdc9,0xbf75bf46
.long 0x3ec43f80,0xbf6dbf35,0x3f7f3e95,0xbf223ef1,0xbf6d3f80,0xbec43f35,0xbe953f22,0x3ef1bdc9
.long 0xbec43f80,0x3f6dbf35,0xbf463f62,0x3f7fbe95,0x3f6d3f80,0x3ec43f35,0x3f623f7f,0x3e953f22
.long 0x3f6da50d,0xbec43f35,0x3f7f3e95,0xbf223ef1,0x3ec4a50d,0x3f6dbf35,0xbe953f22,0x3ef1bdc9
.long 0xbf6da50d,0x3ec43f35,0xbf463f62,0x3f7fbe95,0xbec4a50d,0xbf6dbf35,0x3f623f7f,0x3e953f22
.long 0x3f6da50d,0xbec43f35,0x3dc93f75,0xbf46bf62,0x3ec4a50d,0x3f6dbf35,0xbf753f46,0xbf623f7f
.long 0xbf6da50d,0x3ec43f35,0x3f223ef1,0x3dc9bf75,0xbec4a50d,0xbf6dbf35,0x3ef13dc9,0x3f753f46
.long 0x3f6da50d,0xbec43f35,0xbf7fbe95,0x3f22bef1,0x3ec4a50d,0x3f6dbf35,0x3e95bf22,0xbef13dc9
.long 0xbf6da50d,0x3ec43f35,0x3f46bf62,0xbf7f3e95,0xbec4a50d,0xbf6dbf35,0xbf62bf7f,0xbe95bf22
.long 0x3f6da50d,0xbec43f35,0xbdc9bf75,0x3f463f62,0x3ec4a50d,0x3f6dbf35,0x3f75bf46,0x3f62bf7f
.long 0xbf6da50d,0x3ec43f35,0xbf22bef1,0xbdc93f75,0xbec4a50d,0xbf6dbf35,0xbef1bdc9,0xbf75bf46
.long 0xbec4bf80,0x3f6d3f35,0xbdc9bf75,0x3f463f62,0x3f6dbf80,0x3ec4bf35,0x3f75bf46,0x3f62bf7f
.long 0x3ec4bf80,0xbf6d3f35,0xbf22bef1,0xbdc93f75,0xbf6dbf80,0xbec4bf35,0xbef1bdc9,0xbf75bf46
.long 0xbec4bf80,0x3f6d3f35,0x3f7f3e95,0xbf223ef1,0x3f6dbf80,0x3ec4bf35,0xbe953f22,0x3ef1bdc9
.long 0x3ec4bf80,0xbf6d3f35,0xbf463f62,0x3f7fbe95,0xbf6dbf80,0xbec4bf35,0x3f623f7f,0x3e953f22
.long 0xbec4bf80,0x3f6d3f35,0x3dc93f75,0xbf46bf62,0x3f6dbf80,0x3ec4bf35,0xbf753f46,0xbf623f7f
.long 0x3ec4bf80,0xbf6d3f35,0x3f223ef1,0x3dc9bf75,0xbf6dbf80,0xbec4bf35,0x3ef13dc9,0x3f753f46
.long 0xbec4bf80,0x3f6d3f35,0xbf7fbe95,0x3f22bef1,0x3f6dbf80,0x3ec4bf35,0x3e95bf22,0xbef13dc9
.long 0x3ec4bf80,0xbf6d3f35,0x3f46bf62,0xbf7f3e95,0xbf6dbf80,0xbec4bf35,0xbf62bf7f,0xbe95bf22
.long 0xbf7bbf0e,0x3f55be48,0xbf62bf46,0x3f753dc9,0x3f55bf7b,0x3e48bf0e,0x3f7fbf62,0x3f46bf75
.long 0xbe48bf55,0xbf0e3f7b,0xbf753dc9,0x3ef13f22,0xbf0ebe48,0xbf7bbf55,0x3f463f75,0x3dc93ef1
.long 0x3f7b3f0e,0xbf553e48,0xbef13f22,0xbe95bf7f,0xbf553f7b,0xbe483f0e,0x3dc9bef1,0xbf223e95
.long 0x3e483f55,0x3f0ebf7b,0x3e95bf7f,0xbf623f46,0x3f0e3e48,0x3f7b3f55,0xbf22be95,0xbf7fbf62
.long 0xbf7bbf0e,0x3f55be48,0x3f623f46,0xbf75bdc9,0x3f55bf7b,0x3e48bf0e,0xbf7f3f62,0xbf463f75
.long 0xbe48bf55,0xbf0e3f7b,0x3f75bdc9,0xbef1bf22,0xbf0ebe48,0xbf7bbf55,0xbf46bf75,0xbdc9bef1
.long 0x3f7b3f0e,0xbf553e48,0x3ef1bf22,0x3e953f7f,0xbf553f7b,0xbe483f0e,0xbdc93ef1,0x3f22be95
.long 0x3e483f55,0x3f0ebf7b,0xbe953f7f,0x3f62bf46,0x3f0e3e48,0x3f7b3f55,0x3f223e95,0x3f7f3f62
.long 0xbe483f55,0xbf0ebf7b,0xbef13f22,0xbe95bf7f,0xbf0e3e48,0xbf7b3f55,0x3dc9bef1,0xbf223e95
.long 0x3f7bbf0e,0xbf55be48,0x3e95bf7f,0xbf623f46,0xbf55bf7b,0xbe48bf0e,0xbf22be95,0xbf7fbf62
.long 0x3e48bf55,0x3f0e3f7b,0x3f623f46,0xbf75bdc9,0x3f0ebe48,0x3f7bbf55,0xbf7f3f62,0xbf463f75
.long 0xbf7b3f0e,0x3f553e48,0x3f75bdc9,0xbef1bf22,0x3f553f7b,0x3e483f0e,0xbf46bf75,0xbdc9bef1
.long 0xbe483f55,0xbf0ebf7b,0x3ef1bf22,0x3e953f7f,0xbf0e3e48,0xbf7b3f55,0xbdc93ef1,0x3f22be95
.long 0x3f7bbf0e,0xbf55be48,0xbe953f7f,0x3f62bf46,0xbf55bf7b,0xbe48bf0e,0x3f223e95,0x3f7f3f62
.long 0x3e48bf55,0x3f0e3f7b,0xbf62bf46,0x3f753dc9,0x3f0ebe48,0x3f7bbf55,0x3f7fbf62,0x3f46bf75
.long 0xbf7b3f0e,0x3f553e48,0xbf753dc9,0x3ef13f22,0x3f553f7b,0x3e483f0e,0x3f463f75,0x3dc93ef1
.long 0x3f7b3f0e,0xbf553e48,0x3f623f46,0xbf75bdc9,0xbf553f7b,0xbe483f0e,0xbf7f3f62,0xbf463f75
.long 0x3e483f55,0x3f0ebf7b,0x3f75bdc9,0xbef1bf22,0x3f0e3e48,0x3f7b3f55,0xbf46bf75,0xbdc9bef1
.long 0xbf7bbf0e,0x3f55be48,0x3ef1bf22,0x3e953f7f,0x3f55bf7b,0x3e48bf0e,0xbdc93ef1,0x3f22be95
.long 0xbe48bf55,0xbf0e3f7b,0xbe953f7f,0x3f62bf46,0xbf0ebe48,0xbf7bbf55,0x3f223e95,0x3f7f3f62
.long 0x3f7b3f0e,0xbf553e48,0xbf62bf46,0x3f753dc9,0xbf553f7b,0xbe483f0e,0x3f7fbf62,0x3f46bf75
.long 0x3e483f55,0x3f0ebf7b,0xbf753dc9,0x3ef13f22,0x3f0e3e48,0x3f7b3f55,0x3f463f75,0x3dc93ef1
.long 0xbf7bbf0e,0x3f55be48,0xbef13f22,0xbe95bf7f,0x3f55bf7b,0x3e48bf0e,0x3dc9bef1,0xbf223e95
.long 0xbe48bf55,0xbf0e3f7b,0x3e95bf7f,0xbf623f46,0xbf0ebe48,0xbf7bbf55,0xbf22be95,0xbf7fbf62
.long 0x3e48bf55,0x3f0e3f7b,0x3ef1bf22,0x3e953f7f,0x3f0ebe48,0x3f7bbf55,0xbdc93ef1,0x3f22be95
.long 0xbf7b3f0e,0x3f553e48,0xbe953f7f,0x3f62bf46,0x3f553f7b,0x3e483f0e,0x3f223e95,0x3f7f3f62
.long 0xbe483f55,0xbf0ebf7b,0xbf62bf46,0x3f753dc9,0xbf0e3e48,0xbf7b3f55,0x3f7fbf62,0x3f46bf75
.long 0x3f7bbf0e,0xbf55be48,0xbf753dc9,0x3ef13f22,0xbf55bf7b,0xbe48bf0e,0x3f463f75,0x3dc93ef1
.long 0x3e48bf55,0x3f0e3f7b,0xbef13f22,0xbe95bf7f,0x3f0ebe48,0x3f7bbf55,0x3dc9bef1,0xbf223e95
.long 0xbf7b3f0e,0x3f553e48,0x3e95bf7f,0xbf623f46,0x3f553f7b,0x3e483f0e,0xbf22be95,0xbf7fbf62
.long 0xbe483f55,0xbf0ebf7b,0x3f623f46,0xbf75bdc9,0xbf0e3e48,0xbf7b3f55,0xbf7f3f62,0xbf463f75
.long 0x3f7bbf0e,0xbf55be48,0x3f75bdc9,0xbef1bf22,0xbf55bf7b,0xbe48bf0e,0xbf46bf75,0xbdc9bef1
.long 0x0,0x0,0x0,0x0,0x3f800000,0xbf80250d,0x3f6d3ec4,0xbf6dbec4
.long 0x250d0000,0x250d0000,0xbf353f35,0xbf353f35,0xbf800000,0x3f80250d,0xbec43f6d,0x3ec4bf6d
.long 0x0,0x0,0x3f803f80,0x3f803f80,0x3f800000,0xbf80250d,0xbec43f6d,0x3ec4bf6d
.long 0x250d0000,0x250d0000,0xbf353f35,0xbf353f35,0xbf800000,0x3f80250d,0x3f6d3ec4,0xbf6dbec4
.long 0x0,0x0,0x250d250d,0x250d250d,0x3f800000,0xbf80250d,0xbf6dbec4,0x3f6d3ec4
.long 0x250d0000,0x250d0000,0x3f35bf35,0x3f35bf35,0xbf800000,0x3f80250d,0x3ec4bf6d,0xbec43f6d
.long 0x0,0x0,0xbf80bf80,0xbf80bf80,0x3f800000,0xbf80250d,0x3ec4bf6d,0xbec43f6d
.long 0x250d0000,0x250d0000,0x3f35bf35,0x3f35bf35,0xbf800000,0x3f80250d,0xbf6dbec4,0x3f6d3ec4
.long 0x0,0x0,0x0,0x0,0x3f800000,0xbf80250d,0x3f6d3ec4,0xbf6dbec4
.long 0x250d0000,0x250d0000,0xbf353f35,0xbf353f35,0xbf800000,0x3f80250d,0xbec43f6d,0x3ec4bf6d
.long 0x0,0x0,0x3f803f80,0x3f803f80,0x3f800000,0xbf80250d,0xbec43f6d,0x3ec4bf6d
.long 0x250d0000,0x250d0000,0xbf353f35,0xbf353f35,0xbf800000,0x3f80250d,0x3f6d3ec4,0xbf6dbec4
.long 0x0,0x0,0x250d250d,0x250d250d,0x3f800000,0xbf80250d,0xbf6dbec4,0x3f6d3ec4
.long 0x250d0000,0x250d0000,0x3f35bf35,0x3f35bf35,0xbf800000,0x3f80250d,0x3ec4bf6d,0xbec43f6d
.long 0x0,0x0,0xbf80bf80,0xbf80bf80,0x3f800000,0xbf80250d,0x3ec4bf6d,0xbec43f6d
.long 0x250d0000,0x250d0000,0x3f35bf35,0x3f35bf35,0xbf800000,0x3f80250d,0xbf6dbec4,0x3f6d3ec4
.long 0x0,0x0,0x0,0x0,0x3f800000,0xbf80250d,0x3f6d3ec4,0xbf6dbec4
.long 0x250d0000,0x250d0000,0xbf353f35,0xbf353f35,0xbf800000,0x3f80250d,0xbec43f6d,0x3ec4bf6d
.long 0x0,0x0,0x3f803f80,0x3f803f80,0x3f800000,0xbf80250d,0xbec43f6d,0x3ec4bf6d
.long 0x250d0000,0x250d0000,0xbf353f35,0xbf353f35,0xbf800000,0x3f80250d,0x3f6d3ec4,0xbf6dbec4
.long 0x0,0x0,0x250d250d,0x250d250d,0x3f800000,0xbf80250d,0xbf6dbec4,0x3f6d3ec4
.long 0x250d0000,0x250d0000,0x3f35bf35,0x3f35bf35,0xbf800000,0x3f80250d,0x3ec4bf6d,0xbec43f6d
.long 0x0,0x0,0xbf80bf80,0xbf80bf80,0x3f800000,0xbf80250d,0x3ec4bf6d,0xbec43f6d
.long 0x250d0000,0x250d0000,0x3f35bf35,0x3f35bf35,0xbf800000,0x3f80250d,0xbf6dbec4,0x3f6d3ec4
.long 0x0,0x0,0x0,0x0,0x3f800000,0xbf80250d,0x3f6d3ec4,0xbf6dbec4
.long 0x250d0000,0x250d0000,0xbf353f35,0xbf353f35,0xbf800000,0x3f80250d,0xbec43f6d,0x3ec4bf6d
.long 0x0,0x0,0x3f803f80,0x3f803f80,0x3f800000,0xbf80250d,0xbec43f6d,0x3ec4bf6d
.long 0x250d0000,0x250d0000,0xbf353f35,0xbf353f35,0xbf800000,0x3f80250d,0x3f6d3ec4,0xbf6dbec4
.long 0x0,0x0,0x250d250d,0x250d250d,0x3f800000,0xbf80250d,0xbf6dbec4,0x3f6d3ec4
.long 0x250d0000,0x250d0000,0x3f35bf35,0x3f35bf35,0xbf800000,0x3f80250d,0x3ec4bf6d,0xbec43f6d
.long 0x0,0x0,0xbf80bf80,0xbf80bf80,0x3f800000,0xbf80250d,0x3ec4bf6d,0xbec43f6d
.long 0x250d0000,0x250d0000,0x3f35bf35,0x3f35bf35,0xbf800000,0x3f80250d,0xbf6dbec4,0x3f6d3ec4
.long 0x0,0x0,0x0,0x0,0x3f353f35,0xbf35bf35,0x3ec43f6d,0xbec4bf6d
.long 0xbf803f80,0xbf803f80,0xbf353f35,0xbf353f35,0x3f353f35,0xbf35bf35,0x3f6dbec4,0xbf6d3ec4
.long 0x250d250d,0x250d250d,0xbf80bf80,0xbf80bf80,0xbf35bf35,0x3f353f35,0x3f6dbec4,0xbf6d3ec4
.long 0x3f80bf80,0x3f80bf80,0xbf353f35,0xbf353f35,0xbf35bf35,0x3f353f35,0x3ec43f6d,0xbec4bf6d
.long 0x0,0x0,0x250d250d,0x250d250d,0x3f353f35,0xbf35bf35,0xbec4bf6d,0x3ec43f6d
.long 0xbf803f80,0xbf803f80,0x3f35bf35,0x3f35bf35,0x3f353f35,0xbf35bf35,0xbf6d3ec4,0x3f6dbec4
.long 0x250d250d,0x250d250d,0x3f803f80,0x3f803f80,0xbf35bf35,0x3f353f35,0xbf6d3ec4,0x3f6dbec4
.long 0x3f80bf80,0x3f80bf80,0x3f35bf35,0x3f35bf35,0xbf35bf35,0x3f353f35,0xbec4bf6d,0x3ec43f6d
.long 0x0,0x0,0x0,0x0,0x3f353f35,0xbf35bf35,0x3ec43f6d,0xbec4bf6d
.long 0xbf803f80,0xbf803f80,0xbf353f35,0xbf353f35,0x3f353f35,0xbf35bf35,0x3f6dbec4,0xbf6d3ec4
.long 0x250d250d,0x250d250d,0xbf80bf80,0xbf80bf80,0xbf35bf35,0x3f353f35,0x3f6dbec4,0xbf6d3ec4
.long 0x3f80bf80,0x3f80bf80,0xbf353f35,0xbf353f35,0xbf35bf35,0x3f353f35,0x3ec43f6d,0xbec4bf6d
.long 0x0,0x0,0x250d250d,0x250d250d,0x3f353f35,0xbf35bf35,0xbec4bf6d,0x3ec43f6d
.long 0xbf803f80,0xbf803f80,0x3f35bf35,0x3f35bf35,0x3f353f35,0xbf35bf35,0xbf6d3ec4,0x3f6dbec4
.long 0x250d250d,0x250d250d,0x3f803f80,0x3f803f80,0xbf35bf35,0x3f353f35,0xbf6d3ec4,0x3f6dbec4
.long 0x3f80bf80,0x3f80bf80,0x3f35bf35,0x3f35bf35,0xbf35bf35,0x3f353f35,0xbec4bf6d,0x3ec43f6d
.long 0x0,0x0,0x0,0x0,0x3f353f35,0xbf35bf35,0x3ec43f6d,0xbec4bf6d
.long 0xbf803f80,0xbf803f80,0xbf353f35,0xbf353f35,0x3f353f35,0xbf35bf35,0x3f6dbec4,0xbf6d3ec4
.long 0x250d250d,0x250d250d,0xbf80bf80,0xbf80bf80,0xbf35bf35,0x3f353f35,0x3f6dbec4,0xbf6d3ec4
.long 0x3f80bf80,0x3f80bf80,0xbf353f35,0xbf353f35,0xbf35bf35,0x3f353f35,0x3ec43f6d,0xbec4bf6d
.long 0x0,0x0,0x250d250d,0x250d250d,0x3f353f35,0xbf35bf35,0xbec4bf6d,0x3ec43f6d
.long 0xbf803f80,0xbf803f80,0x3f35bf35,0x3f35bf35,0x3f353f35,0xbf35bf35,0xbf6d3ec4,0x3f6dbec4
.long 0x250d250d,0x250d250d,0x3f803f80,0x3f803f80,0xbf35bf35,0x3f353f35,0xbf6d3ec4,0x3f6dbec4
.long 0x3f80bf80,0x3f80bf80,0x3f35bf35,0x3f35bf35,0xbf35bf35,0x3f353f35,0xbec4bf6d,0x3ec43f6d
.long 0x0,0x0,0x0,0x0,0x3f353f35,0xbf35bf35,0x3ec43f6d,0xbec4bf6d
.long 0xbf803f80,0xbf803f80,0xbf353f35,0xbf353f35,0x3f353f35,0xbf35bf35,0x3f6dbec4,0xbf6d3ec4
.long 0x250d250d,0x250d250d,0xbf80bf80,0xbf80bf80,0xbf35bf35,0x3f353f35,0x3f6dbec4,0xbf6d3ec4
.long 0x3f80bf80,0x3f80bf80,0xbf353f35,0xbf353f35,0xbf35bf35,0x3f353f35,0x3ec43f6d,0xbec4bf6d
.long 0x0,0x0,0x250d250d,0x250d250d,0x3f353f35,0xbf35bf35,0xbec4bf6d,0x3ec43f6d
.long 0xbf803f80,0xbf803f80,0x3f35bf35,0x3f35bf35,0x3f353f35,0xbf35bf35,0xbf6d3ec4,0x3f6dbec4
.long 0x250d250d,0x250d250d,0x3f803f80,0x3f803f80,0xbf35bf35,0x3f353f35,0xbf6d3ec4,0x3f6dbec4
.long 0x3f80bf80,0x3f80bf80,0x3f35bf35,0x3f35bf35,0xbf35bf35,0x3f353f35,0xbec4bf6d,0x3ec43f6d
.long 0x3ec40000,0x3f6d3f35,0x3ef13dc9,0x3f753f46,0x3f6d0000,0xbec4bf35,0x3f223ef1,0x3dc9bf75
.long 0xbec40000,0xbf6d3f35,0xbf753f46,0xbf623f7f,0xbf6d0000,0x3ec4bf35,0x3dc93f75,0xbf46bf62
.long 0x3ec40000,0x3f6d3f35,0x3f623f7f,0x3e953f22,0x3f6d0000,0xbec4bf35,0xbf463f62,0x3f7fbe95
.long 0xbec40000,0xbf6d3f35,0xbe953f22,0x3ef1bdc9,0xbf6d0000,0x3ec4bf35,0x3f7f3e95,0xbf223ef1
.long 0x3ec40000,0x3f6d3f35,0xbef1bdc9,0xbf75bf46,0x3f6d0000,0xbec4bf35,0xbf22bef1,0xbdc93f75
.long 0xbec40000,0xbf6d3f35,0x3f75bf46,0x3f62bf7f,0xbf6d0000,0x3ec4bf35,0xbdc9bf75,0x3f463f62
.long 0x3ec40000,0x3f6d3f35,0xbf62bf7f,0xbe95bf22,0x3f6d0000,0xbec4bf35,0x3f46bf62,0xbf7f3e95
.long 0xbec40000,0xbf6d3f35,0x3e95bf22,0xbef13dc9,0xbf6d0000,0x3ec4bf35,0xbf7fbe95,0x3f22bef1
.long 0x3f6d3f80,0x3ec43f35,0x3f623f7f,0x3e953f22,0xbec43f80,0x3f6dbf35,0xbf463f62,0x3f7fbe95
.long 0xbf6d3f80,0xbec43f35,0xbe953f22,0x3ef1bdc9,0x3ec43f80,0xbf6dbf35,0x3f7f3e95,0xbf223ef1
.long 0x3f6d3f80,0x3ec43f35,0xbef1bdc9,0xbf75bf46,0xbec43f80,0x3f6dbf35,0xbf22bef1,0xbdc93f75
.long 0xbf6d3f80,0xbec43f35,0x3f75bf46,0x3f62bf7f,0x3ec43f80,0xbf6dbf35,0xbdc9bf75,0x3f463f62
.long 0x3f6d3f80,0x3ec43f35,0xbf62bf7f,0xbe95bf22,0xbec43f80,0x3f6dbf35,0x3f46bf62,0xbf7f3e95
.long 0xbf6d3f80,0xbec43f35,0x3e95bf22,0xbef13dc9,0x3ec43f80,0xbf6dbf35,0xbf7fbe95,0x3f22bef1
.long 0x3f6d3f80,0x3ec43f35,0x3ef13dc9,0x3f753f46,0xbec43f80,0x3f6dbf35,0x3f223ef1,0x3dc9bf75
.long 0xbf6d3f80,0xbec43f35,0xbf753f46,0xbf623f7f,0x3ec43f80,0xbf6dbf35,0x3dc93f75,0xbf46bf62
.long 0xbec4250d,0xbf6dbf35,0xbef1bdc9,0xbf75bf46,0xbf6d250d,0x3ec43f35,0xbf22bef1,0xbdc93f75
.long 0x3ec4250d,0x3f6dbf35,0x3f75bf46,0x3f62bf7f,0x3f6d250d,0xbec43f35,0xbdc9bf75,0x3f463f62
.long 0xbec4250d,0xbf6dbf35,0xbf62bf7f,0xbe95bf22,0xbf6d250d,0x3ec43f35,0x3f46bf62,0xbf7f3e95
.long 0x3ec4250d,0x3f6dbf35,0x3e95bf22,0xbef13dc9,0x3f6d250d,0xbec43f35,0xbf7fbe95,0x3f22bef1
.long 0xbec4250d,0xbf6dbf35,0x3ef13dc9,0x3f753f46,0xbf6d250d,0x3ec43f35,0x3f223ef1,0x3dc9bf75
.long 0x3ec4250d,0x3f6dbf35,0xbf753f46,0xbf623f7f,0x3f6d250d,0xbec43f35,0x3dc93f75,0xbf46bf62
.long 0xbec4250d,0xbf6dbf35,0x3f623f7f,0x3e953f22,0xbf6d250d,0x3ec43f35,0xbf463f62,0x3f7fbe95
.long 0x3ec4250d,0x3f6dbf35,0xbe953f22,0x3ef1bdc9,0x3f6d250d,0xbec43f35,0x3f7f3e95,0xbf223ef1
.long 0xbf6dbf80,0xbec4bf35,0xbf62bf7f,0xbe95bf22,0x3ec4bf80,0xbf6d3f35,0x3f46bf62,0xbf7f3e95
.long 0x3f6dbf80,0x3ec4bf35,0x3e95bf22,0xbef13dc9,0xbec4bf80,0x3f6d3f35,0xbf7fbe95,0x3f22bef1
.long 0xbf6dbf80,0xbec4bf35,0x3ef13dc9,0x3f753f46,0x3ec4bf80,0xbf6d3f35,0x3f223ef1,0x3dc9bf75
.long 0x3f6dbf80,0x3ec4bf35,0xbf753f46,0xbf623f7f,0xbec4bf80,0x3f6d3f35,0x3dc93f75,0xbf46bf62
.long 0xbf6dbf80,0xbec4bf35,0x3f623f7f,0x3e953f22,0x3ec4bf80,0xbf6d3f35,0xbf463f62,0x3f7fbe95
.long 0x3f6dbf80,0x3ec4bf35,0xbe953f22,0x3ef1bdc9,0xbec4bf80,0x3f6d3f35,0x3f7f3e95,0xbf223ef1
.long 0xbf6dbf80,0xbec4bf35,0xbef1bdc9,0xbf75bf46,0x3ec4bf80,0xbf6d3f35,0xbf22bef1,0xbdc93f75
.long 0x3f6dbf80,0x3ec4bf35,0x3f75bf46,0x3f62bf7f,0xbec4bf80,0x3f6d3f35,0xbdc9bf75,0x3f463f62
.long 0x3f0e3e48,0x3f7b3f55,0x3f223e95,0x3f7f3f62,0x3e483f55,0x3f0ebf7b,0xbe953f7f,0x3f62bf46
.long 0xbf553f7b,0xbe483f0e,0xbdc93ef1,0x3f22be95,0x3f7b3f0e,0xbf553e48,0x3ef1bf22,0x3e953f7f
.long 0xbf0ebe48,0xbf7bbf55,0xbf46bf75,0xbdc9bef1,0xbe48bf55,0xbf0e3f7b,0x3f75bdc9,0xbef1bf22
.long 0x3f55bf7b,0x3e48bf0e,0xbf7f3f62,0xbf463f75,0xbf7bbf0e,0x3f55be48,0x3f623f46,0xbf75bdc9
.long 0x3f0e3e48,0x3f7b3f55,0xbf22be95,0xbf7fbf62,0x3e483f55,0x3f0ebf7b,0x3e95bf7f,0xbf623f46
.long 0xbf553f7b,0xbe483f0e,0x3dc9bef1,0xbf223e95,0x3f7b3f0e,0xbf553e48,0xbef13f22,0xbe95bf7f
.long 0xbf0ebe48,0xbf7bbf55,0x3f463f75,0x3dc93ef1,0xbe48bf55,0xbf0e3f7b,0xbf753dc9,0x3ef13f22
.long 0x3f55bf7b,0x3e48bf0e,0x3f7fbf62,0x3f46bf75,0xbf7bbf0e,0x3f55be48,0xbf62bf46,0x3f753dc9
.long 0x3f553f7b,0x3e483f0e,0x3f463f75,0x3dc93ef1,0xbf7b3f0e,0x3f553e48,0xbf753dc9,0x3ef13f22
.long 0x3f0ebe48,0x3f7bbf55,0x3f7fbf62,0x3f46bf75,0x3e48bf55,0x3f0e3f7b,0xbf62bf46,0x3f753dc9
.long 0xbf55bf7b,0xbe48bf0e,0x3f223e95,0x3f7f3f62,0x3f7bbf0e,0xbf55be48,0xbe953f7f,0x3f62bf46
.long 0xbf0e3e48,0xbf7b3f55,0xbdc93ef1,0x3f22be95,0xbe483f55,0xbf0ebf7b,0x3ef1bf22,0x3e953f7f
.long 0x3f553f7b,0x3e483f0e,0xbf46bf75,0xbdc9bef1,0xbf7b3f0e,0x3f553e48,0x3f75bdc9,0xbef1bf22
.long 0x3f0ebe48,0x3f7bbf55,0xbf7f3f62,0xbf463f75,0x3e48bf55,0x3f0e3f7b,0x3f623f46,0xbf75bdc9
.long 0xbf55bf7b,0xbe48bf0e,0xbf22be95,0xbf7fbf62,0x3f7bbf0e,0xbf55be48,0x3e95bf7f,0xbf623f46
.long 0xbf0e3e48,0xbf7b3f55,0x3dc9bef1,0xbf223e95,0xbe483f55,0xbf0ebf7b,0xbef13f22,0xbe95bf7f
.long 0xbf0ebe48,0xbf7bbf55,0xbf22be95,0xbf7fbf62,0xbe48bf55,0xbf0e3f7b,0x3e95bf7f,0xbf623f46
.long 0x3f55bf7b,0x3e48bf0e,0x3dc9bef1,0xbf223e95,0xbf7bbf0e,0x3f55be48,0xbef13f22,0xbe95bf7f
.long 0x3f0e3e48,0x3f7b3f55,0x3f463f75,0x3dc93ef1,0x3e483f55,0x3f0ebf7b,0xbf753dc9,0x3ef13f22
.long 0xbf553f7b,0xbe483f0e,0x3f7fbf62,0x3f46bf75,0x3f7b3f0e,0xbf553e48,0xbf62bf46,0x3f753dc9
.long 0xbf0ebe48,0xbf7bbf55,0x3f223e95,0x3f7f3f62,0xbe48bf55,0xbf0e3f7b,0xbe953f7f,0x3f62bf46
.long 0x3f55bf7b,0x3e48bf0e,0xbdc93ef1,0x3f22be95,0xbf7bbf0e,0x3f55be48,0x3ef1bf22,0x3e953f7f
.long 0x3f0e3e48,0x3f7b3f55,0xbf46bf75,0xbdc9bef1,0x3e483f55,0x3f0ebf7b,0x3f75bdc9,0xbef1bf22
.long 0xbf553f7b,0xbe483f0e,0xbf7f3f62,0xbf463f75,0x3f7b3f0e,0xbf553e48,0x3f623f46,0xbf75bdc9
.long 0xbf55bf7b,0xbe48bf0e,0xbf46bf75,0xbdc9bef1,0x3f7bbf0e,0xbf55be48,0x3f75bdc9,0xbef1bf22
.long 0xbf0e3e48,0xbf7b3f55,0xbf7f3f62,0xbf463f75,0xbe483f55,0xbf0ebf7b,0x3f623f46,0xbf75bdc9
.long 0x3f553f7b,0x3e483f0e,0xbf22be95,0xbf7fbf62,0xbf7b3f0e,0x3f553e48,0x3e95bf7f,0xbf623f46
.long 0x3f0ebe48,0x3f7bbf55,0x3dc9bef1,0xbf223e95,0x3e48bf55,0x3f0e3f7b,0xbef13f22,0xbe95bf7f
.long 0xbf55bf7b,0xbe48bf0e,0x3f463f75,0x3dc93ef1,0x3f7bbf0e,0xbf55be48,0xbf753dc9,0x3ef13f22
.long 0xbf0e3e48,0xbf7b3f55,0x3f7fbf62,0x3f46bf75,0xbe483f55,0xbf0ebf7b,0xbf62bf46,0x3f753dc9
.long 0x3f553f7b,0x3e483f0e,0x3f223e95,0x3f7f3f62,0xbf7b3f0e,0x3f553e48,0xbe953f7f,0x3f62bf46
.long 0x3f0ebe48,0x3f7bbf55,0xbdc93ef1,0x3f22be95,0x3e48bf55,0x3f0e3f7b,0x3ef1bf22,0x3e953f7f
.long 0x3f350000,0x3f353f80,0x3f553e48,0x3f0e3f7b,0x3f350000,0x3f35bf80,0x3e483f0e,0x3f7bbf55
.long 0xbf350000,0xbf353f80,0xbf7b3f55,0x3e483f0e,0xbf350000,0xbf35bf80,0x3f0e3f7b,0xbf55be48
.long 0x3f350000,0x3f353f80,0x3f0e3f7b,0xbf55be48,0x3f350000,0x3f35bf80,0xbf7b3f55,0x3e483f0e
.long 0xbf350000,0xbf353f80,0x3e483f0e,0x3f7bbf55,0xbf350000,0xbf35bf80,0x3f553e48,0x3f0e3f7b
.long 0x3f350000,0x3f353f80,0xbf55be48,0xbf0ebf7b,0x3f350000,0x3f35bf80,0xbe48bf0e,0xbf7b3f55
.long 0xbf350000,0xbf353f80,0x3f7bbf55,0xbe48bf0e,0xbf350000,0xbf35bf80,0xbf0ebf7b,0x3f553e48
.long 0x3f350000,0x3f353f80,0xbf0ebf7b,0x3f553e48,0x3f350000,0x3f35bf80,0x3f7bbf55,0xbe48bf0e
.long 0xbf350000,0xbf353f80,0xbe48bf0e,0xbf7b3f55,0xbf350000,0xbf35bf80,0xbf55be48,0xbf0ebf7b
.long 0xbf35250d,0xbf35bf80,0xbf55be48,0xbf0ebf7b,0xbf35250d,0xbf353f80,0xbe48bf0e,0xbf7b3f55
.long 0x3f35250d,0x3f35bf80,0x3f7bbf55,0xbe48bf0e,0x3f35250d,0x3f353f80,0xbf0ebf7b,0x3f553e48
.long 0xbf35250d,0xbf35bf80,0xbf0ebf7b,0x3f553e48,0xbf35250d,0xbf353f80,0x3f7bbf55,0xbe48bf0e
.long 0x3f35250d,0x3f35bf80,0xbe48bf0e,0xbf7b3f55,0x3f35250d,0x3f353f80,0xbf55be48,0xbf0ebf7b
.long 0xbf35250d,0xbf35bf80,0x3f553e48,0x3f0e3f7b,0xbf35250d,0xbf353f80,0x3e483f0e,0x3f7bbf55
.long 0x3f35250d,0x3f35bf80,0xbf7b3f55,0x3e483f0e,0x3f35250d,0x3f353f80,0x3f0e3f7b,0xbf55be48
.long 0xbf35250d,0xbf35bf80,0x3f0e3f7b,0xbf55be48,0xbf35250d,0xbf353f80,0xbf7b3f55,0x3e483f0e
.long 0x3f35250d,0x3f35bf80,0x3e483f0e,0x3f7bbf55,0x3f35250d,0x3f353f80,0x3f553e48,0x3f0e3f7b
.long 0x3f350000,0x3f353f80,0x3f553e48,0x3f0e3f7b,0x3f350000,0x3f35bf80,0x3e483f0e,0x3f7bbf55
.long 0xbf350000,0xbf353f80,0xbf7b3f55,0x3e483f0e,0xbf350000,0xbf35bf80,0x3f0e3f7b,0xbf55be48
.long 0x3f350000,0x3f353f80,0x3f0e3f7b,0xbf55be48,0x3f350000,0x3f35bf80,0xbf7b3f55,0x3e483f0e
.long 0xbf350000,0xbf353f80,0x3e483f0e,0x3f7bbf55,0xbf350000,0xbf35bf80,0x3f553e48,0x3f0e3f7b
.long 0x3f350000,0x3f353f80,0xbf55be48,0xbf0ebf7b,0x3f350000,0x3f35bf80,0xbe48bf0e,0xbf7b3f55
.long 0xbf350000,0xbf353f80,0x3f7bbf55,0xbe48bf0e,0xbf350000,0xbf35bf80,0xbf0ebf7b,0x3f553e48
.long 0x3f350000,0x3f353f80,0xbf0ebf7b,0x3f553e48,0x3f350000,0x3f35bf80,0x3f7bbf55,0xbe48bf0e
.long 0xbf350000,0xbf353f80,0xbe48bf0e,0xbf7b3f55,0xbf350000,0xbf35bf80,0xbf55be48,0xbf0ebf7b
.long 0xbf35250d,0xbf35bf80,0xbf55be48,0xbf0ebf7b,0xbf35250d,0xbf353f80,0xbe48bf0e,0xbf7b3f55
.long 0x3f35250d,0x3f35bf80,0x3f7bbf55,0xbe48bf0e,0x3f35250d,0x3f353f80,0xbf0ebf7b,0x3f553e48
.long 0xbf35250d,0xbf35bf80,0xbf0ebf7b,0x3f553e48,0xbf35250d,0xbf353f80,0x3f7bbf55,0xbe48bf0e
.long 0x3f35250d,0x3f35bf80,0xbe48bf0e,0xbf7b3f55,0x3f35250d,0x3f353f80,0xbf55be48,0xbf0ebf7b
.long 0xbf35250d,0xbf35bf80,0x3f553e48,0x3f0e3f7b,0xbf35250d,0xbf353f80,0x3e483f0e,0x3f7bbf55
.long 0x3f35250d,0x3f35bf80,0xbf7b3f55,0x3e483f0e,0x3f35250d,0x3f353f80,0x3f0e3f7b,0xbf55be48
.long 0xbf35250d,0xbf35bf80,0x3f0e3f7b,0xbf55be48,0xbf35250d,0xbf353f80,0xbf7b3f55,0x3e483f0e
.long 0x3f35250d,0x3f35bf80,0x3e483f0e,0x3f7bbf55,0x3f35250d,0x3f353f80,0x3f553e48,0x3f0e3f7b
.long 0x3f6d3ec4,0x3ec43f6d,0x3f7b3f0e,0x3e483f55,0xbec43f6d,0x3f6dbec4,0xbf553f7b,0x3f0e3e48
.long 0xbec43f6d,0x3f6dbec4,0x3f0e3e48,0x3f55bf7b,0x3f6d3ec4,0x3ec43f6d,0xbe48bf55,0x3f7b3f0e
.long 0xbf6dbec4,0xbec4bf6d,0xbe48bf55,0x3f7b3f0e,0x3ec4bf6d,0xbf6d3ec4,0x3f0e3e48,0x3f55bf7b
.long 0x3ec4bf6d,0xbf6d3ec4,0xbf553f7b,0x3f0e3e48,0xbf6dbec4,0xbec4bf6d,0x3f7b3f0e,0x3e483f55
.long 0x3f6d3ec4,0x3ec43f6d,0xbf7bbf0e,0xbe48bf55,0xbec43f6d,0x3f6dbec4,0x3f55bf7b,0xbf0ebe48
.long 0xbec43f6d,0x3f6dbec4,0xbf0ebe48,0xbf553f7b,0x3f6d3ec4,0x3ec43f6d,0x3e483f55,0xbf7bbf0e
.long 0xbf6dbec4,0xbec4bf6d,0x3e483f55,0xbf7bbf0e,0x3ec4bf6d,0xbf6d3ec4,0xbf0ebe48,0xbf553f7b
.long 0x3ec4bf6d,0xbf6d3ec4,0x3f55bf7b,0xbf0ebe48,0xbf6dbec4,0xbec4bf6d,0xbf7bbf0e,0xbe48bf55
.long 0xbf6dbec4,0xbec4bf6d,0xbf7bbf0e,0xbe48bf55,0x3ec4bf6d,0xbf6d3ec4,0x3f55bf7b,0xbf0ebe48
.long 0x3ec4bf6d,0xbf6d3ec4,0xbf0ebe48,0xbf553f7b,0xbf6dbec4,0xbec4bf6d,0x3e483f55,0xbf7bbf0e
.long 0x3f6d3ec4,0x3ec43f6d,0x3e483f55,0xbf7bbf0e,0xbec43f6d,0x3f6dbec4,0xbf0ebe48,0xbf553f7b
.long 0xbec43f6d,0x3f6dbec4,0x3f55bf7b,0xbf0ebe48,0x3f6d3ec4,0x3ec43f6d,0xbf7bbf0e,0xbe48bf55
.long 0xbf6dbec4,0xbec4bf6d,0x3f7b3f0e,0x3e483f55,0x3ec4bf6d,0xbf6d3ec4,0xbf553f7b,0x3f0e3e48
.long 0x3ec4bf6d,0xbf6d3ec4,0x3f0e3e48,0x3f55bf7b,0xbf6dbec4,0xbec4bf6d,0xbe48bf55,0x3f7b3f0e
.long 0x3f6d3ec4,0x3ec43f6d,0xbe48bf55,0x3f7b3f0e,0xbec43f6d,0x3f6dbec4,0x3f0e3e48,0x3f55bf7b
.long 0xbec43f6d,0x3f6dbec4,0xbf553f7b,0x3f0e3e48,0x3f6d3ec4,0x3ec43f6d,0x3f7b3f0e,0x3e483f55
.long 0x3f6d3ec4,0x3ec43f6d,0x3f7b3f0e,0x3e483f55,0xbec43f6d,0x3f6dbec4,0xbf553f7b,0x3f0e3e48
.long 0xbec43f6d,0x3f6dbec4,0x3f0e3e48,0x3f55bf7b,0x3f6d3ec4,0x3ec43f6d,0xbe48bf55,0x3f7b3f0e
.long 0xbf6dbec4,0xbec4bf6d,0xbe48bf55,0x3f7b3f0e,0x3ec4bf6d,0xbf6d3ec4,0x3f0e3e48,0x3f55bf7b
.long 0x3ec4bf6d,0xbf6d3ec4,0xbf553f7b,0x3f0e3e48,0xbf6dbec4,0xbec4bf6d,0x3f7b3f0e,0x3e483f55
.long 0x3f6d3ec4,0x3ec43f6d,0xbf7bbf0e,0xbe48bf55,0xbec43f6d,0x3f6dbec4,0x3f55bf7b,0xbf0ebe48
.long 0xbec43f6d,0x3f6dbec4,0xbf0ebe48,0xbf553f7b,0x3f6d3ec4,0x3ec43f6d,0x3e483f55,0xbf7bbf0e
.long 0xbf6dbec4,0xbec4bf6d,0x3e483f55,0xbf7bbf0e,0x3ec4bf6d,0xbf6d3ec4,0xbf0ebe48,0xbf553f7b
.long 0x3ec4bf6d,0xbf6d3ec4,0x3f55bf7b,0xbf0ebe48,0xbf6dbec4,0xbec4bf6d,0xbf7bbf0e,0xbe48bf55
.long 0xbf6dbec4,0xbec4bf6d,0xbf7bbf0e,0xbe48bf55,0x3ec4bf6d,0xbf6d3ec4,0x3f55bf7b,0xbf0ebe48
.long 0x3ec4bf6d,0xbf6d3ec4,0xbf0ebe48,0xbf553f7b,0xbf6dbec4,0xbec4bf6d,0x3e483f55,0xbf7bbf0e
.long 0x3f6d3ec4,0x3ec43f6d,0x3e483f55,0xbf7bbf0e,0xbec43f6d,0x3f6dbec4,0xbf0ebe48,0xbf553f7b
.long 0xbec43f6d,0x3f6dbec4,0x3f55bf7b,0xbf0ebe48,0x3f6d3ec4,0x3ec43f6d,0xbf7bbf0e,0xbe48bf55
.long 0xbf6dbec4,0xbec4bf6d,0x3f7b3f0e,0x3e483f55,0x3ec4bf6d,0xbf6d3ec4,0xbf553f7b,0x3f0e3e48
.long 0x3ec4bf6d,0xbf6d3ec4,0x3f0e3e48,0x3f55bf7b,0xbf6dbec4,0xbec4bf6d,0xbe48bf55,0x3f7b3f0e
.long 0x3f6d3ec4,0x3ec43f6d,0xbe48bf55,0x3f7b3f0e,0xbec43f6d,0x3f6dbec4,0x3f0e3e48,0x3f55bf7b
.long 0xbec43f6d,0x3f6dbec4,0xbf553f7b,0x3f0e3e48,0x3f6d3ec4,0x3ec43f6d,0x3f7b3f0e,0x3e483f55
.long 0x3f6d0000,0xbec43f35,0x3f7f3e95,0xbf223ef1,0x3ec40000,0x3f6dbf35,0xbe953f22,0x3ef1bdc9
.long 0xbf6d0000,0x3ec43f35,0xbf463f62,0x3f7fbe95,0xbec40000,0xbf6dbf35,0x3f623f7f,0x3e953f22
.long 0x3f6d0000,0xbec43f35,0x3dc93f75,0xbf46bf62,0x3ec40000,0x3f6dbf35,0xbf753f46,0xbf623f7f
.long 0xbf6d0000,0x3ec43f35,0x3f223ef1,0x3dc9bf75,0xbec40000,0xbf6dbf35,0x3ef13dc9,0x3f753f46
.long 0x3f6d0000,0xbec43f35,0xbf7fbe95,0x3f22bef1,0x3ec40000,0x3f6dbf35,0x3e95bf22,0xbef13dc9
.long 0xbf6d0000,0x3ec43f35,0x3f46bf62,0xbf7f3e95,0xbec40000,0xbf6dbf35,0xbf62bf7f,0xbe95bf22
.long 0x3f6d0000,0xbec43f35,0xbdc9bf75,0x3f463f62,0x3ec40000,0x3f6dbf35,0x3f75bf46,0x3f62bf7f
.long 0xbf6d0000,0x3ec43f35,0xbf22bef1,0xbdc93f75,0xbec40000,0xbf6dbf35,0xbef1bdc9,0xbf75bf46
.long 0xbec4bf80,0x3f6d3f35,0xbdc9bf75,0x3f463f62,0x3f6dbf80,0x3ec4bf35,0x3f75bf46,0x3f62bf7f
.long 0x3ec4bf80,0xbf6d3f35,0xbf22bef1,0xbdc93f75,0xbf6dbf80,0xbec4bf35,0xbef1bdc9,0xbf75bf46
.long 0xbec4bf80,0x3f6d3f35,0x3f7f3e95,0xbf223ef1,0x3f6dbf80,0x3ec4bf35,0xbe953f22,0x3ef1bdc9
.long 0x3ec4bf80,0xbf6d3f35,0xbf463f62,0x3f7fbe95,0xbf6dbf80,0xbec4bf35,0x3f623f7f,0x3e953f22
.long 0xbec4bf80,0x3f6d3f35,0x3dc93f75,0xbf46bf62,0x3f6dbf80,0x3ec4bf35,0xbf753f46,0xbf623f7f
.long 0x3ec4bf80,0xbf6d3f35,0x3f223ef1,0x3dc9bf75,0xbf6dbf80,0xbec4bf35,0x3ef13dc9,0x3f753f46
.long 0xbec4bf80,0x3f6d3f35,0xbf7fbe95,0x3f22bef1,0x3f6dbf80,0x3ec4bf35,0x3e95bf22,0xbef13dc9
.long 0x3ec4bf80,0xbf6d3f35,0x3f46bf62,0xbf7f3e95,0xbf6dbf80,0xbec4bf35,0xbf62bf7f,0xbe95bf22
.long 0xbf6d250d,0x3ec4bf35,0xbf7fbe95,0x3f22bef1,0xbec4250d,0xbf6d3f35,0x3e95bf22,0xbef13dc9
.long 0x3f6d250d,0xbec4bf35,0x3f46bf62,0xbf7f3e95,0x3ec4250d,0x3f6d3f35,0xbf62bf7f,0xbe95bf22
.long 0xbf6d250d,0x3ec4bf35,0xbdc9bf75,0x3f463f62,0xbec4250d,0xbf6d3f35,0x3f75bf46,0x3f62bf7f
.long 0x3f6d250d,0xbec4bf35,0xbf22bef1,0xbdc93f75,0x3ec4250d,0x3f6d3f35,0xbef1bdc9,0xbf75bf46
.long 0xbf6d250d,0x3ec4bf35,0x3f7f3e95,0xbf223ef1,0xbec4250d,0xbf6d3f35,0xbe953f22,0x3ef1bdc9
.long 0x3f6d250d,0xbec4bf35,0xbf463f62,0x3f7fbe95,0x3ec4250d,0x3f6d3f35,0x3f623f7f,0x3e953f22
.long 0xbf6d250d,0x3ec4bf35,0x3dc93f75,0xbf46bf62,0xbec4250d,0xbf6d3f35,0xbf753f46,0xbf623f7f
.long 0x3f6d250d,0xbec4bf35,0x3f223ef1,0x3dc9bf75,0x3ec4250d,0x3f6d3f35,0x3ef13dc9,0x3f753f46
.long 0x3ec43f80,0xbf6dbf35,0x3dc93f75,0xbf46bf62,0xbf6d3f80,0xbec43f35,0xbf753f46,0xbf623f7f
.long 0xbec43f80,0x3f6dbf35,0x3f223ef1,0x3dc9bf75,0x3f6d3f80,0x3ec43f35,0x3ef13dc9,0x3f753f46
.long 0x3ec43f80,0xbf6dbf35,0xbf7fbe95,0x3f22bef1,0xbf6d3f80,0xbec43f35,0x3e95bf22,0xbef13dc9
.long 0xbec43f80,0x3f6dbf35,0x3f46bf62,0xbf7f3e95,0x3f6d3f80,0x3ec43f35,0xbf62bf7f,0xbe95bf22
.long 0x3ec43f80,0xbf6dbf35,0xbdc9bf75,0x3f463f62,0xbf6d3f80,0xbec43f35,0x3f75bf46,0x3f62bf7f
.long 0xbec43f80,0x3f6dbf35,0xbf22bef1,0xbdc93f75,0x3f6d3f80,0x3ec43f35,0xbef1bdc9,0xbf75bf46
.long 0x3ec43f80,0xbf6dbf35,0x3f7f3e95,0xbf223ef1,0xbf6d3f80,0xbec43f35,0xbe953f22,0x3ef1bdc9
.long 0xbec43f80,0x3f6dbf35,0xbf463f62,0x3f7fbe95,0x3f6d3f80,0x3ec43f35,0x3f623f7f,0x3e953f22
.long 0x3f7b3f0e,0xbf553e48,0x3f623f46,0xbf75bdc9,0xbf553f7b,0xbe483f0e,0xbf7f3f62,0xbf463f75
.long 0x3e483f55,0x3f0ebf7b,0x3f75bdc9,0xbef1bf22,0x3f0e3e48,0x3f7b3f55,0xbf46bf75,0xbdc9bef1
.long 0xbf7bbf0e,0x3f55be48,0x3ef1bf22,0x3e953f7f,0x3f55bf7b,0x3e48bf0e,0xbdc93ef1,0x3f22be95
.long 0xbe48bf55,0xbf0e3f7b,0xbe953f7f,0x3f62bf46,0xbf0ebe48,0xbf7bbf55,0x3f223e95,0x3f7f3f62
.long 0x3f7b3f0e,0xbf553e48,0xbf62bf46,0x3f753dc9,0xbf553f7b,0xbe483f0e,0x3f7fbf62,0x3f46bf75
.long 0x3e483f55,0x3f0ebf7b,0xbf753dc9,0x3ef13f22,0x3f0e3e48,0x3f7b3f55,0x3f463f75,0x3dc93ef1
.long 0xbf7bbf0e,0x3f55be48,0xbef13f22,0xbe95bf7f,0x3f55bf7b,0x3e48bf0e,0x3dc9bef1,0xbf223e95
.long 0xbe48bf55,0xbf0e3f7b,0x3e95bf7f,0xbf623f46,0xbf0ebe48,0xbf7bbf55,0xbf22be95,0xbf7fbf62
.long 0x3e48bf55,0x3f0e3f7b,0x3ef1bf22,0x3e953f7f,0x3f0ebe48,0x3f7bbf55,0xbdc93ef1,0x3f22be95
.long 0xbf7b3f0e,0x3f553e48,0xbe953f7f,0x3f62bf46,0x3f553f7b,0x3e483f0e,0x3f223e95,0x3f7f3f62
.long 0xbe483f55,0xbf0ebf7b,0xbf62bf46,0x3f753dc9,0xbf0e3e48,0xbf7b3f55,0x3f7fbf62,0x3f46bf75
.long 0x3f7bbf0e,0xbf55be48,0xbf753dc9,0x3ef13f22,0xbf55bf7b,0xbe48bf0e,0x3f463f75,0x3dc93ef1
.long 0x3e48bf55,0x3f0e3f7b,0xbef13f22,0xbe95bf7f,0x3f0ebe48,0x3f7bbf55,0x3dc9bef1,0xbf223e95
.long 0xbf7b3f0e,0x3f553e48,0x3e95bf7f,0xbf623f46,0x3f553f7b,0x3e483f0e,0xbf22be95,0xbf7fbf62
.long 0xbe483f55,0xbf0ebf7b,0x3f623f46,0xbf75bdc9,0xbf0e3e48,0xbf7b3f55,0xbf7f3f62,0xbf463f75
.long 0x3f7bbf0e,0xbf55be48,0x3f75bdc9,0xbef1bf22,0xbf55bf7b,0xbe48bf0e,0xbf46bf75,0xbdc9bef1
.long 0xbf7bbf0e,0x3f55be48,0xbf62bf46,0x3f753dc9,0x3f55bf7b,0x3e48bf0e,0x3f7fbf62,0x3f46bf75
.long 0xbe48bf55,0xbf0e3f7b,0xbf753dc9,0x3ef13f22,0xbf0ebe48,0xbf7bbf55,0x3f463f75,0x3dc93ef1
.long 0x3f7b3f0e,0xbf553e48,0xbef13f22,0xbe95bf7f,0xbf553f7b,0xbe483f0e,0x3dc9bef1,0xbf223e95
.long 0x3e483f55,0x3f0ebf7b,0x3e95bf7f,0xbf623f46,0x3f0e3e48,0x3f7b3f55,0xbf22be95,0xbf7fbf62
.long 0xbf7bbf0e,0x3f55be48,0x3f623f46,0xbf75bdc9,0x3f55bf7b,0x3e48bf0e,0xbf7f3f62,0xbf463f75
.long 0xbe48bf55,0xbf0e3f7b,0x3f75bdc9,0xbef1bf22,0xbf0ebe48,0xbf7bbf55,0xbf46bf75,0xbdc9bef1
.long 0x3f7b3f0e,0xbf553e48,0x3ef1bf22,0x3e953f7f,0xbf553f7b,0xbe483f0e,0xbdc93ef1,0x3f22be95
.long 0x3e483f55,0x3f0ebf7b,0xbe953f7f,0x3f62bf46,0x3f0e3e48,0x3f7b3f55,0x3f223e95,0x3f7f3f62
.long 0xbe483f55,0xbf0ebf7b,0xbef13f22,0xbe95bf7f,0xbf0e3e48,0xbf7b3f55,0x3dc9bef1,0xbf223e95
.long 0x3f7bbf0e,0xbf55be48,0x3e95bf7f,0xbf623f46,0xbf55bf7b,0xbe48bf0e,0xbf22be95,0xbf7fbf62
.long 0x3e48bf55,0x3f0e3f7b,0x3f623f46,0xbf75bdc9,0x3f0ebe48,0x3f7bbf55,0xbf7f3f62,0xbf463f75
.long 0xbf7b3f0e,0x3f553e48,0x3f75bdc9,0xbef1bf22,0x3f553f7b,0x3e483f0e,0xbf46bf75,0xbdc9bef1
.long 0xbe483f55,0xbf0ebf7b,0x3ef1bf22,0x3e953f7f,0xbf0e3e48,0xbf7b3f55,0xbdc93ef1,0x3f22be95
.long 0x3f7bbf0e,0xbf55be48,0xbe953f7f,0x3f62bf46,0xbf55bf7b,0xbe48bf0e,0x3f223e95,0x3f7f3f62
.long 0x3e48bf55,0x3f0e3f7b,0xbf62bf46,0x3f753dc9,0x3f0ebe48,0x3f7bbf55,0x3f7fbf62,0x3f46bf75
.long 0xbf7b3f0e,0x3f553e48,0xbf753dc9,0x3ef13f22,0x3f553f7b,0x3e483f0e,0x3f463f75,0x3dc93ef1
.p2align 8
tab_TW:
.long 0x3f800000,0x3f800000,0x3f800000,0x3f800000,0x3f800000,0x3f7ffb11,0x3f7fec43,0x3f7fd397
.long 0x3f800000,0x3f7fec43,0x3f7fb10f,0x3f7f4e6d,0x3f800000,0x3f7fd397,0x3f7f4e6d,0x3f7e70b0
.long 0x3f800000,0x3f7fb10f,0x3f7ec46d,0x3f7d3aac,0x3f800000,0x3f7f84ab,0x3f7e1324,0x3f7baccd
.long 0x3f800000,0x3f7f4e6d,0x3f7d3aac,0x3f79c79d,0x3f800000,0x3f7f0e58,0x3f7c3b28,0x3f778bc5
.long 0x3f800000,0x3f7ec46d,0x3f7b14be,0x3f74fa0b,0x3f800000,0x3f7e70b0,0x3f79c79d,0x3f721352
.long 0x3f800000,0x3f7e1324,0x3f7853f8,0x3f6ed89e,0x3f800000,0x3f7dabcc,0x3f76ba07,0x3f6b4b0c
.long 0x3f800000,0x3f7d3aac,0x3f74fa0b,0x3f676bd8,0x3f800000,0x3f7cbfc9,0x3f731447,0x3f633c5a
.long 0x3f800000,0x3f7c3b28,0x3f710908,0x3f5ebe05,0x3f800000,0x3f7baccd,0x3f6ed89e,0x3f59f26a
.long 0x3f800000,0x3f800000,0x3f800000,0x3f800000,0x3f7fb10f,0x3f7f84ab,0x3f7f4e6d,0x3f7f0e58
.long 0x3f7ec46d,0x3f7e1324,0x3f7d3aac,0x3f7c3b28,0x3f7d3aac,0x3f7baccd,0x3f79c79d,0x3f778bc5
.long 0x3f7b14be,0x3f7853f8,0x3f74fa0b,0x3f710908,0x3f7853f8,0x3f740bdd,0x3f6ed89e,0x3f68bf3c
.long 0x3f74fa0b,0x3f6ed89e,0x3f676bd8,0x3f5ebe05,0x3f710908,0x3f68bf3c,0x3f5ebe05,0x3f531849
.long 0x3f6c835e,0x3f61c598,0x3f54db31,0x3f45e403,0x3f676bd8,0x3f59f26a,0x3f49d112,0x3f373a23
.long 0x3f61c598,0x3f514d3d,0x3f3daef9,0x3f273656,0x3f5b941a,0x3f47de65,0x3f3085bb,0x3f15f6d9
.long 0x3f54db31,0x3f3daef9,0x3f226799,0x3f039c3d,0x3f4d9f02,0x3f32c8c9,0x3f13682a,0x3ee0924f
.long 0x3f45e403,0x3f273656,0x3f039c3d,0x3eb8442a,0x3f3daef9,0x3f1b02c6,0x3ee63375,0x3e8e9a22
.long 0x3f800000,0x3f800000,0x3f800000,0x3f800000,0x3f7ec46d,0x3f7e70b0,0x3f7e1324,0x3f7dabcc
.long 0x3f7b14be,0x3f79c79d,0x3f7853f8,0x3f76ba07,0x3f74fa0b,0x3f721352,0x3f6ed89e,0x3f6b4b0c
.long 0x3f6c835e,0x3f676bd8,0x3f61c598,0x3f5b941a,0x3f61c598,0x3f59f26a,0x3f514d3d,0x3f47de65
.long 0x3f54db31,0x3f49d112,0x3f3daef9,0x3f3085bb,0x3f45e403,0x3f373a23,0x3f273656,0x3f15f6d9
.long 0x3f3504f3,0x3f226799,0x3f0e39da,0x3ef15aea,0x3f226799,0x3f0b9a6b,0x3ee63375,0x3eb263ef
.long 0x3f0e39da,0x3ee63375,0x3eac7cd4,0x3e605c13,0x3ef15aea,0x3eb263ef,0x3e605c13,0x3dafb680
.long 0x3ec3ef15,0x3e78cfcc,0x3dc8bd36,0xbd48fb30,0x3e94a031,0x3e09cf86,0xbcc90ab0,0xbe3b6ecf
.long 0x3e47c5c2,0x3cc90ab0,0xbe164083,0xbea09ae5,0x3dc8bd36,0xbdafb680,0xbe888e93,0xbee0924f
.long 0x3f800000,0x3f800000,0x3f800000,0x3f800000,0x3f7d3aac,0x3f7cbfc9,0x3f7c3b28,0x3f7baccd
.long 0x3f74fa0b,0x3f731447,0x3f710908,0x3f6ed89e,0x3f676bd8,0x3f633c5a,0x3f5ebe05,0x3f59f26a
.long 0x3f54db31,0x3f4d9f02,0x3f45e403,0x3f3daef9,0x3f3daef9,0x3f32c8c9,0x3f273656,0x3f1b02c6
.long 0x3f226799,0x3f13682a,0x3f039c3d,0x3ee63375,0x3f039c3d,0x3ee0924f,0x3eb8442a,0x3e8e9a22
.long 0x3ec3ef15,0x3e94a031,0x3e47c5c2,0x3dc8bd36,0x3e78cfcc,0x3e09cf86,0x3cc90ab0,0xbdafb680
.long 0x3dc8bd36,0xbcc90ab0,0xbe164083,0xbe888e93,0xbd48fb30,0xbe3b6ecf,0xbea09ae5,0xbee0924f
.long 0xbe47c5c2,0xbeac7cd4,0xbef15aea,0xbf187fc0,0xbeac7cd4,0xbef6e0cb,0xbf1d7fd1,0xbf3b8f3b
.long 0xbef15aea,0xbf1d7fd1,0xbf3daef9,0xbf584853,0xbf187fc0,0xbf3b8f3b,0xbf584853,0xbf6db293
.long 0x3f800000,0x3f800000,0x3f800000,0x3f800000,0x3f7fffb1,0x3f7ff84a,0x3f7fe705,0x3f7fcbe2
.long 0x3f7ffec4,0x3f7fe129,0x3f7f9c18,0x3f7f2f9d,0x3f7ffd39,0x3f7fba9e,0x3f7f1f49,0x3f7e2b72
.long 0x3f7ffb11,0x3f7f84ab,0x3f7e70b0,0x3f7cbfc9,0x3f7ff84a,0x3f7f3f54,0x3f7d906e,0x3f7aed37
.long 0x3f7ff4e6,0x3f7eea9d,0x3f7c7eb0,0x3f78b47b,0x3f7ff0e3,0x3f7e868b,0x3f7b3bab,0x3f76167a
.long 0x3f7fec43,0x3f7e1324,0x3f79c79d,0x3f731447,0x3f7fe705,0x3f7d906e,0x3f7822d1,0x3f6faf1b
.long 0x3f7fe129,0x3f7cfe73,0x3f764d97,0x3f6be858,0x3f7fdaaf,0x3f7c5d3a,0x3f74484b,0x3f67c187
.long 0x3f7fd397,0x3f7baccd,0x3f721352,0x3f633c5a,0x3f7fcbe2,0x3f7aed37,0x3f6faf1b,0x3f5e5aa6
.long 0x3f7fc38f,0x3f7a1e84,0x3f6d1c1d,0x3f591e6a,0x3f7fba9e,0x3f7940c0,0x3f6a5ad9,0x3f5389c7
.long 0x3f800000,0x3f800000,0x3f800000,0x3f800000,0x3f7fa6e3,0x3f7f7808,0x3f7f3f54,0x3f7efcc9
.long 0x3f7e9bc9,0x3f7de0b1,0x3f7cfe73,0x3f7bf531,0x3f7cdf6c,0x3f7b3bab,0x3f7940c0,0x3f76ef5b
.long 0x3f7a7302,0x3f778bc5,0x3f740bdd,0x3f6ff573,0x3f77583a,0x3f72d4eb,0x3f6d67a1,0x3f671599
.long 0x3f73913f,0x3f6d1c1d,0x3f655e0b,0x3f5c61c7,0x3f6f20b0,0x3f666771,0x3f5bfb34,0x3f4fefa8
.long 0x3f6a09a7,0x3f5ebe05,0x3f514d3d,0x3f41d870,0x3f644fac,0x3f5627fe,0x3f456439,0x3f3238aa
.long 0x3f5df6be,0x3f4cae79,0x3f385216,0x3f212ff9,0x3f570348,0x3f425b89,0x3f2a2a80,0x3f0ee0db
.long 0x3f4f7a1f,0x3f373a23,0x3f1b02c6,0x3ef6e0cb,0x3f476085,0x3f2b561b,0x3f0af1b7,0x3ece0bea
.long 0x3f3ebc1b,0x3f1ebc12,0x3ef41f07,0x3ea395c5,0x3f3592e7,0x3f11796b,0x3ed0eb2a,0x3e6fa8b2
.long 0x3f800000,0x3f800000,0x3f800000,0x3f800000,0x3f7eb069,0x3f7e5a38,0x3f7dfa38,0x3f7d906e
.long 0x3f7ac516,0x3f796e4e,0x3f77f110,0x3f764d97,0x3f74484b,0x3f714c7a,0x3f6dfcf2,0x3f6a5ad9
.long 0x3f6b4b0c,0x3f660f88,0x3f604621,0x3f59f26a,0x3f5fe4e9,0x3f57dc7f,0x3f4f0417,0x3f456439
.long 0x3f5233c6,0x3f46e22a,0x3f3a7ca4,0x3f2d1469,0x3f425b89,0x3f33587a,0x3f2302d3,0x3f11796b
.long 0x3f3085bb,0x3f1d7fd1,0x3f08f59b,0x3ee63375,0x3f1ce11f,0x3f05a02c,0x3ed97cb9,0x3ea5129f
.long 0x3f07a136,0x3ed8106b,0x3e9d9e78,0x3e419b37,0x3ee1fb6a,0x3ea21887,0x3e3e853e,0x3d55880e
.long 0x3eb263ef,0x3e541501,0x3d7b2b74,0xbdafb680,0x3e80f8c0,0x3dc27c39,0xbd83db0a,0xbe636c83
.long 0x3e1c76de,0xbc96c9b6,0xbe419b37,0xbeb554ec,0x3d55880e,0xbe06b26e,0xbe9f1cdf,0xbef58035
.long 0x3f800000,0x3f800000,0x3f800000,0x3f800000,0x3f7d1cdd,0x3f7c9f8a,0x3f7c187a,0x3f7b87b2
.long 0x3f748422,0x3f7294f8,0x3f708066,0x3f6e46be,0x3f666771,0x3f62241a,0x3f5d924d,0x3f58b3a1
.long 0x3f531849,0x3f4bbbf8,0x3f43e200,0x3f3b8f3b,0x3f3b0629,0x3f2ff3e6,0x3f24381a,0x3f17de12
.long 0x3f1ebc12,0x3f0f8784,0x3eff17b2,0x3eddbe79,0x3efdbabb,0x3ed6a399,0x3eadf73c,0x3e840270
.long 0x3eb8442a,0x3e888e93,0x3e2f10a2,0x3d96a905,0x3e5d4b1a,0x3ddb7d37,0xbb490fc6,0xbde7fa9a
.long 0x3d8a200a,0xbd621469,0xbe354098,0xbe97a117,0xbda973ba,0xbe5d4b1a,0xbeb0eacb,0xbeeff7fb
.long 0xbe6c9a7f,0xbebe1d4a,0xbf00e7e4,0xbf1ff6cb,0xbebf926f,0xbf044889,0xbf256bcb,0xbf425b89
.long 0xbf0242b1,0xbf26050a,0xbf44e3f5,0xbf5df6be,0xbf21cbfb,0xbf436051,0xbf5e5aa6,0xbf71d19f
.long 0x3f800000,0x3f800000,0x3f800000,0x3f800000,0x3f7ffec4,0x3f7ff4e6,0x3f7fe129,0x3f7fc38f
.long 0x3f7ffb11,0x3f7fd397,0x3f7f84ab,0x3f7f0e58,0x3f7ff4e6,0x3f7f9c18,0x3f7eea9d,0x3f7de0b1
.long 0x3f7fec43,0x3f7f4e6d,0x3f7e1324,0x3f7c3b28,0x3f7fe129,0x3f7eea9d,0x3f7cfe73,0x3f7a1e84
.long 0x3f7fd397,0x3f7e70b0,0x3f7baccd,0x3f778bc5,0x3f7fc38f,0x3f7de0b1,0x3f7a1e84,0x3f748422
.long 0x3f7fb10f,0x3f7d3aac,0x3f7853f8,0x3f710908,0x3f7f9c18,0x3f7c7eb0,0x3f764d97,0x3f6d1c1d
.long 0x3f7f84ab,0x3f7baccd,0x3f740bdd,0x3f68bf3c,0x3f7f6ac7,0x3f7ac516,0x3f718f57,0x3f63f473
.long 0x3f7f4e6d,0x3f79c79d,0x3f6ed89e,0x3f5ebe05,0x3f7f2f9d,0x3f78b47b,0x3f6be858,0x3f591e6a
.long 0x3f7f0e58,0x3f778bc5,0x3f68bf3c,0x3f531849,0x3f7eea9d,0x3f764d97,0x3f655e0b,0x3f4cae79
.long 0x3f800000,0x3f800000,0x3f800000,0x3f800000,0x3f7f9c18,0x3f7f6ac7,0x3f7f2f9d,0x3f7eea9d
.long 0x3f7e70b0,0x3f7dabcc,0x3f7cbfc9,0x3f7baccd,0x3f7c7eb0,0x3f7ac516,0x3f78b47b,0x3f764d97
.long 0x3f79c79d,0x3f76ba07,0x3f731447,0x3f6ed89e,0x3f764d97,0x3f718f57,0x3f6be858,0x3f655e0b
.long 0x3f721352,0x3f6b4b0c,0x3f633c5a,0x3f59f26a,0x3f6d1c1d,0x3f63f473,0x3f591e6a,0x3f4cae79
.long 0x3f676bd8,0x3f5b941a,0x3f4d9f02,0x3f3daef9,0x3f6106f2,0x3f5233c6,0x3f40d0da,0x3f2d1469
.long 0x3f59f26a,0x3f47de65,0x3f32c8c9,0x3f1b02c6,0x3f5233c6,0x3f3ca003,0x3f239da9,0x3f07a136
.long 0x3f49d112,0x3f3085bb,0x3f13682a,0x3ee63375,0x3f40d0da,0x3f239da9,0x3f0242b1,0x3ebb31a0
.long 0x3f373a23,0x3f15f6d9,0x3ee0924f,0x3e8e9a22,0x3f2d1469,0x3f07a136,0x3ebb31a0,0x3e419b37
.long 0x3f800000,0x3f800000,0x3f800000,0x3f800000,0x3f7e9bc9,0x3f7e4323,0x3f7de0b1,0x3f7d7474
.long 0x3f7a7302,0x3f791298,0x3f778bc5,0x3f75dec6,0x3f73913f,0x3f708066,0x3f6d1c1d,0x3f696591
.long 0x3f6a09a7,0x3f64aa59,0x3f5ebe05,0x3f584853,0x3f5df6be,0x3f55b993,0x3f4cae79,0x3f42de29
.long 0x3f4f7a1f,0x3f43e200,0x3f373a23,0x3f299415,0x3f3ebc1b,0x3f2f61a5,0x3f1ebc12,0x3f0cead0
.long 0x3f2beb4a,0x3f187fc0,0x3f039c3d,0x3edae880,0x3f173c07,0x3eff17b2,0x3ecc9b8b,0x3e97a117
.long 0x3f00e7e4,0x3ec9b953,0x3e8e9a22,0x3e22abb6,0x3ed25a09,0x3e919ddd,0x3e1c76de,0x3c96c9b6
.long 0x3ea09ae5,0x3e2f10a2,0x3cc90ab0,0xbdfab273,0x3e5a3997,0x3d621469,0xbdd53db9,0xbe8586ce
.long 0x3de1bc2e,0xbd7b2b74,0xbe6c9a7f,0xbec9b953,0x3bc90f88,0xbe354098,0xbeb554ec,0xbf04f484
.long 0x3f800000,0x3f800000,0x3f800000,0x3f800000,0x3f7cfe73,0x3f7c7eb0,0x3f7bf531,0x3f7b61fc
.long 0x3f740bdd,0x3f721352,0x3f6ff573,0x3f6db293,0x3f655e0b,0x3f6106f2,0x3f5c61c7,0x3f577026
.long 0x3f514d3d,0x3f49d112,0x3f41d870,0x3f396842,0x3f385216,0x3f2d1469,0x3f212ff9,0x3f14b039
.long 0x3f1b02c6,0x3f0b9a6b,0x3ef6e0cb,0x3ed53641,0x3ef41f07,0x3ecc9b8b,0x3ea395c5,0x3e72b651
.long 0x3eac7cd4,0x3e78cfcc,0x3e164083,0x3d48fb30,0x3e419b37,0x3da3308c,0xbcfb49ba,0xbe1008b7
.long 0x3d16c32c,0xbdafb680,0xbe541501,0xbea68f12,0xbdee3876,0xbe7ee6e1,0xbec1071e,0xbeff17b2
.long 0xbe888e93,0xbecf7bca,0xbf08f59b,0xbf273656,0xbed25a09,0xbf0cead0,0xbf2d1469,0xbf48d8b3
.long 0xbf0b9a6b,0xbf2e3bde,0xbf4bbbf8,0xbf633c5a,0xbf2ac082,0xbf4ac77f,0xbf63f473,0xbf756d97
.long 0x3f800000,0x3f800000,0x3f800000,0x3f800000,0x3f7ffd39,0x3f7ff0e3,0x3f7fdaaf,0x3f7fba9e
.long 0x3f7ff4e6,0x3f7fc38f,0x3f7f6ac7,0x3f7eea9d,0x3f7fe705,0x3f7f7808,0x3f7eb069,0x3f7d906e
.long 0x3f7fd397,0x3f7f0e58,0x3f7dabcc,0x3f7baccd,0x3f7fba9e,0x3f7e868b,0x3f7c5d3a,0x3f7940c0
.long 0x3f7f9c18,0x3f7de0b1,0x3f7ac516,0x3f764d97,0x3f7f7808,0x3f7d1cdd,0x3f78e3d6,0x3f72d4eb
.long 0x3f7f4e6d,0x3f7c3b28,0x3f76ba07,0x3f6ed89e,0x3f7f1f49,0x3f7b3bab,0x3f74484b,0x3f6a5ad9
.long 0x3f7eea9d,0x3f7a1e84,0x3f718f57,0x3f655e0b,0x3f7eb069,0x3f78e3d6,0x3f6e8ff8,0x3f5fe4e9
.long 0x3f7e70b0,0x3f778bc5,0x3f6b4b0c,0x3f59f26a,0x3f7e2b72,0x3f76167a,0x3f67c187,0x3f5389c7
.long 0x3f7de0b1,0x3f748422,0x3f63f473,0x3f4cae79,0x3f7d906e,0x3f72d4eb,0x3f5fe4e9,0x3f456439
.long 0x3f800000,0x3f800000,0x3f800000,0x3f800000,0x3f7f90b1,0x3f7f5ce9,0x3f7f1f49,0x3f7ed7d4
.long 0x3f7e4323,0x3f7d7474,0x3f7c7eb0,0x3f7b61fc,0x3f7c187a,0x3f7a4910,0x3f7822d1,0x3f75a67b
.long 0x3f791298,0x3f75dec6,0x3f721352,0x3f6db293,0x3f75341d,0x3f703b37,0x3f6a5ad9,0x3f6398ac
.long 0x3f708066,0x3f696591,0x3f6106f2,0x3f577026,0x3f6afb8c,0x3f61668a,0x3f5627fe,0x3f495521
.long 0x3f64aa59,0x3f584853,0x3f49d112,0x3f396842,0x3f5d924d,0x3f4e1689,0x3f3c17d9,0x3f27ce61
.long 0x3f55b993,0x3f42de29,0x3f2d1469,0x3f14b039,0x3f4d26fd,0x3f36ad7f,0x3f1ce11f,0x3f003a06
.long 0x3f43e200,0x3f299415,0x3f0b9a6b,0x3ed53641,0x3f39f2ac,0x3f1ba299,0x3ef2bd43,0x3ea80b1f
.long 0x3f2f61a5,0x3f0cead0,0x3ecc9b8b,0x3e72b651,0x3f24381a,0x3efafef7,0x3ea5129f,0x3e1324ca
.long 0x3f800000,0x3f800000,0x3f800000,0x3f800000,0x3f7e868b,0x3f7e2b72,0x3f7dc68c,0x3f7d57de
.long 0x3f7a1e84,0x3f78b47b,0x3f772417,0x3f756d97,0x3f72d4eb,0x3f6faf1b,0x3f6c3624,0x3f686b39
.long 0x3f68bf3c,0x3f633c5a,0x3f5d2d53,0x3f5695e5,0x3f5bfb34,0x3f5389c7,0x3f4a4c87,0x3f404c5c
.long 0x3f4cae79,0x3f40d0da,0x3f33e7bc,0x3f26050a,0x3f3b0629,0x3f2b561b,0x3f1a6293,0x3f084b92
.long 0x3f273656,0x3f13682a,0x3efc5d27,0x3ecf7bca,0x3f11796b,0x3ef2bd43,0x3ebf926f,0x3e8a11f7
.long 0x3ef41f07,0x3ebb31a0,0x3e7ee6e1,0x3e039502,0x3ec27b55,0x3e80f8c0,0x3df475c0,0xbc7b514b
.long 0x3e8e9a22,0x3e09cf86,0xbc490e90,0xbe22abb6,0x3e3228d4,0x3c7b514b,0xbe1324ca,0xbe9920fe
.long 0x3d8a200a,0xbdd53db9,0xbe8b9507,0xbeddbe79,0xbd2351cb,0xbe636c83,0xbecb2aae,0xbf0ee0db
.long 0x3f800000,0x3f800000,0x3f800000,0x3f800000,0x3f7cdf6c,0x3f7c5d3a,0x3f7bd14d,0x3f7b3bab
.long 0x3f73913f,0x3f718f57,0x3f6f6830,0x3f6d1c1d,0x3f644fac,0x3f5fe4e9,0x3f5b2c79,0x3f5627fe
.long 0x3f4f7a1f,0x3f47de65,0x3f3fc767,0x3f373a23,0x3f3592e7,0x3f2a2a80,0x3f1e1e22,0x3f11796b
.long 0x3f173c07,0x3f07a136,0x3eee9479,0x3ecc9b8b,0x3eea6681,0x3ec27b55,0x3e9920fe,0x3e5d4b1a
.long 0x3ea09ae5,0x3e605c13,0x3dfab273,0x3cc90ab0,0x3e25c58c,0x3d55880e,0xbd6ea038,0xbe2bf804
.long 0x3bc90f88,0xbdee3876,0xbe72b651,0xbeb554ec,0xbe195be0,0xbe901c2c,0xbed0eb2a,0xbf06f686
.long 0xbe9aa086,0xbee0924f,0xbf10d3cd,0xbf2e3bde,0xbee4cbfe,0xbf1553b7,0xbf34768f,0xbf4f0417
.long 0xbf14b039,0xbf36206c,0xbf5233c6,0xbf6816a8,0xbf33587a,0xbf51c0c2,0xbf6912ae,0xbf788486
.long 0x80000000,0x80000000,0x80000000,0x80000000,0x80000000,0xbc490e90,0xbcc90ab0,0xbd16c32c
.long 0x80000000,0xbcc90ab0,0xbd48fb30,0xbd96a905,0x80000000,0xbd16c32c,0xbd96a905,0xbde1bc2e
.long 0x80000000,0xbd48fb30,0xbdc8bd36,0xbe164083,0x80000000,0xbd7b2b74,0xbdfab273,0xbe3b6ecf
.long 0x80000000,0xbd96a905,0xbe164083,0xbe605c13,0x80000000,0xbdafb680,0xbe2f10a2,0xbe827dc0
.long 0x80000000,0xbdc8bd36,0xbe47c5c2,0xbe94a031,0x80000000,0xbde1bc2e,0xbe605c13,0xbea68f12
.long 0x80000000,0xbdfab273,0xbe78cfcc,0xbeb8442a,0x80000000,0xbe09cf86,0xbe888e93,0xbec9b953
.long 0x80000000,0xbe164083,0xbe94a031,0xbedae880,0x80000000,0xbe22abb6,0xbea09ae5,0xbeebcbbb
.long 0x80000000,0xbe2f10a2,0xbeac7cd4,0xbefc5d27,0x80000000,0xbe3b6ecf,0xbeb8442a,0xbf064b82
.long 0x80000000,0x80000000,0x80000000,0x80000000,0xbd48fb30,0xbd7b2b74,0xbd96a905,0xbdafb680
.long 0xbdc8bd36,0xbdfab273,0xbe164083,0xbe2f10a2,0xbe164083,0xbe3b6ecf,0xbe605c13,0xbe827dc0
.long 0xbe47c5c2,0xbe78cfcc,0xbe94a031,0xbeac7cd4,0xbe78cfcc,0xbe9aa086,0xbeb8442a,0xbed53641
.long 0xbe94a031,0xbeb8442a,0xbedae880,0xbefc5d27,0xbeac7cd4,0xbed53641,0xbefc5d27,0xbf10d3cd
.long 0xbec3ef15,0xbef15aea,0xbf0e39da,0xbf226799,0xbedae880,0xbf064b82,0xbf1d7fd1,0xbf32c8c9
.long 0xbef15aea,0xbf13682a,0xbf2beb4a,0xbf41d870,0xbf039c3d,0xbf1ff6cb,0xbf396842,0xbf4f7a1f
.long 0xbf0e39da,0xbf2beb4a,0xbf45e403,0xbf5b941a,0xbf187fc0,0xbf373a23,0xbf514d3d,0xbf660f88
.long 0xbf226799,0xbf41d870,0xbf5b941a,0xbf6ed89e,0xbf2beb4a,0xbf4bbbf8,0xbf64aa59,0xbf75dec6
.long 0x80000000,0x80000000,0x80000000,0x80000000,0xbdc8bd36,0xbde1bc2e,0xbdfab273,0xbe09cf86
.long 0xbe47c5c2,0xbe605c13,0xbe78cfcc,0xbe888e93,0xbe94a031,0xbea68f12,0xbeb8442a,0xbec9b953
.long 0xbec3ef15,0xbedae880,0xbef15aea,0xbf039c3d,0xbef15aea,0xbf064b82,0xbf13682a,0xbf1ff6cb
.long 0xbf0e39da,0xbf1d7fd1,0xbf2beb4a,0xbf396842,0xbf226799,0xbf32c8c9,0xbf41d870,0xbf4f7a1f
.long 0xbf3504f3,0xbf45e403,0xbf54db31,0xbf61c598,0xbf45e403,0xbf5695e5,0xbf64aa59,0xbf6ff573
.long 0xbf54db31,0xbf64aa59,0xbf710908,0xbf79c79d,0xbf61c598,0xbf6ff573,0xbf79c79d,0xbf7f0e58
.long 0xbf6c835e,0xbf7853f8,0xbf7ec46d,0xbf7fb10f,0xbf74fa0b,0xbf7dabcc,0xbf7fec43,0xbf7baccd
.long 0xbf7b14be,0xbf7fec43,0xbf7d3aac,0xbf731447,0xbf7ec46d,0xbf7f0e58,0xbf76ba07,0xbf660f88
.long 0x80000000,0x80000000,0x80000000,0x80000000,0xbe164083,0xbe22abb6,0xbe2f10a2,0xbe3b6ecf
.long 0xbe94a031,0xbea09ae5,0xbeac7cd4,0xbeb8442a,0xbedae880,0xbeebcbbb,0xbefc5d27,0xbf064b82
.long 0xbf0e39da,0xbf187fc0,0xbf226799,0xbf2beb4a,0xbf2beb4a,0xbf373a23,0xbf41d870,0xbf4bbbf8
.long 0xbf45e403,0xbf514d3d,0xbf5b941a,0xbf64aa59,0xbf5b941a,0xbf660f88,0xbf6ed89e,0xbf75dec6
.long 0xbf6c835e,0xbf74fa0b,0xbf7b14be,0xbf7ec46d,0xbf7853f8,0xbf7dabcc,0xbf7fec43,0xbf7f0e58
.long 0xbf7ec46d,0xbf7fec43,0xbf7d3aac,0xbf76ba07,0xbf7fb10f,0xbf7baccd,0xbf731447,0xbf660f88
.long 0xbf7b14be,0xbf710908,0xbf61c598,0xbf4d9f02,0xbf710908,0xbf604621,0xbf49d112,0xbf2e3bde
.long 0xbf61c598,0xbf49d112,0xbf2beb4a,0xbf08f59b,0xbf4d9f02,0xbf2e3bde,0xbf08f59b,0xbebe1d4a
.long 0x80000000,0x80000000,0x80000000,0x80000000,0xbb490fc6,0xbc7b514b,0xbce22a7a,0xbd2351cb
.long 0xbbc90f88,0xbcfb49ba,0xbd621469,0xbda3308c,0xbc16cb58,0xbd3c6dd5,0xbda973ba,0xbdf475c0
.long 0xbc490e90,0xbd7b2b74,0xbde1bc2e,0xbe22abb6,0xbc7b514b,0xbd9cecf9,0xbe0cec4a,0xbe4ada4f
.long 0xbc96c9b6,0xbdbc3ac3,0xbe28defc,0xbe72b651,0xbcafea69,0xbddb7d37,0xbe44b0b9,0xbe8d17c0
.long 0xbcc90ab0,0xbdfab273,0xbe605c13,0xbea09ae5,0xbce22a7a,0xbe0cec4a,0xbe7bdba4,0xbeb3dca5
.long 0xbcfb49ba,0xbe1c76de,0xbe8b9507,0xbec6d529,0xbd0a342f,0xbe2bf804,0xbe9920fe,0xbed97cb9
.long 0xbd16c32c,0xbe3b6ecf,0xbea68f12,0xbeebcbbb,0xbd2351cb,0xbe4ada4f,0xbeb3dca5,0xbefdbabb
.long 0xbd2fe007,0xbe5a3997,0xbec1071e,0xbf07a136,0xbd3c6dd5,0xbe698bba,0xbece0bea,0xbf102dd5
.long 0x80000000,0x80000000,0x80000000,0x80000000,0xbd55880e,0xbd83db0a,0xbd9cecf9,0xbdb5f8da
.long 0xbdd53db9,0xbe039502,0xbe1c76de,0xbe354098,0xbe1f917b,0xbe44b0b9,0xbe698bba,0xbe870ada
.long 0xbe541501,0xbe827dc0,0xbe9aa086,0xbeb263ef,0xbe840270,0xbea21887,0xbebf926f,0xbedc53c1
.long 0xbe9d9e78,0xbec1071e,0xbee363fa,0xbf0242b1,0xbeb6ccc3,0xbedf28a9,0xbf02ef9f,0xbf1553b7
.long 0xbecf7bca,0xbefc5d27,0xbf13682a,0xbf273656,0xbee79a5d,0xbf0c42c9,0xbf2302d3,0xbf37c655
.long 0xbeff17b2,0xbf19c200,0xbf31a81d,0xbf46e22a,0xbf0af1b7,0xbf269de3,0xbf3f41fc,0xbf546b3b
.long 0xbf15f6d9,0xbf32c8c9,0xbf4bbbf8,0xbf604621,0xbf209393,0xbf3e35c5,0xbf570348,0xbf6a5ad9
.long 0xbf2ac082,0xbf48d8b3,0xbf6106f2,0xbf7294f8,0xbf34768f,0xbf52a649,0xbf69b7e4,0xbf78e3d6
.long 0x80000000,0x80000000,0x80000000,0x80000000,0xbdcefdb7,0xbde7fa9a,0xbe007745,0xbe0cec4a
.long 0xbe4dee60,0xbe667c66,0xbe7ee6e1,0xbe8b9507,0xbe9920fe,0xbeab0201,0xbebca7af,0xbece0bea
.long 0xbec9b953,0xbee0924f,0xbef6e0cb,0xbf064b82,0xbef840c8,0xbf099f4e,0xbf16999f,0xbf2302d3
.long 0xbf121eb0,0xbf212ff9,0xbf2f61a5,0xbf3ca003,0xbf269de3,0xbf36ad7f,0xbf456439,0xbf52a649
.long 0xbf396842,0xbf49d112,0xbf584853,0xbf64aa59,0xbf4a4c87,0xbf5a5ba0,0xbf67c187,0xbf725470
.long 0xbf591e6a,0xbf6816a8,0xbf73913f,0xbf7b61fc,0xbf65b710,0xbf72d4eb,0xbf7b87b2,0xbf7fa6e3
.long 0xbf6ff573,0xbf7a7302,0xbf7f84ab,0xbf7f0e58,0xbf77beb7,0xbf7ed7d4,0xbf7f7808,0xbf799b43
.long 0xbf7cfe73,0xbf7ff4e6,0xbf7b61fc,0xbf6f6830,0xbf7fa6e3,0xbf7dc68c,0xbf73530e,0xbf60a6cf
.long 0x80000000,0x80000000,0x80000000,0x80000000,0xbe195be0,0xbe25c58c,0xbe3228d4,0xbe3e853e
.long 0xbe97a117,0xbea395c5,0xbeaf713a,0xbebb31a0,0xbedf28a9,0xbeeff7fb,0xbf003a06,0xbf084b92
.long 0xbf10d3cd,0xbf1b02c6,0xbf24d225,0xbf2e3bde,0xbf2ecef7,0xbf39f2ac,0xbf446337,0xbf4e1689
.long 0xbf48d8b3,0xbf53fac3,0xbf5df6be,0xbf66becc,0xbf5e5aa6,0xbf686b39,0xbf70c501,0xbf77583a
.long 0xbf6ed89e,0xbf76ba07,0xbf7c3b28,0xbf7f4e6d,0xbf79f35e,0xbf7e868b,0xbf7fffb1,0xbf7e5a38
.long 0xbf7f6ac7,0xbf7f9c18,0xbf7bf531,0xbf748422,0xbf7f1f49,0xbf79f35e,0xbf703b37,0xbf62241a
.long 0xbf791298,0xbf6db293,0xbf5d2d53,0xbf47de65,0xbf6d67a1,0xbf5b2c79,0xbf436051,0xbf269de3
.long 0xbf5c61c7,0xbf42de29,0xbf239da9,0xbeff17b2,0xbf466354,0xbf256bcb,0xbefdbabb,0xbea80b1f
.long 0x80000000,0x80000000,0x80000000,0x80000000,0xbbc90f88,0xbc96c9b6,0xbcfb49ba,0xbd2fe007
.long 0xbc490e90,0xbd16c32c,0xbd7b2b74,0xbdafb680,0xbc96c9b6,0xbd621469,0xbdbc3ac3,0xbe039502
.long 0xbcc90ab0,0xbd96a905,0xbdfab273,0xbe2f10a2,0xbcfb49ba,0xbdbc3ac3,0xbe1c76de,0xbe5a3997
.long 0xbd16c32c,0xbde1bc2e,0xbe3b6ecf,0xbe827dc0,0xbd2fe007,0xbe039502,0xbe5a3997,0xbe97a117
.long 0xbd48fb30,0xbe164083,0xbe78cfcc,0xbeac7cd4,0xbd621469,0xbe28defc,0xbe8b9507,0xbec1071e
.long 0xbd7b2b74,0xbe3b6ecf,0xbe9aa086,0xbed53641,0xbd8a200a,0xbe4dee60,0xbea986c4,0xbee900b7
.long 0xbd96a905,0xbe605c13,0xbeb8442a,0xbefc5d27,0xbda3308c,0xbe72b651,0xbec6d529,0xbf07a136
.long 0xbdafb680,0xbe827dc0,0xbed53641,0xbf10d3cd,0xbdbc3ac3,0xbe8b9507,0xbee363fa,0xbf19c200
.long 0x80000000,0x80000000,0x80000000,0x80000000,0xbd621469,0xbd8a200a,0xbda3308c,0xbdbc3ac3
.long 0xbde1bc2e,0xbe09cf86,0xbe22abb6,0xbe3b6ecf,0xbe28defc,0xbe4dee60,0xbe72b651,0xbe8b9507
.long 0xbe605c13,0xbe888e93,0xbea09ae5,0xbeb8442a,0xbe8b9507,0xbea986c4,0xbec6d529,0xbee363fa
.long 0xbea68f12,0xbec9b953,0xbeebcbbb,0xbf064b82,0xbec1071e,0xbee900b7,0xbf07a136,0xbf19c200
.long 0xbedae880,0xbf039c3d,0xbf187fc0,0xbf2beb4a,0xbef41f07,0xbf121eb0,0xbf286605,0xbf3ca003
.long 0xbf064b82,0xbf1ff6cb,0xbf373a23,0xbf4bbbf8,0xbf121eb0,0xbf2d1469,0xbf44e3f5,0xbf591e6a
.long 0xbf1d7fd1,0xbf396842,0xbf514d3d,0xbf64aa59,0xbf286605,0xbf44e3f5,0xbf5c61c7,0xbf6e46be
.long 0xbf32c8c9,0xbf4f7a1f,0xbf660f88,0xbf75dec6,0xbf3ca003,0xbf591e6a,0xbf6e46be,0xbf7b61fc
.long 0x80000000,0x80000000,0x80000000,0x80000000,0xbdd53db9,0xbdee3876,0xbe039502,0xbe1008b7
.long 0xbe541501,0xbe6c9a7f,0xbe827dc0,0xbe8e9a22,0xbe9d9e78,0xbeaf713a,0xbec1071e,0xbed25a09
.long 0xbecf7bca,0xbee63375,0xbefc5d27,0xbf08f59b,0xbeff17b2,0xbf0cead0,0xbf19c200,0xbf26050a
.long 0xbf15f6d9,0xbf24d225,0xbf32c8c9,0xbf3fc767,0xbf2ac082,0xbf3a7ca4,0xbf48d8b3,0xbf55b993
.long 0xbf3daef9,0xbf4d9f02,0xbf5b941a,0xbf676bd8,0xbf4e8d90,0xbf5df6be,0xbf6aab7b,0xbf748422
.long 0xbf5d2d53,0xbf6b4b0c,0xbf75dec6,0xbf7cbfc9,0xbf696591,0xbf756d97,0xbf7cfe73,0xbf7ff4e6
.long 0xbf731447,0xbf7c3b28,0xbf7fec43,0xbf7e1324,0xbf7a1e84,0xbf7f9c18,0xbf7e9bc9,0xbf772417
.long 0xbf7e70b0,0xbf7f84ab,0xbf791298,0xbf6b4b0c,0xbf7ffec4,0xbf7bf531,0xbf6f6830,0xbf5ac450
.long 0x80000000,0x80000000,0x80000000,0x80000000,0xbe1c76de,0xbe28defc,0xbe354098,0xbe419b37
.long 0xbe9aa086,0xbea68f12,0xbeb263ef,0xbebe1d4a,0xbee363fa,0xbef41f07,0xbf0242b1,0xbf0a48ad
.long 0xbf13682a,0xbf1d7fd1,0xbf273656,0xbf3085bb,0xbf31a81d,0xbf3ca003,0xbf46e22a,0xbf5064af
.long 0xbf4bbbf8,0xbf5695e5,0xbf604621,0xbf68bf3c,0xbf6106f2,0xbf6aab7b,0xbf7294f8,0xbf78b47b
.long 0xbf710908,0xbf7853f8,0xbf7d3aac,0xbf7fb10f,0xbf7b61fc,0xbf7f2f9d,0xbf7fe129,0xbf7d7474
.long 0xbf7fd397,0xbf7f0e58,0xbf7a7302,0xbf721352,0xbf7e4323,0xbf77f110,0xbf6d1c1d,0xbf5df6be
.long 0xbf76ba07,0xbf6a09a7,0xbf584853,0xbf41d870,0xbf696591,0xbf55b993,0xbf3ca003,0xbf1ebc12
.long 0xbf5695e5,0xbf3b8f3b,0xbf1b02c6,0xbeebcbbb,0xbf3ebc1b,0xbf1c420c,0xbee900b7,0xbe919ddd
.long 0x80000000,0x80000000,0x80000000,0x80000000,0xbc16cb58,0xbcafea69,0xbd0a342f,0xbd3c6dd5
.long 0xbc96c9b6,0xbd2fe007,0xbd8a200a,0xbdbc3ac3,0xbce22a7a,0xbd83db0a,0xbdcefdb7,0xbe0cec4a
.long 0xbd16c32c,0xbdafb680,0xbe09cf86,0xbe3b6ecf,0xbd3c6dd5,0xbddb7d37,0xbe2bf804,0xbe698bba
.long 0xbd621469,0xbe039502,0xbe4dee60,0xbe8b9507,0xbd83db0a,0xbe195be0,0xbe6fa8b2,0xbea21887
.long 0xbd96a905,0xbe2f10a2,0xbe888e93,0xbeb8442a,0xbda973ba,0xbe44b0b9,0xbe9920fe,0xbece0bea
.long 0xbdbc3ac3,0xbe5a3997,0xbea986c4,0xbee363fa,0xbdcefdb7,0xbe6fa8b2,0xbeb9bb1e,0xbef840c8
.long 0xbde1bc2e,0xbe827dc0,0xbec9b953,0xbf064b82,0xbdf475c0,0xbe8d17c0,0xbed97cb9,0xbf102dd5
.long 0xbe039502,0xbe97a117,0xbee900b7,0xbf19c200,0xbe0cec4a,0xbea21887,0xbef840c8,0xbf2302d3
.long 0x80000000,0x80000000,0x80000000,0x80000000,0xbd6ea038,0xbd9064b4,0xbda973ba,0xbdc27c39
.long 0xbdee3876,0xbe1008b7,0xbe28defc,0xbe419b37,0xbe3228d4,0xbe57278f,0xbe7bdba4,0xbe901c2c
.long 0xbe6c9a7f,0xbe8e9a22,0xbea68f12,0xbebe1d4a,0xbe931f35,0xbeb0eacb,0xbece0bea,0xbeea6681
.long 0xbeaf713a,0xbed25a09,0xbef41f07,0xbf0a48ad,0xbecb2aae,0xbef2bd43,0xbf0c42c9,0xbf1e1e22
.long 0xbee63375,0xbf08f59b,0xbf1d7fd1,0xbf3085bb,0xbf003a06,0xbf17de12,0xbf2da859,0xbf4154e1
.long 0xbf0cead0,0xbf26050a,0xbf3ca003,0xbf5064af,0xbf19210f,0xbf33587a,0xbf4a4c87,0xbf5d924d
.long 0xbf24d225,0xbf3fc767,0xbf5695e5,0xbf68bf3c,0xbf2ff3e6,0xbf4b41fa,0xbf61668a,0xbf71d19f
.long 0xbf3a7ca4,0xbf55b993,0xbf6aab7b,0xbf78b47b,0xbf446337,0xbf5f20db,0xbf725470,0xbf7d57de
.long 0x80000000,0x80000000,0x80000000,0x80000000,0xbddb7d37,0xbdf475c0,0xbe06b26e,0xbe1324ca
.long 0xbe5a3997,0xbe72b651,0xbe8586ce,0xbe919ddd,0xbea21887,0xbeb3dca5,0xbec5625c,0xbed6a399
.long 0xbed53641,0xbeebcbbb,0xbf00e7e4,0xbf0b9a6b,0xbf02ef9f,0xbf102dd5,0xbf1ce11f,0xbf28fd41
.long 0xbf19c200,0xbf286605,0xbf36206c,0xbf42de29,0xbf2ecef7,0xbf3e35c5,0xbf4c3578,0xbf58b3a1
.long 0xbf41d870,0xbf514d3d,0xbf5ebe05,0xbf6a09a7,0xbf52a649,0xbf61668a,0xbf6d67a1,0xbf76841b
.long 0xbf6106f2,0xbf6e46be,0xbf77f110,0xbf7de0b1,0xbf6cd007,0xbf77beb7,0xbf7e2b72,0xbf7ff84a
.long 0xbf75dec6,0xbf7dabcc,0xbf7ffb11,0xbf7cbfc9,0xbf7c187a,0xbf7ff84a,0xbf7d57de,0xbf74484b
.long 0xbf7f6ac7,0xbf7e9bc9,0xbf764d97,0xbf66becc,0xbf7fcbe2,0xbf799b43,0xbf6afb8c,0xbf546b3b
.long 0x80000000,0x80000000,0x80000000,0x80000000,0xbe1f917b,0xbe2bf804,0xbe3857ec,0xbe44b0b9
.long 0xbe9d9e78,0xbea986c4,0xbeb554ec,0xbec1071e,0xbee79a5d,0xbef840c8,0xbf044889,0xbf0c42c9
.long 0xbf15f6d9,0xbf1ff6cb,0xbf299415,0xbf32c8c9,0xbf34768f,0xbf3f41fc,0xbf495521,0xbf52a649
.long 0xbf4e8d90,0xbf591e6a,0xbf628210,0xbf6aab7b,0xbf6398ac,0xbf6cd007,0xbf74484b,0xbf79f35e
.long 0xbf731447,0xbf79c79d,0xbf7e1324,0xbf7fec43,0xbf7c9f8a,0xbf7fa6e3,0xbf7f90b1,0xbf7c5d3a
.long 0xbf7ffec4,0xbf7e4323,0xbf78b47b,0xbf6f6830,0xbf7d1cdd,0xbf75a67b,0xbf69b7e4,0xbf5988ad
.long 0xbf740bdd,0xbf660f88,0xbf531849,0xbf3b8f3b,0xbf650479,0xbf4fefa8,0xbf3592e7,0xbf16999f
.long 0xbf5064af,0xbf33e7bc,0xbf121eb0,0xbed8106b,0xbf36ad7f,0xbf12c39a,0xbed3c867,0xbe75c35a
.long 0x3f800000,0x3f7b14be,0x3f6c835e,0x3f54db31,0x3f800000,0x3f7a7302,0x3f6a09a7,0x3f4f7a1f
.long 0x3f800000,0x3f79c79d,0x3f676bd8,0x3f49d112,0x3f800000,0x3f791298,0x3f64aa59,0x3f43e200
.long 0x3f800000,0x3f7853f8,0x3f61c598,0x3f3daef9,0x3f800000,0x3f778bc5,0x3f5ebe05,0x3f373a23
.long 0x3f800000,0x3f76ba07,0x3f5b941a,0x3f3085bb,0x3f800000,0x3f75dec6,0x3f584853,0x3f299415
.long 0x3f800000,0x3f74fa0b,0x3f54db31,0x3f226799,0x3f800000,0x3f740bdd,0x3f514d3d,0x3f1b02c6
.long 0x3f800000,0x3f731447,0x3f4d9f02,0x3f13682a,0x3f800000,0x3f721352,0x3f49d112,0x3f0b9a6b
.long 0x3f800000,0x3f710908,0x3f45e403,0x3f039c3d,0x3f800000,0x3f6ff573,0x3f41d870,0x3ef6e0cb
.long 0x3f800000,0x3f6ed89e,0x3f3daef9,0x3ee63375,0x3f800000,0x3f6db293,0x3f396842,0x3ed53641
.long 0x3f3504f3,0x3f0e39da,0x3ec3ef15,0x3e47c5c2,0x3f2beb4a,0x3f00e7e4,0x3ea09ae5,0x3de1bc2e
.long 0x3f226799,0x3ee63375,0x3e78cfcc,0x3cc90ab0,0x3f187fc0,0x3ec9b953,0x3e2f10a2,0xbd7b2b74
.long 0x3f0e39da,0x3eac7cd4,0x3dc8bd36,0xbe164083,0x3f039c3d,0x3e8e9a22,0x3cc90ab0,0xbe6c9a7f
.long 0x3ef15aea,0x3e605c13,0xbd48fb30,0xbea09ae5,0x3edae880,0x3e22abb6,0xbdfab273,0xbec9b953
.long 0x3ec3ef15,0x3dc8bd36,0xbe47c5c2,0xbef15aea,0x3eac7cd4,0x3d16c32c,0xbe888e93,0xbf0b9a6b
.long 0x3e94a031,0xbcc90ab0,0xbeac7cd4,0xbf1d7fd1,0x3e78cfcc,0xbdafb680,0xbecf7bca,0xbf2e3bde
.long 0x3e47c5c2,0xbe164083,0xbef15aea,0xbf3daef9,0x3e164083,0xbe541501,0xbf08f59b,0xbf4bbbf8
.long 0x3dc8bd36,0xbe888e93,0xbf187fc0,0xbf584853,0x3d48fb30,0xbea68f12,0xbf273656,0xbf633c5a
.long 0x248d3132,0xbe47c5c2,0xbec3ef15,0xbf0e39da,0xbdc8bd36,0xbe9aa086,0xbefc5d27,0xbf299415
.long 0xbe47c5c2,0xbecf7bca,0xbf187fc0,0xbf41d870,0xbe94a031,0xbf00e7e4,0xbf3085bb,0xbf5695e5
.long 0xbec3ef15,0xbf187fc0,0xbf45e403,0xbf676bd8,0xbef15aea,0xbf2e3bde,0xbf584853,0xbf740bdd
.long 0xbf0e39da,0xbf41d870,0xbf676bd8,0xbf7c3b28,0xbf226799,0xbf531849,0xbf731447,0xbf7fd397
.long 0xbf3504f3,0xbf61c598,0xbf7b14be,0xbf7ec46d,0xbf45e403,0xbf6db293,0xbf7f4e6d,0xbf791298
.long 0xbf54db31,0xbf76ba07,0xbf7fb10f,0xbf6ed89e,0xbf61c598,0xbf7cbfc9,0xbf7c3b28,0xbf604621
.long 0xbf6c835e,0xbf7fb10f,0xbf74fa0b,0xbf4d9f02,0xbf74fa0b,0xbf7f84ab,0xbf6a09a7,0xbf373a23
.long 0xbf7b14be,0xbf7c3b28,0xbf5b941a,0xbf1d7fd1,0xbf7ec46d,0xbf75dec6,0xbf49d112,0xbf00e7e4
.long 0xbf3504f3,0xbf54db31,0xbf6c835e,0xbf7b14be,0xbf4d9f02,0xbf68bf3c,0xbf79c79d,0xbf7ffb11
.long 0xbf61c598,0xbf76ba07,0xbf7fb10f,0xbf7c3b28,0xbf710908,0xbf7e70b0,0xbf7e1324,0xbf6ff573
.long 0xbf7b14be,0xbf7fb10f,0xbf74fa0b,0xbf5b941a,0xbf7fb10f,0xbf7a7302,0xbf64aa59,0xbf3fc767
.long 0xbf7ec46d,0xbf6ed89e,0xbf4d9f02,0xbf1d7fd1,0xbf7853f8,0xbf5d2d53,0xbf3085bb,0xbeebcbbb
.long 0xbf6c835e,0xbf45e403,0xbf0e39da,0xbe94a031,0xbf5b941a,0xbf299415,0xbecf7bca,0xbde1bc2e
.long 0xbf45e403,0xbf08f59b,0xbe78cfcc,0x3d96a905,0xbf2beb4a,0xbec9b953,0xbd96a905,0x3e827dc0
.long 0xbf0e39da,0xbe78cfcc,0x3dc8bd36,0x3edae880,0xbedae880,0xbdafb680,0x3e888e93,0x3f15f6d9
.long 0xbe94a031,0x3d96a905,0x3edae880,0x3f396842,0xbe164083,0x3e6c9a7f,0x3f13682a,0x3f5695e5
.long 0x3f7fb10f,0x3f7853f8,0x3f676bd8,0x3f4d9f02,0x3f7fa6e3,0x3f77583a,0x3f644fac,0x3f476085
.long 0x3f7f9c18,0x3f764d97,0x3f6106f2,0x3f40d0da,0x3f7f90b1,0x3f75341d,0x3f5d924d,0x3f39f2ac
.long 0x3f7f84ab,0x3f740bdd,0x3f59f26a,0x3f32c8c9,0x3f7f7808,0x3f72d4eb,0x3f5627fe,0x3f2b561b
.long 0x3f7f6ac7,0x3f718f57,0x3f5233c6,0x3f239da9,0x3f7f5ce9,0x3f703b37,0x3f4e1689,0x3f1ba299
.long 0x3f7f4e6d,0x3f6ed89e,0x3f49d112,0x3f13682a,0x3f7f3f54,0x3f6d67a1,0x3f456439,0x3f0af1b7
.long 0x3f7f2f9d,0x3f6be858,0x3f40d0da,0x3f0242b1,0x3f7f1f49,0x3f6a5ad9,0x3f3c17d9,0x3ef2bd43
.long 0x3f7f0e58,0x3f68bf3c,0x3f373a23,0x3ee0924f,0x3f7efcc9,0x3f671599,0x3f3238aa,0x3ece0bea
.long 0x3f7eea9d,0x3f655e0b,0x3f2d1469,0x3ebb31a0,0x3f7ed7d4,0x3f6398ac,0x3f27ce61,0x3ea80b1f
.long 0x3f2beb4a,0x3f039c3d,0x3eac7cd4,0x3e164083,0x3f21cbfb,0x3eea6681,0x3e870ada,0x3d6ea038
.long 0x3f173c07,0x3ecc9b8b,0x3e419b37,0xbcfb49ba,0x3f0c42c9,0x3eadf73c,0x3de7fa9a,0xbdf475c0
.long 0x3f00e7e4,0x3e8e9a22,0x3d16c32c,0xbe541501,0x3eea6681,0x3e5d4b1a,0xbd2351cb,0xbe9620d2
.long 0x3ed25a09,0x3e1c76de,0xbdee3876,0xbec1071e,0x3eb9bb1e,0x3db5f8da,0xbe44b0b9,0xbeea6681
.long 0x3ea09ae5,0x3cc90ab0,0xbe888e93,0xbf08f59b,0x3e870ada,0xbd2351cb,0xbeadf73c,0xbf1ba299
.long 0x3e5a3997,0xbdd53db9,0xbed25a09,0xbf2d1469,0x3e25c58c,0xbe2bf804,0xbef58035,0xbf3d27b8
.long 0x3de1bc2e,0xbe6c9a7f,0xbf0b9a6b,0xbf4bbbf8,0x3d6ea038,0xbe9620d2,0xbf1ba299,0xbf58b3a1
.long 0x3bc90f88,0xbeb554ec,0xbf2ac082,0xbf63f473,0xbd3c6dd5,0xbed3c867,0xbf38dd65,0xbf6d67a1
.long 0xbd48fb30,0xbe78cfcc,0xbedae880,0xbf187fc0,0xbe195be0,0xbeb3dca5,0xbf099f4e,0xbf33587a
.long 0xbe7ee6e1,0xbee900b7,0xbf239da9,0xbf4ac77f,0xbeb0eacb,0xbf0d9281,0xbf3b0629,0xbf5e5aa6
.long 0xbee0924f,0xbf24d225,0xbf4f7a1f,0xbf6db293,0xbf06f686,0xbf39f2ac,0xbf60a6cf,0xbf788486
.long 0xbf1c420c,0xbf4cae79,0xbf6e46be,0xbf7e9bc9,0xbf2ff3e6,0xbf5cc7d1,0xbf7822d1,0xbf7fdaaf
.long 0xbf41d870,0xbf6a09a7,0xbf7e1324,0xbf7c3b28,0xbf51c0c2,0xbf74484b,0xbf7fffb1,0xbf73ced9
.long 0xbf5f8327,0xbf7b61fc,0xbf7de0b1,0xbf66becc,0xbf6afb8c,0xbf7f3f54,0xbf77beb7,0xbf554aa4
.long 0xbf740bdd,0xbf7fd397,0xbf6db293,0xbf3fc767,0xbf7a9c59,0xbf7d1cdd,0xbf5fe4e9,0xbf269de3
.long 0xbf7e9bc9,0xbf772417,0xbf4e8d90,0xbf0a48ad,0xbf7fffb1,0xbf6dfcf2,0xbf39f2ac,0xbed6a399
.long 0xbf3daef9,0xbf5b941a,0xbf710908,0xbf7d3aac,0xbf554aa4,0xbf6dfcf2,0xbf7c5d3a,0xbf7fcbe2
.long 0xbf6816a8,0xbf7a1e84,0xbf7ffec4,0xbf796e4e,0xbf75a67b,0xbf7fa6e3,0xbf7bd14d,0xbf6a5ad9
.long 0xbf7dabcc,0xbf7e70b0,0xbf6ff573,0xbf531849,0xbf7ff84a,0xbf76841b,0xbf5cc7d1,0xbf34768f
.long 0xbf7c7eb0,0xbf6816a8,0xbf42de29,0xbf0f8784,0xbf73530e,0xbf5389c7,0xbf2302d3,0xbecb2aae
.long 0xbf64aa59,0xbf396842,0xbefc5d27,0xbe605c13,0xbf50d937,0xbf1a6293,0xbeab0201,0xbd0a342f
.long 0xbf385216,0xbeee9479,0xbe28defc,0x3e1c76de,0xbf1ba299,0xbea21887,0x3c16cb58,0x3eab0201
.long 0xbef6e0cb,0xbe22abb6,0x3e3b6ecf,0x3f00e7e4,0xbeb0eacb,0x3b490fc6,0x3eb3dca5,0x3f27ce61
.long 0xbe4dee60,0x3e28defc,0x3f0242b1,0x3f48d8b3,0xbd55880e,0x3ea5129f,0x3f269de3,0x3f62df7b
.long 0x3f7ec46d,0x3f74fa0b,0x3f61c598,0x3f45e403,0x3f7e9bc9,0x3f73913f,0x3f5df6be,0x3f3ebc1b
.long 0x3f7e70b0,0x3f721352,0x3f59f26a,0x3f373a23,0x3f7e4323,0x3f708066,0x3f55b993,0x3f2f61a5
.long 0x3f7e1324,0x3f6ed89e,0x3f514d3d,0x3f273656,0x3f7de0b1,0x3f6d1c1d,0x3f4cae79,0x3f1ebc12
.long 0x3f7dabcc,0x3f6b4b0c,0x3f47de65,0x3f15f6d9,0x3f7d7474,0x3f696591,0x3f42de29,0x3f0cead0
.long 0x3f7d3aac,0x3f676bd8,0x3f3daef9,0x3f039c3d,0x3f7cfe73,0x3f655e0b,0x3f385216,0x3ef41f07
.long 0x3f7cbfc9,0x3f633c5a,0x3f32c8c9,0x3ee0924f,0x3f7c7eb0,0x3f6106f2,0x3f2d1469,0x3ecc9b8b
.long 0x3f7c3b28,0x3f5ebe05,0x3f273656,0x3eb8442a,0x3f7bf531,0x3f5c61c7,0x3f212ff9,0x3ea395c5
.long 0x3f7baccd,0x3f59f26a,0x3f1b02c6,0x3e8e9a22,0x3f7b61fc,0x3f577026,0x3f14b039,0x3e72b651
.long 0x3f226799,0x3ef15aea,0x3e94a031,0x3dc8bd36,0x3f173c07,0x3ed25a09,0x3e5a3997,0x3bc90f88
.long 0x3f0b9a6b,0x3eb263ef,0x3e09cf86,0xbdafb680,0x3eff17b2,0x3e919ddd,0x3d621469,0xbe354098
.long 0x3ee63375,0x3e605c13,0xbcc90ab0,0xbe888e93,0x3ecc9b8b,0x3e1c76de,0xbdd53db9,0xbeb554ec
.long 0x3eb263ef,0x3dafb680,0xbe3b6ecf,0xbee0924f,0x3e97a117,0x3c96c9b6,0xbe8586ce,0xbf04f484
.long 0x3e78cfcc,0xbd48fb30,0xbeac7cd4,0xbf187fc0,0x3e419b37,0xbdee3876,0xbed25a09,0xbf2ac082
.long 0x3e09cf86,0xbe3b6ecf,0xbef6e0cb,0xbf3b8f3b,0x3da3308c,0xbe7ee6e1,0xbf0cead0,0xbf4ac77f
.long 0x3cc90ab0,0xbea09ae5,0xbf1d7fd1,0xbf584853,0xbcfb49ba,0xbec1071e,0xbf2d1469,0xbf63f473
.long 0xbdafb680,0xbee0924f,0xbf3b8f3b,0xbf6db293,0xbe1008b7,0xbeff17b2,0xbf48d8b3,0xbf756d97
.long 0xbdc8bd36,0xbe94a031,0xbef15aea,0xbf226799,0xbe4dee60,0xbecc9b8b,0xbf14b039,0xbf3ca003
.long 0xbe9aa086,0xbf00e7e4,0xbf2e3bde,0xbf531849,0xbecc9b8b,0xbf19c200,0xbf44e3f5,0xbf655e0b
.long 0xbefc5d27,0xbf3085bb,0xbf584853,0xbf731447,0xbf14b039,0xbf44e3f5,0xbf6816a8,0xbf7bf531
.long 0xbf299415,0xbf5695e5,0xbf740bdd,0xbf7fd397,0xbf3ca003,0xbf655e0b,0xbf7bf531,0xbf7e9bc9
.long 0xbf4d9f02,0xbf710908,0xbf7fb10f,0xbf7853f8,0xbf5c61c7,0xbf796e4e,0xbf7f2f9d,0xbf6d1c1d
.long 0xbf68bf3c,0xbf7e70b0,0xbf7a7302,0xbf5d2d53,0xbf7294f8,0xbf7ffec4,0xbf718f57,0xbf48d8b3
.long 0xbf79c79d,0xbf7e1324,0xbf64aa59,0xbf3085bb,0xbf7e4323,0xbf78b47b,0xbf53fac3,0xbf14b039
.long 0xbf7ffb11,0xbf6ff573,0xbf3fc767,0xbeebcbbb,0xbf7eea9d,0xbf63f473,0xbf286605,0xbea986c4
.long 0xbf45e403,0xbf61c598,0xbf74fa0b,0xbf7ec46d,0xbf5c61c7,0xbf7294f8,0xbf7e4323,0xbf7eea9d
.long 0xbf6db293,0xbf7cbfc9,0xbf7f84ab,0xbf75dec6,0xbf796e4e,0xbf7ffec4,0xbf78b47b,0xbf63f473
.long 0xbf7f4e6d,0xbf7c3b28,0xbf6a09a7,0xbf49d112,0xbf7f2f9d,0xbf718f57,0xbf53fac3,0xbf286605
.long 0xbf791298,0xbf604621,0xbf373a23,0xbf00e7e4,0xbf6d1c1d,0xbf48d8b3,0xbf14b039,0xbea986c4
.long 0xbf5b941a,0xbf2beb4a,0xbedae880,0xbe164083,0xbf44e3f5,0xbf0a48ad,0xbe8586ce,0x3d2fe007
.long 0xbf299415,0xbec9b953,0xbdafb680,0x3e6c9a7f,0xbf0a48ad,0xbe72b651,0x3dbc3ac3,0x3ed25a09
.long 0xbecf7bca,0xbd96a905,0x3e888e93,0x3f13682a,0xbe8586ce,0x3dbc3ac3,0x3eddbe79,0x3f385216
.long 0xbde1bc2e,0x3e827dc0,0x3f15f6d9,0x3f5695e5,0x3d2fe007,0x3ed25a09,0x3f385216,0x3f6d1c1d
.long 0x3f7d3aac,0x3f710908,0x3f5b941a,0x3f3daef9,0x3f7cdf6c,0x3f6f20b0,0x3f570348,0x3f3592e7
.long 0x3f7c7eb0,0x3f6d1c1d,0x3f5233c6,0x3f2d1469,0x3f7c187a,0x3f6afb8c,0x3f4d26fd,0x3f24381a
.long 0x3f7baccd,0x3f68bf3c,0x3f47de65,0x3f1b02c6,0x3f7b3bab,0x3f666771,0x3f425b89,0x3f11796b
.long 0x3f7ac516,0x3f63f473,0x3f3ca003,0x3f07a136,0x3f7a4910,0x3f61668a,0x3f36ad7f,0x3efafef7
.long 0x3f79c79d,0x3f5ebe05,0x3f3085bb,0x3ee63375,0x3f7940c0,0x3f5bfb34,0x3f2a2a80,0x3ed0eb2a
.long 0x3f78b47b,0x3f591e6a,0x3f239da9,0x3ebb31a0,0x3f7822d1,0x3f5627fe,0x3f1ce11f,0x3ea5129f
.long 0x3f778bc5,0x3f531849,0x3f15f6d9,0x3e8e9a22,0x3f76ef5b,0x3f4fefa8,0x3f0ee0db,0x3e6fa8b2
.long 0x3f764d97,0x3f4cae79,0x3f07a136,0x3e419b37,0x3f75a67b,0x3f495521,0x3f003a06,0x3e1324ca
.long 0x3f187fc0,0x3edae880,0x3e78cfcc,0x3d48fb30,0x3f0c42c9,0x3eb9bb1e,0x3e25c58c,0xbd3c6dd5
.long 0x3eff17b2,0x3e97a117,0x3da3308c,0xbe1008b7,0x3ee4cbfe,0x3e698bba,0xbb490fc6,0xbe6fa8b2
.long 0x3ec9b953,0x3e22abb6,0xbdafb680,0xbea68f12,0x3eadf73c,0x3db5f8da,0xbe2bf804,0xbed3c867
.long 0x3e919ddd,0x3c96c9b6,0xbe7ee6e1,0xbeff17b2,0x3e698bba,0xbd55880e,0xbea80b1f,0xbf140c5f
.long 0x3e2f10a2,0xbdfab273,0xbecf7bca,0xbf273656,0x3de7fa9a,0xbe44b0b9,0xbef58035,0xbf38dd65
.long 0x3d621469,0xbe8586ce,0xbf0cead0,0xbf48d8b3,0xbb490fc6,0xbea80b1f,0xbf1e1e22,0xbf570348
.long 0xbd7b2b74,0xbec9b953,0xbf2e3bde,0xbf633c5a,0xbdf475c0,0xbeea6681,0xbf3d27b8,0xbf6d67a1
.long 0xbe354098,0xbf04f484,0xbf4ac77f,0xbf756d97,0xbe6fa8b2,0xbf140c5f,0xbf570348,0xbf7b3bab
.long 0xbe164083,0xbeac7cd4,0xbf039c3d,0xbf2beb4a,0xbe80f8c0,0xbee4cbfe,0xbf1f599f,0xbf456439
.long 0xbeb554ec,0xbf0cead0,0xbf385216,0xbf5ac450,0xbee79a5d,0xbf256bcb,0xbf4e1689,0xbf6b99fb
.long 0xbf0b9a6b,0xbf3b8f3b,0xbf604621,0xbf778bc5,0xbf21cbfb,0xbf4f0417,0xbf6e8ff8,0xbf7e5a38
.long 0xbf36206c,0xbf5f8327,0xbf78b47b,0xbf7fe129,0xbf485bca,0xbf6cd007,0xbf7e868b,0xbf7c187a
.long 0xbf584853,0xbf76ba07,0xbf7fec43,0xbf731447,0xbf65b710,0xbf7d1cdd,0xbf7cdf6c,0xbf650479
.long 0xbf708066,0xbf7fe129,0xbf756d97,0xbf5233c6,0xbf788486,0xbf7efcc9,0xbf69b7e4,0xbf3b0629
.long 0xbf7dabcc,0xbf7a7302,0xbf59f26a,0xbf1ff6cb,0xbf7fe705,0xbf725470,0xbf466354,0xbf019573
.long 0xbf7f2f9d,0xbf66becc,0xbf2f61a5,0xbec1071e,0xbf7b87b2,0xbf57dc7f,0xbf1553b7,0xbe75c35a
.long 0xbf4d9f02,0xbf676bd8,0xbf7853f8,0xbf7fb10f,0xbf62df7b,0xbf76841b,0xbf7f7808,0xbf7d57de
.long 0xbf7294f8,0xbf7e9bc9,0xbf7e4323,0xbf718f57,0xbf7c5d3a,0xbf7f7808,0xbf74bf62,0xbf5cc7d1
.long 0xbf7ffb11,0xbf791298,0xbf633c5a,0xbf3fc767,0xbf7d57de,0xbf6b99fb,0xbf4a4c87,0xbf1ba299
.long 0xbf748422,0xbf577026,0xbf2ac082,0xbee363fa,0xbf65b710,0xbf3d27b8,0xbf05a02c,0xbe870ada
.long 0xbf514d3d,0xbf1d7fd1,0xbeb8442a,0xbd96a905,0xbf37c655,0xbef2bd43,0xbe3e853e,0x3df475c0
.long 0xbf19c200,0xbea395c5,0xbbc90f88,0x3e9d9e78,0xbeeff7fb,0xbe1f917b,0x3e3228d4,0x3ef840c8
.long 0xbea68f12,0x3c490e90,0x3eb263ef,0x3f24d225,0xbe3228d4,0x3e3857ec,0x3f02ef9f,0x3f476085
.long 0xbc96c9b6,0x3eaf713a,0x3f286605,0x3f628210,0x3e0cec4a,0x3efdbabb,0x3f485bca,0x3f75341d
.long 0x80000000,0xbe47c5c2,0xbec3ef15,0xbf0e39da,0x80000000,0xbe541501,0xbecf7bca,0xbf15f6d9
.long 0x80000000,0xbe605c13,0xbedae880,0xbf1d7fd1,0x80000000,0xbe6c9a7f,0xbee63375,0xbf24d225
.long 0x80000000,0xbe78cfcc,0xbef15aea,0xbf2beb4a,0x80000000,0xbe827dc0,0xbefc5d27,0xbf32c8c9
.long 0x80000000,0xbe888e93,0xbf039c3d,0xbf396842,0x80000000,0xbe8e9a22,0xbf08f59b,0xbf3fc767
.long 0x80000000,0xbe94a031,0xbf0e39da,0xbf45e403,0x80000000,0xbe9aa086,0xbf13682a,0xbf4bbbf8
.long 0x80000000,0xbea09ae5,0xbf187fc0,0xbf514d3d,0x80000000,0xbea68f12,0xbf1d7fd1,0xbf5695e5
.long 0x80000000,0xbeac7cd4,0xbf226799,0xbf5b941a,0x80000000,0xbeb263ef,0xbf273656,0xbf604621
.long 0x80000000,0xbeb8442a,0xbf2beb4a,0xbf64aa59,0x80000000,0xbebe1d4a,0xbf3085bb,0xbf68bf3c
.long 0xbf3504f3,0xbf54db31,0xbf6c835e,0xbf7b14be,0xbf3daef9,0xbf5d2d53,0xbf731447,0xbf7e70b0
.long 0xbf45e403,0xbf64aa59,0xbf7853f8,0xbf7fec43,0xbf4d9f02,0xbf6b4b0c,0xbf7c3b28,0xbf7f84ab
.long 0xbf54db31,0xbf710908,0xbf7ec46d,0xbf7d3aac,0xbf5b941a,0xbf75dec6,0xbf7fec43,0xbf791298
.long 0xbf61c598,0xbf79c79d,0xbf7fb10f,0xbf731447,0xbf676bd8,0xbf7cbfc9,0xbf7e1324,0xbf6b4b0c
.long 0xbf6c835e,0xbf7ec46d,0xbf7b14be,0xbf61c598,0xbf710908,0xbf7fd397,0xbf76ba07,0xbf5695e5
.long 0xbf74fa0b,0xbf7fec43,0xbf710908,0xbf49d112,0xbf7853f8,0xbf7f0e58,0xbf6a09a7,0xbf3b8f3b
.long 0xbf7b14be,0xbf7d3aac,0xbf61c598,0xbf2beb4a,0xbf7d3aac,0xbf7a7302,0xbf584853,0xbf1b02c6
.long 0xbf7ec46d,0xbf76ba07,0xbf4d9f02,0xbf08f59b,0xbf7fb10f,0xbf721352,0xbf41d870,0xbeebcbbb
.long 0xbf800000,0xbf7b14be,0xbf6c835e,0xbf54db31,0xbf7ec46d,0xbf740bdd,0xbf5ebe05,0xbf3fc767
.long 0xbf7b14be,0xbf6a09a7,0xbf4d9f02,0xbf273656,0xbf74fa0b,0xbf5d2d53,0xbf396842,0xbf0b9a6b
.long 0xbf6c835e,0xbf4d9f02,0xbf226799,0xbedae880,0xbf61c598,0xbf3b8f3b,0xbf08f59b,0xbe9aa086
.long 0xbf54db31,0xbf273656,0xbedae880,0xbe2f10a2,0xbf45e403,0xbf10d3cd,0xbea09ae5,0xbd16c32c
.long 0xbf3504f3,0xbef15aea,0xbe47c5c2,0x3dc8bd36,0xbf226799,0xbebe1d4a,0xbd96a905,0x3e6c9a7f
.long 0xbf0e39da,0xbe888e93,0x3d48fb30,0x3eb8442a,0xbef15aea,0xbe22abb6,0x3e2f10a2,0x3ef6e0cb
.long 0xbec3ef15,0xbd48fb30,0x3e94a031,0x3f187fc0,0xbe94a031,0x3d7b2b74,0x3ecf7bca,0x3f32c8c9
.long 0xbe47c5c2,0x3e2f10a2,0x3f039c3d,0x3f49d112,0xbdc8bd36,0x3e8e9a22,0x3f1d7fd1,0x3f5d2d53
.long 0xbf3504f3,0xbf0e39da,0xbec3ef15,0xbe47c5c2,0xbf187fc0,0xbed53641,0xbe605c13,0xbc490e90
.long 0xbef15aea,0xbe888e93,0xbd48fb30,0x3e2f10a2,0xbeac7cd4,0xbde1bc2e,0x3dfab273,0x3eb263ef
.long 0xbe47c5c2,0x3d48fb30,0x3e94a031,0x3f039c3d,0xbd48fb30,0x3e541501,0x3ee63375,0x3f299415
.long 0x3dc8bd36,0x3eb8442a,0x3f187fc0,0x3f49d112,0x3e78cfcc,0x3f00e7e4,0x3f396842,0x3f633c5a
.long 0x3ec3ef15,0x3f226799,0x3f54db31,0x3f74fa0b,0x3f039c3d,0x3f3fc767,0x3f6a09a7,0x3f7e70b0
.long 0x3f226799,0x3f584853,0x3f7853f8,0x3f7f4e6d,0x3f3daef9,0x3f6b4b0c,0x3f7f4e6d,0x3f778bc5
.long 0x3f54db31,0x3f7853f8,0x3f7ec46d,0x3f676bd8,0x3f676bd8,0x3f7f0e58,0x3f76ba07,0x3f4f7a1f
.long 0x3f74fa0b,0x3f7f4e6d,0x3f676bd8,0x3f3085bb,0x3f7d3aac,0x3f791298,0x3f514d3d,0x3f0b9a6b
.long 0xbd48fb30,0xbe78cfcc,0xbedae880,0xbf187fc0,0xbd55880e,0xbe840270,0xbee79a5d,0xbf209393
.long 0xbd621469,0xbe8b9507,0xbef41f07,0xbf286605,0xbd6ea038,0xbe931f35,0xbf003a06,0xbf2ff3e6
.long 0xbd7b2b74,0xbe9aa086,0xbf064b82,0xbf373a23,0xbd83db0a,0xbea21887,0xbf0c42c9,0xbf3e35c5
.long 0xbd8a200a,0xbea986c4,0xbf121eb0,0xbf44e3f5,0xbd9064b4,0xbeb0eacb,0xbf17de12,0xbf4b41fa
.long 0xbd96a905,0xbeb8442a,0xbf1d7fd1,0xbf514d3d,0xbd9cecf9,0xbebf926f,0xbf2302d3,0xbf570348
.long 0xbda3308c,0xbec6d529,0xbf286605,0xbf5c61c7,0xbda973ba,0xbece0bea,0xbf2da859,0xbf61668a
.long 0xbdafb680,0xbed53641,0xbf32c8c9,0xbf660f88,0xbdb5f8da,0xbedc53c1,0xbf37c655,0xbf6a5ad9
.long 0xbdbc3ac3,0xbee363fa,0xbf3ca003,0xbf6e46be,0xbdc27c39,0xbeea6681,0xbf4154e1,0xbf71d19f
.long 0xbf3daef9,0xbf5b941a,0xbf710908,0xbf7d3aac,0xbf466354,0xbf6398ac,0xbf76ef5b,0xbf7f90b1
.long 0xbf4e8d90,0xbf6aab7b,0xbf7b61fc,0xbf7fe129,0xbf5627fe,0xbf70c501,0xbf7e5a38,0xbf7e2b72
.long 0xbf5d2d53,0xbf75dec6,0xbf7fd397,0xbf7a7302,0xbf6398ac,0xbf79f35e,0xbf7fcbe2,0xbf74bf62
.long 0xbf696591,0xbf7cfe73,0xbf7e4323,0xbf6d1c1d,0xbf6e8ff8,0xbf7efcc9,0xbf7b3bab,0xbf6398ac
.long 0xbf731447,0xbf7fec43,0xbf76ba07,0xbf584853,0xbf76ef5b,0xbf7fcbe2,0xbf70c501,0xbf4b41fa
.long 0xbf7a1e84,0xbf7e9bc9,0xbf696591,0xbf3ca003,0xbf7c9f8a,0xbf7c5d3a,0xbf60a6cf,0xbf2c800f
.long 0xbf7e70b0,0xbf791298,0xbf5695e5,0xbf1b02c6,0xbf7f90b1,0xbf74bf62,0xbf4b41fa,0xbf084b92
.long 0xbf7ffec4,0xbf6f6830,0xbf3ebc1b,0xbee900b7,0xbf7fba9e,0xbf6912ae,0xbf311722,0xbebf926f
.long 0xbf7fb10f,0xbf7853f8,0xbf676bd8,0xbf4d9f02,0xbf7d1cdd,0xbf6faf1b,0xbf57dc7f,0xbf36ad7f
.long 0xbf77f110,0xbf63f473,0xbf44e3f5,0xbf1c420c,0xbf703b37,0xbf554aa4,0xbf2ecef7,0xbefdbabb
.long 0xbf660f88,0xbf43e200,0xbf15f6d9,0xbebe1d4a,0xbf5988ad,0xbf2ff3e6,0xbef58035,0xbe75c35a
.long 0xbf4ac77f,0xbf19c200,0xbebb31a0,0xbdd53db9,0xbf39f2ac,0xbf019573,0xbe7bdba4,0x3d0a342f
.long 0xbf273656,0xbecf7bca,0xbdfab273,0x3e2f10a2,0xbf12c39a,0xbe9920fe,0x3b490fc6,0x3e9c1faf
.long 0xbef9a02d,0xbe419b37,0x3e039502,0x3eddbe79,0xbecb2aae,0xbd9cecf9,0x3e80f8c0,0x3f0d9281
.long 0xbe9aa086,0x3d16c32c,0x3ebe1d4a,0x3f299415,0xbe5101f1,0x3e195be0,0x3ef840c8,0x3f425b89
.long 0xbdd53db9,0x3e8586ce,0x3f173c07,0x3f577026,0xbb490fc6,0x3ebca7af,0x3f2ff3e6,0x3f686b39
.long 0xbf2beb4a,0xbf039c3d,0xbeac7cd4,0xbe164083,0xbf0d9281,0xbebca7af,0xbe2bf804,0x3d2351cb
.long 0xbed8106b,0xbe5a3997,0x3bc90f88,0x3e667c66,0xbe901c2c,0xbd55880e,0x3e3857ec,0x3ece0bea
.long 0xbe09cf86,0x3de1bc2e,0x3eb263ef,0x3f10d3cd,0x3c7b514b,0x3e8a11f7,0x3f019573,0x3f3592e7
.long 0x3e28defc,0x3ed8106b,0x3f26050a,0x3f53fac3,0x3e9f1cdf,0x3f102dd5,0x3f456439,0x3f6afb8c
.long 0x3ee63375,0x3f3085bb,0x3f5ebe05,0x3f79c79d,0x3f140c5f,0x3f4c3578,0x3f714c7a,0x3f7fdaaf
.long 0x3f31a81d,0x3f628210,0x3f7c7eb0,0x3f7cfe73,0x3f4b41fa,0x3f72d4eb,0x3f7ffd39,0x3f714c7a
.long 0x3f604621,0x3f7cbfc9,0x3f7baccd,0x3f5d2d53,0x3f703b37,0x3f7fffb1,0x3f6faf1b,0x3f4154e1
.long 0x3f7ac516,0x3f7c7eb0,0x3f5c61c7,0x3f1ebc12,0x3f7fa6e3,0x3f725470,0x3f425b89,0x3eed3063
.long 0xbdc8bd36,0xbe94a031,0xbef15aea,0xbf226799,0xbdd53db9,0xbe9d9e78,0xbeff17b2,0xbf2ac082
.long 0xbde1bc2e,0xbea68f12,0xbf064b82,0xbf32c8c9,0xbdee3876,0xbeaf713a,0xbf0cead0,0xbf3a7ca4
.long 0xbdfab273,0xbeb8442a,0xbf13682a,0xbf41d870,0xbe039502,0xbec1071e,0xbf19c200,0xbf48d8b3
.long 0xbe09cf86,0xbec9b953,0xbf1ff6cb,0xbf4f7a1f,0xbe1008b7,0xbed25a09,0xbf26050a,0xbf55b993
.long 0xbe164083,0xbedae880,0xbf2beb4a,0xbf5b941a,0xbe1c76de,0xbee363fa,0xbf31a81d,0xbf6106f2
.long 0xbe22abb6,0xbeebcbbb,0xbf373a23,0xbf660f88,0xbe28defc,0xbef41f07,0xbf3ca003,0xbf6aab7b
.long 0xbe2f10a2,0xbefc5d27,0xbf41d870,0xbf6ed89e,0xbe354098,0xbf0242b1,0xbf46e22a,0xbf7294f8
.long 0xbe3b6ecf,0xbf064b82,0xbf4bbbf8,0xbf75dec6,0xbe419b37,0xbf0a48ad,0xbf5064af,0xbf78b47b
.long 0xbf45e403,0xbf61c598,0xbf74fa0b,0xbf7ec46d,0xbf4e8d90,0xbf696591,0xbf7a1e84,0xbf7ffec4
.long 0xbf5695e5,0xbf6ff573,0xbf7dabcc,0xbf7f0e58,0xbf5df6be,0xbf756d97,0xbf7f9c18,0xbf7bf531
.long 0xbf64aa59,0xbf79c79d,0xbf7fec43,0xbf76ba07,0xbf6aab7b,0xbf7cfe73,0xbf7e9bc9,0xbf6f6830
.long 0xbf6ff573,0xbf7f0e58,0xbf7baccd,0xbf660f88,0xbf748422,0xbf7ff4e6,0xbf772417,0xbf5ac450
.long 0xbf7853f8,0xbf7fb10f,0xbf710908,0xbf4d9f02,0xbf7b61fc,0xbf7e4323,0xbf696591,0xbf3ebc1b
.long 0xbf7dabcc,0xbf7baccd,0xbf604621,0xbf2e3bde,0xbf7f2f9d,0xbf77f110,0xbf55b993,0xbf1c420c
.long 0xbf7fec43,0xbf731447,0xbf49d112,0xbf08f59b,0xbf7fe129,0xbf6d1c1d,0xbf3ca003,0xbee900b7
.long 0xbf7f0e58,0xbf660f88,0xbf2e3bde,0xbebe1d4a,0xbf7d7474,0xbf5df6be,0xbf1ebc12,0xbe919ddd
.long 0xbf7ec46d,0xbf74fa0b,0xbf61c598,0xbf45e403,0xbf7ac516,0xbf6aab7b,0xbf5064af,0xbf2d1469
.long 0xbf740bdd,0xbf5d2d53,0xbf3b8f3b,0xbf10d3cd,0xbf6aab7b,0xbf4cae79,0xbf239da9,0xbee363fa
.long 0xbf5ebe05,0xbf396842,0xbf08f59b,0xbea09ae5,0xbf5064af,0xbf239da9,0xbed8106b,0xbe354098
.long 0xbf3fc767,0xbf0b9a6b,0xbe9aa086,0xbd16c32c,0xbf2d1469,0xbee363fa,0xbe354098,0x3dd53db9
.long 0xbf187fc0,0xbeac7cd4,0xbd48fb30,0x3e78cfcc,0xbf0242b1,0xbe667c66,0x3da3308c,0x3ec1071e
.long 0xbed53641,0xbde1bc2e,0x3e541501,0x3f00e7e4,0xbea395c5,0x3bc90f88,0x3ea986c4,0x3f1ebc12
.long 0xbe605c13,0x3dfab273,0x3ee63375,0x3f396842,0xbdee3876,0x3e72b651,0x3f0f8784,0x3f5064af
.long 0xbc490e90,0x3eb263ef,0x3f299415,0x3f633c5a,0x3dbc3ac3,0x3ee900b7,0x3f40d0da,0x3f718f57
.long 0xbf226799,0xbef15aea,0xbe94a031,0xbdc8bd36,0xbf0242b1,0xbea395c5,0xbdee3876,0x3dbc3ac3
.long 0xbebe1d4a,0xbe22abb6,0x3d7b2b74,0x3e8e9a22,0xbe667c66,0x3bc90f88,0x3e72b651,0x3ee900b7
.long 0xbd96a905,0x3e2f10a2,0x3ecf7bca,0x3f1d7fd1,0x3da3308c,0x3ea986c4,0x3f0f8784,0x3f40d0da
.long 0x3e6c9a7f,0x3ef6e0cb,0x3f32c8c9,0x3f5d2d53,0x3ec1071e,0x3f1ebc12,0x3f5064af,0x3f718f57
.long 0x3f039c3d,0x3f3daef9,0x3f676bd8,0x3f7d3aac,0x3f239da9,0x3f577026,0x3f772417,0x3f7fc38f
.long 0x3f3fc767,0x3f6b4b0c,0x3f7f0e58,0x3f791298,0x3f577026,0x3f78b47b,0x3f7eea9d,0x3f696591
.long 0x3f6a09a7,0x3f7f4e6d,0x3f76ba07,0x3f514d3d,0x3f772417,0x3f7eea9d,0x3f66becc,0x3f31a81d
.long 0x3f7e70b0,0x3f778bc5,0x3f4f7a1f,0x3f0b9a6b,0x3f7fc38f,0x3f696591,0x3f31a81d,0x3ec1071e
.long 0xbe164083,0xbeac7cd4,0xbf039c3d,0xbf2beb4a,0xbe1f917b,0xbeb6ccc3,0xbf0af1b7,0xbf34768f
.long 0xbe28defc,0xbec1071e,0xbf121eb0,0xbf3ca003,0xbe3228d4,0xbecb2aae,0xbf19210f,0xbf446337
.long 0xbe3b6ecf,0xbed53641,0xbf1ff6cb,0xbf4bbbf8,0xbe44b0b9,0xbedf28a9,0xbf269de3,0xbf52a649
.long 0xbe4dee60,0xbee900b7,0xbf2d1469,0xbf591e6a,0xbe57278f,0xbef2bd43,0xbf33587a,0xbf5f20db
.long 0xbe605c13,0xbefc5d27,0xbf396842,0xbf64aa59,0xbe698bba,0xbf02ef9f,0xbf3f41fc,0xbf69b7e4
.long 0xbe72b651,0xbf07a136,0xbf44e3f5,0xbf6e46be,0xbe7bdba4,0xbf0c42c9,0xbf4a4c87,0xbf725470
.long 0xbe827dc0,0xbf10d3cd,0xbf4f7a1f,0xbf75dec6,0xbe870ada,0xbf1553b7,0xbf546b3b,0xbf78e3d6
.long 0xbe8b9507,0xbf19c200,0xbf591e6a,0xbf7b61fc,0xbe901c2c,0xbf1e1e22,0xbf5d924d,0xbf7d57de
.long 0xbf4d9f02,0xbf676bd8,0xbf7853f8,0xbf7fb10f,0xbf5627fe,0xbf6e8ff8,0xbf7c9f8a,0xbf7fba9e
.long 0xbf5df6be,0xbf748422,0xbf7f2f9d,0xbf7d7474,0xbf650479,0xbf7940c0,0xbf7fffb1,0xbf78e3d6
.long 0xbf6b4b0c,0xbf7cbfc9,0xbf7f0e58,0xbf721352,0xbf70c501,0xbf7efcc9,0xbf7c5d3a,0xbf6912ae
.long 0xbf756d97,0xbf7ff4e6,0xbf77f110,0xbf5df6be,0xbf7940c0,0xbf7fa6e3,0xbf71d19f,0xbf50d937
.long 0xbf7c3b28,0xbf7e1324,0xbf6a09a7,0xbf41d870,0xbf7e5a38,0xbf7b3bab,0xbf60a6cf,0xbf311722
.long 0xbf7f9c18,0xbf772417,0xbf55b993,0xbf1ebc12,0xbf7fffb1,0xbf71d19f,0xbf495521,0xbf0af1b7
.long 0xbf7f84ab,0xbf6b4b0c,0xbf3b8f3b,0xbeebcbbb,0xbf7e2b72,0xbf6398ac,0xbf2c800f,0xbebf926f
.long 0xbf7bf531,0xbf5ac450,0xbf1c420c,0xbe919ddd,0xbf78e3d6,0xbf50d937,0xbf0af1b7,0xbe44b0b9
.long 0xbf7d3aac,0xbf710908,0xbf5b941a,0xbf3daef9,0xbf77beb7,0xbf650479,0xbf485bca,0xbf2302d3
.long 0xbf6f6830,0xbf55b993,0xbf31a81d,0xbf04f484,0xbf644fac,0xbf436051,0xbf17de12,0xbec8477c
.long 0xbf5695e5,0xbf2e3bde,0xbef6e0cb,0xbe827dc0,0xbf466354,0xbf16999f,0xbeb9bb1e,0xbde7fa9a
.long 0xbf33e7bc,0xbef9a02d,0xbe72b651,0x3cfb49ba,0xbf1f599f,0xbec27b55,0xbddb7d37,0x3e3228d4
.long 0xbf08f59b,0xbe888e93,0x3cc90ab0,0x3ea09ae5,0xbee1fb6a,0xbe195be0,0x3e1f917b,0x3ee4cbfe
.long 0xbeaf713a,0xbcfb49ba,0x3e919ddd,0x3f121eb0,0xbe75c35a,0x3db5f8da,0x3ed0eb2a,0x3f2ecef7
.long 0xbe09cf86,0x3e541501,0x3f064b82,0x3f47de65,0xbce22a7a,0x3ea5129f,0x3f21cbfb,0x3f5cc7d1
.long 0x3da3308c,0x3eddbe79,0x3f3a7ca4,0x3f6d1c1d,0x3e3e853e,0x3f099f4e,0x3f4fefa8,0x3f788486
.long 0xbf187fc0,0xbedae880,0xbe78cfcc,0xbd48fb30,0xbeed3063,0xbe8a11f7,0xbd83db0a,0x3e1324ca
.long 0xbea395c5,0xbdd53db9,0x3dee3876,0x3ea986c4,0xbe2bf804,0x3d83db0a,0x3e9620d2,0x3f019573
.long 0xbc490e90,0x3e6c9a7f,0x3eebcbbb,0x3f299415,0x3e1324ca,0x3ec8477c,0x3f1ce11f,0x3f4b41fa
.long 0x3e97a117,0x3f0a48ad,0x3f3ebc1b,0x3f655e0b,0x3ee1fb6a,0x3f2c800f,0x3f5a5ba0,0x3f76ef5b
.long 0x3f13682a,0x3f49d112,0x3f6ed89e,0x3f7f4e6d,0x3f3238aa,0x3f61668a,0x3f7b87b2,0x3f7e2b72
.long 0x3f4cae79,0x3f7294f8,0x3f7ffec4,0x3f73913f,0x3f62241a,0x3f7cdf6c,0x3f7c187a,0x3f5fe4e9
.long 0x3f721352,0x3f7ffb11,0x3f6ff573,0x3f43e200,0x3f7c187a,0x3f7bd14d,0x3f5bfb34,0x3f209393
.long 0x3f7ff4e6,0x3f708066,0x3f40d0da,0x3eee9479,0x3f7d906e,0x3f5e5aa6,0x3f1f599f,0x3e931f35
.p2align 8
tab_TA:
.long 0x80003f80,0x80003f80,0x80003f80,0x80003f80,0x3f800000,0x3f800000,0x3f800000,0x3f800000
.long 0x80003f80,0xbf353f35,0xbc213f80,0xbf373f33,0x3f800000,0x3f353f35,0x3f803c21,0x3f333f37
.long 0x80003f80,0xbf80248d,0xbca13f80,0xbf80bca1,0x3f800000,0x248d3f80,0x3f803ca1,0xbca13f80
.long 0x80003f80,0xbf35bf35,0xbcf13f80,0xbf30bf3a,0x3f800000,0xbf353f35,0x3f803cf1,0xbf3a3f30
.long 0x80003f80,0xa50dbf80,0xbd213f80,0x3d21bf80,0x3f800000,0xbf80250d,0x3f803d21,0xbf80bd21
.long 0x80003f80,0x3f35bf35,0xbd493f80,0x3f3ebf2c,0x3f800000,0xbf35bf35,0x3f803d49,0xbf2cbf3e
.long 0x80003f80,0x3f80a554,0xbd713f80,0x3f803d71,0x3f800000,0xa554bf80,0x3f803d71,0x3d71bf80
.long 0x80003f80,0x3f353f35,0xbd8d3f7f,0x3f283f41,0x3f800000,0x3f35bf35,0x3f7f3d8d,0x3f41bf28
.long 0x80003f80,0x80003f80,0x80003f80,0x80003f80,0x3f800000,0x3f800000,0x3f800000,0x3f800000
.long 0xbf80248d,0xbf35bf35,0xbf80bc21,0xbf33bf37,0x248d3f80,0xbf353f35,0xbc213f80,0xbf373f33
.long 0xa50dbf80,0x3f80a554,0x3ca1bf80,0x3f803ca1,0xbf80250d,0xa554bf80,0xbf80bca1,0x3ca1bf80
.long 0x3f80a554,0xbf353f35,0x3f803cf1,0xbf3a3f30,0xa554bf80,0x3f353f35,0x3cf1bf80,0x3f303f3a
.long 0x80003f80,0xa50dbf80,0xbd213f80,0x3d21bf80,0x3f800000,0xbf80250d,0x3f803d21,0xbf80bd21
.long 0xbf80248d,0x3f353f35,0xbf80bd49,0x3f2c3f3e,0x248d3f80,0x3f35bf35,0xbd493f80,0x3f3ebf2c
.long 0xa50dbf80,0xbf80248d,0x3d71bf80,0xbf80bd71,0xbf80250d,0x248d3f80,0xbf80bd71,0xbd713f80
.long 0x3f80a554,0x3f35bf35,0x3f7f3d8d,0x3f41bf28,0xa554bf80,0xbf35bf35,0x3d8dbf7f,0xbf28bf41
.long 0x80003f80,0x80003f80,0x80003f80,0x80003f80,0x3f800000,0x3f800000,0x3f800000,0x3f800000
.long 0xa50dbf80,0x3f35bf35,0x3c21bf80,0x3f37bf33,0xbf80250d,0xbf35bf35,0xbf80bc21,0xbf33bf37
.long 0x80003f80,0xbf80248d,0xbca13f80,0xbf80bca1,0x3f800000,0x248d3f80,0x3f803ca1,0xbca13f80
.long 0xa50dbf80,0x3f353f35,0x3cf1bf80,0x3f303f3a,0xbf80250d,0x3f35bf35,0xbf80bcf1,0x3f3abf30
.long 0x80003f80,0xa50dbf80,0xbd213f80,0x3d21bf80,0x3f800000,0xbf80250d,0x3f803d21,0xbf80bd21
.long 0xa50dbf80,0xbf353f35,0x3d49bf80,0xbf3e3f2c,0xbf80250d,0x3f353f35,0xbf80bd49,0x3f2c3f3e
.long 0x80003f80,0x3f80a554,0xbd713f80,0x3f803d71,0x3f800000,0xa554bf80,0x3f803d71,0x3d71bf80
.long 0xa50dbf80,0xbf35bf35,0x3d8dbf7f,0xbf28bf41,0xbf80250d,0xbf353f35,0xbf7fbd8d,0xbf413f28
.long 0x80003f80,0x80003f80,0x80003f80,0x80003f80,0x3f800000,0x3f800000,0x3f800000,0x3f800000
.long 0x3f80a554,0x3f353f35,0x3f803c21,0x3f333f37,0xa554bf80,0x3f35bf35,0x3c21bf80,0x3f37bf33
.long 0xa50dbf80,0x3f80a554,0x3ca1bf80,0x3f803ca1,0xbf80250d,0xa554bf80,0xbf80bca1,0x3ca1bf80
.long 0xbf80248d,0x3f35bf35,0xbf80bcf1,0x3f3abf30,0x248d3f80,0xbf35bf35,0xbcf13f80,0xbf30bf3a
.long 0x80003f80,0xa50dbf80,0xbd213f80,0x3d21bf80,0x3f800000,0xbf80250d,0x3f803d21,0xbf80bd21
.long 0x3f80a554,0xbf35bf35,0x3f803d49,0xbf2cbf3e,0xa554bf80,0xbf353f35,0x3d49bf80,0xbf3e3f2c
.long 0xa50dbf80,0xbf80248d,0x3d71bf80,0xbf80bd71,0xbf80250d,0x248d3f80,0xbf80bd71,0xbd713f80
.long 0xbf80248d,0xbf353f35,0xbf7fbd8d,0xbf413f28,0x248d3f80,0x3f353f35,0xbd8d3f7f,0x3f283f41
.long 0x80003f80,0x80003f80,0x80003f80,0x80003f80,0x3f800000,0x3f800000,0x3f800000,0x3f800000
.long 0xbca13f80,0xbf393f31,0xbcf13f80,0xbf3a3f30,0x3f803ca1,0x3f313f39,0x3f803cf1,0x3f303f3a
.long 0xbd213f80,0xbf80bd21,0xbd713f80,0xbf80bd71,0x3f803d21,0xbd213f80,0x3f803d71,0xbd713f80
.long 0xbd713f80,0xbf2abf3f,0xbdb53f7f,0xbf24bf44,0x3f803d71,0xbf3f3f2a,0x3f7f3db5,0xbf443f24
.long 0xbda13f7f,0x3da1bf7f,0xbdf13f7e,0x3df1bf7e,0x3f7f3da1,0xbf7fbda1,0x3f7e3df1,0xbf7ebdf1
.long 0xbdc93f7f,0x3f46bf22,0xbe163f7d,0x3f4ebf18,0x3f7f3dc9,0xbf22bf46,0x3f7d3e16,0xbf18bf4e
.long 0xbdf13f7e,0x3f7e3df1,0xbe343f7c,0x3f7c3e34,0x3f7e3df1,0x3df1bf7e,0x3f7c3e34,0x3e34bf7c
.long 0xbe0c3f7e,0x3f1b3f4c,0xbe523f7b,0x3f0c3f56,0x3f7e3e0c,0x3f4cbf1b,0x3f7b3e52,0x3f56bf0c
.long 0x80003f80,0x80003f80,0x80003f80,0x80003f80,0x3f800000,0x3f800000,0x3f800000,0x3f800000
.long 0xbf80bca1,0xbf31bf39,0xbf80bcf1,0xbf30bf3a,0xbca13f80,0xbf393f31,0xbcf13f80,0xbf3a3f30
.long 0x3d21bf80,0x3f803d21,0x3d71bf80,0x3f803d71,0xbf80bd21,0x3d21bf80,0xbf80bd71,0x3d71bf80
.long 0x3f803d71,0xbf3f3f2a,0x3f7f3db5,0xbf443f24,0x3d71bf80,0x3f2a3f3f,0x3db5bf7f,0x3f243f44
.long 0xbda13f7f,0x3da1bf7f,0xbdf13f7e,0x3df1bf7e,0x3f7f3da1,0xbf7fbda1,0x3f7e3df1,0xbf7ebdf1
.long 0xbf7fbdc9,0x3f223f46,0xbf7dbe16,0x3f183f4e,0xbdc93f7f,0x3f46bf22,0xbe163f7d,0x3f4ebf18
.long 0x3df1bf7e,0xbf7ebdf1,0x3e34bf7c,0xbf7cbe34,0xbf7ebdf1,0xbdf13f7e,0xbf7cbe34,0xbe343f7c
.long 0x3f7e3e0c,0x3f4cbf1b,0x3f7b3e52,0x3f56bf0c,0x3e0cbf7e,0xbf1bbf4c,0x3e52bf7b,0xbf0cbf56
.long 0x80003f80,0x80003f80,0x80003f80,0x80003f80,0x3f800000,0x3f800000,0x3f800000,0x3f800000
.long 0x3ca1bf80,0x3f39bf31,0x3cf1bf80,0x3f3abf30,0xbf80bca1,0xbf31bf39,0xbf80bcf1,0xbf30bf3a
.long 0xbd213f80,0xbf80bd21,0xbd713f80,0xbf80bd71,0x3f803d21,0xbd213f80,0x3f803d71,0xbd713f80
.long 0x3d71bf80,0x3f2a3f3f,0x3db5bf7f,0x3f243f44,0xbf80bd71,0x3f3fbf2a,0xbf7fbdb5,0x3f44bf24
.long 0xbda13f7f,0x3da1bf7f,0xbdf13f7e,0x3df1bf7e,0x3f7f3da1,0xbf7fbda1,0x3f7e3df1,0xbf7ebdf1
.long 0x3dc9bf7f,0xbf463f22,0x3e16bf7d,0xbf4e3f18,0xbf7fbdc9,0x3f223f46,0xbf7dbe16,0x3f183f4e
.long 0xbdf13f7e,0x3f7e3df1,0xbe343f7c,0x3f7c3e34,0x3f7e3df1,0x3df1bf7e,0x3f7c3e34,0x3e34bf7c
.long 0x3e0cbf7e,0xbf1bbf4c,0x3e52bf7b,0xbf0cbf56,0xbf7ebe0c,0xbf4c3f1b,0xbf7bbe52,0xbf563f0c
.long 0x80003f80,0x80003f80,0x80003f80,0x80003f80,0x3f800000,0x3f800000,0x3f800000,0x3f800000
.long 0x3f803ca1,0x3f313f39,0x3f803cf1,0x3f303f3a,0x3ca1bf80,0x3f39bf31,0x3cf1bf80,0x3f3abf30
.long 0x3d21bf80,0x3f803d21,0x3d71bf80,0x3f803d71,0xbf80bd21,0x3d21bf80,0xbf80bd71,0x3d71bf80
.long 0xbf80bd71,0x3f3fbf2a,0xbf7fbdb5,0x3f44bf24,0xbd713f80,0xbf2abf3f,0xbdb53f7f,0xbf24bf44
.long 0xbda13f7f,0x3da1bf7f,0xbdf13f7e,0x3df1bf7e,0x3f7f3da1,0xbf7fbda1,0x3f7e3df1,0xbf7ebdf1
.long 0x3f7f3dc9,0xbf22bf46,0x3f7d3e16,0xbf18bf4e,0x3dc9bf7f,0xbf463f22,0x3e16bf7d,0xbf4e3f18
.long 0x3df1bf7e,0xbf7ebdf1,0x3e34bf7c,0xbf7cbe34,0xbf7ebdf1,0xbdf13f7e,0xbf7cbe34,0xbe343f7c
.long 0xbf7ebe0c,0xbf4c3f1b,0xbf7bbe52,0xbf563f0c,0xbe0c3f7e,0x3f1b3f4c,0xbe523f7b,0x3f0c3f56
.long 0x80003f80,0x80003f80,0x80003f80,0x80003f80,0x3f800000,0x3f800000,0x3f800000,0x3f800000
.long 0xbd213f80,0xbf3c3f2e,0xbd493f80,0xbf3e3f2c,0x3f803d21,0x3f2e3f3c,0x3f803d49,0x3f2c3f3e
.long 0xbda13f7f,0xbf7fbda1,0xbdc93f7f,0xbf7fbdc9,0x3f7f3da1,0xbda13f7f,0x3f7f3dc9,0xbdc93f7f
.long 0xbdf13f7e,0xbf1ebf49,0xbe163f7d,0xbf18bf4e,0x3f7e3df1,0xbf493f1e,0x3f7d3e16,0xbf4e3f18
.long 0xbe203f7d,0x3e20bf7d,0xbe483f7b,0x3e48bf7b,0x3f7d3e20,0xbf7dbe20,0x3f7b3e48,0xbf7bbe48
.long 0xbe483f7b,0x3f55bf0e,0xbe793f78,0x3f5cbf04,0x3f7b3e48,0xbf0ebf55,0x3f783e79,0xbf04bf5c
.long 0xbe6f3f79,0x3f793e6f,0xbe953f75,0x3f753e95,0x3f793e6f,0x3e6fbf79,0x3f753e95,0x3e95bf75
.long 0xbe8b3f76,0x3efa3f5f,0xbeac3f71,0x3edb3f67,0x3f763e8b,0x3f5fbefa,0x3f713eac,0x3f67bedb
.long 0x80003f80,0x80003f80,0x80003f80,0x80003f80,0x3f800000,0x3f800000,0x3f800000,0x3f800000
.long 0xbf80bd21,0xbf2ebf3c,0xbf80bd49,0xbf2cbf3e,0xbd213f80,0xbf3c3f2e,0xbd493f80,0xbf3e3f2c
.long 0x3da1bf7f,0x3f7f3da1,0x3dc9bf7f,0x3f7f3dc9,0xbf7fbda1,0x3da1bf7f,0xbf7fbdc9,0x3dc9bf7f
.long 0x3f7e3df1,0xbf493f1e,0x3f7d3e16,0xbf4e3f18,0x3df1bf7e,0x3f1e3f49,0x3e16bf7d,0x3f183f4e
.long 0xbe203f7d,0x3e20bf7d,0xbe483f7b,0x3e48bf7b,0x3f7d3e20,0xbf7dbe20,0x3f7b3e48,0xbf7bbe48
.long 0xbf7bbe48,0x3f0e3f55,0xbf78be79,0x3f043f5c,0xbe483f7b,0x3f55bf0e,0xbe793f78,0x3f5cbf04
.long 0x3e6fbf79,0xbf79be6f,0x3e95bf75,0xbf75be95,0xbf79be6f,0xbe6f3f79,0xbf75be95,0xbe953f75
.long 0x3f763e8b,0x3f5fbefa,0x3f713eac,0x3f67bedb,0x3e8bbf76,0xbefabf5f,0x3eacbf71,0xbedbbf67
.long 0x80003f80,0x80003f80,0x80003f80,0x80003f80,0x3f800000,0x3f800000,0x3f800000,0x3f800000
.long 0x3d21bf80,0x3f3cbf2e,0x3d49bf80,0x3f3ebf2c,0xbf80bd21,0xbf2ebf3c,0xbf80bd49,0xbf2cbf3e
.long 0xbda13f7f,0xbf7fbda1,0xbdc93f7f,0xbf7fbdc9,0x3f7f3da1,0xbda13f7f,0x3f7f3dc9,0xbdc93f7f
.long 0x3df1bf7e,0x3f1e3f49,0x3e16bf7d,0x3f183f4e,0xbf7ebdf1,0x3f49bf1e,0xbf7dbe16,0x3f4ebf18
.long 0xbe203f7d,0x3e20bf7d,0xbe483f7b,0x3e48bf7b,0x3f7d3e20,0xbf7dbe20,0x3f7b3e48,0xbf7bbe48
.long 0x3e48bf7b,0xbf553f0e,0x3e79bf78,0xbf5c3f04,0xbf7bbe48,0x3f0e3f55,0xbf78be79,0x3f043f5c
.long 0xbe6f3f79,0x3f793e6f,0xbe953f75,0x3f753e95,0x3f793e6f,0x3e6fbf79,0x3f753e95,0x3e95bf75
.long 0x3e8bbf76,0xbefabf5f,0x3eacbf71,0xbedbbf67,0xbf76be8b,0xbf5f3efa,0xbf71beac,0xbf673edb
.long 0x80003f80,0x80003f80,0x80003f80,0x80003f80,0x3f800000,0x3f800000,0x3f800000,0x3f800000
.long 0x3f803d21,0x3f2e3f3c,0x3f803d49,0x3f2c3f3e,0x3d21bf80,0x3f3cbf2e,0x3d49bf80,0x3f3ebf2c
.long 0x3da1bf7f,0x3f7f3da1,0x3dc9bf7f,0x3f7f3dc9,0xbf7fbda1,0x3da1bf7f,0xbf7fbdc9,0x3dc9bf7f
.long 0xbf7ebdf1,0x3f49bf1e,0xbf7dbe16,0x3f4ebf18,0xbdf13f7e,0xbf1ebf49,0xbe163f7d,0xbf18bf4e
.long 0xbe203f7d,0x3e20bf7d,0xbe483f7b,0x3e48bf7b,0x3f7d3e20,0xbf7dbe20,0x3f7b3e48,0xbf7bbe48
.long 0x3f7b3e48,0xbf0ebf55,0x3f783e79,0xbf04bf5c,0x3e48bf7b,0xbf553f0e,0x3e79bf78,0xbf5c3f04
.long 0x3e6fbf79,0xbf79be6f,0x3e95bf75,0xbf75be95,0xbf79be6f,0xbe6f3f79,0xbf75be95,0xbe953f75
.long 0xbf76be8b,0xbf5f3efa,0xbf71beac,0xbf673edb,0xbe8b3f76,0x3efa3f5f,0xbeac3f71,0x3edb3f67
.long 0x80003f80,0x80003f80,0x80003f80,0x80003f80,0x3f800000,0x3f800000,0x3f800000,0x3f800000
.long 0xbd713f80,0xbf3f3f2a,0xbd8d3f7f,0xbf413f28,0x3f803d71,0x3f2a3f3f,0x3f7f3d8d,0x3f283f41
.long 0xbdf13f7e,0xbf7ebdf1,0xbe0c3f7e,0xbf7ebe0c,0x3f7e3df1,0xbdf13f7e,0x3f7e3e0c,0xbe0c3f7e
.long 0xbe343f7c,0xbf12bf52,0xbe523f7b,0xbf0cbf56,0x3f7c3e34,0xbf523f12,0x3f7b3e52,0xbf563f0c
.long 0xbe6f3f79,0x3e6fbf79,0xbe8b3f76,0x3e8bbf76,0x3f793e6f,0xbf79be6f,0x3f763e8b,0xbf76be8b
.long 0xbe953f75,0x3f62bef1,0xbeac3f71,0x3f67bedb,0x3f753e95,0xbef1bf62,0x3f713eac,0xbedbbf67
.long 0xbeb13f70,0x3f703eb1,0xbecd3f6b,0x3f6b3ecd,0x3f703eb1,0x3eb1bf70,0x3f6b3ecd,0x3ecdbf6b
.long 0xbecd3f6b,0x3ebb3f6e,0xbeed3f63,0x3e993f74,0x3f6b3ecd,0x3f6ebebb,0x3f633eed,0x3f74be99
.long 0x80003f80,0x80003f80,0x80003f80,0x80003f80,0x3f800000,0x3f800000,0x3f800000,0x3f800000
.long 0xbf80bd71,0xbf2abf3f,0xbf7fbd8d,0xbf28bf41,0xbd713f80,0xbf3f3f2a,0xbd8d3f7f,0xbf413f28
.long 0x3df1bf7e,0x3f7e3df1,0x3e0cbf7e,0x3f7e3e0c,0xbf7ebdf1,0x3df1bf7e,0xbf7ebe0c,0x3e0cbf7e
.long 0x3f7c3e34,0xbf523f12,0x3f7b3e52,0xbf563f0c,0x3e34bf7c,0x3f123f52,0x3e52bf7b,0x3f0c3f56
.long 0xbe6f3f79,0x3e6fbf79,0xbe8b3f76,0x3e8bbf76,0x3f793e6f,0xbf79be6f,0x3f763e8b,0xbf76be8b
.long 0xbf75be95,0x3ef13f62,0xbf71beac,0x3edb3f67,0xbe953f75,0x3f62bef1,0xbeac3f71,0x3f67bedb
.long 0x3eb1bf70,0xbf70beb1,0x3ecdbf6b,0xbf6bbecd,0xbf70beb1,0xbeb13f70,0xbf6bbecd,0xbecd3f6b
.long 0x3f6b3ecd,0x3f6ebebb,0x3f633eed,0x3f74be99,0x3ecdbf6b,0xbebbbf6e,0x3eedbf63,0xbe99bf74
.long 0x80003f80,0x80003f80,0x80003f80,0x80003f80,0x3f800000,0x3f800000,0x3f800000,0x3f800000
.long 0x3d71bf80,0x3f3fbf2a,0x3d8dbf7f,0x3f41bf28,0xbf80bd71,0xbf2abf3f,0xbf7fbd8d,0xbf28bf41
.long 0xbdf13f7e,0xbf7ebdf1,0xbe0c3f7e,0xbf7ebe0c,0x3f7e3df1,0xbdf13f7e,0x3f7e3e0c,0xbe0c3f7e
.long 0x3e34bf7c,0x3f123f52,0x3e52bf7b,0x3f0c3f56,0xbf7cbe34,0x3f52bf12,0xbf7bbe52,0x3f56bf0c
.long 0xbe6f3f79,0x3e6fbf79,0xbe8b3f76,0x3e8bbf76,0x3f793e6f,0xbf79be6f,0x3f763e8b,0xbf76be8b
.long 0x3e95bf75,0xbf623ef1,0x3eacbf71,0xbf673edb,0xbf75be95,0x3ef13f62,0xbf71beac,0x3edb3f67
.long 0xbeb13f70,0x3f703eb1,0xbecd3f6b,0x3f6b3ecd,0x3f703eb1,0x3eb1bf70,0x3f6b3ecd,0x3ecdbf6b
.long 0x3ecdbf6b,0xbebbbf6e,0x3eedbf63,0xbe99bf74,0xbf6bbecd,0xbf6e3ebb,0xbf63beed,0xbf743e99
.long 0x80003f80,0x80003f80,0x80003f80,0x80003f80,0x3f800000,0x3f800000,0x3f800000,0x3f800000
.long 0x3f803d71,0x3f2a3f3f,0x3f7f3d8d,0x3f283f41,0x3d71bf80,0x3f3fbf2a,0x3d8dbf7f,0x3f41bf28
.long 0x3df1bf7e,0x3f7e3df1,0x3e0cbf7e,0x3f7e3e0c,0xbf7ebdf1,0x3df1bf7e,0xbf7ebe0c,0x3e0cbf7e
.long 0xbf7cbe34,0x3f52bf12,0xbf7bbe52,0x3f56bf0c,0xbe343f7c,0xbf12bf52,0xbe523f7b,0xbf0cbf56
.long 0xbe6f3f79,0x3e6fbf79,0xbe8b3f76,0x3e8bbf76,0x3f793e6f,0xbf79be6f,0x3f763e8b,0xbf76be8b
.long 0x3f753e95,0xbef1bf62,0x3f713eac,0xbedbbf67,0x3e95bf75,0xbf623ef1,0x3eacbf71,0xbf673edb
.long 0x3eb1bf70,0xbf70beb1,0x3ecdbf6b,0xbf6bbecd,0xbf70beb1,0xbeb13f70,0xbf6bbecd,0xbecd3f6b
.long 0xbf6bbecd,0xbf6e3ebb,0xbf63beed,0xbf743e99,0xbecd3f6b,0x3ebb3f6e,0xbeed3f63,0x3e993f74
.long 0x80003f80,0x80003f80,0x80003f80,0x80003f80,0x3f800000,0x3f800000,0x3f800000,0x3f800000
.long 0xbda13f7f,0xbf433f26,0xbdb53f7f,0xbf443f24,0x3f7f3da1,0x3f263f43,0x3f7f3db5,0x3f243f44
.long 0xbe203f7d,0xbf7dbe20,0xbe343f7c,0xbf7cbe34,0x3f7d3e20,0xbe203f7d,0x3f7c3e34,0xbe343f7c
.long 0xbe6f3f79,0xbf06bf5a,0xbe863f77,0xbeffbf5e,0x3f793e6f,0xbf5a3f06,0x3f773e86,0xbf5e3eff
.long 0xbe9e3f73,0x3e9ebf73,0xbeb13f70,0x3eb1bf70,0x3f733e9e,0xbf73be9e,0x3f703eb1,0xbf70beb1
.long 0xbec43f6d,0x3f6dbec4,0xbedb3f67,0x3f71beac,0x3f6d3ec4,0xbec4bf6d,0x3f673edb,0xbeacbf71
.long 0xbee83f64,0x3f643ee8,0xbf013f5d,0x3f5d3f01,0x3f643ee8,0x3ee8bf64,0x3f5d3f01,0x3f01bf5d
.long 0xbf063f5a,0x3e6f3f79,0xbf143f51,0x3e2a3f7c,0x3f5a3f06,0x3f79be6f,0x3f513f14,0x3f7cbe2a
.long 0x80003f80,0x80003f80,0x80003f80,0x80003f80,0x3f800000,0x3f800000,0x3f800000,0x3f800000
.long 0xbf7fbda1,0xbf26bf43,0xbf7fbdb5,0xbf24bf44,0xbda13f7f,0xbf433f26,0xbdb53f7f,0xbf443f24
.long 0x3e20bf7d,0x3f7d3e20,0x3e34bf7c,0x3f7c3e34,0xbf7dbe20,0x3e20bf7d,0xbf7cbe34,0x3e34bf7c
.long 0x3f793e6f,0xbf5a3f06,0x3f773e86,0xbf5e3eff,0x3e6fbf79,0x3f063f5a,0x3e86bf77,0x3eff3f5e
.long 0xbe9e3f73,0x3e9ebf73,0xbeb13f70,0x3eb1bf70,0x3f733e9e,0xbf73be9e,0x3f703eb1,0xbf70beb1
.long 0xbf6dbec4,0x3ec43f6d,0xbf67bedb,0x3eac3f71,0xbec43f6d,0x3f6dbec4,0xbedb3f67,0x3f71beac
.long 0x3ee8bf64,0xbf64bee8,0x3f01bf5d,0xbf5dbf01,0xbf64bee8,0xbee83f64,0xbf5dbf01,0xbf013f5d
.long 0x3f5a3f06,0x3f79be6f,0x3f513f14,0x3f7cbe2a,0x3f06bf5a,0xbe6fbf79,0x3f14bf51,0xbe2abf7c
.long 0x80003f80,0x80003f80,0x80003f80,0x80003f80,0x3f800000,0x3f800000,0x3f800000,0x3f800000
.long 0x3da1bf7f,0x3f43bf26,0x3db5bf7f,0x3f44bf24,0xbf7fbda1,0xbf26bf43,0xbf7fbdb5,0xbf24bf44
.long 0xbe203f7d,0xbf7dbe20,0xbe343f7c,0xbf7cbe34,0x3f7d3e20,0xbe203f7d,0x3f7c3e34,0xbe343f7c
.long 0x3e6fbf79,0x3f063f5a,0x3e86bf77,0x3eff3f5e,0xbf79be6f,0x3f5abf06,0xbf77be86,0x3f5ebeff
.long 0xbe9e3f73,0x3e9ebf73,0xbeb13f70,0x3eb1bf70,0x3f733e9e,0xbf73be9e,0x3f703eb1,0xbf70beb1
.long 0x3ec4bf6d,0xbf6d3ec4,0x3edbbf67,0xbf713eac,0xbf6dbec4,0x3ec43f6d,0xbf67bedb,0x3eac3f71
.long 0xbee83f64,0x3f643ee8,0xbf013f5d,0x3f5d3f01,0x3f643ee8,0x3ee8bf64,0x3f5d3f01,0x3f01bf5d
.long 0x3f06bf5a,0xbe6fbf79,0x3f14bf51,0xbe2abf7c,0xbf5abf06,0xbf793e6f,0xbf51bf14,0xbf7c3e2a
.long 0x80003f80,0x80003f80,0x80003f80,0x80003f80,0x3f800000,0x3f800000,0x3f800000,0x3f800000
.long 0x3f7f3da1,0x3f263f43,0x3f7f3db5,0x3f243f44,0x3da1bf7f,0x3f43bf26,0x3db5bf7f,0x3f44bf24
.long 0x3e20bf7d,0x3f7d3e20,0x3e34bf7c,0x3f7c3e34,0xbf7dbe20,0x3e20bf7d,0xbf7cbe34,0x3e34bf7c
.long 0xbf79be6f,0x3f5abf06,0xbf77be86,0x3f5ebeff,0xbe6f3f79,0xbf06bf5a,0xbe863f77,0xbeffbf5e
.long 0xbe9e3f73,0x3e9ebf73,0xbeb13f70,0x3eb1bf70,0x3f733e9e,0xbf73be9e,0x3f703eb1,0xbf70beb1
.long 0x3f6d3ec4,0xbec4bf6d,0x3f673edb,0xbeacbf71,0x3ec4bf6d,0xbf6d3ec4,0x3edbbf67,0xbf713eac
.long 0x3ee8bf64,0xbf64bee8,0x3f01bf5d,0xbf5dbf01,0xbf64bee8,0xbee83f64,0xbf5dbf01,0xbf013f5d
.long 0xbf5abf06,0xbf793e6f,0xbf51bf14,0xbf7c3e2a,0xbf063f5a,0x3e6f3f79,0xbf143f51,0x3e2a3f7c
.long 0x80003f80,0x80003f80,0x80003f80,0x80003f80,0x3f800000,0x3f800000,0x3f800000,0x3f800000
.long 0xbdc93f7f,0xbf463f22,0xbddd3f7f,0xbf473f20,0x3f7f3dc9,0x3f223f46,0x3f7f3ddd,0x3f203f47
.long 0xbe483f7b,0xbf7bbe48,0xbe5b3f7a,0xbf7abe5b,0x3f7b3e48,0xbe483f7b,0x3f7a3e5b,0xbe5b3f7a
.long 0xbe953f75,0xbef1bf62,0xbea33f73,0xbee4bf65,0x3f753e95,0xbf623ef1,0x3f733ea3,0xbf653ee4
.long 0xbec43f6d,0x3ec4bf6d,0xbed63f68,0x3ed6bf68,0x3f6d3ec4,0xbf6dbec4,0x3f683ed6,0xbf68bed6
.long 0xbef13f62,0x3f75be95,0xbf043f5c,0x3f78be79,0x3f623ef1,0xbe95bf75,0x3f5c3f04,0xbe79bf78
.long 0xbf0e3f55,0x3f553f0e,0xbf1b3f4c,0x3f4c3f1b,0x3f553f0e,0x3f0ebf55,0x3f4c3f1b,0x3f1bbf4c
.long 0xbf223f46,0x3dc93f7f,0xbf303f3a,0x3cf13f80,0x3f463f22,0x3f7fbdc9,0x3f3a3f30,0x3f80bcf1
.long 0x80003f80,0x80003f80,0x80003f80,0x80003f80,0x3f800000,0x3f800000,0x3f800000,0x3f800000
.long 0xbf7fbdc9,0xbf22bf46,0xbf7fbddd,0xbf20bf47,0xbdc93f7f,0xbf463f22,0xbddd3f7f,0xbf473f20
.long 0x3e48bf7b,0x3f7b3e48,0x3e5bbf7a,0x3f7a3e5b,0xbf7bbe48,0x3e48bf7b,0xbf7abe5b,0x3e5bbf7a
.long 0x3f753e95,0xbf623ef1,0x3f733ea3,0xbf653ee4,0x3e95bf75,0x3ef13f62,0x3ea3bf73,0x3ee43f65
.long 0xbec43f6d,0x3ec4bf6d,0xbed63f68,0x3ed6bf68,0x3f6d3ec4,0xbf6dbec4,0x3f683ed6,0xbf68bed6
.long 0xbf62bef1,0x3e953f75,0xbf5cbf04,0x3e793f78,0xbef13f62,0x3f75be95,0xbf043f5c,0x3f78be79
.long 0x3f0ebf55,0xbf55bf0e,0x3f1bbf4c,0xbf4cbf1b,0xbf55bf0e,0xbf0e3f55,0xbf4cbf1b,0xbf1b3f4c
.long 0x3f463f22,0x3f7fbdc9,0x3f3a3f30,0x3f80bcf1,0x3f22bf46,0xbdc9bf7f,0x3f30bf3a,0xbcf1bf80
.long 0x80003f80,0x80003f80,0x80003f80,0x80003f80,0x3f800000,0x3f800000,0x3f800000,0x3f800000
.long 0x3dc9bf7f,0x3f46bf22,0x3dddbf7f,0x3f47bf20,0xbf7fbdc9,0xbf22bf46,0xbf7fbddd,0xbf20bf47
.long 0xbe483f7b,0xbf7bbe48,0xbe5b3f7a,0xbf7abe5b,0x3f7b3e48,0xbe483f7b,0x3f7a3e5b,0xbe5b3f7a
.long 0x3e95bf75,0x3ef13f62,0x3ea3bf73,0x3ee43f65,0xbf75be95,0x3f62bef1,0xbf73bea3,0x3f65bee4
.long 0xbec43f6d,0x3ec4bf6d,0xbed63f68,0x3ed6bf68,0x3f6d3ec4,0xbf6dbec4,0x3f683ed6,0xbf68bed6
.long 0x3ef1bf62,0xbf753e95,0x3f04bf5c,0xbf783e79,0xbf62bef1,0x3e953f75,0xbf5cbf04,0x3e793f78
.long 0xbf0e3f55,0x3f553f0e,0xbf1b3f4c,0x3f4c3f1b,0x3f553f0e,0x3f0ebf55,0x3f4c3f1b,0x3f1bbf4c
.long 0x3f22bf46,0xbdc9bf7f,0x3f30bf3a,0xbcf1bf80,0xbf46bf22,0xbf7f3dc9,0xbf3abf30,0xbf803cf1
.long 0x80003f80,0x80003f80,0x80003f80,0x80003f80,0x3f800000,0x3f800000,0x3f800000,0x3f800000
.long 0x3f7f3dc9,0x3f223f46,0x3f7f3ddd,0x3f203f47,0x3dc9bf7f,0x3f46bf22,0x3dddbf7f,0x3f47bf20
.long 0x3e48bf7b,0x3f7b3e48,0x3e5bbf7a,0x3f7a3e5b,0xbf7bbe48,0x3e48bf7b,0xbf7abe5b,0x3e5bbf7a
.long 0xbf75be95,0x3f62bef1,0xbf73bea3,0x3f65bee4,0xbe953f75,0xbef1bf62,0xbea33f73,0xbee4bf65
.long 0xbec43f6d,0x3ec4bf6d,0xbed63f68,0x3ed6bf68,0x3f6d3ec4,0xbf6dbec4,0x3f683ed6,0xbf68bed6
.long 0x3f623ef1,0xbe95bf75,0x3f5c3f04,0xbe79bf78,0x3ef1bf62,0xbf753e95,0x3f04bf5c,0xbf783e79
.long 0x3f0ebf55,0xbf55bf0e,0x3f1bbf4c,0xbf4cbf1b,0xbf55bf0e,0xbf0e3f55,0xbf4cbf1b,0xbf1b3f4c
.long 0xbf46bf22,0xbf7f3dc9,0xbf3abf30,0xbf803cf1,0xbf223f46,0x3dc93f7f,0xbf303f3a,0x3cf13f80
.long 0x80003f80,0x80003f80,0x80003f80,0x80003f80,0x3f800000,0x3f800000,0x3f800000,0x3f800000
.long 0xbdf13f7e,0xbf493f1e,0xbe023f7e,0xbf4b3f1d,0x3f7e3df1,0x3f1e3f49,0x3f7e3e02,0x3f1d3f4b
.long 0xbe6f3f79,0xbf79be6f,0xbe813f78,0xbf78be81,0x3f793e6f,0xbe6f3f79,0x3f783e81,0xbe813f78
.long 0xbeb13f70,0xbed6bf68,0xbebf3f6d,0xbec9bf6c,0x3f703eb1,0xbf683ed6,0x3f6d3ebf,0xbf6c3ec9
.long 0xbee83f64,0x3ee8bf64,0xbefa3f5f,0x3efabf5f,0x3f643ee8,0xbf64bee8,0x3f5f3efa,0xbf5fbefa
.long 0xbf0e3f55,0x3f7bbe48,0xbf183f4e,0x3f7dbe16,0x3f553f0e,0xbe48bf7b,0x3f4e3f18,0xbe16bf7d
.long 0xbf263f43,0x3f433f26,0xbf313f39,0x3f393f31,0x3f433f26,0x3f26bf43,0x3f393f31,0x3f31bf39
.long 0xbf3c3f2e,0xbd213f80,0xbf473f20,0xbddd3f7f,0x3f2e3f3c,0x3f803d21,0x3f203f47,0x3f7f3ddd
.long 0x80003f80,0x80003f80,0x80003f80,0x80003f80,0x3f800000,0x3f800000,0x3f800000,0x3f800000
.long 0xbf7ebdf1,0xbf1ebf49,0xbf7ebe02,0xbf1dbf4b,0xbdf13f7e,0xbf493f1e,0xbe023f7e,0xbf4b3f1d
.long 0x3e6fbf79,0x3f793e6f,0x3e81bf78,0x3f783e81,0xbf79be6f,0x3e6fbf79,0xbf78be81,0x3e81bf78
.long 0x3f703eb1,0xbf683ed6,0x3f6d3ebf,0xbf6c3ec9,0x3eb1bf70,0x3ed63f68,0x3ebfbf6d,0x3ec93f6c
.long 0xbee83f64,0x3ee8bf64,0xbefa3f5f,0x3efabf5f,0x3f643ee8,0xbf64bee8,0x3f5f3efa,0xbf5fbefa
.long 0xbf55bf0e,0x3e483f7b,0xbf4ebf18,0x3e163f7d,0xbf0e3f55,0x3f7bbe48,0xbf183f4e,0x3f7dbe16
.long 0x3f26bf43,0xbf43bf26,0x3f31bf39,0xbf39bf31,0xbf43bf26,0xbf263f43,0xbf39bf31,0xbf313f39
.long 0x3f2e3f3c,0x3f803d21,0x3f203f47,0x3f7f3ddd,0x3f3cbf2e,0x3d21bf80,0x3f47bf20,0x3dddbf7f
.long 0x80003f80,0x80003f80,0x80003f80,0x80003f80,0x3f800000,0x3f800000,0x3f800000,0x3f800000
.long 0x3df1bf7e,0x3f49bf1e,0x3e02bf7e,0x3f4bbf1d,0xbf7ebdf1,0xbf1ebf49,0xbf7ebe02,0xbf1dbf4b
.long 0xbe6f3f79,0xbf79be6f,0xbe813f78,0xbf78be81,0x3f793e6f,0xbe6f3f79,0x3f783e81,0xbe813f78
.long 0x3eb1bf70,0x3ed63f68,0x3ebfbf6d,0x3ec93f6c,0xbf70beb1,0x3f68bed6,0xbf6dbebf,0x3f6cbec9
.long 0xbee83f64,0x3ee8bf64,0xbefa3f5f,0x3efabf5f,0x3f643ee8,0xbf64bee8,0x3f5f3efa,0xbf5fbefa
.long 0x3f0ebf55,0xbf7b3e48,0x3f18bf4e,0xbf7d3e16,0xbf55bf0e,0x3e483f7b,0xbf4ebf18,0x3e163f7d
.long 0xbf263f43,0x3f433f26,0xbf313f39,0x3f393f31,0x3f433f26,0x3f26bf43,0x3f393f31,0x3f31bf39
.long 0x3f3cbf2e,0x3d21bf80,0x3f47bf20,0x3dddbf7f,0xbf2ebf3c,0xbf80bd21,0xbf20bf47,0xbf7fbddd
.long 0x80003f80,0x80003f80,0x80003f80,0x80003f80,0x3f800000,0x3f800000,0x3f800000,0x3f800000
.long 0x3f7e3df1,0x3f1e3f49,0x3f7e3e02,0x3f1d3f4b,0x3df1bf7e,0x3f49bf1e,0x3e02bf7e,0x3f4bbf1d
.long 0x3e6fbf79,0x3f793e6f,0x3e81bf78,0x3f783e81,0xbf79be6f,0x3e6fbf79,0xbf78be81,0x3e81bf78
.long 0xbf70beb1,0x3f68bed6,0xbf6dbebf,0x3f6cbec9,0xbeb13f70,0xbed6bf68,0xbebf3f6d,0xbec9bf6c
.long 0xbee83f64,0x3ee8bf64,0xbefa3f5f,0x3efabf5f,0x3f643ee8,0xbf64bee8,0x3f5f3efa,0xbf5fbefa
.long 0x3f553f0e,0xbe48bf7b,0x3f4e3f18,0xbe16bf7d,0x3f0ebf55,0xbf7b3e48,0x3f18bf4e,0xbf7d3e16
.long 0x3f26bf43,0xbf43bf26,0x3f31bf39,0xbf39bf31,0xbf43bf26,0xbf263f43,0xbf39bf31,0xbf313f39
.long 0xbf2ebf3c,0xbf80bd21,0xbf20bf47,0xbf7fbddd,0xbf3c3f2e,0xbd213f80,0xbf473f20,0xbddd3f7f
.long 0x80003f80,0x80003f80,0x80003f80,0x80003f80,0x3f800000,0x3f800000,0x3f800000,0x3f800000
.long 0xbe0c3f7e,0xbf4c3f1b,0xbe163f7d,0xbf4e3f18,0x3f7e3e0c,0x3f1b3f4c,0x3f7d3e16,0x3f183f4e
.long 0xbe8b3f76,0xbf76be8b,0xbe953f75,0xbf75be95,0x3f763e8b,0xbe8b3f76,0x3f753e95,0xbe953f75
.long 0xbecd3f6b,0xbebbbf6e,0xbedb3f67,0xbeacbf71,0x3f6b3ecd,0xbf6e3ebb,0x3f673edb,0xbf713eac
.long 0xbf063f5a,0x3f06bf5a,0xbf0e3f55,0x3f0ebf55,0x3f5a3f06,0xbf5abf06,0x3f553f0e,0xbf55bf0e
.long 0xbf223f46,0x3f7fbdc9,0xbf2c3f3e,0x3f80bd49,0x3f463f22,0xbdc9bf7f,0x3f3e3f2c,0xbd49bf80
.long 0xbf3c3f2e,0x3f2e3f3c,0xbf463f22,0x3f223f46,0x3f2e3f3c,0x3f3cbf2e,0x3f223f46,0x3f46bf22
.long 0xbf523f12,0xbe343f7c,0xbf5c3f04,0xbe793f78,0x3f123f52,0x3f7c3e34,0x3f043f5c,0x3f783e79
.long 0x80003f80,0x80003f80,0x80003f80,0x80003f80,0x3f800000,0x3f800000,0x3f800000,0x3f800000
.long 0xbf7ebe0c,0xbf1bbf4c,0xbf7dbe16,0xbf18bf4e,0xbe0c3f7e,0xbf4c3f1b,0xbe163f7d,0xbf4e3f18
.long 0x3e8bbf76,0x3f763e8b,0x3e95bf75,0x3f753e95,0xbf76be8b,0x3e8bbf76,0xbf75be95,0x3e95bf75
.long 0x3f6b3ecd,0xbf6e3ebb,0x3f673edb,0xbf713eac,0x3ecdbf6b,0x3ebb3f6e,0x3edbbf67,0x3eac3f71
.long 0xbf063f5a,0x3f06bf5a,0xbf0e3f55,0x3f0ebf55,0x3f5a3f06,0xbf5abf06,0x3f553f0e,0xbf55bf0e
.long 0xbf46bf22,0x3dc93f7f,0xbf3ebf2c,0x3d493f80,0xbf223f46,0x3f7fbdc9,0xbf2c3f3e,0x3f80bd49
.long 0x3f3cbf2e,0xbf2ebf3c,0x3f46bf22,0xbf22bf46,0xbf2ebf3c,0xbf3c3f2e,0xbf22bf46,0xbf463f22
.long 0x3f123f52,0x3f7c3e34,0x3f043f5c,0x3f783e79,0x3f52bf12,0x3e34bf7c,0x3f5cbf04,0x3e79bf78
.long 0x80003f80,0x80003f80,0x80003f80,0x80003f80,0x3f800000,0x3f800000,0x3f800000,0x3f800000
.long 0x3e0cbf7e,0x3f4cbf1b,0x3e16bf7d,0x3f4ebf18,0xbf7ebe0c,0xbf1bbf4c,0xbf7dbe16,0xbf18bf4e
.long 0xbe8b3f76,0xbf76be8b,0xbe953f75,0xbf75be95,0x3f763e8b,0xbe8b3f76,0x3f753e95,0xbe953f75
.long 0x3ecdbf6b,0x3ebb3f6e,0x3edbbf67,0x3eac3f71,0xbf6bbecd,0x3f6ebebb,0xbf67bedb,0x3f71beac
.long 0xbf063f5a,0x3f06bf5a,0xbf0e3f55,0x3f0ebf55,0x3f5a3f06,0xbf5abf06,0x3f553f0e,0xbf55bf0e
.long 0x3f22bf46,0xbf7f3dc9,0x3f2cbf3e,0xbf803d49,0xbf46bf22,0x3dc93f7f,0xbf3ebf2c,0x3d493f80
.long 0xbf3c3f2e,0x3f2e3f3c,0xbf463f22,0x3f223f46,0x3f2e3f3c,0x3f3cbf2e,0x3f223f46,0x3f46bf22
.long 0x3f52bf12,0x3e34bf7c,0x3f5cbf04,0x3e79bf78,0xbf12bf52,0xbf7cbe34,0xbf04bf5c,0xbf78be79
.long 0x80003f80,0x80003f80,0x80003f80,0x80003f80,0x3f800000,0x3f800000,0x3f800000,0x3f800000
.long 0x3f7e3e0c,0x3f1b3f4c,0x3f7d3e16,0x3f183f4e,0x3e0cbf7e,0x3f4cbf1b,0x3e16bf7d,0x3f4ebf18
.long 0x3e8bbf76,0x3f763e8b,0x3e95bf75,0x3f753e95,0xbf76be8b,0x3e8bbf76,0xbf75be95,0x3e95bf75
.long 0xbf6bbecd,0x3f6ebebb,0xbf67bedb,0x3f71beac,0xbecd3f6b,0xbebbbf6e,0xbedb3f67,0xbeacbf71
.long 0xbf063f5a,0x3f06bf5a,0xbf0e3f55,0x3f0ebf55,0x3f5a3f06,0xbf5abf06,0x3f553f0e,0xbf55bf0e
.long 0x3f463f22,0xbdc9bf7f,0x3f3e3f2c,0xbd49bf80,0x3f22bf46,0xbf7f3dc9,0x3f2cbf3e,0xbf803d49
.long 0x3f3cbf2e,0xbf2ebf3c,0x3f46bf22,0xbf22bf46,0xbf2ebf3c,0xbf3c3f2e,0xbf22bf46,0xbf463f22
.long 0xbf12bf52,0xbf7cbe34,0xbf04bf5c,0xbf78be79,0xbf523f12,0xbe343f7c,0xbf5c3f04,0xbe793f78
.long 0x80003f80,0x80003f80,0x80003f80,0x80003f80,0x3f800000,0x3f800000,0x3f800000,0x3f800000
.long 0xbe203f7d,0xbf4f3f16,0xbe2a3f7c,0xbf513f14,0x3f7d3e20,0x3f163f4f,0x3f7c3e2a,0x3f143f51
.long 0xbe9e3f73,0xbf73be9e,0xbea83f72,0xbf72bea8,0x3f733e9e,0xbe9e3f73,0x3f723ea8,0xbea83f72
.long 0xbee83f64,0xbe9ebf73,0xbef63f61,0xbe90bf76,0x3f643ee8,0xbf733e9e,0x3f613ef6,0xbf763e90
.long 0xbf163f4f,0x3f16bf4f,0xbf1e3f49,0x3f1ebf49,0x3f4f3f16,0xbf4fbf16,0x3f493f1e,0xbf49bf1e
.long 0xbf353f35,0x3f80a554,0xbf3e3f2c,0x3f803d49,0x3f353f35,0xa554bf80,0x3f2c3f3e,0x3d49bf80
.long 0xbf4f3f16,0x3f163f4f,0xbf583f0a,0x3f0a3f58,0x3f163f4f,0x3f4fbf16,0x3f0a3f58,0x3f58bf0a
.long 0xbf643ee8,0xbe9e3f73,0xbf6c3ec9,0xbebf3f6d,0x3ee83f64,0x3f733e9e,0x3ec93f6c,0x3f6d3ebf
.long 0x80003f80,0x80003f80,0x80003f80,0x80003f80,0x3f800000,0x3f800000,0x3f800000,0x3f800000
.long 0xbf7dbe20,0xbf16bf4f,0xbf7cbe2a,0xbf14bf51,0xbe203f7d,0xbf4f3f16,0xbe2a3f7c,0xbf513f14
.long 0x3e9ebf73,0x3f733e9e,0x3ea8bf72,0x3f723ea8,0xbf73be9e,0x3e9ebf73,0xbf72bea8,0x3ea8bf72
.long 0x3f643ee8,0xbf733e9e,0x3f613ef6,0xbf763e90,0x3ee8bf64,0x3e9e3f73,0x3ef6bf61,0x3e903f76
.long 0xbf163f4f,0x3f16bf4f,0xbf1e3f49,0x3f1ebf49,0x3f4f3f16,0xbf4fbf16,0x3f493f1e,0xbf49bf1e
.long 0xbf35bf35,0x80003f80,0xbf2cbf3e,0xbd493f80,0xbf353f35,0x3f800000,0xbf3e3f2c,0x3f803d49
.long 0x3f4fbf16,0xbf16bf4f,0x3f58bf0a,0xbf0abf58,0xbf16bf4f,0xbf4f3f16,0xbf0abf58,0xbf583f0a
.long 0x3ee83f64,0x3f733e9e,0x3ec93f6c,0x3f6d3ebf,0x3f64bee8,0x3e9ebf73,0x3f6cbec9,0x3ebfbf6d
.long 0x80003f80,0x80003f80,0x80003f80,0x80003f80,0x3f800000,0x3f800000,0x3f800000,0x3f800000
.long 0x3e20bf7d,0x3f4fbf16,0x3e2abf7c,0x3f51bf14,0xbf7dbe20,0xbf16bf4f,0xbf7cbe2a,0xbf14bf51
.long 0xbe9e3f73,0xbf73be9e,0xbea83f72,0xbf72bea8,0x3f733e9e,0xbe9e3f73,0x3f723ea8,0xbea83f72
.long 0x3ee8bf64,0x3e9e3f73,0x3ef6bf61,0x3e903f76,0xbf64bee8,0x3f73be9e,0xbf61bef6,0x3f76be90
.long 0xbf163f4f,0x3f16bf4f,0xbf1e3f49,0x3f1ebf49,0x3f4f3f16,0xbf4fbf16,0x3f493f1e,0xbf49bf1e
.long 0x3f35bf35,0xbf80248d,0x3f3ebf2c,0xbf80bd49,0xbf35bf35,0x248d3f80,0xbf2cbf3e,0xbd493f80
.long 0xbf4f3f16,0x3f163f4f,0xbf583f0a,0x3f0a3f58,0x3f163f4f,0x3f4fbf16,0x3f0a3f58,0x3f58bf0a
.long 0x3f64bee8,0x3e9ebf73,0x3f6cbec9,0x3ebfbf6d,0xbee8bf64,0xbf73be9e,0xbec9bf6c,0xbf6dbebf
.long 0x80003f80,0x80003f80,0x80003f80,0x80003f80,0x3f800000,0x3f800000,0x3f800000,0x3f800000
.long 0x3f7d3e20,0x3f163f4f,0x3f7c3e2a,0x3f143f51,0x3e20bf7d,0x3f4fbf16,0x3e2abf7c,0x3f51bf14
.long 0x3e9ebf73,0x3f733e9e,0x3ea8bf72,0x3f723ea8,0xbf73be9e,0x3e9ebf73,0xbf72bea8,0x3ea8bf72
.long 0xbf64bee8,0x3f73be9e,0xbf61bef6,0x3f76be90,0xbee83f64,0xbe9ebf73,0xbef63f61,0xbe90bf76
.long 0xbf163f4f,0x3f16bf4f,0xbf1e3f49,0x3f1ebf49,0x3f4f3f16,0xbf4fbf16,0x3f493f1e,0xbf49bf1e
.long 0x3f353f35,0xa50dbf80,0x3f2c3f3e,0x3d49bf80,0x3f35bf35,0xbf80250d,0x3f3ebf2c,0xbf80bd49
.long 0x3f4fbf16,0xbf16bf4f,0x3f58bf0a,0xbf0abf58,0xbf16bf4f,0xbf4f3f16,0xbf0abf58,0xbf583f0a
.long 0xbee8bf64,0xbf73be9e,0xbec9bf6c,0xbf6dbebf,0xbf643ee8,0xbe9e3f73,0xbf6c3ec9,0xbebf3f6d
.long 0x80003f80,0x80003f80,0x80003f80,0x80003f80,0x3f800000,0x3f800000,0x3f800000,0x3f800000
.long 0xbe343f7c,0xbf523f12,0xbe3e3f7c,0xbf533f10,0x3f7c3e34,0x3f123f52,0x3f7c3e3e,0x3f103f53
.long 0xbeb13f70,0xbf70beb1,0xbebb3f6e,0xbf6ebebb,0x3f703eb1,0xbeb13f70,0x3f6e3ebb,0xbebb3f6e
.long 0xbf013f5d,0xbe81bf78,0xbf083f59,0xbe65bf7a,0x3f5d3f01,0xbf783e81,0x3f593f08,0xbf7a3e65
.long 0xbf263f43,0x3f26bf43,0xbf2e3f3c,0x3f2ebf3c,0x3f433f26,0xbf43bf26,0x3f3c3f2e,0xbf3cbf2e
.long 0xbf463f22,0x3f7f3dc9,0xbf4e3f18,0x3f7d3e16,0x3f223f46,0x3dc9bf7f,0x3f183f4e,0x3e16bf7d
.long 0xbf5f3efa,0x3efa3f5f,0xbf663edf,0x3edf3f66,0x3efa3f5f,0x3f5fbefa,0x3edf3f66,0x3f66bedf
.long 0xbf723ea8,0xbedf3f66,0xbf773e86,0xbeff3f5e,0x3ea83f72,0x3f663edf,0x3e863f77,0x3f5e3eff
.long 0x80003f80,0x80003f80,0x80003f80,0x80003f80,0x3f800000,0x3f800000,0x3f800000,0x3f800000
.long 0xbf7cbe34,0xbf12bf52,0xbf7cbe3e,0xbf10bf53,0xbe343f7c,0xbf523f12,0xbe3e3f7c,0xbf533f10
.long 0x3eb1bf70,0x3f703eb1,0x3ebbbf6e,0x3f6e3ebb,0xbf70beb1,0x3eb1bf70,0xbf6ebebb,0x3ebbbf6e
.long 0x3f5d3f01,0xbf783e81,0x3f593f08,0xbf7a3e65,0x3f01bf5d,0x3e813f78,0x3f08bf59,0x3e653f7a
.long 0xbf263f43,0x3f26bf43,0xbf2e3f3c,0x3f2ebf3c,0x3f433f26,0xbf43bf26,0x3f3c3f2e,0xbf3cbf2e
.long 0xbf22bf46,0xbdc93f7f,0xbf18bf4e,0xbe163f7d,0xbf463f22,0x3f7f3dc9,0xbf4e3f18,0x3f7d3e16
.long 0x3f5fbefa,0xbefabf5f,0x3f66bedf,0xbedfbf66,0xbefabf5f,0xbf5f3efa,0xbedfbf66,0xbf663edf
.long 0x3ea83f72,0x3f663edf,0x3e863f77,0x3f5e3eff,0x3f72bea8,0x3edfbf66,0x3f77be86,0x3effbf5e
.long 0x80003f80,0x80003f80,0x80003f80,0x80003f80,0x3f800000,0x3f800000,0x3f800000,0x3f800000
.long 0x3e34bf7c,0x3f52bf12,0x3e3ebf7c,0x3f53bf10,0xbf7cbe34,0xbf12bf52,0xbf7cbe3e,0xbf10bf53
.long 0xbeb13f70,0xbf70beb1,0xbebb3f6e,0xbf6ebebb,0x3f703eb1,0xbeb13f70,0x3f6e3ebb,0xbebb3f6e
.long 0x3f01bf5d,0x3e813f78,0x3f08bf59,0x3e653f7a,0xbf5dbf01,0x3f78be81,0xbf59bf08,0x3f7abe65
.long 0xbf263f43,0x3f26bf43,0xbf2e3f3c,0x3f2ebf3c,0x3f433f26,0xbf43bf26,0x3f3c3f2e,0xbf3cbf2e
.long 0x3f46bf22,0xbf7fbdc9,0x3f4ebf18,0xbf7dbe16,0xbf22bf46,0xbdc93f7f,0xbf18bf4e,0xbe163f7d
.long 0xbf5f3efa,0x3efa3f5f,0xbf663edf,0x3edf3f66,0x3efa3f5f,0x3f5fbefa,0x3edf3f66,0x3f66bedf
.long 0x3f72bea8,0x3edfbf66,0x3f77be86,0x3effbf5e,0xbea8bf72,0xbf66bedf,0xbe86bf77,0xbf5ebeff
.long 0x80003f80,0x80003f80,0x80003f80,0x80003f80,0x3f800000,0x3f800000,0x3f800000,0x3f800000
.long 0x3f7c3e34,0x3f123f52,0x3f7c3e3e,0x3f103f53,0x3e34bf7c,0x3f52bf12,0x3e3ebf7c,0x3f53bf10
.long 0x3eb1bf70,0x3f703eb1,0x3ebbbf6e,0x3f6e3ebb,0xbf70beb1,0x3eb1bf70,0xbf6ebebb,0x3ebbbf6e
.long 0xbf5dbf01,0x3f78be81,0xbf59bf08,0x3f7abe65,0xbf013f5d,0xbe81bf78,0xbf083f59,0xbe65bf7a
.long 0xbf263f43,0x3f26bf43,0xbf2e3f3c,0x3f2ebf3c,0x3f433f26,0xbf43bf26,0x3f3c3f2e,0xbf3cbf2e
.long 0x3f223f46,0x3dc9bf7f,0x3f183f4e,0x3e16bf7d,0x3f46bf22,0xbf7fbdc9,0x3f4ebf18,0xbf7dbe16
.long 0x3f5fbefa,0xbefabf5f,0x3f66bedf,0xbedfbf66,0xbefabf5f,0xbf5f3efa,0xbedfbf66,0xbf663edf
.long 0xbea8bf72,0xbf66bedf,0xbe86bf77,0xbf5ebeff,0xbf723ea8,0xbedf3f66,0xbf773e86,0xbeff3f5e
.long 0x80003f80,0x80003f80,0x80003f80,0x80003f80,0x3f800000,0x3f800000,0x3f800000,0x3f800000
.long 0xbe483f7b,0xbf553f0e,0xbe523f7b,0xbf563f0c,0x3f7b3e48,0x3f0e3f55,0x3f7b3e52,0x3f0c3f56
.long 0xbec43f6d,0xbf6dbec4,0xbecd3f6b,0xbf6bbecd,0x3f6d3ec4,0xbec43f6d,0x3f6b3ecd,0xbecd3f6b
.long 0xbf0e3f55,0xbe48bf7b,0xbf143f51,0xbe2abf7c,0x3f553f0e,0xbf7b3e48,0x3f513f14,0xbf7c3e2a
.long 0xbf353f35,0x3f35bf35,0xbf3c3f2e,0x3f3cbf2e,0x3f353f35,0xbf35bf35,0x3f2e3f3c,0xbf2ebf3c
.long 0xbf553f0e,0x3f7b3e48,0xbf5c3f04,0x3f783e79,0x3f0e3f55,0x3e48bf7b,0x3f043f5c,0x3e79bf78
.long 0xbf6d3ec4,0x3ec43f6d,0xbf723ea8,0x3ea83f72,0x3ec43f6d,0x3f6dbec4,0x3ea83f72,0x3f72bea8
.long 0xbf7b3e48,0xbf0e3f55,0xbf7e3e02,0xbf1d3f4b,0x3e483f7b,0x3f553f0e,0x3e023f7e,0x3f4b3f1d
.long 0x80003f80,0x80003f80,0x80003f80,0x80003f80,0x3f800000,0x3f800000,0x3f800000,0x3f800000
.long 0xbf7bbe48,0xbf0ebf55,0xbf7bbe52,0xbf0cbf56,0xbe483f7b,0xbf553f0e,0xbe523f7b,0xbf563f0c
.long 0x3ec4bf6d,0x3f6d3ec4,0x3ecdbf6b,0x3f6b3ecd,0xbf6dbec4,0x3ec4bf6d,0xbf6bbecd,0x3ecdbf6b
.long 0x3f553f0e,0xbf7b3e48,0x3f513f14,0xbf7c3e2a,0x3f0ebf55,0x3e483f7b,0x3f14bf51,0x3e2a3f7c
.long 0xbf353f35,0x3f35bf35,0xbf3c3f2e,0x3f3cbf2e,0x3f353f35,0xbf35bf35,0x3f2e3f3c,0xbf2ebf3c
.long 0xbf0ebf55,0xbe483f7b,0xbf04bf5c,0xbe793f78,0xbf553f0e,0x3f7b3e48,0xbf5c3f04,0x3f783e79
.long 0x3f6dbec4,0xbec4bf6d,0x3f72bea8,0xbea8bf72,0xbec4bf6d,0xbf6d3ec4,0xbea8bf72,0xbf723ea8
.long 0x3e483f7b,0x3f553f0e,0x3e023f7e,0x3f4b3f1d,0x3f7bbe48,0x3f0ebf55,0x3f7ebe02,0x3f1dbf4b
.long 0x80003f80,0x80003f80,0x80003f80,0x80003f80,0x3f800000,0x3f800000,0x3f800000,0x3f800000
.long 0x3e48bf7b,0x3f55bf0e,0x3e52bf7b,0x3f56bf0c,0xbf7bbe48,0xbf0ebf55,0xbf7bbe52,0xbf0cbf56
.long 0xbec43f6d,0xbf6dbec4,0xbecd3f6b,0xbf6bbecd,0x3f6d3ec4,0xbec43f6d,0x3f6b3ecd,0xbecd3f6b
.long 0x3f0ebf55,0x3e483f7b,0x3f14bf51,0x3e2a3f7c,0xbf55bf0e,0x3f7bbe48,0xbf51bf14,0x3f7cbe2a
.long 0xbf353f35,0x3f35bf35,0xbf3c3f2e,0x3f3cbf2e,0x3f353f35,0xbf35bf35,0x3f2e3f3c,0xbf2ebf3c
.long 0x3f55bf0e,0xbf7bbe48,0x3f5cbf04,0xbf78be79,0xbf0ebf55,0xbe483f7b,0xbf04bf5c,0xbe793f78
.long 0xbf6d3ec4,0x3ec43f6d,0xbf723ea8,0x3ea83f72,0x3ec43f6d,0x3f6dbec4,0x3ea83f72,0x3f72bea8
.long 0x3f7bbe48,0x3f0ebf55,0x3f7ebe02,0x3f1dbf4b,0xbe48bf7b,0xbf55bf0e,0xbe02bf7e,0xbf4bbf1d
.long 0x80003f80,0x80003f80,0x80003f80,0x80003f80,0x3f800000,0x3f800000,0x3f800000,0x3f800000
.long 0x3f7b3e48,0x3f0e3f55,0x3f7b3e52,0x3f0c3f56,0x3e48bf7b,0x3f55bf0e,0x3e52bf7b,0x3f56bf0c
.long 0x3ec4bf6d,0x3f6d3ec4,0x3ecdbf6b,0x3f6b3ecd,0xbf6dbec4,0x3ec4bf6d,0xbf6bbecd,0x3ecdbf6b
.long 0xbf55bf0e,0x3f7bbe48,0xbf51bf14,0x3f7cbe2a,0xbf0e3f55,0xbe48bf7b,0xbf143f51,0xbe2abf7c
.long 0xbf353f35,0x3f35bf35,0xbf3c3f2e,0x3f3cbf2e,0x3f353f35,0xbf35bf35,0x3f2e3f3c,0xbf2ebf3c
.long 0x3f0e3f55,0x3e48bf7b,0x3f043f5c,0x3e79bf78,0x3f55bf0e,0xbf7bbe48,0x3f5cbf04,0xbf78be79
.long 0x3f6dbec4,0xbec4bf6d,0x3f72bea8,0xbea8bf72,0xbec4bf6d,0xbf6d3ec4,0xbea8bf72,0xbf723ea8
.long 0xbe48bf7b,0xbf55bf0e,0xbe02bf7e,0xbf4bbf1d,0xbf7b3e48,0xbf0e3f55,0xbf7e3e02,0xbf1d3f4b
.long 0x80003f80,0x80003f80,0x80003f80,0x80003f80,0x3f800000,0x3f800000,0x3f800000,0x3f800000
.long 0xbe5b3f7a,0xbf583f0a,0xbe653f7a,0xbf593f08,0x3f7a3e5b,0x3f0a3f58,0x3f7a3e65,0x3f083f59
.long 0xbed63f68,0xbf68bed6,0xbedf3f66,0xbf66bedf,0x3f683ed6,0xbed63f68,0x3f663edf,0xbedf3f66
.long 0xbf1b3f4c,0xbe0cbf7e,0xbf203f47,0xbdddbf7f,0x3f4c3f1b,0xbf7e3e0c,0x3f473f20,0xbf7f3ddd
.long 0xbf433f26,0x3f43bf26,0xbf493f1e,0x3f49bf1e,0x3f263f43,0xbf26bf43,0x3f1e3f49,0xbf1ebf49
.long 0xbf623ef1,0x3f753e95,0xbf673edb,0x3f713eac,0x3ef13f62,0x3e95bf75,0x3edb3f67,0x3eacbf71
.long 0xbf763e8b,0x3e8b3f76,0xbf7a3e5b,0x3e5b3f7a,0x3e8b3f76,0x3f76be8b,0x3e5b3f7a,0x3f7abe5b
.long 0xbf803d71,0xbf2a3f3f,0xbf80bc21,0xbf373f33,0x3d713f80,0x3f3f3f2a,0xbc213f80,0x3f333f37
.long 0x80003f80,0x80003f80,0x80003f80,0x80003f80,0x3f800000,0x3f800000,0x3f800000,0x3f800000
.long 0xbf7abe5b,0xbf0abf58,0xbf7abe65,0xbf08bf59,0xbe5b3f7a,0xbf583f0a,0xbe653f7a,0xbf593f08
.long 0x3ed6bf68,0x3f683ed6,0x3edfbf66,0x3f663edf,0xbf68bed6,0x3ed6bf68,0xbf66bedf,0x3edfbf66
.long 0x3f4c3f1b,0xbf7e3e0c,0x3f473f20,0xbf7f3ddd,0x3f1bbf4c,0x3e0c3f7e,0x3f20bf47,0x3ddd3f7f
.long 0xbf433f26,0x3f43bf26,0xbf493f1e,0x3f49bf1e,0x3f263f43,0xbf26bf43,0x3f1e3f49,0xbf1ebf49
.long 0xbef1bf62,0xbe953f75,0xbedbbf67,0xbeac3f71,0xbf623ef1,0x3f753e95,0xbf673edb,0x3f713eac
.long 0x3f76be8b,0xbe8bbf76,0x3f7abe5b,0xbe5bbf7a,0xbe8bbf76,0xbf763e8b,0xbe5bbf7a,0xbf7a3e5b
.long 0x3d713f80,0x3f3f3f2a,0xbc213f80,0x3f333f37,0x3f80bd71,0x3f2abf3f,0x3f803c21,0x3f37bf33
.long 0x80003f80,0x80003f80,0x80003f80,0x80003f80,0x3f800000,0x3f800000,0x3f800000,0x3f800000
.long 0x3e5bbf7a,0x3f58bf0a,0x3e65bf7a,0x3f59bf08,0xbf7abe5b,0xbf0abf58,0xbf7abe65,0xbf08bf59
.long 0xbed63f68,0xbf68bed6,0xbedf3f66,0xbf66bedf,0x3f683ed6,0xbed63f68,0x3f663edf,0xbedf3f66
.long 0x3f1bbf4c,0x3e0c3f7e,0x3f20bf47,0x3ddd3f7f,0xbf4cbf1b,0x3f7ebe0c,0xbf47bf20,0x3f7fbddd
.long 0xbf433f26,0x3f43bf26,0xbf493f1e,0x3f49bf1e,0x3f263f43,0xbf26bf43,0x3f1e3f49,0xbf1ebf49
.long 0x3f62bef1,0xbf75be95,0x3f67bedb,0xbf71beac,0xbef1bf62,0xbe953f75,0xbedbbf67,0xbeac3f71
.long 0xbf763e8b,0x3e8b3f76,0xbf7a3e5b,0x3e5b3f7a,0x3e8b3f76,0x3f76be8b,0x3e5b3f7a,0x3f7abe5b
.long 0x3f80bd71,0x3f2abf3f,0x3f803c21,0x3f37bf33,0xbd71bf80,0xbf3fbf2a,0x3c21bf80,0xbf33bf37
.long 0x80003f80,0x80003f80,0x80003f80,0x80003f80,0x3f800000,0x3f800000,0x3f800000,0x3f800000
.long 0x3f7a3e5b,0x3f0a3f58,0x3f7a3e65,0x3f083f59,0x3e5bbf7a,0x3f58bf0a,0x3e65bf7a,0x3f59bf08
.long 0x3ed6bf68,0x3f683ed6,0x3edfbf66,0x3f663edf,0xbf68bed6,0x3ed6bf68,0xbf66bedf,0x3edfbf66
.long 0xbf4cbf1b,0x3f7ebe0c,0xbf47bf20,0x3f7fbddd,0xbf1b3f4c,0xbe0cbf7e,0xbf203f47,0xbdddbf7f
.long 0xbf433f26,0x3f43bf26,0xbf493f1e,0x3f49bf1e,0x3f263f43,0xbf26bf43,0x3f1e3f49,0xbf1ebf49
.long 0x3ef13f62,0x3e95bf75,0x3edb3f67,0x3eacbf71,0x3f62bef1,0xbf75be95,0x3f67bedb,0xbf71beac
.long 0x3f76be8b,0xbe8bbf76,0x3f7abe5b,0xbe5bbf7a,0xbe8bbf76,0xbf763e8b,0xbe5bbf7a,0xbf7a3e5b
.long 0xbd71bf80,0xbf3fbf2a,0x3c21bf80,0xbf33bf37,0xbf803d71,0xbf2a3f3f,0xbf80bc21,0xbf373f33
.long 0x80003f80,0x80003f80,0x80003f80,0x80003f80,0x3f800000,0x3f800000,0x3f800000,0x3f800000
.long 0xbe6f3f79,0xbf5a3f06,0xbe793f78,0xbf5c3f04,0x3f793e6f,0x3f063f5a,0x3f783e79,0x3f043f5c
.long 0xbee83f64,0xbf64bee8,0xbef13f62,0xbf62bef1,0x3f643ee8,0xbee83f64,0x3f623ef1,0xbef13f62
.long 0xbf263f43,0xbda1bf7f,0xbf2c3f3e,0xbd49bf80,0x3f433f26,0xbf7f3da1,0x3f3e3f2c,0xbf803d49
.long 0xbf4f3f16,0x3f4fbf16,0xbf553f0e,0x3f55bf0e,0x3f163f4f,0xbf16bf4f,0x3f0e3f55,0xbf0ebf55
.long 0xbf6d3ec4,0x3f6d3ec4,0xbf713eac,0x3f673edb,0x3ec43f6d,0x3ec4bf6d,0x3eac3f71,0x3edbbf67
.long 0xbf7d3e20,0x3e203f7d,0xbf7f3dc9,0x3dc93f7f,0x3e203f7d,0x3f7dbe20,0x3dc93f7f,0x3f7fbdc9
.long 0xbf7fbda1,0xbf433f26,0xbf7dbe16,0xbf4e3f18,0xbda13f7f,0x3f263f43,0xbe163f7d,0x3f183f4e
.long 0x80003f80,0x80003f80,0x80003f80,0x80003f80,0x3f800000,0x3f800000,0x3f800000,0x3f800000
.long 0xbf79be6f,0xbf06bf5a,0xbf78be79,0xbf04bf5c,0xbe6f3f79,0xbf5a3f06,0xbe793f78,0xbf5c3f04
.long 0x3ee8bf64,0x3f643ee8,0x3ef1bf62,0x3f623ef1,0xbf64bee8,0x3ee8bf64,0xbf62bef1,0x3ef1bf62
.long 0x3f433f26,0xbf7f3da1,0x3f3e3f2c,0xbf803d49,0x3f26bf43,0x3da13f7f,0x3f2cbf3e,0x3d493f80
.long 0xbf4f3f16,0x3f4fbf16,0xbf553f0e,0x3f55bf0e,0x3f163f4f,0xbf16bf4f,0x3f0e3f55,0xbf0ebf55
.long 0xbec4bf6d,0xbec43f6d,0xbeacbf71,0xbedb3f67,0xbf6d3ec4,0x3f6d3ec4,0xbf713eac,0x3f673edb
.long 0x3f7dbe20,0xbe20bf7d,0x3f7fbdc9,0xbdc9bf7f,0xbe20bf7d,0xbf7d3e20,0xbdc9bf7f,0xbf7f3dc9
.long 0xbda13f7f,0x3f263f43,0xbe163f7d,0x3f183f4e,0x3f7f3da1,0x3f43bf26,0x3f7d3e16,0x3f4ebf18
.long 0x80003f80,0x80003f80,0x80003f80,0x80003f80,0x3f800000,0x3f800000,0x3f800000,0x3f800000
.long 0x3e6fbf79,0x3f5abf06,0x3e79bf78,0x3f5cbf04,0xbf79be6f,0xbf06bf5a,0xbf78be79,0xbf04bf5c
.long 0xbee83f64,0xbf64bee8,0xbef13f62,0xbf62bef1,0x3f643ee8,0xbee83f64,0x3f623ef1,0xbef13f62
.long 0x3f26bf43,0x3da13f7f,0x3f2cbf3e,0x3d493f80,0xbf43bf26,0x3f7fbda1,0xbf3ebf2c,0x3f80bd49
.long 0xbf4f3f16,0x3f4fbf16,0xbf553f0e,0x3f55bf0e,0x3f163f4f,0xbf16bf4f,0x3f0e3f55,0xbf0ebf55
.long 0x3f6dbec4,0xbf6dbec4,0x3f71beac,0xbf67bedb,0xbec4bf6d,0xbec43f6d,0xbeacbf71,0xbedb3f67
.long 0xbf7d3e20,0x3e203f7d,0xbf7f3dc9,0x3dc93f7f,0x3e203f7d,0x3f7dbe20,0x3dc93f7f,0x3f7fbdc9
.long 0x3f7f3da1,0x3f43bf26,0x3f7d3e16,0x3f4ebf18,0x3da1bf7f,0xbf26bf43,0x3e16bf7d,0xbf18bf4e
.long 0x80003f80,0x80003f80,0x80003f80,0x80003f80,0x3f800000,0x3f800000,0x3f800000,0x3f800000
.long 0x3f793e6f,0x3f063f5a,0x3f783e79,0x3f043f5c,0x3e6fbf79,0x3f5abf06,0x3e79bf78,0x3f5cbf04
.long 0x3ee8bf64,0x3f643ee8,0x3ef1bf62,0x3f623ef1,0xbf64bee8,0x3ee8bf64,0xbf62bef1,0x3ef1bf62
.long 0xbf43bf26,0x3f7fbda1,0xbf3ebf2c,0x3f80bd49,0xbf263f43,0xbda1bf7f,0xbf2c3f3e,0xbd49bf80
.long 0xbf4f3f16,0x3f4fbf16,0xbf553f0e,0x3f55bf0e,0x3f163f4f,0xbf16bf4f,0x3f0e3f55,0xbf0ebf55
.long 0x3ec43f6d,0x3ec4bf6d,0x3eac3f71,0x3edbbf67,0x3f6dbec4,0xbf6dbec4,0x3f71beac,0xbf67bedb
.long 0x3f7dbe20,0xbe20bf7d,0x3f7fbdc9,0xbdc9bf7f,0xbe20bf7d,0xbf7d3e20,0xbdc9bf7f,0xbf7f3dc9
.long 0x3da1bf7f,0xbf26bf43,0x3e16bf7d,0xbf18bf4e,0xbf7fbda1,0xbf433f26,0xbf7dbe16,0xbf4e3f18
.long 0x80003f80,0x80003f80,0x80003f80,0x80003f80,0x3f800000,0x3f800000,0x3f800000,0x3f800000
.long 0xbe813f78,0xbf5d3f01,0xbe863f77,0xbf5e3eff,0x3f783e81,0x3f013f5d,0x3f773e86,0x3eff3f5e
.long 0xbefa3f5f,0xbf5fbefa,0xbf013f5d,0xbf5dbf01,0x3f5f3efa,0xbefa3f5f,0x3f5d3f01,0xbf013f5d
.long 0xbf313f39,0xbca1bf80,0xbf373f33,0x3c21bf80,0x3f393f31,0xbf803ca1,0x3f333f37,0xbf80bc21
.long 0xbf5a3f06,0x3f5abf06,0xbf5f3efa,0x3f5fbefa,0x3f063f5a,0xbf06bf5a,0x3efa3f5f,0xbefabf5f
.long 0xbf753e95,0x3f623ef1,0xbf783e79,0x3f5c3f04,0x3e953f75,0x3ef1bf62,0x3e793f78,0x3f04bf5c
.long 0xbf803d21,0x3d213f80,0xbf80bca1,0xbca13f80,0x3d213f80,0x3f80bd21,0xbca13f80,0x3f803ca1
.long 0xbf7abe5b,0xbf583f0a,0xbf76be90,0xbf613ef6,0xbe5b3f7a,0x3f0a3f58,0xbe903f76,0x3ef63f61
.long 0x80003f80,0x80003f80,0x80003f80,0x80003f80,0x3f800000,0x3f800000,0x3f800000,0x3f800000
.long 0xbf78be81,0xbf01bf5d,0xbf77be86,0xbeffbf5e,0xbe813f78,0xbf5d3f01,0xbe863f77,0xbf5e3eff
.long 0x3efabf5f,0x3f5f3efa,0x3f01bf5d,0x3f5d3f01,0xbf5fbefa,0x3efabf5f,0xbf5dbf01,0x3f01bf5d
.long 0x3f393f31,0xbf803ca1,0x3f333f37,0xbf80bc21,0x3f31bf39,0x3ca13f80,0x3f37bf33,0xbc213f80
.long 0xbf5a3f06,0x3f5abf06,0xbf5f3efa,0x3f5fbefa,0x3f063f5a,0xbf06bf5a,0x3efa3f5f,0xbefabf5f
.long 0xbe95bf75,0xbef13f62,0xbe79bf78,0xbf043f5c,0xbf753e95,0x3f623ef1,0xbf783e79,0x3f5c3f04
.long 0x3f80bd21,0xbd21bf80,0x3f803ca1,0x3ca1bf80,0xbd21bf80,0xbf803d21,0x3ca1bf80,0xbf80bca1
.long 0xbe5b3f7a,0x3f0a3f58,0xbe903f76,0x3ef63f61,0x3f7a3e5b,0x3f58bf0a,0x3f763e90,0x3f61bef6
.long 0x80003f80,0x80003f80,0x80003f80,0x80003f80,0x3f800000,0x3f800000,0x3f800000,0x3f800000
.long 0x3e81bf78,0x3f5dbf01,0x3e86bf77,0x3f5ebeff,0xbf78be81,0xbf01bf5d,0xbf77be86,0xbeffbf5e
.long 0xbefa3f5f,0xbf5fbefa,0xbf013f5d,0xbf5dbf01,0x3f5f3efa,0xbefa3f5f,0x3f5d3f01,0xbf013f5d
.long 0x3f31bf39,0x3ca13f80,0x3f37bf33,0xbc213f80,0xbf39bf31,0x3f80bca1,0xbf33bf37,0x3f803c21
.long 0xbf5a3f06,0x3f5abf06,0xbf5f3efa,0x3f5fbefa,0x3f063f5a,0xbf06bf5a,0x3efa3f5f,0xbefabf5f
.long 0x3f75be95,0xbf62bef1,0x3f78be79,0xbf5cbf04,0xbe95bf75,0xbef13f62,0xbe79bf78,0xbf043f5c
.long 0xbf803d21,0x3d213f80,0xbf80bca1,0xbca13f80,0x3d213f80,0x3f80bd21,0xbca13f80,0x3f803ca1
.long 0x3f7a3e5b,0x3f58bf0a,0x3f763e90,0x3f61bef6,0x3e5bbf7a,0xbf0abf58,0x3e90bf76,0xbef6bf61
.long 0x80003f80,0x80003f80,0x80003f80,0x80003f80,0x3f800000,0x3f800000,0x3f800000,0x3f800000
.long 0x3f783e81,0x3f013f5d,0x3f773e86,0x3eff3f5e,0x3e81bf78,0x3f5dbf01,0x3e86bf77,0x3f5ebeff
.long 0x3efabf5f,0x3f5f3efa,0x3f01bf5d,0x3f5d3f01,0xbf5fbefa,0x3efabf5f,0xbf5dbf01,0x3f01bf5d
.long 0xbf39bf31,0x3f80bca1,0xbf33bf37,0x3f803c21,0xbf313f39,0xbca1bf80,0xbf373f33,0x3c21bf80
.long 0xbf5a3f06,0x3f5abf06,0xbf5f3efa,0x3f5fbefa,0x3f063f5a,0xbf06bf5a,0x3efa3f5f,0xbefabf5f
.long 0x3e953f75,0x3ef1bf62,0x3e793f78,0x3f04bf5c,0x3f75be95,0xbf62bef1,0x3f78be79,0xbf5cbf04
.long 0x3f80bd21,0xbd21bf80,0x3f803ca1,0x3ca1bf80,0xbd21bf80,0xbf803d21,0x3ca1bf80,0xbf80bca1
.long 0x3e5bbf7a,0xbf0abf58,0x3e90bf76,0xbef6bf61,0xbf7abe5b,0xbf583f0a,0xbf76be90,0xbf613ef6
.long 0x80003f80,0x80003f80,0x80003f80,0x80003f80,0x3f800000,0x3f800000,0x3f800000,0x3f800000
.long 0xbe8b3f76,0xbf5f3efa,0xbe903f76,0xbf613ef6,0x3f763e8b,0x3efa3f5f,0x3f763e90,0x3ef63f61
.long 0xbf063f5a,0xbf5abf06,0xbf0a3f58,0xbf58bf0a,0x3f5a3f06,0xbf063f5a,0x3f583f0a,0xbf0a3f58
.long 0xbf3c3f2e,0x3d21bf80,0xbf413f28,0x3d8dbf7f,0x3f2e3f3c,0xbf80bd21,0x3f283f41,0xbf7fbd8d
.long 0xbf643ee8,0x3f64bee8,0xbf683ed6,0x3f68bed6,0x3ee83f64,0xbee8bf64,0x3ed63f68,0xbed6bf68
.long 0xbf7b3e48,0x3f553f0e,0xbf7d3e16,0x3f4e3f18,0x3e483f7b,0x3f0ebf55,0x3e163f7d,0x3f18bf4e
.long 0xbf7fbda1,0xbda13f7f,0xbf7ebe0c,0xbe0c3f7e,0xbda13f7f,0x3f7f3da1,0xbe0c3f7e,0x3f7e3e0c
.long 0xbf70beb1,0xbf683ed6,0xbf6abed2,0xbf6f3eb6,0xbeb13f70,0x3ed63f68,0xbed23f6a,0x3eb63f6f
.long 0x80003f80,0x80003f80,0x80003f80,0x80003f80,0x3f800000,0x3f800000,0x3f800000,0x3f800000
.long 0xbf76be8b,0xbefabf5f,0xbf76be90,0xbef6bf61,0xbe8b3f76,0xbf5f3efa,0xbe903f76,0xbf613ef6
.long 0x3f06bf5a,0x3f5a3f06,0x3f0abf58,0x3f583f0a,0xbf5abf06,0x3f06bf5a,0xbf58bf0a,0x3f0abf58
.long 0x3f2e3f3c,0xbf80bd21,0x3f283f41,0xbf7fbd8d,0x3f3cbf2e,0xbd213f80,0x3f41bf28,0xbd8d3f7f
.long 0xbf643ee8,0x3f64bee8,0xbf683ed6,0x3f68bed6,0x3ee83f64,0xbee8bf64,0x3ed63f68,0xbed6bf68
.long 0xbe48bf7b,0xbf0e3f55,0xbe16bf7d,0xbf183f4e,0xbf7b3e48,0x3f553f0e,0xbf7d3e16,0x3f4e3f18
.long 0x3f7f3da1,0x3da1bf7f,0x3f7e3e0c,0x3e0cbf7e,0x3da1bf7f,0xbf7fbda1,0x3e0cbf7e,0xbf7ebe0c
.long 0xbeb13f70,0x3ed63f68,0xbed23f6a,0x3eb63f6f,0x3f703eb1,0x3f68bed6,0x3f6a3ed2,0x3f6fbeb6
.long 0x80003f80,0x80003f80,0x80003f80,0x80003f80,0x3f800000,0x3f800000,0x3f800000,0x3f800000
.long 0x3e8bbf76,0x3f5fbefa,0x3e90bf76,0x3f61bef6,0xbf76be8b,0xbefabf5f,0xbf76be90,0xbef6bf61
.long 0xbf063f5a,0xbf5abf06,0xbf0a3f58,0xbf58bf0a,0x3f5a3f06,0xbf063f5a,0x3f583f0a,0xbf0a3f58
.long 0x3f3cbf2e,0xbd213f80,0x3f41bf28,0xbd8d3f7f,0xbf2ebf3c,0x3f803d21,0xbf28bf41,0x3f7f3d8d
.long 0xbf643ee8,0x3f64bee8,0xbf683ed6,0x3f68bed6,0x3ee83f64,0xbee8bf64,0x3ed63f68,0xbed6bf68
.long 0x3f7bbe48,0xbf55bf0e,0x3f7dbe16,0xbf4ebf18,0xbe48bf7b,0xbf0e3f55,0xbe16bf7d,0xbf183f4e
.long 0xbf7fbda1,0xbda13f7f,0xbf7ebe0c,0xbe0c3f7e,0xbda13f7f,0x3f7f3da1,0xbe0c3f7e,0x3f7e3e0c
.long 0x3f703eb1,0x3f68bed6,0x3f6a3ed2,0x3f6fbeb6,0x3eb1bf70,0xbed6bf68,0x3ed2bf6a,0xbeb6bf6f
.long 0x80003f80,0x80003f80,0x80003f80,0x80003f80,0x3f800000,0x3f800000,0x3f800000,0x3f800000
.long 0x3f763e8b,0x3efa3f5f,0x3f763e90,0x3ef63f61,0x3e8bbf76,0x3f5fbefa,0x3e90bf76,0x3f61bef6
.long 0x3f06bf5a,0x3f5a3f06,0x3f0abf58,0x3f583f0a,0xbf5abf06,0x3f06bf5a,0xbf58bf0a,0x3f0abf58
.long 0xbf2ebf3c,0x3f803d21,0xbf28bf41,0x3f7f3d8d,0xbf3c3f2e,0x3d21bf80,0xbf413f28,0x3d8dbf7f
.long 0xbf643ee8,0x3f64bee8,0xbf683ed6,0x3f68bed6,0x3ee83f64,0xbee8bf64,0x3ed63f68,0xbed6bf68
.long 0x3e483f7b,0x3f0ebf55,0x3e163f7d,0x3f18bf4e,0x3f7bbe48,0xbf55bf0e,0x3f7dbe16,0xbf4ebf18
.long 0x3f7f3da1,0x3da1bf7f,0x3f7e3e0c,0x3e0cbf7e,0x3da1bf7f,0xbf7fbda1,0x3e0cbf7e,0xbf7ebe0c
.long 0x3eb1bf70,0xbed6bf68,0x3ed2bf6a,0xbeb6bf6f,0xbf70beb1,0xbf683ed6,0xbf6abed2,0xbf6f3eb6
.long 0x80003f80,0x80003f80,0x80003f80,0x80003f80,0x3f800000,0x3f800000,0x3f800000,0x3f800000
.long 0xbe953f75,0xbf623ef1,0xbe993f74,0xbf633eed,0x3f753e95,0x3ef13f62,0x3f743e99,0x3eed3f63
.long 0xbf0e3f55,0xbf55bf0e,0xbf123f52,0xbf52bf12,0x3f553f0e,0xbf0e3f55,0x3f523f12,0xbf123f52
.long 0xbf463f22,0x3dc9bf7f,0xbf4b3f1d,0x3e02bf7e,0x3f223f46,0xbf7fbdc9,0x3f1d3f4b,0xbf7ebe02
.long 0xbf6d3ec4,0x3f6dbec4,0xbf703eb1,0x3f70beb1,0x3ec43f6d,0xbec4bf6d,0x3eb13f70,0xbeb1bf70
.long 0xbf7f3dc9,0x3f463f22,0xbf803d49,0x3f3e3f2c,0x3dc93f7f,0x3f22bf46,0x3d493f80,0x3f2cbf3e
.long 0xbf7bbe48,0xbe483f7b,0xbf78be81,0xbe813f78,0xbe483f7b,0x3f7b3e48,0xbe813f78,0x3f783e81
.long 0xbf62bef1,0xbf753e95,0xbf59bf08,0xbf7a3e65,0xbef13f62,0x3e953f75,0xbf083f59,0x3e653f7a
.long 0x80003f80,0x80003f80,0x80003f80,0x80003f80,0x3f800000,0x3f800000,0x3f800000,0x3f800000
.long 0xbf75be95,0xbef1bf62,0xbf74be99,0xbeedbf63,0xbe953f75,0xbf623ef1,0xbe993f74,0xbf633eed
.long 0x3f0ebf55,0x3f553f0e,0x3f12bf52,0x3f523f12,0xbf55bf0e,0x3f0ebf55,0xbf52bf12,0x3f12bf52
.long 0x3f223f46,0xbf7fbdc9,0x3f1d3f4b,0xbf7ebe02,0x3f46bf22,0xbdc93f7f,0x3f4bbf1d,0xbe023f7e
.long 0xbf6d3ec4,0x3f6dbec4,0xbf703eb1,0x3f70beb1,0x3ec43f6d,0xbec4bf6d,0x3eb13f70,0xbeb1bf70
.long 0xbdc9bf7f,0xbf223f46,0xbd49bf80,0xbf2c3f3e,0xbf7f3dc9,0x3f463f22,0xbf803d49,0x3f3e3f2c
.long 0x3f7b3e48,0x3e48bf7b,0x3f783e81,0x3e81bf78,0x3e48bf7b,0xbf7bbe48,0x3e81bf78,0xbf78be81
.long 0xbef13f62,0x3e953f75,0xbf083f59,0x3e653f7a,0x3f623ef1,0x3f75be95,0x3f593f08,0x3f7abe65
.long 0x80003f80,0x80003f80,0x80003f80,0x80003f80,0x3f800000,0x3f800000,0x3f800000,0x3f800000
.long 0x3e95bf75,0x3f62bef1,0x3e99bf74,0x3f63beed,0xbf75be95,0xbef1bf62,0xbf74be99,0xbeedbf63
.long 0xbf0e3f55,0xbf55bf0e,0xbf123f52,0xbf52bf12,0x3f553f0e,0xbf0e3f55,0x3f523f12,0xbf123f52
.long 0x3f46bf22,0xbdc93f7f,0x3f4bbf1d,0xbe023f7e,0xbf22bf46,0x3f7f3dc9,0xbf1dbf4b,0x3f7e3e02
.long 0xbf6d3ec4,0x3f6dbec4,0xbf703eb1,0x3f70beb1,0x3ec43f6d,0xbec4bf6d,0x3eb13f70,0xbeb1bf70
.long 0x3f7fbdc9,0xbf46bf22,0x3f80bd49,0xbf3ebf2c,0xbdc9bf7f,0xbf223f46,0xbd49bf80,0xbf2c3f3e
.long 0xbf7bbe48,0xbe483f7b,0xbf78be81,0xbe813f78,0xbe483f7b,0x3f7b3e48,0xbe813f78,0x3f783e81
.long 0x3f623ef1,0x3f75be95,0x3f593f08,0x3f7abe65,0x3ef1bf62,0xbe95bf75,0x3f08bf59,0xbe65bf7a
.long 0x80003f80,0x80003f80,0x80003f80,0x80003f80,0x3f800000,0x3f800000,0x3f800000,0x3f800000
.long 0x3f753e95,0x3ef13f62,0x3f743e99,0x3eed3f63,0x3e95bf75,0x3f62bef1,0x3e99bf74,0x3f63beed
.long 0x3f0ebf55,0x3f553f0e,0x3f12bf52,0x3f523f12,0xbf55bf0e,0x3f0ebf55,0xbf52bf12,0x3f12bf52
.long 0xbf22bf46,0x3f7f3dc9,0xbf1dbf4b,0x3f7e3e02,0xbf463f22,0x3dc9bf7f,0xbf4b3f1d,0x3e02bf7e
.long 0xbf6d3ec4,0x3f6dbec4,0xbf703eb1,0x3f70beb1,0x3ec43f6d,0xbec4bf6d,0x3eb13f70,0xbeb1bf70
.long 0x3dc93f7f,0x3f22bf46,0x3d493f80,0x3f2cbf3e,0x3f7fbdc9,0xbf46bf22,0x3f80bd49,0xbf3ebf2c
.long 0x3f7b3e48,0x3e48bf7b,0x3f783e81,0x3e81bf78,0x3e48bf7b,0xbf7bbe48,0x3e81bf78,0xbf78be81
.long 0x3ef1bf62,0xbe95bf75,0x3f08bf59,0xbe65bf7a,0xbf62bef1,0xbf753e95,0xbf59bf08,0xbf7a3e65
.long 0x80003f80,0x80003f80,0x80003f80,0x80003f80,0x3f800000,0x3f800000,0x3f800000,0x3f800000
.long 0xbe9e3f73,0xbf643ee8,0xbea33f73,0xbf653ee4,0x3f733e9e,0x3ee83f64,0x3f733ea3,0x3ee43f65
.long 0xbf163f4f,0xbf4fbf16,0xbf1b3f4c,0xbf4cbf1b,0x3f4f3f16,0xbf163f4f,0x3f4c3f1b,0xbf1b3f4c
.long 0xbf4f3f16,0x3e20bf7d,0xbf533f10,0x3e3ebf7c,0x3f163f4f,0xbf7dbe20,0x3f103f53,0xbf7cbe3e
.long 0xbf733e9e,0x3f73be9e,0xbf763e8b,0x3f76be8b,0x3e9e3f73,0xbe9ebf73,0x3e8b3f76,0xbe8bbf76
.long 0xbf80248d,0x3f353f35,0xbf80bd49,0x3f2c3f3e,0x248d3f80,0x3f35bf35,0xbd493f80,0x3f3ebf2c
.long 0xbf73be9e,0xbe9e3f73,0xbf6ebebb,0xbebb3f6e,0xbe9e3f73,0x3f733e9e,0xbebb3f6e,0x3f6e3ebb
.long 0xbf4fbf16,0xbf7d3e20,0xbf44bf24,0xbf7f3db5,0xbf163f4f,0x3e203f7d,0xbf243f44,0x3db53f7f
.long 0x80003f80,0x80003f80,0x80003f80,0x80003f80,0x3f800000,0x3f800000,0x3f800000,0x3f800000
.long 0xbf73be9e,0xbee8bf64,0xbf73bea3,0xbee4bf65,0xbe9e3f73,0xbf643ee8,0xbea33f73,0xbf653ee4
.long 0x3f16bf4f,0x3f4f3f16,0x3f1bbf4c,0x3f4c3f1b,0xbf4fbf16,0x3f16bf4f,0xbf4cbf1b,0x3f1bbf4c
.long 0x3f163f4f,0xbf7dbe20,0x3f103f53,0xbf7cbe3e,0x3f4fbf16,0xbe203f7d,0x3f53bf10,0xbe3e3f7c
.long 0xbf733e9e,0x3f73be9e,0xbf763e8b,0x3f76be8b,0x3e9e3f73,0xbe9ebf73,0x3e8b3f76,0xbe8bbf76
.long 0xa50dbf80,0xbf353f35,0x3d49bf80,0xbf3e3f2c,0xbf80250d,0x3f353f35,0xbf80bd49,0x3f2c3f3e
.long 0x3f733e9e,0x3e9ebf73,0x3f6e3ebb,0x3ebbbf6e,0x3e9ebf73,0xbf73be9e,0x3ebbbf6e,0xbf6ebebb
.long 0xbf163f4f,0x3e203f7d,0xbf243f44,0x3db53f7f,0x3f4f3f16,0x3f7dbe20,0x3f443f24,0x3f7fbdb5
.long 0x80003f80,0x80003f80,0x80003f80,0x80003f80,0x3f800000,0x3f800000,0x3f800000,0x3f800000
.long 0x3e9ebf73,0x3f64bee8,0x3ea3bf73,0x3f65bee4,0xbf73be9e,0xbee8bf64,0xbf73bea3,0xbee4bf65
.long 0xbf163f4f,0xbf4fbf16,0xbf1b3f4c,0xbf4cbf1b,0x3f4f3f16,0xbf163f4f,0x3f4c3f1b,0xbf1b3f4c
.long 0x3f4fbf16,0xbe203f7d,0x3f53bf10,0xbe3e3f7c,0xbf16bf4f,0x3f7d3e20,0xbf10bf53,0x3f7c3e3e
.long 0xbf733e9e,0x3f73be9e,0xbf763e8b,0x3f76be8b,0x3e9e3f73,0xbe9ebf73,0x3e8b3f76,0xbe8bbf76
.long 0x3f80a554,0xbf35bf35,0x3f803d49,0xbf2cbf3e,0xa554bf80,0xbf353f35,0x3d49bf80,0xbf3e3f2c
.long 0xbf73be9e,0xbe9e3f73,0xbf6ebebb,0xbebb3f6e,0xbe9e3f73,0x3f733e9e,0xbebb3f6e,0x3f6e3ebb
.long 0x3f4f3f16,0x3f7dbe20,0x3f443f24,0x3f7fbdb5,0x3f16bf4f,0xbe20bf7d,0x3f24bf44,0xbdb5bf7f
.long 0x80003f80,0x80003f80,0x80003f80,0x80003f80,0x3f800000,0x3f800000,0x3f800000,0x3f800000
.long 0x3f733e9e,0x3ee83f64,0x3f733ea3,0x3ee43f65,0x3e9ebf73,0x3f64bee8,0x3ea3bf73,0x3f65bee4
.long 0x3f16bf4f,0x3f4f3f16,0x3f1bbf4c,0x3f4c3f1b,0xbf4fbf16,0x3f16bf4f,0xbf4cbf1b,0x3f1bbf4c
.long 0xbf16bf4f,0x3f7d3e20,0xbf10bf53,0x3f7c3e3e,0xbf4f3f16,0x3e20bf7d,0xbf533f10,0x3e3ebf7c
.long 0xbf733e9e,0x3f73be9e,0xbf763e8b,0x3f76be8b,0x3e9e3f73,0xbe9ebf73,0x3e8b3f76,0xbe8bbf76
.long 0x80003f80,0x3f35bf35,0xbd493f80,0x3f3ebf2c,0x3f800000,0xbf35bf35,0x3f803d49,0xbf2cbf3e
.long 0x3f733e9e,0x3e9ebf73,0x3f6e3ebb,0x3ebbbf6e,0x3e9ebf73,0xbf73be9e,0x3ebbbf6e,0xbf6ebebb
.long 0x3f16bf4f,0xbe20bf7d,0x3f24bf44,0xbdb5bf7f,0xbf4fbf16,0xbf7d3e20,0xbf44bf24,0xbf7f3db5
.long 0x80003f80,0x80003f80,0x80003f80,0x80003f80,0x3f800000,0x3f800000,0x3f800000,0x3f800000
.long 0xbea83f72,0xbf663edf,0xbeac3f71,0xbf673edb,0x3f723ea8,0x3edf3f66,0x3f713eac,0x3edb3f67
.long 0xbf1e3f49,0xbf49bf1e,0xbf223f46,0xbf46bf22,0x3f493f1e,0xbf1e3f49,0x3f463f22,0xbf223f46
.long 0xbf583f0a,0x3e5bbf7a,0xbf5c3f04,0x3e79bf78,0x3f0a3f58,0xbf7abe5b,0x3f043f5c,0xbf78be79
.long 0xbf793e6f,0x3f79be6f,0xbf7b3e48,0x3f7bbe48,0x3e6f3f79,0xbe6fbf79,0x3e483f7b,0xbe48bf7b
.long 0xbf7fbdc9,0x3f223f46,0xbf7dbe16,0x3f183f4e,0xbdc93f7f,0x3f46bf22,0xbe163f7d,0x3f4ebf18
.long 0xbf68bed6,0xbed63f68,0xbf62bef1,0xbef13f62,0xbed63f68,0x3f683ed6,0xbef13f62,0x3f623ef1
.long 0xbf39bf31,0xbf803ca1,0xbf2cbf3e,0xbf80bd49,0xbf313f39,0x3ca13f80,0xbf3e3f2c,0xbd493f80
.long 0x80003f80,0x80003f80,0x80003f80,0x80003f80,0x3f800000,0x3f800000,0x3f800000,0x3f800000
.long 0xbf72bea8,0xbedfbf66,0xbf71beac,0xbedbbf67,0xbea83f72,0xbf663edf,0xbeac3f71,0xbf673edb
.long 0x3f1ebf49,0x3f493f1e,0x3f22bf46,0x3f463f22,0xbf49bf1e,0x3f1ebf49,0xbf46bf22,0x3f22bf46
.long 0x3f0a3f58,0xbf7abe5b,0x3f043f5c,0xbf78be79,0x3f58bf0a,0xbe5b3f7a,0x3f5cbf04,0xbe793f78
.long 0xbf793e6f,0x3f79be6f,0xbf7b3e48,0x3f7bbe48,0x3e6f3f79,0xbe6fbf79,0x3e483f7b,0xbe48bf7b
.long 0x3dc9bf7f,0xbf463f22,0x3e16bf7d,0xbf4e3f18,0xbf7fbdc9,0x3f223f46,0xbf7dbe16,0x3f183f4e
.long 0x3f683ed6,0x3ed6bf68,0x3f623ef1,0x3ef1bf62,0x3ed6bf68,0xbf68bed6,0x3ef1bf62,0xbf62bef1
.long 0xbf313f39,0x3ca13f80,0xbf3e3f2c,0xbd493f80,0x3f393f31,0x3f80bca1,0x3f2c3f3e,0x3f803d49
.long 0x80003f80,0x80003f80,0x80003f80,0x80003f80,0x3f800000,0x3f800000,0x3f800000,0x3f800000
.long 0x3ea8bf72,0x3f66bedf,0x3eacbf71,0x3f67bedb,0xbf72bea8,0xbedfbf66,0xbf71beac,0xbedbbf67
.long 0xbf1e3f49,0xbf49bf1e,0xbf223f46,0xbf46bf22,0x3f493f1e,0xbf1e3f49,0x3f463f22,0xbf223f46
.long 0x3f58bf0a,0xbe5b3f7a,0x3f5cbf04,0xbe793f78,0xbf0abf58,0x3f7a3e5b,0xbf04bf5c,0x3f783e79
.long 0xbf793e6f,0x3f79be6f,0xbf7b3e48,0x3f7bbe48,0x3e6f3f79,0xbe6fbf79,0x3e483f7b,0xbe48bf7b
.long 0x3f7f3dc9,0xbf22bf46,0x3f7d3e16,0xbf18bf4e,0x3dc9bf7f,0xbf463f22,0x3e16bf7d,0xbf4e3f18
.long 0xbf68bed6,0xbed63f68,0xbf62bef1,0xbef13f62,0xbed63f68,0x3f683ed6,0xbef13f62,0x3f623ef1
.long 0x3f393f31,0x3f80bca1,0x3f2c3f3e,0x3f803d49,0x3f31bf39,0xbca1bf80,0x3f3ebf2c,0x3d49bf80
.long 0x80003f80,0x80003f80,0x80003f80,0x80003f80,0x3f800000,0x3f800000,0x3f800000,0x3f800000
.long 0x3f723ea8,0x3edf3f66,0x3f713eac,0x3edb3f67,0x3ea8bf72,0x3f66bedf,0x3eacbf71,0x3f67bedb
.long 0x3f1ebf49,0x3f493f1e,0x3f22bf46,0x3f463f22,0xbf49bf1e,0x3f1ebf49,0xbf46bf22,0x3f22bf46
.long 0xbf0abf58,0x3f7a3e5b,0xbf04bf5c,0x3f783e79,0xbf583f0a,0x3e5bbf7a,0xbf5c3f04,0x3e79bf78
.long 0xbf793e6f,0x3f79be6f,0xbf7b3e48,0x3f7bbe48,0x3e6f3f79,0xbe6fbf79,0x3e483f7b,0xbe48bf7b
.long 0xbdc93f7f,0x3f46bf22,0xbe163f7d,0x3f4ebf18,0x3f7f3dc9,0xbf22bf46,0x3f7d3e16,0xbf18bf4e
.long 0x3f683ed6,0x3ed6bf68,0x3f623ef1,0x3ef1bf62,0x3ed6bf68,0xbf68bed6,0x3ef1bf62,0xbf62bef1
.long 0x3f31bf39,0xbca1bf80,0x3f3ebf2c,0x3d49bf80,0xbf39bf31,0xbf803ca1,0xbf2cbf3e,0xbf80bd49
.long 0x80003f80,0x80003f80,0x80003f80,0x80003f80,0x3f800000,0x3f800000,0x3f800000,0x3f800000
.long 0xbeb13f70,0xbf683ed6,0xbeb63f6f,0xbf6a3ed2,0x3f703eb1,0x3ed63f68,0x3f6f3eb6,0x3ed23f6a
.long 0xbf263f43,0xbf43bf26,0xbf2a3f3f,0xbf3fbf2a,0x3f433f26,0xbf263f43,0x3f3f3f2a,0xbf2a3f3f
.long 0xbf5f3efa,0x3e8bbf76,0xbf633eed,0x3e99bf74,0x3efa3f5f,0xbf76be8b,0x3eed3f63,0xbf74be99
.long 0xbf7d3e20,0x3f7dbe20,0xbf7e3df1,0x3f7ebdf1,0x3e203f7d,0xbe20bf7d,0x3df13f7e,0xbdf1bf7e
.long 0xbf7bbe48,0x3f0e3f55,0xbf78be79,0x3f043f5c,0xbe483f7b,0x3f55bf0e,0xbe793f78,0x3f5cbf04
.long 0xbf5abf06,0xbf063f5a,0xbf52bf12,0xbf123f52,0xbf063f5a,0x3f5a3f06,0xbf123f52,0x3f523f12
.long 0xbf1ebf49,0xbf7ebdf1,0xbf10bf53,0xbf7cbe3e,0xbf493f1e,0xbdf13f7e,0xbf533f10,0xbe3e3f7c
.long 0x80003f80,0x80003f80,0x80003f80,0x80003f80,0x3f800000,0x3f800000,0x3f800000,0x3f800000
.long 0xbf70beb1,0xbed6bf68,0xbf6fbeb6,0xbed2bf6a,0xbeb13f70,0xbf683ed6,0xbeb63f6f,0xbf6a3ed2
.long 0x3f26bf43,0x3f433f26,0x3f2abf3f,0x3f3f3f2a,0xbf43bf26,0x3f26bf43,0xbf3fbf2a,0x3f2abf3f
.long 0x3efa3f5f,0xbf76be8b,0x3eed3f63,0xbf74be99,0x3f5fbefa,0xbe8b3f76,0x3f63beed,0xbe993f74
.long 0xbf7d3e20,0x3f7dbe20,0xbf7e3df1,0x3f7ebdf1,0x3e203f7d,0xbe20bf7d,0x3df13f7e,0xbdf1bf7e
.long 0x3e48bf7b,0xbf553f0e,0x3e79bf78,0xbf5c3f04,0xbf7bbe48,0x3f0e3f55,0xbf78be79,0x3f043f5c
.long 0x3f5a3f06,0x3f06bf5a,0x3f523f12,0x3f12bf52,0x3f06bf5a,0xbf5abf06,0x3f12bf52,0xbf52bf12
.long 0xbf493f1e,0xbdf13f7e,0xbf533f10,0xbe3e3f7c,0x3f1e3f49,0x3f7e3df1,0x3f103f53,0x3f7c3e3e
.long 0x80003f80,0x80003f80,0x80003f80,0x80003f80,0x3f800000,0x3f800000,0x3f800000,0x3f800000
.long 0x3eb1bf70,0x3f68bed6,0x3eb6bf6f,0x3f6abed2,0xbf70beb1,0xbed6bf68,0xbf6fbeb6,0xbed2bf6a
.long 0xbf263f43,0xbf43bf26,0xbf2a3f3f,0xbf3fbf2a,0x3f433f26,0xbf263f43,0x3f3f3f2a,0xbf2a3f3f
.long 0x3f5fbefa,0xbe8b3f76,0x3f63beed,0xbe993f74,0xbefabf5f,0x3f763e8b,0xbeedbf63,0x3f743e99
.long 0xbf7d3e20,0x3f7dbe20,0xbf7e3df1,0x3f7ebdf1,0x3e203f7d,0xbe20bf7d,0x3df13f7e,0xbdf1bf7e
.long 0x3f7b3e48,0xbf0ebf55,0x3f783e79,0xbf04bf5c,0x3e48bf7b,0xbf553f0e,0x3e79bf78,0xbf5c3f04
.long 0xbf5abf06,0xbf063f5a,0xbf52bf12,0xbf123f52,0xbf063f5a,0x3f5a3f06,0xbf123f52,0x3f523f12
.long 0x3f1e3f49,0x3f7e3df1,0x3f103f53,0x3f7c3e3e,0x3f49bf1e,0x3df1bf7e,0x3f53bf10,0x3e3ebf7c
.long 0x80003f80,0x80003f80,0x80003f80,0x80003f80,0x3f800000,0x3f800000,0x3f800000,0x3f800000
.long 0x3f703eb1,0x3ed63f68,0x3f6f3eb6,0x3ed23f6a,0x3eb1bf70,0x3f68bed6,0x3eb6bf6f,0x3f6abed2
.long 0x3f26bf43,0x3f433f26,0x3f2abf3f,0x3f3f3f2a,0xbf43bf26,0x3f26bf43,0xbf3fbf2a,0x3f2abf3f
.long 0xbefabf5f,0x3f763e8b,0xbeedbf63,0x3f743e99,0xbf5f3efa,0x3e8bbf76,0xbf633eed,0x3e99bf74
.long 0xbf7d3e20,0x3f7dbe20,0xbf7e3df1,0x3f7ebdf1,0x3e203f7d,0xbe20bf7d,0x3df13f7e,0xbdf1bf7e
.long 0xbe483f7b,0x3f55bf0e,0xbe793f78,0x3f5cbf04,0x3f7b3e48,0xbf0ebf55,0x3f783e79,0xbf04bf5c
.long 0x3f5a3f06,0x3f06bf5a,0x3f523f12,0x3f12bf52,0x3f06bf5a,0xbf5abf06,0x3f12bf52,0xbf52bf12
.long 0x3f49bf1e,0x3df1bf7e,0x3f53bf10,0x3e3ebf7c,0xbf1ebf49,0xbf7ebdf1,0xbf10bf53,0xbf7cbe3e
.long 0x80003f80,0x80003f80,0x80003f80,0x80003f80,0x3f800000,0x3f800000,0x3f800000,0x3f800000
.long 0xbebb3f6e,0xbf6b3ecd,0xbebf3f6d,0xbf6c3ec9,0x3f6e3ebb,0x3ecd3f6b,0x3f6d3ebf,0x3ec93f6c
.long 0xbf2e3f3c,0xbf3cbf2e,0xbf313f39,0xbf39bf31,0x3f3c3f2e,0xbf2e3f3c,0x3f393f31,0xbf313f39
.long 0xbf663edf,0x3ea8bf72,0xbf6a3ed2,0x3eb6bf6f,0x3edf3f66,0xbf72bea8,0x3ed23f6a,0xbf6fbeb6
.long 0xbf7f3da1,0x3f7fbda1,0xbf803d21,0x3f80bd21,0x3da13f7f,0xbda1bf7f,0x3d213f80,0xbd21bf80
.long 0xbf75be95,0x3ef13f62,0xbf71beac,0x3edb3f67,0xbe953f75,0x3f62bef1,0xbeac3f71,0x3f67bedb
.long 0xbf49bf1e,0xbf1e3f49,0xbf3fbf2a,0xbf2a3f3f,0xbf1e3f49,0x3f493f1e,0xbf2a3f3f,0x3f3f3f2a
.long 0xbf01bf5d,0xbf78be81,0xbee4bf65,0xbf73bea3,0xbf5d3f01,0xbe813f78,0xbf653ee4,0xbea33f73
.long 0x80003f80,0x80003f80,0x80003f80,0x80003f80,0x3f800000,0x3f800000,0x3f800000,0x3f800000
.long 0xbf6ebebb,0xbecdbf6b,0xbf6dbebf,0xbec9bf6c,0xbebb3f6e,0xbf6b3ecd,0xbebf3f6d,0xbf6c3ec9
.long 0x3f2ebf3c,0x3f3c3f2e,0x3f31bf39,0x3f393f31,0xbf3cbf2e,0x3f2ebf3c,0xbf39bf31,0x3f31bf39
.long 0x3edf3f66,0xbf72bea8,0x3ed23f6a,0xbf6fbeb6,0x3f66bedf,0xbea83f72,0x3f6abed2,0xbeb63f6f
.long 0xbf7f3da1,0x3f7fbda1,0xbf803d21,0x3f80bd21,0x3da13f7f,0xbda1bf7f,0x3d213f80,0xbd21bf80
.long 0x3e95bf75,0xbf623ef1,0x3eacbf71,0xbf673edb,0xbf75be95,0x3ef13f62,0xbf71beac,0x3edb3f67
.long 0x3f493f1e,0x3f1ebf49,0x3f3f3f2a,0x3f2abf3f,0x3f1ebf49,0xbf49bf1e,0x3f2abf3f,0xbf3fbf2a
.long 0xbf5d3f01,0xbe813f78,0xbf653ee4,0xbea33f73,0x3f013f5d,0x3f783e81,0x3ee43f65,0x3f733ea3
.long 0x80003f80,0x80003f80,0x80003f80,0x80003f80,0x3f800000,0x3f800000,0x3f800000,0x3f800000
.long 0x3ebbbf6e,0x3f6bbecd,0x3ebfbf6d,0x3f6cbec9,0xbf6ebebb,0xbecdbf6b,0xbf6dbebf,0xbec9bf6c
.long 0xbf2e3f3c,0xbf3cbf2e,0xbf313f39,0xbf39bf31,0x3f3c3f2e,0xbf2e3f3c,0x3f393f31,0xbf313f39
.long 0x3f66bedf,0xbea83f72,0x3f6abed2,0xbeb63f6f,0xbedfbf66,0x3f723ea8,0xbed2bf6a,0x3f6f3eb6
.long 0xbf7f3da1,0x3f7fbda1,0xbf803d21,0x3f80bd21,0x3da13f7f,0xbda1bf7f,0x3d213f80,0xbd21bf80
.long 0x3f753e95,0xbef1bf62,0x3f713eac,0xbedbbf67,0x3e95bf75,0xbf623ef1,0x3eacbf71,0xbf673edb
.long 0xbf49bf1e,0xbf1e3f49,0xbf3fbf2a,0xbf2a3f3f,0xbf1e3f49,0x3f493f1e,0xbf2a3f3f,0x3f3f3f2a
.long 0x3f013f5d,0x3f783e81,0x3ee43f65,0x3f733ea3,0x3f5dbf01,0x3e81bf78,0x3f65bee4,0x3ea3bf73
.long 0x80003f80,0x80003f80,0x80003f80,0x80003f80,0x3f800000,0x3f800000,0x3f800000,0x3f800000
.long 0x3f6e3ebb,0x3ecd3f6b,0x3f6d3ebf,0x3ec93f6c,0x3ebbbf6e,0x3f6bbecd,0x3ebfbf6d,0x3f6cbec9
.long 0x3f2ebf3c,0x3f3c3f2e,0x3f31bf39,0x3f393f31,0xbf3cbf2e,0x3f2ebf3c,0xbf39bf31,0x3f31bf39
.long 0xbedfbf66,0x3f723ea8,0xbed2bf6a,0x3f6f3eb6,0xbf663edf,0x3ea8bf72,0xbf6a3ed2,0x3eb6bf6f
.long 0xbf7f3da1,0x3f7fbda1,0xbf803d21,0x3f80bd21,0x3da13f7f,0xbda1bf7f,0x3d213f80,0xbd21bf80
.long 0xbe953f75,0x3f62bef1,0xbeac3f71,0x3f67bedb,0x3f753e95,0xbef1bf62,0x3f713eac,0xbedbbf67
.long 0x3f493f1e,0x3f1ebf49,0x3f3f3f2a,0x3f2abf3f,0x3f1ebf49,0xbf49bf1e,0x3f2abf3f,0xbf3fbf2a
.long 0x3f5dbf01,0x3e81bf78,0x3f65bee4,0x3ea3bf73,0xbf01bf5d,0xbf78be81,0xbee4bf65,0xbf73bea3
.long 0x80003f80,0x80003f80,0x0,0x0,0x3f800000,0x3f800000,0x0,0x0
.long 0xbec43f6d,0xbf6d3ec4,0x0,0x0,0x3f6d3ec4,0x3ec43f6d,0x0,0x0
.long 0xbf353f35,0xbf35bf35,0x0,0x0,0x3f353f35,0xbf353f35,0x0,0x0
.long 0xbf6d3ec4,0x3ec4bf6d,0x0,0x0,0x3ec43f6d,0xbf6dbec4,0x0,0x0
.long 0xbf80248d,0x3f80a554,0x0,0x0,0x248d3f80,0xa554bf80,0x0,0x0
.long 0xbf6dbec4,0x3ec43f6d,0x0,0x0,0xbec43f6d,0x3f6dbec4,0x0,0x0
.long 0xbf35bf35,0xbf353f35,0x0,0x0,0xbf353f35,0x3f353f35,0x0,0x0
.long 0xbec4bf6d,0xbf6dbec4,0x0,0x0,0xbf6d3ec4,0xbec43f6d,0x0,0x0
.long 0x80003f80,0x80003f80,0x0,0x0,0x3f800000,0x3f800000,0x0,0x0
.long 0xbf6dbec4,0xbec4bf6d,0x0,0x0,0xbec43f6d,0xbf6d3ec4,0x0,0x0
.long 0x3f35bf35,0x3f353f35,0x0,0x0,0xbf35bf35,0x3f35bf35,0x0,0x0
.long 0x3ec43f6d,0xbf6dbec4,0x0,0x0,0x3f6dbec4,0xbec43f6d,0x0,0x0
.long 0xbf80248d,0x3f80a554,0x0,0x0,0x248d3f80,0xa554bf80,0x0,0x0
.long 0x3ec4bf6d,0xbf6d3ec4,0x0,0x0,0xbf6dbec4,0x3ec43f6d,0x0,0x0
.long 0x3f353f35,0x3f35bf35,0x0,0x0,0x3f35bf35,0xbf35bf35,0x0,0x0
.long 0xbf6d3ec4,0xbec43f6d,0x0,0x0,0x3ec43f6d,0x3f6d3ec4,0x0,0x0
.long 0x80003f80,0x80003f80,0x0,0x0,0x3f800000,0x3f800000,0x0,0x0
.long 0x3ec4bf6d,0x3f6dbec4,0x0,0x0,0xbf6dbec4,0xbec4bf6d,0x0,0x0
.long 0xbf353f35,0xbf35bf35,0x0,0x0,0x3f353f35,0xbf353f35,0x0,0x0
.long 0x3f6dbec4,0xbec43f6d,0x0,0x0,0xbec4bf6d,0x3f6d3ec4,0x0,0x0
.long 0xbf80248d,0x3f80a554,0x0,0x0,0x248d3f80,0xa554bf80,0x0,0x0
.long 0x3f6d3ec4,0xbec4bf6d,0x0,0x0,0x3ec4bf6d,0xbf6d3ec4,0x0,0x0
.long 0xbf35bf35,0xbf353f35,0x0,0x0,0xbf353f35,0x3f353f35,0x0,0x0
.long 0x3ec43f6d,0x3f6d3ec4,0x0,0x0,0x3f6dbec4,0x3ec4bf6d,0x0,0x0
.long 0x80003f80,0x80003f80,0x0,0x0,0x3f800000,0x3f800000,0x0,0x0
.long 0x3f6d3ec4,0x3ec43f6d,0x0,0x0,0x3ec4bf6d,0x3f6dbec4,0x0,0x0
.long 0x3f35bf35,0x3f353f35,0x0,0x0,0xbf35bf35,0x3f35bf35,0x0,0x0
.long 0xbec4bf6d,0x3f6d3ec4,0x0,0x0,0xbf6d3ec4,0x3ec4bf6d,0x0,0x0
.long 0xbf80248d,0x3f80a554,0x0,0x0,0x248d3f80,0xa554bf80,0x0,0x0
.long 0xbec43f6d,0x3f6dbec4,0x0,0x0,0x3f6d3ec4,0xbec4bf6d,0x0,0x0
.long 0x3f353f35,0x3f35bf35,0x0,0x0,0x3f35bf35,0xbf35bf35,0x0,0x0
.long 0x3f6dbec4,0x3ec4bf6d,0x0,0x0,0xbec4bf6d,0xbf6dbec4,0x0,0x0
.long 0x0,0x0,0x0,0x0,0x0,0x0,0x0,0x0
.long 0x0,0x0,0x0,0x0,0x0,0x0,0x0,0x0
.long 0x0,0x0,0x0,0x0,0x0,0x0,0x0,0x0
.long 0x0,0x0,0x0,0x0,0x0,0x0,0x0,0x0
.long 0x0,0x0,0x0,0x0,0x0,0x0,0x0,0x0
.long 0x0,0x0,0x0,0x0,0x0,0x0,0x0,0x0
.long 0x0,0x0,0x0,0x0,0x0,0x0,0x0,0x0
.long 0x0,0x0,0x0,0x0,0x0,0x0,0x0,0x0
.long 0x0,0x0,0x0,0x0,0x0,0x0,0x0,0x0
.long 0x0,0x0,0x0,0x0,0x0,0x0,0x0,0x0
.long 0x0,0x0,0x0,0x0,0x0,0x0,0x0,0x0
.long 0x0,0x0,0x0,0x0,0x0,0x0,0x0,0x0
.long 0x0,0x0,0x0,0x0,0x0,0x0,0x0,0x0
.long 0x0,0x0,0x0,0x0,0x0,0x0,0x0,0x0
.long 0x0,0x0,0x0,0x0,0x0,0x0,0x0,0x0
.long 0x0,0x0,0x0,0x0,0x0,0x0,0x0,0x0
.long 0x0,0x0,0x0,0x0,0x0,0x0,0x0,0x0
.long 0x0,0x0,0x0,0x0,0x0,0x0,0x0,0x0
.long 0x0,0x0,0x0,0x0,0x0,0x0,0x0,0x0
.long 0x0,0x0,0x0,0x0,0x0,0x0,0x0,0x0
.long 0x0,0x0,0x0,0x0,0x0,0x0,0x0,0x0
.long 0x0,0x0,0x0,0x0,0x0,0x0,0x0,0x0
.long 0x0,0x0,0x0,0x0,0x0,0x0,0x0,0x0
.long 0x0,0x0,0x0,0x0,0x0,0x0,0x0,0x0
.long 0x0,0x0,0x0,0x0,0x0,0x0,0x0,0x0
.long 0x0,0x0,0x0,0x0,0x0,0x0,0x0,0x0
.long 0x0,0x0,0x0,0x0,0x0,0x0,0x0,0x0
.long 0x0,0x0,0x0,0x0,0x0,0x0,0x0,0x0
.long 0x0,0x0,0x0,0x0,0x0,0x0,0x0,0x0
.long 0x0,0x0,0x0,0x0,0x0,0x0,0x0,0x0
.long 0x0,0x0,0x0,0x0,0x0,0x0,0x0,0x0
.long 0x0,0x0,0x0,0x0,0x0,0x0,0x0,0x0
.p2align 8
tab_G80I:
.long 0x3f80,0x80004000,0x80004000,0x80004000,0x3f80,0xbe213fff,0xbea03ffd,0xbeef3ff9
.long 0x3f80,0xbea03ffd,0xbf1e3ff3,0xbf683fe4,0x3f80,0xbeef3ff9,0xbf683fe4,0xbfa63fc3
.long 0x3f80,0xbf1e3ff3,0xbf963fcf,0xbfcf3f96,0x3f80,0xbf443fed,0xbfb53fb5,0xbfed3f44
.long 0x3f80,0xbf683fe4,0xbfcf3f96,0xbffd3ea0,0x3f80,0xbf863fda,0xbfe43f68,0xbfffbe21
.long 0x3f80,0xbf963fcf,0xbff33f1e,0xbff3bf1e,0x3f80,0xbfa63fc3,0xbffd3ea0,0xbfdabf86
.long 0x3f80,0xbfb53fb5,0xc000250d,0xbfb5bfb5,0x3f80,0xbfc33fa6,0xbffdbea0,0xbf86bfda
.long 0x3f80,0xbfcf3f96,0xbff3bf1e,0xbf1ebff3,0x3f80,0xbfda3f86,0xbfe4bf68,0xbe21bfff
.long 0x3f80,0xbfe43f68,0xbfcfbf96,0x3ea0bffd,0x3f80,0xbfed3f44,0xbfb5bfb5,0x3f44bfed
.long 0x80004000,0x80004000,0x80004000,0x80004000,0xbf1e3ff3,0xbf443fed,0xbf683fe4,0xbf863fda
.long 0xbf963fcf,0xbfb53fb5,0xbfcf3f96,0xbfe43f68,0xbfcf3f96,0xbfed3f44,0xbffd3ea0,0xbfffbe21
.long 0xbff33f1e,0xc000250d,0xbff3bf1e,0xbfcfbf96,0xc000250d,0xbfedbf44,0xbfb5bfb5,0xbf44bfed
.long 0xbff3bf1e,0xbfb5bfb5,0xbf1ebff3,0x3ea0bffd,0xbfcfbf96,0xbf44bfed,0x3ea0bffd,0x3fa6bfc3
.long 0xbf96bfcf,0xa58dc000,0x3f96bfcf,0x3ff3bf1e,0xbf1ebff3,0x3f44bfed,0x3fe4bf68,0x3ff93eef
.long 0xa58dc000,0x3fb5bfb5,0x4000a5d4,0x3fb53fb5,0x3f1ebff3,0x3fedbf44,0x3fe43f68,0x3eef3ff9
.long 0x3f96bfcf,0x4000a5d4,0x3f963fcf,0xbf1e3ff3,0x3fcfbf96,0x3fed3f44,0x3ea03ffd,0xbfc33fa6
.long 0x3ff3bf1e,0x3fb53fb5,0xbf1e3ff3,0xbffd3ea0,0x4000a5d4,0x3f443fed,0xbfb53fb5,0xbfedbf44
.long 0x80004000,0x80004000,0x80004000,0x80004000,0xbf963fcf,0xbfa63fc3,0xbfb53fb5,0xbfc33fa6
.long 0xbff33f1e,0xbffd3ea0,0xc000250d,0xbffdbea0,0xbff3bf1e,0xbfdabf86,0xbfb5bfb5,0xbf86bfda
.long 0xbf96bfcf,0xbf1ebff3,0xa58dc000,0x3f1ebff3,0xa58dc000,0x3f44bfed,0x3fb5bfb5,0x3fedbf44
.long 0x3f96bfcf,0x3fe4bf68,0x4000a5d4,0x3fe43f68,0x3ff3bf1e,0x3ff93eef,0x3fb53fb5,0x3eef3ff9
.long 0x3ff33f1e,0x3f963fcf,0x80004000,0xbf963fcf,0x3f963fcf,0xbe213fff,0xbfb53fb5,0xbfff3e21
.long 0x80004000,0xbfb53fb5,0xc000250d,0xbfb5bfb5,0xbf963fcf,0xbfff3e21,0xbfb5bfb5,0x3e21bfff
.long 0xbff33f1e,0xbfcfbf96,0xa58dc000,0x3fcfbf96,0xbff3bf1e,0xbeefbff9,0x3fb5bfb5,0x3ff93eef
.long 0xbf96bfcf,0x3f68bfe4,0x4000a5d4,0x3f683fe4,0xa58dc000,0x3fedbf44,0x3fb53fb5,0xbf443fed
.long 0x80004000,0x80004000,0x80004000,0x80004000,0xbfcf3f96,0xbfda3f86,0xbfe43f68,0xbfed3f44
.long 0xbff3bf1e,0xbfe4bf68,0xbfcfbf96,0xbfb5bfb5,0xbf1ebff3,0xbe21bfff,0x3ea0bffd,0x3f44bfed
.long 0x3f96bfcf,0x3fcfbf96,0x3ff3bf1e,0x4000a5d4,0x4000a5d4,0x3fed3f44,0x3fb53fb5,0x3f443fed
.long 0x3f963fcf,0x3ea03ffd,0xbf1e3ff3,0xbfb53fb5,0xbf1e3ff3,0xbfc33fa6,0xbffd3ea0,0xbfedbf44
.long 0xbff33f1e,0xbff3bf1e,0xbf96bfcf,0xa58dc000,0xbfcfbf96,0xbeefbff9,0x3f68bfe4,0x3fedbf44
.long 0xa58dc000,0x3fb5bfb5,0x4000a5d4,0x3fb53fb5,0x3fcfbf96,0x3ff93eef,0x3f683fe4,0xbf443fed
.long 0x3ff33f1e,0x3f1e3ff3,0xbf963fcf,0xc000250d,0x3f1e3ff3,0xbfa63fc3,0xbffdbea0,0xbf44bfed
.long 0xbf963fcf,0xbffdbea0,0xbf1ebff3,0x3fb5bfb5,0xc000250d,0xbf44bfed,0x3fb5bfb5,0x3fed3f44
.long 0x80004000,0x80004000,0x80004000,0x80004000,0xbff33f1e,0xbff93eef,0xbffd3ea0,0xbfff3e21
.long 0xbf96bfcf,0xbf68bfe4,0xbf1ebff3,0xbea0bffd,0x3f96bfcf,0x3fc3bfa6,0x3fe4bf68,0x3ff9beef
.long 0x3ff33f1e,0x3fcf3f96,0x3f963fcf,0x3f1e3ff3,0x80004000,0xbf443fed,0xbfb53fb5,0xbfed3f44
.long 0xbff33f1e,0xbffdbea0,0xbfcfbf96,0xbf68bfe4,0xbf96bfcf,0xbe21bfff,0x3f68bfe4,0x3fdabf86
.long 0x3f96bfcf,0x3ff3bf1e,0x3ff33f1e,0x3f963fcf,0x3ff33f1e,0x3f863fda,0xbea03ffd,0xbfc33fa6
.long 0x80004000,0xbfb53fb5,0xc000250d,0xbfb5bfb5,0xbff33f1e,0xbfdabf86,0xbea0bffd,0x3fa6bfc3
.long 0xbf96bfcf,0x3f1ebff3,0x3ff3bf1e,0x3fcf3f96,0x3f96bfcf,0x3fff3e21,0x3f683fe4,0xbf863fda
.long 0x3ff33f1e,0x3ea03ffd,0xbfcf3f96,0xbfe4bf68,0x80004000,0xbfed3f44,0xbfb5bfb5,0x3f44bfed
.long 0x80004000,0x80004000,0x80004000,0x80004000,0xc000250d,0xbfffbe21,0xbffdbea0,0xbff9beef
.long 0xa58dc000,0x3ea0bffd,0x3f1ebff3,0x3f68bfe4,0x4000a5d4,0x3ff93eef,0x3fe43f68,0x3fc33fa6
.long 0x80004000,0xbf1e3ff3,0xbf963fcf,0xbfcf3f96,0xc000250d,0xbfedbf44,0xbfb5bfb5,0xbf44bfed
.long 0xa58dc000,0x3f68bfe4,0x3fcfbf96,0x3ffdbea0,0x4000a5d4,0x3fda3f86,0x3f683fe4,0xbe213fff
.long 0x80004000,0xbf963fcf,0xbff33f1e,0xbff3bf1e,0xc000250d,0xbfc3bfa6,0xbea0bffd,0x3f86bfda
.long 0xa58dc000,0x3fb5bfb5,0x4000a5d4,0x3fb53fb5,0x4000a5d4,0x3fa63fc3,0xbea03ffd,0xbfda3f86
.long 0x80004000,0xbfcf3f96,0xbff3bf1e,0xbf1ebff3,0xc000250d,0xbf86bfda,0x3f68bfe4,0x3fffbe21
.long 0xa58dc000,0x3fe4bf68,0x3fcf3f96,0xbea03ffd,0x4000a5d4,0x3f443fed,0xbfb53fb5,0xbfedbf44
.long 0x80004000,0x80004000,0x80004000,0x80004000,0xbff3bf1e,0xbfedbf44,0xbfe4bf68,0xbfdabf86
.long 0x3f96bfcf,0x3fb5bfb5,0x3fcfbf96,0x3fe4bf68,0x3f963fcf,0x3f443fed,0x3ea03ffd,0xbe213fff
.long 0xbff33f1e,0xc000250d,0xbff3bf1e,0xbfcfbf96,0xa58dc000,0x3f44bfed,0x3fb5bfb5,0x3fedbf44
.long 0x3ff33f1e,0x3fb53fb5,0x3f1e3ff3,0xbea03ffd,0xbf963fcf,0xbfed3f44,0xbffdbea0,0xbfc3bfa6
.long 0xbf96bfcf,0xa58dc000,0x3f96bfcf,0x3ff3bf1e,0x3ff3bf1e,0x3fed3f44,0x3f683fe4,0xbeef3ff9
.long 0x80004000,0xbfb53fb5,0xc000250d,0xbfb5bfb5,0xbff3bf1e,0xbf44bfed,0x3f68bfe4,0x3ff9beef
.long 0x3f96bfcf,0x4000a5d4,0x3f963fcf,0xbf1e3ff3,0x3f963fcf,0xbf443fed,0xbffd3ea0,0xbfa6bfc3
.long 0xbff33f1e,0xbfb5bfb5,0x3f1ebff3,0x3ffdbea0,0xa58dc000,0x3fedbf44,0x3fb53fb5,0xbf443fed
.long 0x80004000,0x80004000,0x80004000,0x80004000,0xbfcfbf96,0xbfc3bfa6,0xbfb5bfb5,0xbfa6bfc3
.long 0x3ff3bf1e,0x3ffdbea0,0x4000a5d4,0x3ffd3ea0,0xbf1e3ff3,0xbf863fda,0xbfb53fb5,0xbfda3f86
.long 0xbf96bfcf,0xbf1ebff3,0xa58dc000,0x3f1ebff3,0x4000a5d4,0x3fed3f44,0x3fb53fb5,0x3f443fed
.long 0xbf963fcf,0xbfe43f68,0xc000250d,0xbfe4bf68,0xbf1ebff3,0x3eefbff9,0x3fb5bfb5,0x3ff9beef
.long 0x3ff33f1e,0x3f963fcf,0x80004000,0xbf963fcf,0xbfcf3f96,0xbfffbe21,0xbfb5bfb5,0xbe21bfff
.long 0xa58dc000,0x3fb5bfb5,0x4000a5d4,0x3fb53fb5,0x3fcf3f96,0x3e213fff,0xbfb53fb5,0xbfffbe21
.long 0xbff33f1e,0xbfcfbf96,0xa58dc000,0x3fcfbf96,0x3f1ebff3,0x3ff9beef,0x3fb53fb5,0xbeef3ff9
.long 0x3f963fcf,0xbf683fe4,0xc000250d,0xbf68bfe4,0xc000250d,0xbf44bfed,0x3fb5bfb5,0x3fed3f44
.long 0x80004000,0x80004000,0x80004000,0x80004000,0xbf96bfcf,0xbf86bfda,0xbf68bfe4,0xbf44bfed
.long 0x3ff33f1e,0x3fe43f68,0x3fcf3f96,0x3fb53fb5,0xbff33f1e,0xbfff3e21,0xbffdbea0,0xbfedbf44
.long 0x3f96bfcf,0x3fcfbf96,0x3ff3bf1e,0x4000a5d4,0x80004000,0xbf443fed,0xbfb53fb5,0xbfed3f44
.long 0xbf96bfcf,0xbea0bffd,0x3f1ebff3,0x3fb5bfb5,0x3ff33f1e,0x3fa63fc3,0x3ea03ffd,0xbf443fed
.long 0xbff33f1e,0xbff3bf1e,0xbf96bfcf,0xa58dc000,0x3f96bfcf,0x3ff9beef,0x3fe43f68,0x3f443fed
.long 0x80004000,0xbfb53fb5,0xc000250d,0xbfb5bfb5,0xbf96bfcf,0x3eefbff9,0x3fe4bf68,0x3fed3f44
.long 0x3ff33f1e,0x3f1e3ff3,0xbf963fcf,0xc000250d,0xbff33f1e,0xbfc3bfa6,0x3ea0bffd,0x3fedbf44
.long 0x3f96bfcf,0x3ffd3ea0,0x3f1e3ff3,0xbfb53fb5,0x80004000,0xbfed3f44,0xbfb5bfb5,0x3f44bfed
.long 0x80004000,0x80004000,0x80004000,0x80004000,0xbf1ebff3,0xbeefbff9,0xbea0bffd,0xbe21bfff
.long 0x3f963fcf,0x3f683fe4,0x3f1e3ff3,0x3ea03ffd,0xbfcfbf96,0xbfa6bfc3,0xbf68bfe4,0xbeefbff9
.long 0x3ff33f1e,0x3fcf3f96,0x3f963fcf,0x3f1e3ff3,0xc000250d,0xbfedbf44,0xbfb5bfb5,0xbf44bfed
.long 0x3ff3bf1e,0x3ffd3ea0,0x3fcf3f96,0x3f683fe4,0xbfcf3f96,0xbfff3e21,0xbfe4bf68,0xbf86bfda
.long 0x3f96bfcf,0x3ff3bf1e,0x3ff33f1e,0x3f963fcf,0xbf1e3ff3,0xbfda3f86,0xbffdbea0,0xbfa6bfc3
.long 0xa58dc000,0x3fb5bfb5,0x4000a5d4,0x3fb53fb5,0x3f1e3ff3,0xbf863fda,0xbffd3ea0,0xbfc3bfa6
.long 0xbf96bfcf,0x3f1ebff3,0x3ff3bf1e,0x3fcf3f96,0x3fcf3f96,0xbe213fff,0xbfe43f68,0xbfdabf86
.long 0xbff3bf1e,0xbea0bffd,0x3fcfbf96,0x3fe43f68,0x4000a5d4,0x3f443fed,0xbfb53fb5,0xbfedbf44
.long 0x3f80,0x0,0x0,0x0,0xbf80,0x0,0x0,0x0
.long 0x3f80,0x0,0x0,0x0,0xbf80,0x0,0x0,0x0
.long 0x3f80,0x0,0x0,0x0,0xbf80,0x0,0x0,0x0
.long 0x3f80,0x0,0x0,0x0,0xbf80,0x0,0x0,0x0
.long 0x3f80,0x0,0x0,0x0,0xbf80,0x0,0x0,0x0
.long 0x3f80,0x0,0x0,0x0,0xbf80,0x0,0x0,0x0
.long 0x3f80,0x0,0x0,0x0,0xbf80,0x0,0x0,0x0
.long 0x3f80,0x0,0x0,0x0,0xbf80,0x0,0x0,0x0
.long 0x0,0x0,0x0,0x0,0x0,0x0,0x0,0x0
.long 0x0,0x0,0x0,0x0,0x0,0x0,0x0,0x0
.long 0x0,0x0,0x0,0x0,0x0,0x0,0x0,0x0
.long 0x0,0x0,0x0,0x0,0x0,0x0,0x0,0x0
.long 0x0,0x0,0x0,0x0,0x0,0x0,0x0,0x0
.long 0x0,0x0,0x0,0x0,0x0,0x0,0x0,0x0
.long 0x0,0x0,0x0,0x0,0x0,0x0,0x0,0x0
.long 0x0,0x0,0x0,0x0,0x0,0x0,0x0,0x0
.long 0x3f80,0xbff33f1e,0xbf96bfcf,0x3f96bfcf,0x3f80,0xbff93eef,0xbf68bfe4,0x3fc3bfa6
.long 0x3f80,0xbffd3ea0,0xbf1ebff3,0x3fe4bf68,0x3f80,0xbfff3e21,0xbea0bffd,0x3ff9beef
.long 0x3f80,0xc000250d,0xa58dc000,0x4000a5d4,0x3f80,0xbfffbe21,0x3ea0bffd,0x3ff93eef
.long 0x3f80,0xbffdbea0,0x3f1ebff3,0x3fe43f68,0x3f80,0xbff9beef,0x3f68bfe4,0x3fc33fa6
.long 0x3f80,0xbff3bf1e,0x3f96bfcf,0x3f963fcf,0x3f80,0xbfedbf44,0x3fb5bfb5,0x3f443fed
.long 0x3f80,0xbfe4bf68,0x3fcfbf96,0x3ea03ffd,0x3f80,0xbfdabf86,0x3fe4bf68,0xbe213fff
.long 0x3f80,0xbfcfbf96,0x3ff3bf1e,0xbf1e3ff3,0x3f80,0xbfc3bfa6,0x3ffdbea0,0xbf863fda
.long 0x3f80,0xbfb5bfb5,0x4000a5d4,0xbfb53fb5,0x3f80,0xbfa6bfc3,0x3ffd3ea0,0xbfda3f86
.long 0x3ff33f1e,0x80004000,0xbff33f1e,0xbf96bfcf,0x3fcf3f96,0xbf443fed,0xbffdbea0,0xbe21bfff
.long 0x3f963fcf,0xbfb53fb5,0xbfcfbf96,0x3f68bfe4,0x3f1e3ff3,0xbfed3f44,0xbf68bfe4,0x3fdabf86
.long 0x80004000,0xc000250d,0xa58dc000,0x4000a5d4,0xbf1e3ff3,0xbfedbf44,0x3f68bfe4,0x3fda3f86
.long 0xbf963fcf,0xbfb5bfb5,0x3fcfbf96,0x3f683fe4,0xbfcf3f96,0xbf44bfed,0x3ffdbea0,0xbe213fff
.long 0xbff33f1e,0xa58dc000,0x3ff33f1e,0xbf963fcf,0xc000250d,0x3f44bfed,0x3fb53fb5,0xbfed3f44
.long 0xbff3bf1e,0x3fb5bfb5,0x3f1e3ff3,0xbffdbea0,0xbfcfbf96,0x3fedbf44,0xbea03ffd,0xbfc3bfa6
.long 0xbf96bfcf,0x4000a5d4,0xbf963fcf,0xbf1ebff3,0xbf1ebff3,0x3fed3f44,0xbfe43f68,0x3eefbff9
.long 0xa58dc000,0x3fb53fb5,0xc000250d,0x3fb5bfb5,0x3f1ebff3,0x3f443fed,0xbfe4bf68,0x3ff9beef
.long 0x3f96bfcf,0x3ff33f1e,0x80004000,0xbff33f1e,0x3ff3bf1e,0x3f863fda,0xbfb53fb5,0xbfdabf86
.long 0x3ff33f1e,0xbea03ffd,0xc000250d,0xbea0bffd,0x3f963fcf,0xbfc33fa6,0xbfb5bfb5,0x3fa6bfc3
.long 0x80004000,0xc000250d,0xa58dc000,0x4000a5d4,0xbf963fcf,0xbfc3bfa6,0x3fb5bfb5,0x3fa63fc3
.long 0xbff33f1e,0xbea0bffd,0x4000a5d4,0xbea03ffd,0xbff3bf1e,0x3f86bfda,0x3fb53fb5,0xbfda3f86
.long 0xbf96bfcf,0x3ff3bf1e,0x80004000,0xbff3bf1e,0xa58dc000,0x3fed3f44,0xbfb53fb5,0xbf44bfed
.long 0x3f96bfcf,0x3f683fe4,0xc000250d,0x3f68bfe4,0x3ff3bf1e,0xbeef3ff9,0xbfb5bfb5,0x3ff9beef
.long 0x3ff33f1e,0xbfcf3f96,0xa58dc000,0x3fcf3f96,0x3f963fcf,0xbfffbe21,0x3fb5bfb5,0x3e213fff
.long 0x80004000,0xbfb5bfb5,0x4000a5d4,0xbfb53fb5,0xbf963fcf,0xbe21bfff,0x3fb53fb5,0xbfffbe21
.long 0xbf96bfcf,0x3f96bfcf,0x3ff33f1e,0x80004000,0x3f1ebff3,0x3fff3e21,0x3ea03ffd,0xbfed3f44
.long 0x3ff3bf1e,0x3f683fe4,0xbfcf3f96,0xbfb5bfb5,0x3fcf3f96,0xbf863fda,0xbfe4bf68,0x3f44bfed
.long 0x80004000,0xc000250d,0xa58dc000,0x4000a5d4,0xbfcf3f96,0xbf86bfda,0x3fe4bf68,0x3f443fed
.long 0xbff3bf1e,0x3f68bfe4,0x3fcf3f96,0xbfb53fb5,0xbf1ebff3,0x3fffbe21,0xbea03ffd,0xbfedbf44
.long 0x3f96bfcf,0x3f963fcf,0xbff33f1e,0xa58dc000,0x4000a5d4,0xbf443fed,0xbfb5bfb5,0x3fedbf44
.long 0x3f963fcf,0xbffd3ea0,0x3f1ebff3,0x3fb53fb5,0xbf1e3ff3,0xbfa6bfc3,0x3ffdbea0,0xbf443fed
.long 0xbff33f1e,0x3f1ebff3,0x3f963fcf,0xc000250d,0xbfcfbf96,0x3ff9beef,0xbf683fe4,0xbf44bfed
.long 0xa58dc000,0x3fb53fb5,0xc000250d,0x3fb5bfb5,0x3fcfbf96,0xbeef3ff9,0xbf68bfe4,0x3fed3f44
.long 0xbff33f1e,0xbf96bfcf,0x3f96bfcf,0x3ff33f1e,0xbf96bfcf,0x3fa6bfc3,0x3fe43f68,0xbeef3ff9
.long 0x3f96bfcf,0x3fe43f68,0xbf1e3ff3,0xbffdbea0,0x3ff33f1e,0xbeef3ff9,0xbffdbea0,0x3e21bfff
.long 0x80004000,0xc000250d,0xa58dc000,0x4000a5d4,0xbff33f1e,0xbeefbff9,0x3ffdbea0,0x3e213fff
.long 0xbf96bfcf,0x3fe4bf68,0x3f1e3ff3,0xbffd3ea0,0x3f96bfcf,0x3fa63fc3,0xbfe43f68,0xbeefbff9
.long 0x3ff33f1e,0xbf963fcf,0xbf96bfcf,0x3ff3bf1e,0x80004000,0xbfedbf44,0x3fb5bfb5,0x3f443fed
.long 0xbff33f1e,0x3ea0bffd,0x3fcf3f96,0xbfe43f68,0xbf96bfcf,0x3fffbe21,0xbf683fe4,0xbf86bfda
.long 0x3f96bfcf,0x3f1e3ff3,0xbff3bf1e,0x3fcfbf96,0x3ff33f1e,0xbfda3f86,0x3ea0bffd,0x3fa63fc3
.long 0x80004000,0xbfb5bfb5,0x4000a5d4,0xbfb53fb5,0xbff33f1e,0x3f86bfda,0x3ea03ffd,0xbfc3bfa6
.long 0x80004000,0xbff33f1e,0xbf96bfcf,0x3f96bfcf,0xc000250d,0xbeefbff9,0x3fe4bf68,0x3fa63fc3
.long 0xa58dc000,0x3ffdbea0,0x3f1e3ff3,0xbfe43f68,0x4000a5d4,0x3e213fff,0xbffd3ea0,0xbeefbff9
.long 0x80004000,0xc000250d,0xa58dc000,0x4000a5d4,0xc000250d,0x3e21bfff,0x3ffd3ea0,0xbeef3ff9
.long 0xa58dc000,0x3ffd3ea0,0xbf1e3ff3,0xbfe4bf68,0x4000a5d4,0xbeef3ff9,0xbfe4bf68,0x3fa6bfc3
.long 0x80004000,0xbff3bf1e,0x3f96bfcf,0x3f963fcf,0xc000250d,0x3f44bfed,0x3fb53fb5,0xbfed3f44
.long 0xa58dc000,0x3fe43f68,0xbfcf3f96,0xbea0bffd,0x4000a5d4,0xbf863fda,0xbf68bfe4,0x3fff3e21
.long 0x80004000,0xbfcfbf96,0x3ff3bf1e,0xbf1e3ff3,0xc000250d,0x3fa6bfc3,0x3ea03ffd,0xbfdabf86
.long 0xa58dc000,0x3fb53fb5,0xc000250d,0x3fb5bfb5,0x4000a5d4,0xbfc33fa6,0x3ea0bffd,0x3f863fda
.long 0x3ff33f1e,0x80004000,0xbff33f1e,0xbf96bfcf,0xbf963fcf,0xbfedbf44,0x3ea0bffd,0x3fffbe21
.long 0xbf96bfcf,0x3fb5bfb5,0x3fcf3f96,0xbf683fe4,0x3ff3bf1e,0x3f443fed,0xbfe43f68,0xbf86bfda
.long 0x80004000,0xc000250d,0xa58dc000,0x4000a5d4,0xbff3bf1e,0x3f44bfed,0x3fe43f68,0xbf863fda
.long 0x3f96bfcf,0x3fb53fb5,0xbfcf3f96,0xbf68bfe4,0x3f963fcf,0xbfed3f44,0xbea0bffd,0x3fff3e21
.long 0xbff33f1e,0xa58dc000,0x3ff33f1e,0xbf963fcf,0xa58dc000,0x3fed3f44,0xbfb53fb5,0xbf44bfed
.long 0x3ff33f1e,0xbfb53fb5,0xbf1ebff3,0x3ffd3ea0,0xbf963fcf,0xbf44bfed,0x3ffd3ea0,0xbfa63fc3
.long 0xbf96bfcf,0x4000a5d4,0xbf963fcf,0xbf1ebff3,0x3ff3bf1e,0xbf443fed,0xbf68bfe4,0x3ff93eef
.long 0x80004000,0xbfb5bfb5,0x4000a5d4,0xbfb53fb5,0xbff3bf1e,0x3fedbf44,0xbf683fe4,0xbeefbff9
.long 0x3f96bfcf,0x3ff33f1e,0x80004000,0xbff33f1e,0x3f1e3ff3,0xbfda3f86,0xbfb5bfb5,0x3f86bfda
.long 0xbff3bf1e,0x3ea0bffd,0x4000a5d4,0x3ea03ffd,0x3fcfbf96,0x3fa63fc3,0xbfb53fb5,0xbfc3bfa6
.long 0x80004000,0xc000250d,0xa58dc000,0x4000a5d4,0xbfcfbf96,0x3fa6bfc3,0x3fb53fb5,0xbfc33fa6
.long 0x3ff3bf1e,0x3ea03ffd,0xc000250d,0x3ea0bffd,0xbf1e3ff3,0xbfdabf86,0x3fb5bfb5,0x3f863fda
.long 0xbf96bfcf,0x3ff3bf1e,0x80004000,0xbff3bf1e,0x4000a5d4,0xbf443fed,0xbfb5bfb5,0x3fedbf44
.long 0xbf963fcf,0xbf68bfe4,0x4000a5d4,0xbf683fe4,0xbf1ebff3,0x3ff93eef,0xbfb53fb5,0xbeefbff9
.long 0x3ff33f1e,0xbfcf3f96,0xa58dc000,0x3fcf3f96,0xbfcf3f96,0x3e21bfff,0x3fb53fb5,0xbfff3e21
.long 0xa58dc000,0x3fb53fb5,0xc000250d,0x3fb5bfb5,0x3fcf3f96,0xbfff3e21,0x3fb5bfb5,0xbe213fff
.long 0xbf96bfcf,0x3f96bfcf,0x3ff33f1e,0x80004000,0x3ff33f1e,0xbe213fff,0xbffd3ea0,0xbf44bfed
.long 0xbff33f1e,0xbf68bfe4,0x3fcfbf96,0x3fb53fb5,0x3f96bfcf,0x3fda3f86,0xbf683fe4,0xbfedbf44
.long 0x80004000,0xc000250d,0xa58dc000,0x4000a5d4,0xbf96bfcf,0x3fdabf86,0x3f683fe4,0xbfed3f44
.long 0x3ff33f1e,0xbf683fe4,0xbfcfbf96,0x3fb5bfb5,0xbff33f1e,0xbe21bfff,0x3ffd3ea0,0xbf443fed
.long 0x3f96bfcf,0x3f963fcf,0xbff33f1e,0xa58dc000,0x80004000,0xbfedbf44,0x3fb5bfb5,0x3f443fed
.long 0xbf96bfcf,0x3ffdbea0,0xbf1e3ff3,0xbfb5bfb5,0x3ff33f1e,0xbfc33fa6,0xbea0bffd,0x3fed3f44
.long 0xbff33f1e,0x3f1ebff3,0x3f963fcf,0xc000250d,0x3f96bfcf,0x3eef3ff9,0xbfe4bf68,0x3fedbf44
.long 0x80004000,0xbfb5bfb5,0x4000a5d4,0xbfb53fb5,0xbf96bfcf,0x3ff93eef,0xbfe43f68,0x3f44bfed
.long 0xbff33f1e,0xbf96bfcf,0x3f96bfcf,0x3ff33f1e,0x3fcfbf96,0x3fc33fa6,0xbf683fe4,0xbff9beef
.long 0xbf963fcf,0xbfe4bf68,0x3f1ebff3,0x3ffd3ea0,0x3f1ebff3,0x3ff93eef,0xbea03ffd,0xbfffbe21
.long 0x80004000,0xc000250d,0xa58dc000,0x4000a5d4,0xbf1ebff3,0x3ff9beef,0x3ea03ffd,0xbfff3e21
.long 0x3f963fcf,0xbfe43f68,0xbf1ebff3,0x3ffdbea0,0xbfcfbf96,0x3fc3bfa6,0x3f683fe4,0xbff93eef
.long 0x3ff33f1e,0xbf963fcf,0xbf96bfcf,0x3ff3bf1e,0xc000250d,0x3f44bfed,0x3fb53fb5,0xbfed3f44
.long 0x3ff3bf1e,0xbea03ffd,0xbfcfbf96,0x3fe4bf68,0xbfcf3f96,0xbe21bfff,0x3fe43f68,0xbfda3f86
.long 0x3f96bfcf,0x3f1e3ff3,0xbff3bf1e,0x3fcfbf96,0xbf1e3ff3,0xbf86bfda,0x3ffd3ea0,0xbfc33fa6
.long 0xa58dc000,0x3fb53fb5,0xc000250d,0x3fb5bfb5,0x3f1e3ff3,0xbfdabf86,0x3ffdbea0,0xbfa63fc3
.long 0x3f80,0x0,0x0,0x0,0xbf80,0x0,0x0,0x0
.long 0x3f80,0x0,0x0,0x0,0xbf80,0x0,0x0,0x0
.long 0x3f80,0x0,0x0,0x0,0xbf80,0x0,0x0,0x0
.long 0x3f80,0x0,0x0,0x0,0xbf80,0x0,0x0,0x0
.long 0x3f80,0x0,0x0,0x0,0xbf80,0x0,0x0,0x0
.long 0x3f80,0x0,0x0,0x0,0xbf80,0x0,0x0,0x0
.long 0x3f80,0x0,0x0,0x0,0xbf80,0x0,0x0,0x0
.long 0x3f80,0x0,0x0,0x0,0xbf80,0x0,0x0,0x0
.long 0x0,0x0,0x0,0x0,0x0,0x0,0x0,0x0
.long 0x0,0x0,0x0,0x0,0x0,0x0,0x0,0x0
.long 0x0,0x0,0x0,0x0,0x0,0x0,0x0,0x0
.long 0x0,0x0,0x0,0x0,0x0,0x0,0x0,0x0
.long 0x0,0x0,0x0,0x0,0x0,0x0,0x0,0x0
.long 0x0,0x0,0x0,0x0,0x0,0x0,0x0,0x0
.long 0x0,0x0,0x0,0x0,0x0,0x0,0x0,0x0
.long 0x0,0x0,0x0,0x0,0x0,0x0,0x0,0x0
.long 0x3f80,0xbf96bfcf,0x3ff33f1e,0xbff33f1e,0x3f80,0xbf86bfda,0x3fe43f68,0xbfff3e21
.long 0x3f80,0xbf68bfe4,0x3fcf3f96,0xbffdbea0,0x3f80,0xbf44bfed,0x3fb53fb5,0xbfedbf44
.long 0x3f80,0xbf1ebff3,0x3f963fcf,0xbfcfbf96,0x3f80,0xbeefbff9,0x3f683fe4,0xbfa6bfc3
.long 0x3f80,0xbea0bffd,0x3f1e3ff3,0xbf68bfe4,0x3f80,0xbe21bfff,0x3ea03ffd,0xbeefbff9
.long 0x3f80,0xa58dc000,0x80004000,0xa58dc000,0x3f80,0x3e21bfff,0xbea03ffd,0x3eefbff9
.long 0x3f80,0x3ea0bffd,0xbf1e3ff3,0x3f68bfe4,0x3f80,0x3eefbff9,0xbf683fe4,0x3fa6bfc3
.long 0x3f80,0x3f1ebff3,0xbf963fcf,0x3fcfbf96,0x3f80,0x3f44bfed,0xbfb53fb5,0x3fedbf44
.long 0x3f80,0x3f68bfe4,0xbfcf3f96,0x3ffdbea0,0x3f80,0x3f86bfda,0xbfe43f68,0x3fff3e21
.long 0x3f96bfcf,0x80004000,0xbf96bfcf,0x3ff33f1e,0x3fcfbf96,0xbf443fed,0xbea0bffd,0x3fa63fc3
.long 0x3ff3bf1e,0xbfb53fb5,0x3f1ebff3,0x3ea03ffd,0x4000a5d4,0xbfed3f44,0x3fb5bfb5,0xbf443fed
.long 0x3ff33f1e,0xc000250d,0x3ff3bf1e,0xbfcf3f96,0x3fcf3f96,0xbfedbf44,0x3ffd3ea0,0xbfff3e21
.long 0x3f963fcf,0xbfb5bfb5,0x3fcf3f96,0xbfe4bf68,0x3f1e3ff3,0xbf44bfed,0x3f683fe4,0xbf86bfda
.long 0x80004000,0xa58dc000,0x80004000,0xa58dc000,0xbf1e3ff3,0x3f44bfed,0xbf683fe4,0x3f86bfda
.long 0xbf963fcf,0x3fb5bfb5,0xbfcf3f96,0x3fe4bf68,0xbfcf3f96,0x3fedbf44,0xbffd3ea0,0x3fff3e21
.long 0xbff33f1e,0x4000a5d4,0xbff3bf1e,0x3fcf3f96,0xc000250d,0x3fed3f44,0xbfb5bfb5,0x3f443fed
.long 0xbff3bf1e,0x3fb53fb5,0xbf1ebff3,0xbea03ffd,0xbfcfbf96,0x3f443fed,0x3ea0bffd,0xbfa63fc3
.long 0xbff33f1e,0x3f96bfcf,0x80004000,0xbf96bfcf,0xbff3bf1e,0x3ff9beef,0xbfb53fb5,0x3eefbff9
.long 0xbf96bfcf,0x3fe43f68,0xc000250d,0x3fe4bf68,0xa58dc000,0x3f443fed,0xbfb5bfb5,0x3fed3f44
.long 0x3f96bfcf,0xbf1e3ff3,0xa58dc000,0x3f1e3ff3,0x3ff3bf1e,0xbfda3f86,0x3fb5bfb5,0xbf863fda
.long 0x3ff33f1e,0xbffdbea0,0x4000a5d4,0xbffd3ea0,0x3f963fcf,0xbfa6bfc3,0x3fb53fb5,0xbfc3bfa6
.long 0x80004000,0xa58dc000,0x80004000,0xa58dc000,0xbf963fcf,0x3fa6bfc3,0xbfb53fb5,0x3fc3bfa6
.long 0xbff33f1e,0x3ffdbea0,0xc000250d,0x3ffd3ea0,0xbff3bf1e,0x3fda3f86,0xbfb5bfb5,0x3f863fda
.long 0xbf96bfcf,0x3f1e3ff3,0xa58dc000,0xbf1e3ff3,0xa58dc000,0xbf443fed,0x3fb5bfb5,0xbfed3f44
.long 0x3f96bfcf,0xbfe43f68,0x4000a5d4,0xbfe4bf68,0x3ff3bf1e,0xbff9beef,0x3fb53fb5,0xbeefbff9
.long 0x3ff33f1e,0xbff33f1e,0x3f96bfcf,0x80004000,0x3f1e3ff3,0xbfc3bfa6,0x3ffd3ea0,0xbfed3f44
.long 0xbf963fcf,0x3ea0bffd,0x3f1e3ff3,0xbfb5bfb5,0xc000250d,0x3fedbf44,0xbfb53fb5,0x3f44bfed
.long 0xbf96bfcf,0x3fcf3f96,0xbff3bf1e,0x4000a5d4,0x3f1ebff3,0xbe213fff,0xbea0bffd,0x3f443fed
.long 0x3ff3bf1e,0xbfe43f68,0x3fcfbf96,0xbfb53fb5,0x3fcf3f96,0xbfdabf86,0x3fe43f68,0xbfedbf44
.long 0x80004000,0xa58dc000,0x80004000,0xa58dc000,0xbfcf3f96,0x3fdabf86,0xbfe43f68,0x3fedbf44
.long 0xbff3bf1e,0x3fe43f68,0xbfcfbf96,0x3fb53fb5,0xbf1ebff3,0x3e213fff,0x3ea0bffd,0xbf443fed
.long 0x3f96bfcf,0xbfcf3f96,0x3ff3bf1e,0xc000250d,0x4000a5d4,0xbfedbf44,0x3fb53fb5,0xbf44bfed
.long 0x3f963fcf,0xbea0bffd,0xbf1e3ff3,0x3fb5bfb5,0xbf1e3ff3,0x3fc3bfa6,0xbffd3ea0,0x3fed3f44
.long 0xbf96bfcf,0x3ff33f1e,0xbff33f1e,0x3f96bfcf,0x3f96bfcf,0xbe213fff,0xbf68bfe4,0x3fda3f86
.long 0x3ff33f1e,0xbffd3ea0,0x3fcfbf96,0xbf683fe4,0x80004000,0xbf44bfed,0x3fb53fb5,0xbfedbf44
.long 0xbff33f1e,0x3fcfbf96,0xbf963fcf,0x3f1ebff3,0xbf96bfcf,0x3fc33fa6,0xbfe4bf68,0x3ff93eef
.long 0x3f96bfcf,0xbf683fe4,0x3f1ebff3,0xbea03ffd,0x3ff33f1e,0xbff9beef,0x3ffd3ea0,0xbfffbe21
.long 0x80004000,0xa58dc000,0x80004000,0xa58dc000,0xbff33f1e,0x3ff9beef,0xbffd3ea0,0x3fffbe21
.long 0xbf96bfcf,0x3f683fe4,0xbf1ebff3,0x3ea03ffd,0x3f96bfcf,0xbfc33fa6,0x3fe4bf68,0xbff93eef
.long 0x3ff33f1e,0xbfcfbf96,0x3f963fcf,0xbf1ebff3,0x80004000,0x3f44bfed,0xbfb53fb5,0x3fedbf44
.long 0xbff33f1e,0x3ffd3ea0,0xbfcfbf96,0x3f683fe4,0xbf96bfcf,0x3e213fff,0x3f68bfe4,0xbfda3f86
.long 0x80004000,0xbf96bfcf,0x3ff33f1e,0xbff33f1e,0xc000250d,0x3fdabf86,0xbf683fe4,0xbe21bfff
.long 0xa58dc000,0x3f683fe4,0xbfcfbf96,0x3ffd3ea0,0x4000a5d4,0xbfed3f44,0x3fb5bfb5,0xbf443fed
.long 0x80004000,0xbf1ebff3,0x3f963fcf,0xbfcfbf96,0xc000250d,0x3ff9beef,0xbfe43f68,0x3fc3bfa6
.long 0xa58dc000,0x3ea03ffd,0xbf1ebff3,0x3f683fe4,0x4000a5d4,0xbfff3e21,0x3ffdbea0,0xbff93eef
.long 0x80004000,0xa58dc000,0x80004000,0xa58dc000,0xc000250d,0x3fff3e21,0xbffdbea0,0x3ff93eef
.long 0xa58dc000,0xbea03ffd,0x3f1ebff3,0xbf683fe4,0x4000a5d4,0xbff9beef,0x3fe43f68,0xbfc3bfa6
.long 0x80004000,0x3f1ebff3,0xbf963fcf,0x3fcfbf96,0xc000250d,0x3fed3f44,0xbfb5bfb5,0x3f443fed
.long 0xa58dc000,0xbf683fe4,0x3fcfbf96,0xbffd3ea0,0x4000a5d4,0xbfdabf86,0x3f683fe4,0x3e21bfff
.long 0x3f96bfcf,0x80004000,0xbf96bfcf,0x3ff33f1e,0x3f963fcf,0xbfedbf44,0x3ffdbea0,0xbfc33fa6
.long 0xbff33f1e,0x3fb5bfb5,0xbf1e3ff3,0xbea0bffd,0xa58dc000,0x3f443fed,0xbfb5bfb5,0x3fed3f44
.long 0x3ff33f1e,0xc000250d,0x3ff3bf1e,0xbfcf3f96,0xbf963fcf,0x3f44bfed,0xbea03ffd,0xbe21bfff
.long 0xbf96bfcf,0x3fb53fb5,0xbfcfbf96,0x3fe43f68,0x3ff3bf1e,0xbfed3f44,0x3fe4bf68,0xbfda3f86
.long 0x80004000,0xa58dc000,0x80004000,0xa58dc000,0xbff3bf1e,0x3fed3f44,0xbfe4bf68,0x3fda3f86
.long 0x3f96bfcf,0xbfb53fb5,0x3fcfbf96,0xbfe43f68,0x3f963fcf,0xbf44bfed,0x3ea03ffd,0x3e21bfff
.long 0xbff33f1e,0x4000a5d4,0xbff3bf1e,0x3fcf3f96,0xa58dc000,0xbf443fed,0x3fb5bfb5,0xbfed3f44
.long 0x3ff33f1e,0xbfb5bfb5,0x3f1e3ff3,0x3ea0bffd,0xbf963fcf,0x3fedbf44,0xbffdbea0,0x3fc33fa6
.long 0xbff33f1e,0x3f96bfcf,0x80004000,0xbf96bfcf,0x3f1ebff3,0x3eef3ff9,0xbfb5bfb5,0x3ff93eef
.long 0x3f963fcf,0xbfe4bf68,0x4000a5d4,0xbfe43f68,0xc000250d,0x3fedbf44,0xbfb53fb5,0x3f44bfed
.long 0x3f96bfcf,0xbf1e3ff3,0xa58dc000,0x3f1e3ff3,0x3f1e3ff3,0xbf86bfda,0x3fb53fb5,0xbfdabf86
.long 0xbff3bf1e,0x3ffd3ea0,0xc000250d,0x3ffdbea0,0x3fcfbf96,0xbfc33fa6,0x3fb5bfb5,0xbfa63fc3
.long 0x80004000,0xa58dc000,0x80004000,0xa58dc000,0xbfcfbf96,0x3fc33fa6,0xbfb5bfb5,0x3fa63fc3
.long 0x3ff3bf1e,0xbffd3ea0,0x4000a5d4,0xbffdbea0,0xbf1e3ff3,0x3f86bfda,0xbfb53fb5,0x3fdabf86
.long 0xbf96bfcf,0x3f1e3ff3,0xa58dc000,0xbf1e3ff3,0x4000a5d4,0xbfedbf44,0x3fb53fb5,0xbf44bfed
.long 0xbf963fcf,0x3fe4bf68,0xc000250d,0x3fe43f68,0xbf1ebff3,0xbeef3ff9,0x3fb5bfb5,0xbff93eef
.long 0x3ff33f1e,0xbff33f1e,0x3f96bfcf,0x80004000,0xbff33f1e,0x3fa6bfc3,0xbea03ffd,0xbf44bfed
.long 0x3f96bfcf,0xbea03ffd,0xbf1ebff3,0x3fb53fb5,0x80004000,0xbf44bfed,0x3fb53fb5,0xbfedbf44
.long 0xbf96bfcf,0x3fcf3f96,0xbff3bf1e,0x4000a5d4,0x3ff33f1e,0xbfffbe21,0x3ffdbea0,0xbfed3f44
.long 0xbff33f1e,0x3fe4bf68,0xbfcf3f96,0x3fb5bfb5,0x3f96bfcf,0xbf863fda,0x3f68bfe4,0xbf443fed
.long 0x80004000,0xa58dc000,0x80004000,0xa58dc000,0xbf96bfcf,0x3f863fda,0xbf68bfe4,0x3f443fed
.long 0x3ff33f1e,0xbfe4bf68,0x3fcf3f96,0xbfb5bfb5,0xbff33f1e,0x3fffbe21,0xbffdbea0,0x3fed3f44
.long 0x3f96bfcf,0xbfcf3f96,0x3ff3bf1e,0xc000250d,0x80004000,0x3f44bfed,0xbfb53fb5,0x3fedbf44
.long 0xbf96bfcf,0x3ea03ffd,0x3f1ebff3,0xbfb53fb5,0x3ff33f1e,0xbfa6bfc3,0x3ea03ffd,0x3f44bfed
.long 0xbf96bfcf,0x3ff33f1e,0xbff33f1e,0x3f96bfcf,0x3fcf3f96,0xbfffbe21,0x3fe4bf68,0xbf863fda
.long 0xbff3bf1e,0x3ffdbea0,0xbfcf3f96,0x3f68bfe4,0x4000a5d4,0xbfed3f44,0x3fb5bfb5,0xbf443fed
.long 0xbff33f1e,0x3fcfbf96,0xbf963fcf,0x3f1ebff3,0x3fcfbf96,0xbfa63fc3,0x3f68bfe4,0xbeef3ff9
.long 0xbf963fcf,0x3f68bfe4,0xbf1e3ff3,0x3ea0bffd,0x3f1ebff3,0xbeef3ff9,0x3ea0bffd,0xbe213fff
.long 0x80004000,0xa58dc000,0x80004000,0xa58dc000,0xbf1ebff3,0x3eef3ff9,0xbea0bffd,0x3e213fff
.long 0x3f963fcf,0xbf68bfe4,0x3f1e3ff3,0xbea0bffd,0xbfcfbf96,0x3fa63fc3,0xbf68bfe4,0x3eef3ff9
.long 0x3ff33f1e,0xbfcfbf96,0x3f963fcf,0xbf1ebff3,0xc000250d,0x3fed3f44,0xbfb5bfb5,0x3f443fed
.long 0x3ff3bf1e,0xbffdbea0,0x3fcf3f96,0xbf68bfe4,0xbfcf3f96,0x3fffbe21,0xbfe4bf68,0x3f863fda
.long 0x3f80,0x0,0x0,0x0,0xbf80,0x0,0x0,0x0
.long 0x3f80,0x0,0x0,0x0,0xbf80,0x0,0x0,0x0
.long 0x3f80,0x0,0x0,0x0,0xbf80,0x0,0x0,0x0
.long 0x3f80,0x0,0x0,0x0,0xbf80,0x0,0x0,0x0
.long 0x3f80,0x0,0x0,0x0,0xbf80,0x0,0x0,0x0
.long 0x3f80,0x0,0x0,0x0,0xbf80,0x0,0x0,0x0
.long 0x3f80,0x0,0x0,0x0,0xbf80,0x0,0x0,0x0
.long 0x3f80,0x0,0x0,0x0,0xbf80,0x0,0x0,0x0
.long 0x0,0x0,0x0,0x0,0x0,0x0,0x0,0x0
.long 0x0,0x0,0x0,0x0,0x0,0x0,0x0,0x0
.long 0x0,0x0,0x0,0x0,0x0,0x0,0x0,0x0
.long 0x0,0x0,0x0,0x0,0x0,0x0,0x0,0x0
.long 0x0,0x0,0x0,0x0,0x0,0x0,0x0,0x0
.long 0x0,0x0,0x0,0x0,0x0,0x0,0x0,0x0
.long 0x0,0x0,0x0,0x0,0x0,0x0,0x0,0x0
.long 0x0,0x0,0x0,0x0,0x0,0x0,0x0,0x0
.long 0x3f80,0x3f96bfcf,0xbff33f1e,0x3ff33f1e,0x3f80,0x3fa6bfc3,0xbffd3ea0,0x3fda3f86
.long 0x3f80,0x3fb5bfb5,0xc000250d,0x3fb53fb5,0x3f80,0x3fc3bfa6,0xbffdbea0,0x3f863fda
.long 0x3f80,0x3fcfbf96,0xbff3bf1e,0x3f1e3ff3,0x3f80,0x3fdabf86,0xbfe4bf68,0x3e213fff
.long 0x3f80,0x3fe4bf68,0xbfcfbf96,0xbea03ffd,0x3f80,0x3fedbf44,0xbfb5bfb5,0xbf443fed
.long 0x3f80,0x3ff3bf1e,0xbf96bfcf,0xbf963fcf,0x3f80,0x3ff9beef,0xbf68bfe4,0xbfc33fa6
.long 0x3f80,0x3ffdbea0,0xbf1ebff3,0xbfe43f68,0x3f80,0x3fffbe21,0xbea0bffd,0xbff93eef
.long 0x3f80,0x4000a5d4,0xa58dc000,0xc000250d,0x3f80,0x3fff3e21,0x3ea0bffd,0xbff9beef
.long 0x3f80,0x3ffd3ea0,0x3f1ebff3,0xbfe4bf68,0x3f80,0x3ff93eef,0x3f68bfe4,0xbfc3bfa6
.long 0xbf96bfcf,0x80004000,0x3f96bfcf,0xbff33f1e,0xbf1ebff3,0xbf443fed,0x3fe4bf68,0xbff9beef
.long 0xa58dc000,0xbfb53fb5,0x4000a5d4,0xbfb5bfb5,0x3f1ebff3,0xbfed3f44,0x3fe43f68,0xbeefbff9
.long 0x3f96bfcf,0xc000250d,0x3f963fcf,0x3f1ebff3,0x3fcfbf96,0xbfedbf44,0x3ea03ffd,0x3fc3bfa6
.long 0x3ff3bf1e,0xbfb5bfb5,0xbf1e3ff3,0x3ffdbea0,0x4000a5d4,0xbf44bfed,0xbfb53fb5,0x3fed3f44
.long 0x3ff33f1e,0xa58dc000,0xbff33f1e,0x3f963fcf,0x3fcf3f96,0x3f44bfed,0xbffdbea0,0x3e213fff
.long 0x3f963fcf,0x3fb5bfb5,0xbfcfbf96,0xbf683fe4,0x3f1e3ff3,0x3fedbf44,0xbf68bfe4,0xbfda3f86
.long 0x80004000,0x4000a5d4,0xa58dc000,0xc000250d,0xbf1e3ff3,0x3fed3f44,0x3f68bfe4,0xbfdabf86
.long 0xbf963fcf,0x3fb53fb5,0x3fcfbf96,0xbf68bfe4,0xbfcf3f96,0x3f443fed,0x3ffdbea0,0x3e21bfff
.long 0x3ff33f1e,0xbf96bfcf,0x80004000,0x3f96bfcf,0x3f963fcf,0x3e21bfff,0xbfb53fb5,0x3fffbe21
.long 0x80004000,0x3fb5bfb5,0xc000250d,0x3fb53fb5,0xbf963fcf,0x3fffbe21,0xbfb5bfb5,0xbe213fff
.long 0xbff33f1e,0x3fcf3f96,0xa58dc000,0xbfcf3f96,0xbff3bf1e,0x3eef3ff9,0x3fb5bfb5,0xbff9beef
.long 0xbf96bfcf,0xbf683fe4,0x4000a5d4,0xbf68bfe4,0xa58dc000,0xbfed3f44,0x3fb53fb5,0x3f44bfed
.long 0x3f96bfcf,0xbff3bf1e,0x80004000,0x3ff3bf1e,0x3ff3bf1e,0xbf86bfda,0xbfb53fb5,0x3fda3f86
.long 0x3ff33f1e,0x3ea0bffd,0xc000250d,0x3ea03ffd,0x3f963fcf,0x3fc3bfa6,0xbfb5bfb5,0xbfa63fc3
.long 0x80004000,0x4000a5d4,0xa58dc000,0xc000250d,0xbf963fcf,0x3fc33fa6,0x3fb5bfb5,0xbfa6bfc3
.long 0xbff33f1e,0x3ea03ffd,0x4000a5d4,0x3ea0bffd,0xbff3bf1e,0xbf863fda,0x3fb53fb5,0x3fdabf86
.long 0xbff33f1e,0x3ff33f1e,0xbf96bfcf,0x80004000,0xbfcfbf96,0x3eef3ff9,0x3f68bfe4,0xbfed3f44
.long 0xa58dc000,0xbfb53fb5,0x4000a5d4,0xbfb5bfb5,0x3fcfbf96,0xbff9beef,0x3f683fe4,0x3f44bfed
.long 0x3ff33f1e,0xbf1ebff3,0xbf963fcf,0x4000a5d4,0x3f1e3ff3,0x3fa6bfc3,0xbffdbea0,0x3f443fed
.long 0xbf963fcf,0x3ffd3ea0,0xbf1ebff3,0xbfb53fb5,0xc000250d,0x3f443fed,0x3fb5bfb5,0xbfedbf44
.long 0xbf96bfcf,0xbf963fcf,0x3ff33f1e,0xa58dc000,0x3f1ebff3,0xbfffbe21,0x3ea03ffd,0x3fedbf44
.long 0x3ff3bf1e,0xbf68bfe4,0xbfcf3f96,0x3fb53fb5,0x3fcf3f96,0x3f86bfda,0xbfe4bf68,0xbf443fed
.long 0x80004000,0x4000a5d4,0xa58dc000,0xc000250d,0xbfcf3f96,0x3f863fda,0x3fe4bf68,0xbf44bfed
.long 0xbff3bf1e,0xbf683fe4,0x3fcf3f96,0x3fb5bfb5,0xbf1ebff3,0xbfff3e21,0xbea03ffd,0x3fed3f44
.long 0x3f96bfcf,0xbff33f1e,0x3ff33f1e,0xbf96bfcf,0x3ff33f1e,0xbf86bfda,0xbea03ffd,0x3fc3bfa6
.long 0x80004000,0x3fb5bfb5,0xc000250d,0x3fb53fb5,0xbff33f1e,0x3fda3f86,0xbea0bffd,0xbfa63fc3
.long 0xbf96bfcf,0xbf1e3ff3,0x3ff3bf1e,0xbfcfbf96,0x3f96bfcf,0xbfffbe21,0x3f683fe4,0x3f86bfda
.long 0x3ff33f1e,0xbea0bffd,0xbfcf3f96,0x3fe43f68,0x80004000,0x3fedbf44,0xbfb5bfb5,0xbf443fed
.long 0xbff33f1e,0x3f963fcf,0x3f96bfcf,0xbff3bf1e,0xbf96bfcf,0xbfa63fc3,0x3fe43f68,0x3eefbff9
.long 0x3f96bfcf,0xbfe4bf68,0xbf1e3ff3,0x3ffd3ea0,0x3ff33f1e,0x3eefbff9,0xbffdbea0,0xbe213fff
.long 0x80004000,0x4000a5d4,0xa58dc000,0xc000250d,0xbff33f1e,0x3eef3ff9,0x3ffdbea0,0xbe21bfff
.long 0xbf96bfcf,0xbfe43f68,0x3f1e3ff3,0x3ffdbea0,0x3f96bfcf,0xbfa6bfc3,0xbfe43f68,0x3eef3ff9
.long 0x80004000,0x3f96bfcf,0xbff33f1e,0x3ff33f1e,0xc000250d,0x3fc33fa6,0xbea0bffd,0xbf863fda
.long 0xa58dc000,0xbfb53fb5,0x4000a5d4,0xbfb5bfb5,0x4000a5d4,0xbfa6bfc3,0xbea03ffd,0x3fdabf86
.long 0x80004000,0x3fcfbf96,0xbff3bf1e,0x3f1e3ff3,0xc000250d,0x3f863fda,0x3f68bfe4,0xbfff3e21
.long 0xa58dc000,0xbfe43f68,0x3fcf3f96,0x3ea0bffd,0x4000a5d4,0xbf44bfed,0xbfb53fb5,0x3fed3f44
.long 0x80004000,0x3ff3bf1e,0xbf96bfcf,0xbf963fcf,0xc000250d,0x3eef3ff9,0x3fe4bf68,0xbfa6bfc3
.long 0xa58dc000,0xbffd3ea0,0x3f1e3ff3,0x3fe4bf68,0x4000a5d4,0xbe21bfff,0xbffd3ea0,0x3eef3ff9
.long 0x80004000,0x4000a5d4,0xa58dc000,0xc000250d,0xc000250d,0xbe213fff,0x3ffd3ea0,0x3eefbff9
.long 0xa58dc000,0xbffdbea0,0xbf1e3ff3,0x3fe43f68,0x4000a5d4,0x3eefbff9,0xbfe4bf68,0xbfa63fc3
.long 0xbf96bfcf,0x80004000,0x3f96bfcf,0xbff33f1e,0x3ff3bf1e,0xbfedbf44,0x3f683fe4,0x3eefbff9
.long 0x80004000,0x3fb5bfb5,0xc000250d,0x3fb53fb5,0xbff3bf1e,0x3f443fed,0x3f68bfe4,0xbff93eef
.long 0x3f96bfcf,0xc000250d,0x3f963fcf,0x3f1ebff3,0x3f963fcf,0x3f44bfed,0xbffd3ea0,0x3fa63fc3
.long 0xbff33f1e,0x3fb53fb5,0x3f1ebff3,0xbffd3ea0,0xa58dc000,0xbfed3f44,0x3fb53fb5,0x3f44bfed
.long 0x3ff33f1e,0xa58dc000,0xbff33f1e,0x3f963fcf,0xbf963fcf,0x3fed3f44,0x3ea0bffd,0xbfff3e21
.long 0xbf96bfcf,0xbfb53fb5,0x3fcf3f96,0x3f68bfe4,0x3ff3bf1e,0xbf44bfed,0xbfe43f68,0x3f863fda
.long 0x80004000,0x4000a5d4,0xa58dc000,0xc000250d,0xbff3bf1e,0xbf443fed,0x3fe43f68,0x3f86bfda
.long 0x3f96bfcf,0xbfb5bfb5,0xbfcf3f96,0x3f683fe4,0x3f963fcf,0x3fedbf44,0xbea0bffd,0xbfffbe21
.long 0x3ff33f1e,0xbf96bfcf,0x80004000,0x3f96bfcf,0xbfcf3f96,0x3fff3e21,0xbfb5bfb5,0x3e213fff
.long 0xa58dc000,0xbfb53fb5,0x4000a5d4,0xbfb5bfb5,0x3fcf3f96,0xbe21bfff,0xbfb53fb5,0x3fff3e21
.long 0xbff33f1e,0x3fcf3f96,0xa58dc000,0xbfcf3f96,0x3f1ebff3,0xbff93eef,0x3fb53fb5,0x3eefbff9
.long 0x3f963fcf,0x3f68bfe4,0xc000250d,0x3f683fe4,0xc000250d,0x3f443fed,0x3fb5bfb5,0xbfedbf44
.long 0x3f96bfcf,0xbff3bf1e,0x80004000,0x3ff3bf1e,0x3f1e3ff3,0x3fdabf86,0xbfb5bfb5,0xbf863fda
.long 0xbff3bf1e,0xbea03ffd,0x4000a5d4,0xbea0bffd,0x3fcfbf96,0xbfa6bfc3,0xbfb53fb5,0x3fc33fa6
.long 0x80004000,0x4000a5d4,0xa58dc000,0xc000250d,0xbfcfbf96,0xbfa63fc3,0x3fb53fb5,0x3fc3bfa6
.long 0x3ff3bf1e,0xbea0bffd,0xc000250d,0xbea03ffd,0xbf1e3ff3,0x3fda3f86,0x3fb5bfb5,0xbf86bfda
.long 0xbff33f1e,0x3ff33f1e,0xbf96bfcf,0x80004000,0x3f96bfcf,0xbff93eef,0x3fe43f68,0xbf44bfed
.long 0x80004000,0x3fb5bfb5,0xc000250d,0x3fb53fb5,0xbf96bfcf,0xbeef3ff9,0x3fe4bf68,0xbfedbf44
.long 0x3ff33f1e,0xbf1ebff3,0xbf963fcf,0x4000a5d4,0xbff33f1e,0x3fc33fa6,0x3ea0bffd,0xbfed3f44
.long 0x3f96bfcf,0xbffdbea0,0x3f1e3ff3,0x3fb5bfb5,0x80004000,0x3fedbf44,0xbfb5bfb5,0xbf443fed
.long 0xbf96bfcf,0xbf963fcf,0x3ff33f1e,0xa58dc000,0x3ff33f1e,0x3e21bfff,0xbffd3ea0,0x3f443fed
.long 0xbff33f1e,0x3f683fe4,0x3fcfbf96,0xbfb5bfb5,0x3f96bfcf,0xbfdabf86,0xbf683fe4,0x3fed3f44
.long 0x80004000,0x4000a5d4,0xa58dc000,0xc000250d,0xbf96bfcf,0xbfda3f86,0x3f683fe4,0x3fedbf44
.long 0x3ff33f1e,0x3f68bfe4,0xbfcfbf96,0xbfb53fb5,0xbff33f1e,0x3e213fff,0x3ffd3ea0,0x3f44bfed
.long 0x3f96bfcf,0xbff33f1e,0x3ff33f1e,0xbf96bfcf,0xbf1e3ff3,0x3fdabf86,0xbffdbea0,0x3fa63fc3
.long 0xa58dc000,0xbfb53fb5,0x4000a5d4,0xbfb5bfb5,0x3f1e3ff3,0x3f86bfda,0xbffd3ea0,0x3fc33fa6
.long 0xbf96bfcf,0xbf1e3ff3,0x3ff3bf1e,0xbfcfbf96,0x3fcf3f96,0x3e21bfff,0xbfe43f68,0x3fda3f86
.long 0xbff3bf1e,0x3ea03ffd,0x3fcfbf96,0xbfe4bf68,0x4000a5d4,0xbf44bfed,0xbfb53fb5,0x3fed3f44
.long 0xbff33f1e,0x3f963fcf,0x3f96bfcf,0xbff3bf1e,0x3fcfbf96,0xbfc3bfa6,0xbf683fe4,0x3ff93eef
.long 0xbf963fcf,0x3fe43f68,0x3f1ebff3,0xbffdbea0,0x3f1ebff3,0xbff9beef,0xbea03ffd,0x3fff3e21
.long 0x80004000,0x4000a5d4,0xa58dc000,0xc000250d,0xbf1ebff3,0xbff93eef,0x3ea03ffd,0x3fffbe21
.long 0x3f963fcf,0x3fe4bf68,0xbf1ebff3,0xbffd3ea0,0xbfcfbf96,0xbfc33fa6,0x3f683fe4,0x3ff9beef
.long 0x3f80,0x0,0x0,0x0,0xbf80,0x0,0x0,0x0
.long 0x3f80,0x0,0x0,0x0,0xbf80,0x0,0x0,0x0
.long 0x3f80,0x0,0x0,0x0,0xbf80,0x0,0x0,0x0
.long 0x3f80,0x0,0x0,0x0,0xbf80,0x0,0x0,0x0
.long 0x3f80,0x0,0x0,0x0,0xbf80,0x0,0x0,0x0
.long 0x3f80,0x0,0x0,0x0,0xbf80,0x0,0x0,0x0
.long 0x3f80,0x0,0x0,0x0,0xbf80,0x0,0x0,0x0
.long 0x3f80,0x0,0x0,0x0,0xbf80,0x0,0x0,0x0
.long 0x0,0x0,0x0,0x0,0x0,0x0,0x0,0x0
.long 0x0,0x0,0x0,0x0,0x0,0x0,0x0,0x0
.long 0x0,0x0,0x0,0x0,0x0,0x0,0x0,0x0
.long 0x0,0x0,0x0,0x0,0x0,0x0,0x0,0x0
.long 0x0,0x0,0x0,0x0,0x0,0x0,0x0,0x0
.long 0x0,0x0,0x0,0x0,0x0,0x0,0x0,0x0
.long 0x0,0x0,0x0,0x0,0x0,0x0,0x0,0x0
.long 0x0,0x0,0x0,0x0,0x0,0x0,0x0,0x0
.long 0x3f80,0x3ff33f1e,0x3f96bfcf,0xbf96bfcf,0x3f80,0x3fed3f44,0x3fb5bfb5,0xbf44bfed
.long 0x3f80,0x3fe43f68,0x3fcfbf96,0xbea0bffd,0x3f80,0x3fda3f86,0x3fe4bf68,0x3e21bfff
.long 0x3f80,0x3fcf3f96,0x3ff3bf1e,0x3f1ebff3,0x3f80,0x3fc33fa6,0x3ffdbea0,0x3f86bfda
.long 0x3f80,0x3fb53fb5,0x4000a5d4,0x3fb5bfb5,0x3f80,0x3fa63fc3,0x3ffd3ea0,0x3fdabf86
.long 0x3f80,0x3f963fcf,0x3ff33f1e,0x3ff3bf1e,0x3f80,0x3f863fda,0x3fe43f68,0x3fffbe21
.long 0x3f80,0x3f683fe4,0x3fcf3f96,0x3ffd3ea0,0x3f80,0x3f443fed,0x3fb53fb5,0x3fed3f44
.long 0x3f80,0x3f1e3ff3,0x3f963fcf,0x3fcf3f96,0x3f80,0x3eef3ff9,0x3f683fe4,0x3fa63fc3
.long 0x3f80,0x3ea03ffd,0x3f1e3ff3,0x3f683fe4,0x3f80,0x3e213fff,0x3ea03ffd,0x3eef3ff9
.long 0xbff33f1e,0x80004000,0x3ff33f1e,0x3f96bfcf,0xc000250d,0xbf443fed,0x3fb53fb5,0x3fedbf44
.long 0xbff3bf1e,0xbfb53fb5,0x3f1e3ff3,0x3ffd3ea0,0xbfcfbf96,0xbfed3f44,0xbea03ffd,0x3fc33fa6
.long 0xbf96bfcf,0xc000250d,0xbf963fcf,0x3f1e3ff3,0xbf1ebff3,0xbfedbf44,0xbfe43f68,0xbeef3ff9
.long 0xa58dc000,0xbfb5bfb5,0xc000250d,0xbfb53fb5,0x3f1ebff3,0xbf44bfed,0xbfe4bf68,0xbff93eef
.long 0x3f96bfcf,0xa58dc000,0xbf96bfcf,0xbff3bf1e,0x3fcfbf96,0x3f44bfed,0xbea0bffd,0xbfa6bfc3
.long 0x3ff3bf1e,0x3fb5bfb5,0x3f1ebff3,0xbea0bffd,0x4000a5d4,0x3fedbf44,0x3fb5bfb5,0x3f44bfed
.long 0x3ff33f1e,0x4000a5d4,0x3ff3bf1e,0x3fcfbf96,0x3fcf3f96,0x3fed3f44,0x3ffd3ea0,0x3fffbe21
.long 0x3f963fcf,0x3fb53fb5,0x3fcf3f96,0x3fe43f68,0x3f1e3ff3,0x3f443fed,0x3f683fe4,0x3f863fda
.long 0xbf96bfcf,0xbff33f1e,0x80004000,0x3ff33f1e,0xa58dc000,0xbfedbf44,0xbfb53fb5,0x3f443fed
.long 0x3f96bfcf,0xbf68bfe4,0xc000250d,0xbf683fe4,0x3ff3bf1e,0x3eefbff9,0xbfb5bfb5,0xbff93eef
.long 0x3ff33f1e,0x3fcfbf96,0xa58dc000,0xbfcfbf96,0x3f963fcf,0x3fff3e21,0x3fb5bfb5,0xbe21bfff
.long 0x80004000,0x3fb53fb5,0x4000a5d4,0x3fb5bfb5,0xbf963fcf,0x3e213fff,0x3fb53fb5,0x3fff3e21
.long 0xbff33f1e,0xbf963fcf,0x80004000,0x3f963fcf,0xbff3bf1e,0xbff93eef,0xbfb53fb5,0xbeef3ff9
.long 0xbf96bfcf,0xbfe4bf68,0xc000250d,0xbfe43f68,0xa58dc000,0xbf44bfed,0xbfb5bfb5,0xbfedbf44
.long 0x3f96bfcf,0x3f1ebff3,0xa58dc000,0xbf1ebff3,0x3ff3bf1e,0x3fdabf86,0x3fb5bfb5,0x3f86bfda
.long 0x3ff33f1e,0x3ffd3ea0,0x4000a5d4,0x3ffdbea0,0x3f963fcf,0x3fa63fc3,0x3fb53fb5,0x3fc33fa6
.long 0x3f96bfcf,0xbf96bfcf,0xbff33f1e,0x80004000,0x4000a5d4,0x3f44bfed,0xbfb5bfb5,0xbfed3f44
.long 0x3f963fcf,0x3ffdbea0,0x3f1ebff3,0xbfb5bfb5,0xbf1e3ff3,0x3fa63fc3,0x3ffdbea0,0x3f44bfed
.long 0xbff33f1e,0xbf1e3ff3,0x3f963fcf,0x4000a5d4,0xbfcfbf96,0xbff93eef,0xbf683fe4,0x3f443fed
.long 0xa58dc000,0xbfb5bfb5,0xc000250d,0xbfb53fb5,0x3fcfbf96,0x3eefbff9,0xbf68bfe4,0xbfedbf44
.long 0x3ff33f1e,0x3ff3bf1e,0x3f96bfcf,0xa58dc000,0x3f1e3ff3,0x3fc33fa6,0x3ffd3ea0,0x3fedbf44
.long 0xbf963fcf,0xbea03ffd,0x3f1e3ff3,0x3fb53fb5,0xc000250d,0xbfed3f44,0xbfb53fb5,0xbf443fed
.long 0xbf96bfcf,0xbfcfbf96,0xbff3bf1e,0xc000250d,0x3f1ebff3,0x3e21bfff,0xbea0bffd,0xbf44bfed
.long 0x3ff3bf1e,0x3fe4bf68,0x3fcfbf96,0x3fb5bfb5,0x3fcf3f96,0x3fda3f86,0x3fe43f68,0x3fed3f44
.long 0x3ff33f1e,0x3f96bfcf,0xbf96bfcf,0xbff33f1e,0x80004000,0x3fed3f44,0x3fb5bfb5,0xbf44bfed
.long 0xbff33f1e,0xbea03ffd,0x3fcf3f96,0x3fe4bf68,0xbf96bfcf,0xbfff3e21,0xbf683fe4,0x3f863fda
.long 0x3f96bfcf,0xbf1ebff3,0xbff3bf1e,0xbfcf3f96,0x3ff33f1e,0x3fdabf86,0x3ea0bffd,0xbfa6bfc3
.long 0x80004000,0x3fb53fb5,0x4000a5d4,0x3fb5bfb5,0xbff33f1e,0xbf863fda,0x3ea03ffd,0x3fc33fa6
.long 0xbf96bfcf,0xbff3bf1e,0xbff33f1e,0xbf963fcf,0x3f96bfcf,0x3e21bfff,0xbf68bfe4,0xbfdabf86
.long 0x3ff33f1e,0x3ffdbea0,0x3fcfbf96,0x3f68bfe4,0x80004000,0x3f443fed,0x3fb53fb5,0x3fed3f44
.long 0xbff33f1e,0xbfcf3f96,0xbf963fcf,0xbf1e3ff3,0xbf96bfcf,0xbfc3bfa6,0xbfe4bf68,0xbff9beef
.long 0x3f96bfcf,0x3f68bfe4,0x3f1ebff3,0x3ea0bffd,0x3ff33f1e,0x3ff93eef,0x3ffd3ea0,0x3fff3e21
.long 0x80004000,0x3ff33f1e,0x3f96bfcf,0xbf96bfcf,0xc000250d,0xbf443fed,0x3fb53fb5,0x3fedbf44
.long 0xa58dc000,0xbfe4bf68,0xbfcf3f96,0x3ea03ffd,0x4000a5d4,0x3f86bfda,0xbf68bfe4,0xbfffbe21
.long 0x80004000,0x3fcf3f96,0x3ff3bf1e,0x3f1ebff3,0xc000250d,0xbfa63fc3,0x3ea03ffd,0x3fda3f86
.long 0xa58dc000,0xbfb5bfb5,0xc000250d,0xbfb53fb5,0x4000a5d4,0x3fc3bfa6,0x3ea0bffd,0xbf86bfda
.long 0x80004000,0x3f963fcf,0x3ff33f1e,0x3ff3bf1e,0xc000250d,0xbfda3f86,0xbf683fe4,0x3e213fff
.long 0xa58dc000,0xbf68bfe4,0xbfcfbf96,0xbffdbea0,0x4000a5d4,0x3fedbf44,0x3fb5bfb5,0x3f44bfed
.long 0x80004000,0x3f1e3ff3,0x3f963fcf,0x3fcf3f96,0xc000250d,0xbff93eef,0xbfe43f68,0xbfc33fa6
.long 0xa58dc000,0xbea0bffd,0xbf1ebff3,0xbf68bfe4,0x4000a5d4,0x3fffbe21,0x3ffdbea0,0x3ff9beef
.long 0xbff33f1e,0x80004000,0x3ff33f1e,0x3f96bfcf,0xa58dc000,0xbfedbf44,0xbfb53fb5,0x3f443fed
.long 0x3ff33f1e,0x3fb5bfb5,0xbf1ebff3,0xbffdbea0,0xbf963fcf,0x3f443fed,0x3ffd3ea0,0x3fa6bfc3
.long 0xbf96bfcf,0xc000250d,0xbf963fcf,0x3f1e3ff3,0x3ff3bf1e,0x3f44bfed,0xbf68bfe4,0xbff9beef
.long 0x80004000,0x3fb53fb5,0x4000a5d4,0x3fb5bfb5,0xbff3bf1e,0xbfed3f44,0xbf683fe4,0x3eef3ff9
.long 0x3f96bfcf,0xa58dc000,0xbf96bfcf,0xbff3bf1e,0x3f963fcf,0x3fed3f44,0x3ffdbea0,0x3fc3bfa6
.long 0xbff33f1e,0xbfb53fb5,0xbf1e3ff3,0x3ea03ffd,0xa58dc000,0xbf44bfed,0xbfb5bfb5,0xbfedbf44
.long 0x3ff33f1e,0x4000a5d4,0x3ff3bf1e,0x3fcfbf96,0xbf963fcf,0xbf443fed,0xbea03ffd,0x3e213fff
.long 0xbf96bfcf,0xbfb5bfb5,0xbfcfbf96,0xbfe4bf68,0x3ff3bf1e,0x3fedbf44,0x3fe4bf68,0x3fdabf86
.long 0xbf96bfcf,0xbff33f1e,0x80004000,0x3ff33f1e,0x4000a5d4,0x3f44bfed,0xbfb5bfb5,0xbfed3f44
.long 0xbf963fcf,0x3f683fe4,0x4000a5d4,0x3f68bfe4,0xbf1ebff3,0xbff9beef,0xbfb53fb5,0x3eef3ff9
.long 0x3ff33f1e,0x3fcfbf96,0xa58dc000,0xbfcfbf96,0xbfcf3f96,0xbe213fff,0x3fb53fb5,0x3fffbe21
.long 0xa58dc000,0xbfb5bfb5,0xc000250d,0xbfb53fb5,0x3fcf3f96,0x3fffbe21,0x3fb5bfb5,0x3e21bfff
.long 0xbff33f1e,0xbf963fcf,0x80004000,0x3f963fcf,0x3f1ebff3,0xbeefbff9,0xbfb5bfb5,0xbff9beef
.long 0x3f963fcf,0x3fe43f68,0x4000a5d4,0x3fe4bf68,0xc000250d,0xbfed3f44,0xbfb53fb5,0xbf443fed
.long 0x3f96bfcf,0x3f1ebff3,0xa58dc000,0xbf1ebff3,0x3f1e3ff3,0x3f863fda,0x3fb53fb5,0x3fda3f86
.long 0xbff3bf1e,0xbffdbea0,0xc000250d,0xbffd3ea0,0x3fcfbf96,0x3fc3bfa6,0x3fb5bfb5,0x3fa6bfc3
.long 0x3f96bfcf,0xbf96bfcf,0xbff33f1e,0x80004000,0x80004000,0x3fed3f44,0x3fb5bfb5,0xbf44bfed
.long 0xbf96bfcf,0xbffd3ea0,0xbf1e3ff3,0x3fb53fb5,0x3ff33f1e,0x3fc3bfa6,0xbea0bffd,0xbfedbf44
.long 0xbff33f1e,0xbf1e3ff3,0x3f963fcf,0x4000a5d4,0x3f96bfcf,0xbeefbff9,0xbfe4bf68,0xbfed3f44
.long 0x80004000,0x3fb53fb5,0x4000a5d4,0x3fb5bfb5,0xbf96bfcf,0xbff9beef,0xbfe43f68,0xbf443fed
.long 0x3ff33f1e,0x3ff3bf1e,0x3f96bfcf,0xa58dc000,0xbff33f1e,0xbfa63fc3,0xbea03ffd,0x3f443fed
.long 0x3f96bfcf,0x3ea0bffd,0xbf1ebff3,0xbfb5bfb5,0x80004000,0x3f443fed,0x3fb53fb5,0x3fed3f44
.long 0xbf96bfcf,0xbfcfbf96,0xbff3bf1e,0xc000250d,0x3ff33f1e,0x3fff3e21,0x3ffdbea0,0x3fedbf44
.long 0xbff33f1e,0xbfe43f68,0xbfcf3f96,0xbfb53fb5,0x3f96bfcf,0x3f86bfda,0x3f68bfe4,0x3f44bfed
.long 0x3ff33f1e,0x3f96bfcf,0xbf96bfcf,0xbff33f1e,0xc000250d,0xbf443fed,0x3fb53fb5,0x3fedbf44
.long 0x3ff3bf1e,0x3ea0bffd,0xbfcfbf96,0xbfe43f68,0xbfcf3f96,0x3e213fff,0x3fe43f68,0x3fdabf86
.long 0x3f96bfcf,0xbf1ebff3,0xbff3bf1e,0xbfcf3f96,0xbf1e3ff3,0x3f863fda,0x3ffd3ea0,0x3fc3bfa6
.long 0xa58dc000,0xbfb5bfb5,0xc000250d,0xbfb53fb5,0x3f1e3ff3,0x3fda3f86,0x3ffdbea0,0x3fa6bfc3
.long 0xbf96bfcf,0xbff3bf1e,0xbff33f1e,0xbf963fcf,0x3fcf3f96,0x3fff3e21,0x3fe4bf68,0x3f86bfda
.long 0xbff3bf1e,0xbffd3ea0,0xbfcf3f96,0xbf683fe4,0x4000a5d4,0x3fedbf44,0x3fb5bfb5,0x3f44bfed
.long 0xbff33f1e,0xbfcf3f96,0xbf963fcf,0xbf1e3ff3,0x3fcfbf96,0x3fa6bfc3,0x3f68bfe4,0x3eefbff9
.long 0xbf963fcf,0xbf683fe4,0xbf1e3ff3,0xbea03ffd,0x3f1ebff3,0x3eefbff9,0x3ea0bffd,0x3e21bfff
.long 0x3f80,0x0,0x0,0x0,0xbf80,0x0,0x0,0x0
.long 0x3f80,0x0,0x0,0x0,0xbf80,0x0,0x0,0x0
.long 0x3f80,0x0,0x0,0x0,0xbf80,0x0,0x0,0x0
.long 0x3f80,0x0,0x0,0x0,0xbf80,0x0,0x0,0x0
.long 0x3f80,0x0,0x0,0x0,0xbf80,0x0,0x0,0x0
.long 0x3f80,0x0,0x0,0x0,0xbf80,0x0,0x0,0x0
.long 0x3f80,0x0,0x0,0x0,0xbf80,0x0,0x0,0x0
.long 0x3f80,0x0,0x0,0x0,0xbf80,0x0,0x0,0x0
.long 0x0,0x0,0x0,0x0,0x0,0x0,0x0,0x0
.long 0x0,0x0,0x0,0x0,0x0,0x0,0x0,0x0
.long 0x0,0x0,0x0,0x0,0x0,0x0,0x0,0x0
.long 0x0,0x0,0x0,0x0,0x0,0x0,0x0,0x0
.long 0x0,0x0,0x0,0x0,0x0,0x0,0x0,0x0
.long 0x0,0x0,0x0,0x0,0x0,0x0,0x0,0x0
.long 0x0,0x0,0x0,0x0,0x0,0x0,0x0,0x0
.long 0x0,0x0,0x0,0x0,0x0,0x0,0x0,0x0
```
